```python
import torch

def _softmax(x, axis=-1):
    return torch.softmax(x, dim=axis)
def _gelu(x):
    return torch.nn.functional.gelu(x, approximate="tanh")
def _silu(x):
    return torch.nn.functional.silu(x)
def _sigmoid(x):
    return torch.sigmoid(x)
def _layernorm(x, axis=-1, eps=1e-5):
    m = x.mean(dim=axis, keepdim=True)
    v = x.var(dim=axis, keepdim=True, unbiased=False)
    return (x - m) / torch.sqrt(v + eps)
def _scatter_add(tgt, idx, src, axis=0):
    return tgt.clone().index_add_(axis, idx, src)
def _segment_sum(src, seg, n):
    out = torch.zeros((n,) + src.shape[1:], dtype=src.dtype)
    return out.index_add_(0, seg, src)
def _pad(x, pw):
    flat = tuple(v for pair in reversed(pw) for v in pair)
    return torch.nn.functional.pad(x, flat)

kernel_name = 'standalone__cross_network_dcn__recsys'

def setup_inputs():

    _w = (lambda a: (lambda t: t.to(torch.bfloat16) if t.is_floating_point() else t)(torch.as_tensor(a)))
    B, F, D, L = 16384, 100, 16, 3
    Din = min(F * D, 1024)
    return {
        "x0": _w((lambda *s: torch.randn(*s, dtype=torch.bfloat16) * 0.05)(B, Din)),
        "ws": _w((lambda *s: torch.randn(*s, dtype=torch.bfloat16) * 0.8)(L, Din, Din) * (Din ** -0.5)),
        "bs": _w((lambda *s: torch.randn(*s, dtype=torch.bfloat16) * 3.2)(L, Din) * 0.01),
    }

def reference(x0, ws, bs):
    x = x0
    L = ws.shape[0]
    for l in range(L):
        proj = torch.einsum('bd,de->be', x, ws[l]) + bs[l]
        x = x0 * proj + x
    return x
```

```asm
; @launch grid=(256,1,1) block=(256,1,1) lds=153600
.amdgcn_target "amdgcn-amd-amdhsa--gfx950"
.text
.globl standalone__cross_network_dcn__recsys_kernel
.p2align 8
.type standalone__cross_network_dcn__recsys_kernel,@function
standalone__cross_network_dcn__recsys_kernel:
L_cs0:
s_cmp_ge_u32 s2, 256
s_cbranch_scc1 L_done
s_load_dwordx8 s[64:71], s[0:1], 0
s_load_dwordx4 s[72:75], s[0:1], 32
s_getpc_b64 s[28:29]
L_pc:
v_lshrrev_b32 v13, 6, v0
v_and_b32 v12, 63, v0
s_sub_u32 s28, s28, L_pc-standalone__cross_network_dcn__recsys_kernel
v_readfirstlane_b32 s32, v13
s_subb_u32 s29, s29, 0
s_and_b32 s29, s29, 0xffff
s_mov_b32 s30, L_end-standalone__cross_network_dcn__recsys_kernel
s_mov_b32 s31, 0x00020000
v_lshlrev_b32 v17, 6, v0
s_bfe_u32 s5, s2, 0x30003
s_lshl_b32 s5, s5, 14
buffer_load_dword v20, v17, s[28:31], s5 offen
v_lshlrev_b32 v1, 4, v12
v_bfe_u32 v14, v0, 4, 2
v_and_b32 v15, 15, v0
v_and_b32 v16, 1, v13
v_lshl_add_u32 v16, v16, 2, v14
v_and_b32 v17, 7, v0
v_xor_b32 v16, v16, v17
v_lshlrev_b32 v8, 4, v16
v_lshrrev_b32 v16, 3, v12
v_lshl_add_u32 v8, v16, 11, v8
v_lshl_add_u32 v8, v13, 14, v8
v_lshlrev_b32 v18, 2, v0
v_lshlrev_b32 v22, 3, v0
v_and_b32 v11, 3, v0
v_lshlrev_b32 v0, 14, v14
v_and_b32 v16, 1, v15
v_lshl_add_u32 v0, v16, 11, v0
v_lshrrev_b32 v16, 1, v15
v_lshl_add_u32 v0, v16, 4, v0
s_mov_b32 s94, 0x55555555
s_mov_b32 s95, 0x55555555
s_and_b32 s92, s2, 1
s_lshr_b32 s93, s2, 1
s_lshl_b32 s37, s93, 18
s_lshl_b32 s5, s92, 10
s_add_u32 s37, s37, s5
s_xor_b32 s38, s37, 0x400
s_lshl_b32 s3, s32, 10
s_xor_b32 s39, s92, 1
s_lshl_b32 s39, s39, 20
s_add_u32 s39, s39, s5
s_lshl_b32 s40, s32, 7
s_add_u32 s6, s5, 0x1000
s_lshr_b32 s43, s2, 3
s_lshl_b32 s43, s43, 2
s_add_u32 s43, s43, s32
s_lshl_b32 s35, s43, 13
s_add_u32 s36, s35, s39
s_add_u32 s39, s39, s40
s_mov_b32 s100, 0x05040100
s_mov_b32 s101, 0x07060302
s_waitcnt lgkmcnt(0)
s_mov_b32 s8, s64
s_and_b32 s9, s65, 0xffff
s_mov_b32 s10, 0x2000000
s_mov_b32 s11, 0x00020000
s_mov_b32 s96, s66
s_and_b32 s97, s67, 0xffff
s_mov_b32 s98, 0x600000
s_mov_b32 s99, 0x00020000
s_mov_b32 s76, s68
s_and_b32 s77, s69, 0xffff
s_mov_b32 s78, 0x1800
s_mov_b32 s79, 0x00020000
s_add_u32 s40, s39, 0x0
buffer_load_dwordx4 v[128:131], v0, s[96:99], s40 offen
s_add_u32 s40, s39, 0x1000
buffer_load_dwordx4 v[132:135], v0, s[96:99], s40 offen
s_add_u32 s40, s39, 0x2000
buffer_load_dwordx4 v[136:139], v0, s[96:99], s40 offen
s_add_u32 s40, s39, 0x3000
buffer_load_dwordx4 v[140:143], v0, s[96:99], s40 offen
s_add_u32 s40, s39, 0x10000
buffer_load_dwordx4 v[144:147], v0, s[96:99], s40 offen
s_add_u32 s40, s39, 0x11000
buffer_load_dwordx4 v[148:151], v0, s[96:99], s40 offen
s_add_u32 s40, s39, 0x12000
buffer_load_dwordx4 v[152:155], v0, s[96:99], s40 offen
s_add_u32 s40, s39, 0x13000
buffer_load_dwordx4 v[156:159], v0, s[96:99], s40 offen
s_add_u32 s35, s38, 0x0
s_add_u32 m0, s3, 0x0
s_nop 0
buffer_load_dwordx4 v8, s[8:11], s35 offen nt lds
s_add_u32 s35, s35, 0x10000
s_add_u32 m0, s3, 0x1000
s_nop 0
buffer_load_dwordx4 v8, s[8:11], s35 offen nt lds
s_add_u32 s35, s35, 0x10000
s_add_u32 m0, s3, 0x2000
s_nop 0
buffer_load_dwordx4 v8, s[8:11], s35 offen nt lds
s_add_u32 s35, s35, 0x10000
s_add_u32 m0, s3, 0x3000
s_nop 0
buffer_load_dwordx4 v8, s[8:11], s35 offen nt lds
s_sub_u32 s35, s35, 196480
buffer_load_dword v19, v18, s[76:79], s5 offen
buffer_load_dword v20, v18, s[76:79], s5 offen offset:2048
buffer_load_dword v21, v18, s[76:79], s6 offen
v_lshlrev_b32 v17, 6, v15
v_lshl_add_u32 v17, v14, 11, v17
buffer_load_dword v23, v17, s[96:99], s36 offen
s_mov_b32 s16, s70
s_and_b32 s17, s71, 0xffff
s_mov_b32 s18, 0x2000000
s_mov_b32 s19, 0x00020000
s_mov_b32 s80, s72
s_and_b32 s81, s73, 0xffff
s_mov_b32 s82, 0x100
s_mov_b32 s83, 0x00020000
s_mov_b32 s12, s74
s_and_b32 s13, s75, 0xffff
s_mov_b32 s14, 0x600000
s_mov_b32 s15, 0x00020000
s_add_u32 s20, s74, 0x800000
s_addc_u32 s21, s75, 0
s_and_b32 s21, s21, 0xffff
s_mov_b32 s22, 0x4000000
s_mov_b32 s23, 0x00020000
s_add_u32 s24, s74, 0x600000
s_addc_u32 s25, s75, 0
s_and_b32 s25, s25, 0xffff
s_mov_b32 s26, 0x10000
s_mov_b32 s27, 0x00020000
s_lshl_b32 s42, s2, 8
s_lshl_b32 s41, s32, 2
s_add_u32 s41, s41, s42
s_xor_b32 s42, s42, 0x100
s_and_b32 s7, s43, 7
s_lshl_b32 s7, s7, 12
s_mul_i32 s33, s92, 0x300000
s_lshl_b32 s43, s43, 12
s_add_u32 s43, s43, s33
s_lshl_b32 s86, s93, 2
s_add_u32 s86, s86, s32
s_add_u32 s86, s86, 128
s_lshr_b32 s85, s86, 1
s_lshl_b32 s85, s85, 13
s_and_b32 s87, s86, 1
s_lshl_b32 s84, s87, 16
s_lshl_b32 s87, s87, 10
s_add_u32 s85, s85, s87
s_add_u32 s85, s85, s33
s_bfe_u32 s87, s86, 0x20001
s_lshl_b32 s87, s87, 7
s_add_u32 s84, s84, s87
s_bfe_u32 s87, s86, 0x20003
s_lshl_b32 s87, s87, 17
s_add_u32 s84, s84, s87
s_bfe_u32 s87, s86, 0x10005
s_lshl_b32 s87, s87, 9
s_add_u32 s84, s84, s87
s_bfe_u32 s87, s86, 0x10006
s_lshl_b32 s87, s87, 19
s_add_u32 s84, s84, s87
s_lshr_b32 s87, s86, 8
s_lshl_b32 s87, s87, 21
s_add_u32 s84, s84, s87
s_lshl_b32 s87, s92, 10
s_add_u32 s84, s84, s87
s_bfe_u32 s87, s86, 0x10007
s_xor_b32 s87, s87, s92
s_cmp_lt_u32 s86, 256
s_cselect_b32 s5, 1, 0
s_xor_b32 s87, s87, s5
s_lshl_b32 s87, s87, 20
s_add_u32 s84, s84, s87
s_lshl_b32 s90, s93, 2
s_add_u32 s90, s90, s32
s_add_u32 s90, s90, 640
s_lshr_b32 s89, s90, 1
s_lshl_b32 s89, s89, 13
s_and_b32 s91, s90, 1
s_lshl_b32 s88, s91, 16
s_lshl_b32 s91, s91, 10
s_add_u32 s89, s89, s91
s_add_u32 s89, s89, s33
s_bfe_u32 s91, s90, 0x20001
s_lshl_b32 s91, s91, 7
s_add_u32 s88, s88, s91
s_bfe_u32 s91, s90, 0x20003
s_lshl_b32 s91, s91, 17
s_add_u32 s88, s88, s91
s_bfe_u32 s91, s90, 0x10005
s_lshl_b32 s91, s91, 9
s_add_u32 s88, s88, s91
s_bfe_u32 s91, s90, 0x10006
s_lshl_b32 s91, s91, 19
s_add_u32 s88, s88, s91
s_lshr_b32 s91, s90, 8
s_lshl_b32 s91, s91, 21
s_add_u32 s88, s88, s91
s_lshl_b32 s91, s92, 10
s_add_u32 s88, s88, s91
s_bfe_u32 s91, s90, 0x10007
s_xor_b32 s91, s91, s92
s_cmp_lt_u32 s90, 256
s_cselect_b32 s5, 1, 0
s_xor_b32 s91, s91, s5
s_lshl_b32 s91, s91, 20
s_add_u32 s88, s88, s91
s_cmp_ge_u32 s90, 768
s_cselect_b32 s88, 0x40000000, s88
s_cselect_b32 s89, 0x40000000, s89
s_lshl_b32 s5, s32, 13
s_add_u32 s33, s33, s5
s_add_u32 s33, s33, 0x80000
s_add_u32 s34, s33, 0x1000
v_lshlrev_b32 v11, 2, v11
v_lshlrev_b32 v10, 6, v14
v_lshl_add_u32 v10, v13, 8, v10
v_add_u32 v10, 0x20000, v10
v_lshrrev_b32 v16, 1, v15
v_xor_b32 v17, v16, v14
v_lshlrev_b32 v2, 4, v17
v_lshl_add_u32 v2, v15, 7, v2
v_xor_b32 v3, 64, v2
v_lshlrev_b32 v17, 1, v14
v_xor_b32 v17, v16, v17
v_lshlrev_b32 v4, 4, v17
v_lshl_add_u32 v4, v15, 7, v4
v_lshl_add_u32 v4, v13, 14, v4
v_xor_b32 v5, 16, v4
v_and_b32 v16, 7, v12
v_lshrrev_b32 v17, 3, v12
v_xor_b32 v6, v16, v14
v_lshlrev_b32 v6, 4, v6
v_lshl_add_u32 v6, v17, 7, v6
v_lshl_add_u32 v6, v13, 14, v6
v_xor_b32 v7, 64, v6
v_lshlrev_b32 v9, 11, v17
v_lshl_add_u32 v9, v16, 4, v9
v_lshl_add_u32 v9, v13, 7, v9
v_add_u32 v22, 0x20000, v22
v_lshlrev_b32 v17, 14, v14
v_lshl_add_u32 v17, v15, 3, v17
s_add_u32 s40, s39, 0x200
buffer_load_dwordx4 v[160:163], v0, s[96:99], s40 offen
s_add_u32 s40, s39, 0x1200
buffer_load_dwordx4 v[164:167], v0, s[96:99], s40 offen
s_add_u32 s40, s39, 0x2200
buffer_load_dwordx4 v[168:171], v0, s[96:99], s40 offen
s_add_u32 s40, s39, 0x3200
buffer_load_dwordx4 v[172:175], v0, s[96:99], s40 offen
s_add_u32 s40, s39, 0x10200
buffer_load_dwordx4 v[176:179], v0, s[96:99], s40 offen
s_add_u32 s40, s39, 0x11200
buffer_load_dwordx4 v[180:183], v0, s[96:99], s40 offen
s_add_u32 s40, s39, 0x12200
buffer_load_dwordx4 v[184:187], v0, s[96:99], s40 offen
s_add_u32 s40, s39, 0x13200
buffer_load_dwordx4 v[188:191], v0, s[96:99], s40 offen
s_add_u32 s40, s39, 0x20000
buffer_load_dwordx4 v[192:195], v0, s[96:99], s40 offen
s_add_u32 s40, s39, 0x21000
buffer_load_dwordx4 v[196:199], v0, s[96:99], s40 offen
s_add_u32 s40, s39, 0x22000
buffer_load_dwordx4 v[200:203], v0, s[96:99], s40 offen
s_add_u32 s40, s39, 0x23000
buffer_load_dwordx4 v[204:207], v0, s[96:99], s40 offen
s_add_u32 s40, s39, 0x30000
buffer_load_dwordx4 v[208:211], v0, s[96:99], s40 offen
s_add_u32 s40, s39, 0x31000
buffer_load_dwordx4 v[212:215], v0, s[96:99], s40 offen
s_add_u32 s40, s39, 0x32000
buffer_load_dwordx4 v[216:219], v0, s[96:99], s40 offen
s_add_u32 s40, s39, 0x33000
buffer_load_dwordx4 v[220:223], v0, s[96:99], s40 offen
s_waitcnt vmcnt(31)
s_mov_b64 vcc, s[94:95]
v_cndmask_b32_dpp v36, v130, v128, vcc quad_perm:[1,0,3,2] row_mask:0xf bank_mask:0xf
v_cndmask_b32_dpp v37, v131, v129, vcc quad_perm:[1,0,3,2] row_mask:0xf bank_mask:0xf
s_not_b64 vcc, s[94:95]
v_cndmask_b32_dpp v130, v128, v130, vcc quad_perm:[1,0,3,2] row_mask:0xf bank_mask:0xf
v_cndmask_b32_dpp v131, v129, v131, vcc quad_perm:[1,0,3,2] row_mask:0xf bank_mask:0xf
v_perm_b32 v64, v130, v36, s100
v_perm_b32 v72, v130, v36, s101
v_perm_b32 v80, v131, v37, s100
v_perm_b32 v88, v131, v37, s101
s_add_u32 s40, s39, 0x20200
buffer_load_dwordx4 v[128:131], v0, s[96:99], s40 offen
s_waitcnt vmcnt(31)
s_mov_b64 vcc, s[94:95]
v_cndmask_b32_dpp v36, v134, v132, vcc quad_perm:[1,0,3,2] row_mask:0xf bank_mask:0xf
v_cndmask_b32_dpp v37, v135, v133, vcc quad_perm:[1,0,3,2] row_mask:0xf bank_mask:0xf
s_not_b64 vcc, s[94:95]
v_cndmask_b32_dpp v134, v132, v134, vcc quad_perm:[1,0,3,2] row_mask:0xf bank_mask:0xf
v_cndmask_b32_dpp v135, v133, v135, vcc quad_perm:[1,0,3,2] row_mask:0xf bank_mask:0xf
v_perm_b32 v65, v134, v36, s100
v_perm_b32 v73, v134, v36, s101
v_perm_b32 v81, v135, v37, s100
v_perm_b32 v89, v135, v37, s101
s_add_u32 s40, s39, 0x21200
buffer_load_dwordx4 v[132:135], v0, s[96:99], s40 offen
s_waitcnt vmcnt(31)
s_mov_b64 vcc, s[94:95]
v_cndmask_b32_dpp v36, v138, v136, vcc quad_perm:[1,0,3,2] row_mask:0xf bank_mask:0xf
v_cndmask_b32_dpp v37, v139, v137, vcc quad_perm:[1,0,3,2] row_mask:0xf bank_mask:0xf
s_not_b64 vcc, s[94:95]
v_cndmask_b32_dpp v138, v136, v138, vcc quad_perm:[1,0,3,2] row_mask:0xf bank_mask:0xf
v_cndmask_b32_dpp v139, v137, v139, vcc quad_perm:[1,0,3,2] row_mask:0xf bank_mask:0xf
v_perm_b32 v66, v138, v36, s100
v_perm_b32 v74, v138, v36, s101
v_perm_b32 v82, v139, v37, s100
v_perm_b32 v90, v139, v37, s101
s_add_u32 s40, s39, 0x22200
buffer_load_dwordx4 v[136:139], v0, s[96:99], s40 offen
s_waitcnt vmcnt(31)
s_mov_b64 vcc, s[94:95]
v_cndmask_b32_dpp v36, v142, v140, vcc quad_perm:[1,0,3,2] row_mask:0xf bank_mask:0xf
v_cndmask_b32_dpp v37, v143, v141, vcc quad_perm:[1,0,3,2] row_mask:0xf bank_mask:0xf
s_not_b64 vcc, s[94:95]
v_cndmask_b32_dpp v142, v140, v142, vcc quad_perm:[1,0,3,2] row_mask:0xf bank_mask:0xf
v_cndmask_b32_dpp v143, v141, v143, vcc quad_perm:[1,0,3,2] row_mask:0xf bank_mask:0xf
v_perm_b32 v67, v142, v36, s100
v_perm_b32 v75, v142, v36, s101
v_perm_b32 v83, v143, v37, s100
v_perm_b32 v91, v143, v37, s101
s_add_u32 s40, s39, 0x23200
buffer_load_dwordx4 v[140:143], v0, s[96:99], s40 offen
s_waitcnt vmcnt(31)
s_mov_b64 vcc, s[94:95]
v_cndmask_b32_dpp v36, v146, v144, vcc quad_perm:[1,0,3,2] row_mask:0xf bank_mask:0xf
v_cndmask_b32_dpp v37, v147, v145, vcc quad_perm:[1,0,3,2] row_mask:0xf bank_mask:0xf
s_not_b64 vcc, s[94:95]
v_cndmask_b32_dpp v146, v144, v146, vcc quad_perm:[1,0,3,2] row_mask:0xf bank_mask:0xf
v_cndmask_b32_dpp v147, v145, v147, vcc quad_perm:[1,0,3,2] row_mask:0xf bank_mask:0xf
v_perm_b32 v68, v146, v36, s100
v_perm_b32 v76, v146, v36, s101
v_perm_b32 v84, v147, v37, s100
v_perm_b32 v92, v147, v37, s101
s_add_u32 s40, s39, 0x30200
buffer_load_dwordx4 v[144:147], v0, s[96:99], s40 offen
s_waitcnt vmcnt(31)
s_mov_b64 vcc, s[94:95]
v_cndmask_b32_dpp v36, v150, v148, vcc quad_perm:[1,0,3,2] row_mask:0xf bank_mask:0xf
v_cndmask_b32_dpp v37, v151, v149, vcc quad_perm:[1,0,3,2] row_mask:0xf bank_mask:0xf
s_not_b64 vcc, s[94:95]
v_cndmask_b32_dpp v150, v148, v150, vcc quad_perm:[1,0,3,2] row_mask:0xf bank_mask:0xf
v_cndmask_b32_dpp v151, v149, v151, vcc quad_perm:[1,0,3,2] row_mask:0xf bank_mask:0xf
v_perm_b32 v69, v150, v36, s100
v_perm_b32 v77, v150, v36, s101
v_perm_b32 v85, v151, v37, s100
v_perm_b32 v93, v151, v37, s101
s_add_u32 s40, s39, 0x31200
buffer_load_dwordx4 v[148:151], v0, s[96:99], s40 offen
s_waitcnt vmcnt(31)
s_mov_b64 vcc, s[94:95]
v_cndmask_b32_dpp v36, v154, v152, vcc quad_perm:[1,0,3,2] row_mask:0xf bank_mask:0xf
v_cndmask_b32_dpp v37, v155, v153, vcc quad_perm:[1,0,3,2] row_mask:0xf bank_mask:0xf
s_not_b64 vcc, s[94:95]
v_cndmask_b32_dpp v154, v152, v154, vcc quad_perm:[1,0,3,2] row_mask:0xf bank_mask:0xf
v_cndmask_b32_dpp v155, v153, v155, vcc quad_perm:[1,0,3,2] row_mask:0xf bank_mask:0xf
v_perm_b32 v70, v154, v36, s100
v_perm_b32 v78, v154, v36, s101
v_perm_b32 v86, v155, v37, s100
v_perm_b32 v94, v155, v37, s101
s_add_u32 s40, s39, 0x32200
buffer_load_dwordx4 v[152:155], v0, s[96:99], s40 offen
s_waitcnt vmcnt(31)
s_mov_b64 vcc, s[94:95]
v_cndmask_b32_dpp v36, v158, v156, vcc quad_perm:[1,0,3,2] row_mask:0xf bank_mask:0xf
v_cndmask_b32_dpp v37, v159, v157, vcc quad_perm:[1,0,3,2] row_mask:0xf bank_mask:0xf
s_not_b64 vcc, s[94:95]
v_cndmask_b32_dpp v158, v156, v158, vcc quad_perm:[1,0,3,2] row_mask:0xf bank_mask:0xf
v_cndmask_b32_dpp v159, v157, v159, vcc quad_perm:[1,0,3,2] row_mask:0xf bank_mask:0xf
v_perm_b32 v71, v158, v36, s100
v_perm_b32 v79, v158, v36, s101
v_perm_b32 v87, v159, v37, s100
v_perm_b32 v95, v159, v37, s101
s_add_u32 s40, s39, 0x33200
buffer_load_dwordx4 v[156:159], v0, s[96:99], s40 offen
s_waitcnt vmcnt(25)
v_lshlrev_b32 v24, 16, v19
v_and_b32 v25, 0xffff0000, v19
v_lshlrev_b32 v26, 16, v20
v_and_b32 v27, 0xffff0000, v20
v_lshlrev_b32 v28, 16, v21
v_and_b32 v29, 0xffff0000, v21
v_add_f32 v30, 1.0, v24
v_mov_b32 v32, v26
v_mov_b32 v34, v28
v_add_f32 v31, 1.0, v25
v_mov_b32 v33, v27
v_mov_b32 v35, v29
ds_write_b64 v22, v[30:31] offset:0
ds_write_b64 v22, v[32:33] offset:2048
ds_write_b64 v22, v[34:35] offset:4096
s_waitcnt lgkmcnt(0)
s_barrier
s_add_u32 s33, s33, 0x0
s_add_u32 s34, s33, 0x1000
ds_read_b128 v[24:27], v10 offset:0
ds_read_b128 v[28:31], v10 offset:16
ds_read_b128 v[32:35], v10 offset:32
ds_read_b128 v[36:39], v10 offset:48
ds_read_b128 v[40:43], v2 offset:0
ds_read_b128 v[44:47], v3 offset:0
ds_read_b128 v[48:51], v2 offset:2048
ds_read_b128 v[52:55], v3 offset:2048
s_waitcnt lgkmcnt(4)
v_accvgpr_write_b32 a112, v24
v_accvgpr_write_b32 a116, v25
v_accvgpr_write_b32 a120, v26
v_accvgpr_write_b32 a124, v27
v_accvgpr_write_b32 a113, v28
v_accvgpr_write_b32 a117, v29
v_accvgpr_write_b32 a121, v30
v_accvgpr_write_b32 a125, v31
v_accvgpr_write_b32 a114, v32
v_accvgpr_write_b32 a118, v33
v_accvgpr_write_b32 a122, v34
v_accvgpr_write_b32 a126, v35
v_accvgpr_write_b32 a115, v36
v_accvgpr_write_b32 a119, v37
v_accvgpr_write_b32 a123, v38
v_accvgpr_write_b32 a127, v39
s_waitcnt lgkmcnt(2)
v_mfma_f32_16x16x32_bf16 a[0:3], v[64:67], v[40:43], a[112:115]
ds_read_b128 v[56:59], v2 offset:4096
v_mfma_f32_16x16x32_bf16 a[0:3], v[68:71], v[44:47], a[0:3]
ds_read_b128 v[60:63], v3 offset:4096
v_mfma_f32_16x16x32_bf16 a[4:7], v[72:75], v[40:43], a[116:119]
s_waitcnt vmcnt(23)
s_mov_b64 vcc, s[94:95]
v_cndmask_b32_dpp v18, v162, v160, vcc quad_perm:[1,0,3,2] row_mask:0xf bank_mask:0xf
v_cndmask_b32_dpp v19, v163, v161, vcc quad_perm:[1,0,3,2] row_mask:0xf bank_mask:0xf
v_mfma_f32_16x16x32_bf16 a[4:7], v[76:79], v[44:47], a[4:7]
s_not_b64 vcc, s[94:95]
v_cndmask_b32_dpp v162, v160, v162, vcc quad_perm:[1,0,3,2] row_mask:0xf bank_mask:0xf
v_cndmask_b32_dpp v163, v161, v163, vcc quad_perm:[1,0,3,2] row_mask:0xf bank_mask:0xf
v_mfma_f32_16x16x32_bf16 a[8:11], v[80:83], v[40:43], a[120:123]
v_perm_b32 v96, v162, v18, s100
v_perm_b32 v104, v162, v18, s101
s_add_u32 m0, s3, 0x4000
v_mfma_f32_16x16x32_bf16 a[8:11], v[84:87], v[44:47], a[8:11]
v_perm_b32 v112, v163, v19, s100
v_perm_b32 v120, v163, v19, s101
buffer_load_dwordx4 v8, s[8:11], s35 offen nt lds
s_add_u32 s35, s35, 0x10000
v_mfma_f32_16x16x32_bf16 a[12:15], v[88:91], v[40:43], a[124:127]
s_add_u32 s40, s39, 0x40000
buffer_load_dwordx4 v[160:163], v0, s[96:99], s40 offen
s_add_u32 m0, s3, 0x5000
v_mfma_f32_16x16x32_bf16 a[12:15], v[92:95], v[44:47], a[12:15]
buffer_load_dwordx4 v8, s[8:11], s35 offen nt lds
s_add_u32 s35, s35, 0x10000
s_waitcnt lgkmcnt(2)
v_mfma_f32_16x16x32_bf16 a[16:19], v[64:67], v[48:51], a[112:115]
ds_read_b128 v[40:43], v2 offset:6144
s_add_u32 m0, s3, 0x6000
v_mfma_f32_16x16x32_bf16 a[16:19], v[68:71], v[52:55], a[16:19]
ds_read_b128 v[44:47], v3 offset:6144
buffer_load_dwordx4 v8, s[8:11], s35 offen nt lds
s_add_u32 s35, s35, 0x10000
v_mfma_f32_16x16x32_bf16 a[20:23], v[72:75], v[48:51], a[116:119]
s_waitcnt vmcnt(26)
s_mov_b64 vcc, s[94:95]
v_cndmask_b32_dpp v18, v166, v164, vcc quad_perm:[1,0,3,2] row_mask:0xf bank_mask:0xf
v_cndmask_b32_dpp v19, v167, v165, vcc quad_perm:[1,0,3,2] row_mask:0xf bank_mask:0xf
s_add_u32 m0, s3, 0x7000
v_mfma_f32_16x16x32_bf16 a[20:23], v[76:79], v[52:55], a[20:23]
s_not_b64 vcc, s[94:95]
v_cndmask_b32_dpp v166, v164, v166, vcc quad_perm:[1,0,3,2] row_mask:0xf bank_mask:0xf
v_cndmask_b32_dpp v167, v165, v167, vcc quad_perm:[1,0,3,2] row_mask:0xf bank_mask:0xf
buffer_load_dwordx4 v8, s[8:11], s35 offen nt lds
s_sub_u32 s35, s35, 196480
v_mfma_f32_16x16x32_bf16 a[24:27], v[80:83], v[48:51], a[120:123]
v_perm_b32 v97, v166, v18, s100
v_perm_b32 v105, v166, v18, s101
v_mfma_f32_16x16x32_bf16 a[24:27], v[84:87], v[52:55], a[24:27]
v_perm_b32 v113, v167, v19, s100
v_perm_b32 v121, v167, v19, s101
v_mfma_f32_16x16x32_bf16 a[28:31], v[88:91], v[48:51], a[124:127]
s_add_u32 s40, s39, 0x41000
buffer_load_dwordx4 v[164:167], v0, s[96:99], s40 offen
v_mfma_f32_16x16x32_bf16 a[28:31], v[92:95], v[52:55], a[28:31]
s_waitcnt lgkmcnt(2)
v_mfma_f32_16x16x32_bf16 a[32:35], v[64:67], v[56:59], a[112:115]
ds_read_b128 v[48:51], v2 offset:8192
v_mfma_f32_16x16x32_bf16 a[32:35], v[68:71], v[60:63], a[32:35]
ds_read_b128 v[52:55], v3 offset:8192
v_mfma_f32_16x16x32_bf16 a[36:39], v[72:75], v[56:59], a[116:119]
s_waitcnt vmcnt(27)
s_mov_b64 vcc, s[94:95]
v_cndmask_b32_dpp v18, v170, v168, vcc quad_perm:[1,0,3,2] row_mask:0xf bank_mask:0xf
v_cndmask_b32_dpp v19, v171, v169, vcc quad_perm:[1,0,3,2] row_mask:0xf bank_mask:0xf
v_mfma_f32_16x16x32_bf16 a[36:39], v[76:79], v[60:63], a[36:39]
s_not_b64 vcc, s[94:95]
v_cndmask_b32_dpp v170, v168, v170, vcc quad_perm:[1,0,3,2] row_mask:0xf bank_mask:0xf
v_cndmask_b32_dpp v171, v169, v171, vcc quad_perm:[1,0,3,2] row_mask:0xf bank_mask:0xf
v_mfma_f32_16x16x32_bf16 a[40:43], v[80:83], v[56:59], a[120:123]
v_perm_b32 v98, v170, v18, s100
v_perm_b32 v106, v170, v18, s101
v_mfma_f32_16x16x32_bf16 a[40:43], v[84:87], v[60:63], a[40:43]
v_perm_b32 v114, v171, v19, s100
v_perm_b32 v122, v171, v19, s101
v_mfma_f32_16x16x32_bf16 a[44:47], v[88:91], v[56:59], a[124:127]
s_add_u32 s40, s39, 0x42000
buffer_load_dwordx4 v[168:171], v0, s[96:99], s40 offen
v_mfma_f32_16x16x32_bf16 a[44:47], v[92:95], v[60:63], a[44:47]
s_waitcnt lgkmcnt(2)
v_mfma_f32_16x16x32_bf16 a[48:51], v[64:67], v[40:43], a[112:115]
ds_read_b128 v[56:59], v2 offset:10240
v_mfma_f32_16x16x32_bf16 a[48:51], v[68:71], v[44:47], a[48:51]
ds_read_b128 v[60:63], v3 offset:10240
v_mfma_f32_16x16x32_bf16 a[52:55], v[72:75], v[40:43], a[116:119]
s_waitcnt vmcnt(27)
s_mov_b64 vcc, s[94:95]
v_cndmask_b32_dpp v18, v174, v172, vcc quad_perm:[1,0,3,2] row_mask:0xf bank_mask:0xf
v_cndmask_b32_dpp v19, v175, v173, vcc quad_perm:[1,0,3,2] row_mask:0xf bank_mask:0xf
v_mfma_f32_16x16x32_bf16 a[52:55], v[76:79], v[44:47], a[52:55]
s_not_b64 vcc, s[94:95]
v_cndmask_b32_dpp v174, v172, v174, vcc quad_perm:[1,0,3,2] row_mask:0xf bank_mask:0xf
v_cndmask_b32_dpp v175, v173, v175, vcc quad_perm:[1,0,3,2] row_mask:0xf bank_mask:0xf
v_mfma_f32_16x16x32_bf16 a[56:59], v[80:83], v[40:43], a[120:123]
v_perm_b32 v99, v174, v18, s100
v_perm_b32 v107, v174, v18, s101
v_mfma_f32_16x16x32_bf16 a[56:59], v[84:87], v[44:47], a[56:59]
v_perm_b32 v115, v175, v19, s100
v_perm_b32 v123, v175, v19, s101
v_mfma_f32_16x16x32_bf16 a[60:63], v[88:91], v[40:43], a[124:127]
s_add_u32 s40, s39, 0x43000
buffer_load_dwordx4 v[172:175], v0, s[96:99], s40 offen
v_mfma_f32_16x16x32_bf16 a[60:63], v[92:95], v[44:47], a[60:63]
s_waitcnt lgkmcnt(2)
v_mfma_f32_16x16x32_bf16 a[64:67], v[64:67], v[48:51], a[112:115]
ds_read_b128 v[40:43], v2 offset:12288
v_mfma_f32_16x16x32_bf16 a[64:67], v[68:71], v[52:55], a[64:67]
ds_read_b128 v[44:47], v3 offset:12288
ds_read_b128 v[24:27], v10 offset:1024
v_mfma_f32_16x16x32_bf16 a[68:71], v[72:75], v[48:51], a[116:119]
s_waitcnt vmcnt(27)
s_mov_b64 vcc, s[94:95]
v_cndmask_b32_dpp v18, v178, v176, vcc quad_perm:[1,0,3,2] row_mask:0xf bank_mask:0xf
v_cndmask_b32_dpp v19, v179, v177, vcc quad_perm:[1,0,3,2] row_mask:0xf bank_mask:0xf
v_mfma_f32_16x16x32_bf16 a[68:71], v[76:79], v[52:55], a[68:71]
s_not_b64 vcc, s[94:95]
v_cndmask_b32_dpp v178, v176, v178, vcc quad_perm:[1,0,3,2] row_mask:0xf bank_mask:0xf
v_cndmask_b32_dpp v179, v177, v179, vcc quad_perm:[1,0,3,2] row_mask:0xf bank_mask:0xf
v_mfma_f32_16x16x32_bf16 a[72:75], v[80:83], v[48:51], a[120:123]
v_perm_b32 v100, v178, v18, s100
v_perm_b32 v108, v178, v18, s101
v_mfma_f32_16x16x32_bf16 a[72:75], v[84:87], v[52:55], a[72:75]
v_perm_b32 v116, v179, v19, s100
v_perm_b32 v124, v179, v19, s101
v_mfma_f32_16x16x32_bf16 a[76:79], v[88:91], v[48:51], a[124:127]
s_add_u32 s40, s39, 0x50000
buffer_load_dwordx4 v[176:179], v0, s[96:99], s40 offen
v_mfma_f32_16x16x32_bf16 a[76:79], v[92:95], v[52:55], a[76:79]
s_waitcnt lgkmcnt(3)
v_mfma_f32_16x16x32_bf16 a[80:83], v[64:67], v[56:59], a[112:115]
ds_read_b128 v[48:51], v2 offset:14336
ds_read_b128 v[28:31], v10 offset:1040
v_mfma_f32_16x16x32_bf16 a[80:83], v[68:71], v[60:63], a[80:83]
ds_read_b128 v[52:55], v3 offset:14336
ds_read_b128 v[32:35], v10 offset:1056
v_mfma_f32_16x16x32_bf16 a[84:87], v[72:75], v[56:59], a[116:119]
s_waitcnt vmcnt(27)
s_mov_b64 vcc, s[94:95]
v_cndmask_b32_dpp v18, v182, v180, vcc quad_perm:[1,0,3,2] row_mask:0xf bank_mask:0xf
v_cndmask_b32_dpp v19, v183, v181, vcc quad_perm:[1,0,3,2] row_mask:0xf bank_mask:0xf
v_mfma_f32_16x16x32_bf16 a[84:87], v[76:79], v[60:63], a[84:87]
s_not_b64 vcc, s[94:95]
v_cndmask_b32_dpp v182, v180, v182, vcc quad_perm:[1,0,3,2] row_mask:0xf bank_mask:0xf
v_cndmask_b32_dpp v183, v181, v183, vcc quad_perm:[1,0,3,2] row_mask:0xf bank_mask:0xf
v_mfma_f32_16x16x32_bf16 a[88:91], v[80:83], v[56:59], a[120:123]
v_perm_b32 v101, v182, v18, s100
v_perm_b32 v109, v182, v18, s101
v_mfma_f32_16x16x32_bf16 a[88:91], v[84:87], v[60:63], a[88:91]
v_perm_b32 v117, v183, v19, s100
v_perm_b32 v125, v183, v19, s101
v_mfma_f32_16x16x32_bf16 a[92:95], v[88:91], v[56:59], a[124:127]
s_add_u32 s40, s39, 0x51000
buffer_load_dwordx4 v[180:183], v0, s[96:99], s40 offen
v_mfma_f32_16x16x32_bf16 a[92:95], v[92:95], v[60:63], a[92:95]
ds_read_b128 v[36:39], v10 offset:1072
s_waitcnt lgkmcnt(0)
v_accvgpr_write_b32 a240, v24
v_accvgpr_write_b32 a244, v25
v_mfma_f32_16x16x32_bf16 a[96:99], v[64:67], v[40:43], a[112:115]
ds_read_b128 v[56:59], v2 offset:0
v_accvgpr_write_b32 a248, v26
v_accvgpr_write_b32 a252, v27
v_mfma_f32_16x16x32_bf16 a[96:99], v[68:71], v[44:47], a[96:99]
ds_read_b128 v[60:63], v3 offset:0
v_accvgpr_write_b32 a241, v28
v_accvgpr_write_b32 a245, v29
v_mfma_f32_16x16x32_bf16 a[100:103], v[72:75], v[40:43], a[116:119]
s_waitcnt vmcnt(27)
s_mov_b64 vcc, s[94:95]
v_cndmask_b32_dpp v18, v186, v184, vcc quad_perm:[1,0,3,2] row_mask:0xf bank_mask:0xf
v_cndmask_b32_dpp v19, v187, v185, vcc quad_perm:[1,0,3,2] row_mask:0xf bank_mask:0xf
v_mfma_f32_16x16x32_bf16 a[100:103], v[76:79], v[44:47], a[100:103]
s_not_b64 vcc, s[94:95]
v_cndmask_b32_dpp v186, v184, v186, vcc quad_perm:[1,0,3,2] row_mask:0xf bank_mask:0xf
v_cndmask_b32_dpp v187, v185, v187, vcc quad_perm:[1,0,3,2] row_mask:0xf bank_mask:0xf
v_mfma_f32_16x16x32_bf16 a[104:107], v[80:83], v[40:43], a[120:123]
v_perm_b32 v102, v186, v18, s100
v_perm_b32 v110, v186, v18, s101
v_mfma_f32_16x16x32_bf16 a[104:107], v[84:87], v[44:47], a[104:107]
v_perm_b32 v118, v187, v19, s100
v_perm_b32 v126, v187, v19, s101
v_accvgpr_write_b32 a249, v30
v_accvgpr_write_b32 a253, v31
v_mfma_f32_16x16x32_bf16 a[108:111], v[88:91], v[40:43], a[124:127]
s_waitcnt vmcnt(26)
s_mov_b64 vcc, s[94:95]
v_cndmask_b32_dpp v18, v190, v188, vcc quad_perm:[1,0,3,2] row_mask:0xf bank_mask:0xf
v_cndmask_b32_dpp v19, v191, v189, vcc quad_perm:[1,0,3,2] row_mask:0xf bank_mask:0xf
v_accvgpr_write_b32 a242, v32
v_mfma_f32_16x16x32_bf16 a[108:111], v[92:95], v[44:47], a[108:111]
s_not_b64 vcc, s[94:95]
v_cndmask_b32_dpp v190, v188, v190, vcc quad_perm:[1,0,3,2] row_mask:0xf bank_mask:0xf
v_cndmask_b32_dpp v191, v189, v191, vcc quad_perm:[1,0,3,2] row_mask:0xf bank_mask:0xf
v_accvgpr_write_b32 a246, v33
v_accvgpr_write_b32 a250, v34
v_accvgpr_write_b32 a254, v35
v_accvgpr_write_b32 a243, v36
v_accvgpr_write_b32 a247, v37
v_accvgpr_write_b32 a251, v38
v_accvgpr_write_b32 a255, v39
v_mfma_f32_16x16x32_bf16 a[112:115], v[64:67], v[48:51], a[112:115]
ds_read_b128 v[40:43], v2 offset:2048
v_perm_b32 v103, v190, v18, s100
v_perm_b32 v111, v190, v18, s101
v_mfma_f32_16x16x32_bf16 a[112:115], v[68:71], v[52:55], a[112:115]
ds_read_b128 v[44:47], v3 offset:2048
v_perm_b32 v119, v191, v19, s100
v_perm_b32 v127, v191, v19, s101
v_mfma_f32_16x16x32_bf16 a[116:119], v[72:75], v[48:51], a[116:119]
s_add_u32 s40, s39, 0x52000
buffer_load_dwordx4 v[184:187], v0, s[96:99], s40 offen
v_mfma_f32_16x16x32_bf16 a[116:119], v[76:79], v[52:55], a[116:119]
v_mfma_f32_16x16x32_bf16 a[120:123], v[80:83], v[48:51], a[120:123]
s_add_u32 s40, s39, 0x53000
buffer_load_dwordx4 v[188:191], v0, s[96:99], s40 offen
v_mfma_f32_16x16x32_bf16 a[120:123], v[84:87], v[52:55], a[120:123]
v_mfma_f32_16x16x32_bf16 a[124:127], v[88:91], v[48:51], a[124:127]
v_mfma_f32_16x16x32_bf16 a[124:127], v[92:95], v[52:55], a[124:127]
s_waitcnt lgkmcnt(2)
v_mfma_f32_16x16x32_bf16 a[128:131], v[96:99], v[56:59], a[240:243]
ds_read_b128 v[48:51], v2 offset:4096
v_mfma_f32_16x16x32_bf16 a[128:131], v[100:103], v[60:63], a[128:131]
ds_read_b128 v[52:55], v3 offset:4096
v_mfma_f32_16x16x32_bf16 a[132:135], v[104:107], v[56:59], a[244:247]
s_waitcnt vmcnt(27)
s_mov_b64 vcc, s[94:95]
v_cndmask_b32_dpp v18, v194, v192, vcc quad_perm:[1,0,3,2] row_mask:0xf bank_mask:0xf
v_cndmask_b32_dpp v19, v195, v193, vcc quad_perm:[1,0,3,2] row_mask:0xf bank_mask:0xf
v_mfma_f32_16x16x32_bf16 a[132:135], v[108:111], v[60:63], a[132:135]
s_not_b64 vcc, s[94:95]
v_cndmask_b32_dpp v194, v192, v194, vcc quad_perm:[1,0,3,2] row_mask:0xf bank_mask:0xf
v_cndmask_b32_dpp v195, v193, v195, vcc quad_perm:[1,0,3,2] row_mask:0xf bank_mask:0xf
v_mfma_f32_16x16x32_bf16 a[136:139], v[112:115], v[56:59], a[248:251]
v_perm_b32 v64, v194, v18, s100
v_perm_b32 v72, v194, v18, s101
s_add_u32 m0, s3, 0x8000
v_mfma_f32_16x16x32_bf16 a[136:139], v[116:119], v[60:63], a[136:139]
v_perm_b32 v80, v195, v19, s100
v_perm_b32 v88, v195, v19, s101
buffer_load_dwordx4 v8, s[8:11], s35 offen nt lds
s_add_u32 s35, s35, 0x10000
v_mfma_f32_16x16x32_bf16 a[140:143], v[120:123], v[56:59], a[252:255]
s_add_u32 s40, s39, 0x40200
buffer_load_dwordx4 v[192:195], v0, s[96:99], s40 offen
s_add_u32 m0, s3, 0x9000
v_mfma_f32_16x16x32_bf16 a[140:143], v[124:127], v[60:63], a[140:143]
buffer_load_dwordx4 v8, s[8:11], s35 offen nt lds
s_add_u32 s35, s35, 0x10000
s_waitcnt lgkmcnt(2)
v_mfma_f32_16x16x32_bf16 a[144:147], v[96:99], v[40:43], a[240:243]
ds_read_b128 v[56:59], v2 offset:6144
s_add_u32 m0, s3, 0xa000
v_mfma_f32_16x16x32_bf16 a[144:147], v[100:103], v[44:47], a[144:147]
ds_read_b128 v[60:63], v3 offset:6144
buffer_load_dwordx4 v8, s[8:11], s35 offen nt lds
s_add_u32 s35, s35, 0x10000
v_mfma_f32_16x16x32_bf16 a[148:151], v[104:107], v[40:43], a[244:247]
s_waitcnt vmcnt(30)
s_mov_b64 vcc, s[94:95]
v_cndmask_b32_dpp v18, v198, v196, vcc quad_perm:[1,0,3,2] row_mask:0xf bank_mask:0xf
v_cndmask_b32_dpp v19, v199, v197, vcc quad_perm:[1,0,3,2] row_mask:0xf bank_mask:0xf
s_add_u32 m0, s3, 0xb000
v_mfma_f32_16x16x32_bf16 a[148:151], v[108:111], v[44:47], a[148:151]
s_not_b64 vcc, s[94:95]
v_cndmask_b32_dpp v198, v196, v198, vcc quad_perm:[1,0,3,2] row_mask:0xf bank_mask:0xf
v_cndmask_b32_dpp v199, v197, v199, vcc quad_perm:[1,0,3,2] row_mask:0xf bank_mask:0xf
buffer_load_dwordx4 v8, s[8:11], s35 offen nt lds
s_sub_u32 s35, s35, 196480
v_mfma_f32_16x16x32_bf16 a[152:155], v[112:115], v[40:43], a[248:251]
v_perm_b32 v65, v198, v18, s100
v_perm_b32 v73, v198, v18, s101
v_mfma_f32_16x16x32_bf16 a[152:155], v[116:119], v[44:47], a[152:155]
v_perm_b32 v81, v199, v19, s100
v_perm_b32 v89, v199, v19, s101
v_mfma_f32_16x16x32_bf16 a[156:159], v[120:123], v[40:43], a[252:255]
s_add_u32 s40, s39, 0x41200
buffer_load_dwordx4 v[196:199], v0, s[96:99], s40 offen
v_mfma_f32_16x16x32_bf16 a[156:159], v[124:127], v[44:47], a[156:159]
s_waitcnt lgkmcnt(2)
v_mfma_f32_16x16x32_bf16 a[160:163], v[96:99], v[48:51], a[240:243]
ds_read_b128 v[40:43], v2 offset:8192
v_mfma_f32_16x16x32_bf16 a[160:163], v[100:103], v[52:55], a[160:163]
ds_read_b128 v[44:47], v3 offset:8192
v_mfma_f32_16x16x32_bf16 a[164:167], v[104:107], v[48:51], a[244:247]
s_waitcnt vmcnt(31)
s_mov_b64 vcc, s[94:95]
v_cndmask_b32_dpp v18, v202, v200, vcc quad_perm:[1,0,3,2] row_mask:0xf bank_mask:0xf
v_cndmask_b32_dpp v19, v203, v201, vcc quad_perm:[1,0,3,2] row_mask:0xf bank_mask:0xf
v_mfma_f32_16x16x32_bf16 a[164:167], v[108:111], v[52:55], a[164:167]
s_not_b64 vcc, s[94:95]
v_cndmask_b32_dpp v202, v200, v202, vcc quad_perm:[1,0,3,2] row_mask:0xf bank_mask:0xf
v_cndmask_b32_dpp v203, v201, v203, vcc quad_perm:[1,0,3,2] row_mask:0xf bank_mask:0xf
v_mfma_f32_16x16x32_bf16 a[168:171], v[112:115], v[48:51], a[248:251]
v_perm_b32 v66, v202, v18, s100
v_perm_b32 v74, v202, v18, s101
v_mfma_f32_16x16x32_bf16 a[168:171], v[116:119], v[52:55], a[168:171]
v_perm_b32 v82, v203, v19, s100
v_perm_b32 v90, v203, v19, s101
v_mfma_f32_16x16x32_bf16 a[172:175], v[120:123], v[48:51], a[252:255]
s_add_u32 s40, s39, 0x42200
buffer_load_dwordx4 v[200:203], v0, s[96:99], s40 offen
v_mfma_f32_16x16x32_bf16 a[172:175], v[124:127], v[52:55], a[172:175]
s_waitcnt lgkmcnt(2)
v_mfma_f32_16x16x32_bf16 a[176:179], v[96:99], v[56:59], a[240:243]
ds_read_b128 v[48:51], v2 offset:10240
v_mfma_f32_16x16x32_bf16 a[176:179], v[100:103], v[60:63], a[176:179]
ds_read_b128 v[52:55], v3 offset:10240
v_mfma_f32_16x16x32_bf16 a[180:183], v[104:107], v[56:59], a[244:247]
s_waitcnt vmcnt(31)
s_mov_b64 vcc, s[94:95]
v_cndmask_b32_dpp v18, v206, v204, vcc quad_perm:[1,0,3,2] row_mask:0xf bank_mask:0xf
v_cndmask_b32_dpp v19, v207, v205, vcc quad_perm:[1,0,3,2] row_mask:0xf bank_mask:0xf
v_mfma_f32_16x16x32_bf16 a[180:183], v[108:111], v[60:63], a[180:183]
s_not_b64 vcc, s[94:95]
v_cndmask_b32_dpp v206, v204, v206, vcc quad_perm:[1,0,3,2] row_mask:0xf bank_mask:0xf
v_cndmask_b32_dpp v207, v205, v207, vcc quad_perm:[1,0,3,2] row_mask:0xf bank_mask:0xf
v_mfma_f32_16x16x32_bf16 a[184:187], v[112:115], v[56:59], a[248:251]
v_perm_b32 v67, v206, v18, s100
v_perm_b32 v75, v206, v18, s101
v_mfma_f32_16x16x32_bf16 a[184:187], v[116:119], v[60:63], a[184:187]
v_perm_b32 v83, v207, v19, s100
v_perm_b32 v91, v207, v19, s101
v_mfma_f32_16x16x32_bf16 a[188:191], v[120:123], v[56:59], a[252:255]
s_add_u32 s40, s39, 0x43200
buffer_load_dwordx4 v[204:207], v0, s[96:99], s40 offen
v_mfma_f32_16x16x32_bf16 a[188:191], v[124:127], v[60:63], a[188:191]
s_waitcnt lgkmcnt(2)
v_mfma_f32_16x16x32_bf16 a[192:195], v[96:99], v[40:43], a[240:243]
ds_read_b128 v[56:59], v2 offset:12288
v_mfma_f32_16x16x32_bf16 a[192:195], v[100:103], v[44:47], a[192:195]
ds_read_b128 v[60:63], v3 offset:12288
buffer_load_dwordx2 v[224:225], v17, s[96:99], s84 offen offset:0 nt
v_mfma_f32_16x16x32_bf16 a[196:199], v[104:107], v[40:43], a[244:247]
s_waitcnt vmcnt(32)
s_mov_b64 vcc, s[94:95]
v_cndmask_b32_dpp v18, v210, v208, vcc quad_perm:[1,0,3,2] row_mask:0xf bank_mask:0xf
v_cndmask_b32_dpp v19, v211, v209, vcc quad_perm:[1,0,3,2] row_mask:0xf bank_mask:0xf
v_mfma_f32_16x16x32_bf16 a[196:199], v[108:111], v[44:47], a[196:199]
s_not_b64 vcc, s[94:95]
v_cndmask_b32_dpp v210, v208, v210, vcc quad_perm:[1,0,3,2] row_mask:0xf bank_mask:0xf
v_cndmask_b32_dpp v211, v209, v211, vcc quad_perm:[1,0,3,2] row_mask:0xf bank_mask:0xf
v_mfma_f32_16x16x32_bf16 a[200:203], v[112:115], v[40:43], a[248:251]
v_perm_b32 v68, v210, v18, s100
v_perm_b32 v76, v210, v18, s101
buffer_load_dwordx2 v[226:227], v17, s[96:99], s84 offen offset:2048 nt
s_add_u32 s84, s84, 0x1000
v_mfma_f32_16x16x32_bf16 a[200:203], v[116:119], v[44:47], a[200:203]
v_perm_b32 v84, v211, v19, s100
v_perm_b32 v92, v211, v19, s101
v_mfma_f32_16x16x32_bf16 a[204:207], v[120:123], v[40:43], a[252:255]
s_add_u32 s40, s39, 0x50200
buffer_load_dwordx4 v[208:211], v0, s[96:99], s40 offen
v_mfma_f32_16x16x32_bf16 a[204:207], v[124:127], v[44:47], a[204:207]
s_waitcnt lgkmcnt(2)
v_mfma_f32_16x16x32_bf16 a[208:211], v[96:99], v[48:51], a[240:243]
ds_read_b128 v[40:43], v2 offset:14336
v_mfma_f32_16x16x32_bf16 a[208:211], v[100:103], v[52:55], a[208:211]
ds_read_b128 v[44:47], v3 offset:14336
buffer_load_dwordx2 v[228:229], v17, s[96:99], s84 offen offset:0 nt
v_mfma_f32_16x16x32_bf16 a[212:215], v[104:107], v[48:51], a[244:247]
s_waitcnt vmcnt(34)
s_mov_b64 vcc, s[94:95]
v_cndmask_b32_dpp v18, v214, v212, vcc quad_perm:[1,0,3,2] row_mask:0xf bank_mask:0xf
v_cndmask_b32_dpp v19, v215, v213, vcc quad_perm:[1,0,3,2] row_mask:0xf bank_mask:0xf
v_mfma_f32_16x16x32_bf16 a[212:215], v[108:111], v[52:55], a[212:215]
s_not_b64 vcc, s[94:95]
v_cndmask_b32_dpp v214, v212, v214, vcc quad_perm:[1,0,3,2] row_mask:0xf bank_mask:0xf
v_cndmask_b32_dpp v215, v213, v215, vcc quad_perm:[1,0,3,2] row_mask:0xf bank_mask:0xf
v_mfma_f32_16x16x32_bf16 a[216:219], v[112:115], v[48:51], a[248:251]
v_perm_b32 v69, v214, v18, s100
v_perm_b32 v77, v214, v18, s101
buffer_load_dwordx2 v[230:231], v17, s[96:99], s84 offen offset:2048 nt
s_add_u32 s84, s84, 0x1000
v_mfma_f32_16x16x32_bf16 a[216:219], v[116:119], v[52:55], a[216:219]
v_perm_b32 v85, v215, v19, s100
v_perm_b32 v93, v215, v19, s101
v_mfma_f32_16x16x32_bf16 a[220:223], v[120:123], v[48:51], a[252:255]
s_add_u32 s40, s39, 0x51200
buffer_load_dwordx4 v[212:215], v0, s[96:99], s40 offen
v_mfma_f32_16x16x32_bf16 a[220:223], v[124:127], v[52:55], a[220:223]
s_waitcnt lgkmcnt(2)
v_mfma_f32_16x16x32_bf16 a[224:227], v[96:99], v[56:59], a[240:243]
v_mfma_f32_16x16x32_bf16 a[224:227], v[100:103], v[60:63], a[224:227]
v_mfma_f32_16x16x32_bf16 a[228:231], v[104:107], v[56:59], a[244:247]
s_waitcnt vmcnt(35)
s_mov_b64 vcc, s[94:95]
v_cndmask_b32_dpp v18, v218, v216, vcc quad_perm:[1,0,3,2] row_mask:0xf bank_mask:0xf
v_cndmask_b32_dpp v19, v219, v217, vcc quad_perm:[1,0,3,2] row_mask:0xf bank_mask:0xf
v_mfma_f32_16x16x32_bf16 a[228:231], v[108:111], v[60:63], a[228:231]
s_not_b64 vcc, s[94:95]
v_cndmask_b32_dpp v218, v216, v218, vcc quad_perm:[1,0,3,2] row_mask:0xf bank_mask:0xf
v_cndmask_b32_dpp v219, v217, v219, vcc quad_perm:[1,0,3,2] row_mask:0xf bank_mask:0xf
v_mfma_f32_16x16x32_bf16 a[232:235], v[112:115], v[56:59], a[248:251]
v_perm_b32 v70, v218, v18, s100
v_perm_b32 v78, v218, v18, s101
v_mfma_f32_16x16x32_bf16 a[232:235], v[116:119], v[60:63], a[232:235]
v_perm_b32 v86, v219, v19, s100
v_perm_b32 v94, v219, v19, s101
v_mfma_f32_16x16x32_bf16 a[236:239], v[120:123], v[56:59], a[252:255]
s_waitcnt vmcnt(34)
s_mov_b64 vcc, s[94:95]
v_cndmask_b32_dpp v18, v222, v220, vcc quad_perm:[1,0,3,2] row_mask:0xf bank_mask:0xf
v_cndmask_b32_dpp v19, v223, v221, vcc quad_perm:[1,0,3,2] row_mask:0xf bank_mask:0xf
v_mfma_f32_16x16x32_bf16 a[236:239], v[124:127], v[60:63], a[236:239]
s_not_b64 vcc, s[94:95]
v_cndmask_b32_dpp v222, v220, v222, vcc quad_perm:[1,0,3,2] row_mask:0xf bank_mask:0xf
v_cndmask_b32_dpp v223, v221, v223, vcc quad_perm:[1,0,3,2] row_mask:0xf bank_mask:0xf
s_waitcnt lgkmcnt(0)
s_waitcnt vmcnt(21)
s_barrier
v_mfma_f32_16x16x32_bf16 a[240:243], v[96:99], v[40:43], a[240:243]
ds_read_b128 v[48:51], v2 offset:16384
v_perm_b32 v71, v222, v18, s100
v_perm_b32 v79, v222, v18, s101
v_mfma_f32_16x16x32_bf16 a[240:243], v[100:103], v[44:47], a[240:243]
ds_read_b128 v[52:55], v3 offset:16384
v_perm_b32 v87, v223, v19, s100
v_perm_b32 v95, v223, v19, s101
v_mfma_f32_16x16x32_bf16 a[244:247], v[104:107], v[40:43], a[244:247]
ds_read_b128 v[56:59], v2 offset:18432
s_add_u32 s40, s39, 0x52200
buffer_load_dwordx4 v[216:219], v0, s[96:99], s40 offen
v_mfma_f32_16x16x32_bf16 a[244:247], v[108:111], v[44:47], a[244:247]
ds_read_b128 v[60:63], v3 offset:18432
v_mfma_f32_16x16x32_bf16 a[248:251], v[112:115], v[40:43], a[248:251]
s_add_u32 s40, s39, 0x53200
buffer_load_dwordx4 v[220:223], v0, s[96:99], s40 offen
v_mfma_f32_16x16x32_bf16 a[248:251], v[116:119], v[44:47], a[248:251]
v_mfma_f32_16x16x32_bf16 a[252:255], v[120:123], v[40:43], a[252:255]
v_mfma_f32_16x16x32_bf16 a[252:255], v[124:127], v[44:47], a[252:255]
s_waitcnt lgkmcnt(2)
v_mfma_f32_16x16x32_bf16 a[0:3], v[64:67], v[48:51], a[0:3]
ds_read_b128 v[40:43], v2 offset:20480
v_mfma_f32_16x16x32_bf16 a[0:3], v[68:71], v[52:55], a[0:3]
ds_read_b128 v[44:47], v3 offset:20480
v_mfma_f32_16x16x32_bf16 a[4:7], v[72:75], v[48:51], a[4:7]
s_mov_b64 vcc, s[94:95]
v_cndmask_b32_dpp v18, v130, v128, vcc quad_perm:[1,0,3,2] row_mask:0xf bank_mask:0xf
v_cndmask_b32_dpp v19, v131, v129, vcc quad_perm:[1,0,3,2] row_mask:0xf bank_mask:0xf
v_mfma_f32_16x16x32_bf16 a[4:7], v[76:79], v[52:55], a[4:7]
s_not_b64 vcc, s[94:95]
v_cndmask_b32_dpp v130, v128, v130, vcc quad_perm:[1,0,3,2] row_mask:0xf bank_mask:0xf
v_cndmask_b32_dpp v131, v129, v131, vcc quad_perm:[1,0,3,2] row_mask:0xf bank_mask:0xf
v_mfma_f32_16x16x32_bf16 a[8:11], v[80:83], v[48:51], a[8:11]
v_perm_b32 v96, v130, v18, s100
v_perm_b32 v104, v130, v18, s101
s_add_u32 m0, s3, 0xc000
v_mfma_f32_16x16x32_bf16 a[8:11], v[84:87], v[52:55], a[8:11]
v_perm_b32 v112, v131, v19, s100
v_perm_b32 v120, v131, v19, s101
buffer_load_dwordx4 v8, s[8:11], s35 offen nt lds
s_add_u32 s35, s35, 0x10000
v_mfma_f32_16x16x32_bf16 a[12:15], v[88:91], v[48:51], a[12:15]
s_add_u32 s40, s39, 0x60000
buffer_load_dwordx4 v[128:131], v0, s[96:99], s40 offen
s_add_u32 m0, s3, 0xd000
v_mfma_f32_16x16x32_bf16 a[12:15], v[92:95], v[52:55], a[12:15]
buffer_load_dwordx4 v8, s[8:11], s35 offen nt lds
s_add_u32 s35, s35, 0x10000
s_waitcnt lgkmcnt(2)
v_mfma_f32_16x16x32_bf16 a[16:19], v[64:67], v[56:59], a[16:19]
ds_read_b128 v[48:51], v2 offset:22528
s_add_u32 m0, s3, 0xe000
v_mfma_f32_16x16x32_bf16 a[16:19], v[68:71], v[60:63], a[16:19]
ds_read_b128 v[52:55], v3 offset:22528
buffer_load_dwordx4 v8, s[8:11], s35 offen nt lds
s_add_u32 s35, s35, 0x10000
v_mfma_f32_16x16x32_bf16 a[20:23], v[72:75], v[56:59], a[20:23]
s_mov_b64 vcc, s[94:95]
v_cndmask_b32_dpp v18, v134, v132, vcc quad_perm:[1,0,3,2] row_mask:0xf bank_mask:0xf
v_cndmask_b32_dpp v19, v135, v133, vcc quad_perm:[1,0,3,2] row_mask:0xf bank_mask:0xf
s_add_u32 m0, s3, 0xf000
v_mfma_f32_16x16x32_bf16 a[20:23], v[76:79], v[60:63], a[20:23]
s_not_b64 vcc, s[94:95]
v_cndmask_b32_dpp v134, v132, v134, vcc quad_perm:[1,0,3,2] row_mask:0xf bank_mask:0xf
v_cndmask_b32_dpp v135, v133, v135, vcc quad_perm:[1,0,3,2] row_mask:0xf bank_mask:0xf
buffer_load_dwordx4 v8, s[8:11], s35 offen nt lds
v_mfma_f32_16x16x32_bf16 a[24:27], v[80:83], v[56:59], a[24:27]
v_perm_b32 v97, v134, v18, s100
v_perm_b32 v105, v134, v18, s101
v_mfma_f32_16x16x32_bf16 a[24:27], v[84:87], v[60:63], a[24:27]
v_perm_b32 v113, v135, v19, s100
v_perm_b32 v121, v135, v19, s101
v_mfma_f32_16x16x32_bf16 a[28:31], v[88:91], v[56:59], a[28:31]
s_add_u32 s40, s39, 0x61000
buffer_load_dwordx4 v[132:135], v0, s[96:99], s40 offen
v_mfma_f32_16x16x32_bf16 a[28:31], v[92:95], v[60:63], a[28:31]
s_waitcnt lgkmcnt(2)
v_mfma_f32_16x16x32_bf16 a[32:35], v[64:67], v[40:43], a[32:35]
ds_read_b128 v[56:59], v2 offset:24576
v_mfma_f32_16x16x32_bf16 a[32:35], v[68:71], v[44:47], a[32:35]
ds_read_b128 v[60:63], v3 offset:24576
v_mfma_f32_16x16x32_bf16 a[36:39], v[72:75], v[40:43], a[36:39]
s_mov_b64 vcc, s[94:95]
v_cndmask_b32_dpp v18, v138, v136, vcc quad_perm:[1,0,3,2] row_mask:0xf bank_mask:0xf
v_cndmask_b32_dpp v19, v139, v137, vcc quad_perm:[1,0,3,2] row_mask:0xf bank_mask:0xf
v_mfma_f32_16x16x32_bf16 a[36:39], v[76:79], v[44:47], a[36:39]
s_not_b64 vcc, s[94:95]
v_cndmask_b32_dpp v138, v136, v138, vcc quad_perm:[1,0,3,2] row_mask:0xf bank_mask:0xf
v_cndmask_b32_dpp v139, v137, v139, vcc quad_perm:[1,0,3,2] row_mask:0xf bank_mask:0xf
v_mfma_f32_16x16x32_bf16 a[40:43], v[80:83], v[40:43], a[40:43]
v_perm_b32 v98, v138, v18, s100
v_perm_b32 v106, v138, v18, s101
v_mfma_f32_16x16x32_bf16 a[40:43], v[84:87], v[44:47], a[40:43]
v_perm_b32 v114, v139, v19, s100
v_perm_b32 v122, v139, v19, s101
v_mfma_f32_16x16x32_bf16 a[44:47], v[88:91], v[40:43], a[44:47]
s_add_u32 s40, s39, 0x62000
buffer_load_dwordx4 v[136:139], v0, s[96:99], s40 offen
v_mfma_f32_16x16x32_bf16 a[44:47], v[92:95], v[44:47], a[44:47]
s_waitcnt lgkmcnt(2)
v_mfma_f32_16x16x32_bf16 a[48:51], v[64:67], v[48:51], a[48:51]
ds_read_b128 v[40:43], v2 offset:26624
v_mfma_f32_16x16x32_bf16 a[48:51], v[68:71], v[52:55], a[48:51]
ds_read_b128 v[44:47], v3 offset:26624
v_mfma_f32_16x16x32_bf16 a[52:55], v[72:75], v[48:51], a[52:55]
s_mov_b64 vcc, s[94:95]
v_cndmask_b32_dpp v18, v142, v140, vcc quad_perm:[1,0,3,2] row_mask:0xf bank_mask:0xf
v_cndmask_b32_dpp v19, v143, v141, vcc quad_perm:[1,0,3,2] row_mask:0xf bank_mask:0xf
v_mfma_f32_16x16x32_bf16 a[52:55], v[76:79], v[52:55], a[52:55]
s_not_b64 vcc, s[94:95]
v_cndmask_b32_dpp v142, v140, v142, vcc quad_perm:[1,0,3,2] row_mask:0xf bank_mask:0xf
v_cndmask_b32_dpp v143, v141, v143, vcc quad_perm:[1,0,3,2] row_mask:0xf bank_mask:0xf
v_mfma_f32_16x16x32_bf16 a[56:59], v[80:83], v[48:51], a[56:59]
v_perm_b32 v99, v142, v18, s100
v_perm_b32 v107, v142, v18, s101
v_mfma_f32_16x16x32_bf16 a[56:59], v[84:87], v[52:55], a[56:59]
v_perm_b32 v115, v143, v19, s100
v_perm_b32 v123, v143, v19, s101
v_mfma_f32_16x16x32_bf16 a[60:63], v[88:91], v[48:51], a[60:63]
s_add_u32 s40, s39, 0x63000
buffer_load_dwordx4 v[140:143], v0, s[96:99], s40 offen
v_mfma_f32_16x16x32_bf16 a[60:63], v[92:95], v[52:55], a[60:63]
s_waitcnt lgkmcnt(2)
v_mfma_f32_16x16x32_bf16 a[64:67], v[64:67], v[56:59], a[64:67]
ds_read_b128 v[48:51], v2 offset:28672
v_mfma_f32_16x16x32_bf16 a[64:67], v[68:71], v[60:63], a[64:67]
ds_read_b128 v[52:55], v3 offset:28672
buffer_load_dwordx2 v[232:233], v17, s[96:99], s84 offen offset:0 nt
v_mfma_f32_16x16x32_bf16 a[68:71], v[72:75], v[56:59], a[68:71]
s_mov_b64 vcc, s[94:95]
v_cndmask_b32_dpp v18, v146, v144, vcc quad_perm:[1,0,3,2] row_mask:0xf bank_mask:0xf
v_cndmask_b32_dpp v19, v147, v145, vcc quad_perm:[1,0,3,2] row_mask:0xf bank_mask:0xf
v_mfma_f32_16x16x32_bf16 a[68:71], v[76:79], v[60:63], a[68:71]
s_not_b64 vcc, s[94:95]
v_cndmask_b32_dpp v146, v144, v146, vcc quad_perm:[1,0,3,2] row_mask:0xf bank_mask:0xf
v_cndmask_b32_dpp v147, v145, v147, vcc quad_perm:[1,0,3,2] row_mask:0xf bank_mask:0xf
v_mfma_f32_16x16x32_bf16 a[72:75], v[80:83], v[56:59], a[72:75]
v_perm_b32 v100, v146, v18, s100
v_perm_b32 v108, v146, v18, s101
buffer_load_dwordx2 v[234:235], v17, s[96:99], s84 offen offset:2048 nt
s_add_u32 s84, s84, 0x1000
v_mfma_f32_16x16x32_bf16 a[72:75], v[84:87], v[60:63], a[72:75]
v_perm_b32 v116, v147, v19, s100
v_perm_b32 v124, v147, v19, s101
v_mfma_f32_16x16x32_bf16 a[76:79], v[88:91], v[56:59], a[76:79]
s_add_u32 s40, s39, 0x70000
buffer_load_dwordx4 v[144:147], v0, s[96:99], s40 offen
v_mfma_f32_16x16x32_bf16 a[76:79], v[92:95], v[60:63], a[76:79]
s_waitcnt lgkmcnt(2)
v_mfma_f32_16x16x32_bf16 a[80:83], v[64:67], v[40:43], a[80:83]
ds_read_b128 v[56:59], v2 offset:30720
v_mfma_f32_16x16x32_bf16 a[80:83], v[68:71], v[44:47], a[80:83]
ds_read_b128 v[60:63], v3 offset:30720
buffer_load_dwordx2 v[236:237], v17, s[96:99], s84 offen offset:0 nt
v_mfma_f32_16x16x32_bf16 a[84:87], v[72:75], v[40:43], a[84:87]
s_mov_b64 vcc, s[94:95]
v_cndmask_b32_dpp v18, v150, v148, vcc quad_perm:[1,0,3,2] row_mask:0xf bank_mask:0xf
v_cndmask_b32_dpp v19, v151, v149, vcc quad_perm:[1,0,3,2] row_mask:0xf bank_mask:0xf
v_mfma_f32_16x16x32_bf16 a[84:87], v[76:79], v[44:47], a[84:87]
s_not_b64 vcc, s[94:95]
v_cndmask_b32_dpp v150, v148, v150, vcc quad_perm:[1,0,3,2] row_mask:0xf bank_mask:0xf
v_cndmask_b32_dpp v151, v149, v151, vcc quad_perm:[1,0,3,2] row_mask:0xf bank_mask:0xf
v_mfma_f32_16x16x32_bf16 a[88:91], v[80:83], v[40:43], a[88:91]
v_perm_b32 v101, v150, v18, s100
v_perm_b32 v109, v150, v18, s101
buffer_load_dwordx2 v[238:239], v17, s[96:99], s84 offen offset:2048 nt
v_mfma_f32_16x16x32_bf16 a[88:91], v[84:87], v[44:47], a[88:91]
v_perm_b32 v117, v151, v19, s100
v_perm_b32 v125, v151, v19, s101
v_mfma_f32_16x16x32_bf16 a[92:95], v[88:91], v[40:43], a[92:95]
s_add_u32 s40, s39, 0x71000
buffer_load_dwordx4 v[148:151], v0, s[96:99], s40 offen
v_mfma_f32_16x16x32_bf16 a[92:95], v[92:95], v[44:47], a[92:95]
s_waitcnt lgkmcnt(2)
v_mfma_f32_16x16x32_bf16 a[96:99], v[64:67], v[48:51], a[96:99]
ds_read_b128 v[40:43], v2 offset:16384
v_mfma_f32_16x16x32_bf16 a[96:99], v[68:71], v[52:55], a[96:99]
ds_read_b128 v[44:47], v3 offset:16384
v_mfma_f32_16x16x32_bf16 a[100:103], v[72:75], v[48:51], a[100:103]
s_mov_b64 vcc, s[94:95]
v_cndmask_b32_dpp v18, v154, v152, vcc quad_perm:[1,0,3,2] row_mask:0xf bank_mask:0xf
v_cndmask_b32_dpp v19, v155, v153, vcc quad_perm:[1,0,3,2] row_mask:0xf bank_mask:0xf
v_mfma_f32_16x16x32_bf16 a[100:103], v[76:79], v[52:55], a[100:103]
s_not_b64 vcc, s[94:95]
v_cndmask_b32_dpp v154, v152, v154, vcc quad_perm:[1,0,3,2] row_mask:0xf bank_mask:0xf
v_cndmask_b32_dpp v155, v153, v155, vcc quad_perm:[1,0,3,2] row_mask:0xf bank_mask:0xf
v_mfma_f32_16x16x32_bf16 a[104:107], v[80:83], v[48:51], a[104:107]
v_perm_b32 v102, v154, v18, s100
v_perm_b32 v110, v154, v18, s101
v_mfma_f32_16x16x32_bf16 a[104:107], v[84:87], v[52:55], a[104:107]
v_perm_b32 v118, v155, v19, s100
v_perm_b32 v126, v155, v19, s101
v_mfma_f32_16x16x32_bf16 a[108:111], v[88:91], v[48:51], a[108:111]
s_mov_b64 vcc, s[94:95]
v_cndmask_b32_dpp v18, v158, v156, vcc quad_perm:[1,0,3,2] row_mask:0xf bank_mask:0xf
v_cndmask_b32_dpp v19, v159, v157, vcc quad_perm:[1,0,3,2] row_mask:0xf bank_mask:0xf
v_mfma_f32_16x16x32_bf16 a[108:111], v[92:95], v[52:55], a[108:111]
s_not_b64 vcc, s[94:95]
v_cndmask_b32_dpp v158, v156, v158, vcc quad_perm:[1,0,3,2] row_mask:0xf bank_mask:0xf
v_cndmask_b32_dpp v159, v157, v159, vcc quad_perm:[1,0,3,2] row_mask:0xf bank_mask:0xf
s_waitcnt lgkmcnt(2)
v_mfma_f32_16x16x32_bf16 a[112:115], v[64:67], v[56:59], a[112:115]
ds_read_b128 v[48:51], v2 offset:18432
v_perm_b32 v103, v158, v18, s100
v_perm_b32 v111, v158, v18, s101
v_mfma_f32_16x16x32_bf16 a[112:115], v[68:71], v[60:63], a[112:115]
ds_read_b128 v[52:55], v3 offset:18432
v_perm_b32 v119, v159, v19, s100
v_perm_b32 v127, v159, v19, s101
v_mfma_f32_16x16x32_bf16 a[116:119], v[72:75], v[56:59], a[116:119]
s_add_u32 s40, s39, 0x72000
buffer_load_dwordx4 v[152:155], v0, s[96:99], s40 offen
v_mfma_f32_16x16x32_bf16 a[116:119], v[76:79], v[60:63], a[116:119]
v_mfma_f32_16x16x32_bf16 a[120:123], v[80:83], v[56:59], a[120:123]
s_add_u32 s40, s39, 0x73000
buffer_load_dwordx4 v[156:159], v0, s[96:99], s40 offen
v_mfma_f32_16x16x32_bf16 a[120:123], v[84:87], v[60:63], a[120:123]
v_mfma_f32_16x16x32_bf16 a[124:127], v[88:91], v[56:59], a[124:127]
v_mfma_f32_16x16x32_bf16 a[124:127], v[92:95], v[60:63], a[124:127]
s_waitcnt lgkmcnt(2)
v_mfma_f32_16x16x32_bf16 a[128:131], v[96:99], v[40:43], a[128:131]
ds_read_b128 v[56:59], v2 offset:20480
v_mfma_f32_16x16x32_bf16 a[128:131], v[100:103], v[44:47], a[128:131]
ds_read_b128 v[60:63], v3 offset:20480
v_mfma_f32_16x16x32_bf16 a[132:135], v[104:107], v[40:43], a[132:135]
s_mov_b64 vcc, s[94:95]
v_cndmask_b32_dpp v18, v162, v160, vcc quad_perm:[1,0,3,2] row_mask:0xf bank_mask:0xf
v_cndmask_b32_dpp v19, v163, v161, vcc quad_perm:[1,0,3,2] row_mask:0xf bank_mask:0xf
v_mfma_f32_16x16x32_bf16 a[132:135], v[108:111], v[44:47], a[132:135]
s_not_b64 vcc, s[94:95]
v_cndmask_b32_dpp v162, v160, v162, vcc quad_perm:[1,0,3,2] row_mask:0xf bank_mask:0xf
v_cndmask_b32_dpp v163, v161, v163, vcc quad_perm:[1,0,3,2] row_mask:0xf bank_mask:0xf
v_mfma_f32_16x16x32_bf16 a[136:139], v[112:115], v[40:43], a[136:139]
v_perm_b32 v64, v162, v18, s100
v_perm_b32 v72, v162, v18, s101
s_add_u32 s35, s38, 0x200
s_add_u32 m0, s3, 0x10000
v_mfma_f32_16x16x32_bf16 a[136:139], v[116:119], v[44:47], a[136:139]
v_perm_b32 v80, v163, v19, s100
v_perm_b32 v88, v163, v19, s101
buffer_load_dwordx4 v8, s[8:11], s35 offen nt lds
s_add_u32 s35, s35, 0x10000
v_mfma_f32_16x16x32_bf16 a[140:143], v[120:123], v[40:43], a[140:143]
s_add_u32 s40, s39, 0x60200
buffer_load_dwordx4 v[160:163], v0, s[96:99], s40 offen
s_add_u32 m0, s3, 0x11000
v_mfma_f32_16x16x32_bf16 a[140:143], v[124:127], v[44:47], a[140:143]
buffer_load_dwordx4 v8, s[8:11], s35 offen nt lds
s_add_u32 s35, s35, 0x10000
s_waitcnt lgkmcnt(2)
v_mfma_f32_16x16x32_bf16 a[144:147], v[96:99], v[48:51], a[144:147]
ds_read_b128 v[40:43], v2 offset:22528
s_add_u32 m0, s3, 0x12000
v_mfma_f32_16x16x32_bf16 a[144:147], v[100:103], v[52:55], a[144:147]
ds_read_b128 v[44:47], v3 offset:22528
buffer_load_dwordx4 v8, s[8:11], s35 offen nt lds
s_add_u32 s35, s35, 0x10000
v_mfma_f32_16x16x32_bf16 a[148:151], v[104:107], v[48:51], a[148:151]
s_waitcnt vmcnt(42)
s_mov_b64 vcc, s[94:95]
v_cndmask_b32_dpp v18, v166, v164, vcc quad_perm:[1,0,3,2] row_mask:0xf bank_mask:0xf
v_cndmask_b32_dpp v19, v167, v165, vcc quad_perm:[1,0,3,2] row_mask:0xf bank_mask:0xf
s_add_u32 m0, s3, 0x13000
v_mfma_f32_16x16x32_bf16 a[148:151], v[108:111], v[52:55], a[148:151]
s_not_b64 vcc, s[94:95]
v_cndmask_b32_dpp v166, v164, v166, vcc quad_perm:[1,0,3,2] row_mask:0xf bank_mask:0xf
v_cndmask_b32_dpp v167, v165, v167, vcc quad_perm:[1,0,3,2] row_mask:0xf bank_mask:0xf
buffer_load_dwordx4 v8, s[8:11], s35 offen nt lds
s_sub_u32 s35, s35, 196480
v_mfma_f32_16x16x32_bf16 a[152:155], v[112:115], v[48:51], a[152:155]
v_perm_b32 v65, v166, v18, s100
v_perm_b32 v73, v166, v18, s101
v_mfma_f32_16x16x32_bf16 a[152:155], v[116:119], v[52:55], a[152:155]
v_perm_b32 v81, v167, v19, s100
v_perm_b32 v89, v167, v19, s101
v_mfma_f32_16x16x32_bf16 a[156:159], v[120:123], v[48:51], a[156:159]
s_add_u32 s40, s39, 0x61200
buffer_load_dwordx4 v[164:167], v0, s[96:99], s40 offen
v_mfma_f32_16x16x32_bf16 a[156:159], v[124:127], v[52:55], a[156:159]
s_waitcnt lgkmcnt(2)
v_mfma_f32_16x16x32_bf16 a[160:163], v[96:99], v[56:59], a[160:163]
ds_read_b128 v[48:51], v2 offset:24576
v_mfma_f32_16x16x32_bf16 a[160:163], v[100:103], v[60:63], a[160:163]
ds_read_b128 v[52:55], v3 offset:24576
v_mfma_f32_16x16x32_bf16 a[164:167], v[104:107], v[56:59], a[164:167]
s_waitcnt vmcnt(43)
s_mov_b64 vcc, s[94:95]
v_cndmask_b32_dpp v18, v170, v168, vcc quad_perm:[1,0,3,2] row_mask:0xf bank_mask:0xf
v_cndmask_b32_dpp v19, v171, v169, vcc quad_perm:[1,0,3,2] row_mask:0xf bank_mask:0xf
v_mfma_f32_16x16x32_bf16 a[164:167], v[108:111], v[60:63], a[164:167]
s_not_b64 vcc, s[94:95]
v_cndmask_b32_dpp v170, v168, v170, vcc quad_perm:[1,0,3,2] row_mask:0xf bank_mask:0xf
v_cndmask_b32_dpp v171, v169, v171, vcc quad_perm:[1,0,3,2] row_mask:0xf bank_mask:0xf
v_mfma_f32_16x16x32_bf16 a[168:171], v[112:115], v[56:59], a[168:171]
v_perm_b32 v66, v170, v18, s100
v_perm_b32 v74, v170, v18, s101
v_mfma_f32_16x16x32_bf16 a[168:171], v[116:119], v[60:63], a[168:171]
v_perm_b32 v82, v171, v19, s100
v_perm_b32 v90, v171, v19, s101
v_mfma_f32_16x16x32_bf16 a[172:175], v[120:123], v[56:59], a[172:175]
s_add_u32 s40, s39, 0x62200
buffer_load_dwordx4 v[168:171], v0, s[96:99], s40 offen
v_mfma_f32_16x16x32_bf16 a[172:175], v[124:127], v[60:63], a[172:175]
s_waitcnt lgkmcnt(2)
v_mfma_f32_16x16x32_bf16 a[176:179], v[96:99], v[40:43], a[176:179]
ds_read_b128 v[56:59], v2 offset:26624
v_mfma_f32_16x16x32_bf16 a[176:179], v[100:103], v[44:47], a[176:179]
ds_read_b128 v[60:63], v3 offset:26624
v_mfma_f32_16x16x32_bf16 a[180:183], v[104:107], v[40:43], a[180:183]
s_waitcnt vmcnt(43)
s_mov_b64 vcc, s[94:95]
v_cndmask_b32_dpp v18, v174, v172, vcc quad_perm:[1,0,3,2] row_mask:0xf bank_mask:0xf
v_cndmask_b32_dpp v19, v175, v173, vcc quad_perm:[1,0,3,2] row_mask:0xf bank_mask:0xf
v_mfma_f32_16x16x32_bf16 a[180:183], v[108:111], v[44:47], a[180:183]
s_not_b64 vcc, s[94:95]
v_cndmask_b32_dpp v174, v172, v174, vcc quad_perm:[1,0,3,2] row_mask:0xf bank_mask:0xf
v_cndmask_b32_dpp v175, v173, v175, vcc quad_perm:[1,0,3,2] row_mask:0xf bank_mask:0xf
v_mfma_f32_16x16x32_bf16 a[184:187], v[112:115], v[40:43], a[184:187]
v_perm_b32 v67, v174, v18, s100
v_perm_b32 v75, v174, v18, s101
v_mfma_f32_16x16x32_bf16 a[184:187], v[116:119], v[44:47], a[184:187]
v_perm_b32 v83, v175, v19, s100
v_perm_b32 v91, v175, v19, s101
v_mfma_f32_16x16x32_bf16 a[188:191], v[120:123], v[40:43], a[188:191]
s_add_u32 s40, s39, 0x63200
buffer_load_dwordx4 v[172:175], v0, s[96:99], s40 offen
v_mfma_f32_16x16x32_bf16 a[188:191], v[124:127], v[44:47], a[188:191]
s_waitcnt lgkmcnt(2)
v_mfma_f32_16x16x32_bf16 a[192:195], v[96:99], v[48:51], a[192:195]
ds_read_b128 v[40:43], v2 offset:28672
v_mfma_f32_16x16x32_bf16 a[192:195], v[100:103], v[52:55], a[192:195]
ds_read_b128 v[44:47], v3 offset:28672
v_mfma_f32_16x16x32_bf16 a[196:199], v[104:107], v[48:51], a[196:199]
s_waitcnt vmcnt(43)
s_mov_b64 vcc, s[94:95]
v_cndmask_b32_dpp v18, v178, v176, vcc quad_perm:[1,0,3,2] row_mask:0xf bank_mask:0xf
v_cndmask_b32_dpp v19, v179, v177, vcc quad_perm:[1,0,3,2] row_mask:0xf bank_mask:0xf
v_mfma_f32_16x16x32_bf16 a[196:199], v[108:111], v[52:55], a[196:199]
s_not_b64 vcc, s[94:95]
v_cndmask_b32_dpp v178, v176, v178, vcc quad_perm:[1,0,3,2] row_mask:0xf bank_mask:0xf
v_cndmask_b32_dpp v179, v177, v179, vcc quad_perm:[1,0,3,2] row_mask:0xf bank_mask:0xf
v_mfma_f32_16x16x32_bf16 a[200:203], v[112:115], v[48:51], a[200:203]
v_perm_b32 v68, v178, v18, s100
v_perm_b32 v76, v178, v18, s101
v_mfma_f32_16x16x32_bf16 a[200:203], v[116:119], v[52:55], a[200:203]
v_perm_b32 v84, v179, v19, s100
v_perm_b32 v92, v179, v19, s101
v_mfma_f32_16x16x32_bf16 a[204:207], v[120:123], v[48:51], a[204:207]
s_add_u32 s40, s39, 0x70200
buffer_load_dwordx4 v[176:179], v0, s[96:99], s40 offen
v_mfma_f32_16x16x32_bf16 a[204:207], v[124:127], v[52:55], a[204:207]
s_waitcnt lgkmcnt(2)
v_mfma_f32_16x16x32_bf16 a[208:211], v[96:99], v[56:59], a[208:211]
ds_read_b128 v[48:51], v2 offset:30720
v_mfma_f32_16x16x32_bf16 a[208:211], v[100:103], v[60:63], a[208:211]
ds_read_b128 v[52:55], v3 offset:30720
v_mfma_f32_16x16x32_bf16 a[212:215], v[104:107], v[56:59], a[212:215]
s_waitcnt vmcnt(43)
s_mov_b64 vcc, s[94:95]
v_cndmask_b32_dpp v18, v182, v180, vcc quad_perm:[1,0,3,2] row_mask:0xf bank_mask:0xf
v_cndmask_b32_dpp v19, v183, v181, vcc quad_perm:[1,0,3,2] row_mask:0xf bank_mask:0xf
v_mfma_f32_16x16x32_bf16 a[212:215], v[108:111], v[60:63], a[212:215]
s_not_b64 vcc, s[94:95]
v_cndmask_b32_dpp v182, v180, v182, vcc quad_perm:[1,0,3,2] row_mask:0xf bank_mask:0xf
v_cndmask_b32_dpp v183, v181, v183, vcc quad_perm:[1,0,3,2] row_mask:0xf bank_mask:0xf
v_mfma_f32_16x16x32_bf16 a[216:219], v[112:115], v[56:59], a[216:219]
v_perm_b32 v69, v182, v18, s100
v_perm_b32 v77, v182, v18, s101
v_mfma_f32_16x16x32_bf16 a[216:219], v[116:119], v[60:63], a[216:219]
v_perm_b32 v85, v183, v19, s100
v_perm_b32 v93, v183, v19, s101
v_mfma_f32_16x16x32_bf16 a[220:223], v[120:123], v[56:59], a[220:223]
s_add_u32 s40, s39, 0x71200
buffer_load_dwordx4 v[180:183], v0, s[96:99], s40 offen
v_mfma_f32_16x16x32_bf16 a[220:223], v[124:127], v[60:63], a[220:223]
s_waitcnt lgkmcnt(2)
v_mfma_f32_16x16x32_bf16 a[224:227], v[96:99], v[40:43], a[224:227]
v_mfma_f32_16x16x32_bf16 a[224:227], v[100:103], v[44:47], a[224:227]
v_mfma_f32_16x16x32_bf16 a[228:231], v[104:107], v[40:43], a[228:231]
s_waitcnt vmcnt(43)
s_mov_b64 vcc, s[94:95]
v_cndmask_b32_dpp v18, v186, v184, vcc quad_perm:[1,0,3,2] row_mask:0xf bank_mask:0xf
v_cndmask_b32_dpp v19, v187, v185, vcc quad_perm:[1,0,3,2] row_mask:0xf bank_mask:0xf
v_mfma_f32_16x16x32_bf16 a[228:231], v[108:111], v[44:47], a[228:231]
s_not_b64 vcc, s[94:95]
v_cndmask_b32_dpp v186, v184, v186, vcc quad_perm:[1,0,3,2] row_mask:0xf bank_mask:0xf
v_cndmask_b32_dpp v187, v185, v187, vcc quad_perm:[1,0,3,2] row_mask:0xf bank_mask:0xf
v_mfma_f32_16x16x32_bf16 a[232:235], v[112:115], v[40:43], a[232:235]
v_perm_b32 v70, v186, v18, s100
v_perm_b32 v78, v186, v18, s101
v_mfma_f32_16x16x32_bf16 a[232:235], v[116:119], v[44:47], a[232:235]
v_perm_b32 v86, v187, v19, s100
v_perm_b32 v94, v187, v19, s101
v_mfma_f32_16x16x32_bf16 a[236:239], v[120:123], v[40:43], a[236:239]
s_waitcnt vmcnt(42)
s_mov_b64 vcc, s[94:95]
v_cndmask_b32_dpp v18, v190, v188, vcc quad_perm:[1,0,3,2] row_mask:0xf bank_mask:0xf
v_cndmask_b32_dpp v19, v191, v189, vcc quad_perm:[1,0,3,2] row_mask:0xf bank_mask:0xf
v_mfma_f32_16x16x32_bf16 a[236:239], v[124:127], v[44:47], a[236:239]
s_not_b64 vcc, s[94:95]
v_cndmask_b32_dpp v190, v188, v190, vcc quad_perm:[1,0,3,2] row_mask:0xf bank_mask:0xf
v_cndmask_b32_dpp v191, v189, v191, vcc quad_perm:[1,0,3,2] row_mask:0xf bank_mask:0xf
s_waitcnt lgkmcnt(0)
s_waitcnt vmcnt(37)
s_barrier
v_mfma_f32_16x16x32_bf16 a[240:243], v[96:99], v[48:51], a[240:243]
ds_read_b128 v[56:59], v2 offset:32768
v_perm_b32 v71, v190, v18, s100
v_perm_b32 v79, v190, v18, s101
v_mfma_f32_16x16x32_bf16 a[240:243], v[100:103], v[52:55], a[240:243]
ds_read_b128 v[60:63], v3 offset:32768
v_perm_b32 v87, v191, v19, s100
v_perm_b32 v95, v191, v19, s101
v_mfma_f32_16x16x32_bf16 a[244:247], v[104:107], v[48:51], a[244:247]
ds_read_b128 v[40:43], v2 offset:34816
s_add_u32 s40, s39, 0x72200
buffer_load_dwordx4 v[184:187], v0, s[96:99], s40 offen
v_mfma_f32_16x16x32_bf16 a[244:247], v[108:111], v[52:55], a[244:247]
ds_read_b128 v[44:47], v3 offset:34816
v_mfma_f32_16x16x32_bf16 a[248:251], v[112:115], v[48:51], a[248:251]
s_add_u32 s40, s39, 0x73200
buffer_load_dwordx4 v[188:191], v0, s[96:99], s40 offen
v_mfma_f32_16x16x32_bf16 a[248:251], v[116:119], v[52:55], a[248:251]
v_mfma_f32_16x16x32_bf16 a[252:255], v[120:123], v[48:51], a[252:255]
v_mfma_f32_16x16x32_bf16 a[252:255], v[124:127], v[52:55], a[252:255]
s_waitcnt lgkmcnt(2)
v_mfma_f32_16x16x32_bf16 a[0:3], v[64:67], v[56:59], a[0:3]
ds_read_b128 v[48:51], v2 offset:36864
v_mfma_f32_16x16x32_bf16 a[0:3], v[68:71], v[60:63], a[0:3]
ds_read_b128 v[52:55], v3 offset:36864
v_mfma_f32_16x16x32_bf16 a[4:7], v[72:75], v[56:59], a[4:7]
s_mov_b64 vcc, s[94:95]
v_cndmask_b32_dpp v18, v194, v192, vcc quad_perm:[1,0,3,2] row_mask:0xf bank_mask:0xf
v_cndmask_b32_dpp v19, v195, v193, vcc quad_perm:[1,0,3,2] row_mask:0xf bank_mask:0xf
v_mfma_f32_16x16x32_bf16 a[4:7], v[76:79], v[60:63], a[4:7]
s_not_b64 vcc, s[94:95]
v_cndmask_b32_dpp v194, v192, v194, vcc quad_perm:[1,0,3,2] row_mask:0xf bank_mask:0xf
v_cndmask_b32_dpp v195, v193, v195, vcc quad_perm:[1,0,3,2] row_mask:0xf bank_mask:0xf
v_mfma_f32_16x16x32_bf16 a[8:11], v[80:83], v[56:59], a[8:11]
v_perm_b32 v96, v194, v18, s100
v_perm_b32 v104, v194, v18, s101
s_add_u32 m0, s3, 0x14000
v_mfma_f32_16x16x32_bf16 a[8:11], v[84:87], v[60:63], a[8:11]
v_perm_b32 v112, v195, v19, s100
v_perm_b32 v120, v195, v19, s101
buffer_load_dwordx4 v8, s[8:11], s35 offen nt lds
s_add_u32 s35, s35, 0x10000
v_mfma_f32_16x16x32_bf16 a[12:15], v[88:91], v[56:59], a[12:15]
s_add_u32 s40, s39, 0x80000
buffer_load_dwordx4 v[192:195], v0, s[96:99], s40 offen
s_add_u32 m0, s3, 0x15000
v_mfma_f32_16x16x32_bf16 a[12:15], v[92:95], v[60:63], a[12:15]
buffer_load_dwordx4 v8, s[8:11], s35 offen nt lds
s_add_u32 s35, s35, 0x10000
s_waitcnt lgkmcnt(2)
v_mfma_f32_16x16x32_bf16 a[16:19], v[64:67], v[40:43], a[16:19]
ds_read_b128 v[56:59], v2 offset:38912
s_add_u32 m0, s3, 0x16000
v_mfma_f32_16x16x32_bf16 a[16:19], v[68:71], v[44:47], a[16:19]
ds_read_b128 v[60:63], v3 offset:38912
buffer_load_dwordx4 v8, s[8:11], s35 offen nt lds
s_add_u32 s35, s35, 0x10000
v_mfma_f32_16x16x32_bf16 a[20:23], v[72:75], v[40:43], a[20:23]
s_waitcnt vmcnt(42)
s_mov_b64 vcc, s[94:95]
v_cndmask_b32_dpp v18, v198, v196, vcc quad_perm:[1,0,3,2] row_mask:0xf bank_mask:0xf
v_cndmask_b32_dpp v19, v199, v197, vcc quad_perm:[1,0,3,2] row_mask:0xf bank_mask:0xf
s_add_u32 m0, s3, 0x17000
v_mfma_f32_16x16x32_bf16 a[20:23], v[76:79], v[44:47], a[20:23]
s_not_b64 vcc, s[94:95]
v_cndmask_b32_dpp v198, v196, v198, vcc quad_perm:[1,0,3,2] row_mask:0xf bank_mask:0xf
v_cndmask_b32_dpp v199, v197, v199, vcc quad_perm:[1,0,3,2] row_mask:0xf bank_mask:0xf
buffer_load_dwordx4 v8, s[8:11], s35 offen nt lds
s_sub_u32 s35, s35, 196480
v_mfma_f32_16x16x32_bf16 a[24:27], v[80:83], v[40:43], a[24:27]
v_perm_b32 v97, v198, v18, s100
v_perm_b32 v105, v198, v18, s101
v_mfma_f32_16x16x32_bf16 a[24:27], v[84:87], v[44:47], a[24:27]
v_perm_b32 v113, v199, v19, s100
v_perm_b32 v121, v199, v19, s101
v_mfma_f32_16x16x32_bf16 a[28:31], v[88:91], v[40:43], a[28:31]
s_add_u32 s40, s39, 0x81000
buffer_load_dwordx4 v[196:199], v0, s[96:99], s40 offen
v_mfma_f32_16x16x32_bf16 a[28:31], v[92:95], v[44:47], a[28:31]
s_waitcnt lgkmcnt(2)
v_mfma_f32_16x16x32_bf16 a[32:35], v[64:67], v[48:51], a[32:35]
ds_read_b128 v[40:43], v2 offset:40960
v_mfma_f32_16x16x32_bf16 a[32:35], v[68:71], v[52:55], a[32:35]
ds_read_b128 v[44:47], v3 offset:40960
v_mfma_f32_16x16x32_bf16 a[36:39], v[72:75], v[48:51], a[36:39]
s_waitcnt vmcnt(43)
s_mov_b64 vcc, s[94:95]
v_cndmask_b32_dpp v18, v202, v200, vcc quad_perm:[1,0,3,2] row_mask:0xf bank_mask:0xf
v_cndmask_b32_dpp v19, v203, v201, vcc quad_perm:[1,0,3,2] row_mask:0xf bank_mask:0xf
v_mfma_f32_16x16x32_bf16 a[36:39], v[76:79], v[52:55], a[36:39]
s_not_b64 vcc, s[94:95]
v_cndmask_b32_dpp v202, v200, v202, vcc quad_perm:[1,0,3,2] row_mask:0xf bank_mask:0xf
v_cndmask_b32_dpp v203, v201, v203, vcc quad_perm:[1,0,3,2] row_mask:0xf bank_mask:0xf
v_mfma_f32_16x16x32_bf16 a[40:43], v[80:83], v[48:51], a[40:43]
v_perm_b32 v98, v202, v18, s100
v_perm_b32 v106, v202, v18, s101
v_mfma_f32_16x16x32_bf16 a[40:43], v[84:87], v[52:55], a[40:43]
v_perm_b32 v114, v203, v19, s100
v_perm_b32 v122, v203, v19, s101
v_mfma_f32_16x16x32_bf16 a[44:47], v[88:91], v[48:51], a[44:47]
s_add_u32 s40, s39, 0x82000
buffer_load_dwordx4 v[200:203], v0, s[96:99], s40 offen
v_mfma_f32_16x16x32_bf16 a[44:47], v[92:95], v[52:55], a[44:47]
s_waitcnt lgkmcnt(2)
v_mfma_f32_16x16x32_bf16 a[48:51], v[64:67], v[56:59], a[48:51]
ds_read_b128 v[48:51], v2 offset:43008
v_mfma_f32_16x16x32_bf16 a[48:51], v[68:71], v[60:63], a[48:51]
ds_read_b128 v[52:55], v3 offset:43008
v_mfma_f32_16x16x32_bf16 a[52:55], v[72:75], v[56:59], a[52:55]
s_waitcnt vmcnt(43)
s_mov_b64 vcc, s[94:95]
v_cndmask_b32_dpp v18, v206, v204, vcc quad_perm:[1,0,3,2] row_mask:0xf bank_mask:0xf
v_cndmask_b32_dpp v19, v207, v205, vcc quad_perm:[1,0,3,2] row_mask:0xf bank_mask:0xf
v_mfma_f32_16x16x32_bf16 a[52:55], v[76:79], v[60:63], a[52:55]
s_not_b64 vcc, s[94:95]
v_cndmask_b32_dpp v206, v204, v206, vcc quad_perm:[1,0,3,2] row_mask:0xf bank_mask:0xf
v_cndmask_b32_dpp v207, v205, v207, vcc quad_perm:[1,0,3,2] row_mask:0xf bank_mask:0xf
v_mfma_f32_16x16x32_bf16 a[56:59], v[80:83], v[56:59], a[56:59]
v_perm_b32 v99, v206, v18, s100
v_perm_b32 v107, v206, v18, s101
v_mfma_f32_16x16x32_bf16 a[56:59], v[84:87], v[60:63], a[56:59]
v_perm_b32 v115, v207, v19, s100
v_perm_b32 v123, v207, v19, s101
v_mfma_f32_16x16x32_bf16 a[60:63], v[88:91], v[56:59], a[60:63]
s_add_u32 s40, s39, 0x83000
buffer_load_dwordx4 v[204:207], v0, s[96:99], s40 offen
v_mfma_f32_16x16x32_bf16 a[60:63], v[92:95], v[60:63], a[60:63]
s_waitcnt lgkmcnt(2)
v_mfma_f32_16x16x32_bf16 a[64:67], v[64:67], v[40:43], a[64:67]
ds_read_b128 v[56:59], v2 offset:45056
v_mfma_f32_16x16x32_bf16 a[64:67], v[68:71], v[44:47], a[64:67]
ds_read_b128 v[60:63], v3 offset:45056
v_mfma_f32_16x16x32_bf16 a[68:71], v[72:75], v[40:43], a[68:71]
s_waitcnt vmcnt(41)
s_mov_b64 vcc, s[94:95]
v_cndmask_b32_dpp v18, v210, v208, vcc quad_perm:[1,0,3,2] row_mask:0xf bank_mask:0xf
v_cndmask_b32_dpp v19, v211, v209, vcc quad_perm:[1,0,3,2] row_mask:0xf bank_mask:0xf
v_mfma_f32_16x16x32_bf16 a[68:71], v[76:79], v[44:47], a[68:71]
s_not_b64 vcc, s[94:95]
v_cndmask_b32_dpp v210, v208, v210, vcc quad_perm:[1,0,3,2] row_mask:0xf bank_mask:0xf
v_cndmask_b32_dpp v211, v209, v211, vcc quad_perm:[1,0,3,2] row_mask:0xf bank_mask:0xf
v_mfma_f32_16x16x32_bf16 a[72:75], v[80:83], v[40:43], a[72:75]
v_perm_b32 v100, v210, v18, s100
v_perm_b32 v108, v210, v18, s101
v_mfma_f32_16x16x32_bf16 a[72:75], v[84:87], v[44:47], a[72:75]
v_perm_b32 v116, v211, v19, s100
v_perm_b32 v124, v211, v19, s101
v_mfma_f32_16x16x32_bf16 a[76:79], v[88:91], v[40:43], a[76:79]
s_add_u32 s40, s39, 0x90000
buffer_load_dwordx4 v[208:211], v0, s[96:99], s40 offen
v_mfma_f32_16x16x32_bf16 a[76:79], v[92:95], v[44:47], a[76:79]
s_waitcnt lgkmcnt(2)
v_mfma_f32_16x16x32_bf16 a[80:83], v[64:67], v[48:51], a[80:83]
ds_read_b128 v[40:43], v2 offset:47104
v_mfma_f32_16x16x32_bf16 a[80:83], v[68:71], v[52:55], a[80:83]
ds_read_b128 v[44:47], v3 offset:47104
v_mov_b32 v12, 0
s_mov_b64 exec, 1
buffer_store_dword v12, off, s[24:27], s41 sc1
s_mov_b64 exec, -1
v_mfma_f32_16x16x32_bf16 a[84:87], v[72:75], v[48:51], a[84:87]
s_waitcnt vmcnt(40)
s_mov_b64 vcc, s[94:95]
v_cndmask_b32_dpp v18, v214, v212, vcc quad_perm:[1,0,3,2] row_mask:0xf bank_mask:0xf
v_cndmask_b32_dpp v19, v215, v213, vcc quad_perm:[1,0,3,2] row_mask:0xf bank_mask:0xf
v_mfma_f32_16x16x32_bf16 a[84:87], v[76:79], v[52:55], a[84:87]
s_not_b64 vcc, s[94:95]
v_cndmask_b32_dpp v214, v212, v214, vcc quad_perm:[1,0,3,2] row_mask:0xf bank_mask:0xf
v_cndmask_b32_dpp v215, v213, v215, vcc quad_perm:[1,0,3,2] row_mask:0xf bank_mask:0xf
v_mfma_f32_16x16x32_bf16 a[88:91], v[80:83], v[48:51], a[88:91]
v_perm_b32 v101, v214, v18, s100
v_perm_b32 v109, v214, v18, s101
v_mfma_f32_16x16x32_bf16 a[88:91], v[84:87], v[52:55], a[88:91]
v_perm_b32 v117, v215, v19, s100
v_perm_b32 v125, v215, v19, s101
v_mfma_f32_16x16x32_bf16 a[92:95], v[88:91], v[48:51], a[92:95]
s_add_u32 s40, s39, 0x91000
buffer_load_dwordx4 v[212:215], v0, s[96:99], s40 offen
v_mfma_f32_16x16x32_bf16 a[92:95], v[92:95], v[52:55], a[92:95]
s_waitcnt vmcnt(26)
v_perm_b32 v32, v226, v224, s100
s_waitcnt lgkmcnt(2)
v_mfma_f32_16x16x32_bf16 a[96:99], v[64:67], v[56:59], a[96:99]
ds_read_b128 v[48:51], v2 offset:32768
v_perm_b32 v33, v230, v228, s100
v_mfma_f32_16x16x32_bf16 a[96:99], v[68:71], v[60:63], a[96:99]
ds_read_b128 v[52:55], v3 offset:32768
v_perm_b32 v34, v234, v232, s100
v_mfma_f32_16x16x32_bf16 a[100:103], v[72:75], v[56:59], a[100:103]
s_mov_b64 vcc, s[94:95]
v_cndmask_b32_dpp v18, v218, v216, vcc quad_perm:[1,0,3,2] row_mask:0xf bank_mask:0xf
v_cndmask_b32_dpp v19, v219, v217, vcc quad_perm:[1,0,3,2] row_mask:0xf bank_mask:0xf
v_mfma_f32_16x16x32_bf16 a[100:103], v[76:79], v[60:63], a[100:103]
s_not_b64 vcc, s[94:95]
v_cndmask_b32_dpp v218, v216, v218, vcc quad_perm:[1,0,3,2] row_mask:0xf bank_mask:0xf
v_cndmask_b32_dpp v219, v217, v219, vcc quad_perm:[1,0,3,2] row_mask:0xf bank_mask:0xf
v_mfma_f32_16x16x32_bf16 a[104:107], v[80:83], v[56:59], a[104:107]
v_perm_b32 v102, v218, v18, s100
v_perm_b32 v110, v218, v18, s101
v_mfma_f32_16x16x32_bf16 a[104:107], v[84:87], v[60:63], a[104:107]
v_perm_b32 v118, v219, v19, s100
v_perm_b32 v126, v219, v19, s101
v_perm_b32 v35, v238, v236, s100
v_mfma_f32_16x16x32_bf16 a[108:111], v[88:91], v[56:59], a[108:111]
s_mov_b64 vcc, s[94:95]
v_cndmask_b32_dpp v18, v222, v220, vcc quad_perm:[1,0,3,2] row_mask:0xf bank_mask:0xf
v_cndmask_b32_dpp v19, v223, v221, vcc quad_perm:[1,0,3,2] row_mask:0xf bank_mask:0xf
v_mfma_f32_16x16x32_bf16 a[108:111], v[92:95], v[60:63], a[108:111]
s_not_b64 vcc, s[94:95]
v_cndmask_b32_dpp v222, v220, v222, vcc quad_perm:[1,0,3,2] row_mask:0xf bank_mask:0xf
v_cndmask_b32_dpp v223, v221, v223, vcc quad_perm:[1,0,3,2] row_mask:0xf bank_mask:0xf
s_waitcnt lgkmcnt(2)
v_mfma_f32_16x16x32_bf16 a[112:115], v[64:67], v[40:43], a[112:115]
ds_read_b128 v[56:59], v2 offset:34816
v_perm_b32 v103, v222, v18, s100
v_perm_b32 v111, v222, v18, s101
v_mfma_f32_16x16x32_bf16 a[112:115], v[68:71], v[44:47], a[112:115]
ds_read_b128 v[60:63], v3 offset:34816
v_perm_b32 v119, v223, v19, s100
v_perm_b32 v127, v223, v19, s101
v_mfma_f32_16x16x32_bf16 a[116:119], v[72:75], v[40:43], a[116:119]
s_add_u32 s40, s39, 0x92000
buffer_load_dwordx4 v[216:219], v0, s[96:99], s40 offen
buffer_store_dwordx4 v[32:35], v1, s[12:15], s85 offen offset:0 sc1
v_perm_b32 v36, v226, v224, s101
v_mfma_f32_16x16x32_bf16 a[116:119], v[76:79], v[44:47], a[116:119]
v_perm_b32 v37, v230, v228, s101
v_perm_b32 v38, v234, v232, s101
v_perm_b32 v39, v238, v236, s101
buffer_store_dwordx4 v[36:39], v1, s[12:15], s85 offen offset:2048 sc1
v_mfma_f32_16x16x32_bf16 a[120:123], v[80:83], v[40:43], a[120:123]
s_add_u32 s40, s39, 0x93000
buffer_load_dwordx4 v[220:223], v0, s[96:99], s40 offen
v_perm_b32 v32, v227, v225, s100
v_mfma_f32_16x16x32_bf16 a[120:123], v[84:87], v[44:47], a[120:123]
v_perm_b32 v33, v231, v229, s100
v_perm_b32 v34, v235, v233, s100
v_perm_b32 v35, v239, v237, s100
s_add_u32 s85, s85, 0x1000
v_mfma_f32_16x16x32_bf16 a[124:127], v[88:91], v[40:43], a[124:127]
buffer_store_dwordx4 v[32:35], v1, s[12:15], s85 offen offset:0 sc1
v_perm_b32 v36, v227, v225, s101
v_perm_b32 v37, v231, v229, s101
v_mfma_f32_16x16x32_bf16 a[124:127], v[92:95], v[44:47], a[124:127]
v_perm_b32 v38, v235, v233, s101
v_perm_b32 v39, v239, v237, s101
buffer_store_dwordx4 v[36:39], v1, s[12:15], s85 offen offset:2048 sc1
s_waitcnt lgkmcnt(2)
v_mfma_f32_16x16x32_bf16 a[128:131], v[96:99], v[48:51], a[128:131]
ds_read_b128 v[40:43], v2 offset:36864
v_mfma_f32_16x16x32_bf16 a[128:131], v[100:103], v[52:55], a[128:131]
ds_read_b128 v[44:47], v3 offset:36864
v_mfma_f32_16x16x32_bf16 a[132:135], v[104:107], v[48:51], a[132:135]
s_mov_b64 vcc, s[94:95]
v_cndmask_b32_dpp v18, v130, v128, vcc quad_perm:[1,0,3,2] row_mask:0xf bank_mask:0xf
v_cndmask_b32_dpp v19, v131, v129, vcc quad_perm:[1,0,3,2] row_mask:0xf bank_mask:0xf
v_mfma_f32_16x16x32_bf16 a[132:135], v[108:111], v[52:55], a[132:135]
s_not_b64 vcc, s[94:95]
v_cndmask_b32_dpp v130, v128, v130, vcc quad_perm:[1,0,3,2] row_mask:0xf bank_mask:0xf
v_cndmask_b32_dpp v131, v129, v131, vcc quad_perm:[1,0,3,2] row_mask:0xf bank_mask:0xf
v_mfma_f32_16x16x32_bf16 a[136:139], v[112:115], v[48:51], a[136:139]
v_perm_b32 v64, v130, v18, s100
v_perm_b32 v72, v130, v18, s101
s_add_u32 m0, s3, 0x18000
v_mfma_f32_16x16x32_bf16 a[136:139], v[116:119], v[52:55], a[136:139]
v_perm_b32 v80, v131, v19, s100
v_perm_b32 v88, v131, v19, s101
buffer_load_dwordx4 v8, s[8:11], s35 offen nt lds
s_add_u32 s35, s35, 0x10000
v_mfma_f32_16x16x32_bf16 a[140:143], v[120:123], v[48:51], a[140:143]
s_add_u32 s40, s39, 0xa0000
buffer_load_dwordx4 v[128:131], v0, s[96:99], s40 offen
s_add_u32 m0, s3, 0x19000
v_mfma_f32_16x16x32_bf16 a[140:143], v[124:127], v[52:55], a[140:143]
buffer_load_dwordx4 v8, s[8:11], s35 offen nt lds
s_add_u32 s35, s35, 0x10000
s_waitcnt lgkmcnt(2)
v_mfma_f32_16x16x32_bf16 a[144:147], v[96:99], v[56:59], a[144:147]
ds_read_b128 v[48:51], v2 offset:38912
s_add_u32 m0, s3, 0x1a000
v_mfma_f32_16x16x32_bf16 a[144:147], v[100:103], v[60:63], a[144:147]
ds_read_b128 v[52:55], v3 offset:38912
buffer_load_dwordx4 v8, s[8:11], s35 offen nt lds
s_add_u32 s35, s35, 0x10000
v_mfma_f32_16x16x32_bf16 a[148:151], v[104:107], v[56:59], a[148:151]
s_mov_b64 vcc, s[94:95]
v_cndmask_b32_dpp v18, v134, v132, vcc quad_perm:[1,0,3,2] row_mask:0xf bank_mask:0xf
v_cndmask_b32_dpp v19, v135, v133, vcc quad_perm:[1,0,3,2] row_mask:0xf bank_mask:0xf
s_add_u32 m0, s3, 0x1b000
v_mfma_f32_16x16x32_bf16 a[148:151], v[108:111], v[60:63], a[148:151]
s_not_b64 vcc, s[94:95]
v_cndmask_b32_dpp v134, v132, v134, vcc quad_perm:[1,0,3,2] row_mask:0xf bank_mask:0xf
v_cndmask_b32_dpp v135, v133, v135, vcc quad_perm:[1,0,3,2] row_mask:0xf bank_mask:0xf
buffer_load_dwordx4 v8, s[8:11], s35 offen nt lds
s_sub_u32 s35, s35, 196480
v_mfma_f32_16x16x32_bf16 a[152:155], v[112:115], v[56:59], a[152:155]
v_perm_b32 v65, v134, v18, s100
v_perm_b32 v73, v134, v18, s101
v_mfma_f32_16x16x32_bf16 a[152:155], v[116:119], v[60:63], a[152:155]
v_perm_b32 v81, v135, v19, s100
v_perm_b32 v89, v135, v19, s101
v_mfma_f32_16x16x32_bf16 a[156:159], v[120:123], v[56:59], a[156:159]
s_add_u32 s40, s39, 0xa1000
buffer_load_dwordx4 v[132:135], v0, s[96:99], s40 offen
v_mfma_f32_16x16x32_bf16 a[156:159], v[124:127], v[60:63], a[156:159]
s_waitcnt lgkmcnt(2)
v_mfma_f32_16x16x32_bf16 a[160:163], v[96:99], v[40:43], a[160:163]
ds_read_b128 v[56:59], v2 offset:40960
v_mfma_f32_16x16x32_bf16 a[160:163], v[100:103], v[44:47], a[160:163]
ds_read_b128 v[60:63], v3 offset:40960
v_mfma_f32_16x16x32_bf16 a[164:167], v[104:107], v[40:43], a[164:167]
s_mov_b64 vcc, s[94:95]
v_cndmask_b32_dpp v18, v138, v136, vcc quad_perm:[1,0,3,2] row_mask:0xf bank_mask:0xf
v_cndmask_b32_dpp v19, v139, v137, vcc quad_perm:[1,0,3,2] row_mask:0xf bank_mask:0xf
v_mfma_f32_16x16x32_bf16 a[164:167], v[108:111], v[44:47], a[164:167]
s_not_b64 vcc, s[94:95]
v_cndmask_b32_dpp v138, v136, v138, vcc quad_perm:[1,0,3,2] row_mask:0xf bank_mask:0xf
v_cndmask_b32_dpp v139, v137, v139, vcc quad_perm:[1,0,3,2] row_mask:0xf bank_mask:0xf
v_mfma_f32_16x16x32_bf16 a[168:171], v[112:115], v[40:43], a[168:171]
v_perm_b32 v66, v138, v18, s100
v_perm_b32 v74, v138, v18, s101
v_mfma_f32_16x16x32_bf16 a[168:171], v[116:119], v[44:47], a[168:171]
v_perm_b32 v82, v139, v19, s100
v_perm_b32 v90, v139, v19, s101
v_mfma_f32_16x16x32_bf16 a[172:175], v[120:123], v[40:43], a[172:175]
s_add_u32 s40, s39, 0xa2000
buffer_load_dwordx4 v[136:139], v0, s[96:99], s40 offen
v_mfma_f32_16x16x32_bf16 a[172:175], v[124:127], v[44:47], a[172:175]
s_waitcnt lgkmcnt(2)
v_mfma_f32_16x16x32_bf16 a[176:179], v[96:99], v[48:51], a[176:179]
ds_read_b128 v[40:43], v2 offset:43008
v_mfma_f32_16x16x32_bf16 a[176:179], v[100:103], v[52:55], a[176:179]
ds_read_b128 v[44:47], v3 offset:43008
v_mfma_f32_16x16x32_bf16 a[180:183], v[104:107], v[48:51], a[180:183]
s_mov_b64 vcc, s[94:95]
v_cndmask_b32_dpp v18, v142, v140, vcc quad_perm:[1,0,3,2] row_mask:0xf bank_mask:0xf
v_cndmask_b32_dpp v19, v143, v141, vcc quad_perm:[1,0,3,2] row_mask:0xf bank_mask:0xf
v_mfma_f32_16x16x32_bf16 a[180:183], v[108:111], v[52:55], a[180:183]
s_not_b64 vcc, s[94:95]
v_cndmask_b32_dpp v142, v140, v142, vcc quad_perm:[1,0,3,2] row_mask:0xf bank_mask:0xf
v_cndmask_b32_dpp v143, v141, v143, vcc quad_perm:[1,0,3,2] row_mask:0xf bank_mask:0xf
v_mfma_f32_16x16x32_bf16 a[184:187], v[112:115], v[48:51], a[184:187]
v_perm_b32 v67, v142, v18, s100
v_perm_b32 v75, v142, v18, s101
v_mfma_f32_16x16x32_bf16 a[184:187], v[116:119], v[52:55], a[184:187]
v_perm_b32 v83, v143, v19, s100
v_perm_b32 v91, v143, v19, s101
v_mfma_f32_16x16x32_bf16 a[188:191], v[120:123], v[48:51], a[188:191]
s_add_u32 s40, s39, 0xa3000
buffer_load_dwordx4 v[140:143], v0, s[96:99], s40 offen
v_mfma_f32_16x16x32_bf16 a[188:191], v[124:127], v[52:55], a[188:191]
s_waitcnt lgkmcnt(2)
v_mfma_f32_16x16x32_bf16 a[192:195], v[96:99], v[56:59], a[192:195]
ds_read_b128 v[48:51], v2 offset:45056
v_mfma_f32_16x16x32_bf16 a[192:195], v[100:103], v[60:63], a[192:195]
ds_read_b128 v[52:55], v3 offset:45056
v_mfma_f32_16x16x32_bf16 a[196:199], v[104:107], v[56:59], a[196:199]
s_mov_b64 vcc, s[94:95]
v_cndmask_b32_dpp v18, v146, v144, vcc quad_perm:[1,0,3,2] row_mask:0xf bank_mask:0xf
v_cndmask_b32_dpp v19, v147, v145, vcc quad_perm:[1,0,3,2] row_mask:0xf bank_mask:0xf
v_mfma_f32_16x16x32_bf16 a[196:199], v[108:111], v[60:63], a[196:199]
s_not_b64 vcc, s[94:95]
v_cndmask_b32_dpp v146, v144, v146, vcc quad_perm:[1,0,3,2] row_mask:0xf bank_mask:0xf
v_cndmask_b32_dpp v147, v145, v147, vcc quad_perm:[1,0,3,2] row_mask:0xf bank_mask:0xf
v_mfma_f32_16x16x32_bf16 a[200:203], v[112:115], v[56:59], a[200:203]
v_perm_b32 v68, v146, v18, s100
v_perm_b32 v76, v146, v18, s101
v_mfma_f32_16x16x32_bf16 a[200:203], v[116:119], v[60:63], a[200:203]
v_perm_b32 v84, v147, v19, s100
v_perm_b32 v92, v147, v19, s101
v_mfma_f32_16x16x32_bf16 a[204:207], v[120:123], v[56:59], a[204:207]
s_add_u32 s40, s39, 0xb0000
buffer_load_dwordx4 v[144:147], v0, s[96:99], s40 offen
v_mfma_f32_16x16x32_bf16 a[204:207], v[124:127], v[60:63], a[204:207]
s_waitcnt lgkmcnt(2)
v_mfma_f32_16x16x32_bf16 a[208:211], v[96:99], v[40:43], a[208:211]
ds_read_b128 v[56:59], v2 offset:47104
v_mfma_f32_16x16x32_bf16 a[208:211], v[100:103], v[44:47], a[208:211]
ds_read_b128 v[60:63], v3 offset:47104
v_mfma_f32_16x16x32_bf16 a[212:215], v[104:107], v[40:43], a[212:215]
s_waitcnt vmcnt(40)
s_mov_b64 vcc, s[94:95]
v_cndmask_b32_dpp v18, v150, v148, vcc quad_perm:[1,0,3,2] row_mask:0xf bank_mask:0xf
v_cndmask_b32_dpp v19, v151, v149, vcc quad_perm:[1,0,3,2] row_mask:0xf bank_mask:0xf
v_mfma_f32_16x16x32_bf16 a[212:215], v[108:111], v[44:47], a[212:215]
s_not_b64 vcc, s[94:95]
v_cndmask_b32_dpp v150, v148, v150, vcc quad_perm:[1,0,3,2] row_mask:0xf bank_mask:0xf
v_cndmask_b32_dpp v151, v149, v151, vcc quad_perm:[1,0,3,2] row_mask:0xf bank_mask:0xf
v_mfma_f32_16x16x32_bf16 a[216:219], v[112:115], v[40:43], a[216:219]
v_perm_b32 v69, v150, v18, s100
v_perm_b32 v77, v150, v18, s101
v_mfma_f32_16x16x32_bf16 a[216:219], v[116:119], v[44:47], a[216:219]
v_perm_b32 v85, v151, v19, s100
v_perm_b32 v93, v151, v19, s101
v_mfma_f32_16x16x32_bf16 a[220:223], v[120:123], v[40:43], a[220:223]
s_add_u32 s40, s39, 0xb1000
buffer_load_dwordx4 v[148:151], v0, s[96:99], s40 offen
v_mfma_f32_16x16x32_bf16 a[220:223], v[124:127], v[44:47], a[220:223]
s_waitcnt lgkmcnt(2)
v_mfma_f32_16x16x32_bf16 a[224:227], v[96:99], v[48:51], a[224:227]
v_mfma_f32_16x16x32_bf16 a[224:227], v[100:103], v[52:55], a[224:227]
v_mfma_f32_16x16x32_bf16 a[228:231], v[104:107], v[48:51], a[228:231]
s_waitcnt vmcnt(40)
s_mov_b64 vcc, s[94:95]
v_cndmask_b32_dpp v18, v154, v152, vcc quad_perm:[1,0,3,2] row_mask:0xf bank_mask:0xf
v_cndmask_b32_dpp v19, v155, v153, vcc quad_perm:[1,0,3,2] row_mask:0xf bank_mask:0xf
v_mfma_f32_16x16x32_bf16 a[228:231], v[108:111], v[52:55], a[228:231]
s_not_b64 vcc, s[94:95]
v_cndmask_b32_dpp v154, v152, v154, vcc quad_perm:[1,0,3,2] row_mask:0xf bank_mask:0xf
v_cndmask_b32_dpp v155, v153, v155, vcc quad_perm:[1,0,3,2] row_mask:0xf bank_mask:0xf
v_mfma_f32_16x16x32_bf16 a[232:235], v[112:115], v[48:51], a[232:235]
v_perm_b32 v70, v154, v18, s100
v_perm_b32 v78, v154, v18, s101
v_mfma_f32_16x16x32_bf16 a[232:235], v[116:119], v[52:55], a[232:235]
v_perm_b32 v86, v155, v19, s100
v_perm_b32 v94, v155, v19, s101
v_mfma_f32_16x16x32_bf16 a[236:239], v[120:123], v[48:51], a[236:239]
s_waitcnt vmcnt(39)
s_mov_b64 vcc, s[94:95]
v_cndmask_b32_dpp v18, v158, v156, vcc quad_perm:[1,0,3,2] row_mask:0xf bank_mask:0xf
v_cndmask_b32_dpp v19, v159, v157, vcc quad_perm:[1,0,3,2] row_mask:0xf bank_mask:0xf
v_mfma_f32_16x16x32_bf16 a[236:239], v[124:127], v[52:55], a[236:239]
s_not_b64 vcc, s[94:95]
v_cndmask_b32_dpp v158, v156, v158, vcc quad_perm:[1,0,3,2] row_mask:0xf bank_mask:0xf
v_cndmask_b32_dpp v159, v157, v159, vcc quad_perm:[1,0,3,2] row_mask:0xf bank_mask:0xf
s_waitcnt lgkmcnt(0)
s_waitcnt vmcnt(10)
s_barrier
v_mov_b32 v12, 1
s_lshl_b32 s5, s92, 7
s_cmp_eq_u32 s32, 0
s_cselect_b64 exec, 1, 0
buffer_atomic_add v12, off, s[80:83], s5 sc1
s_mov_b64 exec, -1
v_mfma_f32_16x16x32_bf16 a[240:243], v[96:99], v[56:59], a[240:243]
ds_read_b128 v[40:43], v2 offset:49152
v_perm_b32 v71, v158, v18, s100
v_perm_b32 v79, v158, v18, s101
v_mfma_f32_16x16x32_bf16 a[240:243], v[100:103], v[60:63], a[240:243]
ds_read_b128 v[44:47], v3 offset:49152
v_perm_b32 v87, v159, v19, s100
v_perm_b32 v95, v159, v19, s101
v_mfma_f32_16x16x32_bf16 a[244:247], v[104:107], v[56:59], a[244:247]
ds_read_b128 v[48:51], v2 offset:51200
s_add_u32 s40, s39, 0xb2000
buffer_load_dwordx4 v[152:155], v0, s[96:99], s40 offen
v_mfma_f32_16x16x32_bf16 a[244:247], v[108:111], v[60:63], a[244:247]
ds_read_b128 v[52:55], v3 offset:51200
v_mfma_f32_16x16x32_bf16 a[248:251], v[112:115], v[56:59], a[248:251]
s_add_u32 s40, s39, 0xb3000
buffer_load_dwordx4 v[156:159], v0, s[96:99], s40 offen
v_mfma_f32_16x16x32_bf16 a[248:251], v[116:119], v[60:63], a[248:251]
v_mfma_f32_16x16x32_bf16 a[252:255], v[120:123], v[56:59], a[252:255]
v_mfma_f32_16x16x32_bf16 a[252:255], v[124:127], v[60:63], a[252:255]
s_waitcnt lgkmcnt(2)
v_mfma_f32_16x16x32_bf16 a[0:3], v[64:67], v[40:43], a[0:3]
ds_read_b128 v[56:59], v2 offset:53248
v_mfma_f32_16x16x32_bf16 a[0:3], v[68:71], v[44:47], a[0:3]
ds_read_b128 v[60:63], v3 offset:53248
v_mfma_f32_16x16x32_bf16 a[4:7], v[72:75], v[40:43], a[4:7]
s_mov_b64 vcc, s[94:95]
v_cndmask_b32_dpp v18, v162, v160, vcc quad_perm:[1,0,3,2] row_mask:0xf bank_mask:0xf
v_cndmask_b32_dpp v19, v163, v161, vcc quad_perm:[1,0,3,2] row_mask:0xf bank_mask:0xf
v_mfma_f32_16x16x32_bf16 a[4:7], v[76:79], v[44:47], a[4:7]
s_not_b64 vcc, s[94:95]
v_cndmask_b32_dpp v162, v160, v162, vcc quad_perm:[1,0,3,2] row_mask:0xf bank_mask:0xf
v_cndmask_b32_dpp v163, v161, v163, vcc quad_perm:[1,0,3,2] row_mask:0xf bank_mask:0xf
v_mfma_f32_16x16x32_bf16 a[8:11], v[80:83], v[40:43], a[8:11]
v_perm_b32 v96, v162, v18, s100
v_perm_b32 v104, v162, v18, s101
s_add_u32 m0, s3, 0x1c000
v_mfma_f32_16x16x32_bf16 a[8:11], v[84:87], v[44:47], a[8:11]
v_perm_b32 v112, v163, v19, s100
v_perm_b32 v120, v163, v19, s101
buffer_load_dwordx4 v8, s[8:11], s35 offen nt lds
s_add_u32 s35, s35, 0x10000
v_mfma_f32_16x16x32_bf16 a[12:15], v[88:91], v[40:43], a[12:15]
s_add_u32 s40, s39, 0xc0000
buffer_load_dwordx4 v[160:163], v0, s[96:99], s40 offen
s_add_u32 m0, s3, 0x1d000
v_mfma_f32_16x16x32_bf16 a[12:15], v[92:95], v[44:47], a[12:15]
buffer_load_dwordx4 v8, s[8:11], s35 offen nt lds
s_add_u32 s35, s35, 0x10000
s_waitcnt lgkmcnt(2)
v_mfma_f32_16x16x32_bf16 a[16:19], v[64:67], v[48:51], a[16:19]
ds_read_b128 v[40:43], v2 offset:55296
s_add_u32 m0, s3, 0x1e000
v_mfma_f32_16x16x32_bf16 a[16:19], v[68:71], v[52:55], a[16:19]
ds_read_b128 v[44:47], v3 offset:55296
buffer_load_dwordx4 v8, s[8:11], s35 offen nt lds
s_add_u32 s35, s35, 0x10000
v_mfma_f32_16x16x32_bf16 a[20:23], v[72:75], v[48:51], a[20:23]
s_mov_b64 vcc, s[94:95]
v_cndmask_b32_dpp v18, v166, v164, vcc quad_perm:[1,0,3,2] row_mask:0xf bank_mask:0xf
v_cndmask_b32_dpp v19, v167, v165, vcc quad_perm:[1,0,3,2] row_mask:0xf bank_mask:0xf
s_add_u32 m0, s3, 0x1f000
v_mfma_f32_16x16x32_bf16 a[20:23], v[76:79], v[52:55], a[20:23]
s_not_b64 vcc, s[94:95]
v_cndmask_b32_dpp v166, v164, v166, vcc quad_perm:[1,0,3,2] row_mask:0xf bank_mask:0xf
v_cndmask_b32_dpp v167, v165, v167, vcc quad_perm:[1,0,3,2] row_mask:0xf bank_mask:0xf
buffer_load_dwordx4 v8, s[8:11], s35 offen nt lds
v_mfma_f32_16x16x32_bf16 a[24:27], v[80:83], v[48:51], a[24:27]
v_perm_b32 v97, v166, v18, s100
v_perm_b32 v105, v166, v18, s101
v_mfma_f32_16x16x32_bf16 a[24:27], v[84:87], v[52:55], a[24:27]
v_perm_b32 v113, v167, v19, s100
v_perm_b32 v121, v167, v19, s101
v_mfma_f32_16x16x32_bf16 a[28:31], v[88:91], v[48:51], a[28:31]
s_add_u32 s40, s39, 0xc1000
buffer_load_dwordx4 v[164:167], v0, s[96:99], s40 offen
v_mfma_f32_16x16x32_bf16 a[28:31], v[92:95], v[52:55], a[28:31]
s_waitcnt lgkmcnt(2)
v_mfma_f32_16x16x32_bf16 a[32:35], v[64:67], v[56:59], a[32:35]
ds_read_b128 v[48:51], v2 offset:57344
v_mfma_f32_16x16x32_bf16 a[32:35], v[68:71], v[60:63], a[32:35]
ds_read_b128 v[52:55], v3 offset:57344
v_mfma_f32_16x16x32_bf16 a[36:39], v[72:75], v[56:59], a[36:39]
s_mov_b64 vcc, s[94:95]
v_cndmask_b32_dpp v18, v170, v168, vcc quad_perm:[1,0,3,2] row_mask:0xf bank_mask:0xf
v_cndmask_b32_dpp v19, v171, v169, vcc quad_perm:[1,0,3,2] row_mask:0xf bank_mask:0xf
v_mfma_f32_16x16x32_bf16 a[36:39], v[76:79], v[60:63], a[36:39]
s_not_b64 vcc, s[94:95]
v_cndmask_b32_dpp v170, v168, v170, vcc quad_perm:[1,0,3,2] row_mask:0xf bank_mask:0xf
v_cndmask_b32_dpp v171, v169, v171, vcc quad_perm:[1,0,3,2] row_mask:0xf bank_mask:0xf
v_mfma_f32_16x16x32_bf16 a[40:43], v[80:83], v[56:59], a[40:43]
v_perm_b32 v98, v170, v18, s100
v_perm_b32 v106, v170, v18, s101
v_mfma_f32_16x16x32_bf16 a[40:43], v[84:87], v[60:63], a[40:43]
v_perm_b32 v114, v171, v19, s100
v_perm_b32 v122, v171, v19, s101
v_mfma_f32_16x16x32_bf16 a[44:47], v[88:91], v[56:59], a[44:47]
s_add_u32 s40, s39, 0xc2000
buffer_load_dwordx4 v[168:171], v0, s[96:99], s40 offen
v_mfma_f32_16x16x32_bf16 a[44:47], v[92:95], v[60:63], a[44:47]
s_waitcnt lgkmcnt(2)
v_mfma_f32_16x16x32_bf16 a[48:51], v[64:67], v[40:43], a[48:51]
ds_read_b128 v[56:59], v2 offset:59392
v_mfma_f32_16x16x32_bf16 a[48:51], v[68:71], v[44:47], a[48:51]
ds_read_b128 v[60:63], v3 offset:59392
v_mfma_f32_16x16x32_bf16 a[52:55], v[72:75], v[40:43], a[52:55]
s_mov_b64 vcc, s[94:95]
v_cndmask_b32_dpp v18, v174, v172, vcc quad_perm:[1,0,3,2] row_mask:0xf bank_mask:0xf
v_cndmask_b32_dpp v19, v175, v173, vcc quad_perm:[1,0,3,2] row_mask:0xf bank_mask:0xf
v_mfma_f32_16x16x32_bf16 a[52:55], v[76:79], v[44:47], a[52:55]
s_not_b64 vcc, s[94:95]
v_cndmask_b32_dpp v174, v172, v174, vcc quad_perm:[1,0,3,2] row_mask:0xf bank_mask:0xf
v_cndmask_b32_dpp v175, v173, v175, vcc quad_perm:[1,0,3,2] row_mask:0xf bank_mask:0xf
v_mfma_f32_16x16x32_bf16 a[56:59], v[80:83], v[40:43], a[56:59]
v_perm_b32 v99, v174, v18, s100
v_perm_b32 v107, v174, v18, s101
v_mfma_f32_16x16x32_bf16 a[56:59], v[84:87], v[44:47], a[56:59]
v_perm_b32 v115, v175, v19, s100
v_perm_b32 v123, v175, v19, s101
v_mfma_f32_16x16x32_bf16 a[60:63], v[88:91], v[40:43], a[60:63]
s_add_u32 s40, s39, 0xc3000
buffer_load_dwordx4 v[172:175], v0, s[96:99], s40 offen
v_mfma_f32_16x16x32_bf16 a[60:63], v[92:95], v[44:47], a[60:63]
s_waitcnt lgkmcnt(2)
v_mfma_f32_16x16x32_bf16 a[64:67], v[64:67], v[48:51], a[64:67]
ds_read_b128 v[40:43], v2 offset:61440
v_mfma_f32_16x16x32_bf16 a[64:67], v[68:71], v[52:55], a[64:67]
ds_read_b128 v[44:47], v3 offset:61440
v_mfma_f32_16x16x32_bf16 a[68:71], v[72:75], v[48:51], a[68:71]
s_mov_b64 vcc, s[94:95]
v_cndmask_b32_dpp v18, v178, v176, vcc quad_perm:[1,0,3,2] row_mask:0xf bank_mask:0xf
v_cndmask_b32_dpp v19, v179, v177, vcc quad_perm:[1,0,3,2] row_mask:0xf bank_mask:0xf
v_mfma_f32_16x16x32_bf16 a[68:71], v[76:79], v[52:55], a[68:71]
s_not_b64 vcc, s[94:95]
v_cndmask_b32_dpp v178, v176, v178, vcc quad_perm:[1,0,3,2] row_mask:0xf bank_mask:0xf
v_cndmask_b32_dpp v179, v177, v179, vcc quad_perm:[1,0,3,2] row_mask:0xf bank_mask:0xf
v_mfma_f32_16x16x32_bf16 a[72:75], v[80:83], v[48:51], a[72:75]
v_perm_b32 v100, v178, v18, s100
v_perm_b32 v108, v178, v18, s101
v_mfma_f32_16x16x32_bf16 a[72:75], v[84:87], v[52:55], a[72:75]
v_perm_b32 v116, v179, v19, s100
v_perm_b32 v124, v179, v19, s101
v_mfma_f32_16x16x32_bf16 a[76:79], v[88:91], v[48:51], a[76:79]
s_add_u32 s40, s39, 0xd0000
buffer_load_dwordx4 v[176:179], v0, s[96:99], s40 offen
v_mfma_f32_16x16x32_bf16 a[76:79], v[92:95], v[52:55], a[76:79]
s_waitcnt lgkmcnt(2)
v_mfma_f32_16x16x32_bf16 a[80:83], v[64:67], v[56:59], a[80:83]
ds_read_b128 v[48:51], v2 offset:63488
v_mfma_f32_16x16x32_bf16 a[80:83], v[68:71], v[60:63], a[80:83]
ds_read_b128 v[52:55], v3 offset:63488
v_mfma_f32_16x16x32_bf16 a[84:87], v[72:75], v[56:59], a[84:87]
s_mov_b64 vcc, s[94:95]
v_cndmask_b32_dpp v18, v182, v180, vcc quad_perm:[1,0,3,2] row_mask:0xf bank_mask:0xf
v_cndmask_b32_dpp v19, v183, v181, vcc quad_perm:[1,0,3,2] row_mask:0xf bank_mask:0xf
v_mfma_f32_16x16x32_bf16 a[84:87], v[76:79], v[60:63], a[84:87]
s_not_b64 vcc, s[94:95]
v_cndmask_b32_dpp v182, v180, v182, vcc quad_perm:[1,0,3,2] row_mask:0xf bank_mask:0xf
v_cndmask_b32_dpp v183, v181, v183, vcc quad_perm:[1,0,3,2] row_mask:0xf bank_mask:0xf
v_mfma_f32_16x16x32_bf16 a[88:91], v[80:83], v[56:59], a[88:91]
v_perm_b32 v101, v182, v18, s100
v_perm_b32 v109, v182, v18, s101
v_mfma_f32_16x16x32_bf16 a[88:91], v[84:87], v[60:63], a[88:91]
v_perm_b32 v117, v183, v19, s100
v_perm_b32 v125, v183, v19, s101
v_mfma_f32_16x16x32_bf16 a[92:95], v[88:91], v[56:59], a[92:95]
s_add_u32 s40, s39, 0xd1000
buffer_load_dwordx4 v[180:183], v0, s[96:99], s40 offen
v_mfma_f32_16x16x32_bf16 a[92:95], v[92:95], v[60:63], a[92:95]
s_waitcnt lgkmcnt(2)
v_mfma_f32_16x16x32_bf16 a[96:99], v[64:67], v[40:43], a[96:99]
ds_read_b128 v[56:59], v2 offset:49152
v_mfma_f32_16x16x32_bf16 a[96:99], v[68:71], v[44:47], a[96:99]
ds_read_b128 v[60:63], v3 offset:49152
v_mfma_f32_16x16x32_bf16 a[100:103], v[72:75], v[40:43], a[100:103]
s_mov_b64 vcc, s[94:95]
v_cndmask_b32_dpp v18, v186, v184, vcc quad_perm:[1,0,3,2] row_mask:0xf bank_mask:0xf
v_cndmask_b32_dpp v19, v187, v185, vcc quad_perm:[1,0,3,2] row_mask:0xf bank_mask:0xf
v_mfma_f32_16x16x32_bf16 a[100:103], v[76:79], v[44:47], a[100:103]
s_not_b64 vcc, s[94:95]
v_cndmask_b32_dpp v186, v184, v186, vcc quad_perm:[1,0,3,2] row_mask:0xf bank_mask:0xf
v_cndmask_b32_dpp v187, v185, v187, vcc quad_perm:[1,0,3,2] row_mask:0xf bank_mask:0xf
v_mfma_f32_16x16x32_bf16 a[104:107], v[80:83], v[40:43], a[104:107]
v_perm_b32 v102, v186, v18, s100
v_perm_b32 v110, v186, v18, s101
v_mfma_f32_16x16x32_bf16 a[104:107], v[84:87], v[44:47], a[104:107]
v_perm_b32 v118, v187, v19, s100
v_perm_b32 v126, v187, v19, s101
v_mfma_f32_16x16x32_bf16 a[108:111], v[88:91], v[40:43], a[108:111]
s_mov_b64 vcc, s[94:95]
v_cndmask_b32_dpp v18, v190, v188, vcc quad_perm:[1,0,3,2] row_mask:0xf bank_mask:0xf
v_cndmask_b32_dpp v19, v191, v189, vcc quad_perm:[1,0,3,2] row_mask:0xf bank_mask:0xf
v_mfma_f32_16x16x32_bf16 a[108:111], v[92:95], v[44:47], a[108:111]
s_not_b64 vcc, s[94:95]
v_cndmask_b32_dpp v190, v188, v190, vcc quad_perm:[1,0,3,2] row_mask:0xf bank_mask:0xf
v_cndmask_b32_dpp v191, v189, v191, vcc quad_perm:[1,0,3,2] row_mask:0xf bank_mask:0xf
s_waitcnt lgkmcnt(2)
v_mfma_f32_16x16x32_bf16 a[112:115], v[64:67], v[48:51], a[112:115]
ds_read_b128 v[40:43], v2 offset:51200
v_perm_b32 v103, v190, v18, s100
v_perm_b32 v111, v190, v18, s101
v_mfma_f32_16x16x32_bf16 a[112:115], v[68:71], v[52:55], a[112:115]
ds_read_b128 v[44:47], v3 offset:51200
v_perm_b32 v119, v191, v19, s100
v_perm_b32 v127, v191, v19, s101
v_mfma_f32_16x16x32_bf16 a[116:119], v[72:75], v[48:51], a[116:119]
s_add_u32 s40, s39, 0xd2000
buffer_load_dwordx4 v[184:187], v0, s[96:99], s40 offen
v_mfma_f32_16x16x32_bf16 a[116:119], v[76:79], v[52:55], a[116:119]
v_mfma_f32_16x16x32_bf16 a[120:123], v[80:83], v[48:51], a[120:123]
s_add_u32 s40, s39, 0xd3000
buffer_load_dwordx4 v[188:191], v0, s[96:99], s40 offen
v_mfma_f32_16x16x32_bf16 a[120:123], v[84:87], v[52:55], a[120:123]
v_mfma_f32_16x16x32_bf16 a[124:127], v[88:91], v[48:51], a[124:127]
v_mfma_f32_16x16x32_bf16 a[124:127], v[92:95], v[52:55], a[124:127]
s_waitcnt lgkmcnt(2)
v_mfma_f32_16x16x32_bf16 a[128:131], v[96:99], v[56:59], a[128:131]
ds_read_b128 v[48:51], v2 offset:53248
v_mfma_f32_16x16x32_bf16 a[128:131], v[100:103], v[60:63], a[128:131]
ds_read_b128 v[52:55], v3 offset:53248
v_mfma_f32_16x16x32_bf16 a[132:135], v[104:107], v[56:59], a[132:135]
s_mov_b64 vcc, s[94:95]
v_cndmask_b32_dpp v18, v194, v192, vcc quad_perm:[1,0,3,2] row_mask:0xf bank_mask:0xf
v_cndmask_b32_dpp v19, v195, v193, vcc quad_perm:[1,0,3,2] row_mask:0xf bank_mask:0xf
v_mfma_f32_16x16x32_bf16 a[132:135], v[108:111], v[60:63], a[132:135]
s_not_b64 vcc, s[94:95]
v_cndmask_b32_dpp v194, v192, v194, vcc quad_perm:[1,0,3,2] row_mask:0xf bank_mask:0xf
v_cndmask_b32_dpp v195, v193, v195, vcc quad_perm:[1,0,3,2] row_mask:0xf bank_mask:0xf
v_mfma_f32_16x16x32_bf16 a[136:139], v[112:115], v[56:59], a[136:139]
v_perm_b32 v64, v194, v18, s100
v_perm_b32 v72, v194, v18, s101
v_mfma_f32_16x16x32_bf16 a[136:139], v[116:119], v[60:63], a[136:139]
v_perm_b32 v80, v195, v19, s100
v_perm_b32 v88, v195, v19, s101
v_mfma_f32_16x16x32_bf16 a[140:143], v[120:123], v[56:59], a[140:143]
s_add_u32 s40, s39, 0xe0000
buffer_load_dwordx4 v[192:195], v0, s[96:99], s40 offen
v_mfma_f32_16x16x32_bf16 a[140:143], v[124:127], v[60:63], a[140:143]
s_waitcnt lgkmcnt(2)
v_mfma_f32_16x16x32_bf16 a[144:147], v[96:99], v[40:43], a[144:147]
ds_read_b128 v[56:59], v2 offset:55296
v_mfma_f32_16x16x32_bf16 a[144:147], v[100:103], v[44:47], a[144:147]
ds_read_b128 v[60:63], v3 offset:55296
v_mfma_f32_16x16x32_bf16 a[148:151], v[104:107], v[40:43], a[148:151]
s_mov_b64 vcc, s[94:95]
v_cndmask_b32_dpp v18, v198, v196, vcc quad_perm:[1,0,3,2] row_mask:0xf bank_mask:0xf
v_cndmask_b32_dpp v19, v199, v197, vcc quad_perm:[1,0,3,2] row_mask:0xf bank_mask:0xf
v_mfma_f32_16x16x32_bf16 a[148:151], v[108:111], v[44:47], a[148:151]
s_not_b64 vcc, s[94:95]
v_cndmask_b32_dpp v198, v196, v198, vcc quad_perm:[1,0,3,2] row_mask:0xf bank_mask:0xf
v_cndmask_b32_dpp v199, v197, v199, vcc quad_perm:[1,0,3,2] row_mask:0xf bank_mask:0xf
v_mfma_f32_16x16x32_bf16 a[152:155], v[112:115], v[40:43], a[152:155]
v_perm_b32 v65, v198, v18, s100
v_perm_b32 v73, v198, v18, s101
v_mfma_f32_16x16x32_bf16 a[152:155], v[116:119], v[44:47], a[152:155]
v_perm_b32 v81, v199, v19, s100
v_perm_b32 v89, v199, v19, s101
v_mfma_f32_16x16x32_bf16 a[156:159], v[120:123], v[40:43], a[156:159]
s_add_u32 s40, s39, 0xe1000
buffer_load_dwordx4 v[196:199], v0, s[96:99], s40 offen
v_mfma_f32_16x16x32_bf16 a[156:159], v[124:127], v[44:47], a[156:159]
s_waitcnt lgkmcnt(2)
v_mfma_f32_16x16x32_bf16 a[160:163], v[96:99], v[48:51], a[160:163]
ds_read_b128 v[40:43], v2 offset:57344
v_mfma_f32_16x16x32_bf16 a[160:163], v[100:103], v[52:55], a[160:163]
ds_read_b128 v[44:47], v3 offset:57344
v_mfma_f32_16x16x32_bf16 a[164:167], v[104:107], v[48:51], a[164:167]
s_mov_b64 vcc, s[94:95]
v_cndmask_b32_dpp v18, v202, v200, vcc quad_perm:[1,0,3,2] row_mask:0xf bank_mask:0xf
v_cndmask_b32_dpp v19, v203, v201, vcc quad_perm:[1,0,3,2] row_mask:0xf bank_mask:0xf
v_mfma_f32_16x16x32_bf16 a[164:167], v[108:111], v[52:55], a[164:167]
s_not_b64 vcc, s[94:95]
v_cndmask_b32_dpp v202, v200, v202, vcc quad_perm:[1,0,3,2] row_mask:0xf bank_mask:0xf
v_cndmask_b32_dpp v203, v201, v203, vcc quad_perm:[1,0,3,2] row_mask:0xf bank_mask:0xf
v_mfma_f32_16x16x32_bf16 a[168:171], v[112:115], v[48:51], a[168:171]
v_perm_b32 v66, v202, v18, s100
v_perm_b32 v74, v202, v18, s101
v_mfma_f32_16x16x32_bf16 a[168:171], v[116:119], v[52:55], a[168:171]
v_perm_b32 v82, v203, v19, s100
v_perm_b32 v90, v203, v19, s101
v_mfma_f32_16x16x32_bf16 a[172:175], v[120:123], v[48:51], a[172:175]
s_add_u32 s40, s39, 0xe2000
buffer_load_dwordx4 v[200:203], v0, s[96:99], s40 offen
v_mfma_f32_16x16x32_bf16 a[172:175], v[124:127], v[52:55], a[172:175]
s_waitcnt lgkmcnt(2)
v_mfma_f32_16x16x32_bf16 a[176:179], v[96:99], v[56:59], a[176:179]
ds_read_b128 v[48:51], v2 offset:59392
v_mfma_f32_16x16x32_bf16 a[176:179], v[100:103], v[60:63], a[176:179]
ds_read_b128 v[52:55], v3 offset:59392
v_mfma_f32_16x16x32_bf16 a[180:183], v[104:107], v[56:59], a[180:183]
s_mov_b64 vcc, s[94:95]
v_cndmask_b32_dpp v18, v206, v204, vcc quad_perm:[1,0,3,2] row_mask:0xf bank_mask:0xf
v_cndmask_b32_dpp v19, v207, v205, vcc quad_perm:[1,0,3,2] row_mask:0xf bank_mask:0xf
v_mfma_f32_16x16x32_bf16 a[180:183], v[108:111], v[60:63], a[180:183]
s_not_b64 vcc, s[94:95]
v_cndmask_b32_dpp v206, v204, v206, vcc quad_perm:[1,0,3,2] row_mask:0xf bank_mask:0xf
v_cndmask_b32_dpp v207, v205, v207, vcc quad_perm:[1,0,3,2] row_mask:0xf bank_mask:0xf
v_mfma_f32_16x16x32_bf16 a[184:187], v[112:115], v[56:59], a[184:187]
v_perm_b32 v67, v206, v18, s100
v_perm_b32 v75, v206, v18, s101
v_mfma_f32_16x16x32_bf16 a[184:187], v[116:119], v[60:63], a[184:187]
v_perm_b32 v83, v207, v19, s100
v_perm_b32 v91, v207, v19, s101
v_mfma_f32_16x16x32_bf16 a[188:191], v[120:123], v[56:59], a[188:191]
s_add_u32 s40, s39, 0xe3000
buffer_load_dwordx4 v[204:207], v0, s[96:99], s40 offen
v_mfma_f32_16x16x32_bf16 a[188:191], v[124:127], v[60:63], a[188:191]
s_waitcnt lgkmcnt(2)
v_mfma_f32_16x16x32_bf16 a[192:195], v[96:99], v[40:43], a[192:195]
ds_read_b128 v[56:59], v2 offset:61440
v_mfma_f32_16x16x32_bf16 a[192:195], v[100:103], v[44:47], a[192:195]
ds_read_b128 v[60:63], v3 offset:61440
v_mfma_f32_16x16x32_bf16 a[196:199], v[104:107], v[40:43], a[196:199]
s_mov_b64 vcc, s[94:95]
v_cndmask_b32_dpp v18, v210, v208, vcc quad_perm:[1,0,3,2] row_mask:0xf bank_mask:0xf
v_cndmask_b32_dpp v19, v211, v209, vcc quad_perm:[1,0,3,2] row_mask:0xf bank_mask:0xf
v_mfma_f32_16x16x32_bf16 a[196:199], v[108:111], v[44:47], a[196:199]
s_not_b64 vcc, s[94:95]
v_cndmask_b32_dpp v210, v208, v210, vcc quad_perm:[1,0,3,2] row_mask:0xf bank_mask:0xf
v_cndmask_b32_dpp v211, v209, v211, vcc quad_perm:[1,0,3,2] row_mask:0xf bank_mask:0xf
v_mfma_f32_16x16x32_bf16 a[200:203], v[112:115], v[40:43], a[200:203]
v_perm_b32 v68, v210, v18, s100
v_perm_b32 v76, v210, v18, s101
v_mfma_f32_16x16x32_bf16 a[200:203], v[116:119], v[44:47], a[200:203]
v_perm_b32 v84, v211, v19, s100
v_perm_b32 v92, v211, v19, s101
v_mfma_f32_16x16x32_bf16 a[204:207], v[120:123], v[40:43], a[204:207]
s_add_u32 s40, s39, 0xf0000
buffer_load_dwordx4 v[208:211], v0, s[96:99], s40 offen
v_mfma_f32_16x16x32_bf16 a[204:207], v[124:127], v[44:47], a[204:207]
s_waitcnt lgkmcnt(2)
v_mfma_f32_16x16x32_bf16 a[208:211], v[96:99], v[48:51], a[208:211]
ds_read_b128 v[40:43], v2 offset:63488
v_mfma_f32_16x16x32_bf16 a[208:211], v[100:103], v[52:55], a[208:211]
ds_read_b128 v[44:47], v3 offset:63488
v_mfma_f32_16x16x32_bf16 a[212:215], v[104:107], v[48:51], a[212:215]
s_mov_b64 vcc, s[94:95]
v_cndmask_b32_dpp v18, v214, v212, vcc quad_perm:[1,0,3,2] row_mask:0xf bank_mask:0xf
v_cndmask_b32_dpp v19, v215, v213, vcc quad_perm:[1,0,3,2] row_mask:0xf bank_mask:0xf
v_mfma_f32_16x16x32_bf16 a[212:215], v[108:111], v[52:55], a[212:215]
s_not_b64 vcc, s[94:95]
v_cndmask_b32_dpp v214, v212, v214, vcc quad_perm:[1,0,3,2] row_mask:0xf bank_mask:0xf
v_cndmask_b32_dpp v215, v213, v215, vcc quad_perm:[1,0,3,2] row_mask:0xf bank_mask:0xf
v_mfma_f32_16x16x32_bf16 a[216:219], v[112:115], v[48:51], a[216:219]
v_perm_b32 v69, v214, v18, s100
v_perm_b32 v77, v214, v18, s101
v_mfma_f32_16x16x32_bf16 a[216:219], v[116:119], v[52:55], a[216:219]
v_perm_b32 v85, v215, v19, s100
v_perm_b32 v93, v215, v19, s101
v_mfma_f32_16x16x32_bf16 a[220:223], v[120:123], v[48:51], a[220:223]
s_add_u32 s40, s39, 0xf1000
buffer_load_dwordx4 v[212:215], v0, s[96:99], s40 offen
v_mfma_f32_16x16x32_bf16 a[220:223], v[124:127], v[52:55], a[220:223]
s_waitcnt lgkmcnt(2)
v_mfma_f32_16x16x32_bf16 a[224:227], v[96:99], v[56:59], a[224:227]
v_mfma_f32_16x16x32_bf16 a[224:227], v[100:103], v[60:63], a[224:227]
v_mfma_f32_16x16x32_bf16 a[228:231], v[104:107], v[56:59], a[228:231]
s_mov_b64 vcc, s[94:95]
v_cndmask_b32_dpp v18, v218, v216, vcc quad_perm:[1,0,3,2] row_mask:0xf bank_mask:0xf
v_cndmask_b32_dpp v19, v219, v217, vcc quad_perm:[1,0,3,2] row_mask:0xf bank_mask:0xf
v_mfma_f32_16x16x32_bf16 a[228:231], v[108:111], v[60:63], a[228:231]
s_not_b64 vcc, s[94:95]
v_cndmask_b32_dpp v218, v216, v218, vcc quad_perm:[1,0,3,2] row_mask:0xf bank_mask:0xf
v_cndmask_b32_dpp v219, v217, v219, vcc quad_perm:[1,0,3,2] row_mask:0xf bank_mask:0xf
v_mfma_f32_16x16x32_bf16 a[232:235], v[112:115], v[56:59], a[232:235]
v_perm_b32 v70, v218, v18, s100
v_perm_b32 v78, v218, v18, s101
v_mfma_f32_16x16x32_bf16 a[232:235], v[116:119], v[60:63], a[232:235]
v_perm_b32 v86, v219, v19, s100
v_perm_b32 v94, v219, v19, s101
v_mfma_f32_16x16x32_bf16 a[236:239], v[120:123], v[56:59], a[236:239]
s_mov_b64 vcc, s[94:95]
v_cndmask_b32_dpp v18, v222, v220, vcc quad_perm:[1,0,3,2] row_mask:0xf bank_mask:0xf
v_cndmask_b32_dpp v19, v223, v221, vcc quad_perm:[1,0,3,2] row_mask:0xf bank_mask:0xf
v_mfma_f32_16x16x32_bf16 a[236:239], v[124:127], v[60:63], a[236:239]
s_not_b64 vcc, s[94:95]
v_cndmask_b32_dpp v222, v220, v222, vcc quad_perm:[1,0,3,2] row_mask:0xf bank_mask:0xf
v_cndmask_b32_dpp v223, v221, v223, vcc quad_perm:[1,0,3,2] row_mask:0xf bank_mask:0xf
s_waitcnt lgkmcnt(0)
s_waitcnt vmcnt(13)
s_barrier
v_xor_b32 v2, 0x10000, v2
v_xor_b32 v3, 0x10000, v3
v_mfma_f32_16x16x32_bf16 a[240:243], v[96:99], v[40:43], a[240:243]
ds_read_b128 v[48:51], v2 offset:0
v_perm_b32 v71, v222, v18, s100
v_perm_b32 v79, v222, v18, s101
v_mfma_f32_16x16x32_bf16 a[240:243], v[100:103], v[44:47], a[240:243]
ds_read_b128 v[52:55], v3 offset:0
v_perm_b32 v87, v223, v19, s100
v_perm_b32 v95, v223, v19, s101
v_mfma_f32_16x16x32_bf16 a[244:247], v[104:107], v[40:43], a[244:247]
ds_read_b128 v[56:59], v2 offset:2048
s_add_u32 s40, s39, 0xf2000
buffer_load_dwordx4 v[216:219], v0, s[96:99], s40 offen
v_mfma_f32_16x16x32_bf16 a[244:247], v[108:111], v[44:47], a[244:247]
ds_read_b128 v[60:63], v3 offset:2048
v_mfma_f32_16x16x32_bf16 a[248:251], v[112:115], v[40:43], a[248:251]
s_add_u32 s40, s39, 0xf3000
buffer_load_dwordx4 v[220:223], v0, s[96:99], s40 offen
v_mfma_f32_16x16x32_bf16 a[248:251], v[116:119], v[44:47], a[248:251]
v_mfma_f32_16x16x32_bf16 a[252:255], v[120:123], v[40:43], a[252:255]
v_mfma_f32_16x16x32_bf16 a[252:255], v[124:127], v[44:47], a[252:255]
s_waitcnt lgkmcnt(2)
v_mfma_f32_16x16x32_bf16 a[0:3], v[64:67], v[48:51], a[0:3]
ds_read_b128 v[40:43], v2 offset:4096
v_mfma_f32_16x16x32_bf16 a[0:3], v[68:71], v[52:55], a[0:3]
ds_read_b128 v[44:47], v3 offset:4096
v_mfma_f32_16x16x32_bf16 a[4:7], v[72:75], v[48:51], a[4:7]
s_mov_b64 vcc, s[94:95]
v_cndmask_b32_dpp v18, v130, v128, vcc quad_perm:[1,0,3,2] row_mask:0xf bank_mask:0xf
v_cndmask_b32_dpp v19, v131, v129, vcc quad_perm:[1,0,3,2] row_mask:0xf bank_mask:0xf
v_mfma_f32_16x16x32_bf16 a[4:7], v[76:79], v[52:55], a[4:7]
s_not_b64 vcc, s[94:95]
v_cndmask_b32_dpp v130, v128, v130, vcc quad_perm:[1,0,3,2] row_mask:0xf bank_mask:0xf
v_cndmask_b32_dpp v131, v129, v131, vcc quad_perm:[1,0,3,2] row_mask:0xf bank_mask:0xf
v_mfma_f32_16x16x32_bf16 a[8:11], v[80:83], v[48:51], a[8:11]
v_perm_b32 v96, v130, v18, s100
v_perm_b32 v104, v130, v18, s101
s_add_u32 s35, s37, 0x0
s_add_u32 m0, s3, 0x0
v_mfma_f32_16x16x32_bf16 a[8:11], v[84:87], v[52:55], a[8:11]
v_perm_b32 v112, v131, v19, s100
v_perm_b32 v120, v131, v19, s101
buffer_load_dwordx4 v8, s[8:11], s35 offen nt lds
s_add_u32 s35, s35, 0x10000
v_mfma_f32_16x16x32_bf16 a[12:15], v[88:91], v[48:51], a[12:15]
s_add_u32 s40, s39, 0x80200
buffer_load_dwordx4 v[128:131], v0, s[96:99], s40 offen
s_add_u32 m0, s3, 0x1000
v_mfma_f32_16x16x32_bf16 a[12:15], v[92:95], v[52:55], a[12:15]
buffer_load_dwordx4 v8, s[8:11], s35 offen nt lds
s_add_u32 s35, s35, 0x10000
s_waitcnt lgkmcnt(2)
v_mfma_f32_16x16x32_bf16 a[16:19], v[64:67], v[56:59], a[16:19]
ds_read_b128 v[48:51], v2 offset:6144
s_add_u32 m0, s3, 0x2000
v_mfma_f32_16x16x32_bf16 a[16:19], v[68:71], v[60:63], a[16:19]
ds_read_b128 v[52:55], v3 offset:6144
buffer_load_dwordx4 v8, s[8:11], s35 offen nt lds
s_add_u32 s35, s35, 0x10000
v_mfma_f32_16x16x32_bf16 a[20:23], v[72:75], v[56:59], a[20:23]
s_mov_b64 vcc, s[94:95]
v_cndmask_b32_dpp v18, v134, v132, vcc quad_perm:[1,0,3,2] row_mask:0xf bank_mask:0xf
v_cndmask_b32_dpp v19, v135, v133, vcc quad_perm:[1,0,3,2] row_mask:0xf bank_mask:0xf
s_add_u32 m0, s3, 0x3000
v_mfma_f32_16x16x32_bf16 a[20:23], v[76:79], v[60:63], a[20:23]
s_not_b64 vcc, s[94:95]
v_cndmask_b32_dpp v134, v132, v134, vcc quad_perm:[1,0,3,2] row_mask:0xf bank_mask:0xf
v_cndmask_b32_dpp v135, v133, v135, vcc quad_perm:[1,0,3,2] row_mask:0xf bank_mask:0xf
buffer_load_dwordx4 v8, s[8:11], s35 offen nt lds
s_sub_u32 s35, s35, 196480
v_mfma_f32_16x16x32_bf16 a[24:27], v[80:83], v[56:59], a[24:27]
v_perm_b32 v97, v134, v18, s100
v_perm_b32 v105, v134, v18, s101
v_mfma_f32_16x16x32_bf16 a[24:27], v[84:87], v[60:63], a[24:27]
v_perm_b32 v113, v135, v19, s100
v_perm_b32 v121, v135, v19, s101
v_mfma_f32_16x16x32_bf16 a[28:31], v[88:91], v[56:59], a[28:31]
s_add_u32 s40, s39, 0x81200
buffer_load_dwordx4 v[132:135], v0, s[96:99], s40 offen
v_mfma_f32_16x16x32_bf16 a[28:31], v[92:95], v[60:63], a[28:31]
s_waitcnt lgkmcnt(2)
v_mfma_f32_16x16x32_bf16 a[32:35], v[64:67], v[40:43], a[32:35]
ds_read_b128 v[56:59], v2 offset:8192
v_mfma_f32_16x16x32_bf16 a[32:35], v[68:71], v[44:47], a[32:35]
ds_read_b128 v[60:63], v3 offset:8192
v_mfma_f32_16x16x32_bf16 a[36:39], v[72:75], v[40:43], a[36:39]
s_mov_b64 vcc, s[94:95]
v_cndmask_b32_dpp v18, v138, v136, vcc quad_perm:[1,0,3,2] row_mask:0xf bank_mask:0xf
v_cndmask_b32_dpp v19, v139, v137, vcc quad_perm:[1,0,3,2] row_mask:0xf bank_mask:0xf
v_mfma_f32_16x16x32_bf16 a[36:39], v[76:79], v[44:47], a[36:39]
s_not_b64 vcc, s[94:95]
v_cndmask_b32_dpp v138, v136, v138, vcc quad_perm:[1,0,3,2] row_mask:0xf bank_mask:0xf
v_cndmask_b32_dpp v139, v137, v139, vcc quad_perm:[1,0,3,2] row_mask:0xf bank_mask:0xf
v_mfma_f32_16x16x32_bf16 a[40:43], v[80:83], v[40:43], a[40:43]
v_perm_b32 v98, v138, v18, s100
v_perm_b32 v106, v138, v18, s101
v_mfma_f32_16x16x32_bf16 a[40:43], v[84:87], v[44:47], a[40:43]
v_perm_b32 v114, v139, v19, s100
v_perm_b32 v122, v139, v19, s101
v_mfma_f32_16x16x32_bf16 a[44:47], v[88:91], v[40:43], a[44:47]
s_add_u32 s40, s39, 0x82200
buffer_load_dwordx4 v[136:139], v0, s[96:99], s40 offen
v_mfma_f32_16x16x32_bf16 a[44:47], v[92:95], v[44:47], a[44:47]
s_waitcnt lgkmcnt(2)
v_mfma_f32_16x16x32_bf16 a[48:51], v[64:67], v[48:51], a[48:51]
ds_read_b128 v[40:43], v2 offset:10240
v_mfma_f32_16x16x32_bf16 a[48:51], v[68:71], v[52:55], a[48:51]
ds_read_b128 v[44:47], v3 offset:10240
v_mfma_f32_16x16x32_bf16 a[52:55], v[72:75], v[48:51], a[52:55]
s_mov_b64 vcc, s[94:95]
v_cndmask_b32_dpp v18, v142, v140, vcc quad_perm:[1,0,3,2] row_mask:0xf bank_mask:0xf
v_cndmask_b32_dpp v19, v143, v141, vcc quad_perm:[1,0,3,2] row_mask:0xf bank_mask:0xf
v_mfma_f32_16x16x32_bf16 a[52:55], v[76:79], v[52:55], a[52:55]
s_not_b64 vcc, s[94:95]
v_cndmask_b32_dpp v142, v140, v142, vcc quad_perm:[1,0,3,2] row_mask:0xf bank_mask:0xf
v_cndmask_b32_dpp v143, v141, v143, vcc quad_perm:[1,0,3,2] row_mask:0xf bank_mask:0xf
v_mfma_f32_16x16x32_bf16 a[56:59], v[80:83], v[48:51], a[56:59]
v_perm_b32 v99, v142, v18, s100
v_perm_b32 v107, v142, v18, s101
v_mfma_f32_16x16x32_bf16 a[56:59], v[84:87], v[52:55], a[56:59]
v_perm_b32 v115, v143, v19, s100
v_perm_b32 v123, v143, v19, s101
v_mfma_f32_16x16x32_bf16 a[60:63], v[88:91], v[48:51], a[60:63]
s_add_u32 s40, s39, 0x83200
buffer_load_dwordx4 v[140:143], v0, s[96:99], s40 offen
v_mfma_f32_16x16x32_bf16 a[60:63], v[92:95], v[52:55], a[60:63]
s_waitcnt lgkmcnt(2)
v_mfma_f32_16x16x32_bf16 a[64:67], v[64:67], v[56:59], a[64:67]
ds_read_b128 v[48:51], v2 offset:12288
v_mfma_f32_16x16x32_bf16 a[64:67], v[68:71], v[60:63], a[64:67]
ds_read_b128 v[52:55], v3 offset:12288
v_mfma_f32_16x16x32_bf16 a[68:71], v[72:75], v[56:59], a[68:71]
s_mov_b64 vcc, s[94:95]
v_cndmask_b32_dpp v18, v146, v144, vcc quad_perm:[1,0,3,2] row_mask:0xf bank_mask:0xf
v_cndmask_b32_dpp v19, v147, v145, vcc quad_perm:[1,0,3,2] row_mask:0xf bank_mask:0xf
v_mfma_f32_16x16x32_bf16 a[68:71], v[76:79], v[60:63], a[68:71]
s_not_b64 vcc, s[94:95]
v_cndmask_b32_dpp v146, v144, v146, vcc quad_perm:[1,0,3,2] row_mask:0xf bank_mask:0xf
v_cndmask_b32_dpp v147, v145, v147, vcc quad_perm:[1,0,3,2] row_mask:0xf bank_mask:0xf
v_mfma_f32_16x16x32_bf16 a[72:75], v[80:83], v[56:59], a[72:75]
v_perm_b32 v100, v146, v18, s100
v_perm_b32 v108, v146, v18, s101
v_mfma_f32_16x16x32_bf16 a[72:75], v[84:87], v[60:63], a[72:75]
v_perm_b32 v116, v147, v19, s100
v_perm_b32 v124, v147, v19, s101
v_mfma_f32_16x16x32_bf16 a[76:79], v[88:91], v[56:59], a[76:79]
s_add_u32 s40, s39, 0x90200
buffer_load_dwordx4 v[144:147], v0, s[96:99], s40 offen
v_mfma_f32_16x16x32_bf16 a[76:79], v[92:95], v[60:63], a[76:79]
s_waitcnt lgkmcnt(2)
v_mfma_f32_16x16x32_bf16 a[80:83], v[64:67], v[40:43], a[80:83]
ds_read_b128 v[56:59], v2 offset:14336
v_mfma_f32_16x16x32_bf16 a[80:83], v[68:71], v[44:47], a[80:83]
ds_read_b128 v[60:63], v3 offset:14336
v_mfma_f32_16x16x32_bf16 a[84:87], v[72:75], v[40:43], a[84:87]
s_mov_b64 vcc, s[94:95]
v_cndmask_b32_dpp v18, v150, v148, vcc quad_perm:[1,0,3,2] row_mask:0xf bank_mask:0xf
v_cndmask_b32_dpp v19, v151, v149, vcc quad_perm:[1,0,3,2] row_mask:0xf bank_mask:0xf
v_mfma_f32_16x16x32_bf16 a[84:87], v[76:79], v[44:47], a[84:87]
s_not_b64 vcc, s[94:95]
v_cndmask_b32_dpp v150, v148, v150, vcc quad_perm:[1,0,3,2] row_mask:0xf bank_mask:0xf
v_cndmask_b32_dpp v151, v149, v151, vcc quad_perm:[1,0,3,2] row_mask:0xf bank_mask:0xf
v_mfma_f32_16x16x32_bf16 a[88:91], v[80:83], v[40:43], a[88:91]
v_perm_b32 v101, v150, v18, s100
v_perm_b32 v109, v150, v18, s101
v_mfma_f32_16x16x32_bf16 a[88:91], v[84:87], v[44:47], a[88:91]
v_perm_b32 v117, v151, v19, s100
v_perm_b32 v125, v151, v19, s101
v_mfma_f32_16x16x32_bf16 a[92:95], v[88:91], v[40:43], a[92:95]
s_add_u32 s40, s39, 0x91200
buffer_load_dwordx4 v[148:151], v0, s[96:99], s40 offen
v_mfma_f32_16x16x32_bf16 a[92:95], v[92:95], v[44:47], a[92:95]
s_waitcnt lgkmcnt(2)
v_mfma_f32_16x16x32_bf16 a[96:99], v[64:67], v[48:51], a[96:99]
ds_read_b128 v[40:43], v2 offset:16384
v_mfma_f32_16x16x32_bf16 a[96:99], v[68:71], v[52:55], a[96:99]
ds_read_b128 v[44:47], v3 offset:16384
v_mfma_f32_16x16x32_bf16 a[100:103], v[72:75], v[48:51], a[100:103]
s_mov_b64 vcc, s[94:95]
v_cndmask_b32_dpp v18, v154, v152, vcc quad_perm:[1,0,3,2] row_mask:0xf bank_mask:0xf
v_cndmask_b32_dpp v19, v155, v153, vcc quad_perm:[1,0,3,2] row_mask:0xf bank_mask:0xf
v_mfma_f32_16x16x32_bf16 a[100:103], v[76:79], v[52:55], a[100:103]
s_not_b64 vcc, s[94:95]
v_cndmask_b32_dpp v154, v152, v154, vcc quad_perm:[1,0,3,2] row_mask:0xf bank_mask:0xf
v_cndmask_b32_dpp v155, v153, v155, vcc quad_perm:[1,0,3,2] row_mask:0xf bank_mask:0xf
v_mfma_f32_16x16x32_bf16 a[104:107], v[80:83], v[48:51], a[104:107]
v_perm_b32 v102, v154, v18, s100
v_perm_b32 v110, v154, v18, s101
v_mfma_f32_16x16x32_bf16 a[104:107], v[84:87], v[52:55], a[104:107]
v_perm_b32 v118, v155, v19, s100
v_perm_b32 v126, v155, v19, s101
v_mfma_f32_16x16x32_bf16 a[108:111], v[88:91], v[48:51], a[108:111]
s_mov_b64 vcc, s[94:95]
v_cndmask_b32_dpp v18, v158, v156, vcc quad_perm:[1,0,3,2] row_mask:0xf bank_mask:0xf
v_cndmask_b32_dpp v19, v159, v157, vcc quad_perm:[1,0,3,2] row_mask:0xf bank_mask:0xf
v_mfma_f32_16x16x32_bf16 a[108:111], v[92:95], v[52:55], a[108:111]
s_not_b64 vcc, s[94:95]
v_cndmask_b32_dpp v158, v156, v158, vcc quad_perm:[1,0,3,2] row_mask:0xf bank_mask:0xf
v_cndmask_b32_dpp v159, v157, v159, vcc quad_perm:[1,0,3,2] row_mask:0xf bank_mask:0xf
s_waitcnt lgkmcnt(2)
v_mfma_f32_16x16x32_bf16 a[112:115], v[64:67], v[56:59], a[112:115]
ds_read_b128 v[48:51], v2 offset:18432
v_perm_b32 v103, v158, v18, s100
v_perm_b32 v111, v158, v18, s101
v_mfma_f32_16x16x32_bf16 a[112:115], v[68:71], v[60:63], a[112:115]
ds_read_b128 v[52:55], v3 offset:18432
v_perm_b32 v119, v159, v19, s100
v_perm_b32 v127, v159, v19, s101
v_mfma_f32_16x16x32_bf16 a[116:119], v[72:75], v[56:59], a[116:119]
s_add_u32 s40, s39, 0x92200
buffer_load_dwordx4 v[152:155], v0, s[96:99], s40 offen
v_mfma_f32_16x16x32_bf16 a[116:119], v[76:79], v[60:63], a[116:119]
v_mfma_f32_16x16x32_bf16 a[120:123], v[80:83], v[56:59], a[120:123]
s_add_u32 s40, s39, 0x93200
buffer_load_dwordx4 v[156:159], v0, s[96:99], s40 offen
v_mfma_f32_16x16x32_bf16 a[120:123], v[84:87], v[60:63], a[120:123]
v_mfma_f32_16x16x32_bf16 a[124:127], v[88:91], v[56:59], a[124:127]
v_mfma_f32_16x16x32_bf16 a[124:127], v[92:95], v[60:63], a[124:127]
s_waitcnt lgkmcnt(2)
v_mfma_f32_16x16x32_bf16 a[0:3], v[96:99], v[40:43], a[0:3]
ds_read_b128 v[56:59], v2 offset:20480
v_mfma_f32_16x16x32_bf16 a[0:3], v[100:103], v[44:47], a[0:3]
ds_read_b128 v[60:63], v3 offset:20480
v_mfma_f32_16x16x32_bf16 a[4:7], v[104:107], v[40:43], a[4:7]
s_mov_b64 vcc, s[94:95]
v_cndmask_b32_dpp v18, v162, v160, vcc quad_perm:[1,0,3,2] row_mask:0xf bank_mask:0xf
v_cndmask_b32_dpp v19, v163, v161, vcc quad_perm:[1,0,3,2] row_mask:0xf bank_mask:0xf
v_mfma_f32_16x16x32_bf16 a[4:7], v[108:111], v[44:47], a[4:7]
s_not_b64 vcc, s[94:95]
v_cndmask_b32_dpp v162, v160, v162, vcc quad_perm:[1,0,3,2] row_mask:0xf bank_mask:0xf
v_cndmask_b32_dpp v163, v161, v163, vcc quad_perm:[1,0,3,2] row_mask:0xf bank_mask:0xf
v_mfma_f32_16x16x32_bf16 a[8:11], v[112:115], v[40:43], a[8:11]
v_perm_b32 v64, v162, v18, s100
v_perm_b32 v72, v162, v18, s101
v_mfma_f32_16x16x32_bf16 a[8:11], v[116:119], v[44:47], a[8:11]
v_perm_b32 v80, v163, v19, s100
v_perm_b32 v88, v163, v19, s101
v_mfma_f32_16x16x32_bf16 a[12:15], v[120:123], v[40:43], a[12:15]
s_add_u32 s40, s39, 0xa0200
buffer_load_dwordx4 v[160:163], v0, s[96:99], s40 offen
v_mfma_f32_16x16x32_bf16 a[12:15], v[124:127], v[44:47], a[12:15]
s_waitcnt lgkmcnt(2)
v_mfma_f32_16x16x32_bf16 a[16:19], v[96:99], v[48:51], a[16:19]
ds_read_b128 v[40:43], v2 offset:22528
v_mfma_f32_16x16x32_bf16 a[16:19], v[100:103], v[52:55], a[16:19]
ds_read_b128 v[44:47], v3 offset:22528
v_mfma_f32_16x16x32_bf16 a[20:23], v[104:107], v[48:51], a[20:23]
s_waitcnt vmcnt(27)
s_mov_b64 vcc, s[94:95]
v_cndmask_b32_dpp v18, v166, v164, vcc quad_perm:[1,0,3,2] row_mask:0xf bank_mask:0xf
v_cndmask_b32_dpp v19, v167, v165, vcc quad_perm:[1,0,3,2] row_mask:0xf bank_mask:0xf
v_mfma_f32_16x16x32_bf16 a[20:23], v[108:111], v[52:55], a[20:23]
s_not_b64 vcc, s[94:95]
v_cndmask_b32_dpp v166, v164, v166, vcc quad_perm:[1,0,3,2] row_mask:0xf bank_mask:0xf
v_cndmask_b32_dpp v167, v165, v167, vcc quad_perm:[1,0,3,2] row_mask:0xf bank_mask:0xf
v_mfma_f32_16x16x32_bf16 a[24:27], v[112:115], v[48:51], a[24:27]
v_perm_b32 v65, v166, v18, s100
v_perm_b32 v73, v166, v18, s101
v_mfma_f32_16x16x32_bf16 a[24:27], v[116:119], v[52:55], a[24:27]
v_perm_b32 v81, v167, v19, s100
v_perm_b32 v89, v167, v19, s101
v_mfma_f32_16x16x32_bf16 a[28:31], v[120:123], v[48:51], a[28:31]
s_add_u32 s40, s39, 0xa1200
buffer_load_dwordx4 v[164:167], v0, s[96:99], s40 offen
v_mfma_f32_16x16x32_bf16 a[28:31], v[124:127], v[52:55], a[28:31]
s_waitcnt lgkmcnt(2)
v_mfma_f32_16x16x32_bf16 a[32:35], v[96:99], v[56:59], a[32:35]
ds_read_b128 v[48:51], v2 offset:24576
v_mfma_f32_16x16x32_bf16 a[32:35], v[100:103], v[60:63], a[32:35]
ds_read_b128 v[52:55], v3 offset:24576
v_mfma_f32_16x16x32_bf16 a[36:39], v[104:107], v[56:59], a[36:39]
s_waitcnt vmcnt(27)
s_mov_b64 vcc, s[94:95]
v_cndmask_b32_dpp v18, v170, v168, vcc quad_perm:[1,0,3,2] row_mask:0xf bank_mask:0xf
v_cndmask_b32_dpp v19, v171, v169, vcc quad_perm:[1,0,3,2] row_mask:0xf bank_mask:0xf
v_mfma_f32_16x16x32_bf16 a[36:39], v[108:111], v[60:63], a[36:39]
s_not_b64 vcc, s[94:95]
v_cndmask_b32_dpp v170, v168, v170, vcc quad_perm:[1,0,3,2] row_mask:0xf bank_mask:0xf
v_cndmask_b32_dpp v171, v169, v171, vcc quad_perm:[1,0,3,2] row_mask:0xf bank_mask:0xf
v_mfma_f32_16x16x32_bf16 a[40:43], v[112:115], v[56:59], a[40:43]
v_perm_b32 v66, v170, v18, s100
v_perm_b32 v74, v170, v18, s101
v_mfma_f32_16x16x32_bf16 a[40:43], v[116:119], v[60:63], a[40:43]
v_perm_b32 v82, v171, v19, s100
v_perm_b32 v90, v171, v19, s101
v_mfma_f32_16x16x32_bf16 a[44:47], v[120:123], v[56:59], a[44:47]
s_add_u32 s40, s39, 0xa2200
buffer_load_dwordx4 v[168:171], v0, s[96:99], s40 offen
v_mfma_f32_16x16x32_bf16 a[44:47], v[124:127], v[60:63], a[44:47]
s_waitcnt lgkmcnt(2)
v_mfma_f32_16x16x32_bf16 a[48:51], v[96:99], v[40:43], a[48:51]
ds_read_b128 v[56:59], v2 offset:26624
v_mfma_f32_16x16x32_bf16 a[48:51], v[100:103], v[44:47], a[48:51]
ds_read_b128 v[60:63], v3 offset:26624
v_mfma_f32_16x16x32_bf16 a[52:55], v[104:107], v[40:43], a[52:55]
s_waitcnt vmcnt(27)
s_mov_b64 vcc, s[94:95]
v_cndmask_b32_dpp v18, v174, v172, vcc quad_perm:[1,0,3,2] row_mask:0xf bank_mask:0xf
v_cndmask_b32_dpp v19, v175, v173, vcc quad_perm:[1,0,3,2] row_mask:0xf bank_mask:0xf
v_mfma_f32_16x16x32_bf16 a[52:55], v[108:111], v[44:47], a[52:55]
s_not_b64 vcc, s[94:95]
v_cndmask_b32_dpp v174, v172, v174, vcc quad_perm:[1,0,3,2] row_mask:0xf bank_mask:0xf
v_cndmask_b32_dpp v175, v173, v175, vcc quad_perm:[1,0,3,2] row_mask:0xf bank_mask:0xf
v_mfma_f32_16x16x32_bf16 a[56:59], v[112:115], v[40:43], a[56:59]
v_perm_b32 v67, v174, v18, s100
v_perm_b32 v75, v174, v18, s101
v_mfma_f32_16x16x32_bf16 a[56:59], v[116:119], v[44:47], a[56:59]
v_perm_b32 v83, v175, v19, s100
v_perm_b32 v91, v175, v19, s101
v_mfma_f32_16x16x32_bf16 a[60:63], v[120:123], v[40:43], a[60:63]
s_add_u32 s40, s39, 0xa3200
buffer_load_dwordx4 v[172:175], v0, s[96:99], s40 offen
v_mfma_f32_16x16x32_bf16 a[60:63], v[124:127], v[44:47], a[60:63]
s_waitcnt lgkmcnt(2)
v_mfma_f32_16x16x32_bf16 a[64:67], v[96:99], v[48:51], a[64:67]
ds_read_b128 v[40:43], v2 offset:28672
v_mfma_f32_16x16x32_bf16 a[64:67], v[100:103], v[52:55], a[64:67]
ds_read_b128 v[44:47], v3 offset:28672
v_mfma_f32_16x16x32_bf16 a[68:71], v[104:107], v[48:51], a[68:71]
s_waitcnt vmcnt(27)
s_mov_b64 vcc, s[94:95]
v_cndmask_b32_dpp v18, v178, v176, vcc quad_perm:[1,0,3,2] row_mask:0xf bank_mask:0xf
v_cndmask_b32_dpp v19, v179, v177, vcc quad_perm:[1,0,3,2] row_mask:0xf bank_mask:0xf
v_mfma_f32_16x16x32_bf16 a[68:71], v[108:111], v[52:55], a[68:71]
s_not_b64 vcc, s[94:95]
v_cndmask_b32_dpp v178, v176, v178, vcc quad_perm:[1,0,3,2] row_mask:0xf bank_mask:0xf
v_cndmask_b32_dpp v179, v177, v179, vcc quad_perm:[1,0,3,2] row_mask:0xf bank_mask:0xf
v_mfma_f32_16x16x32_bf16 a[72:75], v[112:115], v[48:51], a[72:75]
v_perm_b32 v68, v178, v18, s100
v_perm_b32 v76, v178, v18, s101
v_mfma_f32_16x16x32_bf16 a[72:75], v[116:119], v[52:55], a[72:75]
v_perm_b32 v84, v179, v19, s100
v_perm_b32 v92, v179, v19, s101
v_mfma_f32_16x16x32_bf16 a[76:79], v[120:123], v[48:51], a[76:79]
s_add_u32 s40, s39, 0xb0200
buffer_load_dwordx4 v[176:179], v0, s[96:99], s40 offen
v_mfma_f32_16x16x32_bf16 a[76:79], v[124:127], v[52:55], a[76:79]
s_waitcnt lgkmcnt(2)
v_mfma_f32_16x16x32_bf16 a[80:83], v[96:99], v[56:59], a[80:83]
ds_read_b128 v[48:51], v2 offset:30720
v_mfma_f32_16x16x32_bf16 a[80:83], v[100:103], v[60:63], a[80:83]
ds_read_b128 v[52:55], v3 offset:30720
v_mfma_f32_16x16x32_bf16 a[84:87], v[104:107], v[56:59], a[84:87]
s_waitcnt vmcnt(27)
s_mov_b64 vcc, s[94:95]
v_cndmask_b32_dpp v18, v182, v180, vcc quad_perm:[1,0,3,2] row_mask:0xf bank_mask:0xf
v_cndmask_b32_dpp v19, v183, v181, vcc quad_perm:[1,0,3,2] row_mask:0xf bank_mask:0xf
v_mfma_f32_16x16x32_bf16 a[84:87], v[108:111], v[60:63], a[84:87]
s_not_b64 vcc, s[94:95]
v_cndmask_b32_dpp v182, v180, v182, vcc quad_perm:[1,0,3,2] row_mask:0xf bank_mask:0xf
v_cndmask_b32_dpp v183, v181, v183, vcc quad_perm:[1,0,3,2] row_mask:0xf bank_mask:0xf
v_mfma_f32_16x16x32_bf16 a[88:91], v[112:115], v[56:59], a[88:91]
v_perm_b32 v69, v182, v18, s100
v_perm_b32 v77, v182, v18, s101
v_mfma_f32_16x16x32_bf16 a[88:91], v[116:119], v[60:63], a[88:91]
v_perm_b32 v85, v183, v19, s100
v_perm_b32 v93, v183, v19, s101
v_mfma_f32_16x16x32_bf16 a[92:95], v[120:123], v[56:59], a[92:95]
s_add_u32 s40, s39, 0xb1200
buffer_load_dwordx4 v[180:183], v0, s[96:99], s40 offen
v_mfma_f32_16x16x32_bf16 a[92:95], v[124:127], v[60:63], a[92:95]
s_waitcnt lgkmcnt(2)
v_mfma_f32_16x16x32_bf16 a[96:99], v[96:99], v[40:43], a[96:99]
ds_read_b128 v[56:59], v2 offset:32768
v_mfma_f32_16x16x32_bf16 a[96:99], v[100:103], v[44:47], a[96:99]
ds_read_b128 v[60:63], v3 offset:32768
v_mfma_f32_16x16x32_bf16 a[100:103], v[104:107], v[40:43], a[100:103]
s_waitcnt vmcnt(27)
s_mov_b64 vcc, s[94:95]
v_cndmask_b32_dpp v18, v186, v184, vcc quad_perm:[1,0,3,2] row_mask:0xf bank_mask:0xf
v_cndmask_b32_dpp v19, v187, v185, vcc quad_perm:[1,0,3,2] row_mask:0xf bank_mask:0xf
v_mfma_f32_16x16x32_bf16 a[100:103], v[108:111], v[44:47], a[100:103]
s_not_b64 vcc, s[94:95]
v_cndmask_b32_dpp v186, v184, v186, vcc quad_perm:[1,0,3,2] row_mask:0xf bank_mask:0xf
v_cndmask_b32_dpp v187, v185, v187, vcc quad_perm:[1,0,3,2] row_mask:0xf bank_mask:0xf
v_mfma_f32_16x16x32_bf16 a[104:107], v[112:115], v[40:43], a[104:107]
v_perm_b32 v70, v186, v18, s100
v_perm_b32 v78, v186, v18, s101
v_mfma_f32_16x16x32_bf16 a[104:107], v[116:119], v[44:47], a[104:107]
v_perm_b32 v86, v187, v19, s100
v_perm_b32 v94, v187, v19, s101
v_mfma_f32_16x16x32_bf16 a[108:111], v[120:123], v[40:43], a[108:111]
s_waitcnt vmcnt(26)
s_mov_b64 vcc, s[94:95]
v_cndmask_b32_dpp v18, v190, v188, vcc quad_perm:[1,0,3,2] row_mask:0xf bank_mask:0xf
v_cndmask_b32_dpp v19, v191, v189, vcc quad_perm:[1,0,3,2] row_mask:0xf bank_mask:0xf
v_mfma_f32_16x16x32_bf16 a[108:111], v[124:127], v[44:47], a[108:111]
s_not_b64 vcc, s[94:95]
v_cndmask_b32_dpp v190, v188, v190, vcc quad_perm:[1,0,3,2] row_mask:0xf bank_mask:0xf
v_cndmask_b32_dpp v191, v189, v191, vcc quad_perm:[1,0,3,2] row_mask:0xf bank_mask:0xf
s_waitcnt lgkmcnt(2)
v_mfma_f32_16x16x32_bf16 a[112:115], v[96:99], v[48:51], a[112:115]
ds_read_b128 v[40:43], v2 offset:34816
v_perm_b32 v71, v190, v18, s100
v_perm_b32 v79, v190, v18, s101
v_mfma_f32_16x16x32_bf16 a[112:115], v[100:103], v[52:55], a[112:115]
ds_read_b128 v[44:47], v3 offset:34816
v_perm_b32 v87, v191, v19, s100
v_perm_b32 v95, v191, v19, s101
v_mfma_f32_16x16x32_bf16 a[116:119], v[104:107], v[48:51], a[116:119]
s_add_u32 s40, s39, 0xb2200
buffer_load_dwordx4 v[184:187], v0, s[96:99], s40 offen
v_mfma_f32_16x16x32_bf16 a[116:119], v[108:111], v[52:55], a[116:119]
v_mfma_f32_16x16x32_bf16 a[120:123], v[112:115], v[48:51], a[120:123]
s_add_u32 s40, s39, 0xb3200
buffer_load_dwordx4 v[188:191], v0, s[96:99], s40 offen
v_mfma_f32_16x16x32_bf16 a[120:123], v[116:119], v[52:55], a[120:123]
v_mfma_f32_16x16x32_bf16 a[124:127], v[120:123], v[48:51], a[124:127]
v_mfma_f32_16x16x32_bf16 a[124:127], v[124:127], v[52:55], a[124:127]
s_waitcnt lgkmcnt(2)
v_mfma_f32_16x16x32_bf16 a[0:3], v[64:67], v[56:59], a[0:3]
ds_read_b128 v[48:51], v2 offset:36864
v_mfma_f32_16x16x32_bf16 a[0:3], v[68:71], v[60:63], a[0:3]
ds_read_b128 v[52:55], v3 offset:36864
v_mfma_f32_16x16x32_bf16 a[4:7], v[72:75], v[56:59], a[4:7]
s_waitcnt vmcnt(27)
s_mov_b64 vcc, s[94:95]
v_cndmask_b32_dpp v18, v194, v192, vcc quad_perm:[1,0,3,2] row_mask:0xf bank_mask:0xf
v_cndmask_b32_dpp v19, v195, v193, vcc quad_perm:[1,0,3,2] row_mask:0xf bank_mask:0xf
v_mfma_f32_16x16x32_bf16 a[4:7], v[76:79], v[60:63], a[4:7]
s_not_b64 vcc, s[94:95]
v_cndmask_b32_dpp v194, v192, v194, vcc quad_perm:[1,0,3,2] row_mask:0xf bank_mask:0xf
v_cndmask_b32_dpp v195, v193, v195, vcc quad_perm:[1,0,3,2] row_mask:0xf bank_mask:0xf
v_mfma_f32_16x16x32_bf16 a[8:11], v[80:83], v[56:59], a[8:11]
v_perm_b32 v96, v194, v18, s100
v_perm_b32 v104, v194, v18, s101
s_add_u32 m0, s3, 0x4000
v_mfma_f32_16x16x32_bf16 a[8:11], v[84:87], v[60:63], a[8:11]
v_perm_b32 v112, v195, v19, s100
v_perm_b32 v120, v195, v19, s101
buffer_load_dwordx4 v8, s[8:11], s35 offen nt lds
s_add_u32 s35, s35, 0x10000
v_mfma_f32_16x16x32_bf16 a[12:15], v[88:91], v[56:59], a[12:15]
s_add_u32 s40, s39, 0xc0200
buffer_load_dwordx4 v[192:195], v0, s[96:99], s40 offen
s_add_u32 m0, s3, 0x5000
v_mfma_f32_16x16x32_bf16 a[12:15], v[92:95], v[60:63], a[12:15]
buffer_load_dwordx4 v8, s[8:11], s35 offen nt lds
s_add_u32 s35, s35, 0x10000
s_waitcnt lgkmcnt(2)
v_mfma_f32_16x16x32_bf16 a[16:19], v[64:67], v[40:43], a[16:19]
ds_read_b128 v[56:59], v2 offset:38912
s_add_u32 m0, s3, 0x6000
v_mfma_f32_16x16x32_bf16 a[16:19], v[68:71], v[44:47], a[16:19]
ds_read_b128 v[60:63], v3 offset:38912
buffer_load_dwordx4 v8, s[8:11], s35 offen nt lds
s_add_u32 s35, s35, 0x10000
v_mfma_f32_16x16x32_bf16 a[20:23], v[72:75], v[40:43], a[20:23]
s_waitcnt vmcnt(30)
s_mov_b64 vcc, s[94:95]
v_cndmask_b32_dpp v18, v198, v196, vcc quad_perm:[1,0,3,2] row_mask:0xf bank_mask:0xf
v_cndmask_b32_dpp v19, v199, v197, vcc quad_perm:[1,0,3,2] row_mask:0xf bank_mask:0xf
s_add_u32 m0, s3, 0x7000
v_mfma_f32_16x16x32_bf16 a[20:23], v[76:79], v[44:47], a[20:23]
s_not_b64 vcc, s[94:95]
v_cndmask_b32_dpp v198, v196, v198, vcc quad_perm:[1,0,3,2] row_mask:0xf bank_mask:0xf
v_cndmask_b32_dpp v199, v197, v199, vcc quad_perm:[1,0,3,2] row_mask:0xf bank_mask:0xf
buffer_load_dwordx4 v8, s[8:11], s35 offen nt lds
s_sub_u32 s35, s35, 196480
v_mfma_f32_16x16x32_bf16 a[24:27], v[80:83], v[40:43], a[24:27]
v_perm_b32 v97, v198, v18, s100
v_perm_b32 v105, v198, v18, s101
v_mfma_f32_16x16x32_bf16 a[24:27], v[84:87], v[44:47], a[24:27]
v_perm_b32 v113, v199, v19, s100
v_perm_b32 v121, v199, v19, s101
v_mfma_f32_16x16x32_bf16 a[28:31], v[88:91], v[40:43], a[28:31]
s_add_u32 s40, s39, 0xc1200
buffer_load_dwordx4 v[196:199], v0, s[96:99], s40 offen
v_mfma_f32_16x16x32_bf16 a[28:31], v[92:95], v[44:47], a[28:31]
s_waitcnt lgkmcnt(2)
v_mfma_f32_16x16x32_bf16 a[32:35], v[64:67], v[48:51], a[32:35]
ds_read_b128 v[40:43], v2 offset:40960
v_mfma_f32_16x16x32_bf16 a[32:35], v[68:71], v[52:55], a[32:35]
ds_read_b128 v[44:47], v3 offset:40960
v_mfma_f32_16x16x32_bf16 a[36:39], v[72:75], v[48:51], a[36:39]
s_waitcnt vmcnt(31)
s_mov_b64 vcc, s[94:95]
v_cndmask_b32_dpp v18, v202, v200, vcc quad_perm:[1,0,3,2] row_mask:0xf bank_mask:0xf
v_cndmask_b32_dpp v19, v203, v201, vcc quad_perm:[1,0,3,2] row_mask:0xf bank_mask:0xf
v_mfma_f32_16x16x32_bf16 a[36:39], v[76:79], v[52:55], a[36:39]
s_not_b64 vcc, s[94:95]
v_cndmask_b32_dpp v202, v200, v202, vcc quad_perm:[1,0,3,2] row_mask:0xf bank_mask:0xf
v_cndmask_b32_dpp v203, v201, v203, vcc quad_perm:[1,0,3,2] row_mask:0xf bank_mask:0xf
v_mfma_f32_16x16x32_bf16 a[40:43], v[80:83], v[48:51], a[40:43]
v_perm_b32 v98, v202, v18, s100
v_perm_b32 v106, v202, v18, s101
v_mfma_f32_16x16x32_bf16 a[40:43], v[84:87], v[52:55], a[40:43]
v_perm_b32 v114, v203, v19, s100
v_perm_b32 v122, v203, v19, s101
v_mfma_f32_16x16x32_bf16 a[44:47], v[88:91], v[48:51], a[44:47]
s_add_u32 s40, s39, 0xc2200
buffer_load_dwordx4 v[200:203], v0, s[96:99], s40 offen
v_mfma_f32_16x16x32_bf16 a[44:47], v[92:95], v[52:55], a[44:47]
s_waitcnt lgkmcnt(2)
v_mfma_f32_16x16x32_bf16 a[48:51], v[64:67], v[56:59], a[48:51]
ds_read_b128 v[48:51], v2 offset:43008
v_mfma_f32_16x16x32_bf16 a[48:51], v[68:71], v[60:63], a[48:51]
ds_read_b128 v[52:55], v3 offset:43008
v_mfma_f32_16x16x32_bf16 a[52:55], v[72:75], v[56:59], a[52:55]
s_waitcnt vmcnt(31)
s_mov_b64 vcc, s[94:95]
v_cndmask_b32_dpp v18, v206, v204, vcc quad_perm:[1,0,3,2] row_mask:0xf bank_mask:0xf
v_cndmask_b32_dpp v19, v207, v205, vcc quad_perm:[1,0,3,2] row_mask:0xf bank_mask:0xf
v_mfma_f32_16x16x32_bf16 a[52:55], v[76:79], v[60:63], a[52:55]
s_not_b64 vcc, s[94:95]
v_cndmask_b32_dpp v206, v204, v206, vcc quad_perm:[1,0,3,2] row_mask:0xf bank_mask:0xf
v_cndmask_b32_dpp v207, v205, v207, vcc quad_perm:[1,0,3,2] row_mask:0xf bank_mask:0xf
v_mfma_f32_16x16x32_bf16 a[56:59], v[80:83], v[56:59], a[56:59]
v_perm_b32 v99, v206, v18, s100
v_perm_b32 v107, v206, v18, s101
v_mfma_f32_16x16x32_bf16 a[56:59], v[84:87], v[60:63], a[56:59]
v_perm_b32 v115, v207, v19, s100
v_perm_b32 v123, v207, v19, s101
v_mfma_f32_16x16x32_bf16 a[60:63], v[88:91], v[56:59], a[60:63]
s_add_u32 s40, s39, 0xc3200
buffer_load_dwordx4 v[204:207], v0, s[96:99], s40 offen
v_mfma_f32_16x16x32_bf16 a[60:63], v[92:95], v[60:63], a[60:63]
s_waitcnt lgkmcnt(2)
v_mfma_f32_16x16x32_bf16 a[64:67], v[64:67], v[40:43], a[64:67]
ds_read_b128 v[56:59], v2 offset:45056
v_mfma_f32_16x16x32_bf16 a[64:67], v[68:71], v[44:47], a[64:67]
ds_read_b128 v[60:63], v3 offset:45056
v_mfma_f32_16x16x32_bf16 a[68:71], v[72:75], v[40:43], a[68:71]
s_waitcnt vmcnt(31)
s_mov_b64 vcc, s[94:95]
v_cndmask_b32_dpp v18, v210, v208, vcc quad_perm:[1,0,3,2] row_mask:0xf bank_mask:0xf
v_cndmask_b32_dpp v19, v211, v209, vcc quad_perm:[1,0,3,2] row_mask:0xf bank_mask:0xf
v_mfma_f32_16x16x32_bf16 a[68:71], v[76:79], v[44:47], a[68:71]
s_not_b64 vcc, s[94:95]
v_cndmask_b32_dpp v210, v208, v210, vcc quad_perm:[1,0,3,2] row_mask:0xf bank_mask:0xf
v_cndmask_b32_dpp v211, v209, v211, vcc quad_perm:[1,0,3,2] row_mask:0xf bank_mask:0xf
v_mfma_f32_16x16x32_bf16 a[72:75], v[80:83], v[40:43], a[72:75]
v_perm_b32 v100, v210, v18, s100
v_perm_b32 v108, v210, v18, s101
v_mfma_f32_16x16x32_bf16 a[72:75], v[84:87], v[44:47], a[72:75]
v_perm_b32 v116, v211, v19, s100
v_perm_b32 v124, v211, v19, s101
v_mfma_f32_16x16x32_bf16 a[76:79], v[88:91], v[40:43], a[76:79]
s_add_u32 s40, s39, 0xd0200
buffer_load_dwordx4 v[208:211], v0, s[96:99], s40 offen
v_mfma_f32_16x16x32_bf16 a[76:79], v[92:95], v[44:47], a[76:79]
s_waitcnt lgkmcnt(2)
v_mfma_f32_16x16x32_bf16 a[80:83], v[64:67], v[48:51], a[80:83]
ds_read_b128 v[40:43], v2 offset:47104
v_mfma_f32_16x16x32_bf16 a[80:83], v[68:71], v[52:55], a[80:83]
ds_read_b128 v[44:47], v3 offset:47104
v_mfma_f32_16x16x32_bf16 a[84:87], v[72:75], v[48:51], a[84:87]
s_waitcnt vmcnt(31)
s_mov_b64 vcc, s[94:95]
v_cndmask_b32_dpp v18, v214, v212, vcc quad_perm:[1,0,3,2] row_mask:0xf bank_mask:0xf
v_cndmask_b32_dpp v19, v215, v213, vcc quad_perm:[1,0,3,2] row_mask:0xf bank_mask:0xf
v_mfma_f32_16x16x32_bf16 a[84:87], v[76:79], v[52:55], a[84:87]
s_not_b64 vcc, s[94:95]
v_cndmask_b32_dpp v214, v212, v214, vcc quad_perm:[1,0,3,2] row_mask:0xf bank_mask:0xf
v_cndmask_b32_dpp v215, v213, v215, vcc quad_perm:[1,0,3,2] row_mask:0xf bank_mask:0xf
v_mfma_f32_16x16x32_bf16 a[88:91], v[80:83], v[48:51], a[88:91]
v_perm_b32 v101, v214, v18, s100
v_perm_b32 v109, v214, v18, s101
v_mfma_f32_16x16x32_bf16 a[88:91], v[84:87], v[52:55], a[88:91]
v_perm_b32 v117, v215, v19, s100
v_perm_b32 v125, v215, v19, s101
v_mfma_f32_16x16x32_bf16 a[92:95], v[88:91], v[48:51], a[92:95]
s_add_u32 s40, s39, 0xd1200
buffer_load_dwordx4 v[212:215], v0, s[96:99], s40 offen
v_mfma_f32_16x16x32_bf16 a[92:95], v[92:95], v[52:55], a[92:95]
s_waitcnt lgkmcnt(2)
v_mfma_f32_16x16x32_bf16 a[96:99], v[64:67], v[56:59], a[96:99]
ds_read_b128 v[48:51], v2 offset:49152
v_mfma_f32_16x16x32_bf16 a[96:99], v[68:71], v[60:63], a[96:99]
ds_read_b128 v[52:55], v3 offset:49152
v_mfma_f32_16x16x32_bf16 a[100:103], v[72:75], v[56:59], a[100:103]
s_waitcnt vmcnt(31)
s_mov_b64 vcc, s[94:95]
v_cndmask_b32_dpp v18, v218, v216, vcc quad_perm:[1,0,3,2] row_mask:0xf bank_mask:0xf
v_cndmask_b32_dpp v19, v219, v217, vcc quad_perm:[1,0,3,2] row_mask:0xf bank_mask:0xf
v_mfma_f32_16x16x32_bf16 a[100:103], v[76:79], v[60:63], a[100:103]
s_not_b64 vcc, s[94:95]
v_cndmask_b32_dpp v218, v216, v218, vcc quad_perm:[1,0,3,2] row_mask:0xf bank_mask:0xf
v_cndmask_b32_dpp v219, v217, v219, vcc quad_perm:[1,0,3,2] row_mask:0xf bank_mask:0xf
v_mfma_f32_16x16x32_bf16 a[104:107], v[80:83], v[56:59], a[104:107]
v_perm_b32 v102, v218, v18, s100
v_perm_b32 v110, v218, v18, s101
v_mfma_f32_16x16x32_bf16 a[104:107], v[84:87], v[60:63], a[104:107]
v_perm_b32 v118, v219, v19, s100
v_perm_b32 v126, v219, v19, s101
v_mfma_f32_16x16x32_bf16 a[108:111], v[88:91], v[56:59], a[108:111]
s_waitcnt vmcnt(30)
s_mov_b64 vcc, s[94:95]
v_cndmask_b32_dpp v18, v222, v220, vcc quad_perm:[1,0,3,2] row_mask:0xf bank_mask:0xf
v_cndmask_b32_dpp v19, v223, v221, vcc quad_perm:[1,0,3,2] row_mask:0xf bank_mask:0xf
v_mfma_f32_16x16x32_bf16 a[108:111], v[92:95], v[60:63], a[108:111]
s_not_b64 vcc, s[94:95]
v_cndmask_b32_dpp v222, v220, v222, vcc quad_perm:[1,0,3,2] row_mask:0xf bank_mask:0xf
v_cndmask_b32_dpp v223, v221, v223, vcc quad_perm:[1,0,3,2] row_mask:0xf bank_mask:0xf
s_waitcnt lgkmcnt(2)
v_mfma_f32_16x16x32_bf16 a[112:115], v[64:67], v[40:43], a[112:115]
ds_read_b128 v[56:59], v2 offset:51200
v_perm_b32 v103, v222, v18, s100
v_perm_b32 v111, v222, v18, s101
v_mfma_f32_16x16x32_bf16 a[112:115], v[68:71], v[44:47], a[112:115]
ds_read_b128 v[60:63], v3 offset:51200
v_perm_b32 v119, v223, v19, s100
v_perm_b32 v127, v223, v19, s101
v_mfma_f32_16x16x32_bf16 a[116:119], v[72:75], v[40:43], a[116:119]
s_add_u32 s40, s39, 0xd2200
buffer_load_dwordx4 v[216:219], v0, s[96:99], s40 offen
v_mfma_f32_16x16x32_bf16 a[116:119], v[76:79], v[44:47], a[116:119]
v_mfma_f32_16x16x32_bf16 a[120:123], v[80:83], v[40:43], a[120:123]
s_add_u32 s40, s39, 0xd3200
buffer_load_dwordx4 v[220:223], v0, s[96:99], s40 offen
v_mfma_f32_16x16x32_bf16 a[120:123], v[84:87], v[44:47], a[120:123]
v_mfma_f32_16x16x32_bf16 a[124:127], v[88:91], v[40:43], a[124:127]
v_mfma_f32_16x16x32_bf16 a[124:127], v[92:95], v[44:47], a[124:127]
s_waitcnt lgkmcnt(2)
v_mfma_f32_16x16x32_bf16 a[0:3], v[96:99], v[48:51], a[0:3]
ds_read_b128 v[40:43], v2 offset:53248
v_mfma_f32_16x16x32_bf16 a[0:3], v[100:103], v[52:55], a[0:3]
ds_read_b128 v[44:47], v3 offset:53248
v_mfma_f32_16x16x32_bf16 a[4:7], v[104:107], v[48:51], a[4:7]
s_waitcnt vmcnt(30)
s_mov_b64 vcc, s[94:95]
v_cndmask_b32_dpp v18, v130, v128, vcc quad_perm:[1,0,3,2] row_mask:0xf bank_mask:0xf
v_cndmask_b32_dpp v19, v131, v129, vcc quad_perm:[1,0,3,2] row_mask:0xf bank_mask:0xf
v_mfma_f32_16x16x32_bf16 a[4:7], v[108:111], v[52:55], a[4:7]
s_not_b64 vcc, s[94:95]
v_cndmask_b32_dpp v130, v128, v130, vcc quad_perm:[1,0,3,2] row_mask:0xf bank_mask:0xf
v_cndmask_b32_dpp v131, v129, v131, vcc quad_perm:[1,0,3,2] row_mask:0xf bank_mask:0xf
v_mfma_f32_16x16x32_bf16 a[8:11], v[112:115], v[48:51], a[8:11]
v_perm_b32 v64, v130, v18, s100
v_perm_b32 v72, v130, v18, s101
v_mfma_f32_16x16x32_bf16 a[8:11], v[116:119], v[52:55], a[8:11]
v_perm_b32 v80, v131, v19, s100
v_perm_b32 v88, v131, v19, s101
v_mfma_f32_16x16x32_bf16 a[12:15], v[120:123], v[48:51], a[12:15]
s_add_u32 s40, s39, 0xe0200
buffer_load_dwordx4 v[128:131], v0, s[96:99], s40 offen
v_mfma_f32_16x16x32_bf16 a[12:15], v[124:127], v[52:55], a[12:15]
s_waitcnt lgkmcnt(2)
v_mfma_f32_16x16x32_bf16 a[16:19], v[96:99], v[56:59], a[16:19]
ds_read_b128 v[48:51], v2 offset:55296
v_mfma_f32_16x16x32_bf16 a[16:19], v[100:103], v[60:63], a[16:19]
ds_read_b128 v[52:55], v3 offset:55296
v_mfma_f32_16x16x32_bf16 a[20:23], v[104:107], v[56:59], a[20:23]
s_waitcnt vmcnt(27)
s_mov_b64 vcc, s[94:95]
v_cndmask_b32_dpp v18, v134, v132, vcc quad_perm:[1,0,3,2] row_mask:0xf bank_mask:0xf
v_cndmask_b32_dpp v19, v135, v133, vcc quad_perm:[1,0,3,2] row_mask:0xf bank_mask:0xf
v_mfma_f32_16x16x32_bf16 a[20:23], v[108:111], v[60:63], a[20:23]
s_not_b64 vcc, s[94:95]
v_cndmask_b32_dpp v134, v132, v134, vcc quad_perm:[1,0,3,2] row_mask:0xf bank_mask:0xf
v_cndmask_b32_dpp v135, v133, v135, vcc quad_perm:[1,0,3,2] row_mask:0xf bank_mask:0xf
v_mfma_f32_16x16x32_bf16 a[24:27], v[112:115], v[56:59], a[24:27]
v_perm_b32 v65, v134, v18, s100
v_perm_b32 v73, v134, v18, s101
v_mfma_f32_16x16x32_bf16 a[24:27], v[116:119], v[60:63], a[24:27]
v_perm_b32 v81, v135, v19, s100
v_perm_b32 v89, v135, v19, s101
v_mfma_f32_16x16x32_bf16 a[28:31], v[120:123], v[56:59], a[28:31]
s_add_u32 s40, s39, 0xe1200
buffer_load_dwordx4 v[132:135], v0, s[96:99], s40 offen
v_mfma_f32_16x16x32_bf16 a[28:31], v[124:127], v[60:63], a[28:31]
s_waitcnt lgkmcnt(2)
v_mfma_f32_16x16x32_bf16 a[32:35], v[96:99], v[40:43], a[32:35]
ds_read_b128 v[56:59], v2 offset:57344
v_mfma_f32_16x16x32_bf16 a[32:35], v[100:103], v[44:47], a[32:35]
ds_read_b128 v[60:63], v3 offset:57344
v_mfma_f32_16x16x32_bf16 a[36:39], v[104:107], v[40:43], a[36:39]
s_waitcnt vmcnt(27)
s_mov_b64 vcc, s[94:95]
v_cndmask_b32_dpp v18, v138, v136, vcc quad_perm:[1,0,3,2] row_mask:0xf bank_mask:0xf
v_cndmask_b32_dpp v19, v139, v137, vcc quad_perm:[1,0,3,2] row_mask:0xf bank_mask:0xf
v_mfma_f32_16x16x32_bf16 a[36:39], v[108:111], v[44:47], a[36:39]
s_not_b64 vcc, s[94:95]
v_cndmask_b32_dpp v138, v136, v138, vcc quad_perm:[1,0,3,2] row_mask:0xf bank_mask:0xf
v_cndmask_b32_dpp v139, v137, v139, vcc quad_perm:[1,0,3,2] row_mask:0xf bank_mask:0xf
v_mfma_f32_16x16x32_bf16 a[40:43], v[112:115], v[40:43], a[40:43]
v_perm_b32 v66, v138, v18, s100
v_perm_b32 v74, v138, v18, s101
v_mfma_f32_16x16x32_bf16 a[40:43], v[116:119], v[44:47], a[40:43]
v_perm_b32 v82, v139, v19, s100
v_perm_b32 v90, v139, v19, s101
v_mfma_f32_16x16x32_bf16 a[44:47], v[120:123], v[40:43], a[44:47]
s_add_u32 s40, s39, 0xe2200
buffer_load_dwordx4 v[136:139], v0, s[96:99], s40 offen
v_mfma_f32_16x16x32_bf16 a[44:47], v[124:127], v[44:47], a[44:47]
s_waitcnt lgkmcnt(2)
v_mfma_f32_16x16x32_bf16 a[48:51], v[96:99], v[48:51], a[48:51]
ds_read_b128 v[40:43], v2 offset:59392
v_mfma_f32_16x16x32_bf16 a[48:51], v[100:103], v[52:55], a[48:51]
ds_read_b128 v[44:47], v3 offset:59392
v_mfma_f32_16x16x32_bf16 a[52:55], v[104:107], v[48:51], a[52:55]
s_waitcnt vmcnt(27)
s_mov_b64 vcc, s[94:95]
v_cndmask_b32_dpp v18, v142, v140, vcc quad_perm:[1,0,3,2] row_mask:0xf bank_mask:0xf
v_cndmask_b32_dpp v19, v143, v141, vcc quad_perm:[1,0,3,2] row_mask:0xf bank_mask:0xf
v_mfma_f32_16x16x32_bf16 a[52:55], v[108:111], v[52:55], a[52:55]
s_not_b64 vcc, s[94:95]
v_cndmask_b32_dpp v142, v140, v142, vcc quad_perm:[1,0,3,2] row_mask:0xf bank_mask:0xf
v_cndmask_b32_dpp v143, v141, v143, vcc quad_perm:[1,0,3,2] row_mask:0xf bank_mask:0xf
v_mfma_f32_16x16x32_bf16 a[56:59], v[112:115], v[48:51], a[56:59]
v_perm_b32 v67, v142, v18, s100
v_perm_b32 v75, v142, v18, s101
v_mfma_f32_16x16x32_bf16 a[56:59], v[116:119], v[52:55], a[56:59]
v_perm_b32 v83, v143, v19, s100
v_perm_b32 v91, v143, v19, s101
v_mfma_f32_16x16x32_bf16 a[60:63], v[120:123], v[48:51], a[60:63]
s_add_u32 s40, s39, 0xe3200
buffer_load_dwordx4 v[140:143], v0, s[96:99], s40 offen
v_mfma_f32_16x16x32_bf16 a[60:63], v[124:127], v[52:55], a[60:63]
s_waitcnt lgkmcnt(2)
v_mfma_f32_16x16x32_bf16 a[64:67], v[96:99], v[56:59], a[64:67]
ds_read_b128 v[48:51], v2 offset:61440
v_mfma_f32_16x16x32_bf16 a[64:67], v[100:103], v[60:63], a[64:67]
ds_read_b128 v[52:55], v3 offset:61440
v_mfma_f32_16x16x32_bf16 a[68:71], v[104:107], v[56:59], a[68:71]
s_waitcnt vmcnt(27)
s_mov_b64 vcc, s[94:95]
v_cndmask_b32_dpp v18, v146, v144, vcc quad_perm:[1,0,3,2] row_mask:0xf bank_mask:0xf
v_cndmask_b32_dpp v19, v147, v145, vcc quad_perm:[1,0,3,2] row_mask:0xf bank_mask:0xf
v_mfma_f32_16x16x32_bf16 a[68:71], v[108:111], v[60:63], a[68:71]
s_not_b64 vcc, s[94:95]
v_cndmask_b32_dpp v146, v144, v146, vcc quad_perm:[1,0,3,2] row_mask:0xf bank_mask:0xf
v_cndmask_b32_dpp v147, v145, v147, vcc quad_perm:[1,0,3,2] row_mask:0xf bank_mask:0xf
v_mfma_f32_16x16x32_bf16 a[72:75], v[112:115], v[56:59], a[72:75]
v_perm_b32 v68, v146, v18, s100
v_perm_b32 v76, v146, v18, s101
v_mfma_f32_16x16x32_bf16 a[72:75], v[116:119], v[60:63], a[72:75]
v_perm_b32 v84, v147, v19, s100
v_perm_b32 v92, v147, v19, s101
v_mfma_f32_16x16x32_bf16 a[76:79], v[120:123], v[56:59], a[76:79]
s_add_u32 s40, s39, 0xf0200
buffer_load_dwordx4 v[144:147], v0, s[96:99], s40 offen
v_mfma_f32_16x16x32_bf16 a[76:79], v[124:127], v[60:63], a[76:79]
s_waitcnt lgkmcnt(2)
v_mfma_f32_16x16x32_bf16 a[80:83], v[96:99], v[40:43], a[80:83]
ds_read_b128 v[56:59], v2 offset:63488
v_mfma_f32_16x16x32_bf16 a[80:83], v[100:103], v[44:47], a[80:83]
ds_read_b128 v[60:63], v3 offset:63488
v_mfma_f32_16x16x32_bf16 a[84:87], v[104:107], v[40:43], a[84:87]
s_waitcnt vmcnt(27)
s_mov_b64 vcc, s[94:95]
v_cndmask_b32_dpp v18, v150, v148, vcc quad_perm:[1,0,3,2] row_mask:0xf bank_mask:0xf
v_cndmask_b32_dpp v19, v151, v149, vcc quad_perm:[1,0,3,2] row_mask:0xf bank_mask:0xf
v_mfma_f32_16x16x32_bf16 a[84:87], v[108:111], v[44:47], a[84:87]
s_not_b64 vcc, s[94:95]
v_cndmask_b32_dpp v150, v148, v150, vcc quad_perm:[1,0,3,2] row_mask:0xf bank_mask:0xf
v_cndmask_b32_dpp v151, v149, v151, vcc quad_perm:[1,0,3,2] row_mask:0xf bank_mask:0xf
v_mfma_f32_16x16x32_bf16 a[88:91], v[112:115], v[40:43], a[88:91]
v_perm_b32 v69, v150, v18, s100
v_perm_b32 v77, v150, v18, s101
v_mfma_f32_16x16x32_bf16 a[88:91], v[116:119], v[44:47], a[88:91]
v_perm_b32 v85, v151, v19, s100
v_perm_b32 v93, v151, v19, s101
v_mfma_f32_16x16x32_bf16 a[92:95], v[120:123], v[40:43], a[92:95]
s_add_u32 s40, s39, 0xf1200
buffer_load_dwordx4 v[148:151], v0, s[96:99], s40 offen
v_mfma_f32_16x16x32_bf16 a[92:95], v[124:127], v[44:47], a[92:95]
s_waitcnt lgkmcnt(2)
v_mfma_f32_16x16x32_bf16 a[96:99], v[96:99], v[48:51], a[96:99]
ds_read_b128 v[40:43], v2 offset:0
v_mfma_f32_16x16x32_bf16 a[96:99], v[100:103], v[52:55], a[96:99]
ds_read_b128 v[44:47], v3 offset:0
v_mfma_f32_16x16x32_bf16 a[100:103], v[104:107], v[48:51], a[100:103]
s_waitcnt vmcnt(27)
s_mov_b64 vcc, s[94:95]
v_cndmask_b32_dpp v18, v154, v152, vcc quad_perm:[1,0,3,2] row_mask:0xf bank_mask:0xf
v_cndmask_b32_dpp v19, v155, v153, vcc quad_perm:[1,0,3,2] row_mask:0xf bank_mask:0xf
v_mfma_f32_16x16x32_bf16 a[100:103], v[108:111], v[52:55], a[100:103]
s_not_b64 vcc, s[94:95]
v_cndmask_b32_dpp v154, v152, v154, vcc quad_perm:[1,0,3,2] row_mask:0xf bank_mask:0xf
v_cndmask_b32_dpp v155, v153, v155, vcc quad_perm:[1,0,3,2] row_mask:0xf bank_mask:0xf
v_mfma_f32_16x16x32_bf16 a[104:107], v[112:115], v[48:51], a[104:107]
v_perm_b32 v70, v154, v18, s100
v_perm_b32 v78, v154, v18, s101
v_mfma_f32_16x16x32_bf16 a[104:107], v[116:119], v[52:55], a[104:107]
v_perm_b32 v86, v155, v19, s100
v_perm_b32 v94, v155, v19, s101
v_mfma_f32_16x16x32_bf16 a[108:111], v[120:123], v[48:51], a[108:111]
s_waitcnt vmcnt(26)
s_mov_b64 vcc, s[94:95]
v_cndmask_b32_dpp v18, v158, v156, vcc quad_perm:[1,0,3,2] row_mask:0xf bank_mask:0xf
v_cndmask_b32_dpp v19, v159, v157, vcc quad_perm:[1,0,3,2] row_mask:0xf bank_mask:0xf
v_mfma_f32_16x16x32_bf16 a[108:111], v[124:127], v[52:55], a[108:111]
s_not_b64 vcc, s[94:95]
v_cndmask_b32_dpp v158, v156, v158, vcc quad_perm:[1,0,3,2] row_mask:0xf bank_mask:0xf
v_cndmask_b32_dpp v159, v157, v159, vcc quad_perm:[1,0,3,2] row_mask:0xf bank_mask:0xf
s_waitcnt lgkmcnt(2)
v_mfma_f32_16x16x32_bf16 a[112:115], v[96:99], v[56:59], a[112:115]
ds_read_b128 v[48:51], v2 offset:2048
v_perm_b32 v71, v158, v18, s100
v_perm_b32 v79, v158, v18, s101
v_mfma_f32_16x16x32_bf16 a[112:115], v[100:103], v[60:63], a[112:115]
ds_read_b128 v[52:55], v3 offset:2048
v_perm_b32 v87, v159, v19, s100
v_perm_b32 v95, v159, v19, s101
v_mfma_f32_16x16x32_bf16 a[116:119], v[104:107], v[56:59], a[116:119]
s_add_u32 s40, s39, 0xf2200
buffer_load_dwordx4 v[152:155], v0, s[96:99], s40 offen
v_mfma_f32_16x16x32_bf16 a[116:119], v[108:111], v[60:63], a[116:119]
v_mfma_f32_16x16x32_bf16 a[120:123], v[112:115], v[56:59], a[120:123]
s_add_u32 s40, s39, 0xf3200
buffer_load_dwordx4 v[156:159], v0, s[96:99], s40 offen
v_mfma_f32_16x16x32_bf16 a[120:123], v[116:119], v[60:63], a[120:123]
v_mfma_f32_16x16x32_bf16 a[124:127], v[120:123], v[56:59], a[124:127]
v_mfma_f32_16x16x32_bf16 a[124:127], v[124:127], v[60:63], a[124:127]
s_waitcnt lgkmcnt(2)
v_mfma_f32_16x16x32_bf16 a[128:131], v[64:67], v[40:43], a[128:131]
ds_read_b128 v[56:59], v2 offset:4096
v_mfma_f32_16x16x32_bf16 a[128:131], v[68:71], v[44:47], a[128:131]
ds_read_b128 v[60:63], v3 offset:4096
v_and_b32 v16, 4, v11
v_lshlrev_b32 v16, 5, v16
buffer_load_dword v12, v16, s[80:83], 0 offen sc1
v_mfma_f32_16x16x32_bf16 a[132:135], v[72:75], v[40:43], a[132:135]
s_waitcnt vmcnt(28)
s_mov_b64 vcc, s[94:95]
v_cndmask_b32_dpp v18, v162, v160, vcc quad_perm:[1,0,3,2] row_mask:0xf bank_mask:0xf
v_cndmask_b32_dpp v19, v163, v161, vcc quad_perm:[1,0,3,2] row_mask:0xf bank_mask:0xf
v_mfma_f32_16x16x32_bf16 a[132:135], v[76:79], v[44:47], a[132:135]
s_not_b64 vcc, s[94:95]
v_cndmask_b32_dpp v162, v160, v162, vcc quad_perm:[1,0,3,2] row_mask:0xf bank_mask:0xf
v_cndmask_b32_dpp v163, v161, v163, vcc quad_perm:[1,0,3,2] row_mask:0xf bank_mask:0xf
v_mfma_f32_16x16x32_bf16 a[136:139], v[80:83], v[40:43], a[136:139]
v_perm_b32 v96, v162, v18, s100
v_perm_b32 v104, v162, v18, s101
s_add_u32 m0, s3, 0x8000
v_mfma_f32_16x16x32_bf16 a[136:139], v[84:87], v[44:47], a[136:139]
v_perm_b32 v112, v163, v19, s100
v_perm_b32 v120, v163, v19, s101
buffer_load_dwordx4 v8, s[8:11], s35 offen nt lds
s_add_u32 s35, s35, 0x10000
v_mfma_f32_16x16x32_bf16 a[140:143], v[88:91], v[40:43], a[140:143]
s_add_u32 m0, s3, 0x9000
v_mfma_f32_16x16x32_bf16 a[140:143], v[92:95], v[44:47], a[140:143]
buffer_load_dwordx4 v8, s[8:11], s35 offen nt lds
s_add_u32 s35, s35, 0x10000
s_waitcnt lgkmcnt(2)
v_mfma_f32_16x16x32_bf16 a[144:147], v[64:67], v[48:51], a[144:147]
ds_read_b128 v[40:43], v2 offset:6144
s_add_u32 m0, s3, 0xa000
v_mfma_f32_16x16x32_bf16 a[144:147], v[68:71], v[52:55], a[144:147]
ds_read_b128 v[44:47], v3 offset:6144
buffer_load_dwordx4 v8, s[8:11], s35 offen nt lds
s_add_u32 s35, s35, 0x10000
v_mfma_f32_16x16x32_bf16 a[148:151], v[72:75], v[48:51], a[148:151]
s_waitcnt vmcnt(30)
s_mov_b64 vcc, s[94:95]
v_cndmask_b32_dpp v18, v166, v164, vcc quad_perm:[1,0,3,2] row_mask:0xf bank_mask:0xf
v_cndmask_b32_dpp v19, v167, v165, vcc quad_perm:[1,0,3,2] row_mask:0xf bank_mask:0xf
s_add_u32 m0, s3, 0xb000
v_mfma_f32_16x16x32_bf16 a[148:151], v[76:79], v[52:55], a[148:151]
s_not_b64 vcc, s[94:95]
v_cndmask_b32_dpp v166, v164, v166, vcc quad_perm:[1,0,3,2] row_mask:0xf bank_mask:0xf
v_cndmask_b32_dpp v167, v165, v167, vcc quad_perm:[1,0,3,2] row_mask:0xf bank_mask:0xf
buffer_load_dwordx4 v8, s[8:11], s35 offen nt lds
s_sub_u32 s35, s35, 196480
v_mfma_f32_16x16x32_bf16 a[152:155], v[80:83], v[48:51], a[152:155]
v_perm_b32 v97, v166, v18, s100
v_perm_b32 v105, v166, v18, s101
v_mfma_f32_16x16x32_bf16 a[152:155], v[84:87], v[52:55], a[152:155]
v_perm_b32 v113, v167, v19, s100
v_perm_b32 v121, v167, v19, s101
v_mfma_f32_16x16x32_bf16 a[156:159], v[88:91], v[48:51], a[156:159]
v_mfma_f32_16x16x32_bf16 a[156:159], v[92:95], v[52:55], a[156:159]
s_waitcnt lgkmcnt(2)
v_mfma_f32_16x16x32_bf16 a[160:163], v[64:67], v[56:59], a[160:163]
ds_read_b128 v[48:51], v2 offset:8192
v_mfma_f32_16x16x32_bf16 a[160:163], v[68:71], v[60:63], a[160:163]
ds_read_b128 v[52:55], v3 offset:8192
v_mfma_f32_16x16x32_bf16 a[164:167], v[72:75], v[56:59], a[164:167]
s_waitcnt vmcnt(30)
s_mov_b64 vcc, s[94:95]
v_cndmask_b32_dpp v18, v170, v168, vcc quad_perm:[1,0,3,2] row_mask:0xf bank_mask:0xf
v_cndmask_b32_dpp v19, v171, v169, vcc quad_perm:[1,0,3,2] row_mask:0xf bank_mask:0xf
v_mfma_f32_16x16x32_bf16 a[164:167], v[76:79], v[60:63], a[164:167]
s_not_b64 vcc, s[94:95]
v_cndmask_b32_dpp v170, v168, v170, vcc quad_perm:[1,0,3,2] row_mask:0xf bank_mask:0xf
v_cndmask_b32_dpp v171, v169, v171, vcc quad_perm:[1,0,3,2] row_mask:0xf bank_mask:0xf
v_mfma_f32_16x16x32_bf16 a[168:171], v[80:83], v[56:59], a[168:171]
v_perm_b32 v98, v170, v18, s100
v_perm_b32 v106, v170, v18, s101
v_mfma_f32_16x16x32_bf16 a[168:171], v[84:87], v[60:63], a[168:171]
v_perm_b32 v114, v171, v19, s100
v_perm_b32 v122, v171, v19, s101
v_mfma_f32_16x16x32_bf16 a[172:175], v[88:91], v[56:59], a[172:175]
v_mfma_f32_16x16x32_bf16 a[172:175], v[92:95], v[60:63], a[172:175]
s_waitcnt lgkmcnt(2)
v_mfma_f32_16x16x32_bf16 a[176:179], v[64:67], v[40:43], a[176:179]
ds_read_b128 v[56:59], v2 offset:10240
v_mfma_f32_16x16x32_bf16 a[176:179], v[68:71], v[44:47], a[176:179]
ds_read_b128 v[60:63], v3 offset:10240
v_mfma_f32_16x16x32_bf16 a[180:183], v[72:75], v[40:43], a[180:183]
s_waitcnt vmcnt(29)
s_mov_b64 vcc, s[94:95]
v_cndmask_b32_dpp v18, v174, v172, vcc quad_perm:[1,0,3,2] row_mask:0xf bank_mask:0xf
v_cndmask_b32_dpp v19, v175, v173, vcc quad_perm:[1,0,3,2] row_mask:0xf bank_mask:0xf
v_mfma_f32_16x16x32_bf16 a[180:183], v[76:79], v[44:47], a[180:183]
s_not_b64 vcc, s[94:95]
v_cndmask_b32_dpp v174, v172, v174, vcc quad_perm:[1,0,3,2] row_mask:0xf bank_mask:0xf
v_cndmask_b32_dpp v175, v173, v175, vcc quad_perm:[1,0,3,2] row_mask:0xf bank_mask:0xf
v_mfma_f32_16x16x32_bf16 a[184:187], v[80:83], v[40:43], a[184:187]
v_perm_b32 v99, v174, v18, s100
v_perm_b32 v107, v174, v18, s101
v_mfma_f32_16x16x32_bf16 a[184:187], v[84:87], v[44:47], a[184:187]
v_perm_b32 v115, v175, v19, s100
v_perm_b32 v123, v175, v19, s101
v_mfma_f32_16x16x32_bf16 a[188:191], v[88:91], v[40:43], a[188:191]
v_mfma_f32_16x16x32_bf16 a[188:191], v[92:95], v[44:47], a[188:191]
s_waitcnt lgkmcnt(2)
v_mfma_f32_16x16x32_bf16 a[192:195], v[64:67], v[48:51], a[192:195]
ds_read_b128 v[40:43], v2 offset:12288
v_mfma_f32_16x16x32_bf16 a[192:195], v[68:71], v[52:55], a[192:195]
ds_read_b128 v[44:47], v3 offset:12288
v_mfma_f32_16x16x32_bf16 a[196:199], v[72:75], v[48:51], a[196:199]
s_waitcnt vmcnt(28)
s_mov_b64 vcc, s[94:95]
v_cndmask_b32_dpp v18, v178, v176, vcc quad_perm:[1,0,3,2] row_mask:0xf bank_mask:0xf
v_cndmask_b32_dpp v19, v179, v177, vcc quad_perm:[1,0,3,2] row_mask:0xf bank_mask:0xf
v_mfma_f32_16x16x32_bf16 a[196:199], v[76:79], v[52:55], a[196:199]
s_not_b64 vcc, s[94:95]
v_cndmask_b32_dpp v178, v176, v178, vcc quad_perm:[1,0,3,2] row_mask:0xf bank_mask:0xf
v_cndmask_b32_dpp v179, v177, v179, vcc quad_perm:[1,0,3,2] row_mask:0xf bank_mask:0xf
v_mfma_f32_16x16x32_bf16 a[200:203], v[80:83], v[48:51], a[200:203]
v_perm_b32 v100, v178, v18, s100
v_perm_b32 v108, v178, v18, s101
v_mfma_f32_16x16x32_bf16 a[200:203], v[84:87], v[52:55], a[200:203]
v_perm_b32 v116, v179, v19, s100
v_perm_b32 v124, v179, v19, s101
v_mfma_f32_16x16x32_bf16 a[204:207], v[88:91], v[48:51], a[204:207]
v_mfma_f32_16x16x32_bf16 a[204:207], v[92:95], v[52:55], a[204:207]
s_waitcnt lgkmcnt(2)
v_mfma_f32_16x16x32_bf16 a[208:211], v[64:67], v[56:59], a[208:211]
ds_read_b128 v[48:51], v2 offset:14336
v_mfma_f32_16x16x32_bf16 a[208:211], v[68:71], v[60:63], a[208:211]
ds_read_b128 v[52:55], v3 offset:14336
v_mfma_f32_16x16x32_bf16 a[212:215], v[72:75], v[56:59], a[212:215]
s_waitcnt vmcnt(27)
s_mov_b64 vcc, s[94:95]
v_cndmask_b32_dpp v18, v182, v180, vcc quad_perm:[1,0,3,2] row_mask:0xf bank_mask:0xf
v_cndmask_b32_dpp v19, v183, v181, vcc quad_perm:[1,0,3,2] row_mask:0xf bank_mask:0xf
v_mfma_f32_16x16x32_bf16 a[212:215], v[76:79], v[60:63], a[212:215]
s_not_b64 vcc, s[94:95]
v_cndmask_b32_dpp v182, v180, v182, vcc quad_perm:[1,0,3,2] row_mask:0xf bank_mask:0xf
v_cndmask_b32_dpp v183, v181, v183, vcc quad_perm:[1,0,3,2] row_mask:0xf bank_mask:0xf
v_mfma_f32_16x16x32_bf16 a[216:219], v[80:83], v[56:59], a[216:219]
v_perm_b32 v101, v182, v18, s100
v_perm_b32 v109, v182, v18, s101
v_mfma_f32_16x16x32_bf16 a[216:219], v[84:87], v[60:63], a[216:219]
v_perm_b32 v117, v183, v19, s100
v_perm_b32 v125, v183, v19, s101
v_mfma_f32_16x16x32_bf16 a[220:223], v[88:91], v[56:59], a[220:223]
v_mfma_f32_16x16x32_bf16 a[220:223], v[92:95], v[60:63], a[220:223]
s_waitcnt lgkmcnt(2)
v_mfma_f32_16x16x32_bf16 a[224:227], v[64:67], v[40:43], a[224:227]
ds_read_b128 v[56:59], v2 offset:16384
v_mfma_f32_16x16x32_bf16 a[224:227], v[68:71], v[44:47], a[224:227]
ds_read_b128 v[60:63], v3 offset:16384
v_mfma_f32_16x16x32_bf16 a[228:231], v[72:75], v[40:43], a[228:231]
s_waitcnt vmcnt(26)
s_mov_b64 vcc, s[94:95]
v_cndmask_b32_dpp v18, v186, v184, vcc quad_perm:[1,0,3,2] row_mask:0xf bank_mask:0xf
v_cndmask_b32_dpp v19, v187, v185, vcc quad_perm:[1,0,3,2] row_mask:0xf bank_mask:0xf
v_mfma_f32_16x16x32_bf16 a[228:231], v[76:79], v[44:47], a[228:231]
s_not_b64 vcc, s[94:95]
v_cndmask_b32_dpp v186, v184, v186, vcc quad_perm:[1,0,3,2] row_mask:0xf bank_mask:0xf
v_cndmask_b32_dpp v187, v185, v187, vcc quad_perm:[1,0,3,2] row_mask:0xf bank_mask:0xf
v_mfma_f32_16x16x32_bf16 a[232:235], v[80:83], v[40:43], a[232:235]
v_perm_b32 v102, v186, v18, s100
v_perm_b32 v110, v186, v18, s101
v_mfma_f32_16x16x32_bf16 a[232:235], v[84:87], v[44:47], a[232:235]
v_perm_b32 v118, v187, v19, s100
v_perm_b32 v126, v187, v19, s101
v_mfma_f32_16x16x32_bf16 a[236:239], v[88:91], v[40:43], a[236:239]
s_waitcnt vmcnt(25)
s_mov_b64 vcc, s[94:95]
v_cndmask_b32_dpp v18, v190, v188, vcc quad_perm:[1,0,3,2] row_mask:0xf bank_mask:0xf
v_cndmask_b32_dpp v19, v191, v189, vcc quad_perm:[1,0,3,2] row_mask:0xf bank_mask:0xf
v_mfma_f32_16x16x32_bf16 a[236:239], v[92:95], v[44:47], a[236:239]
s_not_b64 vcc, s[94:95]
v_cndmask_b32_dpp v190, v188, v190, vcc quad_perm:[1,0,3,2] row_mask:0xf bank_mask:0xf
v_cndmask_b32_dpp v191, v189, v191, vcc quad_perm:[1,0,3,2] row_mask:0xf bank_mask:0xf
s_waitcnt lgkmcnt(2)
v_mfma_f32_16x16x32_bf16 a[240:243], v[64:67], v[48:51], a[240:243]
ds_read_b128 v[40:43], v2 offset:18432
v_perm_b32 v103, v190, v18, s100
v_perm_b32 v111, v190, v18, s101
v_mfma_f32_16x16x32_bf16 a[240:243], v[68:71], v[52:55], a[240:243]
ds_read_b128 v[44:47], v3 offset:18432
v_perm_b32 v119, v191, v19, s100
v_perm_b32 v127, v191, v19, s101
v_mfma_f32_16x16x32_bf16 a[244:247], v[72:75], v[48:51], a[244:247]
v_mfma_f32_16x16x32_bf16 a[244:247], v[76:79], v[52:55], a[244:247]
v_mfma_f32_16x16x32_bf16 a[248:251], v[80:83], v[48:51], a[248:251]
v_mfma_f32_16x16x32_bf16 a[248:251], v[84:87], v[52:55], a[248:251]
v_mfma_f32_16x16x32_bf16 a[252:255], v[88:91], v[48:51], a[252:255]
v_mfma_f32_16x16x32_bf16 a[252:255], v[92:95], v[52:55], a[252:255]
s_waitcnt lgkmcnt(2)
v_mfma_f32_16x16x32_bf16 a[128:131], v[96:99], v[56:59], a[128:131]
ds_read_b128 v[48:51], v2 offset:20480
v_mfma_f32_16x16x32_bf16 a[128:131], v[100:103], v[60:63], a[128:131]
ds_read_b128 v[52:55], v3 offset:20480
v_mfma_f32_16x16x32_bf16 a[132:135], v[104:107], v[56:59], a[132:135]
s_waitcnt vmcnt(23)
s_mov_b64 vcc, s[94:95]
v_cndmask_b32_dpp v18, v194, v192, vcc quad_perm:[1,0,3,2] row_mask:0xf bank_mask:0xf
v_cndmask_b32_dpp v19, v195, v193, vcc quad_perm:[1,0,3,2] row_mask:0xf bank_mask:0xf
s_waitcnt vmcnt(4)
v_cmp_gt_u32 vcc, 128, v12
s_cbranch_vccz L_pok0
s_mov_b32 s4, 0x40000
L_psp0:
s_sleep 2
buffer_load_dword v12, v16, s[80:83], 0 offen sc1
s_sub_u32 s4, s4, 1
s_cbranch_scc1 L_pok0
s_waitcnt vmcnt(0)
v_cmp_gt_u32 vcc, 128, v12
s_cbranch_vccnz L_psp0
L_pok0:
v_mfma_f32_16x16x32_bf16 a[132:135], v[108:111], v[60:63], a[132:135]
s_not_b64 vcc, s[94:95]
v_cndmask_b32_dpp v194, v192, v194, vcc quad_perm:[1,0,3,2] row_mask:0xf bank_mask:0xf
v_cndmask_b32_dpp v195, v193, v195, vcc quad_perm:[1,0,3,2] row_mask:0xf bank_mask:0xf
v_lshlrev_b32 v20, 2, v1
s_add_u32 s5, s43, 0x80000
buffer_load_dword v21, v20, s[12:15], s5 offen sc1
v_mfma_f32_16x16x32_bf16 a[136:139], v[112:115], v[56:59], a[136:139]
v_perm_b32 v64, v194, v18, s100
v_perm_b32 v72, v194, v18, s101
s_add_u32 m0, s3, 0xc000
v_mfma_f32_16x16x32_bf16 a[136:139], v[116:119], v[60:63], a[136:139]
v_perm_b32 v80, v195, v19, s100
v_perm_b32 v88, v195, v19, s101
buffer_load_dwordx4 v8, s[8:11], s35 offen nt lds
s_add_u32 s35, s35, 0x10000
v_mfma_f32_16x16x32_bf16 a[140:143], v[120:123], v[56:59], a[140:143]
s_add_u32 m0, s3, 0xd000
v_mfma_f32_16x16x32_bf16 a[140:143], v[124:127], v[60:63], a[140:143]
buffer_load_dwordx4 v8, s[8:11], s35 offen nt lds
s_add_u32 s35, s35, 0x10000
s_waitcnt lgkmcnt(2)
v_mfma_f32_16x16x32_bf16 a[144:147], v[96:99], v[40:43], a[144:147]
ds_read_b128 v[56:59], v2 offset:22528
s_add_u32 m0, s3, 0xe000
v_mfma_f32_16x16x32_bf16 a[144:147], v[100:103], v[44:47], a[144:147]
ds_read_b128 v[60:63], v3 offset:22528
buffer_load_dwordx4 v8, s[8:11], s35 offen nt lds
s_add_u32 s35, s35, 0x10000
v_mfma_f32_16x16x32_bf16 a[148:151], v[104:107], v[40:43], a[148:151]
s_mov_b64 vcc, s[94:95]
v_cndmask_b32_dpp v18, v198, v196, vcc quad_perm:[1,0,3,2] row_mask:0xf bank_mask:0xf
v_cndmask_b32_dpp v19, v199, v197, vcc quad_perm:[1,0,3,2] row_mask:0xf bank_mask:0xf
s_add_u32 m0, s3, 0xf000
v_mfma_f32_16x16x32_bf16 a[148:151], v[108:111], v[44:47], a[148:151]
s_not_b64 vcc, s[94:95]
v_cndmask_b32_dpp v198, v196, v198, vcc quad_perm:[1,0,3,2] row_mask:0xf bank_mask:0xf
v_cndmask_b32_dpp v199, v197, v199, vcc quad_perm:[1,0,3,2] row_mask:0xf bank_mask:0xf
buffer_load_dwordx4 v8, s[8:11], s35 offen nt lds
v_mfma_f32_16x16x32_bf16 a[152:155], v[112:115], v[40:43], a[152:155]
v_perm_b32 v65, v198, v18, s100
v_perm_b32 v73, v198, v18, s101
v_mfma_f32_16x16x32_bf16 a[152:155], v[116:119], v[44:47], a[152:155]
v_perm_b32 v81, v199, v19, s100
v_perm_b32 v89, v199, v19, s101
v_mfma_f32_16x16x32_bf16 a[156:159], v[120:123], v[40:43], a[156:159]
v_mfma_f32_16x16x32_bf16 a[156:159], v[124:127], v[44:47], a[156:159]
s_waitcnt lgkmcnt(2)
v_mfma_f32_16x16x32_bf16 a[160:163], v[96:99], v[48:51], a[160:163]
ds_read_b128 v[40:43], v2 offset:24576
v_mfma_f32_16x16x32_bf16 a[160:163], v[100:103], v[52:55], a[160:163]
ds_read_b128 v[44:47], v3 offset:24576
v_mfma_f32_16x16x32_bf16 a[164:167], v[104:107], v[48:51], a[164:167]
s_mov_b64 vcc, s[94:95]
v_cndmask_b32_dpp v18, v202, v200, vcc quad_perm:[1,0,3,2] row_mask:0xf bank_mask:0xf
v_cndmask_b32_dpp v19, v203, v201, vcc quad_perm:[1,0,3,2] row_mask:0xf bank_mask:0xf
v_mfma_f32_16x16x32_bf16 a[164:167], v[108:111], v[52:55], a[164:167]
s_not_b64 vcc, s[94:95]
v_cndmask_b32_dpp v202, v200, v202, vcc quad_perm:[1,0,3,2] row_mask:0xf bank_mask:0xf
v_cndmask_b32_dpp v203, v201, v203, vcc quad_perm:[1,0,3,2] row_mask:0xf bank_mask:0xf
v_mfma_f32_16x16x32_bf16 a[168:171], v[112:115], v[48:51], a[168:171]
v_perm_b32 v66, v202, v18, s100
v_perm_b32 v74, v202, v18, s101
v_mfma_f32_16x16x32_bf16 a[168:171], v[116:119], v[52:55], a[168:171]
v_perm_b32 v82, v203, v19, s100
v_perm_b32 v90, v203, v19, s101
v_mfma_f32_16x16x32_bf16 a[172:175], v[120:123], v[48:51], a[172:175]
v_mfma_f32_16x16x32_bf16 a[172:175], v[124:127], v[52:55], a[172:175]
s_waitcnt lgkmcnt(2)
v_mfma_f32_16x16x32_bf16 a[176:179], v[96:99], v[56:59], a[176:179]
ds_read_b128 v[48:51], v2 offset:26624
v_mfma_f32_16x16x32_bf16 a[176:179], v[100:103], v[60:63], a[176:179]
ds_read_b128 v[52:55], v3 offset:26624
v_mfma_f32_16x16x32_bf16 a[180:183], v[104:107], v[56:59], a[180:183]
s_mov_b64 vcc, s[94:95]
v_cndmask_b32_dpp v18, v206, v204, vcc quad_perm:[1,0,3,2] row_mask:0xf bank_mask:0xf
v_cndmask_b32_dpp v19, v207, v205, vcc quad_perm:[1,0,3,2] row_mask:0xf bank_mask:0xf
v_mfma_f32_16x16x32_bf16 a[180:183], v[108:111], v[60:63], a[180:183]
s_not_b64 vcc, s[94:95]
v_cndmask_b32_dpp v206, v204, v206, vcc quad_perm:[1,0,3,2] row_mask:0xf bank_mask:0xf
v_cndmask_b32_dpp v207, v205, v207, vcc quad_perm:[1,0,3,2] row_mask:0xf bank_mask:0xf
v_mfma_f32_16x16x32_bf16 a[184:187], v[112:115], v[56:59], a[184:187]
v_perm_b32 v67, v206, v18, s100
v_perm_b32 v75, v206, v18, s101
v_mfma_f32_16x16x32_bf16 a[184:187], v[116:119], v[60:63], a[184:187]
v_perm_b32 v83, v207, v19, s100
v_perm_b32 v91, v207, v19, s101
v_mfma_f32_16x16x32_bf16 a[188:191], v[120:123], v[56:59], a[188:191]
v_mfma_f32_16x16x32_bf16 a[188:191], v[124:127], v[60:63], a[188:191]
s_waitcnt lgkmcnt(2)
v_mfma_f32_16x16x32_bf16 a[192:195], v[96:99], v[40:43], a[192:195]
ds_read_b128 v[56:59], v2 offset:28672
v_mfma_f32_16x16x32_bf16 a[192:195], v[100:103], v[44:47], a[192:195]
ds_read_b128 v[60:63], v3 offset:28672
v_mfma_f32_16x16x32_bf16 a[196:199], v[104:107], v[40:43], a[196:199]
s_mov_b64 vcc, s[94:95]
v_cndmask_b32_dpp v18, v210, v208, vcc quad_perm:[1,0,3,2] row_mask:0xf bank_mask:0xf
v_cndmask_b32_dpp v19, v211, v209, vcc quad_perm:[1,0,3,2] row_mask:0xf bank_mask:0xf
v_mfma_f32_16x16x32_bf16 a[196:199], v[108:111], v[44:47], a[196:199]
s_not_b64 vcc, s[94:95]
v_cndmask_b32_dpp v210, v208, v210, vcc quad_perm:[1,0,3,2] row_mask:0xf bank_mask:0xf
v_cndmask_b32_dpp v211, v209, v211, vcc quad_perm:[1,0,3,2] row_mask:0xf bank_mask:0xf
v_mfma_f32_16x16x32_bf16 a[200:203], v[112:115], v[40:43], a[200:203]
v_perm_b32 v68, v210, v18, s100
v_perm_b32 v76, v210, v18, s101
v_mfma_f32_16x16x32_bf16 a[200:203], v[116:119], v[44:47], a[200:203]
v_perm_b32 v84, v211, v19, s100
v_perm_b32 v92, v211, v19, s101
v_mfma_f32_16x16x32_bf16 a[204:207], v[120:123], v[40:43], a[204:207]
v_mfma_f32_16x16x32_bf16 a[204:207], v[124:127], v[44:47], a[204:207]
s_waitcnt lgkmcnt(2)
v_mfma_f32_16x16x32_bf16 a[208:211], v[96:99], v[48:51], a[208:211]
ds_read_b128 v[40:43], v2 offset:30720
v_mfma_f32_16x16x32_bf16 a[208:211], v[100:103], v[52:55], a[208:211]
ds_read_b128 v[44:47], v3 offset:30720
v_mfma_f32_16x16x32_bf16 a[212:215], v[104:107], v[48:51], a[212:215]
s_mov_b64 vcc, s[94:95]
v_cndmask_b32_dpp v18, v214, v212, vcc quad_perm:[1,0,3,2] row_mask:0xf bank_mask:0xf
v_cndmask_b32_dpp v19, v215, v213, vcc quad_perm:[1,0,3,2] row_mask:0xf bank_mask:0xf
v_mfma_f32_16x16x32_bf16 a[212:215], v[108:111], v[52:55], a[212:215]
s_not_b64 vcc, s[94:95]
v_cndmask_b32_dpp v214, v212, v214, vcc quad_perm:[1,0,3,2] row_mask:0xf bank_mask:0xf
v_cndmask_b32_dpp v215, v213, v215, vcc quad_perm:[1,0,3,2] row_mask:0xf bank_mask:0xf
v_mfma_f32_16x16x32_bf16 a[216:219], v[112:115], v[48:51], a[216:219]
v_perm_b32 v69, v214, v18, s100
v_perm_b32 v77, v214, v18, s101
v_mfma_f32_16x16x32_bf16 a[216:219], v[116:119], v[52:55], a[216:219]
v_perm_b32 v85, v215, v19, s100
v_perm_b32 v93, v215, v19, s101
v_mfma_f32_16x16x32_bf16 a[220:223], v[120:123], v[48:51], a[220:223]
v_mfma_f32_16x16x32_bf16 a[220:223], v[124:127], v[52:55], a[220:223]
s_waitcnt lgkmcnt(2)
v_mfma_f32_16x16x32_bf16 a[224:227], v[96:99], v[56:59], a[224:227]
ds_read_b128 v[48:51], v2 offset:32768
v_mfma_f32_16x16x32_bf16 a[224:227], v[100:103], v[60:63], a[224:227]
ds_read_b128 v[52:55], v3 offset:32768
v_mfma_f32_16x16x32_bf16 a[228:231], v[104:107], v[56:59], a[228:231]
s_mov_b64 vcc, s[94:95]
v_cndmask_b32_dpp v18, v218, v216, vcc quad_perm:[1,0,3,2] row_mask:0xf bank_mask:0xf
v_cndmask_b32_dpp v19, v219, v217, vcc quad_perm:[1,0,3,2] row_mask:0xf bank_mask:0xf
v_mfma_f32_16x16x32_bf16 a[228:231], v[108:111], v[60:63], a[228:231]
s_not_b64 vcc, s[94:95]
v_cndmask_b32_dpp v218, v216, v218, vcc quad_perm:[1,0,3,2] row_mask:0xf bank_mask:0xf
v_cndmask_b32_dpp v219, v217, v219, vcc quad_perm:[1,0,3,2] row_mask:0xf bank_mask:0xf
v_mfma_f32_16x16x32_bf16 a[232:235], v[112:115], v[56:59], a[232:235]
v_perm_b32 v70, v218, v18, s100
v_perm_b32 v78, v218, v18, s101
v_mfma_f32_16x16x32_bf16 a[232:235], v[116:119], v[60:63], a[232:235]
v_perm_b32 v86, v219, v19, s100
v_perm_b32 v94, v219, v19, s101
v_mfma_f32_16x16x32_bf16 a[236:239], v[120:123], v[56:59], a[236:239]
s_mov_b64 vcc, s[94:95]
v_cndmask_b32_dpp v18, v222, v220, vcc quad_perm:[1,0,3,2] row_mask:0xf bank_mask:0xf
v_cndmask_b32_dpp v19, v223, v221, vcc quad_perm:[1,0,3,2] row_mask:0xf bank_mask:0xf
v_mfma_f32_16x16x32_bf16 a[236:239], v[124:127], v[60:63], a[236:239]
s_not_b64 vcc, s[94:95]
v_cndmask_b32_dpp v222, v220, v222, vcc quad_perm:[1,0,3,2] row_mask:0xf bank_mask:0xf
v_cndmask_b32_dpp v223, v221, v223, vcc quad_perm:[1,0,3,2] row_mask:0xf bank_mask:0xf
s_waitcnt lgkmcnt(2)
v_mfma_f32_16x16x32_bf16 a[240:243], v[96:99], v[40:43], a[240:243]
ds_read_b128 v[56:59], v2 offset:34816
v_perm_b32 v71, v222, v18, s100
v_perm_b32 v79, v222, v18, s101
v_mfma_f32_16x16x32_bf16 a[240:243], v[100:103], v[44:47], a[240:243]
ds_read_b128 v[60:63], v3 offset:34816
v_perm_b32 v87, v223, v19, s100
v_perm_b32 v95, v223, v19, s101
v_mfma_f32_16x16x32_bf16 a[244:247], v[104:107], v[40:43], a[244:247]
v_mfma_f32_16x16x32_bf16 a[244:247], v[108:111], v[44:47], a[244:247]
v_mfma_f32_16x16x32_bf16 a[248:251], v[112:115], v[40:43], a[248:251]
v_mfma_f32_16x16x32_bf16 a[248:251], v[116:119], v[44:47], a[248:251]
v_mfma_f32_16x16x32_bf16 a[252:255], v[120:123], v[40:43], a[252:255]
v_mfma_f32_16x16x32_bf16 a[252:255], v[124:127], v[44:47], a[252:255]
s_waitcnt lgkmcnt(2)
v_mfma_f32_16x16x32_bf16 a[128:131], v[64:67], v[48:51], a[128:131]
ds_read_b128 v[40:43], v2 offset:36864
v_mfma_f32_16x16x32_bf16 a[128:131], v[68:71], v[52:55], a[128:131]
ds_read_b128 v[44:47], v3 offset:36864
v_mfma_f32_16x16x32_bf16 a[132:135], v[72:75], v[48:51], a[132:135]
s_mov_b64 vcc, s[94:95]
v_cndmask_b32_dpp v18, v130, v128, vcc quad_perm:[1,0,3,2] row_mask:0xf bank_mask:0xf
v_cndmask_b32_dpp v19, v131, v129, vcc quad_perm:[1,0,3,2] row_mask:0xf bank_mask:0xf
v_mfma_f32_16x16x32_bf16 a[132:135], v[76:79], v[52:55], a[132:135]
s_not_b64 vcc, s[94:95]
v_cndmask_b32_dpp v130, v128, v130, vcc quad_perm:[1,0,3,2] row_mask:0xf bank_mask:0xf
v_cndmask_b32_dpp v131, v129, v131, vcc quad_perm:[1,0,3,2] row_mask:0xf bank_mask:0xf
v_lshlrev_b32 v20, 2, v1
s_add_u32 s5, s43, 0x100000
buffer_load_dword v21, v20, s[12:15], s5 offen sc1
v_mfma_f32_16x16x32_bf16 a[136:139], v[80:83], v[48:51], a[136:139]
v_perm_b32 v96, v130, v18, s100
v_perm_b32 v104, v130, v18, s101
v_mfma_f32_16x16x32_bf16 a[136:139], v[84:87], v[52:55], a[136:139]
v_perm_b32 v112, v131, v19, s100
v_perm_b32 v120, v131, v19, s101
v_mfma_f32_16x16x32_bf16 a[140:143], v[88:91], v[48:51], a[140:143]
v_mfma_f32_16x16x32_bf16 a[140:143], v[92:95], v[52:55], a[140:143]
s_waitcnt lgkmcnt(2)
v_mfma_f32_16x16x32_bf16 a[144:147], v[64:67], v[56:59], a[144:147]
ds_read_b128 v[48:51], v2 offset:38912
v_mfma_f32_16x16x32_bf16 a[144:147], v[68:71], v[60:63], a[144:147]
ds_read_b128 v[52:55], v3 offset:38912
v_mfma_f32_16x16x32_bf16 a[148:151], v[72:75], v[56:59], a[148:151]
s_mov_b64 vcc, s[94:95]
v_cndmask_b32_dpp v18, v134, v132, vcc quad_perm:[1,0,3,2] row_mask:0xf bank_mask:0xf
v_cndmask_b32_dpp v19, v135, v133, vcc quad_perm:[1,0,3,2] row_mask:0xf bank_mask:0xf
v_mfma_f32_16x16x32_bf16 a[148:151], v[76:79], v[60:63], a[148:151]
s_not_b64 vcc, s[94:95]
v_cndmask_b32_dpp v134, v132, v134, vcc quad_perm:[1,0,3,2] row_mask:0xf bank_mask:0xf
v_cndmask_b32_dpp v135, v133, v135, vcc quad_perm:[1,0,3,2] row_mask:0xf bank_mask:0xf
v_mfma_f32_16x16x32_bf16 a[152:155], v[80:83], v[56:59], a[152:155]
v_perm_b32 v97, v134, v18, s100
v_perm_b32 v105, v134, v18, s101
v_mfma_f32_16x16x32_bf16 a[152:155], v[84:87], v[60:63], a[152:155]
v_perm_b32 v113, v135, v19, s100
v_perm_b32 v121, v135, v19, s101
v_mfma_f32_16x16x32_bf16 a[156:159], v[88:91], v[56:59], a[156:159]
v_mfma_f32_16x16x32_bf16 a[156:159], v[92:95], v[60:63], a[156:159]
s_waitcnt lgkmcnt(2)
v_mfma_f32_16x16x32_bf16 a[160:163], v[64:67], v[40:43], a[160:163]
ds_read_b128 v[56:59], v2 offset:40960
v_mfma_f32_16x16x32_bf16 a[160:163], v[68:71], v[44:47], a[160:163]
ds_read_b128 v[60:63], v3 offset:40960
v_mfma_f32_16x16x32_bf16 a[164:167], v[72:75], v[40:43], a[164:167]
s_mov_b64 vcc, s[94:95]
v_cndmask_b32_dpp v18, v138, v136, vcc quad_perm:[1,0,3,2] row_mask:0xf bank_mask:0xf
v_cndmask_b32_dpp v19, v139, v137, vcc quad_perm:[1,0,3,2] row_mask:0xf bank_mask:0xf
v_mfma_f32_16x16x32_bf16 a[164:167], v[76:79], v[44:47], a[164:167]
s_not_b64 vcc, s[94:95]
v_cndmask_b32_dpp v138, v136, v138, vcc quad_perm:[1,0,3,2] row_mask:0xf bank_mask:0xf
v_cndmask_b32_dpp v139, v137, v139, vcc quad_perm:[1,0,3,2] row_mask:0xf bank_mask:0xf
v_mfma_f32_16x16x32_bf16 a[168:171], v[80:83], v[40:43], a[168:171]
v_perm_b32 v98, v138, v18, s100
v_perm_b32 v106, v138, v18, s101
v_mfma_f32_16x16x32_bf16 a[168:171], v[84:87], v[44:47], a[168:171]
v_perm_b32 v114, v139, v19, s100
v_perm_b32 v122, v139, v19, s101
v_mfma_f32_16x16x32_bf16 a[172:175], v[88:91], v[40:43], a[172:175]
v_mfma_f32_16x16x32_bf16 a[172:175], v[92:95], v[44:47], a[172:175]
s_waitcnt lgkmcnt(2)
v_mfma_f32_16x16x32_bf16 a[176:179], v[64:67], v[48:51], a[176:179]
ds_read_b128 v[40:43], v2 offset:43008
v_mfma_f32_16x16x32_bf16 a[176:179], v[68:71], v[52:55], a[176:179]
ds_read_b128 v[44:47], v3 offset:43008
v_mfma_f32_16x16x32_bf16 a[180:183], v[72:75], v[48:51], a[180:183]
s_mov_b64 vcc, s[94:95]
v_cndmask_b32_dpp v18, v142, v140, vcc quad_perm:[1,0,3,2] row_mask:0xf bank_mask:0xf
v_cndmask_b32_dpp v19, v143, v141, vcc quad_perm:[1,0,3,2] row_mask:0xf bank_mask:0xf
v_mfma_f32_16x16x32_bf16 a[180:183], v[76:79], v[52:55], a[180:183]
s_not_b64 vcc, s[94:95]
v_cndmask_b32_dpp v142, v140, v142, vcc quad_perm:[1,0,3,2] row_mask:0xf bank_mask:0xf
v_cndmask_b32_dpp v143, v141, v143, vcc quad_perm:[1,0,3,2] row_mask:0xf bank_mask:0xf
v_mfma_f32_16x16x32_bf16 a[184:187], v[80:83], v[48:51], a[184:187]
v_perm_b32 v99, v142, v18, s100
v_perm_b32 v107, v142, v18, s101
v_mfma_f32_16x16x32_bf16 a[184:187], v[84:87], v[52:55], a[184:187]
v_perm_b32 v115, v143, v19, s100
v_perm_b32 v123, v143, v19, s101
v_mfma_f32_16x16x32_bf16 a[188:191], v[88:91], v[48:51], a[188:191]
v_mfma_f32_16x16x32_bf16 a[188:191], v[92:95], v[52:55], a[188:191]
s_waitcnt lgkmcnt(2)
v_mfma_f32_16x16x32_bf16 a[192:195], v[64:67], v[56:59], a[192:195]
ds_read_b128 v[48:51], v2 offset:45056
v_mfma_f32_16x16x32_bf16 a[192:195], v[68:71], v[60:63], a[192:195]
ds_read_b128 v[52:55], v3 offset:45056
v_mfma_f32_16x16x32_bf16 a[196:199], v[72:75], v[56:59], a[196:199]
s_mov_b64 vcc, s[94:95]
v_cndmask_b32_dpp v18, v146, v144, vcc quad_perm:[1,0,3,2] row_mask:0xf bank_mask:0xf
v_cndmask_b32_dpp v19, v147, v145, vcc quad_perm:[1,0,3,2] row_mask:0xf bank_mask:0xf
v_mfma_f32_16x16x32_bf16 a[196:199], v[76:79], v[60:63], a[196:199]
s_not_b64 vcc, s[94:95]
v_cndmask_b32_dpp v146, v144, v146, vcc quad_perm:[1,0,3,2] row_mask:0xf bank_mask:0xf
v_cndmask_b32_dpp v147, v145, v147, vcc quad_perm:[1,0,3,2] row_mask:0xf bank_mask:0xf
v_mfma_f32_16x16x32_bf16 a[200:203], v[80:83], v[56:59], a[200:203]
v_perm_b32 v100, v146, v18, s100
v_perm_b32 v108, v146, v18, s101
v_mfma_f32_16x16x32_bf16 a[200:203], v[84:87], v[60:63], a[200:203]
v_perm_b32 v116, v147, v19, s100
v_perm_b32 v124, v147, v19, s101
v_mfma_f32_16x16x32_bf16 a[204:207], v[88:91], v[56:59], a[204:207]
v_mfma_f32_16x16x32_bf16 a[204:207], v[92:95], v[60:63], a[204:207]
s_waitcnt lgkmcnt(2)
v_mfma_f32_16x16x32_bf16 a[208:211], v[64:67], v[40:43], a[208:211]
ds_read_b128 v[56:59], v2 offset:47104
v_mfma_f32_16x16x32_bf16 a[208:211], v[68:71], v[44:47], a[208:211]
ds_read_b128 v[60:63], v3 offset:47104
v_mfma_f32_16x16x32_bf16 a[212:215], v[72:75], v[40:43], a[212:215]
s_mov_b64 vcc, s[94:95]
v_cndmask_b32_dpp v18, v150, v148, vcc quad_perm:[1,0,3,2] row_mask:0xf bank_mask:0xf
v_cndmask_b32_dpp v19, v151, v149, vcc quad_perm:[1,0,3,2] row_mask:0xf bank_mask:0xf
v_mfma_f32_16x16x32_bf16 a[212:215], v[76:79], v[44:47], a[212:215]
s_not_b64 vcc, s[94:95]
v_cndmask_b32_dpp v150, v148, v150, vcc quad_perm:[1,0,3,2] row_mask:0xf bank_mask:0xf
v_cndmask_b32_dpp v151, v149, v151, vcc quad_perm:[1,0,3,2] row_mask:0xf bank_mask:0xf
v_mfma_f32_16x16x32_bf16 a[216:219], v[80:83], v[40:43], a[216:219]
v_perm_b32 v101, v150, v18, s100
v_perm_b32 v109, v150, v18, s101
v_mfma_f32_16x16x32_bf16 a[216:219], v[84:87], v[44:47], a[216:219]
v_perm_b32 v117, v151, v19, s100
v_perm_b32 v125, v151, v19, s101
v_mfma_f32_16x16x32_bf16 a[220:223], v[88:91], v[40:43], a[220:223]
v_mfma_f32_16x16x32_bf16 a[220:223], v[92:95], v[44:47], a[220:223]
s_waitcnt lgkmcnt(2)
v_mfma_f32_16x16x32_bf16 a[224:227], v[64:67], v[48:51], a[224:227]
ds_read_b128 v[40:43], v2 offset:49152
v_mfma_f32_16x16x32_bf16 a[224:227], v[68:71], v[52:55], a[224:227]
ds_read_b128 v[44:47], v3 offset:49152
v_mfma_f32_16x16x32_bf16 a[228:231], v[72:75], v[48:51], a[228:231]
s_mov_b64 vcc, s[94:95]
v_cndmask_b32_dpp v18, v154, v152, vcc quad_perm:[1,0,3,2] row_mask:0xf bank_mask:0xf
v_cndmask_b32_dpp v19, v155, v153, vcc quad_perm:[1,0,3,2] row_mask:0xf bank_mask:0xf
v_mfma_f32_16x16x32_bf16 a[228:231], v[76:79], v[52:55], a[228:231]
s_not_b64 vcc, s[94:95]
v_cndmask_b32_dpp v154, v152, v154, vcc quad_perm:[1,0,3,2] row_mask:0xf bank_mask:0xf
v_cndmask_b32_dpp v155, v153, v155, vcc quad_perm:[1,0,3,2] row_mask:0xf bank_mask:0xf
v_mfma_f32_16x16x32_bf16 a[232:235], v[80:83], v[48:51], a[232:235]
v_perm_b32 v102, v154, v18, s100
v_perm_b32 v110, v154, v18, s101
v_mfma_f32_16x16x32_bf16 a[232:235], v[84:87], v[52:55], a[232:235]
v_perm_b32 v118, v155, v19, s100
v_perm_b32 v126, v155, v19, s101
v_mfma_f32_16x16x32_bf16 a[236:239], v[88:91], v[48:51], a[236:239]
s_mov_b64 vcc, s[94:95]
v_cndmask_b32_dpp v18, v158, v156, vcc quad_perm:[1,0,3,2] row_mask:0xf bank_mask:0xf
v_cndmask_b32_dpp v19, v159, v157, vcc quad_perm:[1,0,3,2] row_mask:0xf bank_mask:0xf
v_mfma_f32_16x16x32_bf16 a[236:239], v[92:95], v[52:55], a[236:239]
s_not_b64 vcc, s[94:95]
v_cndmask_b32_dpp v158, v156, v158, vcc quad_perm:[1,0,3,2] row_mask:0xf bank_mask:0xf
v_cndmask_b32_dpp v159, v157, v159, vcc quad_perm:[1,0,3,2] row_mask:0xf bank_mask:0xf
s_waitcnt lgkmcnt(2)
v_mfma_f32_16x16x32_bf16 a[240:243], v[64:67], v[56:59], a[240:243]
ds_read_b128 v[48:51], v2 offset:51200
buffer_load_dwordx4 v[64:67], v1, s[12:15], s33 offen offset:0 sc1
v_perm_b32 v103, v158, v18, s100
v_perm_b32 v111, v158, v18, s101
v_mfma_f32_16x16x32_bf16 a[240:243], v[68:71], v[60:63], a[240:243]
ds_read_b128 v[52:55], v3 offset:51200
v_perm_b32 v119, v159, v19, s100
v_perm_b32 v127, v159, v19, s101
v_mfma_f32_16x16x32_bf16 a[244:247], v[72:75], v[56:59], a[244:247]
v_mfma_f32_16x16x32_bf16 a[244:247], v[76:79], v[60:63], a[244:247]
buffer_load_dwordx4 v[68:71], v1, s[12:15], s33 offen offset:1024 sc1
v_mfma_f32_16x16x32_bf16 a[248:251], v[80:83], v[56:59], a[248:251]
v_mfma_f32_16x16x32_bf16 a[248:251], v[84:87], v[60:63], a[248:251]
v_mfma_f32_16x16x32_bf16 a[252:255], v[88:91], v[56:59], a[252:255]
buffer_load_dwordx4 v[72:75], v1, s[12:15], s33 offen offset:2048 sc1
v_mfma_f32_16x16x32_bf16 a[252:255], v[92:95], v[60:63], a[252:255]
s_waitcnt lgkmcnt(2)
v_mfma_f32_16x16x32_bf16 a[128:131], v[96:99], v[40:43], a[128:131]
ds_read_b128 v[56:59], v2 offset:53248
v_mfma_f32_16x16x32_bf16 a[128:131], v[100:103], v[44:47], a[128:131]
ds_read_b128 v[60:63], v3 offset:53248
buffer_load_dwordx4 v[76:79], v1, s[12:15], s33 offen offset:3072 sc1
v_mfma_f32_16x16x32_bf16 a[132:135], v[104:107], v[40:43], a[132:135]
v_mfma_f32_16x16x32_bf16 a[132:135], v[108:111], v[44:47], a[132:135]
v_mfma_f32_16x16x32_bf16 a[136:139], v[112:115], v[40:43], a[136:139]
buffer_load_dwordx4 v[80:83], v1, s[12:15], s34 offen offset:0 sc1
v_mfma_f32_16x16x32_bf16 a[136:139], v[116:119], v[44:47], a[136:139]
v_mfma_f32_16x16x32_bf16 a[140:143], v[120:123], v[40:43], a[140:143]
v_mfma_f32_16x16x32_bf16 a[140:143], v[124:127], v[44:47], a[140:143]
buffer_load_dwordx4 v[84:87], v1, s[12:15], s34 offen offset:1024 sc1
s_waitcnt lgkmcnt(2)
v_mfma_f32_16x16x32_bf16 a[144:147], v[96:99], v[48:51], a[144:147]
ds_read_b128 v[40:43], v2 offset:55296
v_mfma_f32_16x16x32_bf16 a[144:147], v[100:103], v[52:55], a[144:147]
ds_read_b128 v[44:47], v3 offset:55296
v_mfma_f32_16x16x32_bf16 a[148:151], v[104:107], v[48:51], a[148:151]
buffer_load_dwordx4 v[88:91], v1, s[12:15], s34 offen offset:2048 sc1
v_mfma_f32_16x16x32_bf16 a[148:151], v[108:111], v[52:55], a[148:151]
v_mfma_f32_16x16x32_bf16 a[152:155], v[112:115], v[48:51], a[152:155]
v_mfma_f32_16x16x32_bf16 a[152:155], v[116:119], v[52:55], a[152:155]
buffer_load_dwordx4 v[92:95], v1, s[12:15], s34 offen offset:3072 sc1
s_add_u32 s33, s33, 0x8000
s_add_u32 s34, s34, 0x8000
v_mfma_f32_16x16x32_bf16 a[156:159], v[120:123], v[48:51], a[156:159]
v_mfma_f32_16x16x32_bf16 a[156:159], v[124:127], v[52:55], a[156:159]
s_waitcnt lgkmcnt(2)
v_mfma_f32_16x16x32_bf16 a[160:163], v[96:99], v[56:59], a[160:163]
ds_read_b128 v[48:51], v2 offset:57344
v_mfma_f32_16x16x32_bf16 a[160:163], v[100:103], v[60:63], a[160:163]
ds_read_b128 v[52:55], v3 offset:57344
v_mfma_f32_16x16x32_bf16 a[164:167], v[104:107], v[56:59], a[164:167]
v_mfma_f32_16x16x32_bf16 a[164:167], v[108:111], v[60:63], a[164:167]
v_mfma_f32_16x16x32_bf16 a[168:171], v[112:115], v[56:59], a[168:171]
v_mfma_f32_16x16x32_bf16 a[168:171], v[116:119], v[60:63], a[168:171]
v_mfma_f32_16x16x32_bf16 a[172:175], v[120:123], v[56:59], a[172:175]
v_mfma_f32_16x16x32_bf16 a[172:175], v[124:127], v[60:63], a[172:175]
s_waitcnt lgkmcnt(2)
v_mfma_f32_16x16x32_bf16 a[176:179], v[96:99], v[40:43], a[176:179]
ds_read_b128 v[56:59], v2 offset:59392
v_mfma_f32_16x16x32_bf16 a[176:179], v[100:103], v[44:47], a[176:179]
ds_read_b128 v[60:63], v3 offset:59392
v_mfma_f32_16x16x32_bf16 a[180:183], v[104:107], v[40:43], a[180:183]
v_mfma_f32_16x16x32_bf16 a[180:183], v[108:111], v[44:47], a[180:183]
v_mfma_f32_16x16x32_bf16 a[184:187], v[112:115], v[40:43], a[184:187]
v_mfma_f32_16x16x32_bf16 a[184:187], v[116:119], v[44:47], a[184:187]
v_mfma_f32_16x16x32_bf16 a[188:191], v[120:123], v[40:43], a[188:191]
v_mfma_f32_16x16x32_bf16 a[188:191], v[124:127], v[44:47], a[188:191]
s_waitcnt lgkmcnt(2)
v_mfma_f32_16x16x32_bf16 a[192:195], v[96:99], v[48:51], a[192:195]
ds_read_b128 v[40:43], v2 offset:61440
v_mfma_f32_16x16x32_bf16 a[192:195], v[100:103], v[52:55], a[192:195]
ds_read_b128 v[44:47], v3 offset:61440
buffer_load_dwordx2 v[240:241], v17, s[96:99], s88 offen offset:0 nt
v_mfma_f32_16x16x32_bf16 a[196:199], v[104:107], v[48:51], a[196:199]
v_mfma_f32_16x16x32_bf16 a[196:199], v[108:111], v[52:55], a[196:199]
v_mfma_f32_16x16x32_bf16 a[200:203], v[112:115], v[48:51], a[200:203]
buffer_load_dwordx2 v[242:243], v17, s[96:99], s88 offen offset:2048 nt
s_add_u32 s88, s88, 0x1000
v_mfma_f32_16x16x32_bf16 a[200:203], v[116:119], v[52:55], a[200:203]
v_mfma_f32_16x16x32_bf16 a[204:207], v[120:123], v[48:51], a[204:207]
v_mfma_f32_16x16x32_bf16 a[204:207], v[124:127], v[52:55], a[204:207]
s_waitcnt lgkmcnt(2)
v_mfma_f32_16x16x32_bf16 a[208:211], v[96:99], v[56:59], a[208:211]
ds_read_b128 v[48:51], v2 offset:63488
v_mfma_f32_16x16x32_bf16 a[208:211], v[100:103], v[60:63], a[208:211]
ds_read_b128 v[52:55], v3 offset:63488
buffer_load_dwordx2 v[244:245], v17, s[96:99], s88 offen offset:0 nt
v_mfma_f32_16x16x32_bf16 a[212:215], v[104:107], v[56:59], a[212:215]
v_mfma_f32_16x16x32_bf16 a[212:215], v[108:111], v[60:63], a[212:215]
v_mfma_f32_16x16x32_bf16 a[216:219], v[112:115], v[56:59], a[216:219]
buffer_load_dwordx2 v[246:247], v17, s[96:99], s88 offen offset:2048 nt
s_add_u32 s88, s88, 0x1000
v_mfma_f32_16x16x32_bf16 a[216:219], v[116:119], v[60:63], a[216:219]
v_mfma_f32_16x16x32_bf16 a[220:223], v[120:123], v[56:59], a[220:223]
v_mfma_f32_16x16x32_bf16 a[220:223], v[124:127], v[60:63], a[220:223]
s_waitcnt lgkmcnt(2)
v_mfma_f32_16x16x32_bf16 a[224:227], v[96:99], v[40:43], a[224:227]
v_mfma_f32_16x16x32_bf16 a[224:227], v[100:103], v[44:47], a[224:227]
v_mfma_f32_16x16x32_bf16 a[228:231], v[104:107], v[40:43], a[228:231]
v_mfma_f32_16x16x32_bf16 a[228:231], v[108:111], v[44:47], a[228:231]
v_mfma_f32_16x16x32_bf16 a[232:235], v[112:115], v[40:43], a[232:235]
v_mfma_f32_16x16x32_bf16 a[232:235], v[116:119], v[44:47], a[232:235]
v_mfma_f32_16x16x32_bf16 a[236:239], v[120:123], v[40:43], a[236:239]
v_mfma_f32_16x16x32_bf16 a[236:239], v[124:127], v[44:47], a[236:239]
s_waitcnt lgkmcnt(0)
s_waitcnt vmcnt(13)
s_barrier
v_xor_b32 v2, 0x10000, v2
v_xor_b32 v3, 0x10000, v3
v_mfma_f32_16x16x32_bf16 a[240:243], v[96:99], v[48:51], a[240:243]
ds_read_b128 v[56:59], v2 offset:0
buffer_load_dwordx4 v[96:99], v1, s[12:15], s33 offen offset:0 sc1
v_mfma_f32_16x16x32_bf16 a[240:243], v[100:103], v[52:55], a[240:243]
ds_read_b128 v[60:63], v3 offset:0
v_mfma_f32_16x16x32_bf16 a[244:247], v[104:107], v[48:51], a[244:247]
ds_read_b128 v[40:43], v2 offset:2048
v_mfma_f32_16x16x32_bf16 a[244:247], v[108:111], v[52:55], a[244:247]
ds_read_b128 v[44:47], v3 offset:2048
buffer_load_dwordx4 v[100:103], v1, s[12:15], s33 offen offset:1024 sc1
v_mfma_f32_16x16x32_bf16 a[248:251], v[112:115], v[48:51], a[248:251]
v_mfma_f32_16x16x32_bf16 a[248:251], v[116:119], v[52:55], a[248:251]
v_mfma_f32_16x16x32_bf16 a[252:255], v[120:123], v[48:51], a[252:255]
buffer_load_dwordx4 v[104:107], v1, s[12:15], s33 offen offset:2048 sc1
v_mfma_f32_16x16x32_bf16 a[252:255], v[124:127], v[52:55], a[252:255]
s_waitcnt vmcnt(13) lgkmcnt(2)
L_cs1:
v_mfma_f32_16x16x32_bf16 a[0:3], v[64:67], v[56:59], a[0:3]
ds_read_b128 v[48:51], v2 offset:4096
v_mfma_f32_16x16x32_bf16 a[0:3], v[68:71], v[60:63], a[0:3]
ds_read_b128 v[52:55], v3 offset:4096
buffer_load_dwordx4 v[108:111], v1, s[12:15], s33 offen offset:3072 sc1
s_waitcnt vmcnt(12)
v_mfma_f32_16x16x32_bf16 a[4:7], v[72:75], v[56:59], a[4:7]
v_mfma_f32_16x16x32_bf16 a[4:7], v[76:79], v[60:63], a[4:7]
s_waitcnt vmcnt(10)
v_mfma_f32_16x16x32_bf16 a[8:11], v[80:83], v[56:59], a[8:11]
buffer_load_dwordx4 v[112:115], v1, s[12:15], s34 offen offset:0 sc1
v_mfma_f32_16x16x32_bf16 a[8:11], v[84:87], v[60:63], a[8:11]
s_waitcnt vmcnt(9)
v_mfma_f32_16x16x32_bf16 a[12:15], v[88:91], v[56:59], a[12:15]
v_mfma_f32_16x16x32_bf16 a[12:15], v[92:95], v[60:63], a[12:15]
buffer_load_dwordx4 v[116:119], v1, s[12:15], s34 offen offset:1024 sc1
s_waitcnt lgkmcnt(2)
v_mfma_f32_16x16x32_bf16 a[16:19], v[64:67], v[40:43], a[16:19]
ds_read_b128 v[56:59], v2 offset:6144
v_mfma_f32_16x16x32_bf16 a[16:19], v[68:71], v[44:47], a[16:19]
ds_read_b128 v[60:63], v3 offset:6144
v_mfma_f32_16x16x32_bf16 a[20:23], v[72:75], v[40:43], a[20:23]
buffer_load_dwordx4 v[120:123], v1, s[12:15], s34 offen offset:2048 sc1
v_mfma_f32_16x16x32_bf16 a[20:23], v[76:79], v[44:47], a[20:23]
v_mfma_f32_16x16x32_bf16 a[24:27], v[80:83], v[40:43], a[24:27]
v_mfma_f32_16x16x32_bf16 a[24:27], v[84:87], v[44:47], a[24:27]
buffer_load_dwordx4 v[124:127], v1, s[12:15], s34 offen offset:3072 sc1
s_add_u32 s33, s33, 0x8000
s_add_u32 s34, s34, 0x8000
v_mfma_f32_16x16x32_bf16 a[28:31], v[88:91], v[40:43], a[28:31]
v_mfma_f32_16x16x32_bf16 a[28:31], v[92:95], v[44:47], a[28:31]
s_waitcnt lgkmcnt(2)
v_mfma_f32_16x16x32_bf16 a[32:35], v[64:67], v[48:51], a[32:35]
ds_read_b128 v[40:43], v2 offset:8192
v_mfma_f32_16x16x32_bf16 a[32:35], v[68:71], v[52:55], a[32:35]
ds_read_b128 v[44:47], v3 offset:8192
v_mfma_f32_16x16x32_bf16 a[36:39], v[72:75], v[48:51], a[36:39]
v_mfma_f32_16x16x32_bf16 a[36:39], v[76:79], v[52:55], a[36:39]
v_mfma_f32_16x16x32_bf16 a[40:43], v[80:83], v[48:51], a[40:43]
s_add_u32 s35, s37, 0x200
s_add_u32 m0, s3, 0x10000
v_mfma_f32_16x16x32_bf16 a[40:43], v[84:87], v[52:55], a[40:43]
buffer_load_dwordx4 v8, s[8:11], s35 offen nt lds
s_add_u32 s35, s35, 0x10000
v_mfma_f32_16x16x32_bf16 a[44:47], v[88:91], v[48:51], a[44:47]
s_add_u32 m0, s3, 0x11000
v_mfma_f32_16x16x32_bf16 a[44:47], v[92:95], v[52:55], a[44:47]
buffer_load_dwordx4 v8, s[8:11], s35 offen nt lds
s_add_u32 s35, s35, 0x10000
s_waitcnt lgkmcnt(2)
v_mfma_f32_16x16x32_bf16 a[48:51], v[64:67], v[56:59], a[48:51]
ds_read_b128 v[48:51], v2 offset:10240
s_add_u32 m0, s3, 0x12000
v_mfma_f32_16x16x32_bf16 a[48:51], v[68:71], v[60:63], a[48:51]
ds_read_b128 v[52:55], v3 offset:10240
buffer_load_dwordx4 v8, s[8:11], s35 offen nt lds
s_add_u32 s35, s35, 0x10000
v_mfma_f32_16x16x32_bf16 a[52:55], v[72:75], v[56:59], a[52:55]
s_add_u32 m0, s3, 0x13000
v_mfma_f32_16x16x32_bf16 a[52:55], v[76:79], v[60:63], a[52:55]
buffer_load_dwordx4 v8, s[8:11], s35 offen nt lds
s_sub_u32 s35, s35, 196480
v_mfma_f32_16x16x32_bf16 a[56:59], v[80:83], v[56:59], a[56:59]
v_mfma_f32_16x16x32_bf16 a[56:59], v[84:87], v[60:63], a[56:59]
v_mfma_f32_16x16x32_bf16 a[60:63], v[88:91], v[56:59], a[60:63]
v_mfma_f32_16x16x32_bf16 a[60:63], v[92:95], v[60:63], a[60:63]
s_waitcnt lgkmcnt(2)
v_mfma_f32_16x16x32_bf16 a[64:67], v[64:67], v[40:43], a[64:67]
ds_read_b128 v[56:59], v2 offset:12288
v_mfma_f32_16x16x32_bf16 a[64:67], v[68:71], v[44:47], a[64:67]
ds_read_b128 v[60:63], v3 offset:12288
v_mfma_f32_16x16x32_bf16 a[68:71], v[72:75], v[40:43], a[68:71]
v_mfma_f32_16x16x32_bf16 a[68:71], v[76:79], v[44:47], a[68:71]
v_mfma_f32_16x16x32_bf16 a[72:75], v[80:83], v[40:43], a[72:75]
v_mfma_f32_16x16x32_bf16 a[72:75], v[84:87], v[44:47], a[72:75]
v_mfma_f32_16x16x32_bf16 a[76:79], v[88:91], v[40:43], a[76:79]
v_mfma_f32_16x16x32_bf16 a[76:79], v[92:95], v[44:47], a[76:79]
s_waitcnt lgkmcnt(2)
v_mfma_f32_16x16x32_bf16 a[80:83], v[64:67], v[48:51], a[80:83]
ds_read_b128 v[40:43], v2 offset:14336
v_mfma_f32_16x16x32_bf16 a[80:83], v[68:71], v[52:55], a[80:83]
ds_read_b128 v[44:47], v3 offset:14336
v_mfma_f32_16x16x32_bf16 a[84:87], v[72:75], v[48:51], a[84:87]
v_mfma_f32_16x16x32_bf16 a[84:87], v[76:79], v[52:55], a[84:87]
v_mfma_f32_16x16x32_bf16 a[88:91], v[80:83], v[48:51], a[88:91]
v_mfma_f32_16x16x32_bf16 a[88:91], v[84:87], v[52:55], a[88:91]
v_mfma_f32_16x16x32_bf16 a[92:95], v[88:91], v[48:51], a[92:95]
v_mfma_f32_16x16x32_bf16 a[92:95], v[92:95], v[52:55], a[92:95]
s_waitcnt lgkmcnt(2)
v_mfma_f32_16x16x32_bf16 a[96:99], v[64:67], v[56:59], a[96:99]
ds_read_b128 v[48:51], v2 offset:16384
v_mfma_f32_16x16x32_bf16 a[96:99], v[68:71], v[60:63], a[96:99]
ds_read_b128 v[52:55], v3 offset:16384
v_mfma_f32_16x16x32_bf16 a[100:103], v[72:75], v[56:59], a[100:103]
v_mfma_f32_16x16x32_bf16 a[100:103], v[76:79], v[60:63], a[100:103]
v_mfma_f32_16x16x32_bf16 a[104:107], v[80:83], v[56:59], a[104:107]
v_mfma_f32_16x16x32_bf16 a[104:107], v[84:87], v[60:63], a[104:107]
v_mfma_f32_16x16x32_bf16 a[108:111], v[88:91], v[56:59], a[108:111]
v_mfma_f32_16x16x32_bf16 a[108:111], v[92:95], v[60:63], a[108:111]
s_waitcnt lgkmcnt(2)
v_mfma_f32_16x16x32_bf16 a[112:115], v[64:67], v[40:43], a[112:115]
ds_read_b128 v[56:59], v2 offset:18432
buffer_load_dwordx4 v[64:67], v1, s[12:15], s33 offen offset:0 sc1
v_mfma_f32_16x16x32_bf16 a[112:115], v[68:71], v[44:47], a[112:115]
ds_read_b128 v[60:63], v3 offset:18432
v_mfma_f32_16x16x32_bf16 a[116:119], v[72:75], v[40:43], a[116:119]
v_mfma_f32_16x16x32_bf16 a[116:119], v[76:79], v[44:47], a[116:119]
buffer_load_dwordx4 v[68:71], v1, s[12:15], s33 offen offset:1024 sc1
v_mfma_f32_16x16x32_bf16 a[120:123], v[80:83], v[40:43], a[120:123]
v_mfma_f32_16x16x32_bf16 a[120:123], v[84:87], v[44:47], a[120:123]
v_mfma_f32_16x16x32_bf16 a[124:127], v[88:91], v[40:43], a[124:127]
buffer_load_dwordx4 v[72:75], v1, s[12:15], s33 offen offset:2048 sc1
v_mfma_f32_16x16x32_bf16 a[124:127], v[92:95], v[44:47], a[124:127]
s_waitcnt vmcnt(13) lgkmcnt(2)
v_mfma_f32_16x16x32_bf16 a[0:3], v[96:99], v[48:51], a[0:3]
ds_read_b128 v[40:43], v2 offset:20480
v_mfma_f32_16x16x32_bf16 a[0:3], v[100:103], v[52:55], a[0:3]
ds_read_b128 v[44:47], v3 offset:20480
buffer_load_dwordx4 v[76:79], v1, s[12:15], s33 offen offset:3072 sc1
s_waitcnt vmcnt(12)
v_mfma_f32_16x16x32_bf16 a[4:7], v[104:107], v[48:51], a[4:7]
v_mfma_f32_16x16x32_bf16 a[4:7], v[108:111], v[52:55], a[4:7]
s_waitcnt vmcnt(10)
v_mfma_f32_16x16x32_bf16 a[8:11], v[112:115], v[48:51], a[8:11]
buffer_load_dwordx4 v[80:83], v1, s[12:15], s34 offen offset:0 sc1
v_mfma_f32_16x16x32_bf16 a[8:11], v[116:119], v[52:55], a[8:11]
s_waitcnt vmcnt(9)
v_mfma_f32_16x16x32_bf16 a[12:15], v[120:123], v[48:51], a[12:15]
v_mfma_f32_16x16x32_bf16 a[12:15], v[124:127], v[52:55], a[12:15]
buffer_load_dwordx4 v[84:87], v1, s[12:15], s34 offen offset:1024 sc1
s_waitcnt lgkmcnt(2)
v_mfma_f32_16x16x32_bf16 a[16:19], v[96:99], v[56:59], a[16:19]
ds_read_b128 v[48:51], v2 offset:22528
v_mfma_f32_16x16x32_bf16 a[16:19], v[100:103], v[60:63], a[16:19]
ds_read_b128 v[52:55], v3 offset:22528
v_mfma_f32_16x16x32_bf16 a[20:23], v[104:107], v[56:59], a[20:23]
buffer_load_dwordx4 v[88:91], v1, s[12:15], s34 offen offset:2048 sc1
v_mfma_f32_16x16x32_bf16 a[20:23], v[108:111], v[60:63], a[20:23]
v_mfma_f32_16x16x32_bf16 a[24:27], v[112:115], v[56:59], a[24:27]
v_mfma_f32_16x16x32_bf16 a[24:27], v[116:119], v[60:63], a[24:27]
buffer_load_dwordx4 v[92:95], v1, s[12:15], s34 offen offset:3072 sc1
s_add_u32 s33, s33, 0x8000
s_add_u32 s34, s34, 0x8000
v_mfma_f32_16x16x32_bf16 a[28:31], v[120:123], v[56:59], a[28:31]
v_mfma_f32_16x16x32_bf16 a[28:31], v[124:127], v[60:63], a[28:31]
s_waitcnt lgkmcnt(2)
v_mfma_f32_16x16x32_bf16 a[32:35], v[96:99], v[40:43], a[32:35]
ds_read_b128 v[56:59], v2 offset:24576
v_mfma_f32_16x16x32_bf16 a[32:35], v[100:103], v[44:47], a[32:35]
ds_read_b128 v[60:63], v3 offset:24576
v_mfma_f32_16x16x32_bf16 a[36:39], v[104:107], v[40:43], a[36:39]
v_mfma_f32_16x16x32_bf16 a[36:39], v[108:111], v[44:47], a[36:39]
v_mfma_f32_16x16x32_bf16 a[40:43], v[112:115], v[40:43], a[40:43]
v_mfma_f32_16x16x32_bf16 a[40:43], v[116:119], v[44:47], a[40:43]
v_mfma_f32_16x16x32_bf16 a[44:47], v[120:123], v[40:43], a[44:47]
v_mfma_f32_16x16x32_bf16 a[44:47], v[124:127], v[44:47], a[44:47]
s_waitcnt lgkmcnt(2)
v_mfma_f32_16x16x32_bf16 a[48:51], v[96:99], v[48:51], a[48:51]
ds_read_b128 v[40:43], v2 offset:26624
v_mfma_f32_16x16x32_bf16 a[48:51], v[100:103], v[52:55], a[48:51]
ds_read_b128 v[44:47], v3 offset:26624
v_mfma_f32_16x16x32_bf16 a[52:55], v[104:107], v[48:51], a[52:55]
v_mfma_f32_16x16x32_bf16 a[52:55], v[108:111], v[52:55], a[52:55]
v_mfma_f32_16x16x32_bf16 a[56:59], v[112:115], v[48:51], a[56:59]
v_mfma_f32_16x16x32_bf16 a[56:59], v[116:119], v[52:55], a[56:59]
v_mfma_f32_16x16x32_bf16 a[60:63], v[120:123], v[48:51], a[60:63]
v_mfma_f32_16x16x32_bf16 a[60:63], v[124:127], v[52:55], a[60:63]
s_waitcnt lgkmcnt(2)
v_mfma_f32_16x16x32_bf16 a[64:67], v[96:99], v[56:59], a[64:67]
ds_read_b128 v[48:51], v2 offset:28672
v_mfma_f32_16x16x32_bf16 a[64:67], v[100:103], v[60:63], a[64:67]
ds_read_b128 v[52:55], v3 offset:28672
buffer_load_dwordx2 v[248:249], v17, s[96:99], s88 offen offset:0 nt
v_mfma_f32_16x16x32_bf16 a[68:71], v[104:107], v[56:59], a[68:71]
v_mfma_f32_16x16x32_bf16 a[68:71], v[108:111], v[60:63], a[68:71]
v_mfma_f32_16x16x32_bf16 a[72:75], v[112:115], v[56:59], a[72:75]
buffer_load_dwordx2 v[250:251], v17, s[96:99], s88 offen offset:2048 nt
s_add_u32 s88, s88, 0x1000
v_mfma_f32_16x16x32_bf16 a[72:75], v[116:119], v[60:63], a[72:75]
v_mfma_f32_16x16x32_bf16 a[76:79], v[120:123], v[56:59], a[76:79]
v_mfma_f32_16x16x32_bf16 a[76:79], v[124:127], v[60:63], a[76:79]
s_waitcnt lgkmcnt(2)
v_mfma_f32_16x16x32_bf16 a[80:83], v[96:99], v[40:43], a[80:83]
ds_read_b128 v[56:59], v2 offset:30720
v_mfma_f32_16x16x32_bf16 a[80:83], v[100:103], v[44:47], a[80:83]
ds_read_b128 v[60:63], v3 offset:30720
buffer_load_dwordx2 v[252:253], v17, s[96:99], s88 offen offset:0 nt
v_mfma_f32_16x16x32_bf16 a[84:87], v[104:107], v[40:43], a[84:87]
v_mfma_f32_16x16x32_bf16 a[84:87], v[108:111], v[44:47], a[84:87]
v_mfma_f32_16x16x32_bf16 a[88:91], v[112:115], v[40:43], a[88:91]
buffer_load_dwordx2 v[254:255], v17, s[96:99], s88 offen offset:2048 nt
v_mfma_f32_16x16x32_bf16 a[88:91], v[116:119], v[44:47], a[88:91]
v_mfma_f32_16x16x32_bf16 a[92:95], v[120:123], v[40:43], a[92:95]
v_mfma_f32_16x16x32_bf16 a[92:95], v[124:127], v[44:47], a[92:95]
s_waitcnt lgkmcnt(2)
v_mfma_f32_16x16x32_bf16 a[96:99], v[96:99], v[48:51], a[96:99]
ds_read_b128 v[40:43], v2 offset:32768
v_mfma_f32_16x16x32_bf16 a[96:99], v[100:103], v[52:55], a[96:99]
ds_read_b128 v[44:47], v3 offset:32768
v_mfma_f32_16x16x32_bf16 a[100:103], v[104:107], v[48:51], a[100:103]
v_mfma_f32_16x16x32_bf16 a[100:103], v[108:111], v[52:55], a[100:103]
v_mfma_f32_16x16x32_bf16 a[104:107], v[112:115], v[48:51], a[104:107]
v_mfma_f32_16x16x32_bf16 a[104:107], v[116:119], v[52:55], a[104:107]
v_mfma_f32_16x16x32_bf16 a[108:111], v[120:123], v[48:51], a[108:111]
v_mfma_f32_16x16x32_bf16 a[108:111], v[124:127], v[52:55], a[108:111]
s_waitcnt lgkmcnt(2)
v_mfma_f32_16x16x32_bf16 a[112:115], v[96:99], v[56:59], a[112:115]
ds_read_b128 v[48:51], v2 offset:34816
buffer_load_dwordx4 v[96:99], v1, s[12:15], s33 offen offset:0 sc1
v_mfma_f32_16x16x32_bf16 a[112:115], v[100:103], v[60:63], a[112:115]
ds_read_b128 v[52:55], v3 offset:34816
v_mfma_f32_16x16x32_bf16 a[116:119], v[104:107], v[56:59], a[116:119]
v_mfma_f32_16x16x32_bf16 a[116:119], v[108:111], v[60:63], a[116:119]
buffer_load_dwordx4 v[100:103], v1, s[12:15], s33 offen offset:1024 sc1
v_mfma_f32_16x16x32_bf16 a[120:123], v[112:115], v[56:59], a[120:123]
v_mfma_f32_16x16x32_bf16 a[120:123], v[116:119], v[60:63], a[120:123]
v_mfma_f32_16x16x32_bf16 a[124:127], v[120:123], v[56:59], a[124:127]
buffer_load_dwordx4 v[104:107], v1, s[12:15], s33 offen offset:2048 sc1
v_mfma_f32_16x16x32_bf16 a[124:127], v[124:127], v[60:63], a[124:127]
s_waitcnt vmcnt(13) lgkmcnt(2)
v_mfma_f32_16x16x32_bf16 a[0:3], v[64:67], v[40:43], a[0:3]
ds_read_b128 v[56:59], v2 offset:36864
v_mfma_f32_16x16x32_bf16 a[0:3], v[68:71], v[44:47], a[0:3]
ds_read_b128 v[60:63], v3 offset:36864
buffer_load_dwordx4 v[108:111], v1, s[12:15], s33 offen offset:3072 sc1
s_waitcnt vmcnt(12)
v_mfma_f32_16x16x32_bf16 a[4:7], v[72:75], v[40:43], a[4:7]
v_mfma_f32_16x16x32_bf16 a[4:7], v[76:79], v[44:47], a[4:7]
s_waitcnt vmcnt(10)
v_mfma_f32_16x16x32_bf16 a[8:11], v[80:83], v[40:43], a[8:11]
buffer_load_dwordx4 v[112:115], v1, s[12:15], s34 offen offset:0 sc1
v_mfma_f32_16x16x32_bf16 a[8:11], v[84:87], v[44:47], a[8:11]
s_waitcnt vmcnt(9)
v_mfma_f32_16x16x32_bf16 a[12:15], v[88:91], v[40:43], a[12:15]
v_mfma_f32_16x16x32_bf16 a[12:15], v[92:95], v[44:47], a[12:15]
buffer_load_dwordx4 v[116:119], v1, s[12:15], s34 offen offset:1024 sc1
s_waitcnt lgkmcnt(2)
v_mfma_f32_16x16x32_bf16 a[16:19], v[64:67], v[48:51], a[16:19]
ds_read_b128 v[40:43], v2 offset:38912
v_mfma_f32_16x16x32_bf16 a[16:19], v[68:71], v[52:55], a[16:19]
ds_read_b128 v[44:47], v3 offset:38912
v_mfma_f32_16x16x32_bf16 a[20:23], v[72:75], v[48:51], a[20:23]
buffer_load_dwordx4 v[120:123], v1, s[12:15], s34 offen offset:2048 sc1
v_mfma_f32_16x16x32_bf16 a[20:23], v[76:79], v[52:55], a[20:23]
v_mfma_f32_16x16x32_bf16 a[24:27], v[80:83], v[48:51], a[24:27]
v_mfma_f32_16x16x32_bf16 a[24:27], v[84:87], v[52:55], a[24:27]
buffer_load_dwordx4 v[124:127], v1, s[12:15], s34 offen offset:3072 sc1
s_add_u32 s33, s33, 0x8000
s_add_u32 s34, s34, 0x8000
v_mfma_f32_16x16x32_bf16 a[28:31], v[88:91], v[48:51], a[28:31]
v_mfma_f32_16x16x32_bf16 a[28:31], v[92:95], v[52:55], a[28:31]
s_waitcnt lgkmcnt(2)
v_mfma_f32_16x16x32_bf16 a[32:35], v[64:67], v[56:59], a[32:35]
ds_read_b128 v[48:51], v2 offset:40960
v_mfma_f32_16x16x32_bf16 a[32:35], v[68:71], v[60:63], a[32:35]
ds_read_b128 v[52:55], v3 offset:40960
v_mfma_f32_16x16x32_bf16 a[36:39], v[72:75], v[56:59], a[36:39]
v_mfma_f32_16x16x32_bf16 a[36:39], v[76:79], v[60:63], a[36:39]
ds_read_b128 v[128:131], v4 offset:0
v_mfma_f32_16x16x32_bf16 a[40:43], v[80:83], v[56:59], a[40:43]
s_add_u32 m0, s3, 0x14000
v_mfma_f32_16x16x32_bf16 a[40:43], v[84:87], v[60:63], a[40:43]
buffer_load_dwordx4 v8, s[8:11], s35 offen nt lds
s_add_u32 s35, s35, 0x10000
v_mfma_f32_16x16x32_bf16 a[44:47], v[88:91], v[56:59], a[44:47]
s_add_u32 m0, s3, 0x15000
v_mfma_f32_16x16x32_bf16 a[44:47], v[92:95], v[60:63], a[44:47]
buffer_load_dwordx4 v8, s[8:11], s35 offen nt lds
s_add_u32 s35, s35, 0x10000
s_waitcnt lgkmcnt(3)
v_mfma_f32_16x16x32_bf16 a[48:51], v[64:67], v[40:43], a[48:51]
ds_read_b128 v[56:59], v2 offset:43008
s_add_u32 m0, s3, 0x16000
v_mfma_f32_16x16x32_bf16 a[48:51], v[68:71], v[44:47], a[48:51]
ds_read_b128 v[60:63], v3 offset:43008
buffer_load_dwordx4 v8, s[8:11], s35 offen nt lds
s_add_u32 s35, s35, 0x10000
v_mfma_f32_16x16x32_bf16 a[52:55], v[72:75], v[40:43], a[52:55]
s_add_u32 m0, s3, 0x17000
v_mfma_f32_16x16x32_bf16 a[52:55], v[76:79], v[44:47], a[52:55]
buffer_load_dwordx4 v8, s[8:11], s35 offen nt lds
s_sub_u32 s35, s35, 196480
v_mfma_f32_16x16x32_bf16 a[56:59], v[80:83], v[40:43], a[56:59]
v_mfma_f32_16x16x32_bf16 a[56:59], v[84:87], v[44:47], a[56:59]
v_mfma_f32_16x16x32_bf16 a[60:63], v[88:91], v[40:43], a[60:63]
ds_read_b128 v[132:135], v5 offset:0
v_mfma_f32_16x16x32_bf16 a[60:63], v[92:95], v[44:47], a[60:63]
ds_read_b128 v[136:139], v4 offset:2048
s_waitcnt lgkmcnt(5)
v_mfma_f32_16x16x32_bf16 a[64:67], v[64:67], v[48:51], a[64:67]
ds_read_b128 v[40:43], v2 offset:45056
v_mfma_f32_16x16x32_bf16 a[64:67], v[68:71], v[52:55], a[64:67]
ds_read_b128 v[44:47], v3 offset:45056
v_mfma_f32_16x16x32_bf16 a[68:71], v[72:75], v[48:51], a[68:71]
v_mfma_f32_16x16x32_bf16 a[68:71], v[76:79], v[52:55], a[68:71]
ds_read_b128 v[140:143], v5 offset:2048
v_mfma_f32_16x16x32_bf16 a[72:75], v[80:83], v[48:51], a[72:75]
ds_read_b128 v[144:147], v4 offset:4096
v_mfma_f32_16x16x32_bf16 a[72:75], v[84:87], v[52:55], a[72:75]
ds_read_b128 v[148:151], v5 offset:4096
v_mfma_f32_16x16x32_bf16 a[76:79], v[88:91], v[48:51], a[76:79]
ds_read_b128 v[152:155], v4 offset:6144
v_mfma_f32_16x16x32_bf16 a[76:79], v[92:95], v[52:55], a[76:79]
ds_read_b128 v[156:159], v5 offset:6144
s_waitcnt lgkmcnt(9)
v_mfma_f32_16x16x32_bf16 a[80:83], v[64:67], v[56:59], a[80:83]
ds_read_b128 v[48:51], v2 offset:47104
v_mfma_f32_16x16x32_bf16 a[80:83], v[68:71], v[60:63], a[80:83]
ds_read_b128 v[52:55], v3 offset:47104
v_mfma_f32_16x16x32_bf16 a[84:87], v[72:75], v[56:59], a[84:87]
v_mfma_f32_16x16x32_bf16 a[84:87], v[76:79], v[60:63], a[84:87]
ds_read_b128 v[160:163], v4 offset:8192
v_mfma_f32_16x16x32_bf16 a[88:91], v[80:83], v[56:59], a[88:91]
ds_read_b128 v[164:167], v5 offset:8192
v_mfma_f32_16x16x32_bf16 a[88:91], v[84:87], v[60:63], a[88:91]
ds_read_b128 v[168:171], v4 offset:10240
v_mfma_f32_16x16x32_bf16 a[92:95], v[88:91], v[56:59], a[92:95]
ds_read_b128 v[172:175], v5 offset:10240
v_mfma_f32_16x16x32_bf16 a[92:95], v[92:95], v[60:63], a[92:95]
ds_read_b128 v[176:179], v4 offset:12288
s_waitcnt lgkmcnt(12)
v_mfma_f32_16x16x32_bf16 a[96:99], v[64:67], v[40:43], a[96:99]
ds_read_b128 v[56:59], v2 offset:49152
v_mfma_f32_16x16x32_bf16 a[96:99], v[68:71], v[44:47], a[96:99]
ds_read_b128 v[60:63], v3 offset:49152
v_mfma_f32_16x16x32_bf16 a[100:103], v[72:75], v[40:43], a[100:103]
v_mfma_f32_16x16x32_bf16 a[100:103], v[76:79], v[44:47], a[100:103]
ds_read_b128 v[180:183], v5 offset:12288
v_mfma_f32_16x16x32_bf16 a[104:107], v[80:83], v[40:43], a[104:107]
ds_read_b128 v[184:187], v4 offset:14336
v_mfma_f32_16x16x32_bf16 a[104:107], v[84:87], v[44:47], a[104:107]
ds_read_b128 v[188:191], v5 offset:14336
v_mfma_f32_16x16x32_bf16 a[108:111], v[88:91], v[40:43], a[108:111]
v_mfma_f32_16x16x32_bf16 a[108:111], v[92:95], v[44:47], a[108:111]
s_waitcnt lgkmcnt(10)
v_mfma_f32_16x16x32_bf16 a[112:115], v[64:67], v[48:51], a[112:115]
ds_read_b128 v[40:43], v2 offset:51200
buffer_load_dwordx4 v[64:67], v1, s[12:15], s33 offen offset:0 sc1
v_mfma_f32_16x16x32_bf16 a[112:115], v[68:71], v[52:55], a[112:115]
ds_read_b128 v[44:47], v3 offset:51200
v_mfma_f32_16x16x32_bf16 a[116:119], v[72:75], v[48:51], a[116:119]
v_mfma_f32_16x16x32_bf16 a[116:119], v[76:79], v[52:55], a[116:119]
buffer_load_dwordx4 v[68:71], v1, s[12:15], s33 offen offset:1024 sc1
v_mfma_f32_16x16x32_bf16 a[120:123], v[80:83], v[48:51], a[120:123]
v_mfma_f32_16x16x32_bf16 a[120:123], v[84:87], v[52:55], a[120:123]
v_mfma_f32_16x16x32_bf16 a[124:127], v[88:91], v[48:51], a[124:127]
buffer_load_dwordx4 v[72:75], v1, s[12:15], s33 offen offset:2048 sc1
v_mfma_f32_16x16x32_bf16 a[124:127], v[92:95], v[52:55], a[124:127]
s_waitcnt vmcnt(13) lgkmcnt(5)
v_mfma_f32_16x16x32_bf16 a[0:3], v[96:99], v[56:59], a[0:3]
ds_read_b128 v[48:51], v2 offset:53248
v_mfma_f32_16x16x32_bf16 a[0:3], v[100:103], v[60:63], a[0:3]
ds_read_b128 v[52:55], v3 offset:53248
buffer_load_dwordx4 v[76:79], v1, s[12:15], s33 offen offset:3072 sc1
s_waitcnt vmcnt(12)
v_mfma_f32_16x16x32_bf16 a[4:7], v[104:107], v[56:59], a[4:7]
v_mfma_f32_16x16x32_bf16 a[4:7], v[108:111], v[60:63], a[4:7]
s_waitcnt vmcnt(10)
v_mfma_f32_16x16x32_bf16 a[8:11], v[112:115], v[56:59], a[8:11]
buffer_load_dwordx4 v[80:83], v1, s[12:15], s34 offen offset:0 sc1
v_mfma_f32_16x16x32_bf16 a[8:11], v[116:119], v[60:63], a[8:11]
s_waitcnt vmcnt(9)
v_mfma_f32_16x16x32_bf16 a[12:15], v[120:123], v[56:59], a[12:15]
v_mfma_f32_16x16x32_bf16 a[12:15], v[124:127], v[60:63], a[12:15]
buffer_load_dwordx4 v[84:87], v1, s[12:15], s34 offen offset:1024 sc1
s_waitcnt lgkmcnt(2)
v_mfma_f32_16x16x32_bf16 a[16:19], v[96:99], v[40:43], a[16:19]
ds_read_b128 v[56:59], v2 offset:55296
v_mfma_f32_16x16x32_bf16 a[16:19], v[100:103], v[44:47], a[16:19]
ds_read_b128 v[60:63], v3 offset:55296
v_mfma_f32_16x16x32_bf16 a[20:23], v[104:107], v[40:43], a[20:23]
buffer_load_dwordx4 v[88:91], v1, s[12:15], s34 offen offset:2048 sc1
v_mfma_f32_16x16x32_bf16 a[20:23], v[108:111], v[44:47], a[20:23]
v_mfma_f32_16x16x32_bf16 a[24:27], v[112:115], v[40:43], a[24:27]
v_mfma_f32_16x16x32_bf16 a[24:27], v[116:119], v[44:47], a[24:27]
buffer_load_dwordx4 v[92:95], v1, s[12:15], s34 offen offset:3072 sc1
s_add_u32 s33, s33, 0x8000
s_add_u32 s34, s34, 0x8000
v_mfma_f32_16x16x32_bf16 a[28:31], v[120:123], v[40:43], a[28:31]
v_mfma_f32_16x16x32_bf16 a[28:31], v[124:127], v[44:47], a[28:31]
s_waitcnt lgkmcnt(2)
v_mfma_f32_16x16x32_bf16 a[32:35], v[96:99], v[48:51], a[32:35]
ds_read_b128 v[40:43], v2 offset:57344
v_mfma_f32_16x16x32_bf16 a[32:35], v[100:103], v[52:55], a[32:35]
ds_read_b128 v[44:47], v3 offset:57344
v_mfma_f32_16x16x32_bf16 a[36:39], v[104:107], v[48:51], a[36:39]
v_mfma_f32_16x16x32_bf16 a[36:39], v[108:111], v[52:55], a[36:39]
v_mfma_f32_16x16x32_bf16 a[40:43], v[112:115], v[48:51], a[40:43]
v_mfma_f32_16x16x32_bf16 a[40:43], v[116:119], v[52:55], a[40:43]
v_mfma_f32_16x16x32_bf16 a[44:47], v[120:123], v[48:51], a[44:47]
v_mfma_f32_16x16x32_bf16 a[44:47], v[124:127], v[52:55], a[44:47]
s_waitcnt lgkmcnt(2)
v_mfma_f32_16x16x32_bf16 a[48:51], v[96:99], v[56:59], a[48:51]
ds_read_b128 v[48:51], v2 offset:59392
v_mfma_f32_16x16x32_bf16 a[48:51], v[100:103], v[60:63], a[48:51]
ds_read_b128 v[52:55], v3 offset:59392
v_mfma_f32_16x16x32_bf16 a[52:55], v[104:107], v[56:59], a[52:55]
v_mfma_f32_16x16x32_bf16 a[52:55], v[108:111], v[60:63], a[52:55]
v_mfma_f32_16x16x32_bf16 a[56:59], v[112:115], v[56:59], a[56:59]
v_mfma_f32_16x16x32_bf16 a[56:59], v[116:119], v[60:63], a[56:59]
v_mfma_f32_16x16x32_bf16 a[60:63], v[120:123], v[56:59], a[60:63]
v_mfma_f32_16x16x32_bf16 a[60:63], v[124:127], v[60:63], a[60:63]
s_waitcnt lgkmcnt(2)
v_mfma_f32_16x16x32_bf16 a[64:67], v[96:99], v[40:43], a[64:67]
ds_read_b128 v[56:59], v2 offset:61440
v_mfma_f32_16x16x32_bf16 a[64:67], v[100:103], v[44:47], a[64:67]
ds_read_b128 v[60:63], v3 offset:61440
v_mfma_f32_16x16x32_bf16 a[68:71], v[104:107], v[40:43], a[68:71]
v_mfma_f32_16x16x32_bf16 a[68:71], v[108:111], v[44:47], a[68:71]
v_mfma_f32_16x16x32_bf16 a[72:75], v[112:115], v[40:43], a[72:75]
v_mfma_f32_16x16x32_bf16 a[72:75], v[116:119], v[44:47], a[72:75]
v_mfma_f32_16x16x32_bf16 a[76:79], v[120:123], v[40:43], a[76:79]
v_mfma_f32_16x16x32_bf16 a[76:79], v[124:127], v[44:47], a[76:79]
s_waitcnt lgkmcnt(2)
v_mfma_f32_16x16x32_bf16 a[80:83], v[96:99], v[48:51], a[80:83]
ds_read_b128 v[40:43], v2 offset:63488
v_mfma_f32_16x16x32_bf16 a[80:83], v[100:103], v[52:55], a[80:83]
ds_read_b128 v[44:47], v3 offset:63488
v_mfma_f32_16x16x32_bf16 a[84:87], v[104:107], v[48:51], a[84:87]
v_mfma_f32_16x16x32_bf16 a[84:87], v[108:111], v[52:55], a[84:87]
v_mfma_f32_16x16x32_bf16 a[88:91], v[112:115], v[48:51], a[88:91]
v_mfma_f32_16x16x32_bf16 a[88:91], v[116:119], v[52:55], a[88:91]
v_mfma_f32_16x16x32_bf16 a[92:95], v[120:123], v[48:51], a[92:95]
v_mfma_f32_16x16x32_bf16 a[92:95], v[124:127], v[52:55], a[92:95]
s_waitcnt lgkmcnt(2)
v_mfma_f32_16x16x32_bf16 a[96:99], v[96:99], v[56:59], a[96:99]
ds_read_b128 v[48:51], v2 offset:0
v_mfma_f32_16x16x32_bf16 a[96:99], v[100:103], v[60:63], a[96:99]
ds_read_b128 v[52:55], v3 offset:0
v_mfma_f32_16x16x32_bf16 a[100:103], v[104:107], v[56:59], a[100:103]
v_mfma_f32_16x16x32_bf16 a[100:103], v[108:111], v[60:63], a[100:103]
v_mfma_f32_16x16x32_bf16 a[104:107], v[112:115], v[56:59], a[104:107]
v_mfma_f32_16x16x32_bf16 a[104:107], v[116:119], v[60:63], a[104:107]
v_mfma_f32_16x16x32_bf16 a[108:111], v[120:123], v[56:59], a[108:111]
v_mfma_f32_16x16x32_bf16 a[108:111], v[124:127], v[60:63], a[108:111]
s_waitcnt lgkmcnt(2)
v_mfma_f32_16x16x32_bf16 a[112:115], v[96:99], v[40:43], a[112:115]
ds_read_b128 v[56:59], v2 offset:2048
buffer_load_dwordx4 v[96:99], v1, s[12:15], s33 offen offset:0 sc1
v_mfma_f32_16x16x32_bf16 a[112:115], v[100:103], v[44:47], a[112:115]
ds_read_b128 v[60:63], v3 offset:2048
v_mfma_f32_16x16x32_bf16 a[116:119], v[104:107], v[40:43], a[116:119]
v_mfma_f32_16x16x32_bf16 a[116:119], v[108:111], v[44:47], a[116:119]
buffer_load_dwordx4 v[100:103], v1, s[12:15], s33 offen offset:1024 sc1
v_mfma_f32_16x16x32_bf16 a[120:123], v[112:115], v[40:43], a[120:123]
v_mfma_f32_16x16x32_bf16 a[120:123], v[116:119], v[44:47], a[120:123]
v_mfma_f32_16x16x32_bf16 a[124:127], v[120:123], v[40:43], a[124:127]
buffer_load_dwordx4 v[104:107], v1, s[12:15], s33 offen offset:2048 sc1
v_mfma_f32_16x16x32_bf16 a[124:127], v[124:127], v[44:47], a[124:127]
s_waitcnt vmcnt(9) lgkmcnt(2)
v_mfma_f32_16x16x32_bf16 a[128:131], v[64:67], v[48:51], a[128:131]
ds_read_b128 v[40:43], v2 offset:4096
v_mfma_f32_16x16x32_bf16 a[128:131], v[68:71], v[52:55], a[128:131]
ds_read_b128 v[44:47], v3 offset:4096
buffer_load_dwordx4 v[108:111], v1, s[12:15], s33 offen offset:3072 sc1
s_waitcnt vmcnt(8)
v_mfma_f32_16x16x32_bf16 a[132:135], v[72:75], v[48:51], a[132:135]
v_mfma_f32_16x16x32_bf16 a[132:135], v[76:79], v[52:55], a[132:135]
s_waitcnt vmcnt(6)
v_mfma_f32_16x16x32_bf16 a[136:139], v[80:83], v[48:51], a[136:139]
buffer_load_dwordx4 v[112:115], v1, s[12:15], s34 offen offset:0 sc1
v_mfma_f32_16x16x32_bf16 a[136:139], v[84:87], v[52:55], a[136:139]
s_waitcnt vmcnt(5)
v_mfma_f32_16x16x32_bf16 a[140:143], v[88:91], v[48:51], a[140:143]
v_mfma_f32_16x16x32_bf16 a[140:143], v[92:95], v[52:55], a[140:143]
buffer_load_dwordx4 v[116:119], v1, s[12:15], s34 offen offset:1024 sc1
s_waitcnt lgkmcnt(2)
v_mfma_f32_16x16x32_bf16 a[144:147], v[64:67], v[56:59], a[144:147]
ds_read_b128 v[48:51], v2 offset:6144
v_mfma_f32_16x16x32_bf16 a[144:147], v[68:71], v[60:63], a[144:147]
ds_read_b128 v[52:55], v3 offset:6144
v_mfma_f32_16x16x32_bf16 a[148:151], v[72:75], v[56:59], a[148:151]
buffer_load_dwordx4 v[120:123], v1, s[12:15], s34 offen offset:2048 sc1
v_mfma_f32_16x16x32_bf16 a[148:151], v[76:79], v[60:63], a[148:151]
v_mfma_f32_16x16x32_bf16 a[152:155], v[80:83], v[56:59], a[152:155]
v_mfma_f32_16x16x32_bf16 a[152:155], v[84:87], v[60:63], a[152:155]
buffer_load_dwordx4 v[124:127], v1, s[12:15], s34 offen offset:3072 sc1
s_add_u32 s33, s33, 0x8000
s_add_u32 s34, s34, 0x8000
v_mfma_f32_16x16x32_bf16 a[156:159], v[88:91], v[56:59], a[156:159]
v_mfma_f32_16x16x32_bf16 a[156:159], v[92:95], v[60:63], a[156:159]
s_waitcnt lgkmcnt(2)
v_mfma_f32_16x16x32_bf16 a[160:163], v[64:67], v[40:43], a[160:163]
ds_read_b128 v[56:59], v2 offset:8192
v_mfma_f32_16x16x32_bf16 a[160:163], v[68:71], v[44:47], a[160:163]
ds_read_b128 v[60:63], v3 offset:8192
v_mfma_f32_16x16x32_bf16 a[164:167], v[72:75], v[40:43], a[164:167]
v_mfma_f32_16x16x32_bf16 a[164:167], v[76:79], v[44:47], a[164:167]
v_mfma_f32_16x16x32_bf16 a[168:171], v[80:83], v[40:43], a[168:171]
s_add_u32 m0, s3, 0x18000
v_mfma_f32_16x16x32_bf16 a[168:171], v[84:87], v[44:47], a[168:171]
buffer_load_dwordx4 v8, s[8:11], s35 offen nt lds
s_add_u32 s35, s35, 0x10000
v_mfma_f32_16x16x32_bf16 a[172:175], v[88:91], v[40:43], a[172:175]
s_add_u32 m0, s3, 0x19000
v_mfma_f32_16x16x32_bf16 a[172:175], v[92:95], v[44:47], a[172:175]
buffer_load_dwordx4 v8, s[8:11], s35 offen nt lds
s_add_u32 s35, s35, 0x10000
s_waitcnt lgkmcnt(2)
v_mfma_f32_16x16x32_bf16 a[176:179], v[64:67], v[48:51], a[176:179]
ds_read_b128 v[40:43], v2 offset:10240
s_add_u32 m0, s3, 0x1a000
v_mfma_f32_16x16x32_bf16 a[176:179], v[68:71], v[52:55], a[176:179]
ds_read_b128 v[44:47], v3 offset:10240
buffer_load_dwordx4 v8, s[8:11], s35 offen nt lds
s_add_u32 s35, s35, 0x10000
v_mfma_f32_16x16x32_bf16 a[180:183], v[72:75], v[48:51], a[180:183]
s_add_u32 m0, s3, 0x1b000
v_mfma_f32_16x16x32_bf16 a[180:183], v[76:79], v[52:55], a[180:183]
buffer_load_dwordx4 v8, s[8:11], s35 offen nt lds
s_sub_u32 s35, s35, 196480
v_mfma_f32_16x16x32_bf16 a[184:187], v[80:83], v[48:51], a[184:187]
v_mfma_f32_16x16x32_bf16 a[184:187], v[84:87], v[52:55], a[184:187]
v_mfma_f32_16x16x32_bf16 a[188:191], v[88:91], v[48:51], a[188:191]
v_mfma_f32_16x16x32_bf16 a[188:191], v[92:95], v[52:55], a[188:191]
s_waitcnt lgkmcnt(2)
v_mfma_f32_16x16x32_bf16 a[192:195], v[64:67], v[56:59], a[192:195]
ds_read_b128 v[48:51], v2 offset:12288
v_mfma_f32_16x16x32_bf16 a[192:195], v[68:71], v[60:63], a[192:195]
ds_read_b128 v[52:55], v3 offset:12288
v_mfma_f32_16x16x32_bf16 a[196:199], v[72:75], v[56:59], a[196:199]
v_mfma_f32_16x16x32_bf16 a[196:199], v[76:79], v[60:63], a[196:199]
v_mfma_f32_16x16x32_bf16 a[200:203], v[80:83], v[56:59], a[200:203]
v_mfma_f32_16x16x32_bf16 a[200:203], v[84:87], v[60:63], a[200:203]
v_mfma_f32_16x16x32_bf16 a[204:207], v[88:91], v[56:59], a[204:207]
v_mfma_f32_16x16x32_bf16 a[204:207], v[92:95], v[60:63], a[204:207]
s_waitcnt lgkmcnt(2)
v_mfma_f32_16x16x32_bf16 a[208:211], v[64:67], v[40:43], a[208:211]
ds_read_b128 v[56:59], v2 offset:14336
v_mfma_f32_16x16x32_bf16 a[208:211], v[68:71], v[44:47], a[208:211]
ds_read_b128 v[60:63], v3 offset:14336
v_mfma_f32_16x16x32_bf16 a[212:215], v[72:75], v[40:43], a[212:215]
v_mfma_f32_16x16x32_bf16 a[212:215], v[76:79], v[44:47], a[212:215]
v_mfma_f32_16x16x32_bf16 a[216:219], v[80:83], v[40:43], a[216:219]
v_mfma_f32_16x16x32_bf16 a[216:219], v[84:87], v[44:47], a[216:219]
v_mfma_f32_16x16x32_bf16 a[220:223], v[88:91], v[40:43], a[220:223]
v_mfma_f32_16x16x32_bf16 a[220:223], v[92:95], v[44:47], a[220:223]
s_waitcnt lgkmcnt(2)
v_mfma_f32_16x16x32_bf16 a[224:227], v[64:67], v[48:51], a[224:227]
ds_read_b128 v[40:43], v2 offset:16384
v_mfma_f32_16x16x32_bf16 a[224:227], v[68:71], v[52:55], a[224:227]
ds_read_b128 v[44:47], v3 offset:16384
v_mfma_f32_16x16x32_bf16 a[228:231], v[72:75], v[48:51], a[228:231]
v_mfma_f32_16x16x32_bf16 a[228:231], v[76:79], v[52:55], a[228:231]
v_mfma_f32_16x16x32_bf16 a[232:235], v[80:83], v[48:51], a[232:235]
v_mfma_f32_16x16x32_bf16 a[232:235], v[84:87], v[52:55], a[232:235]
v_mfma_f32_16x16x32_bf16 a[236:239], v[88:91], v[48:51], a[236:239]
v_mfma_f32_16x16x32_bf16 a[236:239], v[92:95], v[52:55], a[236:239]
s_waitcnt lgkmcnt(2)
v_mfma_f32_16x16x32_bf16 a[240:243], v[64:67], v[56:59], a[240:243]
ds_read_b128 v[48:51], v2 offset:18432
buffer_load_dwordx4 v[64:67], v1, s[12:15], s33 offen offset:0 sc1
v_mfma_f32_16x16x32_bf16 a[240:243], v[68:71], v[60:63], a[240:243]
ds_read_b128 v[52:55], v3 offset:18432
v_mfma_f32_16x16x32_bf16 a[244:247], v[72:75], v[56:59], a[244:247]
v_mfma_f32_16x16x32_bf16 a[244:247], v[76:79], v[60:63], a[244:247]
buffer_load_dwordx4 v[68:71], v1, s[12:15], s33 offen offset:1024 sc1
v_mfma_f32_16x16x32_bf16 a[248:251], v[80:83], v[56:59], a[248:251]
v_mfma_f32_16x16x32_bf16 a[248:251], v[84:87], v[60:63], a[248:251]
v_mfma_f32_16x16x32_bf16 a[252:255], v[88:91], v[56:59], a[252:255]
buffer_load_dwordx4 v[72:75], v1, s[12:15], s33 offen offset:2048 sc1
v_mfma_f32_16x16x32_bf16 a[252:255], v[92:95], v[60:63], a[252:255]
s_waitcnt vmcnt(13) lgkmcnt(2)
v_mfma_f32_16x16x32_bf16 a[128:131], v[96:99], v[40:43], a[128:131]
ds_read_b128 v[56:59], v2 offset:20480
v_mfma_f32_16x16x32_bf16 a[128:131], v[100:103], v[44:47], a[128:131]
ds_read_b128 v[60:63], v3 offset:20480
buffer_load_dwordx4 v[76:79], v1, s[12:15], s33 offen offset:3072 sc1
s_waitcnt vmcnt(12)
v_mfma_f32_16x16x32_bf16 a[132:135], v[104:107], v[40:43], a[132:135]
v_mfma_f32_16x16x32_bf16 a[132:135], v[108:111], v[44:47], a[132:135]
s_waitcnt vmcnt(10)
v_mfma_f32_16x16x32_bf16 a[136:139], v[112:115], v[40:43], a[136:139]
buffer_load_dwordx4 v[80:83], v1, s[12:15], s34 offen offset:0 sc1
v_mfma_f32_16x16x32_bf16 a[136:139], v[116:119], v[44:47], a[136:139]
s_waitcnt vmcnt(9)
v_mfma_f32_16x16x32_bf16 a[140:143], v[120:123], v[40:43], a[140:143]
v_mfma_f32_16x16x32_bf16 a[140:143], v[124:127], v[44:47], a[140:143]
buffer_load_dwordx4 v[84:87], v1, s[12:15], s34 offen offset:1024 sc1
s_waitcnt lgkmcnt(2)
v_mfma_f32_16x16x32_bf16 a[144:147], v[96:99], v[48:51], a[144:147]
ds_read_b128 v[40:43], v2 offset:22528
v_mfma_f32_16x16x32_bf16 a[144:147], v[100:103], v[52:55], a[144:147]
ds_read_b128 v[44:47], v3 offset:22528
v_mfma_f32_16x16x32_bf16 a[148:151], v[104:107], v[48:51], a[148:151]
buffer_load_dwordx4 v[88:91], v1, s[12:15], s34 offen offset:2048 sc1
v_mfma_f32_16x16x32_bf16 a[148:151], v[108:111], v[52:55], a[148:151]
v_mfma_f32_16x16x32_bf16 a[152:155], v[112:115], v[48:51], a[152:155]
v_mfma_f32_16x16x32_bf16 a[152:155], v[116:119], v[52:55], a[152:155]
buffer_load_dwordx4 v[92:95], v1, s[12:15], s34 offen offset:3072 sc1
s_add_u32 s33, s33, 0x8000
s_add_u32 s34, s34, 0x8000
v_mfma_f32_16x16x32_bf16 a[156:159], v[120:123], v[48:51], a[156:159]
v_mfma_f32_16x16x32_bf16 a[156:159], v[124:127], v[52:55], a[156:159]
s_waitcnt lgkmcnt(2)
v_mfma_f32_16x16x32_bf16 a[160:163], v[96:99], v[56:59], a[160:163]
ds_read_b128 v[48:51], v2 offset:24576
v_mfma_f32_16x16x32_bf16 a[160:163], v[100:103], v[60:63], a[160:163]
ds_read_b128 v[52:55], v3 offset:24576
v_mfma_f32_16x16x32_bf16 a[164:167], v[104:107], v[56:59], a[164:167]
v_mfma_f32_16x16x32_bf16 a[164:167], v[108:111], v[60:63], a[164:167]
v_perm_b32 v32, v242, v240, s100
v_mfma_f32_16x16x32_bf16 a[168:171], v[112:115], v[56:59], a[168:171]
v_perm_b32 v33, v246, v244, s100
v_mfma_f32_16x16x32_bf16 a[168:171], v[116:119], v[60:63], a[168:171]
v_perm_b32 v34, v250, v248, s100
v_mfma_f32_16x16x32_bf16 a[172:175], v[120:123], v[56:59], a[172:175]
v_perm_b32 v35, v254, v252, s100
v_mfma_f32_16x16x32_bf16 a[172:175], v[124:127], v[60:63], a[172:175]
buffer_store_dwordx4 v[32:35], v1, s[12:15], s89 offen offset:0 sc1
s_waitcnt lgkmcnt(2)
v_mfma_f32_16x16x32_bf16 a[176:179], v[96:99], v[40:43], a[176:179]
ds_read_b128 v[56:59], v2 offset:26624
v_mfma_f32_16x16x32_bf16 a[176:179], v[100:103], v[44:47], a[176:179]
ds_read_b128 v[60:63], v3 offset:26624
v_mfma_f32_16x16x32_bf16 a[180:183], v[104:107], v[40:43], a[180:183]
v_mfma_f32_16x16x32_bf16 a[180:183], v[108:111], v[44:47], a[180:183]
v_perm_b32 v36, v242, v240, s101
v_mfma_f32_16x16x32_bf16 a[184:187], v[112:115], v[40:43], a[184:187]
v_perm_b32 v37, v246, v244, s101
v_mfma_f32_16x16x32_bf16 a[184:187], v[116:119], v[44:47], a[184:187]
v_perm_b32 v38, v250, v248, s101
v_mfma_f32_16x16x32_bf16 a[188:191], v[120:123], v[40:43], a[188:191]
v_perm_b32 v39, v254, v252, s101
v_mfma_f32_16x16x32_bf16 a[188:191], v[124:127], v[44:47], a[188:191]
buffer_store_dwordx4 v[36:39], v1, s[12:15], s89 offen offset:2048 sc1
s_waitcnt lgkmcnt(2)
v_mfma_f32_16x16x32_bf16 a[192:195], v[96:99], v[48:51], a[192:195]
ds_read_b128 v[40:43], v2 offset:28672
v_mfma_f32_16x16x32_bf16 a[192:195], v[100:103], v[52:55], a[192:195]
ds_read_b128 v[44:47], v3 offset:28672
v_mfma_f32_16x16x32_bf16 a[196:199], v[104:107], v[48:51], a[196:199]
v_mfma_f32_16x16x32_bf16 a[196:199], v[108:111], v[52:55], a[196:199]
v_perm_b32 v32, v243, v241, s100
v_mfma_f32_16x16x32_bf16 a[200:203], v[112:115], v[48:51], a[200:203]
v_perm_b32 v33, v247, v245, s100
v_mfma_f32_16x16x32_bf16 a[200:203], v[116:119], v[52:55], a[200:203]
v_perm_b32 v34, v251, v249, s100
v_mfma_f32_16x16x32_bf16 a[204:207], v[120:123], v[48:51], a[204:207]
v_perm_b32 v35, v255, v253, s100
v_mfma_f32_16x16x32_bf16 a[204:207], v[124:127], v[52:55], a[204:207]
s_add_u32 s89, s89, 0x1000
s_waitcnt lgkmcnt(2)
v_mfma_f32_16x16x32_bf16 a[208:211], v[96:99], v[56:59], a[208:211]
ds_read_b128 v[48:51], v2 offset:30720
v_mfma_f32_16x16x32_bf16 a[208:211], v[100:103], v[60:63], a[208:211]
ds_read_b128 v[52:55], v3 offset:30720
v_mfma_f32_16x16x32_bf16 a[212:215], v[104:107], v[56:59], a[212:215]
v_mfma_f32_16x16x32_bf16 a[212:215], v[108:111], v[60:63], a[212:215]
buffer_store_dwordx4 v[32:35], v1, s[12:15], s89 offen offset:0 sc1
v_mfma_f32_16x16x32_bf16 a[216:219], v[112:115], v[56:59], a[216:219]
v_perm_b32 v36, v243, v241, s101
v_mfma_f32_16x16x32_bf16 a[216:219], v[116:119], v[60:63], a[216:219]
v_perm_b32 v37, v247, v245, s101
v_mfma_f32_16x16x32_bf16 a[220:223], v[120:123], v[56:59], a[220:223]
v_perm_b32 v38, v251, v249, s101
v_mfma_f32_16x16x32_bf16 a[220:223], v[124:127], v[60:63], a[220:223]
v_perm_b32 v39, v255, v253, s101
s_waitcnt lgkmcnt(2)
v_mfma_f32_16x16x32_bf16 a[224:227], v[96:99], v[40:43], a[224:227]
ds_read_b128 v[56:59], v2 offset:32768
v_mfma_f32_16x16x32_bf16 a[224:227], v[100:103], v[44:47], a[224:227]
ds_read_b128 v[60:63], v3 offset:32768
v_mfma_f32_16x16x32_bf16 a[228:231], v[104:107], v[40:43], a[228:231]
v_mfma_f32_16x16x32_bf16 a[228:231], v[108:111], v[44:47], a[228:231]
buffer_store_dwordx4 v[36:39], v1, s[12:15], s89 offen offset:2048 sc1
v_mfma_f32_16x16x32_bf16 a[232:235], v[112:115], v[40:43], a[232:235]
v_mfma_f32_16x16x32_bf16 a[232:235], v[116:119], v[44:47], a[232:235]
v_mfma_f32_16x16x32_bf16 a[236:239], v[120:123], v[40:43], a[236:239]
v_mfma_f32_16x16x32_bf16 a[236:239], v[124:127], v[44:47], a[236:239]
s_waitcnt lgkmcnt(2)
v_mfma_f32_16x16x32_bf16 a[240:243], v[96:99], v[48:51], a[240:243]
ds_read_b128 v[40:43], v2 offset:34816
buffer_load_dwordx4 v[96:99], v1, s[12:15], s33 offen offset:0 sc1
v_mfma_f32_16x16x32_bf16 a[240:243], v[100:103], v[52:55], a[240:243]
ds_read_b128 v[44:47], v3 offset:34816
v_mfma_f32_16x16x32_bf16 a[244:247], v[104:107], v[48:51], a[244:247]
v_mfma_f32_16x16x32_bf16 a[244:247], v[108:111], v[52:55], a[244:247]
buffer_load_dwordx4 v[100:103], v1, s[12:15], s33 offen offset:1024 sc1
v_mfma_f32_16x16x32_bf16 a[248:251], v[112:115], v[48:51], a[248:251]
v_mfma_f32_16x16x32_bf16 a[248:251], v[116:119], v[52:55], a[248:251]
v_mfma_f32_16x16x32_bf16 a[252:255], v[120:123], v[48:51], a[252:255]
buffer_load_dwordx4 v[104:107], v1, s[12:15], s33 offen offset:2048 sc1
v_mfma_f32_16x16x32_bf16 a[252:255], v[124:127], v[52:55], a[252:255]
s_waitcnt vmcnt(13) lgkmcnt(2)
v_mfma_f32_16x16x32_bf16 a[128:131], v[64:67], v[56:59], a[128:131]
ds_read_b128 v[48:51], v2 offset:36864
v_mfma_f32_16x16x32_bf16 a[128:131], v[68:71], v[60:63], a[128:131]
ds_read_b128 v[52:55], v3 offset:36864
buffer_load_dwordx4 v[108:111], v1, s[12:15], s33 offen offset:3072 sc1
s_waitcnt vmcnt(12)
v_mfma_f32_16x16x32_bf16 a[132:135], v[72:75], v[56:59], a[132:135]
v_mfma_f32_16x16x32_bf16 a[132:135], v[76:79], v[60:63], a[132:135]
s_waitcnt vmcnt(10)
v_mfma_f32_16x16x32_bf16 a[136:139], v[80:83], v[56:59], a[136:139]
buffer_load_dwordx4 v[112:115], v1, s[12:15], s34 offen offset:0 sc1
v_mfma_f32_16x16x32_bf16 a[136:139], v[84:87], v[60:63], a[136:139]
s_waitcnt vmcnt(9)
v_mfma_f32_16x16x32_bf16 a[140:143], v[88:91], v[56:59], a[140:143]
v_mfma_f32_16x16x32_bf16 a[140:143], v[92:95], v[60:63], a[140:143]
buffer_load_dwordx4 v[116:119], v1, s[12:15], s34 offen offset:1024 sc1
s_waitcnt lgkmcnt(2)
v_mfma_f32_16x16x32_bf16 a[144:147], v[64:67], v[40:43], a[144:147]
ds_read_b128 v[56:59], v2 offset:38912
v_mfma_f32_16x16x32_bf16 a[144:147], v[68:71], v[44:47], a[144:147]
ds_read_b128 v[60:63], v3 offset:38912
v_mfma_f32_16x16x32_bf16 a[148:151], v[72:75], v[40:43], a[148:151]
buffer_load_dwordx4 v[120:123], v1, s[12:15], s34 offen offset:2048 sc1
v_mfma_f32_16x16x32_bf16 a[148:151], v[76:79], v[44:47], a[148:151]
v_mfma_f32_16x16x32_bf16 a[152:155], v[80:83], v[40:43], a[152:155]
v_mfma_f32_16x16x32_bf16 a[152:155], v[84:87], v[44:47], a[152:155]
buffer_load_dwordx4 v[124:127], v1, s[12:15], s34 offen offset:3072 sc1
s_add_u32 s33, s33, 0x8000
s_add_u32 s34, s34, 0x8000
v_mfma_f32_16x16x32_bf16 a[156:159], v[88:91], v[40:43], a[156:159]
v_mfma_f32_16x16x32_bf16 a[156:159], v[92:95], v[44:47], a[156:159]
s_waitcnt lgkmcnt(2)
v_mfma_f32_16x16x32_bf16 a[160:163], v[64:67], v[48:51], a[160:163]
ds_read_b128 v[40:43], v2 offset:40960
v_mfma_f32_16x16x32_bf16 a[160:163], v[68:71], v[52:55], a[160:163]
ds_read_b128 v[44:47], v3 offset:40960
v_mfma_f32_16x16x32_bf16 a[164:167], v[72:75], v[48:51], a[164:167]
v_mfma_f32_16x16x32_bf16 a[164:167], v[76:79], v[52:55], a[164:167]
v_mfma_f32_16x16x32_bf16 a[168:171], v[80:83], v[48:51], a[168:171]
s_add_u32 m0, s3, 0x1c000
v_mfma_f32_16x16x32_bf16 a[168:171], v[84:87], v[52:55], a[168:171]
buffer_load_dwordx4 v8, s[8:11], s35 offen nt lds
s_add_u32 s35, s35, 0x10000
v_mfma_f32_16x16x32_bf16 a[172:175], v[88:91], v[48:51], a[172:175]
s_add_u32 m0, s3, 0x1d000
v_mfma_f32_16x16x32_bf16 a[172:175], v[92:95], v[52:55], a[172:175]
buffer_load_dwordx4 v8, s[8:11], s35 offen nt lds
s_add_u32 s35, s35, 0x10000
s_waitcnt lgkmcnt(2)
v_mfma_f32_16x16x32_bf16 a[176:179], v[64:67], v[56:59], a[176:179]
ds_read_b128 v[48:51], v2 offset:43008
s_add_u32 m0, s3, 0x1e000
v_mfma_f32_16x16x32_bf16 a[176:179], v[68:71], v[60:63], a[176:179]
ds_read_b128 v[52:55], v3 offset:43008
buffer_load_dwordx4 v8, s[8:11], s35 offen nt lds
s_add_u32 s35, s35, 0x10000
v_mfma_f32_16x16x32_bf16 a[180:183], v[72:75], v[56:59], a[180:183]
s_add_u32 m0, s3, 0x1f000
v_mfma_f32_16x16x32_bf16 a[180:183], v[76:79], v[60:63], a[180:183]
buffer_load_dwordx4 v8, s[8:11], s35 offen nt lds
v_mfma_f32_16x16x32_bf16 a[184:187], v[80:83], v[56:59], a[184:187]
v_mfma_f32_16x16x32_bf16 a[184:187], v[84:87], v[60:63], a[184:187]
v_mfma_f32_16x16x32_bf16 a[188:191], v[88:91], v[56:59], a[188:191]
v_mfma_f32_16x16x32_bf16 a[188:191], v[92:95], v[60:63], a[188:191]
s_waitcnt lgkmcnt(2)
v_mfma_f32_16x16x32_bf16 a[192:195], v[64:67], v[40:43], a[192:195]
ds_read_b128 v[56:59], v2 offset:45056
v_mfma_f32_16x16x32_bf16 a[192:195], v[68:71], v[44:47], a[192:195]
ds_read_b128 v[60:63], v3 offset:45056
v_mfma_f32_16x16x32_bf16 a[196:199], v[72:75], v[40:43], a[196:199]
v_mfma_f32_16x16x32_bf16 a[196:199], v[76:79], v[44:47], a[196:199]
v_mfma_f32_16x16x32_bf16 a[200:203], v[80:83], v[40:43], a[200:203]
v_mfma_f32_16x16x32_bf16 a[200:203], v[84:87], v[44:47], a[200:203]
v_mfma_f32_16x16x32_bf16 a[204:207], v[88:91], v[40:43], a[204:207]
v_mfma_f32_16x16x32_bf16 a[204:207], v[92:95], v[44:47], a[204:207]
s_waitcnt lgkmcnt(2)
v_mfma_f32_16x16x32_bf16 a[208:211], v[64:67], v[48:51], a[208:211]
ds_read_b128 v[40:43], v2 offset:47104
v_mfma_f32_16x16x32_bf16 a[208:211], v[68:71], v[52:55], a[208:211]
ds_read_b128 v[44:47], v3 offset:47104
v_mfma_f32_16x16x32_bf16 a[212:215], v[72:75], v[48:51], a[212:215]
v_mfma_f32_16x16x32_bf16 a[212:215], v[76:79], v[52:55], a[212:215]
v_mfma_f32_16x16x32_bf16 a[216:219], v[80:83], v[48:51], a[216:219]
v_mfma_f32_16x16x32_bf16 a[216:219], v[84:87], v[52:55], a[216:219]
v_mfma_f32_16x16x32_bf16 a[220:223], v[88:91], v[48:51], a[220:223]
v_mfma_f32_16x16x32_bf16 a[220:223], v[92:95], v[52:55], a[220:223]
s_waitcnt lgkmcnt(2)
v_mfma_f32_16x16x32_bf16 a[224:227], v[64:67], v[56:59], a[224:227]
ds_read_b128 v[48:51], v2 offset:49152
v_mfma_f32_16x16x32_bf16 a[224:227], v[68:71], v[60:63], a[224:227]
ds_read_b128 v[52:55], v3 offset:49152
v_mfma_f32_16x16x32_bf16 a[228:231], v[72:75], v[56:59], a[228:231]
v_mfma_f32_16x16x32_bf16 a[228:231], v[76:79], v[60:63], a[228:231]
v_mfma_f32_16x16x32_bf16 a[232:235], v[80:83], v[56:59], a[232:235]
v_mfma_f32_16x16x32_bf16 a[232:235], v[84:87], v[60:63], a[232:235]
v_mfma_f32_16x16x32_bf16 a[236:239], v[88:91], v[56:59], a[236:239]
v_mfma_f32_16x16x32_bf16 a[236:239], v[92:95], v[60:63], a[236:239]
s_waitcnt lgkmcnt(2)
v_mfma_f32_16x16x32_bf16 a[240:243], v[64:67], v[40:43], a[240:243]
ds_read_b128 v[56:59], v2 offset:51200
buffer_load_dwordx4 v[64:67], v1, s[12:15], s33 offen offset:0 sc1
v_mfma_f32_16x16x32_bf16 a[240:243], v[68:71], v[44:47], a[240:243]
ds_read_b128 v[60:63], v3 offset:51200
v_mfma_f32_16x16x32_bf16 a[244:247], v[72:75], v[40:43], a[244:247]
v_mfma_f32_16x16x32_bf16 a[244:247], v[76:79], v[44:47], a[244:247]
buffer_load_dwordx4 v[68:71], v1, s[12:15], s33 offen offset:1024 sc1
v_mfma_f32_16x16x32_bf16 a[248:251], v[80:83], v[40:43], a[248:251]
v_mfma_f32_16x16x32_bf16 a[248:251], v[84:87], v[44:47], a[248:251]
v_mfma_f32_16x16x32_bf16 a[252:255], v[88:91], v[40:43], a[252:255]
buffer_load_dwordx4 v[72:75], v1, s[12:15], s33 offen offset:2048 sc1
v_mfma_f32_16x16x32_bf16 a[252:255], v[92:95], v[44:47], a[252:255]
s_waitcnt vmcnt(13) lgkmcnt(2)
v_mfma_f32_16x16x32_bf16 a[128:131], v[96:99], v[48:51], a[128:131]
ds_read_b128 v[40:43], v2 offset:53248
v_mfma_f32_16x16x32_bf16 a[128:131], v[100:103], v[52:55], a[128:131]
ds_read_b128 v[44:47], v3 offset:53248
buffer_load_dwordx4 v[76:79], v1, s[12:15], s33 offen offset:3072 sc1
s_waitcnt vmcnt(12)
v_mfma_f32_16x16x32_bf16 a[132:135], v[104:107], v[48:51], a[132:135]
v_mfma_f32_16x16x32_bf16 a[132:135], v[108:111], v[52:55], a[132:135]
s_waitcnt vmcnt(10)
v_mfma_f32_16x16x32_bf16 a[136:139], v[112:115], v[48:51], a[136:139]
buffer_load_dwordx4 v[80:83], v1, s[12:15], s34 offen offset:0 sc1
v_mfma_f32_16x16x32_bf16 a[136:139], v[116:119], v[52:55], a[136:139]
s_waitcnt vmcnt(9)
v_mfma_f32_16x16x32_bf16 a[140:143], v[120:123], v[48:51], a[140:143]
v_mfma_f32_16x16x32_bf16 a[140:143], v[124:127], v[52:55], a[140:143]
buffer_load_dwordx4 v[84:87], v1, s[12:15], s34 offen offset:1024 sc1
s_waitcnt lgkmcnt(2)
v_mfma_f32_16x16x32_bf16 a[144:147], v[96:99], v[56:59], a[144:147]
ds_read_b128 v[48:51], v2 offset:55296
v_mfma_f32_16x16x32_bf16 a[144:147], v[100:103], v[60:63], a[144:147]
ds_read_b128 v[52:55], v3 offset:55296
v_mfma_f32_16x16x32_bf16 a[148:151], v[104:107], v[56:59], a[148:151]
buffer_load_dwordx4 v[88:91], v1, s[12:15], s34 offen offset:2048 sc1
v_mfma_f32_16x16x32_bf16 a[148:151], v[108:111], v[60:63], a[148:151]
v_mfma_f32_16x16x32_bf16 a[152:155], v[112:115], v[56:59], a[152:155]
v_mfma_f32_16x16x32_bf16 a[152:155], v[116:119], v[60:63], a[152:155]
buffer_load_dwordx4 v[92:95], v1, s[12:15], s34 offen offset:3072 sc1
s_add_u32 s33, s33, 0x8000
s_add_u32 s34, s34, 0x8000
v_mfma_f32_16x16x32_bf16 a[156:159], v[120:123], v[56:59], a[156:159]
v_mfma_f32_16x16x32_bf16 a[156:159], v[124:127], v[60:63], a[156:159]
s_waitcnt lgkmcnt(2)
v_mfma_f32_16x16x32_bf16 a[160:163], v[96:99], v[40:43], a[160:163]
ds_read_b128 v[56:59], v2 offset:57344
v_mfma_f32_16x16x32_bf16 a[160:163], v[100:103], v[44:47], a[160:163]
ds_read_b128 v[60:63], v3 offset:57344
v_mfma_f32_16x16x32_bf16 a[164:167], v[104:107], v[40:43], a[164:167]
v_mfma_f32_16x16x32_bf16 a[164:167], v[108:111], v[44:47], a[164:167]
v_mfma_f32_16x16x32_bf16 a[168:171], v[112:115], v[40:43], a[168:171]
v_mfma_f32_16x16x32_bf16 a[168:171], v[116:119], v[44:47], a[168:171]
v_mfma_f32_16x16x32_bf16 a[172:175], v[120:123], v[40:43], a[172:175]
v_mfma_f32_16x16x32_bf16 a[172:175], v[124:127], v[44:47], a[172:175]
s_waitcnt lgkmcnt(2)
v_mfma_f32_16x16x32_bf16 a[176:179], v[96:99], v[48:51], a[176:179]
ds_read_b128 v[40:43], v2 offset:59392
v_mfma_f32_16x16x32_bf16 a[176:179], v[100:103], v[52:55], a[176:179]
ds_read_b128 v[44:47], v3 offset:59392
v_mfma_f32_16x16x32_bf16 a[180:183], v[104:107], v[48:51], a[180:183]
v_mfma_f32_16x16x32_bf16 a[180:183], v[108:111], v[52:55], a[180:183]
v_mfma_f32_16x16x32_bf16 a[184:187], v[112:115], v[48:51], a[184:187]
v_mfma_f32_16x16x32_bf16 a[184:187], v[116:119], v[52:55], a[184:187]
v_mfma_f32_16x16x32_bf16 a[188:191], v[120:123], v[48:51], a[188:191]
v_mfma_f32_16x16x32_bf16 a[188:191], v[124:127], v[52:55], a[188:191]
s_waitcnt lgkmcnt(2)
v_mfma_f32_16x16x32_bf16 a[192:195], v[96:99], v[56:59], a[192:195]
ds_read_b128 v[48:51], v2 offset:61440
v_mfma_f32_16x16x32_bf16 a[192:195], v[100:103], v[60:63], a[192:195]
ds_read_b128 v[52:55], v3 offset:61440
v_mfma_f32_16x16x32_bf16 a[196:199], v[104:107], v[56:59], a[196:199]
v_mfma_f32_16x16x32_bf16 a[196:199], v[108:111], v[60:63], a[196:199]
v_mfma_f32_16x16x32_bf16 a[200:203], v[112:115], v[56:59], a[200:203]
v_mfma_f32_16x16x32_bf16 a[200:203], v[116:119], v[60:63], a[200:203]
v_mfma_f32_16x16x32_bf16 a[204:207], v[120:123], v[56:59], a[204:207]
v_mfma_f32_16x16x32_bf16 a[204:207], v[124:127], v[60:63], a[204:207]
s_waitcnt lgkmcnt(2)
v_mfma_f32_16x16x32_bf16 a[208:211], v[96:99], v[40:43], a[208:211]
ds_read_b128 v[56:59], v2 offset:63488
v_mfma_f32_16x16x32_bf16 a[208:211], v[100:103], v[44:47], a[208:211]
ds_read_b128 v[60:63], v3 offset:63488
v_mfma_f32_16x16x32_bf16 a[212:215], v[104:107], v[40:43], a[212:215]
v_mfma_f32_16x16x32_bf16 a[212:215], v[108:111], v[44:47], a[212:215]
v_mfma_f32_16x16x32_bf16 a[216:219], v[112:115], v[40:43], a[216:219]
v_mfma_f32_16x16x32_bf16 a[216:219], v[116:119], v[44:47], a[216:219]
v_mfma_f32_16x16x32_bf16 a[220:223], v[120:123], v[40:43], a[220:223]
v_mfma_f32_16x16x32_bf16 a[220:223], v[124:127], v[44:47], a[220:223]
s_waitcnt lgkmcnt(2)
v_mfma_f32_16x16x32_bf16 a[224:227], v[96:99], v[48:51], a[224:227]
v_mfma_f32_16x16x32_bf16 a[224:227], v[100:103], v[52:55], a[224:227]
v_mfma_f32_16x16x32_bf16 a[228:231], v[104:107], v[48:51], a[228:231]
v_mfma_f32_16x16x32_bf16 a[228:231], v[108:111], v[52:55], a[228:231]
v_mfma_f32_16x16x32_bf16 a[232:235], v[112:115], v[48:51], a[232:235]
v_mfma_f32_16x16x32_bf16 a[232:235], v[116:119], v[52:55], a[232:235]
v_mfma_f32_16x16x32_bf16 a[236:239], v[120:123], v[48:51], a[236:239]
v_mfma_f32_16x16x32_bf16 a[236:239], v[124:127], v[52:55], a[236:239]
s_waitcnt lgkmcnt(0)
s_barrier
v_mov_b32 v12, 1
s_lshl_b32 s5, s92, 7
s_cmp_eq_u32 s32, 0
s_cselect_b64 exec, 1, 0
buffer_atomic_add v12, off, s[80:83], s5 sc1
s_mov_b64 exec, -1
v_xor_b32 v2, 0x10000, v2
v_xor_b32 v3, 0x10000, v3
v_mfma_f32_16x16x32_bf16 a[240:243], v[96:99], v[56:59], a[240:243]
ds_read_b128 v[40:43], v2 offset:0
buffer_load_dwordx4 v[96:99], v1, s[12:15], s33 offen offset:0 sc1
v_mfma_f32_16x16x32_bf16 a[240:243], v[100:103], v[60:63], a[240:243]
ds_read_b128 v[44:47], v3 offset:0
v_mfma_f32_16x16x32_bf16 a[244:247], v[104:107], v[56:59], a[244:247]
ds_read_b128 v[48:51], v2 offset:2048
v_mfma_f32_16x16x32_bf16 a[244:247], v[108:111], v[60:63], a[244:247]
ds_read_b128 v[52:55], v3 offset:2048
buffer_load_dwordx4 v[100:103], v1, s[12:15], s33 offen offset:1024 sc1
v_mfma_f32_16x16x32_bf16 a[248:251], v[112:115], v[56:59], a[248:251]
v_mfma_f32_16x16x32_bf16 a[248:251], v[116:119], v[60:63], a[248:251]
v_mfma_f32_16x16x32_bf16 a[252:255], v[120:123], v[56:59], a[252:255]
buffer_load_dwordx4 v[104:107], v1, s[12:15], s33 offen offset:2048 sc1
v_mfma_f32_16x16x32_bf16 a[252:255], v[124:127], v[60:63], a[252:255]
s_waitcnt vmcnt(9) lgkmcnt(2)
v_mfma_f32_16x16x32_bf16 a[0:3], v[64:67], v[40:43], a[0:3]
ds_read_b128 v[56:59], v2 offset:4096
v_mfma_f32_16x16x32_bf16 a[0:3], v[68:71], v[44:47], a[0:3]
ds_read_b128 v[60:63], v3 offset:4096
buffer_load_dwordx4 v[108:111], v1, s[12:15], s33 offen offset:3072 sc1
s_waitcnt vmcnt(8)
v_mfma_f32_16x16x32_bf16 a[4:7], v[72:75], v[40:43], a[4:7]
v_mfma_f32_16x16x32_bf16 a[4:7], v[76:79], v[44:47], a[4:7]
s_waitcnt vmcnt(6)
v_mfma_f32_16x16x32_bf16 a[8:11], v[80:83], v[40:43], a[8:11]
buffer_load_dwordx4 v[112:115], v1, s[12:15], s34 offen offset:0 sc1
v_mfma_f32_16x16x32_bf16 a[8:11], v[84:87], v[44:47], a[8:11]
s_waitcnt vmcnt(5)
v_mfma_f32_16x16x32_bf16 a[12:15], v[88:91], v[40:43], a[12:15]
v_mfma_f32_16x16x32_bf16 a[12:15], v[92:95], v[44:47], a[12:15]
buffer_load_dwordx4 v[116:119], v1, s[12:15], s34 offen offset:1024 sc1
s_waitcnt lgkmcnt(2)
v_mfma_f32_16x16x32_bf16 a[16:19], v[64:67], v[48:51], a[16:19]
ds_read_b128 v[40:43], v2 offset:6144
v_mfma_f32_16x16x32_bf16 a[16:19], v[68:71], v[52:55], a[16:19]
ds_read_b128 v[44:47], v3 offset:6144
v_mfma_f32_16x16x32_bf16 a[20:23], v[72:75], v[48:51], a[20:23]
buffer_load_dwordx4 v[120:123], v1, s[12:15], s34 offen offset:2048 sc1
v_mfma_f32_16x16x32_bf16 a[20:23], v[76:79], v[52:55], a[20:23]
v_lshlrev_b32 v20, 2, v1
s_add_u32 s5, s7, L_cs2-standalone__cross_network_dcn__recsys_kernel
buffer_load_dword v22, v20, s[28:31], s5 offen
v_mfma_f32_16x16x32_bf16 a[24:27], v[80:83], v[48:51], a[24:27]
v_mfma_f32_16x16x32_bf16 a[24:27], v[84:87], v[52:55], a[24:27]
buffer_load_dwordx4 v[124:127], v1, s[12:15], s34 offen offset:3072 sc1
s_add_u32 s33, s33, 0x8000
s_add_u32 s34, s34, 0x8000
v_mfma_f32_16x16x32_bf16 a[28:31], v[88:91], v[48:51], a[28:31]
v_mfma_f32_16x16x32_bf16 a[28:31], v[92:95], v[52:55], a[28:31]
s_waitcnt lgkmcnt(2)
v_mfma_f32_16x16x32_bf16 a[32:35], v[64:67], v[56:59], a[32:35]
ds_read_b128 v[48:51], v2 offset:8192
v_mfma_f32_16x16x32_bf16 a[32:35], v[68:71], v[60:63], a[32:35]
ds_read_b128 v[52:55], v3 offset:8192
v_mfma_f32_16x16x32_bf16 a[36:39], v[72:75], v[56:59], a[36:39]
v_mfma_f32_16x16x32_bf16 a[36:39], v[76:79], v[60:63], a[36:39]
v_mfma_f32_16x16x32_bf16 a[40:43], v[80:83], v[56:59], a[40:43]
v_mfma_f32_16x16x32_bf16 a[40:43], v[84:87], v[60:63], a[40:43]
v_mfma_f32_16x16x32_bf16 a[44:47], v[88:91], v[56:59], a[44:47]
v_mfma_f32_16x16x32_bf16 a[44:47], v[92:95], v[60:63], a[44:47]
s_waitcnt lgkmcnt(2)
v_mfma_f32_16x16x32_bf16 a[48:51], v[64:67], v[40:43], a[48:51]
ds_read_b128 v[56:59], v2 offset:10240
v_mfma_f32_16x16x32_bf16 a[48:51], v[68:71], v[44:47], a[48:51]
ds_read_b128 v[60:63], v3 offset:10240
v_mfma_f32_16x16x32_bf16 a[52:55], v[72:75], v[40:43], a[52:55]
v_mfma_f32_16x16x32_bf16 a[52:55], v[76:79], v[44:47], a[52:55]
v_mfma_f32_16x16x32_bf16 a[56:59], v[80:83], v[40:43], a[56:59]
v_mfma_f32_16x16x32_bf16 a[56:59], v[84:87], v[44:47], a[56:59]
v_mfma_f32_16x16x32_bf16 a[60:63], v[88:91], v[40:43], a[60:63]
v_mfma_f32_16x16x32_bf16 a[60:63], v[92:95], v[44:47], a[60:63]
s_waitcnt lgkmcnt(2)
v_mfma_f32_16x16x32_bf16 a[64:67], v[64:67], v[48:51], a[64:67]
ds_read_b128 v[40:43], v2 offset:12288
v_mfma_f32_16x16x32_bf16 a[64:67], v[68:71], v[52:55], a[64:67]
ds_read_b128 v[44:47], v3 offset:12288
v_mfma_f32_16x16x32_bf16 a[68:71], v[72:75], v[48:51], a[68:71]
v_mfma_f32_16x16x32_bf16 a[68:71], v[76:79], v[52:55], a[68:71]
v_mfma_f32_16x16x32_bf16 a[72:75], v[80:83], v[48:51], a[72:75]
v_mfma_f32_16x16x32_bf16 a[72:75], v[84:87], v[52:55], a[72:75]
v_mfma_f32_16x16x32_bf16 a[76:79], v[88:91], v[48:51], a[76:79]
v_mfma_f32_16x16x32_bf16 a[76:79], v[92:95], v[52:55], a[76:79]
s_waitcnt lgkmcnt(2)
v_mfma_f32_16x16x32_bf16 a[80:83], v[64:67], v[56:59], a[80:83]
ds_read_b128 v[48:51], v2 offset:14336
v_mfma_f32_16x16x32_bf16 a[80:83], v[68:71], v[60:63], a[80:83]
ds_read_b128 v[52:55], v3 offset:14336
v_mfma_f32_16x16x32_bf16 a[84:87], v[72:75], v[56:59], a[84:87]
v_mfma_f32_16x16x32_bf16 a[84:87], v[76:79], v[60:63], a[84:87]
v_mfma_f32_16x16x32_bf16 a[88:91], v[80:83], v[56:59], a[88:91]
v_mfma_f32_16x16x32_bf16 a[88:91], v[84:87], v[60:63], a[88:91]
v_mfma_f32_16x16x32_bf16 a[92:95], v[88:91], v[56:59], a[92:95]
v_mfma_f32_16x16x32_bf16 a[92:95], v[92:95], v[60:63], a[92:95]
s_waitcnt lgkmcnt(2)
v_mfma_f32_16x16x32_bf16 a[96:99], v[64:67], v[40:43], a[96:99]
ds_read_b128 v[56:59], v2 offset:16384
v_mfma_f32_16x16x32_bf16 a[96:99], v[68:71], v[44:47], a[96:99]
ds_read_b128 v[60:63], v3 offset:16384
v_mfma_f32_16x16x32_bf16 a[100:103], v[72:75], v[40:43], a[100:103]
v_mfma_f32_16x16x32_bf16 a[100:103], v[76:79], v[44:47], a[100:103]
v_mfma_f32_16x16x32_bf16 a[104:107], v[80:83], v[40:43], a[104:107]
v_mfma_f32_16x16x32_bf16 a[104:107], v[84:87], v[44:47], a[104:107]
v_mfma_f32_16x16x32_bf16 a[108:111], v[88:91], v[40:43], a[108:111]
v_mfma_f32_16x16x32_bf16 a[108:111], v[92:95], v[44:47], a[108:111]
s_waitcnt lgkmcnt(2)
v_mfma_f32_16x16x32_bf16 a[112:115], v[64:67], v[48:51], a[112:115]
ds_read_b128 v[40:43], v2 offset:18432
buffer_load_dwordx4 v[64:67], v1, s[12:15], s33 offen offset:0 sc1
v_mfma_f32_16x16x32_bf16 a[112:115], v[68:71], v[52:55], a[112:115]
ds_read_b128 v[44:47], v3 offset:18432
v_mfma_f32_16x16x32_bf16 a[116:119], v[72:75], v[48:51], a[116:119]
v_mfma_f32_16x16x32_bf16 a[116:119], v[76:79], v[52:55], a[116:119]
buffer_load_dwordx4 v[68:71], v1, s[12:15], s33 offen offset:1024 sc1
v_mfma_f32_16x16x32_bf16 a[120:123], v[80:83], v[48:51], a[120:123]
v_mfma_f32_16x16x32_bf16 a[120:123], v[84:87], v[52:55], a[120:123]
v_mfma_f32_16x16x32_bf16 a[124:127], v[88:91], v[48:51], a[124:127]
buffer_load_dwordx4 v[72:75], v1, s[12:15], s33 offen offset:2048 sc1
v_mfma_f32_16x16x32_bf16 a[124:127], v[92:95], v[52:55], a[124:127]
s_waitcnt vmcnt(10) lgkmcnt(2)
v_mfma_f32_16x16x32_bf16 a[0:3], v[96:99], v[56:59], a[0:3]
ds_read_b128 v[48:51], v2 offset:20480
v_mfma_f32_16x16x32_bf16 a[0:3], v[100:103], v[60:63], a[0:3]
ds_read_b128 v[52:55], v3 offset:20480
buffer_load_dwordx4 v[76:79], v1, s[12:15], s33 offen offset:3072 sc1
s_waitcnt vmcnt(9)
v_mfma_f32_16x16x32_bf16 a[4:7], v[104:107], v[56:59], a[4:7]
v_mfma_f32_16x16x32_bf16 a[4:7], v[108:111], v[60:63], a[4:7]
v_lshlrev_b32 v20, 2, v1
s_add_u32 s5, s43, 0x180000
buffer_load_dword v21, v20, s[12:15], s5 offen sc1
s_waitcnt vmcnt(8)
v_mfma_f32_16x16x32_bf16 a[8:11], v[112:115], v[56:59], a[8:11]
buffer_load_dwordx4 v[80:83], v1, s[12:15], s34 offen offset:0 sc1
v_mfma_f32_16x16x32_bf16 a[8:11], v[116:119], v[60:63], a[8:11]
s_waitcnt vmcnt(6)
v_mfma_f32_16x16x32_bf16 a[12:15], v[120:123], v[56:59], a[12:15]
v_mfma_f32_16x16x32_bf16 a[12:15], v[124:127], v[60:63], a[12:15]
buffer_load_dwordx4 v[84:87], v1, s[12:15], s34 offen offset:1024 sc1
s_waitcnt lgkmcnt(2)
v_mfma_f32_16x16x32_bf16 a[16:19], v[96:99], v[40:43], a[16:19]
ds_read_b128 v[56:59], v2 offset:22528
v_mfma_f32_16x16x32_bf16 a[16:19], v[100:103], v[44:47], a[16:19]
ds_read_b128 v[60:63], v3 offset:22528
v_mfma_f32_16x16x32_bf16 a[20:23], v[104:107], v[40:43], a[20:23]
buffer_load_dwordx4 v[88:91], v1, s[12:15], s34 offen offset:2048 sc1
v_mfma_f32_16x16x32_bf16 a[20:23], v[108:111], v[44:47], a[20:23]
v_mfma_f32_16x16x32_bf16 a[24:27], v[112:115], v[40:43], a[24:27]
v_mfma_f32_16x16x32_bf16 a[24:27], v[116:119], v[44:47], a[24:27]
buffer_load_dwordx4 v[92:95], v1, s[12:15], s34 offen offset:3072 sc1
s_add_u32 s33, s33, 0x8000
s_add_u32 s34, s34, 0x8000
v_mfma_f32_16x16x32_bf16 a[28:31], v[120:123], v[40:43], a[28:31]
v_mfma_f32_16x16x32_bf16 a[28:31], v[124:127], v[44:47], a[28:31]
s_waitcnt lgkmcnt(2)
v_mfma_f32_16x16x32_bf16 a[32:35], v[96:99], v[48:51], a[32:35]
ds_read_b128 v[40:43], v2 offset:24576
v_mfma_f32_16x16x32_bf16 a[32:35], v[100:103], v[52:55], a[32:35]
ds_read_b128 v[44:47], v3 offset:24576
v_mfma_f32_16x16x32_bf16 a[36:39], v[104:107], v[48:51], a[36:39]
v_mfma_f32_16x16x32_bf16 a[36:39], v[108:111], v[52:55], a[36:39]
v_mfma_f32_16x16x32_bf16 a[40:43], v[112:115], v[48:51], a[40:43]
v_mfma_f32_16x16x32_bf16 a[40:43], v[116:119], v[52:55], a[40:43]
s_and_b32 s6, s37, 0x400
v_bfe_u32 v25, v9, 11, 2
v_lshlrev_b32 v25, 9, v25
v_xor_b32 v25, s6, v25
v_add_u32 v24, v9, v25
v_xor_b32 v25, 0x400, v25
v_add_u32 v8, v8, v25
s_and_b32 s38, s37, 0xfffffbff
v_mfma_f32_16x16x32_bf16 a[44:47], v[120:123], v[48:51], a[44:47]
v_mfma_f32_16x16x32_bf16 a[44:47], v[124:127], v[52:55], a[44:47]
s_waitcnt lgkmcnt(2)
v_mfma_f32_16x16x32_bf16 a[48:51], v[96:99], v[56:59], a[48:51]
ds_read_b128 v[48:51], v2 offset:26624
v_mfma_f32_16x16x32_bf16 a[48:51], v[100:103], v[60:63], a[48:51]
ds_read_b128 v[52:55], v3 offset:26624
v_mfma_f32_16x16x32_bf16 a[52:55], v[104:107], v[56:59], a[52:55]
v_mfma_f32_16x16x32_bf16 a[52:55], v[108:111], v[60:63], a[52:55]
v_mfma_f32_16x16x32_bf16 a[56:59], v[112:115], v[56:59], a[56:59]
v_mfma_f32_16x16x32_bf16 a[56:59], v[116:119], v[60:63], a[56:59]
v_mfma_f32_16x16x32_bf16 a[60:63], v[120:123], v[56:59], a[60:63]
v_mfma_f32_16x16x32_bf16 a[60:63], v[124:127], v[60:63], a[60:63]
s_waitcnt lgkmcnt(2)
v_mfma_f32_16x16x32_bf16 a[64:67], v[96:99], v[40:43], a[64:67]
ds_read_b128 v[56:59], v2 offset:28672
v_mfma_f32_16x16x32_bf16 a[64:67], v[100:103], v[44:47], a[64:67]
ds_read_b128 v[60:63], v3 offset:28672
v_mfma_f32_16x16x32_bf16 a[68:71], v[104:107], v[40:43], a[68:71]
v_mfma_f32_16x16x32_bf16 a[68:71], v[108:111], v[44:47], a[68:71]
v_mfma_f32_16x16x32_bf16 a[72:75], v[112:115], v[40:43], a[72:75]
v_mfma_f32_16x16x32_bf16 a[72:75], v[116:119], v[44:47], a[72:75]
v_mfma_f32_16x16x32_bf16 a[76:79], v[120:123], v[40:43], a[76:79]
v_mfma_f32_16x16x32_bf16 a[76:79], v[124:127], v[44:47], a[76:79]
s_waitcnt lgkmcnt(2)
v_mfma_f32_16x16x32_bf16 a[80:83], v[96:99], v[48:51], a[80:83]
ds_read_b128 v[40:43], v2 offset:30720
v_mfma_f32_16x16x32_bf16 a[80:83], v[100:103], v[52:55], a[80:83]
ds_read_b128 v[44:47], v3 offset:30720
v_mfma_f32_16x16x32_bf16 a[84:87], v[104:107], v[48:51], a[84:87]
v_mfma_f32_16x16x32_bf16 a[84:87], v[108:111], v[52:55], a[84:87]
v_mfma_f32_16x16x32_bf16 a[88:91], v[112:115], v[48:51], a[88:91]
v_mfma_f32_16x16x32_bf16 a[88:91], v[116:119], v[52:55], a[88:91]
v_mfma_f32_16x16x32_bf16 a[92:95], v[120:123], v[48:51], a[92:95]
v_mfma_f32_16x16x32_bf16 a[92:95], v[124:127], v[52:55], a[92:95]
s_waitcnt lgkmcnt(2)
v_mfma_f32_16x16x32_bf16 a[96:99], v[96:99], v[56:59], a[96:99]
v_mfma_f32_16x16x32_bf16 a[96:99], v[100:103], v[60:63], a[96:99]
v_mfma_f32_16x16x32_bf16 a[100:103], v[104:107], v[56:59], a[100:103]
v_mfma_f32_16x16x32_bf16 a[100:103], v[108:111], v[60:63], a[100:103]
v_mfma_f32_16x16x32_bf16 a[104:107], v[112:115], v[56:59], a[104:107]
v_mfma_f32_16x16x32_bf16 a[104:107], v[116:119], v[60:63], a[104:107]
v_mfma_f32_16x16x32_bf16 a[108:111], v[120:123], v[56:59], a[108:111]
v_mfma_f32_16x16x32_bf16 a[108:111], v[124:127], v[60:63], a[108:111]
s_waitcnt lgkmcnt(0)
s_barrier
v_mfma_f32_16x16x32_bf16 a[112:115], v[96:99], v[40:43], a[112:115]
ds_read_b128 v[48:51], v2 offset:32768
buffer_load_dwordx4 v[96:99], v1, s[12:15], s33 offen offset:0 sc1
v_mfma_f32_16x16x32_bf16 a[112:115], v[100:103], v[44:47], a[112:115]
ds_read_b128 v[52:55], v3 offset:32768
v_mfma_f32_16x16x32_bf16 a[116:119], v[104:107], v[40:43], a[116:119]
ds_read_b128 v[56:59], v2 offset:34816
v_mfma_f32_16x16x32_bf16 a[116:119], v[108:111], v[44:47], a[116:119]
ds_read_b128 v[60:63], v3 offset:34816
buffer_load_dwordx4 v[100:103], v1, s[12:15], s33 offen offset:1024 sc1
v_mfma_f32_16x16x32_bf16 a[120:123], v[112:115], v[40:43], a[120:123]
v_mfma_f32_16x16x32_bf16 a[120:123], v[116:119], v[44:47], a[120:123]
v_mfma_f32_16x16x32_bf16 a[124:127], v[120:123], v[40:43], a[124:127]
buffer_load_dwordx4 v[104:107], v1, s[12:15], s33 offen offset:2048 sc1
v_mfma_f32_16x16x32_bf16 a[124:127], v[124:127], v[44:47], a[124:127]
s_waitcnt vmcnt(10) lgkmcnt(2)
v_mfma_f32_16x16x32_bf16 a[0:3], v[64:67], v[48:51], a[0:3]
ds_read_b128 v[40:43], v2 offset:36864
v_mfma_f32_16x16x32_bf16 a[0:3], v[68:71], v[52:55], a[0:3]
ds_read_b128 v[44:47], v3 offset:36864
buffer_load_dwordx4 v[108:111], v1, s[12:15], s33 offen offset:3072 sc1
s_waitcnt vmcnt(9)
v_mfma_f32_16x16x32_bf16 a[4:7], v[72:75], v[48:51], a[4:7]
v_mfma_f32_16x16x32_bf16 a[4:7], v[76:79], v[52:55], a[4:7]
s_waitcnt vmcnt(6)
v_mfma_f32_16x16x32_bf16 a[8:11], v[80:83], v[48:51], a[8:11]
buffer_load_dwordx4 v[112:115], v1, s[12:15], s34 offen offset:0 sc1
v_mfma_f32_16x16x32_bf16 a[8:11], v[84:87], v[52:55], a[8:11]
s_waitcnt vmcnt(5)
v_mfma_f32_16x16x32_bf16 a[12:15], v[88:91], v[48:51], a[12:15]
v_mfma_f32_16x16x32_bf16 a[12:15], v[92:95], v[52:55], a[12:15]
buffer_load_dwordx4 v[116:119], v1, s[12:15], s34 offen offset:1024 sc1
s_waitcnt lgkmcnt(2)
v_mfma_f32_16x16x32_bf16 a[16:19], v[64:67], v[56:59], a[16:19]
ds_read_b128 v[48:51], v2 offset:38912
v_mfma_f32_16x16x32_bf16 a[16:19], v[68:71], v[60:63], a[16:19]
ds_read_b128 v[52:55], v3 offset:38912
v_mfma_f32_16x16x32_bf16 a[20:23], v[72:75], v[56:59], a[20:23]
buffer_load_dwordx4 v[120:123], v1, s[12:15], s34 offen offset:2048 sc1
v_mfma_f32_16x16x32_bf16 a[20:23], v[76:79], v[60:63], a[20:23]
v_mfma_f32_16x16x32_bf16 a[24:27], v[80:83], v[56:59], a[24:27]
v_mfma_f32_16x16x32_bf16 a[24:27], v[84:87], v[60:63], a[24:27]
buffer_load_dwordx4 v[124:127], v1, s[12:15], s34 offen offset:3072 sc1
s_add_u32 s33, s33, 0x8000
s_add_u32 s34, s34, 0x8000
v_mfma_f32_16x16x32_bf16 a[28:31], v[88:91], v[56:59], a[28:31]
v_mfma_f32_16x16x32_bf16 a[28:31], v[92:95], v[60:63], a[28:31]
s_waitcnt lgkmcnt(2)
v_mfma_f32_16x16x32_bf16 a[32:35], v[64:67], v[40:43], a[32:35]
ds_read_b128 v[56:59], v2 offset:40960
v_mfma_f32_16x16x32_bf16 a[32:35], v[68:71], v[44:47], a[32:35]
ds_read_b128 v[60:63], v3 offset:40960
v_mfma_f32_16x16x32_bf16 a[36:39], v[72:75], v[40:43], a[36:39]
v_mfma_f32_16x16x32_bf16 a[36:39], v[76:79], v[44:47], a[36:39]
v_xor_b32 v4, 0x10000, v4
v_mfma_f32_16x16x32_bf16 a[40:43], v[80:83], v[40:43], a[40:43]
v_xor_b32 v5, 0x10000, v5
v_mfma_f32_16x16x32_bf16 a[40:43], v[84:87], v[44:47], a[40:43]
v_lshrrev_b32 v28, 8, v1
v_mul_u32_u24 v28, 316, v28
v_add_u32 v10, v10, v1
v_sub_u32 v10, v10, v28
v_mov_b32 v29, 0
v_mov_b32 v30, 1.0
v_mov_b32 v31, 0
v_mfma_f32_16x16x32_bf16 a[44:47], v[88:91], v[40:43], a[44:47]
v_mfma_f32_16x16x32_bf16 a[44:47], v[92:95], v[44:47], a[44:47]
s_waitcnt lgkmcnt(2)
v_mfma_f32_16x16x32_bf16 a[48:51], v[64:67], v[48:51], a[48:51]
ds_read_b128 v[40:43], v2 offset:43008
v_mfma_f32_16x16x32_bf16 a[48:51], v[68:71], v[52:55], a[48:51]
ds_read_b128 v[44:47], v3 offset:43008
v_mfma_f32_16x16x32_bf16 a[52:55], v[72:75], v[48:51], a[52:55]
v_mfma_f32_16x16x32_bf16 a[52:55], v[76:79], v[52:55], a[52:55]
ds_read_b128 v[192:195], v4 offset:0
v_mfma_f32_16x16x32_bf16 a[56:59], v[80:83], v[48:51], a[56:59]
ds_read_b128 v[196:199], v5 offset:0
v_mfma_f32_16x16x32_bf16 a[56:59], v[84:87], v[52:55], a[56:59]
ds_read_b128 v[200:203], v4 offset:2048
v_mfma_f32_16x16x32_bf16 a[60:63], v[88:91], v[48:51], a[60:63]
ds_read_b128 v[204:207], v5 offset:2048
v_mfma_f32_16x16x32_bf16 a[60:63], v[92:95], v[52:55], a[60:63]
ds_read_b128 v[208:211], v4 offset:4096
s_waitcnt lgkmcnt(7)
v_mfma_f32_16x16x32_bf16 a[64:67], v[64:67], v[56:59], a[64:67]
ds_read_b128 v[48:51], v2 offset:45056
v_mfma_f32_16x16x32_bf16 a[64:67], v[68:71], v[60:63], a[64:67]
ds_read_b128 v[52:55], v3 offset:45056
v_mfma_f32_16x16x32_bf16 a[68:71], v[72:75], v[56:59], a[68:71]
v_mfma_f32_16x16x32_bf16 a[68:71], v[76:79], v[60:63], a[68:71]
ds_read_b128 v[212:215], v5 offset:4096
v_mfma_f32_16x16x32_bf16 a[72:75], v[80:83], v[56:59], a[72:75]
ds_read_b128 v[216:219], v4 offset:6144
v_mfma_f32_16x16x32_bf16 a[72:75], v[84:87], v[60:63], a[72:75]
ds_read_b128 v[220:223], v5 offset:6144
v_mfma_f32_16x16x32_bf16 a[76:79], v[88:91], v[56:59], a[76:79]
ds_read_b128 v[224:227], v4 offset:8192
v_mfma_f32_16x16x32_bf16 a[76:79], v[92:95], v[60:63], a[76:79]
ds_read_b128 v[228:231], v5 offset:8192
s_waitcnt lgkmcnt(12)
v_mfma_f32_16x16x32_bf16 a[80:83], v[64:67], v[40:43], a[80:83]
ds_read_b128 v[56:59], v2 offset:47104
v_mfma_f32_16x16x32_bf16 a[80:83], v[68:71], v[44:47], a[80:83]
ds_read_b128 v[60:63], v3 offset:47104
v_mfma_f32_16x16x32_bf16 a[84:87], v[72:75], v[40:43], a[84:87]
v_mfma_f32_16x16x32_bf16 a[84:87], v[76:79], v[44:47], a[84:87]
ds_read_b128 v[232:235], v4 offset:10240
v_mfma_f32_16x16x32_bf16 a[88:91], v[80:83], v[40:43], a[88:91]
ds_read_b128 v[236:239], v5 offset:10240
v_mfma_f32_16x16x32_bf16 a[88:91], v[84:87], v[44:47], a[88:91]
ds_read_b128 v[240:243], v4 offset:12288
v_mfma_f32_16x16x32_bf16 a[92:95], v[88:91], v[40:43], a[92:95]
ds_read_b128 v[244:247], v5 offset:12288
v_mfma_f32_16x16x32_bf16 a[92:95], v[92:95], v[44:47], a[92:95]
ds_read_b128 v[248:251], v4 offset:14336
s_waitcnt lgkmcnt(12)
v_mfma_f32_16x16x32_bf16 a[96:99], v[64:67], v[48:51], a[96:99]
ds_read_b128 v[40:43], v2 offset:49152
v_mfma_f32_16x16x32_bf16 a[96:99], v[68:71], v[52:55], a[96:99]
ds_read_b128 v[44:47], v3 offset:49152
v_mfma_f32_16x16x32_bf16 a[100:103], v[72:75], v[48:51], a[100:103]
v_mfma_f32_16x16x32_bf16 a[100:103], v[76:79], v[52:55], a[100:103]
ds_read_b128 v[252:255], v5 offset:14336
v_mfma_f32_16x16x32_bf16 a[104:107], v[80:83], v[48:51], a[104:107]
v_mfma_f32_16x16x32_bf16 a[104:107], v[84:87], v[52:55], a[104:107]
v_mfma_f32_16x16x32_bf16 a[108:111], v[88:91], v[48:51], a[108:111]
v_mfma_f32_16x16x32_bf16 a[108:111], v[92:95], v[52:55], a[108:111]
s_waitcnt lgkmcnt(8)
v_mfma_f32_16x16x32_bf16 a[112:115], v[64:67], v[56:59], a[112:115]
ds_read_b128 v[48:51], v2 offset:51200
buffer_load_dwordx4 v[64:67], v1, s[12:15], s33 offen offset:0 sc1
v_mfma_f32_16x16x32_bf16 a[112:115], v[68:71], v[60:63], a[112:115]
ds_read_b128 v[52:55], v3 offset:51200
v_mfma_f32_16x16x32_bf16 a[116:119], v[72:75], v[56:59], a[116:119]
v_mfma_f32_16x16x32_bf16 a[116:119], v[76:79], v[60:63], a[116:119]
buffer_load_dwordx4 v[68:71], v1, s[12:15], s33 offen offset:1024 sc1
v_mfma_f32_16x16x32_bf16 a[120:123], v[80:83], v[56:59], a[120:123]
v_mfma_f32_16x16x32_bf16 a[120:123], v[84:87], v[60:63], a[120:123]
v_mfma_f32_16x16x32_bf16 a[124:127], v[88:91], v[56:59], a[124:127]
buffer_load_dwordx4 v[72:75], v1, s[12:15], s33 offen offset:2048 sc1
v_mfma_f32_16x16x32_bf16 a[124:127], v[92:95], v[60:63], a[124:127]
s_waitcnt vmcnt(9) lgkmcnt(3)
v_mfma_f32_16x16x32_bf16 a[0:3], v[96:99], v[40:43], a[0:3]
ds_read_b128 v[56:59], v2 offset:53248
v_mfma_f32_16x16x32_bf16 a[0:3], v[100:103], v[44:47], a[0:3]
ds_read_b128 v[60:63], v3 offset:53248
buffer_load_dwordx4 v[76:79], v1, s[12:15], s33 offen offset:3072 sc1
s_waitcnt vmcnt(8)
v_mfma_f32_16x16x32_bf16 a[4:7], v[104:107], v[40:43], a[4:7]
v_mfma_f32_16x16x32_bf16 a[4:7], v[108:111], v[44:47], a[4:7]
s_waitcnt vmcnt(6)
v_mfma_f32_16x16x32_bf16 a[8:11], v[112:115], v[40:43], a[8:11]
buffer_load_dwordx4 v[80:83], v1, s[12:15], s34 offen offset:0 sc1
v_mfma_f32_16x16x32_bf16 a[8:11], v[116:119], v[44:47], a[8:11]
s_waitcnt vmcnt(5)
v_mfma_f32_16x16x32_bf16 a[12:15], v[120:123], v[40:43], a[12:15]
v_mfma_f32_16x16x32_bf16 a[12:15], v[124:127], v[44:47], a[12:15]
buffer_load_dwordx4 v[84:87], v1, s[12:15], s34 offen offset:1024 sc1
s_waitcnt lgkmcnt(2)
v_mfma_f32_16x16x32_bf16 a[16:19], v[96:99], v[48:51], a[16:19]
ds_read_b128 v[40:43], v2 offset:55296
v_mfma_f32_16x16x32_bf16 a[16:19], v[100:103], v[52:55], a[16:19]
ds_read_b128 v[44:47], v3 offset:55296
v_mfma_f32_16x16x32_bf16 a[20:23], v[104:107], v[48:51], a[20:23]
buffer_load_dwordx4 v[88:91], v1, s[12:15], s34 offen offset:2048 sc1
v_xor_b32 v4, 0x10000, v4
v_mfma_f32_16x16x32_bf16 a[20:23], v[108:111], v[52:55], a[20:23]
v_xor_b32 v5, 0x10000, v5
v_accvgpr_read_b32 v12, a0
v_mfma_f32_16x16x32_bf16 a[24:27], v[112:115], v[48:51], a[24:27]
v_accvgpr_read_b32 v13, a4
v_lshlrev_b32 v16, 16, v128
v_mfma_f32_16x16x32_bf16 a[24:27], v[116:119], v[52:55], a[24:27]
buffer_load_dwordx4 v[92:95], v1, s[12:15], s34 offen offset:3072 sc1
s_add_u32 s33, s33, 0x8000
s_add_u32 s34, s34, 0x8000
v_mfma_f32_16x16x32_bf16 a[28:31], v[120:123], v[48:51], a[28:31]
v_and_b32 v17, 0xffff0000, v128
v_mfma_f32_16x16x32_bf16 a[28:31], v[124:127], v[52:55], a[28:31]
v_mul_f32 v12, v12, v16
v_mul_f32 v13, v13, v17
s_waitcnt lgkmcnt(2)
v_mfma_f32_16x16x32_bf16 a[32:35], v[96:99], v[56:59], a[32:35]
ds_read_b128 v[48:51], v2 offset:57344
v_mfma_f32_16x16x32_bf16 a[32:35], v[100:103], v[60:63], a[32:35]
ds_read_b128 v[52:55], v3 offset:57344
v_cvt_pk_bf16_f32 v20, v12, v13
v_accvgpr_read_b32 v14, a8
v_mfma_f32_16x16x32_bf16 a[36:39], v[104:107], v[56:59], a[36:39]
v_accvgpr_read_b32 v15, a12
v_lshlrev_b32 v18, 16, v129
v_mfma_f32_16x16x32_bf16 a[36:39], v[108:111], v[60:63], a[36:39]
v_and_b32 v19, 0xffff0000, v129
v_mul_f32 v14, v14, v18
v_mfma_f32_16x16x32_bf16 a[40:43], v[112:115], v[56:59], a[40:43]
v_mul_f32 v15, v15, v19
v_cvt_pk_bf16_f32 v21, v14, v15
v_mfma_f32_16x16x32_bf16 a[40:43], v[116:119], v[60:63], a[40:43]
v_accvgpr_read_b32 v12, a1
v_accvgpr_read_b32 v13, a5
v_mfma_f32_16x16x32_bf16 a[44:47], v[120:123], v[56:59], a[44:47]
v_lshlrev_b32 v16, 16, v130
v_and_b32 v17, 0xffff0000, v130
v_mfma_f32_16x16x32_bf16 a[44:47], v[124:127], v[60:63], a[44:47]
v_mul_f32 v12, v12, v16
v_mul_f32 v13, v13, v17
s_waitcnt lgkmcnt(2)
v_mfma_f32_16x16x32_bf16 a[48:51], v[96:99], v[40:43], a[48:51]
ds_read_b128 v[56:59], v2 offset:59392
v_mfma_f32_16x16x32_bf16 a[48:51], v[100:103], v[44:47], a[48:51]
ds_read_b128 v[60:63], v3 offset:59392
v_cvt_pk_bf16_f32 v22, v12, v13
v_accvgpr_read_b32 v14, a9
v_mfma_f32_16x16x32_bf16 a[52:55], v[104:107], v[40:43], a[52:55]
v_accvgpr_read_b32 v15, a13
v_lshlrev_b32 v18, 16, v131
v_mfma_f32_16x16x32_bf16 a[52:55], v[108:111], v[44:47], a[52:55]
v_and_b32 v19, 0xffff0000, v131
v_mul_f32 v14, v14, v18
v_mfma_f32_16x16x32_bf16 a[56:59], v[112:115], v[40:43], a[56:59]
v_mul_f32 v15, v15, v19
v_cvt_pk_bf16_f32 v23, v14, v15
v_mfma_f32_16x16x32_bf16 a[56:59], v[116:119], v[44:47], a[56:59]
ds_write_b128 v4, v[20:23] offset:0
v_accvgpr_read_b32 v12, a16
v_mfma_f32_16x16x32_bf16 a[60:63], v[120:123], v[40:43], a[60:63]
v_accvgpr_read_b32 v13, a20
v_lshlrev_b32 v16, 16, v136
v_mfma_f32_16x16x32_bf16 a[60:63], v[124:127], v[44:47], a[60:63]
v_and_b32 v17, 0xffff0000, v136
v_mul_f32 v12, v12, v16
s_waitcnt lgkmcnt(3)
v_mfma_f32_16x16x32_bf16 a[64:67], v[96:99], v[48:51], a[64:67]
ds_read_b128 v[40:43], v2 offset:61440
v_mfma_f32_16x16x32_bf16 a[64:67], v[100:103], v[52:55], a[64:67]
ds_read_b128 v[44:47], v3 offset:61440
v_mul_f32 v13, v13, v17
v_cvt_pk_bf16_f32 v20, v12, v13
v_mfma_f32_16x16x32_bf16 a[68:71], v[104:107], v[48:51], a[68:71]
v_accvgpr_read_b32 v14, a24
v_accvgpr_read_b32 v15, a28
v_mfma_f32_16x16x32_bf16 a[68:71], v[108:111], v[52:55], a[68:71]
v_lshlrev_b32 v18, 16, v137
v_and_b32 v19, 0xffff0000, v137
v_mfma_f32_16x16x32_bf16 a[72:75], v[112:115], v[48:51], a[72:75]
v_mul_f32 v14, v14, v18
v_mul_f32 v15, v15, v19
v_mfma_f32_16x16x32_bf16 a[72:75], v[116:119], v[52:55], a[72:75]
v_cvt_pk_bf16_f32 v21, v14, v15
v_accvgpr_read_b32 v12, a17
v_mfma_f32_16x16x32_bf16 a[76:79], v[120:123], v[48:51], a[76:79]
v_accvgpr_read_b32 v13, a21
v_lshlrev_b32 v16, 16, v138
v_mfma_f32_16x16x32_bf16 a[76:79], v[124:127], v[52:55], a[76:79]
v_and_b32 v17, 0xffff0000, v138
v_mul_f32 v12, v12, v16
s_waitcnt lgkmcnt(3)
v_mfma_f32_16x16x32_bf16 a[80:83], v[96:99], v[56:59], a[80:83]
ds_read_b128 v[48:51], v2 offset:63488
v_mfma_f32_16x16x32_bf16 a[80:83], v[100:103], v[60:63], a[80:83]
ds_read_b128 v[52:55], v3 offset:63488
v_mul_f32 v13, v13, v17
v_cvt_pk_bf16_f32 v22, v12, v13
v_mfma_f32_16x16x32_bf16 a[84:87], v[104:107], v[56:59], a[84:87]
v_accvgpr_read_b32 v14, a25
v_accvgpr_read_b32 v15, a29
v_mfma_f32_16x16x32_bf16 a[84:87], v[108:111], v[60:63], a[84:87]
v_lshlrev_b32 v18, 16, v139
v_and_b32 v19, 0xffff0000, v139
v_mfma_f32_16x16x32_bf16 a[88:91], v[112:115], v[56:59], a[88:91]
v_mul_f32 v14, v14, v18
v_mul_f32 v15, v15, v19
v_mfma_f32_16x16x32_bf16 a[88:91], v[116:119], v[60:63], a[88:91]
v_cvt_pk_bf16_f32 v23, v14, v15
ds_write_b128 v4, v[20:23] offset:2048
v_mfma_f32_16x16x32_bf16 a[92:95], v[120:123], v[56:59], a[92:95]
v_accvgpr_read_b32 v12, a32
v_accvgpr_read_b32 v13, a36
v_mfma_f32_16x16x32_bf16 a[92:95], v[124:127], v[60:63], a[92:95]
v_lshlrev_b32 v16, 16, v144
v_and_b32 v17, 0xffff0000, v144
s_waitcnt lgkmcnt(3)
v_mfma_f32_16x16x32_bf16 a[96:99], v[96:99], v[40:43], a[96:99]
ds_read_b128 v[56:59], v2 offset:0
v_mfma_f32_16x16x32_bf16 a[96:99], v[100:103], v[44:47], a[96:99]
ds_read_b128 v[60:63], v3 offset:0
v_mul_f32 v12, v12, v16
v_mul_f32 v13, v13, v17
v_mfma_f32_16x16x32_bf16 a[100:103], v[104:107], v[40:43], a[100:103]
v_cvt_pk_bf16_f32 v20, v12, v13
v_accvgpr_read_b32 v14, a40
v_mfma_f32_16x16x32_bf16 a[100:103], v[108:111], v[44:47], a[100:103]
v_accvgpr_read_b32 v15, a44
v_lshlrev_b32 v18, 16, v145
v_mfma_f32_16x16x32_bf16 a[104:107], v[112:115], v[40:43], a[104:107]
v_and_b32 v19, 0xffff0000, v145
v_mul_f32 v14, v14, v18
v_mfma_f32_16x16x32_bf16 a[104:107], v[116:119], v[44:47], a[104:107]
v_mul_f32 v15, v15, v19
v_cvt_pk_bf16_f32 v21, v14, v15
v_mfma_f32_16x16x32_bf16 a[108:111], v[120:123], v[40:43], a[108:111]
v_accvgpr_read_b32 v12, a33
v_accvgpr_read_b32 v13, a37
v_mfma_f32_16x16x32_bf16 a[108:111], v[124:127], v[44:47], a[108:111]
v_lshlrev_b32 v16, 16, v146
v_and_b32 v17, 0xffff0000, v146
s_waitcnt lgkmcnt(3)
v_mfma_f32_16x16x32_bf16 a[112:115], v[96:99], v[48:51], a[112:115]
ds_read_b128 v[40:43], v2 offset:2048
buffer_load_dwordx4 v[96:99], v1, s[12:15], s33 offen offset:0 sc1
v_mfma_f32_16x16x32_bf16 a[112:115], v[100:103], v[52:55], a[112:115]
ds_read_b128 v[44:47], v3 offset:2048
v_mul_f32 v12, v12, v16
v_mfma_f32_16x16x32_bf16 a[116:119], v[104:107], v[48:51], a[116:119]
v_mul_f32 v13, v13, v17
v_cvt_pk_bf16_f32 v22, v12, v13
v_mfma_f32_16x16x32_bf16 a[116:119], v[108:111], v[52:55], a[116:119]
buffer_load_dwordx4 v[100:103], v1, s[12:15], s33 offen offset:1024 sc1
v_accvgpr_read_b32 v14, a41
v_mfma_f32_16x16x32_bf16 a[120:123], v[112:115], v[48:51], a[120:123]
v_accvgpr_read_b32 v15, a45
v_lshlrev_b32 v18, 16, v147
v_mfma_f32_16x16x32_bf16 a[120:123], v[116:119], v[52:55], a[120:123]
v_and_b32 v19, 0xffff0000, v147
v_mul_f32 v14, v14, v18
v_mfma_f32_16x16x32_bf16 a[124:127], v[120:123], v[48:51], a[124:127]
buffer_load_dwordx4 v[104:107], v1, s[12:15], s33 offen offset:2048 sc1
v_mul_f32 v15, v15, v19
v_mfma_f32_16x16x32_bf16 a[124:127], v[124:127], v[52:55], a[124:127]
v_cvt_pk_bf16_f32 v23, v14, v15
ds_write_b128 v4, v[20:23] offset:4096
s_waitcnt vmcnt(9) lgkmcnt(3)
v_mfma_f32_16x16x32_bf16 a[128:131], v[64:67], v[56:59], a[128:131]
ds_read_b128 v[48:51], v2 offset:4096
v_accvgpr_read_b32 v12, a48
v_mfma_f32_16x16x32_bf16 a[128:131], v[68:71], v[60:63], a[128:131]
ds_read_b128 v[52:55], v3 offset:4096
buffer_load_dwordx4 v[108:111], v1, s[12:15], s33 offen offset:3072 sc1
s_waitcnt vmcnt(8)
v_mfma_f32_16x16x32_bf16 a[132:135], v[72:75], v[56:59], a[132:135]
v_accvgpr_read_b32 v13, a52
v_mfma_f32_16x16x32_bf16 a[132:135], v[76:79], v[60:63], a[132:135]
v_lshlrev_b32 v16, 16, v152
v_and_b32 v17, 0xffff0000, v152
s_waitcnt vmcnt(6)
v_mfma_f32_16x16x32_bf16 a[136:139], v[80:83], v[56:59], a[136:139]
buffer_load_dwordx4 v[112:115], v1, s[12:15], s34 offen offset:0 sc1
v_mfma_f32_16x16x32_bf16 a[136:139], v[84:87], v[60:63], a[136:139]
v_mul_f32 v12, v12, v16
v_mul_f32 v13, v13, v17
s_waitcnt vmcnt(5)
v_mfma_f32_16x16x32_bf16 a[140:143], v[88:91], v[56:59], a[140:143]
v_cvt_pk_bf16_f32 v20, v12, v13
v_mfma_f32_16x16x32_bf16 a[140:143], v[92:95], v[60:63], a[140:143]
buffer_load_dwordx4 v[116:119], v1, s[12:15], s34 offen offset:1024 sc1
v_accvgpr_read_b32 v14, a56
s_waitcnt lgkmcnt(3)
v_mfma_f32_16x16x32_bf16 a[144:147], v[64:67], v[40:43], a[144:147]
ds_read_b128 v[56:59], v2 offset:6144
v_accvgpr_read_b32 v15, a60
v_mfma_f32_16x16x32_bf16 a[144:147], v[68:71], v[44:47], a[144:147]
ds_read_b128 v[60:63], v3 offset:6144
v_lshlrev_b32 v18, 16, v153
v_mfma_f32_16x16x32_bf16 a[148:151], v[72:75], v[40:43], a[148:151]
buffer_load_dwordx4 v[120:123], v1, s[12:15], s34 offen offset:2048 sc1
v_and_b32 v19, 0xffff0000, v153
v_mfma_f32_16x16x32_bf16 a[148:151], v[76:79], v[44:47], a[148:151]
v_mul_f32 v14, v14, v18
v_mul_f32 v15, v15, v19
v_mfma_f32_16x16x32_bf16 a[152:155], v[80:83], v[40:43], a[152:155]
v_cvt_pk_bf16_f32 v21, v14, v15
v_accvgpr_read_b32 v12, a49
v_mfma_f32_16x16x32_bf16 a[152:155], v[84:87], v[44:47], a[152:155]
buffer_load_dwordx4 v[124:127], v1, s[12:15], s34 offen offset:3072 sc1
s_add_u32 s33, s33, 0x8000
s_add_u32 s34, s34, 0x8000
v_mfma_f32_16x16x32_bf16 a[156:159], v[88:91], v[40:43], a[156:159]
v_accvgpr_read_b32 v13, a53
v_mfma_f32_16x16x32_bf16 a[156:159], v[92:95], v[44:47], a[156:159]
v_lshlrev_b32 v16, 16, v154
v_and_b32 v17, 0xffff0000, v154
s_waitcnt lgkmcnt(2)
v_mfma_f32_16x16x32_bf16 a[160:163], v[64:67], v[48:51], a[160:163]
ds_read_b128 v[40:43], v2 offset:8192
v_mul_f32 v12, v12, v16
v_mfma_f32_16x16x32_bf16 a[160:163], v[68:71], v[52:55], a[160:163]
ds_read_b128 v[44:47], v3 offset:8192
v_mul_f32 v13, v13, v17
v_mfma_f32_16x16x32_bf16 a[164:167], v[72:75], v[48:51], a[164:167]
v_cvt_pk_bf16_f32 v22, v12, v13
v_accvgpr_read_b32 v14, a57
v_mfma_f32_16x16x32_bf16 a[164:167], v[76:79], v[52:55], a[164:167]
v_accvgpr_read_b32 v15, a61
v_lshlrev_b32 v18, 16, v155
v_mfma_f32_16x16x32_bf16 a[168:171], v[80:83], v[48:51], a[168:171]
v_and_b32 v19, 0xffff0000, v155
v_mul_f32 v14, v14, v18
v_mfma_f32_16x16x32_bf16 a[168:171], v[84:87], v[52:55], a[168:171]
v_mul_f32 v15, v15, v19
v_cvt_pk_bf16_f32 v23, v14, v15
v_mfma_f32_16x16x32_bf16 a[172:175], v[88:91], v[48:51], a[172:175]
ds_write_b128 v4, v[20:23] offset:6144
v_accvgpr_read_b32 v12, a64
v_mfma_f32_16x16x32_bf16 a[172:175], v[92:95], v[52:55], a[172:175]
v_accvgpr_read_b32 v13, a68
v_lshlrev_b32 v16, 16, v160
s_waitcnt lgkmcnt(3)
v_mfma_f32_16x16x32_bf16 a[176:179], v[64:67], v[56:59], a[176:179]
ds_read_b128 v[48:51], v2 offset:10240
v_and_b32 v17, 0xffff0000, v160
v_mfma_f32_16x16x32_bf16 a[176:179], v[68:71], v[60:63], a[176:179]
ds_read_b128 v[52:55], v3 offset:10240
v_mul_f32 v12, v12, v16
v_mfma_f32_16x16x32_bf16 a[180:183], v[72:75], v[56:59], a[180:183]
v_mul_f32 v13, v13, v17
v_cvt_pk_bf16_f32 v20, v12, v13
v_mfma_f32_16x16x32_bf16 a[180:183], v[76:79], v[60:63], a[180:183]
v_accvgpr_read_b32 v14, a72
v_accvgpr_read_b32 v15, a76
v_mfma_f32_16x16x32_bf16 a[184:187], v[80:83], v[56:59], a[184:187]
v_lshlrev_b32 v18, 16, v161
v_and_b32 v19, 0xffff0000, v161
v_mfma_f32_16x16x32_bf16 a[184:187], v[84:87], v[60:63], a[184:187]
v_mul_f32 v14, v14, v18
v_mul_f32 v15, v15, v19
v_mfma_f32_16x16x32_bf16 a[188:191], v[88:91], v[56:59], a[188:191]
v_cvt_pk_bf16_f32 v21, v14, v15
v_accvgpr_read_b32 v12, a65
v_mfma_f32_16x16x32_bf16 a[188:191], v[92:95], v[60:63], a[188:191]
v_accvgpr_read_b32 v13, a69
v_lshlrev_b32 v16, 16, v162
s_waitcnt lgkmcnt(3)
v_mfma_f32_16x16x32_bf16 a[192:195], v[64:67], v[40:43], a[192:195]
ds_read_b128 v[56:59], v2 offset:12288
v_and_b32 v17, 0xffff0000, v162
v_mfma_f32_16x16x32_bf16 a[192:195], v[68:71], v[44:47], a[192:195]
ds_read_b128 v[60:63], v3 offset:12288
v_mul_f32 v12, v12, v16
v_mfma_f32_16x16x32_bf16 a[196:199], v[72:75], v[40:43], a[196:199]
v_mul_f32 v13, v13, v17
v_cvt_pk_bf16_f32 v22, v12, v13
v_mfma_f32_16x16x32_bf16 a[196:199], v[76:79], v[44:47], a[196:199]
v_accvgpr_read_b32 v14, a73
v_accvgpr_read_b32 v15, a77
v_mfma_f32_16x16x32_bf16 a[200:203], v[80:83], v[40:43], a[200:203]
v_lshlrev_b32 v18, 16, v163
v_and_b32 v19, 0xffff0000, v163
v_mfma_f32_16x16x32_bf16 a[200:203], v[84:87], v[44:47], a[200:203]
v_mul_f32 v14, v14, v18
v_mul_f32 v15, v15, v19
v_mfma_f32_16x16x32_bf16 a[204:207], v[88:91], v[40:43], a[204:207]
v_cvt_pk_bf16_f32 v23, v14, v15
ds_write_b128 v4, v[20:23] offset:8192
v_mfma_f32_16x16x32_bf16 a[204:207], v[92:95], v[44:47], a[204:207]
v_accvgpr_read_b32 v12, a80
v_accvgpr_read_b32 v13, a84
s_waitcnt lgkmcnt(3)
v_mfma_f32_16x16x32_bf16 a[208:211], v[64:67], v[48:51], a[208:211]
ds_read_b128 v[40:43], v2 offset:14336
v_lshlrev_b32 v16, 16, v168
v_mfma_f32_16x16x32_bf16 a[208:211], v[68:71], v[52:55], a[208:211]
ds_read_b128 v[44:47], v3 offset:14336
v_and_b32 v17, 0xffff0000, v168
v_mfma_f32_16x16x32_bf16 a[212:215], v[72:75], v[48:51], a[212:215]
v_mul_f32 v12, v12, v16
v_mul_f32 v13, v13, v17
v_mfma_f32_16x16x32_bf16 a[212:215], v[76:79], v[52:55], a[212:215]
v_cvt_pk_bf16_f32 v20, v12, v13
v_accvgpr_read_b32 v14, a88
v_mfma_f32_16x16x32_bf16 a[216:219], v[80:83], v[48:51], a[216:219]
v_accvgpr_read_b32 v15, a92
v_lshlrev_b32 v18, 16, v169
v_mfma_f32_16x16x32_bf16 a[216:219], v[84:87], v[52:55], a[216:219]
v_and_b32 v19, 0xffff0000, v169
v_mul_f32 v14, v14, v18
v_mfma_f32_16x16x32_bf16 a[220:223], v[88:91], v[48:51], a[220:223]
v_mul_f32 v15, v15, v19
v_cvt_pk_bf16_f32 v21, v14, v15
v_mfma_f32_16x16x32_bf16 a[220:223], v[92:95], v[52:55], a[220:223]
v_accvgpr_read_b32 v12, a81
v_accvgpr_read_b32 v13, a85
v_lshlrev_b32 v16, 16, v170
s_waitcnt lgkmcnt(3)
v_mfma_f32_16x16x32_bf16 a[224:227], v[64:67], v[56:59], a[224:227]
ds_read_b128 v[48:51], v2 offset:16384
v_mfma_f32_16x16x32_bf16 a[224:227], v[68:71], v[60:63], a[224:227]
ds_read_b128 v[52:55], v3 offset:16384
v_and_b32 v17, 0xffff0000, v170
v_mfma_f32_16x16x32_bf16 a[228:231], v[72:75], v[56:59], a[228:231]
v_mul_f32 v12, v12, v16
v_mul_f32 v13, v13, v17
v_mfma_f32_16x16x32_bf16 a[228:231], v[76:79], v[60:63], a[228:231]
v_cvt_pk_bf16_f32 v22, v12, v13
v_accvgpr_read_b32 v14, a89
v_mfma_f32_16x16x32_bf16 a[232:235], v[80:83], v[56:59], a[232:235]
v_accvgpr_read_b32 v15, a93
v_lshlrev_b32 v18, 16, v171
v_mfma_f32_16x16x32_bf16 a[232:235], v[84:87], v[60:63], a[232:235]
v_and_b32 v19, 0xffff0000, v171
v_mul_f32 v14, v14, v18
v_mfma_f32_16x16x32_bf16 a[236:239], v[88:91], v[56:59], a[236:239]
v_mul_f32 v15, v15, v19
v_cvt_pk_bf16_f32 v23, v14, v15
v_mfma_f32_16x16x32_bf16 a[236:239], v[92:95], v[60:63], a[236:239]
ds_write_b128 v4, v[20:23] offset:10240
v_accvgpr_read_b32 v12, a96
v_accvgpr_read_b32 v13, a100
s_waitcnt lgkmcnt(3)
v_mfma_f32_16x16x32_bf16 a[240:243], v[64:67], v[40:43], a[240:243]
ds_read_b128 v[56:59], v2 offset:18432
buffer_load_dwordx4 v[64:67], v1, s[12:15], s33 offen offset:0 sc1
v_mfma_f32_16x16x32_bf16 a[240:243], v[68:71], v[44:47], a[240:243]
ds_read_b128 v[60:63], v3 offset:18432
v_mfma_f32_16x16x32_bf16 a[244:247], v[72:75], v[40:43], a[244:247]
v_lshlrev_b32 v16, 16, v176
v_and_b32 v17, 0xffff0000, v176
v_mfma_f32_16x16x32_bf16 a[244:247], v[76:79], v[44:47], a[244:247]
buffer_load_dwordx4 v[68:71], v1, s[12:15], s33 offen offset:1024 sc1
v_mul_f32 v12, v12, v16
v_mfma_f32_16x16x32_bf16 a[248:251], v[80:83], v[40:43], a[248:251]
v_mul_f32 v13, v13, v17
v_cvt_pk_bf16_f32 v20, v12, v13
v_mfma_f32_16x16x32_bf16 a[248:251], v[84:87], v[44:47], a[248:251]
v_accvgpr_read_b32 v14, a104
v_accvgpr_read_b32 v15, a108
v_mfma_f32_16x16x32_bf16 a[252:255], v[88:91], v[40:43], a[252:255]
buffer_load_dwordx4 v[72:75], v1, s[12:15], s33 offen offset:2048 sc1
v_lshlrev_b32 v18, 16, v177
v_mfma_f32_16x16x32_bf16 a[252:255], v[92:95], v[44:47], a[252:255]
v_and_b32 v19, 0xffff0000, v177
v_mul_f32 v14, v14, v18
v_mul_f32 v15, v15, v19
s_waitcnt vmcnt(9) lgkmcnt(3)
v_mfma_f32_16x16x32_bf16 a[128:131], v[96:99], v[48:51], a[128:131]
ds_read_b128 v[40:43], v2 offset:20480
v_mfma_f32_16x16x32_bf16 a[128:131], v[100:103], v[52:55], a[128:131]
ds_read_b128 v[44:47], v3 offset:20480
buffer_load_dwordx4 v[76:79], v1, s[12:15], s33 offen offset:3072 sc1
s_waitcnt vmcnt(8)
v_mfma_f32_16x16x32_bf16 a[132:135], v[104:107], v[48:51], a[132:135]
v_cvt_pk_bf16_f32 v21, v14, v15
v_mfma_f32_16x16x32_bf16 a[132:135], v[108:111], v[52:55], a[132:135]
v_accvgpr_read_b32 v12, a97
v_accvgpr_read_b32 v13, a101
s_waitcnt vmcnt(6)
v_mfma_f32_16x16x32_bf16 a[136:139], v[112:115], v[48:51], a[136:139]
buffer_load_dwordx4 v[80:83], v1, s[12:15], s34 offen offset:0 sc1
v_mfma_f32_16x16x32_bf16 a[136:139], v[116:119], v[52:55], a[136:139]
v_lshlrev_b32 v16, 16, v178
v_and_b32 v17, 0xffff0000, v178
s_waitcnt vmcnt(5)
v_mfma_f32_16x16x32_bf16 a[140:143], v[120:123], v[48:51], a[140:143]
v_mul_f32 v12, v12, v16
v_mfma_f32_16x16x32_bf16 a[140:143], v[124:127], v[52:55], a[140:143]
buffer_load_dwordx4 v[84:87], v1, s[12:15], s34 offen offset:1024 sc1
v_mul_f32 v13, v13, v17
v_cvt_pk_bf16_f32 v22, v12, v13
s_waitcnt lgkmcnt(2)
v_mfma_f32_16x16x32_bf16 a[144:147], v[96:99], v[56:59], a[144:147]
ds_read_b128 v[48:51], v2 offset:22528
v_mfma_f32_16x16x32_bf16 a[144:147], v[100:103], v[60:63], a[144:147]
ds_read_b128 v[52:55], v3 offset:22528
v_accvgpr_read_b32 v14, a105
v_mfma_f32_16x16x32_bf16 a[148:151], v[104:107], v[56:59], a[148:151]
buffer_load_dwordx4 v[88:91], v1, s[12:15], s34 offen offset:2048 sc1
v_accvgpr_read_b32 v15, a109
v_mfma_f32_16x16x32_bf16 a[148:151], v[108:111], v[60:63], a[148:151]
v_lshlrev_b32 v18, 16, v179
v_and_b32 v19, 0xffff0000, v179
v_mfma_f32_16x16x32_bf16 a[152:155], v[112:115], v[56:59], a[152:155]
v_mul_f32 v14, v14, v18
v_mul_f32 v15, v15, v19
v_mfma_f32_16x16x32_bf16 a[152:155], v[116:119], v[60:63], a[152:155]
buffer_load_dwordx4 v[92:95], v1, s[12:15], s34 offen offset:3072 sc1
s_add_u32 s33, s33, 0x8000
s_add_u32 s34, s34, 0x8000
v_mfma_f32_16x16x32_bf16 a[156:159], v[120:123], v[56:59], a[156:159]
v_cvt_pk_bf16_f32 v23, v14, v15
ds_write_b128 v4, v[20:23] offset:12288
v_mfma_f32_16x16x32_bf16 a[156:159], v[124:127], v[60:63], a[156:159]
v_accvgpr_read_b32 v12, a112
v_accvgpr_read_b32 v13, a116
s_waitcnt lgkmcnt(3)
v_mfma_f32_16x16x32_bf16 a[160:163], v[96:99], v[40:43], a[160:163]
ds_read_b128 v[56:59], v2 offset:24576
v_mfma_f32_16x16x32_bf16 a[160:163], v[100:103], v[44:47], a[160:163]
ds_read_b128 v[60:63], v3 offset:24576
v_lshlrev_b32 v16, 16, v184
v_mfma_f32_16x16x32_bf16 a[164:167], v[104:107], v[40:43], a[164:167]
v_and_b32 v17, 0xffff0000, v184
v_mul_f32 v12, v12, v16
v_mfma_f32_16x16x32_bf16 a[164:167], v[108:111], v[44:47], a[164:167]
v_mul_f32 v13, v13, v17
v_cvt_pk_bf16_f32 v20, v12, v13
v_mfma_f32_16x16x32_bf16 a[168:171], v[112:115], v[40:43], a[168:171]
v_accvgpr_read_b32 v14, a120
v_accvgpr_read_b32 v15, a124
v_mfma_f32_16x16x32_bf16 a[168:171], v[116:119], v[44:47], a[168:171]
v_lshlrev_b32 v18, 16, v185
v_and_b32 v19, 0xffff0000, v185
v_mfma_f32_16x16x32_bf16 a[172:175], v[120:123], v[40:43], a[172:175]
v_mul_f32 v14, v14, v18
v_mul_f32 v15, v15, v19
v_cvt_pk_bf16_f32 v21, v14, v15
v_mfma_f32_16x16x32_bf16 a[172:175], v[124:127], v[44:47], a[172:175]
v_accvgpr_read_b32 v12, a113
v_accvgpr_read_b32 v13, a117
s_waitcnt lgkmcnt(3)
v_mfma_f32_16x16x32_bf16 a[176:179], v[96:99], v[48:51], a[176:179]
ds_read_b128 v[40:43], v2 offset:26624
v_mfma_f32_16x16x32_bf16 a[176:179], v[100:103], v[52:55], a[176:179]
ds_read_b128 v[44:47], v3 offset:26624
v_lshlrev_b32 v16, 16, v186
v_mfma_f32_16x16x32_bf16 a[180:183], v[104:107], v[48:51], a[180:183]
v_and_b32 v17, 0xffff0000, v186
v_mul_f32 v12, v12, v16
v_mfma_f32_16x16x32_bf16 a[180:183], v[108:111], v[52:55], a[180:183]
v_mul_f32 v13, v13, v17
v_cvt_pk_bf16_f32 v22, v12, v13
v_mfma_f32_16x16x32_bf16 a[184:187], v[112:115], v[48:51], a[184:187]
v_accvgpr_read_b32 v14, a121
v_accvgpr_read_b32 v15, a125
v_mfma_f32_16x16x32_bf16 a[184:187], v[116:119], v[52:55], a[184:187]
v_lshlrev_b32 v18, 16, v187
v_and_b32 v19, 0xffff0000, v187
v_mul_f32 v14, v14, v18
v_mfma_f32_16x16x32_bf16 a[188:191], v[120:123], v[48:51], a[188:191]
v_mul_f32 v15, v15, v19
v_cvt_pk_bf16_f32 v23, v14, v15
v_mfma_f32_16x16x32_bf16 a[188:191], v[124:127], v[52:55], a[188:191]
ds_write_b128 v4, v[20:23] offset:14336
v_accvgpr_read_b32 v12, a2
s_waitcnt lgkmcnt(3)
v_mfma_f32_16x16x32_bf16 a[192:195], v[96:99], v[56:59], a[192:195]
ds_read_b128 v[48:51], v2 offset:28672
v_mfma_f32_16x16x32_bf16 a[192:195], v[100:103], v[60:63], a[192:195]
ds_read_b128 v[52:55], v3 offset:28672
v_accvgpr_read_b32 v13, a6
v_mfma_f32_16x16x32_bf16 a[196:199], v[104:107], v[56:59], a[196:199]
v_lshlrev_b32 v16, 16, v132
v_and_b32 v17, 0xffff0000, v132
v_mfma_f32_16x16x32_bf16 a[196:199], v[108:111], v[60:63], a[196:199]
v_mul_f32 v12, v12, v16
v_mul_f32 v13, v13, v17
v_mfma_f32_16x16x32_bf16 a[200:203], v[112:115], v[56:59], a[200:203]
v_cvt_pk_bf16_f32 v20, v12, v13
v_accvgpr_read_b32 v14, a10
v_mfma_f32_16x16x32_bf16 a[200:203], v[116:119], v[60:63], a[200:203]
v_accvgpr_read_b32 v15, a14
v_lshlrev_b32 v18, 16, v133
v_and_b32 v19, 0xffff0000, v133
v_mfma_f32_16x16x32_bf16 a[204:207], v[120:123], v[56:59], a[204:207]
v_mul_f32 v14, v14, v18
v_mul_f32 v15, v15, v19
v_mfma_f32_16x16x32_bf16 a[204:207], v[124:127], v[60:63], a[204:207]
v_cvt_pk_bf16_f32 v21, v14, v15
v_accvgpr_read_b32 v12, a3
s_waitcnt lgkmcnt(3)
v_mfma_f32_16x16x32_bf16 a[208:211], v[96:99], v[40:43], a[208:211]
ds_read_b128 v[56:59], v2 offset:30720
v_mfma_f32_16x16x32_bf16 a[208:211], v[100:103], v[44:47], a[208:211]
ds_read_b128 v[60:63], v3 offset:30720
v_accvgpr_read_b32 v13, a7
v_mfma_f32_16x16x32_bf16 a[212:215], v[104:107], v[40:43], a[212:215]
v_lshlrev_b32 v16, 16, v134
v_and_b32 v17, 0xffff0000, v134
v_mfma_f32_16x16x32_bf16 a[212:215], v[108:111], v[44:47], a[212:215]
v_mul_f32 v12, v12, v16
v_mul_f32 v13, v13, v17
v_mfma_f32_16x16x32_bf16 a[216:219], v[112:115], v[40:43], a[216:219]
v_cvt_pk_bf16_f32 v22, v12, v13
v_accvgpr_read_b32 v14, a11
v_accvgpr_read_b32 v15, a15
v_mfma_f32_16x16x32_bf16 a[216:219], v[116:119], v[44:47], a[216:219]
v_lshlrev_b32 v18, 16, v135
v_and_b32 v19, 0xffff0000, v135
v_mfma_f32_16x16x32_bf16 a[220:223], v[120:123], v[40:43], a[220:223]
v_mul_f32 v14, v14, v18
v_mul_f32 v15, v15, v19
v_mfma_f32_16x16x32_bf16 a[220:223], v[124:127], v[44:47], a[220:223]
v_cvt_pk_bf16_f32 v23, v14, v15
ds_write_b128 v5, v[20:23] offset:0
s_waitcnt lgkmcnt(3)
v_mfma_f32_16x16x32_bf16 a[224:227], v[96:99], v[48:51], a[224:227]
ds_read_b128 v[40:43], v2 offset:32768
v_mfma_f32_16x16x32_bf16 a[224:227], v[100:103], v[52:55], a[224:227]
ds_read_b128 v[44:47], v3 offset:32768
v_accvgpr_read_b32 v12, a18
v_mfma_f32_16x16x32_bf16 a[228:231], v[104:107], v[48:51], a[228:231]
v_accvgpr_read_b32 v13, a22
v_lshlrev_b32 v16, 16, v140
v_mfma_f32_16x16x32_bf16 a[228:231], v[108:111], v[52:55], a[228:231]
v_and_b32 v17, 0xffff0000, v140
v_mul_f32 v12, v12, v16
v_mfma_f32_16x16x32_bf16 a[232:235], v[112:115], v[48:51], a[232:235]
v_mul_f32 v13, v13, v17
v_cvt_pk_bf16_f32 v20, v12, v13
v_accvgpr_read_b32 v14, a26
v_mfma_f32_16x16x32_bf16 a[232:235], v[116:119], v[52:55], a[232:235]
v_accvgpr_read_b32 v15, a30
v_lshlrev_b32 v18, 16, v141
v_mfma_f32_16x16x32_bf16 a[236:239], v[120:123], v[48:51], a[236:239]
v_and_b32 v19, 0xffff0000, v141
v_mul_f32 v14, v14, v18
v_mfma_f32_16x16x32_bf16 a[236:239], v[124:127], v[52:55], a[236:239]
v_mul_f32 v15, v15, v19
v_cvt_pk_bf16_f32 v21, v14, v15
s_waitcnt lgkmcnt(3)
v_mfma_f32_16x16x32_bf16 a[240:243], v[96:99], v[56:59], a[240:243]
ds_read_b128 v[48:51], v2 offset:34816
buffer_load_dwordx4 v[96:99], v1, s[12:15], s33 offen offset:0 sc1
v_mfma_f32_16x16x32_bf16 a[240:243], v[100:103], v[60:63], a[240:243]
ds_read_b128 v[52:55], v3 offset:34816
v_mfma_f32_16x16x32_bf16 a[244:247], v[104:107], v[56:59], a[244:247]
v_accvgpr_read_b32 v12, a19
v_accvgpr_read_b32 v13, a23
v_mfma_f32_16x16x32_bf16 a[244:247], v[108:111], v[60:63], a[244:247]
buffer_load_dwordx4 v[100:103], v1, s[12:15], s33 offen offset:1024 sc1
v_lshlrev_b32 v16, 16, v142
v_and_b32 v17, 0xffff0000, v142
v_mfma_f32_16x16x32_bf16 a[248:251], v[112:115], v[56:59], a[248:251]
v_mul_f32 v12, v12, v16
v_mul_f32 v13, v13, v17
v_mfma_f32_16x16x32_bf16 a[248:251], v[116:119], v[60:63], a[248:251]
v_cvt_pk_bf16_f32 v22, v12, v13
v_accvgpr_read_b32 v14, a27
v_mfma_f32_16x16x32_bf16 a[252:255], v[120:123], v[56:59], a[252:255]
buffer_load_dwordx4 v[104:107], v1, s[12:15], s33 offen offset:2048 sc1
v_accvgpr_read_b32 v15, a31
v_mfma_f32_16x16x32_bf16 a[252:255], v[124:127], v[60:63], a[252:255]
v_lshlrev_b32 v18, 16, v143
v_and_b32 v19, 0xffff0000, v143
s_waitcnt vmcnt(9) lgkmcnt(2)
v_mfma_f32_16x16x32_bf16 a[128:131], v[64:67], v[40:43], a[128:131]
ds_read_b128 v[56:59], v2 offset:36864
v_mfma_f32_16x16x32_bf16 a[128:131], v[68:71], v[44:47], a[128:131]
ds_read_b128 v[60:63], v3 offset:36864
buffer_load_dwordx4 v[108:111], v1, s[12:15], s33 offen offset:3072 sc1
s_waitcnt vmcnt(8)
v_mfma_f32_16x16x32_bf16 a[132:135], v[72:75], v[40:43], a[132:135]
v_mul_f32 v14, v14, v18
v_mul_f32 v15, v15, v19
v_mfma_f32_16x16x32_bf16 a[132:135], v[76:79], v[44:47], a[132:135]
ds_read_b128 v[32:35], v6 offset:0
v_cvt_pk_bf16_f32 v23, v14, v15
s_waitcnt vmcnt(6)
v_mfma_f32_16x16x32_bf16 a[136:139], v[80:83], v[40:43], a[136:139]
buffer_load_dwordx4 v[112:115], v1, s[12:15], s34 offen offset:0 sc1
v_mfma_f32_16x16x32_bf16 a[136:139], v[84:87], v[44:47], a[136:139]
ds_write_b128 v5, v[20:23] offset:2048
v_accvgpr_read_b32 v12, a34
s_waitcnt vmcnt(5)
v_mfma_f32_16x16x32_bf16 a[140:143], v[88:91], v[40:43], a[140:143]
v_accvgpr_read_b32 v13, a38
v_mfma_f32_16x16x32_bf16 a[140:143], v[92:95], v[44:47], a[140:143]
buffer_load_dwordx4 v[116:119], v1, s[12:15], s34 offen offset:1024 sc1
v_lshlrev_b32 v16, 16, v148
s_waitcnt lgkmcnt(4)
v_mfma_f32_16x16x32_bf16 a[144:147], v[64:67], v[48:51], a[144:147]
ds_read_b128 v[40:43], v2 offset:38912
v_mfma_f32_16x16x32_bf16 a[144:147], v[68:71], v[52:55], a[144:147]
ds_read_b128 v[44:47], v3 offset:38912
v_and_b32 v17, 0xffff0000, v148
v_mfma_f32_16x16x32_bf16 a[148:151], v[72:75], v[48:51], a[148:151]
buffer_load_dwordx4 v[120:123], v1, s[12:15], s34 offen offset:2048 sc1
v_mul_f32 v12, v12, v16
v_mul_f32 v13, v13, v17
v_mfma_f32_16x16x32_bf16 a[148:151], v[76:79], v[52:55], a[148:151]
ds_read_b128 v[36:39], v7 offset:1024
v_cvt_pk_bf16_f32 v20, v12, v13
v_mfma_f32_16x16x32_bf16 a[152:155], v[80:83], v[48:51], a[152:155]
v_accvgpr_read_b32 v14, a42
v_accvgpr_read_b32 v15, a46
v_mfma_f32_16x16x32_bf16 a[152:155], v[84:87], v[52:55], a[152:155]
buffer_load_dwordx4 v[124:127], v1, s[12:15], s34 offen offset:3072 sc1
s_add_u32 s33, s33, 0x8000
s_add_u32 s34, s34, 0x8000
v_mfma_f32_16x16x32_bf16 a[156:159], v[88:91], v[48:51], a[156:159]
s_add_u32 s6, s38, 0x0
s_waitcnt lgkmcnt(4)
buffer_store_dwordx4 v[32:35], v24, s[20:23], s6 offen sc1
v_mfma_f32_16x16x32_bf16 a[156:159], v[92:95], v[52:55], a[156:159]
v_mfma_f32_16x16x32_bf16 a[160:163], v[64:67], v[56:59], a[160:163]
ds_read_b128 v[48:51], v2 offset:40960
v_lshlrev_b32 v18, 16, v149
v_mfma_f32_16x16x32_bf16 a[160:163], v[68:71], v[60:63], a[160:163]
ds_read_b128 v[52:55], v3 offset:40960
v_and_b32 v19, 0xffff0000, v149
v_mul_f32 v14, v14, v18
v_mfma_f32_16x16x32_bf16 a[164:167], v[72:75], v[56:59], a[164:167]
v_mul_f32 v15, v15, v19
v_cvt_pk_bf16_f32 v21, v14, v15
v_mfma_f32_16x16x32_bf16 a[164:167], v[76:79], v[60:63], a[164:167]
v_accvgpr_read_b32 v12, a35
v_accvgpr_read_b32 v13, a39
v_mfma_f32_16x16x32_bf16 a[168:171], v[80:83], v[56:59], a[168:171]
v_lshlrev_b32 v16, 16, v150
v_and_b32 v17, 0xffff0000, v150
v_mfma_f32_16x16x32_bf16 a[168:171], v[84:87], v[60:63], a[168:171]
v_mul_f32 v12, v12, v16
v_mul_f32 v13, v13, v17
v_mfma_f32_16x16x32_bf16 a[172:175], v[88:91], v[56:59], a[172:175]
s_add_u32 s6, s38, 0x4000
s_waitcnt lgkmcnt(2)
buffer_store_dwordx4 v[36:39], v24, s[20:23], s6 offen sc1
v_mfma_f32_16x16x32_bf16 a[172:175], v[92:95], v[60:63], a[172:175]
v_cvt_pk_bf16_f32 v22, v12, v13
v_accvgpr_read_b32 v14, a43
v_mfma_f32_16x16x32_bf16 a[176:179], v[64:67], v[40:43], a[176:179]
ds_read_b128 v[56:59], v2 offset:43008
v_accvgpr_read_b32 v15, a47
v_mfma_f32_16x16x32_bf16 a[176:179], v[68:71], v[44:47], a[176:179]
ds_read_b128 v[60:63], v3 offset:43008
v_lshlrev_b32 v18, 16, v151
v_mfma_f32_16x16x32_bf16 a[180:183], v[72:75], v[40:43], a[180:183]
v_and_b32 v19, 0xffff0000, v151
v_mul_f32 v14, v14, v18
v_mfma_f32_16x16x32_bf16 a[180:183], v[76:79], v[44:47], a[180:183]
v_mul_f32 v15, v15, v19
v_cvt_pk_bf16_f32 v23, v14, v15
v_mfma_f32_16x16x32_bf16 a[184:187], v[80:83], v[40:43], a[184:187]
ds_write_b128 v5, v[20:23] offset:4096
v_accvgpr_read_b32 v12, a50
v_mfma_f32_16x16x32_bf16 a[184:187], v[84:87], v[44:47], a[184:187]
v_accvgpr_read_b32 v13, a54
v_lshlrev_b32 v16, 16, v156
v_and_b32 v17, 0xffff0000, v156
v_mfma_f32_16x16x32_bf16 a[188:191], v[88:91], v[40:43], a[188:191]
v_mul_f32 v12, v12, v16
v_mul_f32 v13, v13, v17
v_mfma_f32_16x16x32_bf16 a[188:191], v[92:95], v[44:47], a[188:191]
v_cvt_pk_bf16_f32 v20, v12, v13
v_accvgpr_read_b32 v14, a58
s_waitcnt lgkmcnt(3)
v_mfma_f32_16x16x32_bf16 a[192:195], v[64:67], v[48:51], a[192:195]
ds_read_b128 v[40:43], v2 offset:45056
v_mfma_f32_16x16x32_bf16 a[192:195], v[68:71], v[52:55], a[192:195]
ds_read_b128 v[44:47], v3 offset:45056
v_accvgpr_read_b32 v15, a62
v_mfma_f32_16x16x32_bf16 a[196:199], v[72:75], v[48:51], a[196:199]
v_lshlrev_b32 v18, 16, v157
v_and_b32 v19, 0xffff0000, v157
v_mfma_f32_16x16x32_bf16 a[196:199], v[76:79], v[52:55], a[196:199]
v_mul_f32 v14, v14, v18
v_mul_f32 v15, v15, v19
v_cvt_pk_bf16_f32 v21, v14, v15
v_mfma_f32_16x16x32_bf16 a[200:203], v[80:83], v[48:51], a[200:203]
v_accvgpr_read_b32 v12, a51
v_accvgpr_read_b32 v13, a55
v_mfma_f32_16x16x32_bf16 a[200:203], v[84:87], v[52:55], a[200:203]
v_lshlrev_b32 v16, 16, v158
v_and_b32 v17, 0xffff0000, v158
v_mfma_f32_16x16x32_bf16 a[204:207], v[88:91], v[48:51], a[204:207]
v_mul_f32 v12, v12, v16
v_mul_f32 v13, v13, v17
v_mfma_f32_16x16x32_bf16 a[204:207], v[92:95], v[52:55], a[204:207]
v_cvt_pk_bf16_f32 v22, v12, v13
v_accvgpr_read_b32 v14, a59
s_waitcnt lgkmcnt(3)
v_mfma_f32_16x16x32_bf16 a[208:211], v[64:67], v[56:59], a[208:211]
ds_read_b128 v[48:51], v2 offset:47104
v_mfma_f32_16x16x32_bf16 a[208:211], v[68:71], v[60:63], a[208:211]
ds_read_b128 v[52:55], v3 offset:47104
v_accvgpr_read_b32 v15, a63
v_mfma_f32_16x16x32_bf16 a[212:215], v[72:75], v[56:59], a[212:215]
v_lshlrev_b32 v18, 16, v159
v_and_b32 v19, 0xffff0000, v159
v_mul_f32 v14, v14, v18
v_mfma_f32_16x16x32_bf16 a[212:215], v[76:79], v[60:63], a[212:215]
v_mul_f32 v15, v15, v19
v_cvt_pk_bf16_f32 v23, v14, v15
v_mfma_f32_16x16x32_bf16 a[216:219], v[80:83], v[56:59], a[216:219]
ds_write_b128 v5, v[20:23] offset:6144
v_accvgpr_read_b32 v12, a66
v_mfma_f32_16x16x32_bf16 a[216:219], v[84:87], v[60:63], a[216:219]
v_accvgpr_read_b32 v13, a70
v_lshlrev_b32 v16, 16, v164
v_mfma_f32_16x16x32_bf16 a[220:223], v[88:91], v[56:59], a[220:223]
v_and_b32 v17, 0xffff0000, v164
v_mul_f32 v12, v12, v16
v_mfma_f32_16x16x32_bf16 a[220:223], v[92:95], v[60:63], a[220:223]
v_mul_f32 v13, v13, v17
v_cvt_pk_bf16_f32 v20, v12, v13
s_waitcnt lgkmcnt(3)
v_mfma_f32_16x16x32_bf16 a[224:227], v[64:67], v[40:43], a[224:227]
ds_read_b128 v[56:59], v2 offset:49152
v_accvgpr_read_b32 v14, a74
v_mfma_f32_16x16x32_bf16 a[224:227], v[68:71], v[44:47], a[224:227]
ds_read_b128 v[60:63], v3 offset:49152
v_accvgpr_read_b32 v15, a78
v_mfma_f32_16x16x32_bf16 a[228:231], v[72:75], v[40:43], a[228:231]
v_lshlrev_b32 v18, 16, v165
v_and_b32 v19, 0xffff0000, v165
v_mfma_f32_16x16x32_bf16 a[228:231], v[76:79], v[44:47], a[228:231]
v_mul_f32 v14, v14, v18
v_mul_f32 v15, v15, v19
v_mfma_f32_16x16x32_bf16 a[232:235], v[80:83], v[40:43], a[232:235]
v_cvt_pk_bf16_f32 v21, v14, v15
v_accvgpr_read_b32 v12, a67
v_mfma_f32_16x16x32_bf16 a[232:235], v[84:87], v[44:47], a[232:235]
v_accvgpr_read_b32 v13, a71
v_lshlrev_b32 v16, 16, v166
v_mfma_f32_16x16x32_bf16 a[236:239], v[88:91], v[40:43], a[236:239]
v_and_b32 v17, 0xffff0000, v166
v_mul_f32 v12, v12, v16
v_mul_f32 v13, v13, v17
v_mfma_f32_16x16x32_bf16 a[236:239], v[92:95], v[44:47], a[236:239]
v_cvt_pk_bf16_f32 v22, v12, v13
v_accvgpr_read_b32 v14, a75
s_waitcnt lgkmcnt(3)
v_mfma_f32_16x16x32_bf16 a[240:243], v[64:67], v[48:51], a[240:243]
ds_read_b128 v[40:43], v2 offset:51200
buffer_load_dwordx4 v[64:67], v1, s[12:15], s33 offen offset:0 sc1
v_mfma_f32_16x16x32_bf16 a[240:243], v[68:71], v[52:55], a[240:243]
ds_read_b128 v[44:47], v3 offset:51200
v_mfma_f32_16x16x32_bf16 a[244:247], v[72:75], v[48:51], a[244:247]
v_accvgpr_read_b32 v15, a79
v_lshlrev_b32 v18, 16, v167
v_mfma_f32_16x16x32_bf16 a[244:247], v[76:79], v[52:55], a[244:247]
buffer_load_dwordx4 v[68:71], v1, s[12:15], s33 offen offset:1024 sc1
v_and_b32 v19, 0xffff0000, v167
v_mfma_f32_16x16x32_bf16 a[248:251], v[80:83], v[48:51], a[248:251]
v_mul_f32 v14, v14, v18
v_mul_f32 v15, v15, v19
v_cvt_pk_bf16_f32 v23, v14, v15
v_mfma_f32_16x16x32_bf16 a[248:251], v[84:87], v[52:55], a[248:251]
ds_write_b128 v5, v[20:23] offset:8192
v_accvgpr_read_b32 v12, a82
v_mfma_f32_16x16x32_bf16 a[252:255], v[88:91], v[48:51], a[252:255]
buffer_load_dwordx4 v[72:75], v1, s[12:15], s33 offen offset:2048 sc1
v_accvgpr_read_b32 v13, a86
v_mfma_f32_16x16x32_bf16 a[252:255], v[92:95], v[52:55], a[252:255]
v_lshlrev_b32 v16, 16, v172
v_and_b32 v17, 0xffff0000, v172
s_waitcnt vmcnt(11) lgkmcnt(3)
v_mfma_f32_16x16x32_bf16 a[128:131], v[96:99], v[56:59], a[128:131]
ds_read_b128 v[48:51], v2 offset:53248
v_mfma_f32_16x16x32_bf16 a[128:131], v[100:103], v[60:63], a[128:131]
ds_read_b128 v[52:55], v3 offset:53248
buffer_load_dwordx4 v[76:79], v1, s[12:15], s33 offen offset:3072 sc1
s_waitcnt vmcnt(10)
v_mfma_f32_16x16x32_bf16 a[132:135], v[104:107], v[56:59], a[132:135]
v_mul_f32 v12, v12, v16
v_mul_f32 v13, v13, v17
v_mfma_f32_16x16x32_bf16 a[132:135], v[108:111], v[60:63], a[132:135]
ds_read_b128 v[32:35], v6 offset:2048
v_cvt_pk_bf16_f32 v20, v12, v13
s_waitcnt vmcnt(8)
v_mfma_f32_16x16x32_bf16 a[136:139], v[112:115], v[56:59], a[136:139]
buffer_load_dwordx4 v[80:83], v1, s[12:15], s34 offen offset:0 sc1
v_mfma_f32_16x16x32_bf16 a[136:139], v[116:119], v[60:63], a[136:139]
v_accvgpr_read_b32 v14, a90
v_accvgpr_read_b32 v15, a94
s_waitcnt vmcnt(7)
v_mfma_f32_16x16x32_bf16 a[140:143], v[120:123], v[56:59], a[140:143]
v_lshlrev_b32 v18, 16, v173
v_mfma_f32_16x16x32_bf16 a[140:143], v[124:127], v[60:63], a[140:143]
buffer_load_dwordx4 v[84:87], v1, s[12:15], s34 offen offset:1024 sc1
v_and_b32 v19, 0xffff0000, v173
s_waitcnt lgkmcnt(4)
v_mfma_f32_16x16x32_bf16 a[144:147], v[96:99], v[40:43], a[144:147]
ds_read_b128 v[56:59], v2 offset:55296
v_mul_f32 v14, v14, v18
v_mfma_f32_16x16x32_bf16 a[144:147], v[100:103], v[44:47], a[144:147]
ds_read_b128 v[60:63], v3 offset:55296
v_mul_f32 v15, v15, v19
v_mfma_f32_16x16x32_bf16 a[148:151], v[104:107], v[40:43], a[148:151]
buffer_load_dwordx4 v[88:91], v1, s[12:15], s34 offen offset:2048 sc1
v_cvt_pk_bf16_f32 v21, v14, v15
v_mfma_f32_16x16x32_bf16 a[148:151], v[108:111], v[44:47], a[148:151]
ds_read_b128 v[36:39], v7 offset:3072
v_accvgpr_read_b32 v12, a83
v_mfma_f32_16x16x32_bf16 a[152:155], v[112:115], v[40:43], a[152:155]
v_accvgpr_read_b32 v13, a87
v_lshlrev_b32 v16, 16, v174
v_mfma_f32_16x16x32_bf16 a[152:155], v[116:119], v[44:47], a[152:155]
buffer_load_dwordx4 v[92:95], v1, s[12:15], s34 offen offset:3072 sc1
s_add_u32 s33, s33, 0x8000
s_add_u32 s34, s34, 0x8000
v_mfma_f32_16x16x32_bf16 a[156:159], v[120:123], v[40:43], a[156:159]
s_add_u32 s6, s38, 0x8000
s_waitcnt lgkmcnt(3)
buffer_store_dwordx4 v[32:35], v24, s[20:23], s6 offen sc1
v_mfma_f32_16x16x32_bf16 a[156:159], v[124:127], v[44:47], a[156:159]
v_and_b32 v17, 0xffff0000, v174
v_mfma_f32_16x16x32_bf16 a[160:163], v[96:99], v[48:51], a[160:163]
ds_read_b128 v[40:43], v2 offset:57344
v_mul_f32 v12, v12, v16
v_mfma_f32_16x16x32_bf16 a[160:163], v[100:103], v[52:55], a[160:163]
ds_read_b128 v[44:47], v3 offset:57344
v_mul_f32 v13, v13, v17
v_mfma_f32_16x16x32_bf16 a[164:167], v[104:107], v[48:51], a[164:167]
v_cvt_pk_bf16_f32 v22, v12, v13
v_accvgpr_read_b32 v14, a91
v_mfma_f32_16x16x32_bf16 a[164:167], v[108:111], v[52:55], a[164:167]
ds_read_b128 v[32:35], v6 offset:4096
v_accvgpr_read_b32 v15, a95
v_lshlrev_b32 v18, 16, v175
v_mfma_f32_16x16x32_bf16 a[168:171], v[112:115], v[48:51], a[168:171]
v_and_b32 v19, 0xffff0000, v175
v_mul_f32 v14, v14, v18
v_mfma_f32_16x16x32_bf16 a[168:171], v[116:119], v[52:55], a[168:171]
v_mul_f32 v15, v15, v19
v_cvt_pk_bf16_f32 v23, v14, v15
v_mfma_f32_16x16x32_bf16 a[172:175], v[120:123], v[48:51], a[172:175]
s_add_u32 s6, s38, 0xc000
s_waitcnt lgkmcnt(3)
buffer_store_dwordx4 v[36:39], v24, s[20:23], s6 offen sc1
v_mfma_f32_16x16x32_bf16 a[172:175], v[124:127], v[52:55], a[172:175]
ds_write_b128 v5, v[20:23] offset:10240
v_accvgpr_read_b32 v12, a98
v_mfma_f32_16x16x32_bf16 a[176:179], v[96:99], v[56:59], a[176:179]
ds_read_b128 v[48:51], v2 offset:59392
v_accvgpr_read_b32 v13, a102
v_mfma_f32_16x16x32_bf16 a[176:179], v[100:103], v[60:63], a[176:179]
ds_read_b128 v[52:55], v3 offset:59392
v_lshlrev_b32 v16, 16, v180
v_mfma_f32_16x16x32_bf16 a[180:183], v[104:107], v[56:59], a[180:183]
v_and_b32 v17, 0xffff0000, v180
v_mul_f32 v12, v12, v16
v_mfma_f32_16x16x32_bf16 a[180:183], v[108:111], v[60:63], a[180:183]
v_mul_f32 v13, v13, v17
v_cvt_pk_bf16_f32 v20, v12, v13
v_accvgpr_read_b32 v14, a106
v_mfma_f32_16x16x32_bf16 a[184:187], v[112:115], v[56:59], a[184:187]
v_accvgpr_read_b32 v15, a110
v_lshlrev_b32 v18, 16, v181
v_mfma_f32_16x16x32_bf16 a[184:187], v[116:119], v[60:63], a[184:187]
v_and_b32 v19, 0xffff0000, v181
v_mul_f32 v14, v14, v18
v_mfma_f32_16x16x32_bf16 a[188:191], v[120:123], v[56:59], a[188:191]
s_add_u32 s6, s38, 0x10000
s_waitcnt lgkmcnt(3)
buffer_store_dwordx4 v[32:35], v24, s[20:23], s6 offen sc1
v_mfma_f32_16x16x32_bf16 a[188:191], v[124:127], v[60:63], a[188:191]
v_mul_f32 v15, v15, v19
v_cvt_pk_bf16_f32 v21, v14, v15
v_mfma_f32_16x16x32_bf16 a[192:195], v[96:99], v[40:43], a[192:195]
ds_read_b128 v[56:59], v2 offset:61440
v_accvgpr_read_b32 v12, a99
v_mfma_f32_16x16x32_bf16 a[192:195], v[100:103], v[44:47], a[192:195]
ds_read_b128 v[60:63], v3 offset:61440
v_accvgpr_read_b32 v13, a103
v_mfma_f32_16x16x32_bf16 a[196:199], v[104:107], v[40:43], a[196:199]
v_lshlrev_b32 v16, 16, v182
v_and_b32 v17, 0xffff0000, v182
v_mul_f32 v12, v12, v16
v_mfma_f32_16x16x32_bf16 a[196:199], v[108:111], v[44:47], a[196:199]
v_mul_f32 v13, v13, v17
v_cvt_pk_bf16_f32 v22, v12, v13
v_mfma_f32_16x16x32_bf16 a[200:203], v[112:115], v[40:43], a[200:203]
v_accvgpr_read_b32 v14, a107
v_accvgpr_read_b32 v15, a111
v_mfma_f32_16x16x32_bf16 a[200:203], v[116:119], v[44:47], a[200:203]
v_lshlrev_b32 v18, 16, v183
v_and_b32 v19, 0xffff0000, v183
v_mfma_f32_16x16x32_bf16 a[204:207], v[120:123], v[40:43], a[204:207]
v_mul_f32 v14, v14, v18
v_mul_f32 v15, v15, v19
v_cvt_pk_bf16_f32 v23, v14, v15
v_mfma_f32_16x16x32_bf16 a[204:207], v[124:127], v[44:47], a[204:207]
ds_write_b128 v5, v[20:23] offset:12288
v_accvgpr_read_b32 v12, a114
s_waitcnt lgkmcnt(3)
v_mfma_f32_16x16x32_bf16 a[208:211], v[96:99], v[48:51], a[208:211]
ds_read_b128 v[40:43], v2 offset:63488
v_mfma_f32_16x16x32_bf16 a[208:211], v[100:103], v[52:55], a[208:211]
ds_read_b128 v[44:47], v3 offset:63488
v_accvgpr_read_b32 v13, a118
v_lshlrev_b32 v16, 16, v188
v_mfma_f32_16x16x32_bf16 a[212:215], v[104:107], v[48:51], a[212:215]
v_and_b32 v17, 0xffff0000, v188
v_mul_f32 v12, v12, v16
v_mfma_f32_16x16x32_bf16 a[212:215], v[108:111], v[52:55], a[212:215]
v_mul_f32 v13, v13, v17
v_cvt_pk_bf16_f32 v20, v12, v13
v_mfma_f32_16x16x32_bf16 a[216:219], v[112:115], v[48:51], a[216:219]
v_accvgpr_read_b32 v14, a122
v_accvgpr_read_b32 v15, a126
v_mfma_f32_16x16x32_bf16 a[216:219], v[116:119], v[52:55], a[216:219]
v_lshlrev_b32 v18, 16, v189
v_and_b32 v19, 0xffff0000, v189
v_mul_f32 v14, v14, v18
v_mfma_f32_16x16x32_bf16 a[220:223], v[120:123], v[48:51], a[220:223]
v_mul_f32 v15, v15, v19
v_cvt_pk_bf16_f32 v21, v14, v15
v_mfma_f32_16x16x32_bf16 a[220:223], v[124:127], v[52:55], a[220:223]
v_accvgpr_read_b32 v12, a115
v_accvgpr_read_b32 v13, a119
s_waitcnt lgkmcnt(3)
v_mfma_f32_16x16x32_bf16 a[224:227], v[96:99], v[56:59], a[224:227]
v_lshlrev_b32 v16, 16, v190
v_and_b32 v17, 0xffff0000, v190
v_mfma_f32_16x16x32_bf16 a[224:227], v[100:103], v[60:63], a[224:227]
v_mul_f32 v12, v12, v16
v_mul_f32 v13, v13, v17
v_mfma_f32_16x16x32_bf16 a[228:231], v[104:107], v[56:59], a[228:231]
v_cvt_pk_bf16_f32 v22, v12, v13
v_accvgpr_read_b32 v14, a123
v_mfma_f32_16x16x32_bf16 a[228:231], v[108:111], v[60:63], a[228:231]
v_accvgpr_read_b32 v15, a127
v_lshlrev_b32 v18, 16, v191
v_mfma_f32_16x16x32_bf16 a[232:235], v[112:115], v[56:59], a[232:235]
v_and_b32 v19, 0xffff0000, v191
v_mul_f32 v14, v14, v18
v_mul_f32 v15, v15, v19
v_mfma_f32_16x16x32_bf16 a[232:235], v[116:119], v[60:63], a[232:235]
v_cvt_pk_bf16_f32 v23, v14, v15
ds_write_b128 v5, v[20:23] offset:14336
v_mfma_f32_16x16x32_bf16 a[236:239], v[120:123], v[56:59], a[236:239]
v_mfma_f32_16x16x32_bf16 a[236:239], v[124:127], v[60:63], a[236:239]
s_waitcnt lgkmcnt(1)
s_waitcnt lgkmcnt(0)
s_barrier
v_xor_b32 v2, 0x10000, v2
v_xor_b32 v3, 0x10000, v3
v_mfma_f32_16x16x32_bf16 a[240:243], v[96:99], v[40:43], a[240:243]
ds_read_b128 v[48:51], v2 offset:0
buffer_load_dwordx4 v[96:99], v1, s[12:15], s33 offen offset:0 sc1
v_mfma_f32_16x16x32_bf16 a[240:243], v[100:103], v[44:47], a[240:243]
ds_read_b128 v[52:55], v3 offset:0
v_mfma_f32_16x16x32_bf16 a[244:247], v[104:107], v[40:43], a[244:247]
ds_read_b128 v[56:59], v2 offset:2048
v_mfma_f32_16x16x32_bf16 a[244:247], v[108:111], v[44:47], a[244:247]
ds_read_b128 v[60:63], v3 offset:2048
buffer_load_dwordx4 v[100:103], v1, s[12:15], s33 offen offset:1024 sc1
v_mfma_f32_16x16x32_bf16 a[248:251], v[112:115], v[40:43], a[248:251]
v_xor_b32 v4, 0x10000, v4
v_mfma_f32_16x16x32_bf16 a[248:251], v[116:119], v[44:47], a[248:251]
v_xor_b32 v5, 0x10000, v5
v_accvgpr_read_b32 v12, a128
v_mfma_f32_16x16x32_bf16 a[252:255], v[120:123], v[40:43], a[252:255]
buffer_load_dwordx4 v[104:107], v1, s[12:15], s33 offen offset:2048 sc1
v_accvgpr_read_b32 v13, a132
v_mfma_f32_16x16x32_bf16 a[252:255], v[124:127], v[44:47], a[252:255]
v_lshlrev_b32 v16, 16, v192
v_and_b32 v17, 0xffff0000, v192
s_waitcnt vmcnt(12) lgkmcnt(2)
L_cs2:
v_mfma_f32_16x16x32_bf16 a[0:3], v[64:67], v[48:51], a[0:3]
ds_read_b128 v[40:43], v2 offset:4096
v_mfma_f32_16x16x32_bf16 a[0:3], v[68:71], v[52:55], a[0:3]
ds_read_b128 v[44:47], v3 offset:4096
buffer_load_dwordx4 v[108:111], v1, s[12:15], s33 offen offset:3072 sc1
s_waitcnt vmcnt(11)
v_mfma_f32_16x16x32_bf16 a[4:7], v[72:75], v[48:51], a[4:7]
v_mul_f32 v12, v12, v16
v_mfma_f32_16x16x32_bf16 a[4:7], v[76:79], v[52:55], a[4:7]
ds_read_b128 v[36:39], v7 offset:5120
v_mul_f32 v13, v13, v17
s_waitcnt vmcnt(9)
v_mfma_f32_16x16x32_bf16 a[8:11], v[80:83], v[48:51], a[8:11]
buffer_load_dwordx4 v[112:115], v1, s[12:15], s34 offen offset:0 sc1
v_mfma_f32_16x16x32_bf16 a[8:11], v[84:87], v[52:55], a[8:11]
v_cvt_pk_bf16_f32 v20, v12, v13
v_accvgpr_read_b32 v14, a136
s_waitcnt vmcnt(8)
v_mfma_f32_16x16x32_bf16 a[12:15], v[88:91], v[48:51], a[12:15]
v_accvgpr_read_b32 v15, a140
v_mfma_f32_16x16x32_bf16 a[12:15], v[92:95], v[52:55], a[12:15]
buffer_load_dwordx4 v[116:119], v1, s[12:15], s34 offen offset:1024 sc1
s_waitcnt lgkmcnt(3)
v_mfma_f32_16x16x32_bf16 a[16:19], v[64:67], v[56:59], a[16:19]
ds_read_b128 v[48:51], v2 offset:6144
v_mfma_f32_16x16x32_bf16 a[16:19], v[68:71], v[60:63], a[16:19]
ds_read_b128 v[52:55], v3 offset:6144
v_lshlrev_b32 v18, 16, v193
v_mfma_f32_16x16x32_bf16 a[20:23], v[72:75], v[56:59], a[20:23]
buffer_load_dwordx4 v[120:123], v1, s[12:15], s34 offen offset:2048 sc1
v_and_b32 v19, 0xffff0000, v193
v_mfma_f32_16x16x32_bf16 a[20:23], v[76:79], v[60:63], a[20:23]
ds_read_b128 v[32:35], v6 offset:6144
v_mul_f32 v14, v14, v18
v_mfma_f32_16x16x32_bf16 a[24:27], v[80:83], v[56:59], a[24:27]
v_mul_f32 v15, v15, v19
v_cvt_pk_bf16_f32 v21, v14, v15
v_mfma_f32_16x16x32_bf16 a[24:27], v[84:87], v[60:63], a[24:27]
buffer_load_dwordx4 v[124:127], v1, s[12:15], s34 offen offset:3072 sc1
s_add_u32 s33, s33, 0x8000
s_add_u32 s34, s34, 0x8000
v_mfma_f32_16x16x32_bf16 a[28:31], v[88:91], v[56:59], a[28:31]
s_add_u32 s6, s38, 0x14000
s_waitcnt lgkmcnt(3)
buffer_store_dwordx4 v[36:39], v24, s[20:23], s6 offen sc1
v_mfma_f32_16x16x32_bf16 a[28:31], v[92:95], v[60:63], a[28:31]
v_mfma_f32_16x16x32_bf16 a[32:35], v[64:67], v[40:43], a[32:35]
ds_read_b128 v[56:59], v2 offset:8192
v_accvgpr_read_b32 v12, a129
v_mfma_f32_16x16x32_bf16 a[32:35], v[68:71], v[44:47], a[32:35]
ds_read_b128 v[60:63], v3 offset:8192
v_accvgpr_read_b32 v13, a133
v_mfma_f32_16x16x32_bf16 a[36:39], v[72:75], v[40:43], a[36:39]
v_lshlrev_b32 v16, 16, v194
v_and_b32 v17, 0xffff0000, v194
v_mfma_f32_16x16x32_bf16 a[36:39], v[76:79], v[44:47], a[36:39]
ds_read_b128 v[36:39], v7 offset:7168
v_mfma_f32_16x16x32_bf16 a[40:43], v[80:83], v[40:43], a[40:43]
v_mul_f32 v12, v12, v16
v_mul_f32 v13, v13, v17
v_mfma_f32_16x16x32_bf16 a[40:43], v[84:87], v[44:47], a[40:43]
v_cvt_pk_bf16_f32 v22, v12, v13
v_accvgpr_read_b32 v14, a137
v_mfma_f32_16x16x32_bf16 a[44:47], v[88:91], v[40:43], a[44:47]
s_add_u32 s6, s38, 0x18000
s_waitcnt lgkmcnt(3)
buffer_store_dwordx4 v[32:35], v24, s[20:23], s6 offen sc1
v_mfma_f32_16x16x32_bf16 a[44:47], v[92:95], v[44:47], a[44:47]
v_accvgpr_read_b32 v15, a141
v_mfma_f32_16x16x32_bf16 a[48:51], v[64:67], v[48:51], a[48:51]
ds_read_b128 v[40:43], v2 offset:10240
v_lshlrev_b32 v18, 16, v195
v_mfma_f32_16x16x32_bf16 a[48:51], v[68:71], v[52:55], a[48:51]
ds_read_b128 v[44:47], v3 offset:10240
v_and_b32 v19, 0xffff0000, v195
v_mfma_f32_16x16x32_bf16 a[52:55], v[72:75], v[48:51], a[52:55]
v_mul_f32 v14, v14, v18
v_mul_f32 v15, v15, v19
v_mfma_f32_16x16x32_bf16 a[52:55], v[76:79], v[52:55], a[52:55]
v_cvt_pk_bf16_f32 v23, v14, v15
ds_write_b128 v4, v[20:23] offset:0
v_mfma_f32_16x16x32_bf16 a[56:59], v[80:83], v[48:51], a[56:59]
v_accvgpr_read_b32 v12, a144
v_accvgpr_read_b32 v13, a148
v_mfma_f32_16x16x32_bf16 a[56:59], v[84:87], v[52:55], a[56:59]
v_lshlrev_b32 v16, 16, v200
v_and_b32 v17, 0xffff0000, v200
v_mfma_f32_16x16x32_bf16 a[60:63], v[88:91], v[48:51], a[60:63]
s_add_u32 s6, s38, 0x1c000
s_waitcnt lgkmcnt(3)
buffer_store_dwordx4 v[36:39], v24, s[20:23], s6 offen sc1
v_mfma_f32_16x16x32_bf16 a[60:63], v[92:95], v[52:55], a[60:63]
v_mfma_f32_16x16x32_bf16 a[64:67], v[64:67], v[56:59], a[64:67]
ds_read_b128 v[48:51], v2 offset:12288
v_mul_f32 v12, v12, v16
v_mfma_f32_16x16x32_bf16 a[64:67], v[68:71], v[60:63], a[64:67]
ds_read_b128 v[52:55], v3 offset:12288
v_mul_f32 v13, v13, v17
v_mfma_f32_16x16x32_bf16 a[68:71], v[72:75], v[56:59], a[68:71]
v_cvt_pk_bf16_f32 v20, v12, v13
v_accvgpr_read_b32 v14, a152
v_mfma_f32_16x16x32_bf16 a[68:71], v[76:79], v[60:63], a[68:71]
v_accvgpr_read_b32 v15, a156
v_lshlrev_b32 v18, 16, v201
v_mfma_f32_16x16x32_bf16 a[72:75], v[80:83], v[56:59], a[72:75]
v_and_b32 v19, 0xffff0000, v201
v_mul_f32 v14, v14, v18
v_mfma_f32_16x16x32_bf16 a[72:75], v[84:87], v[60:63], a[72:75]
ds_read_b32 v28, v10 offset:2048
v_mul_f32 v15, v15, v19
v_mfma_f32_16x16x32_bf16 a[76:79], v[88:91], v[56:59], a[76:79]
v_cvt_pk_bf16_f32 v21, v14, v15
v_accvgpr_read_b32 v12, a145
v_mfma_f32_16x16x32_bf16 a[76:79], v[92:95], v[60:63], a[76:79]
v_accvgpr_read_b32 v13, a149
v_lshlrev_b32 v16, 16, v202
s_waitcnt lgkmcnt(4)
v_mfma_f32_16x16x32_bf16 a[80:83], v[64:67], v[40:43], a[80:83]
ds_read_b128 v[56:59], v2 offset:14336
v_mfma_f32_16x16x32_bf16 a[80:83], v[68:71], v[44:47], a[80:83]
ds_read_b128 v[60:63], v3 offset:14336
v_and_b32 v17, 0xffff0000, v202
v_mfma_f32_16x16x32_bf16 a[84:87], v[72:75], v[40:43], a[84:87]
v_mul_f32 v12, v12, v16
v_mul_f32 v13, v13, v17
v_mfma_f32_16x16x32_bf16 a[84:87], v[76:79], v[44:47], a[84:87]
v_cvt_pk_bf16_f32 v22, v12, v13
v_accvgpr_read_b32 v14, a153
v_mfma_f32_16x16x32_bf16 a[88:91], v[80:83], v[40:43], a[88:91]
v_accvgpr_read_b32 v15, a157
v_mfma_f32_16x16x32_bf16 a[88:91], v[84:87], v[44:47], a[88:91]
v_lshlrev_b32 v18, 16, v203
v_and_b32 v19, 0xffff0000, v203
v_mfma_f32_16x16x32_bf16 a[92:95], v[88:91], v[40:43], a[92:95]
v_mul_f32 v14, v14, v18
v_mul_f32 v15, v15, v19
v_mfma_f32_16x16x32_bf16 a[92:95], v[92:95], v[44:47], a[92:95]
v_cvt_pk_bf16_f32 v23, v14, v15
ds_write_b128 v4, v[20:23] offset:2048
s_waitcnt lgkmcnt(4)
v_mfma_f32_16x16x32_bf16 a[96:99], v[64:67], v[48:51], a[96:99]
ds_read_b128 v[40:43], v2 offset:16384
v_mfma_f32_16x16x32_bf16 a[96:99], v[68:71], v[52:55], a[96:99]
ds_read_b128 v[44:47], v3 offset:16384
v_accvgpr_read_b32 v12, a160
v_mfma_f32_16x16x32_bf16 a[100:103], v[72:75], v[48:51], a[100:103]
v_accvgpr_read_b32 v13, a164
v_lshlrev_b32 v16, 16, v208
v_mfma_f32_16x16x32_bf16 a[100:103], v[76:79], v[52:55], a[100:103]
v_and_b32 v17, 0xffff0000, v208
v_mul_f32 v12, v12, v16
v_mfma_f32_16x16x32_bf16 a[104:107], v[80:83], v[48:51], a[104:107]
v_mul_f32 v13, v13, v17
v_cvt_pk_bf16_f32 v20, v12, v13
v_mfma_f32_16x16x32_bf16 a[104:107], v[84:87], v[52:55], a[104:107]
v_accvgpr_read_b32 v14, a168
v_accvgpr_read_b32 v15, a172
v_mfma_f32_16x16x32_bf16 a[108:111], v[88:91], v[48:51], a[108:111]
v_lshlrev_b32 v18, 16, v209
v_and_b32 v19, 0xffff0000, v209
v_mfma_f32_16x16x32_bf16 a[108:111], v[92:95], v[52:55], a[108:111]
v_mul_f32 v14, v14, v18
v_mul_f32 v15, v15, v19
s_waitcnt lgkmcnt(3)
v_mfma_f32_16x16x32_bf16 a[112:115], v[64:67], v[56:59], a[112:115]
ds_read_b128 v[48:51], v2 offset:18432
buffer_load_dwordx4 v[64:67], v1, s[12:15], s33 offen offset:0 sc1
v_mfma_f32_16x16x32_bf16 a[112:115], v[68:71], v[60:63], a[112:115]
ds_read_b128 v[52:55], v3 offset:18432
v_mfma_f32_16x16x32_bf16 a[116:119], v[72:75], v[56:59], a[116:119]
v_cvt_pk_bf16_f32 v21, v14, v15
v_mfma_f32_16x16x32_bf16 a[116:119], v[76:79], v[60:63], a[116:119]
buffer_load_dwordx4 v[68:71], v1, s[12:15], s33 offen offset:1024 sc1
v_accvgpr_read_b32 v12, a161
v_mfma_f32_16x16x32_bf16 a[120:123], v[80:83], v[56:59], a[120:123]
v_accvgpr_read_b32 v13, a165
v_lshlrev_b32 v16, 16, v210
v_mfma_f32_16x16x32_bf16 a[120:123], v[84:87], v[60:63], a[120:123]
v_and_b32 v17, 0xffff0000, v210
v_mul_f32 v12, v12, v16
v_mfma_f32_16x16x32_bf16 a[124:127], v[88:91], v[56:59], a[124:127]
buffer_load_dwordx4 v[72:75], v1, s[12:15], s33 offen offset:2048 sc1
v_mul_f32 v13, v13, v17
v_mfma_f32_16x16x32_bf16 a[124:127], v[92:95], v[60:63], a[124:127]
v_cvt_pk_bf16_f32 v22, v12, v13
v_accvgpr_read_b32 v14, a169
s_waitcnt vmcnt(12) lgkmcnt(2)
v_mfma_f32_16x16x32_bf16 a[0:3], v[96:99], v[40:43], a[0:3]
ds_read_b128 v[56:59], v2 offset:20480
v_mfma_f32_16x16x32_bf16 a[0:3], v[100:103], v[44:47], a[0:3]
ds_read_b128 v[60:63], v3 offset:20480
buffer_load_dwordx4 v[76:79], v1, s[12:15], s33 offen offset:3072 sc1
s_waitcnt vmcnt(11)
v_mfma_f32_16x16x32_bf16 a[4:7], v[104:107], v[40:43], a[4:7]
v_accvgpr_read_b32 v15, a173
v_mfma_f32_16x16x32_bf16 a[4:7], v[108:111], v[44:47], a[4:7]
ds_read_b128 v[32:35], v6 offset:8192
v_lshlrev_b32 v18, 16, v211
s_waitcnt vmcnt(9)
v_mfma_f32_16x16x32_bf16 a[8:11], v[112:115], v[40:43], a[8:11]
buffer_load_dwordx4 v[80:83], v1, s[12:15], s34 offen offset:0 sc1
v_mfma_f32_16x16x32_bf16 a[8:11], v[116:119], v[44:47], a[8:11]
v_and_b32 v19, 0xffff0000, v211
v_mul_f32 v14, v14, v18
v_mfma_f32_16x16x4_4b_bf16 a[64:79], v[28:29], v[30:31], a[64:79]
v_mul_f32 v15, v15, v19
v_cvt_pk_bf16_f32 v23, v14, v15
ds_write_b128 v4, v[20:23] offset:4096
v_accvgpr_read_b32 v12, a176
v_accvgpr_read_b32 v13, a180
v_lshlrev_b32 v16, 16, v216
v_and_b32 v17, 0xffff0000, v216
v_mul_f32 v12, v12, v16
v_mul_f32 v13, v13, v17
v_cvt_pk_bf16_f32 v20, v12, v13
s_waitcnt vmcnt(8)
v_mfma_f32_16x16x32_bf16 a[12:15], v[120:123], v[40:43], a[12:15]
v_accvgpr_read_b32 v14, a184
v_mfma_f32_16x16x32_bf16 a[12:15], v[124:127], v[44:47], a[12:15]
buffer_load_dwordx4 v[84:87], v1, s[12:15], s34 offen offset:1024 sc1
s_waitcnt lgkmcnt(4)
v_mfma_f32_16x16x32_bf16 a[16:19], v[96:99], v[48:51], a[16:19]
ds_read_b128 v[40:43], v2 offset:22528
v_mfma_f32_16x16x32_bf16 a[16:19], v[100:103], v[52:55], a[16:19]
ds_read_b128 v[44:47], v3 offset:22528
v_accvgpr_read_b32 v15, a188
v_mfma_f32_16x16x32_bf16 a[20:23], v[104:107], v[48:51], a[20:23]
buffer_load_dwordx4 v[88:91], v1, s[12:15], s34 offen offset:2048 sc1
v_lshlrev_b32 v18, 16, v217
v_mfma_f32_16x16x32_bf16 a[20:23], v[108:111], v[52:55], a[20:23]
ds_read_b128 v[36:39], v7 offset:9216
v_and_b32 v19, 0xffff0000, v217
v_mfma_f32_16x16x32_bf16 a[24:27], v[112:115], v[48:51], a[24:27]
v_mul_f32 v14, v14, v18
v_mul_f32 v15, v15, v19
v_mfma_f32_16x16x32_bf16 a[24:27], v[116:119], v[52:55], a[24:27]
buffer_load_dwordx4 v[92:95], v1, s[12:15], s34 offen offset:3072 sc1
s_add_u32 s33, s33, 0x8000
s_add_u32 s34, s34, 0x8000
v_mfma_f32_16x16x4_4b_bf16 a[80:95], v[28:29], v[30:31], a[80:95]
v_cvt_pk_bf16_f32 v21, v14, v15
v_accvgpr_read_b32 v12, a177
v_accvgpr_read_b32 v13, a181
v_lshlrev_b32 v16, 16, v218
v_and_b32 v17, 0xffff0000, v218
v_mul_f32 v12, v12, v16
v_mul_f32 v13, v13, v17
v_cvt_pk_bf16_f32 v22, v12, v13
v_accvgpr_read_b32 v14, a185
v_mfma_f32_16x16x32_bf16 a[28:31], v[120:123], v[48:51], a[28:31]
s_add_u32 s6, s38, 0x20000
s_waitcnt lgkmcnt(4)
buffer_store_dwordx4 v[32:35], v24, s[20:23], s6 offen sc1
v_mfma_f32_16x16x32_bf16 a[28:31], v[124:127], v[52:55], a[28:31]
v_accvgpr_read_b32 v15, a189
v_mfma_f32_16x16x32_bf16 a[32:35], v[96:99], v[56:59], a[32:35]
ds_read_b128 v[48:51], v2 offset:24576
v_lshlrev_b32 v18, 16, v219
v_mfma_f32_16x16x32_bf16 a[32:35], v[100:103], v[60:63], a[32:35]
ds_read_b128 v[52:55], v3 offset:24576
v_and_b32 v19, 0xffff0000, v219
v_mfma_f32_16x16x32_bf16 a[36:39], v[104:107], v[56:59], a[36:39]
v_mul_f32 v14, v14, v18
v_mul_f32 v15, v15, v19
v_mfma_f32_16x16x32_bf16 a[36:39], v[108:111], v[60:63], a[36:39]
ds_read_b128 v[32:35], v6 offset:10240
v_cvt_pk_bf16_f32 v23, v14, v15
v_mfma_f32_16x16x32_bf16 a[40:43], v[112:115], v[56:59], a[40:43]
ds_write_b128 v4, v[20:23] offset:6144
v_accvgpr_read_b32 v12, a192
v_mfma_f32_16x16x32_bf16 a[40:43], v[116:119], v[60:63], a[40:43]
v_accvgpr_read_b32 v13, a196
v_mfma_f32_16x16x4_4b_bf16 a[96:111], v[28:29], v[30:31], a[96:111]
v_lshlrev_b32 v16, 16, v224
v_and_b32 v17, 0xffff0000, v224
v_mul_f32 v12, v12, v16
v_mul_f32 v13, v13, v17
v_cvt_pk_bf16_f32 v20, v12, v13
v_accvgpr_read_b32 v14, a200
v_accvgpr_read_b32 v15, a204
v_lshlrev_b32 v18, 16, v225
v_and_b32 v19, 0xffff0000, v225
v_mul_f32 v14, v14, v18
v_mfma_f32_16x16x32_bf16 a[44:47], v[120:123], v[56:59], a[44:47]
s_add_u32 s6, s38, 0x24000
s_waitcnt lgkmcnt(4)
buffer_store_dwordx4 v[36:39], v24, s[20:23], s6 offen sc1
v_mfma_f32_16x16x32_bf16 a[44:47], v[124:127], v[60:63], a[44:47]
v_mul_f32 v15, v15, v19
v_mfma_f32_16x16x32_bf16 a[48:51], v[96:99], v[40:43], a[48:51]
ds_read_b128 v[56:59], v2 offset:26624
v_cvt_pk_bf16_f32 v21, v14, v15
v_mfma_f32_16x16x32_bf16 a[48:51], v[100:103], v[44:47], a[48:51]
ds_read_b128 v[60:63], v3 offset:26624
v_accvgpr_read_b32 v12, a193
v_mfma_f32_16x16x32_bf16 a[52:55], v[104:107], v[40:43], a[52:55]
v_accvgpr_read_b32 v13, a197
v_lshlrev_b32 v16, 16, v226
v_mfma_f32_16x16x32_bf16 a[52:55], v[108:111], v[44:47], a[52:55]
v_and_b32 v17, 0xffff0000, v226
v_mul_f32 v12, v12, v16
v_mfma_f32_16x16x32_bf16 a[56:59], v[112:115], v[40:43], a[56:59]
v_mul_f32 v13, v13, v17
v_cvt_pk_bf16_f32 v22, v12, v13
v_mfma_f32_16x16x32_bf16 a[56:59], v[116:119], v[44:47], a[56:59]
v_accvgpr_read_b32 v14, a201
v_accvgpr_read_b32 v15, a205
v_mfma_f32_16x16x4_4b_bf16 a[112:127], v[28:29], v[30:31], a[112:127]
v_lshlrev_b32 v18, 16, v227
v_and_b32 v19, 0xffff0000, v227
v_mul_f32 v14, v14, v18
v_mul_f32 v15, v15, v19
v_cvt_pk_bf16_f32 v23, v14, v15
ds_write_b128 v4, v[20:23] offset:8192
v_accvgpr_read_b32 v12, a208
v_accvgpr_read_b32 v13, a212
v_lshlrev_b32 v16, 16, v232
v_and_b32 v17, 0xffff0000, v232
v_mfma_f32_16x16x32_bf16 a[60:63], v[120:123], v[40:43], a[60:63]
s_add_u32 s6, s38, 0x28000
s_waitcnt lgkmcnt(4)
buffer_store_dwordx4 v[32:35], v24, s[20:23], s6 offen sc1
v_mfma_f32_16x16x32_bf16 a[60:63], v[124:127], v[44:47], a[60:63]
v_mul_f32 v12, v12, v16
v_mfma_f32_16x16x32_bf16 a[64:67], v[96:99], v[48:51], a[64:67]
ds_read_b128 v[40:43], v2 offset:28672
v_mul_f32 v13, v13, v17
v_mfma_f32_16x16x32_bf16 a[64:67], v[100:103], v[52:55], a[64:67]
ds_read_b128 v[44:47], v3 offset:28672
v_cvt_pk_bf16_f32 v20, v12, v13
v_mfma_f32_16x16x32_bf16 a[68:71], v[104:107], v[48:51], a[68:71]
v_accvgpr_read_b32 v14, a216
v_accvgpr_read_b32 v15, a220
v_mfma_f32_16x16x32_bf16 a[68:71], v[108:111], v[52:55], a[68:71]
v_lshlrev_b32 v18, 16, v233
v_and_b32 v19, 0xffff0000, v233
v_mfma_f32_16x16x32_bf16 a[72:75], v[112:115], v[48:51], a[72:75]
v_mul_f32 v14, v14, v18
v_mul_f32 v15, v15, v19
v_mfma_f32_16x16x32_bf16 a[72:75], v[116:119], v[52:55], a[72:75]
v_cvt_pk_bf16_f32 v21, v14, v15
v_accvgpr_read_b32 v12, a209
v_mfma_f32_16x16x4_4b_bf16 a[0:15], v[28:29], v[30:31], a[0:15]
v_accvgpr_read_b32 v13, a213
v_lshlrev_b32 v16, 16, v234
v_and_b32 v17, 0xffff0000, v234
v_mul_f32 v12, v12, v16
v_mul_f32 v13, v13, v17
v_cvt_pk_bf16_f32 v22, v12, v13
v_accvgpr_read_b32 v14, a217
v_accvgpr_read_b32 v15, a221
v_lshlrev_b32 v18, 16, v235
v_and_b32 v19, 0xffff0000, v235
v_mfma_f32_16x16x32_bf16 a[76:79], v[120:123], v[48:51], a[76:79]
v_mul_f32 v14, v14, v18
v_mfma_f32_16x16x32_bf16 a[76:79], v[124:127], v[52:55], a[76:79]
v_mul_f32 v15, v15, v19
v_cvt_pk_bf16_f32 v23, v14, v15
s_waitcnt lgkmcnt(3)
v_mfma_f32_16x16x32_bf16 a[80:83], v[96:99], v[56:59], a[80:83]
ds_read_b128 v[48:51], v2 offset:30720
v_mfma_f32_16x16x32_bf16 a[80:83], v[100:103], v[60:63], a[80:83]
ds_read_b128 v[52:55], v3 offset:30720
ds_write_b128 v4, v[20:23] offset:10240
v_mfma_f32_16x16x32_bf16 a[84:87], v[104:107], v[56:59], a[84:87]
v_accvgpr_read_b32 v12, a224
v_accvgpr_read_b32 v13, a228
v_mfma_f32_16x16x32_bf16 a[84:87], v[108:111], v[60:63], a[84:87]
v_lshlrev_b32 v16, 16, v240
v_and_b32 v17, 0xffff0000, v240
v_mfma_f32_16x16x32_bf16 a[88:91], v[112:115], v[56:59], a[88:91]
v_mul_f32 v12, v12, v16
v_mul_f32 v13, v13, v17
v_mfma_f32_16x16x32_bf16 a[88:91], v[116:119], v[60:63], a[88:91]
v_cvt_pk_bf16_f32 v20, v12, v13
v_accvgpr_read_b32 v14, a232
v_mfma_f32_16x16x4_4b_bf16 a[16:31], v[28:29], v[30:31], a[16:31]
v_accvgpr_read_b32 v15, a236
v_lshlrev_b32 v18, 16, v241
v_and_b32 v19, 0xffff0000, v241
v_mul_f32 v14, v14, v18
v_mul_f32 v15, v15, v19
v_cvt_pk_bf16_f32 v21, v14, v15
v_accvgpr_read_b32 v12, a225
v_accvgpr_read_b32 v13, a229
v_lshlrev_b32 v16, 16, v242
v_and_b32 v17, 0xffff0000, v242
v_mfma_f32_16x16x32_bf16 a[92:95], v[120:123], v[56:59], a[92:95]
v_mul_f32 v12, v12, v16
v_mul_f32 v13, v13, v17
v_mfma_f32_16x16x32_bf16 a[92:95], v[124:127], v[60:63], a[92:95]
v_cvt_pk_bf16_f32 v22, v12, v13
v_accvgpr_read_b32 v14, a233
s_waitcnt lgkmcnt(3)
v_mfma_f32_16x16x32_bf16 a[96:99], v[96:99], v[40:43], a[96:99]
ds_read_b128 v[56:59], v2 offset:32768
v_mfma_f32_16x16x32_bf16 a[96:99], v[100:103], v[44:47], a[96:99]
ds_read_b128 v[60:63], v3 offset:32768
v_accvgpr_read_b32 v15, a237
v_mfma_f32_16x16x32_bf16 a[100:103], v[104:107], v[40:43], a[100:103]
v_lshlrev_b32 v18, 16, v243
v_and_b32 v19, 0xffff0000, v243
v_mfma_f32_16x16x32_bf16 a[100:103], v[108:111], v[44:47], a[100:103]
v_mul_f32 v14, v14, v18
v_mul_f32 v15, v15, v19
v_mfma_f32_16x16x32_bf16 a[104:107], v[112:115], v[40:43], a[104:107]
v_cvt_pk_bf16_f32 v23, v14, v15
ds_write_b128 v4, v[20:23] offset:12288
v_mfma_f32_16x16x32_bf16 a[104:107], v[116:119], v[44:47], a[104:107]
v_accvgpr_read_b32 v12, a240
v_accvgpr_read_b32 v13, a244
v_mfma_f32_16x16x4_4b_bf16 a[32:47], v[28:29], v[30:31], a[32:47]
v_lshlrev_b32 v16, 16, v248
v_and_b32 v17, 0xffff0000, v248
v_mul_f32 v12, v12, v16
v_mul_f32 v13, v13, v17
v_cvt_pk_bf16_f32 v20, v12, v13
v_accvgpr_read_b32 v14, a248
v_accvgpr_read_b32 v15, a252
v_lshlrev_b32 v18, 16, v249
v_and_b32 v19, 0xffff0000, v249
v_mul_f32 v14, v14, v18
v_mfma_f32_16x16x32_bf16 a[108:111], v[120:123], v[40:43], a[108:111]
v_mul_f32 v15, v15, v19
v_cvt_pk_bf16_f32 v21, v14, v15
v_mfma_f32_16x16x32_bf16 a[108:111], v[124:127], v[44:47], a[108:111]
v_accvgpr_read_b32 v12, a241
s_waitcnt lgkmcnt(4)
v_mfma_f32_16x16x32_bf16 a[112:115], v[96:99], v[48:51], a[112:115]
ds_read_b128 v[40:43], v2 offset:34816
buffer_load_dwordx4 v[96:99], v1, s[12:15], s33 offen offset:0 sc1
v_mfma_f32_16x16x32_bf16 a[112:115], v[100:103], v[52:55], a[112:115]
ds_read_b128 v[44:47], v3 offset:34816
v_mfma_f32_16x16x32_bf16 a[116:119], v[104:107], v[48:51], a[116:119]
v_accvgpr_read_b32 v13, a245
v_lshlrev_b32 v16, 16, v250
v_mfma_f32_16x16x32_bf16 a[116:119], v[108:111], v[52:55], a[116:119]
buffer_load_dwordx4 v[100:103], v1, s[12:15], s33 offen offset:1024 sc1
v_and_b32 v17, 0xffff0000, v250
v_mfma_f32_16x16x32_bf16 a[120:123], v[112:115], v[48:51], a[120:123]
v_mul_f32 v12, v12, v16
v_mul_f32 v13, v13, v17
v_mfma_f32_16x16x32_bf16 a[120:123], v[116:119], v[52:55], a[120:123]
v_cvt_pk_bf16_f32 v22, v12, v13
v_accvgpr_read_b32 v14, a249
v_mfma_f32_16x16x4_4b_bf16 a[48:63], v[28:29], v[30:31], a[48:63]
v_accvgpr_read_b32 v15, a253
v_lshlrev_b32 v18, 16, v251
v_and_b32 v19, 0xffff0000, v251
v_mul_f32 v14, v14, v18
v_mul_f32 v15, v15, v19
v_cvt_pk_bf16_f32 v23, v14, v15
ds_write_b128 v4, v[20:23] offset:14336
v_accvgpr_read_b32 v12, a130
v_accvgpr_read_b32 v13, a134
v_lshlrev_b32 v16, 16, v196
v_mfma_f32_16x16x32_bf16 a[124:127], v[120:123], v[48:51], a[124:127]
buffer_load_dwordx4 v[104:107], v1, s[12:15], s33 offen offset:2048 sc1
v_and_b32 v17, 0xffff0000, v196
v_mfma_f32_16x16x32_bf16 a[124:127], v[124:127], v[52:55], a[124:127]
v_mul_f32 v12, v12, v16
v_mul_f32 v13, v13, v17
s_waitcnt vmcnt(12) lgkmcnt(4)
v_mfma_f32_16x16x32_bf16 a[0:3], v[64:67], v[56:59], a[0:3]
ds_read_b128 v[48:51], v2 offset:36864
v_mfma_f32_16x16x32_bf16 a[0:3], v[68:71], v[60:63], a[0:3]
ds_read_b128 v[52:55], v3 offset:36864
buffer_load_dwordx4 v[108:111], v1, s[12:15], s33 offen offset:3072 sc1
s_waitcnt vmcnt(11)
v_mfma_f32_16x16x32_bf16 a[4:7], v[72:75], v[56:59], a[4:7]
v_cvt_pk_bf16_f32 v20, v12, v13
v_mfma_f32_16x16x32_bf16 a[4:7], v[76:79], v[60:63], a[4:7]
ds_read_b128 v[36:39], v7 offset:11264
v_accvgpr_read_b32 v14, a138
s_waitcnt vmcnt(9)
v_mfma_f32_16x16x32_bf16 a[8:11], v[80:83], v[56:59], a[8:11]
buffer_load_dwordx4 v[112:115], v1, s[12:15], s34 offen offset:0 sc1
v_mfma_f32_16x16x32_bf16 a[8:11], v[84:87], v[60:63], a[8:11]
v_accvgpr_read_b32 v15, a142
v_lshlrev_b32 v18, 16, v197
s_waitcnt vmcnt(8)
v_mfma_f32_16x16x32_bf16 a[12:15], v[88:91], v[56:59], a[12:15]
v_and_b32 v19, 0xffff0000, v197
v_mfma_f32_16x16x32_bf16 a[12:15], v[92:95], v[60:63], a[12:15]
buffer_load_dwordx4 v[116:119], v1, s[12:15], s34 offen offset:1024 sc1
v_mul_f32 v14, v14, v18
s_waitcnt lgkmcnt(4)
v_mfma_f32_16x16x32_bf16 a[16:19], v[64:67], v[40:43], a[16:19]
ds_read_b128 v[56:59], v2 offset:38912
v_mfma_f32_16x16x32_bf16 a[16:19], v[68:71], v[44:47], a[16:19]
ds_read_b128 v[60:63], v3 offset:38912
v_mfma_f32_16x16x32_bf16 a[20:23], v[72:75], v[40:43], a[20:23]
buffer_load_dwordx4 v[120:123], v1, s[12:15], s34 offen offset:2048 sc1
v_mul_f32 v15, v15, v19
v_mfma_f32_16x16x32_bf16 a[20:23], v[76:79], v[44:47], a[20:23]
ds_read_b128 v[32:35], v6 offset:12288
v_cvt_pk_bf16_f32 v21, v14, v15
v_mfma_f32_16x16x32_bf16 a[24:27], v[80:83], v[40:43], a[24:27]
v_accvgpr_read_b32 v12, a131
v_accvgpr_read_b32 v13, a135
v_mfma_f32_16x16x32_bf16 a[24:27], v[84:87], v[44:47], a[24:27]
buffer_load_dwordx4 v[124:127], v1, s[12:15], s34 offen offset:3072 sc1
s_add_u32 s33, s33, 0x8000
s_add_u32 s34, s34, 0x8000
v_mfma_f32_16x16x32_bf16 a[28:31], v[88:91], v[40:43], a[28:31]
s_add_u32 s6, s38, 0x2c000
s_waitcnt lgkmcnt(3)
buffer_store_dwordx4 v[36:39], v24, s[20:23], s6 offen sc1
v_mfma_f32_16x16x32_bf16 a[28:31], v[92:95], v[44:47], a[28:31]
v_mfma_f32_16x16x32_bf16 a[32:35], v[64:67], v[48:51], a[32:35]
ds_read_b128 v[40:43], v2 offset:40960
v_lshlrev_b32 v16, 16, v198
v_mfma_f32_16x16x32_bf16 a[32:35], v[68:71], v[52:55], a[32:35]
ds_read_b128 v[44:47], v3 offset:40960
v_and_b32 v17, 0xffff0000, v198
v_mfma_f32_16x16x32_bf16 a[36:39], v[72:75], v[48:51], a[36:39]
v_mul_f32 v12, v12, v16
v_mul_f32 v13, v13, v17
v_mfma_f32_16x16x32_bf16 a[36:39], v[76:79], v[52:55], a[36:39]
ds_read_b128 v[36:39], v7 offset:13312
v_cvt_pk_bf16_f32 v22, v12, v13
v_mfma_f32_16x16x32_bf16 a[40:43], v[80:83], v[48:51], a[40:43]
v_accvgpr_read_b32 v14, a139
v_accvgpr_read_b32 v15, a143
v_mfma_f32_16x16x32_bf16 a[40:43], v[84:87], v[52:55], a[40:43]
v_lshlrev_b32 v18, 16, v199
v_and_b32 v19, 0xffff0000, v199
v_mfma_f32_16x16x32_bf16 a[44:47], v[88:91], v[48:51], a[44:47]
s_add_u32 s6, s38, 0x30000
s_waitcnt lgkmcnt(3)
buffer_store_dwordx4 v[32:35], v24, s[20:23], s6 offen sc1
v_mfma_f32_16x16x32_bf16 a[44:47], v[92:95], v[52:55], a[44:47]
v_mul_f32 v14, v14, v18
v_mfma_f32_16x16x32_bf16 a[48:51], v[64:67], v[56:59], a[48:51]
ds_read_b128 v[48:51], v2 offset:43008
v_mul_f32 v15, v15, v19
v_mfma_f32_16x16x32_bf16 a[48:51], v[68:71], v[60:63], a[48:51]
ds_read_b128 v[52:55], v3 offset:43008
v_cvt_pk_bf16_f32 v23, v14, v15
v_mfma_f32_16x16x32_bf16 a[52:55], v[72:75], v[56:59], a[52:55]
ds_write_b128 v5, v[20:23] offset:0
v_accvgpr_read_b32 v12, a146
v_mfma_f32_16x16x32_bf16 a[52:55], v[76:79], v[60:63], a[52:55]
v_accvgpr_read_b32 v13, a150
v_lshlrev_b32 v16, 16, v204
v_mfma_f32_16x16x32_bf16 a[56:59], v[80:83], v[56:59], a[56:59]
v_and_b32 v17, 0xffff0000, v204
v_mul_f32 v12, v12, v16
v_mfma_f32_16x16x32_bf16 a[56:59], v[84:87], v[60:63], a[56:59]
v_mul_f32 v13, v13, v17
v_cvt_pk_bf16_f32 v20, v12, v13
v_mfma_f32_16x16x32_bf16 a[60:63], v[88:91], v[56:59], a[60:63]
s_add_u32 s6, s38, 0x34000
s_waitcnt lgkmcnt(3)
buffer_store_dwordx4 v[36:39], v24, s[20:23], s6 offen sc1
v_mfma_f32_16x16x32_bf16 a[60:63], v[92:95], v[60:63], a[60:63]
v_mfma_f32_16x16x32_bf16 a[64:67], v[64:67], v[40:43], a[64:67]
ds_read_b128 v[56:59], v2 offset:45056
v_accvgpr_read_b32 v14, a154
v_mfma_f32_16x16x32_bf16 a[64:67], v[68:71], v[44:47], a[64:67]
ds_read_b128 v[60:63], v3 offset:45056
v_accvgpr_read_b32 v15, a158
v_mfma_f32_16x16x32_bf16 a[68:71], v[72:75], v[40:43], a[68:71]
v_lshlrev_b32 v18, 16, v205
v_and_b32 v19, 0xffff0000, v205
v_mfma_f32_16x16x32_bf16 a[68:71], v[76:79], v[44:47], a[68:71]
v_mul_f32 v14, v14, v18
v_mul_f32 v15, v15, v19
v_mfma_f32_16x16x32_bf16 a[72:75], v[80:83], v[40:43], a[72:75]
v_cvt_pk_bf16_f32 v21, v14, v15
v_accvgpr_read_b32 v12, a147
v_mfma_f32_16x16x32_bf16 a[72:75], v[84:87], v[44:47], a[72:75]
v_accvgpr_read_b32 v13, a151
v_lshlrev_b32 v16, 16, v206
v_mfma_f32_16x16x32_bf16 a[76:79], v[88:91], v[40:43], a[76:79]
v_and_b32 v17, 0xffff0000, v206
v_mul_f32 v12, v12, v16
v_mfma_f32_16x16x32_bf16 a[76:79], v[92:95], v[44:47], a[76:79]
v_mul_f32 v13, v13, v17
v_cvt_pk_bf16_f32 v22, v12, v13
s_waitcnt lgkmcnt(3)
v_mfma_f32_16x16x32_bf16 a[80:83], v[64:67], v[48:51], a[80:83]
ds_read_b128 v[40:43], v2 offset:47104
v_mfma_f32_16x16x32_bf16 a[80:83], v[68:71], v[52:55], a[80:83]
ds_read_b128 v[44:47], v3 offset:47104
v_accvgpr_read_b32 v14, a155
v_mfma_f32_16x16x32_bf16 a[84:87], v[72:75], v[48:51], a[84:87]
v_accvgpr_read_b32 v15, a159
v_lshlrev_b32 v18, 16, v207
v_mfma_f32_16x16x32_bf16 a[84:87], v[76:79], v[52:55], a[84:87]
v_and_b32 v19, 0xffff0000, v207
v_mul_f32 v14, v14, v18
v_mfma_f32_16x16x32_bf16 a[88:91], v[80:83], v[48:51], a[88:91]
v_mul_f32 v15, v15, v19
v_cvt_pk_bf16_f32 v23, v14, v15
v_mfma_f32_16x16x32_bf16 a[88:91], v[84:87], v[52:55], a[88:91]
ds_write_b128 v5, v[20:23] offset:2048
v_accvgpr_read_b32 v12, a162
v_mfma_f32_16x16x32_bf16 a[92:95], v[88:91], v[48:51], a[92:95]
v_accvgpr_read_b32 v13, a166
v_lshlrev_b32 v16, 16, v212
v_mfma_f32_16x16x32_bf16 a[92:95], v[92:95], v[52:55], a[92:95]
v_and_b32 v17, 0xffff0000, v212
v_mul_f32 v12, v12, v16
s_waitcnt lgkmcnt(3)
v_mfma_f32_16x16x32_bf16 a[96:99], v[64:67], v[56:59], a[96:99]
ds_read_b128 v[48:51], v2 offset:49152
v_mfma_f32_16x16x32_bf16 a[96:99], v[68:71], v[60:63], a[96:99]
ds_read_b128 v[52:55], v3 offset:49152
v_mul_f32 v13, v13, v17
v_mfma_f32_16x16x32_bf16 a[100:103], v[72:75], v[56:59], a[100:103]
v_cvt_pk_bf16_f32 v20, v12, v13
v_accvgpr_read_b32 v14, a170
v_mfma_f32_16x16x32_bf16 a[100:103], v[76:79], v[60:63], a[100:103]
v_accvgpr_read_b32 v15, a174
v_lshlrev_b32 v18, 16, v213
v_mfma_f32_16x16x32_bf16 a[104:107], v[80:83], v[56:59], a[104:107]
v_and_b32 v19, 0xffff0000, v213
v_mul_f32 v14, v14, v18
v_mfma_f32_16x16x32_bf16 a[104:107], v[84:87], v[60:63], a[104:107]
v_mul_f32 v15, v15, v19
v_cvt_pk_bf16_f32 v21, v14, v15
v_mfma_f32_16x16x32_bf16 a[108:111], v[88:91], v[56:59], a[108:111]
v_accvgpr_read_b32 v12, a163
v_accvgpr_read_b32 v13, a167
v_mfma_f32_16x16x32_bf16 a[108:111], v[92:95], v[60:63], a[108:111]
v_lshlrev_b32 v16, 16, v214
v_and_b32 v17, 0xffff0000, v214
s_waitcnt lgkmcnt(3)
v_mfma_f32_16x16x32_bf16 a[112:115], v[64:67], v[40:43], a[112:115]
ds_read_b128 v[56:59], v2 offset:51200
buffer_load_dwordx4 v[64:67], v1, s[12:15], s33 offen offset:0 sc1
v_mfma_f32_16x16x32_bf16 a[112:115], v[68:71], v[44:47], a[112:115]
ds_read_b128 v[60:63], v3 offset:51200
v_mfma_f32_16x16x32_bf16 a[116:119], v[72:75], v[40:43], a[116:119]
v_mul_f32 v12, v12, v16
v_mul_f32 v13, v13, v17
v_mfma_f32_16x16x32_bf16 a[116:119], v[76:79], v[44:47], a[116:119]
buffer_load_dwordx4 v[68:71], v1, s[12:15], s33 offen offset:1024 sc1
v_cvt_pk_bf16_f32 v22, v12, v13
v_mfma_f32_16x16x32_bf16 a[120:123], v[80:83], v[40:43], a[120:123]
v_accvgpr_read_b32 v14, a171
v_accvgpr_read_b32 v15, a175
v_mfma_f32_16x16x32_bf16 a[120:123], v[84:87], v[44:47], a[120:123]
v_lshlrev_b32 v18, 16, v215
v_and_b32 v19, 0xffff0000, v215
v_mfma_f32_16x16x32_bf16 a[124:127], v[88:91], v[40:43], a[124:127]
buffer_load_dwordx4 v[72:75], v1, s[12:15], s33 offen offset:2048 sc1
v_mul_f32 v14, v14, v18
v_mfma_f32_16x16x32_bf16 a[124:127], v[92:95], v[44:47], a[124:127]
v_mul_f32 v15, v15, v19
s_waitcnt vmcnt(12) lgkmcnt(2)
v_mfma_f32_16x16x32_bf16 a[0:3], v[96:99], v[48:51], a[0:3]
ds_read_b128 v[40:43], v2 offset:53248
v_mfma_f32_16x16x32_bf16 a[0:3], v[100:103], v[52:55], a[0:3]
ds_read_b128 v[44:47], v3 offset:53248
buffer_load_dwordx4 v[76:79], v1, s[12:15], s33 offen offset:3072 sc1
s_waitcnt vmcnt(11)
v_mfma_f32_16x16x32_bf16 a[4:7], v[104:107], v[48:51], a[4:7]
v_cvt_pk_bf16_f32 v23, v14, v15
v_mfma_f32_16x16x32_bf16 a[4:7], v[108:111], v[52:55], a[4:7]
ds_read_b128 v[32:35], v6 offset:14336
v_xor_b32 v6, 0x10000, v6
s_waitcnt vmcnt(9)
v_mfma_f32_16x16x32_bf16 a[8:11], v[112:115], v[48:51], a[8:11]
buffer_load_dwordx4 v[80:83], v1, s[12:15], s34 offen offset:0 sc1
v_mfma_f32_16x16x32_bf16 a[8:11], v[116:119], v[52:55], a[8:11]
ds_write_b128 v5, v[20:23] offset:4096
v_accvgpr_read_b32 v12, a178
s_waitcnt vmcnt(8)
v_mfma_f32_16x16x32_bf16 a[12:15], v[120:123], v[48:51], a[12:15]
v_accvgpr_read_b32 v13, a182
v_mfma_f32_16x16x32_bf16 a[12:15], v[124:127], v[52:55], a[12:15]
buffer_load_dwordx4 v[84:87], v1, s[12:15], s34 offen offset:1024 sc1
v_lshlrev_b32 v16, 16, v220
s_waitcnt lgkmcnt(4)
v_mfma_f32_16x16x32_bf16 a[16:19], v[96:99], v[56:59], a[16:19]
ds_read_b128 v[48:51], v2 offset:55296
v_mfma_f32_16x16x32_bf16 a[16:19], v[100:103], v[60:63], a[16:19]
ds_read_b128 v[52:55], v3 offset:55296
v_and_b32 v17, 0xffff0000, v220
v_mfma_f32_16x16x32_bf16 a[20:23], v[104:107], v[56:59], a[20:23]
buffer_load_dwordx4 v[88:91], v1, s[12:15], s34 offen offset:2048 sc1
v_mul_f32 v12, v12, v16
v_mfma_f32_16x16x32_bf16 a[20:23], v[108:111], v[60:63], a[20:23]
ds_read_b128 v[36:39], v7 offset:15360
v_xor_b32 v7, 0x10000, v7
v_mfma_f32_16x16x32_bf16 a[24:27], v[112:115], v[56:59], a[24:27]
v_mul_f32 v13, v13, v17
v_cvt_pk_bf16_f32 v20, v12, v13
v_mfma_f32_16x16x32_bf16 a[24:27], v[116:119], v[60:63], a[24:27]
buffer_load_dwordx4 v[92:95], v1, s[12:15], s34 offen offset:3072 sc1
s_add_u32 s33, s33, 0x8000
s_add_u32 s34, s34, 0x8000
v_mfma_f32_16x16x32_bf16 a[28:31], v[120:123], v[56:59], a[28:31]
s_add_u32 s6, s38, 0x38000
s_waitcnt lgkmcnt(4)
buffer_store_dwordx4 v[32:35], v24, s[20:23], s6 offen sc1
v_mfma_f32_16x16x32_bf16 a[28:31], v[124:127], v[60:63], a[28:31]
v_mfma_f32_16x16x32_bf16 a[32:35], v[96:99], v[40:43], a[32:35]
ds_read_b128 v[56:59], v2 offset:57344
v_accvgpr_read_b32 v14, a186
v_mfma_f32_16x16x32_bf16 a[32:35], v[100:103], v[44:47], a[32:35]
ds_read_b128 v[60:63], v3 offset:57344
v_accvgpr_read_b32 v15, a190
v_mfma_f32_16x16x32_bf16 a[36:39], v[104:107], v[40:43], a[36:39]
v_lshlrev_b32 v18, 16, v221
v_and_b32 v19, 0xffff0000, v221
v_mfma_f32_16x16x32_bf16 a[36:39], v[108:111], v[44:47], a[36:39]
v_mul_f32 v14, v14, v18
v_mul_f32 v15, v15, v19
v_mfma_f32_16x16x32_bf16 a[40:43], v[112:115], v[40:43], a[40:43]
v_cvt_pk_bf16_f32 v21, v14, v15
v_accvgpr_read_b32 v12, a179
v_mfma_f32_16x16x32_bf16 a[40:43], v[116:119], v[44:47], a[40:43]
v_accvgpr_read_b32 v13, a183
v_lshlrev_b32 v16, 16, v222
v_mfma_f32_16x16x32_bf16 a[44:47], v[120:123], v[40:43], a[44:47]
s_add_u32 s6, s38, 0x3c000
s_waitcnt lgkmcnt(2)
buffer_store_dwordx4 v[36:39], v24, s[20:23], s6 offen sc1
v_xor_b32 v24, 0x200, v24
v_mfma_f32_16x16x32_bf16 a[44:47], v[124:127], v[44:47], a[44:47]
v_mfma_f32_16x16x32_bf16 a[48:51], v[96:99], v[48:51], a[48:51]
ds_read_b128 v[40:43], v2 offset:59392
v_and_b32 v17, 0xffff0000, v222
v_mfma_f32_16x16x32_bf16 a[48:51], v[100:103], v[52:55], a[48:51]
ds_read_b128 v[44:47], v3 offset:59392
v_mul_f32 v12, v12, v16
v_mfma_f32_16x16x32_bf16 a[52:55], v[104:107], v[48:51], a[52:55]
v_mul_f32 v13, v13, v17
v_cvt_pk_bf16_f32 v22, v12, v13
v_mfma_f32_16x16x32_bf16 a[52:55], v[108:111], v[52:55], a[52:55]
v_accvgpr_read_b32 v14, a187
v_accvgpr_read_b32 v15, a191
v_mfma_f32_16x16x32_bf16 a[56:59], v[112:115], v[48:51], a[56:59]
v_lshlrev_b32 v18, 16, v223
v_and_b32 v19, 0xffff0000, v223
v_mfma_f32_16x16x32_bf16 a[56:59], v[116:119], v[52:55], a[56:59]
v_mul_f32 v14, v14, v18
v_mul_f32 v15, v15, v19
v_cvt_pk_bf16_f32 v23, v14, v15
v_mfma_f32_16x16x32_bf16 a[60:63], v[120:123], v[48:51], a[60:63]
ds_write_b128 v5, v[20:23] offset:6144
v_accvgpr_read_b32 v12, a194
v_mfma_f32_16x16x32_bf16 a[60:63], v[124:127], v[52:55], a[60:63]
v_accvgpr_read_b32 v13, a198
v_lshlrev_b32 v16, 16, v228
s_waitcnt lgkmcnt(3)
v_mfma_f32_16x16x32_bf16 a[64:67], v[96:99], v[56:59], a[64:67]
ds_read_b128 v[48:51], v2 offset:61440
v_mfma_f32_16x16x32_bf16 a[64:67], v[100:103], v[60:63], a[64:67]
ds_read_b128 v[52:55], v3 offset:61440
v_and_b32 v17, 0xffff0000, v228
v_mfma_f32_16x16x32_bf16 a[68:71], v[104:107], v[56:59], a[68:71]
v_mul_f32 v12, v12, v16
v_mul_f32 v13, v13, v17
v_mfma_f32_16x16x32_bf16 a[68:71], v[108:111], v[60:63], a[68:71]
v_cvt_pk_bf16_f32 v20, v12, v13
v_accvgpr_read_b32 v14, a202
v_mfma_f32_16x16x32_bf16 a[72:75], v[112:115], v[56:59], a[72:75]
v_accvgpr_read_b32 v15, a206
v_lshlrev_b32 v18, 16, v229
v_mfma_f32_16x16x32_bf16 a[72:75], v[116:119], v[60:63], a[72:75]
v_and_b32 v19, 0xffff0000, v229
v_mul_f32 v14, v14, v18
v_mfma_f32_16x16x32_bf16 a[76:79], v[120:123], v[56:59], a[76:79]
v_mul_f32 v15, v15, v19
v_cvt_pk_bf16_f32 v21, v14, v15
v_mfma_f32_16x16x32_bf16 a[76:79], v[124:127], v[60:63], a[76:79]
v_accvgpr_read_b32 v12, a195
v_accvgpr_read_b32 v13, a199
s_waitcnt lgkmcnt(3)
v_mfma_f32_16x16x32_bf16 a[80:83], v[96:99], v[40:43], a[80:83]
ds_read_b128 v[56:59], v2 offset:63488
v_mfma_f32_16x16x32_bf16 a[80:83], v[100:103], v[44:47], a[80:83]
ds_read_b128 v[60:63], v3 offset:63488
v_lshlrev_b32 v16, 16, v230
v_mfma_f32_16x16x32_bf16 a[84:87], v[104:107], v[40:43], a[84:87]
v_and_b32 v17, 0xffff0000, v230
v_mul_f32 v12, v12, v16
v_mfma_f32_16x16x32_bf16 a[84:87], v[108:111], v[44:47], a[84:87]
v_mul_f32 v13, v13, v17
v_cvt_pk_bf16_f32 v22, v12, v13
v_mfma_f32_16x16x32_bf16 a[88:91], v[112:115], v[40:43], a[88:91]
v_accvgpr_read_b32 v14, a203
v_accvgpr_read_b32 v15, a207
v_mfma_f32_16x16x32_bf16 a[88:91], v[116:119], v[44:47], a[88:91]
v_lshlrev_b32 v18, 16, v231
v_and_b32 v19, 0xffff0000, v231
v_mfma_f32_16x16x32_bf16 a[92:95], v[120:123], v[40:43], a[92:95]
v_mul_f32 v14, v14, v18
v_mul_f32 v15, v15, v19
v_mfma_f32_16x16x32_bf16 a[92:95], v[124:127], v[44:47], a[92:95]
v_cvt_pk_bf16_f32 v23, v14, v15
ds_write_b128 v5, v[20:23] offset:8192
s_waitcnt lgkmcnt(3)
v_mfma_f32_16x16x32_bf16 a[96:99], v[96:99], v[48:51], a[96:99]
ds_read_b128 v[40:43], v2 offset:0
v_mfma_f32_16x16x32_bf16 a[96:99], v[100:103], v[52:55], a[96:99]
ds_read_b128 v[44:47], v3 offset:0
v_accvgpr_read_b32 v12, a210
v_mfma_f32_16x16x32_bf16 a[100:103], v[104:107], v[48:51], a[100:103]
v_accvgpr_read_b32 v13, a214
v_lshlrev_b32 v16, 16, v236
v_mfma_f32_16x16x32_bf16 a[100:103], v[108:111], v[52:55], a[100:103]
v_and_b32 v17, 0xffff0000, v236
v_mul_f32 v12, v12, v16
v_mfma_f32_16x16x32_bf16 a[104:107], v[112:115], v[48:51], a[104:107]
v_mul_f32 v13, v13, v17
v_cvt_pk_bf16_f32 v20, v12, v13
v_mfma_f32_16x16x32_bf16 a[104:107], v[116:119], v[52:55], a[104:107]
v_accvgpr_read_b32 v14, a218
v_accvgpr_read_b32 v15, a222
v_mfma_f32_16x16x32_bf16 a[108:111], v[120:123], v[48:51], a[108:111]
v_lshlrev_b32 v18, 16, v237
v_and_b32 v19, 0xffff0000, v237
v_mfma_f32_16x16x32_bf16 a[108:111], v[124:127], v[52:55], a[108:111]
v_mul_f32 v14, v14, v18
v_mul_f32 v15, v15, v19
s_waitcnt lgkmcnt(3)
v_mfma_f32_16x16x32_bf16 a[112:115], v[96:99], v[56:59], a[112:115]
ds_read_b128 v[48:51], v2 offset:2048
buffer_load_dwordx4 v[96:99], v1, s[12:15], s33 offen offset:0 sc1
v_mfma_f32_16x16x32_bf16 a[112:115], v[100:103], v[60:63], a[112:115]
ds_read_b128 v[52:55], v3 offset:2048
v_mfma_f32_16x16x32_bf16 a[116:119], v[104:107], v[56:59], a[116:119]
v_cvt_pk_bf16_f32 v21, v14, v15
v_accvgpr_read_b32 v12, a211
v_mfma_f32_16x16x32_bf16 a[116:119], v[108:111], v[60:63], a[116:119]
buffer_load_dwordx4 v[100:103], v1, s[12:15], s33 offen offset:1024 sc1
v_accvgpr_read_b32 v13, a215
v_mfma_f32_16x16x32_bf16 a[120:123], v[112:115], v[56:59], a[120:123]
v_lshlrev_b32 v16, 16, v238
v_and_b32 v17, 0xffff0000, v238
v_mfma_f32_16x16x32_bf16 a[120:123], v[116:119], v[60:63], a[120:123]
v_mul_f32 v12, v12, v16
v_mul_f32 v13, v13, v17
v_mfma_f32_16x16x32_bf16 a[124:127], v[120:123], v[56:59], a[124:127]
buffer_load_dwordx4 v[104:107], v1, s[12:15], s33 offen offset:2048 sc1
v_cvt_pk_bf16_f32 v22, v12, v13
v_accvgpr_read_b32 v14, a219
v_mfma_f32_16x16x32_bf16 a[124:127], v[124:127], v[60:63], a[124:127]
v_accvgpr_read_b32 v15, a223
v_lshlrev_b32 v18, 16, v239
s_waitcnt vmcnt(11) lgkmcnt(2)
v_mfma_f32_16x16x32_bf16 a[128:131], v[64:67], v[40:43], a[128:131]
ds_read_b128 v[56:59], v2 offset:4096
v_mfma_f32_16x16x32_bf16 a[128:131], v[68:71], v[44:47], a[128:131]
ds_read_b128 v[60:63], v3 offset:4096
buffer_load_dwordx4 v[108:111], v1, s[12:15], s33 offen offset:3072 sc1
s_waitcnt vmcnt(10)
v_mfma_f32_16x16x32_bf16 a[132:135], v[72:75], v[40:43], a[132:135]
v_and_b32 v19, 0xffff0000, v239
v_mfma_f32_16x16x32_bf16 a[132:135], v[76:79], v[44:47], a[132:135]
ds_read_b128 v[32:35], v6 offset:0
v_mul_f32 v14, v14, v18
s_waitcnt vmcnt(8)
v_mfma_f32_16x16x32_bf16 a[136:139], v[80:83], v[40:43], a[136:139]
buffer_load_dwordx4 v[112:115], v1, s[12:15], s34 offen offset:0 sc1
v_mfma_f32_16x16x32_bf16 a[136:139], v[84:87], v[44:47], a[136:139]
v_mul_f32 v15, v15, v19
v_cvt_pk_bf16_f32 v23, v14, v15
s_waitcnt vmcnt(7)
v_mfma_f32_16x16x32_bf16 a[140:143], v[88:91], v[40:43], a[140:143]
ds_write_b128 v5, v[20:23] offset:10240
v_mfma_f32_16x16x32_bf16 a[140:143], v[92:95], v[44:47], a[140:143]
buffer_load_dwordx4 v[116:119], v1, s[12:15], s34 offen offset:1024 sc1
v_accvgpr_read_b32 v12, a226
s_waitcnt lgkmcnt(4)
v_mfma_f32_16x16x32_bf16 a[144:147], v[64:67], v[48:51], a[144:147]
ds_read_b128 v[40:43], v2 offset:6144
v_mfma_f32_16x16x32_bf16 a[144:147], v[68:71], v[52:55], a[144:147]
ds_read_b128 v[44:47], v3 offset:6144
v_accvgpr_read_b32 v13, a230
v_mfma_f32_16x16x32_bf16 a[148:151], v[72:75], v[48:51], a[148:151]
buffer_load_dwordx4 v[120:123], v1, s[12:15], s34 offen offset:2048 sc1
v_lshlrev_b32 v16, 16, v244
v_mfma_f32_16x16x32_bf16 a[148:151], v[76:79], v[52:55], a[148:151]
ds_read_b128 v[36:39], v7 offset:1024
v_and_b32 v17, 0xffff0000, v244
v_mfma_f32_16x16x32_bf16 a[152:155], v[80:83], v[48:51], a[152:155]
v_mul_f32 v12, v12, v16
v_mul_f32 v13, v13, v17
v_mfma_f32_16x16x32_bf16 a[152:155], v[84:87], v[52:55], a[152:155]
buffer_load_dwordx4 v[124:127], v1, s[12:15], s34 offen offset:3072 sc1
s_add_u32 s33, s33, 0x8000
s_add_u32 s34, s34, 0x8000
v_mfma_f32_16x16x32_bf16 a[156:159], v[88:91], v[48:51], a[156:159]
s_add_u32 s6, s38, 0x0
s_waitcnt lgkmcnt(4)
buffer_store_dwordx4 v[32:35], v24, s[20:23], s6 offen sc1
v_mfma_f32_16x16x32_bf16 a[156:159], v[92:95], v[52:55], a[156:159]
v_mfma_f32_16x16x32_bf16 a[160:163], v[64:67], v[56:59], a[160:163]
ds_read_b128 v[48:51], v2 offset:8192
v_cvt_pk_bf16_f32 v20, v12, v13
v_mfma_f32_16x16x32_bf16 a[160:163], v[68:71], v[60:63], a[160:163]
ds_read_b128 v[52:55], v3 offset:8192
v_accvgpr_read_b32 v14, a234
v_mfma_f32_16x16x32_bf16 a[164:167], v[72:75], v[56:59], a[164:167]
v_accvgpr_read_b32 v15, a238
v_lshlrev_b32 v18, 16, v245
v_mfma_f32_16x16x32_bf16 a[164:167], v[76:79], v[60:63], a[164:167]
ds_read_b128 v[32:35], v6 offset:2048
v_and_b32 v19, 0xffff0000, v245
v_mfma_f32_16x16x32_bf16 a[168:171], v[80:83], v[56:59], a[168:171]
v_mul_f32 v14, v14, v18
v_mul_f32 v15, v15, v19
v_mfma_f32_16x16x32_bf16 a[168:171], v[84:87], v[60:63], a[168:171]
v_cvt_pk_bf16_f32 v21, v14, v15
v_accvgpr_read_b32 v12, a227
v_mfma_f32_16x16x32_bf16 a[172:175], v[88:91], v[56:59], a[172:175]
s_add_u32 s6, s38, 0x4000
s_waitcnt lgkmcnt(3)
buffer_store_dwordx4 v[36:39], v24, s[20:23], s6 offen sc1
v_mfma_f32_16x16x32_bf16 a[172:175], v[92:95], v[60:63], a[172:175]
v_accvgpr_read_b32 v13, a231
v_mfma_f32_16x16x32_bf16 a[176:179], v[64:67], v[40:43], a[176:179]
ds_read_b128 v[56:59], v2 offset:10240
v_lshlrev_b32 v16, 16, v246
v_mfma_f32_16x16x32_bf16 a[176:179], v[68:71], v[44:47], a[176:179]
ds_read_b128 v[60:63], v3 offset:10240
v_and_b32 v17, 0xffff0000, v246
v_mul_f32 v12, v12, v16
v_mfma_f32_16x16x32_bf16 a[180:183], v[72:75], v[40:43], a[180:183]
v_mul_f32 v13, v13, v17
v_cvt_pk_bf16_f32 v22, v12, v13
v_mfma_f32_16x16x32_bf16 a[180:183], v[76:79], v[44:47], a[180:183]
v_accvgpr_read_b32 v14, a235
v_accvgpr_read_b32 v15, a239
v_mfma_f32_16x16x32_bf16 a[184:187], v[80:83], v[40:43], a[184:187]
v_lshlrev_b32 v18, 16, v247
v_and_b32 v19, 0xffff0000, v247
v_mfma_f32_16x16x32_bf16 a[184:187], v[84:87], v[44:47], a[184:187]
v_mul_f32 v14, v14, v18
v_mul_f32 v15, v15, v19
v_mfma_f32_16x16x32_bf16 a[188:191], v[88:91], v[40:43], a[188:191]
s_add_u32 s6, s38, 0x8000
s_waitcnt lgkmcnt(2)
buffer_store_dwordx4 v[32:35], v24, s[20:23], s6 offen sc1
v_mfma_f32_16x16x32_bf16 a[188:191], v[92:95], v[44:47], a[188:191]
v_cvt_pk_bf16_f32 v23, v14, v15
v_mfma_f32_16x16x32_bf16 a[192:195], v[64:67], v[48:51], a[192:195]
ds_read_b128 v[40:43], v2 offset:12288
ds_write_b128 v5, v[20:23] offset:12288
v_mfma_f32_16x16x32_bf16 a[192:195], v[68:71], v[52:55], a[192:195]
ds_read_b128 v[44:47], v3 offset:12288
v_accvgpr_read_b32 v12, a242
v_accvgpr_read_b32 v13, a246
v_mfma_f32_16x16x32_bf16 a[196:199], v[72:75], v[48:51], a[196:199]
v_lshlrev_b32 v16, 16, v252
v_and_b32 v17, 0xffff0000, v252
v_mfma_f32_16x16x32_bf16 a[196:199], v[76:79], v[52:55], a[196:199]
v_mul_f32 v12, v12, v16
v_mul_f32 v13, v13, v17
v_mfma_f32_16x16x32_bf16 a[200:203], v[80:83], v[48:51], a[200:203]
v_cvt_pk_bf16_f32 v20, v12, v13
v_accvgpr_read_b32 v14, a250
v_mfma_f32_16x16x32_bf16 a[200:203], v[84:87], v[52:55], a[200:203]
v_accvgpr_read_b32 v15, a254
v_lshlrev_b32 v18, 16, v253
v_mfma_f32_16x16x32_bf16 a[204:207], v[88:91], v[48:51], a[204:207]
v_and_b32 v19, 0xffff0000, v253
v_mul_f32 v14, v14, v18
v_mul_f32 v15, v15, v19
v_mfma_f32_16x16x32_bf16 a[204:207], v[92:95], v[52:55], a[204:207]
v_cvt_pk_bf16_f32 v21, v14, v15
v_accvgpr_read_b32 v12, a243
s_waitcnt lgkmcnt(3)
v_mfma_f32_16x16x32_bf16 a[208:211], v[64:67], v[56:59], a[208:211]
ds_read_b128 v[48:51], v2 offset:14336
v_mfma_f32_16x16x32_bf16 a[208:211], v[68:71], v[60:63], a[208:211]
ds_read_b128 v[52:55], v3 offset:14336
v_accvgpr_read_b32 v13, a247
v_mfma_f32_16x16x32_bf16 a[212:215], v[72:75], v[56:59], a[212:215]
v_lshlrev_b32 v16, 16, v254
v_and_b32 v17, 0xffff0000, v254
v_mfma_f32_16x16x32_bf16 a[212:215], v[76:79], v[60:63], a[212:215]
v_mul_f32 v12, v12, v16
v_mul_f32 v13, v13, v17
v_mfma_f32_16x16x32_bf16 a[216:219], v[80:83], v[56:59], a[216:219]
v_cvt_pk_bf16_f32 v22, v12, v13
v_accvgpr_read_b32 v14, a251
v_mfma_f32_16x16x32_bf16 a[216:219], v[84:87], v[60:63], a[216:219]
v_accvgpr_read_b32 v15, a255
v_lshlrev_b32 v18, 16, v255
v_and_b32 v19, 0xffff0000, v255
v_mfma_f32_16x16x32_bf16 a[220:223], v[88:91], v[56:59], a[220:223]
v_mul_f32 v14, v14, v18
v_mul_f32 v15, v15, v19
v_mfma_f32_16x16x32_bf16 a[220:223], v[92:95], v[60:63], a[220:223]
v_cvt_pk_bf16_f32 v23, v14, v15
ds_write_b128 v5, v[20:23] offset:14336
s_waitcnt lgkmcnt(3)
v_mfma_f32_16x16x32_bf16 a[224:227], v[64:67], v[40:43], a[224:227]
ds_read_b128 v[56:59], v2 offset:16384
v_mfma_f32_16x16x32_bf16 a[224:227], v[68:71], v[44:47], a[224:227]
ds_read_b128 v[60:63], v3 offset:16384
v_mfma_f32_16x16x32_bf16 a[228:231], v[72:75], v[40:43], a[228:231]
v_mfma_f32_16x16x32_bf16 a[228:231], v[76:79], v[44:47], a[228:231]
v_mfma_f32_16x16x32_bf16 a[232:235], v[80:83], v[40:43], a[232:235]
v_mfma_f32_16x16x32_bf16 a[232:235], v[84:87], v[44:47], a[232:235]
v_mfma_f32_16x16x32_bf16 a[236:239], v[88:91], v[40:43], a[236:239]
v_mfma_f32_16x16x32_bf16 a[236:239], v[92:95], v[44:47], a[236:239]
s_waitcnt lgkmcnt(3)
v_mfma_f32_16x16x32_bf16 a[240:243], v[64:67], v[48:51], a[240:243]
ds_read_b128 v[40:43], v2 offset:18432
buffer_load_dwordx4 v[64:67], v1, s[12:15], s33 offen offset:0 sc1
v_mfma_f32_16x16x32_bf16 a[240:243], v[68:71], v[52:55], a[240:243]
ds_read_b128 v[44:47], v3 offset:18432
v_mfma_f32_16x16x32_bf16 a[244:247], v[72:75], v[48:51], a[244:247]
v_mfma_f32_16x16x32_bf16 a[244:247], v[76:79], v[52:55], a[244:247]
buffer_load_dwordx4 v[68:71], v1, s[12:15], s33 offen offset:1024 sc1
v_mfma_f32_16x16x32_bf16 a[248:251], v[80:83], v[48:51], a[248:251]
v_mfma_f32_16x16x32_bf16 a[248:251], v[84:87], v[52:55], a[248:251]
v_mfma_f32_16x16x32_bf16 a[252:255], v[88:91], v[48:51], a[252:255]
buffer_load_dwordx4 v[72:75], v1, s[12:15], s33 offen offset:2048 sc1
v_mfma_f32_16x16x32_bf16 a[252:255], v[92:95], v[52:55], a[252:255]
s_waitcnt vmcnt(12) lgkmcnt(2)
v_mfma_f32_16x16x32_bf16 a[128:131], v[96:99], v[56:59], a[128:131]
ds_read_b128 v[48:51], v2 offset:20480
v_mfma_f32_16x16x32_bf16 a[128:131], v[100:103], v[60:63], a[128:131]
ds_read_b128 v[52:55], v3 offset:20480
buffer_load_dwordx4 v[76:79], v1, s[12:15], s33 offen offset:3072 sc1
s_waitcnt vmcnt(11)
v_mfma_f32_16x16x32_bf16 a[132:135], v[104:107], v[56:59], a[132:135]
v_mfma_f32_16x16x32_bf16 a[132:135], v[108:111], v[60:63], a[132:135]
ds_read_b128 v[36:39], v7 offset:3072
s_waitcnt vmcnt(9)
v_mfma_f32_16x16x32_bf16 a[136:139], v[112:115], v[56:59], a[136:139]
buffer_load_dwordx4 v[80:83], v1, s[12:15], s34 offen offset:0 sc1
v_mfma_f32_16x16x32_bf16 a[136:139], v[116:119], v[60:63], a[136:139]
s_waitcnt vmcnt(8)
v_mfma_f32_16x16x32_bf16 a[140:143], v[120:123], v[56:59], a[140:143]
v_mfma_f32_16x16x32_bf16 a[140:143], v[124:127], v[60:63], a[140:143]
buffer_load_dwordx4 v[84:87], v1, s[12:15], s34 offen offset:1024 sc1
v_mov_b32 v0, 1
s_mov_b64 exec, 1
buffer_store_dword v0, off, s[24:27], s41 sc1
s_mov_b64 exec, -1
s_waitcnt lgkmcnt(3)
v_mfma_f32_16x16x32_bf16 a[144:147], v[96:99], v[40:43], a[144:147]
ds_read_b128 v[56:59], v2 offset:22528
v_mfma_f32_16x16x32_bf16 a[144:147], v[100:103], v[44:47], a[144:147]
ds_read_b128 v[60:63], v3 offset:22528
v_mfma_f32_16x16x32_bf16 a[148:151], v[104:107], v[40:43], a[148:151]
buffer_load_dwordx4 v[88:91], v1, s[12:15], s34 offen offset:2048 sc1
v_mfma_f32_16x16x32_bf16 a[148:151], v[108:111], v[44:47], a[148:151]
ds_read_b128 v[32:35], v6 offset:4096
v_mfma_f32_16x16x32_bf16 a[152:155], v[112:115], v[40:43], a[152:155]
v_mfma_f32_16x16x32_bf16 a[152:155], v[116:119], v[44:47], a[152:155]
buffer_load_dwordx4 v[92:95], v1, s[12:15], s34 offen offset:3072 sc1
s_add_u32 s33, s33, 0x8000
s_add_u32 s34, s34, 0x8000
v_mfma_f32_16x16x32_bf16 a[156:159], v[120:123], v[40:43], a[156:159]
s_add_u32 s6, s38, 0xc000
s_waitcnt lgkmcnt(3)
buffer_store_dwordx4 v[36:39], v24, s[20:23], s6 offen sc1
v_mfma_f32_16x16x32_bf16 a[156:159], v[124:127], v[44:47], a[156:159]
v_mfma_f32_16x16x32_bf16 a[160:163], v[96:99], v[48:51], a[160:163]
ds_read_b128 v[40:43], v2 offset:24576
v_mfma_f32_16x16x32_bf16 a[160:163], v[100:103], v[52:55], a[160:163]
ds_read_b128 v[44:47], v3 offset:24576
v_mfma_f32_16x16x32_bf16 a[164:167], v[104:107], v[48:51], a[164:167]
v_mfma_f32_16x16x32_bf16 a[164:167], v[108:111], v[52:55], a[164:167]
ds_read_b128 v[36:39], v7 offset:5120
v_mfma_f32_16x16x32_bf16 a[168:171], v[112:115], v[48:51], a[168:171]
v_mfma_f32_16x16x32_bf16 a[168:171], v[116:119], v[52:55], a[168:171]
v_mfma_f32_16x16x32_bf16 a[172:175], v[120:123], v[48:51], a[172:175]
s_add_u32 s6, s38, 0x10000
s_waitcnt lgkmcnt(3)
buffer_store_dwordx4 v[32:35], v24, s[20:23], s6 offen sc1
v_mfma_f32_16x16x32_bf16 a[172:175], v[124:127], v[52:55], a[172:175]
v_mfma_f32_16x16x32_bf16 a[176:179], v[96:99], v[56:59], a[176:179]
ds_read_b128 v[48:51], v2 offset:26624
v_mfma_f32_16x16x32_bf16 a[176:179], v[100:103], v[60:63], a[176:179]
ds_read_b128 v[52:55], v3 offset:26624
v_mfma_f32_16x16x32_bf16 a[180:183], v[104:107], v[56:59], a[180:183]
v_mfma_f32_16x16x32_bf16 a[180:183], v[108:111], v[60:63], a[180:183]
v_mfma_f32_16x16x32_bf16 a[184:187], v[112:115], v[56:59], a[184:187]
v_mfma_f32_16x16x32_bf16 a[184:187], v[116:119], v[60:63], a[184:187]
v_mfma_f32_16x16x32_bf16 a[188:191], v[120:123], v[56:59], a[188:191]
s_add_u32 s6, s38, 0x14000
s_waitcnt lgkmcnt(2)
buffer_store_dwordx4 v[36:39], v24, s[20:23], s6 offen sc1
v_mfma_f32_16x16x32_bf16 a[188:191], v[124:127], v[60:63], a[188:191]
v_mfma_f32_16x16x32_bf16 a[192:195], v[96:99], v[40:43], a[192:195]
ds_read_b128 v[56:59], v2 offset:28672
v_mfma_f32_16x16x32_bf16 a[192:195], v[100:103], v[44:47], a[192:195]
ds_read_b128 v[60:63], v3 offset:28672
v_mfma_f32_16x16x32_bf16 a[196:199], v[104:107], v[40:43], a[196:199]
v_mfma_f32_16x16x32_bf16 a[196:199], v[108:111], v[44:47], a[196:199]
v_mfma_f32_16x16x32_bf16 a[200:203], v[112:115], v[40:43], a[200:203]
v_mfma_f32_16x16x32_bf16 a[200:203], v[116:119], v[44:47], a[200:203]
v_mfma_f32_16x16x32_bf16 a[204:207], v[120:123], v[40:43], a[204:207]
v_mfma_f32_16x16x32_bf16 a[204:207], v[124:127], v[44:47], a[204:207]
s_waitcnt lgkmcnt(2)
v_mfma_f32_16x16x32_bf16 a[208:211], v[96:99], v[48:51], a[208:211]
ds_read_b128 v[40:43], v2 offset:30720
v_mfma_f32_16x16x32_bf16 a[208:211], v[100:103], v[52:55], a[208:211]
ds_read_b128 v[44:47], v3 offset:30720
v_mfma_f32_16x16x32_bf16 a[212:215], v[104:107], v[48:51], a[212:215]
v_mfma_f32_16x16x32_bf16 a[212:215], v[108:111], v[52:55], a[212:215]
v_mfma_f32_16x16x32_bf16 a[216:219], v[112:115], v[48:51], a[216:219]
v_mfma_f32_16x16x32_bf16 a[216:219], v[116:119], v[52:55], a[216:219]
v_mfma_f32_16x16x32_bf16 a[220:223], v[120:123], v[48:51], a[220:223]
v_mfma_f32_16x16x32_bf16 a[220:223], v[124:127], v[52:55], a[220:223]
s_waitcnt lgkmcnt(2)
v_mfma_f32_16x16x32_bf16 a[224:227], v[96:99], v[56:59], a[224:227]
ds_read_b128 v[48:51], v2 offset:32768
v_mfma_f32_16x16x32_bf16 a[224:227], v[100:103], v[60:63], a[224:227]
ds_read_b128 v[52:55], v3 offset:32768
v_mfma_f32_16x16x32_bf16 a[228:231], v[104:107], v[56:59], a[228:231]
v_mfma_f32_16x16x32_bf16 a[228:231], v[108:111], v[60:63], a[228:231]
v_mfma_f32_16x16x32_bf16 a[232:235], v[112:115], v[56:59], a[232:235]
v_mfma_f32_16x16x32_bf16 a[232:235], v[116:119], v[60:63], a[232:235]
v_mfma_f32_16x16x32_bf16 a[236:239], v[120:123], v[56:59], a[236:239]
v_mfma_f32_16x16x32_bf16 a[236:239], v[124:127], v[60:63], a[236:239]
s_waitcnt lgkmcnt(2)
v_mfma_f32_16x16x32_bf16 a[240:243], v[96:99], v[40:43], a[240:243]
ds_read_b128 v[56:59], v2 offset:34816
buffer_load_dwordx4 v[96:99], v1, s[12:15], s33 offen offset:0 sc1
v_mfma_f32_16x16x32_bf16 a[240:243], v[100:103], v[44:47], a[240:243]
ds_read_b128 v[60:63], v3 offset:34816
v_mfma_f32_16x16x32_bf16 a[244:247], v[104:107], v[40:43], a[244:247]
v_mfma_f32_16x16x32_bf16 a[244:247], v[108:111], v[44:47], a[244:247]
buffer_load_dwordx4 v[100:103], v1, s[12:15], s33 offen offset:1024 sc1
v_mfma_f32_16x16x32_bf16 a[248:251], v[112:115], v[40:43], a[248:251]
v_mfma_f32_16x16x32_bf16 a[248:251], v[116:119], v[44:47], a[248:251]
v_mfma_f32_16x16x32_bf16 a[252:255], v[120:123], v[40:43], a[252:255]
buffer_load_dwordx4 v[104:107], v1, s[12:15], s33 offen offset:2048 sc1
v_mfma_f32_16x16x32_bf16 a[252:255], v[124:127], v[44:47], a[252:255]
s_waitcnt vmcnt(13) lgkmcnt(2)
v_mfma_f32_16x16x32_bf16 a[128:131], v[64:67], v[48:51], a[128:131]
ds_read_b128 v[40:43], v2 offset:36864
v_mfma_f32_16x16x32_bf16 a[128:131], v[68:71], v[52:55], a[128:131]
ds_read_b128 v[44:47], v3 offset:36864
buffer_load_dwordx4 v[108:111], v1, s[12:15], s33 offen offset:3072 sc1
buffer_load_dword v12, v11, s[24:27], s42 offen sc1
s_waitcnt vmcnt(13)
v_mfma_f32_16x16x32_bf16 a[132:135], v[72:75], v[48:51], a[132:135]
v_mfma_f32_16x16x32_bf16 a[132:135], v[76:79], v[52:55], a[132:135]
ds_read_b128 v[32:35], v6 offset:6144
s_waitcnt vmcnt(11)
v_mfma_f32_16x16x32_bf16 a[136:139], v[80:83], v[48:51], a[136:139]
buffer_load_dwordx4 v[112:115], v1, s[12:15], s34 offen offset:0 sc1
v_mfma_f32_16x16x32_bf16 a[136:139], v[84:87], v[52:55], a[136:139]
s_waitcnt vmcnt(9)
v_mfma_f32_16x16x32_bf16 a[140:143], v[88:91], v[48:51], a[140:143]
v_mfma_f32_16x16x32_bf16 a[140:143], v[92:95], v[52:55], a[140:143]
buffer_load_dwordx4 v[116:119], v1, s[12:15], s34 offen offset:1024 sc1
s_waitcnt lgkmcnt(3)
v_mfma_f32_16x16x32_bf16 a[144:147], v[64:67], v[56:59], a[144:147]
ds_read_b128 v[48:51], v2 offset:38912
v_mfma_f32_16x16x32_bf16 a[144:147], v[68:71], v[60:63], a[144:147]
ds_read_b128 v[52:55], v3 offset:38912
v_mfma_f32_16x16x32_bf16 a[148:151], v[72:75], v[56:59], a[148:151]
buffer_load_dwordx4 v[120:123], v1, s[12:15], s34 offen offset:2048 sc1
v_mfma_f32_16x16x32_bf16 a[148:151], v[76:79], v[60:63], a[148:151]
ds_read_b128 v[36:39], v7 offset:7168
v_mfma_f32_16x16x32_bf16 a[152:155], v[80:83], v[56:59], a[152:155]
v_mfma_f32_16x16x32_bf16 a[152:155], v[84:87], v[60:63], a[152:155]
buffer_load_dwordx4 v[124:127], v1, s[12:15], s34 offen offset:3072 sc1
s_add_u32 s33, s33, 0x8000
s_add_u32 s34, s34, 0x8000
v_mfma_f32_16x16x32_bf16 a[156:159], v[88:91], v[56:59], a[156:159]
s_add_u32 s6, s38, 0x18000
s_waitcnt lgkmcnt(3)
buffer_store_dwordx4 v[32:35], v24, s[20:23], s6 offen sc1
v_mfma_f32_16x16x32_bf16 a[156:159], v[92:95], v[60:63], a[156:159]
v_mfma_f32_16x16x32_bf16 a[160:163], v[64:67], v[40:43], a[160:163]
ds_read_b128 v[56:59], v2 offset:40960
v_mfma_f32_16x16x32_bf16 a[160:163], v[68:71], v[44:47], a[160:163]
ds_read_b128 v[60:63], v3 offset:40960
v_mfma_f32_16x16x32_bf16 a[164:167], v[72:75], v[40:43], a[164:167]
v_mfma_f32_16x16x32_bf16 a[164:167], v[76:79], v[44:47], a[164:167]
ds_read_b128 v[32:35], v6 offset:8192
v_mfma_f32_16x16x32_bf16 a[168:171], v[80:83], v[40:43], a[168:171]
v_mfma_f32_16x16x32_bf16 a[168:171], v[84:87], v[44:47], a[168:171]
v_mfma_f32_16x16x32_bf16 a[172:175], v[88:91], v[40:43], a[172:175]
s_add_u32 s6, s38, 0x1c000
s_waitcnt lgkmcnt(3)
buffer_store_dwordx4 v[36:39], v24, s[20:23], s6 offen sc1
v_mfma_f32_16x16x32_bf16 a[172:175], v[92:95], v[44:47], a[172:175]
v_mfma_f32_16x16x32_bf16 a[176:179], v[64:67], v[48:51], a[176:179]
ds_read_b128 v[40:43], v2 offset:43008
v_mfma_f32_16x16x32_bf16 a[176:179], v[68:71], v[52:55], a[176:179]
ds_read_b128 v[44:47], v3 offset:43008
v_mfma_f32_16x16x32_bf16 a[180:183], v[72:75], v[48:51], a[180:183]
v_mfma_f32_16x16x32_bf16 a[180:183], v[76:79], v[52:55], a[180:183]
v_mfma_f32_16x16x32_bf16 a[184:187], v[80:83], v[48:51], a[184:187]
v_mfma_f32_16x16x32_bf16 a[184:187], v[84:87], v[52:55], a[184:187]
v_mfma_f32_16x16x32_bf16 a[188:191], v[88:91], v[48:51], a[188:191]
s_add_u32 s6, s38, 0x20000
s_waitcnt lgkmcnt(2)
buffer_store_dwordx4 v[32:35], v24, s[20:23], s6 offen sc1
v_mfma_f32_16x16x32_bf16 a[188:191], v[92:95], v[52:55], a[188:191]
v_mfma_f32_16x16x32_bf16 a[192:195], v[64:67], v[56:59], a[192:195]
ds_read_b128 v[48:51], v2 offset:45056
v_mfma_f32_16x16x32_bf16 a[192:195], v[68:71], v[60:63], a[192:195]
ds_read_b128 v[52:55], v3 offset:45056
v_mfma_f32_16x16x32_bf16 a[196:199], v[72:75], v[56:59], a[196:199]
v_mfma_f32_16x16x32_bf16 a[196:199], v[76:79], v[60:63], a[196:199]
v_mfma_f32_16x16x32_bf16 a[200:203], v[80:83], v[56:59], a[200:203]
v_mfma_f32_16x16x32_bf16 a[200:203], v[84:87], v[60:63], a[200:203]
v_mfma_f32_16x16x32_bf16 a[204:207], v[88:91], v[56:59], a[204:207]
v_mfma_f32_16x16x32_bf16 a[204:207], v[92:95], v[60:63], a[204:207]
s_waitcnt lgkmcnt(2)
v_mfma_f32_16x16x32_bf16 a[208:211], v[64:67], v[40:43], a[208:211]
ds_read_b128 v[56:59], v2 offset:47104
v_mfma_f32_16x16x32_bf16 a[208:211], v[68:71], v[44:47], a[208:211]
ds_read_b128 v[60:63], v3 offset:47104
v_mfma_f32_16x16x32_bf16 a[212:215], v[72:75], v[40:43], a[212:215]
v_mfma_f32_16x16x32_bf16 a[212:215], v[76:79], v[44:47], a[212:215]
v_mfma_f32_16x16x32_bf16 a[216:219], v[80:83], v[40:43], a[216:219]
v_mfma_f32_16x16x32_bf16 a[216:219], v[84:87], v[44:47], a[216:219]
v_mfma_f32_16x16x32_bf16 a[220:223], v[88:91], v[40:43], a[220:223]
v_mfma_f32_16x16x32_bf16 a[220:223], v[92:95], v[44:47], a[220:223]
s_waitcnt lgkmcnt(2)
v_mfma_f32_16x16x32_bf16 a[224:227], v[64:67], v[48:51], a[224:227]
ds_read_b128 v[40:43], v2 offset:49152
v_mfma_f32_16x16x32_bf16 a[224:227], v[68:71], v[52:55], a[224:227]
ds_read_b128 v[44:47], v3 offset:49152
v_mfma_f32_16x16x32_bf16 a[228:231], v[72:75], v[48:51], a[228:231]
v_mfma_f32_16x16x32_bf16 a[228:231], v[76:79], v[52:55], a[228:231]
v_mfma_f32_16x16x32_bf16 a[232:235], v[80:83], v[48:51], a[232:235]
v_mfma_f32_16x16x32_bf16 a[232:235], v[84:87], v[52:55], a[232:235]
v_mfma_f32_16x16x32_bf16 a[236:239], v[88:91], v[48:51], a[236:239]
v_mfma_f32_16x16x32_bf16 a[236:239], v[92:95], v[52:55], a[236:239]
s_waitcnt lgkmcnt(2)
v_mfma_f32_16x16x32_bf16 a[240:243], v[64:67], v[56:59], a[240:243]
ds_read_b128 v[48:51], v2 offset:51200
buffer_load_dwordx4 v[64:67], v1, s[12:15], s33 offen offset:0 sc1
v_mfma_f32_16x16x32_bf16 a[240:243], v[68:71], v[60:63], a[240:243]
ds_read_b128 v[52:55], v3 offset:51200
v_mfma_f32_16x16x32_bf16 a[244:247], v[72:75], v[56:59], a[244:247]
v_mfma_f32_16x16x32_bf16 a[244:247], v[76:79], v[60:63], a[244:247]
buffer_load_dwordx4 v[68:71], v1, s[12:15], s33 offen offset:1024 sc1
v_mfma_f32_16x16x32_bf16 a[248:251], v[80:83], v[56:59], a[248:251]
v_mfma_f32_16x16x32_bf16 a[248:251], v[84:87], v[60:63], a[248:251]
v_mfma_f32_16x16x32_bf16 a[252:255], v[88:91], v[56:59], a[252:255]
buffer_load_dwordx4 v[72:75], v1, s[12:15], s33 offen offset:2048 sc1
v_mfma_f32_16x16x32_bf16 a[252:255], v[92:95], v[60:63], a[252:255]
s_waitcnt vmcnt(13) lgkmcnt(2)
v_mfma_f32_16x16x32_bf16 a[128:131], v[96:99], v[40:43], a[128:131]
ds_read_b128 v[56:59], v2 offset:53248
v_mfma_f32_16x16x32_bf16 a[128:131], v[100:103], v[44:47], a[128:131]
ds_read_b128 v[60:63], v3 offset:53248
buffer_load_dwordx4 v[76:79], v1, s[12:15], s33 offen offset:3072 sc1
s_waitcnt vmcnt(12)
v_mfma_f32_16x16x32_bf16 a[132:135], v[104:107], v[40:43], a[132:135]
v_mfma_f32_16x16x32_bf16 a[132:135], v[108:111], v[44:47], a[132:135]
ds_read_b128 v[36:39], v7 offset:9216
s_waitcnt vmcnt(9)
v_mfma_f32_16x16x32_bf16 a[136:139], v[112:115], v[40:43], a[136:139]
buffer_load_dwordx4 v[80:83], v1, s[12:15], s34 offen offset:0 sc1
v_mfma_f32_16x16x32_bf16 a[136:139], v[116:119], v[44:47], a[136:139]
s_waitcnt vmcnt(8)
v_mfma_f32_16x16x32_bf16 a[140:143], v[120:123], v[40:43], a[140:143]
v_mfma_f32_16x16x32_bf16 a[140:143], v[124:127], v[44:47], a[140:143]
buffer_load_dwordx4 v[84:87], v1, s[12:15], s34 offen offset:1024 sc1
s_waitcnt lgkmcnt(3)
v_mfma_f32_16x16x32_bf16 a[144:147], v[96:99], v[48:51], a[144:147]
ds_read_b128 v[40:43], v2 offset:55296
v_mfma_f32_16x16x32_bf16 a[144:147], v[100:103], v[52:55], a[144:147]
ds_read_b128 v[44:47], v3 offset:55296
v_mfma_f32_16x16x32_bf16 a[148:151], v[104:107], v[48:51], a[148:151]
buffer_load_dwordx4 v[88:91], v1, s[12:15], s34 offen offset:2048 sc1
v_mfma_f32_16x16x32_bf16 a[148:151], v[108:111], v[52:55], a[148:151]
ds_read_b128 v[32:35], v6 offset:10240
v_mfma_f32_16x16x32_bf16 a[152:155], v[112:115], v[48:51], a[152:155]
v_mfma_f32_16x16x32_bf16 a[152:155], v[116:119], v[52:55], a[152:155]
buffer_load_dwordx4 v[92:95], v1, s[12:15], s34 offen offset:3072 sc1
s_add_u32 s33, s33, 0x8000
s_add_u32 s34, s34, 0x8000
v_mfma_f32_16x16x32_bf16 a[156:159], v[120:123], v[48:51], a[156:159]
s_add_u32 s6, s38, 0x24000
s_waitcnt lgkmcnt(3)
buffer_store_dwordx4 v[36:39], v24, s[20:23], s6 offen sc1
v_mfma_f32_16x16x32_bf16 a[156:159], v[124:127], v[52:55], a[156:159]
v_mfma_f32_16x16x32_bf16 a[160:163], v[96:99], v[56:59], a[160:163]
ds_read_b128 v[48:51], v2 offset:57344
v_mfma_f32_16x16x32_bf16 a[160:163], v[100:103], v[60:63], a[160:163]
ds_read_b128 v[52:55], v3 offset:57344
v_mfma_f32_16x16x32_bf16 a[164:167], v[104:107], v[56:59], a[164:167]
v_mfma_f32_16x16x32_bf16 a[164:167], v[108:111], v[60:63], a[164:167]
ds_read_b128 v[36:39], v7 offset:11264
v_mfma_f32_16x16x32_bf16 a[168:171], v[112:115], v[56:59], a[168:171]
v_mfma_f32_16x16x32_bf16 a[168:171], v[116:119], v[60:63], a[168:171]
v_mfma_f32_16x16x32_bf16 a[172:175], v[120:123], v[56:59], a[172:175]
s_add_u32 s6, s38, 0x28000
s_waitcnt lgkmcnt(3)
buffer_store_dwordx4 v[32:35], v24, s[20:23], s6 offen sc1
v_mfma_f32_16x16x32_bf16 a[172:175], v[124:127], v[60:63], a[172:175]
v_mfma_f32_16x16x32_bf16 a[176:179], v[96:99], v[40:43], a[176:179]
ds_read_b128 v[56:59], v2 offset:59392
v_mfma_f32_16x16x32_bf16 a[176:179], v[100:103], v[44:47], a[176:179]
ds_read_b128 v[60:63], v3 offset:59392
v_mfma_f32_16x16x32_bf16 a[180:183], v[104:107], v[40:43], a[180:183]
v_mfma_f32_16x16x32_bf16 a[180:183], v[108:111], v[44:47], a[180:183]
v_mfma_f32_16x16x32_bf16 a[184:187], v[112:115], v[40:43], a[184:187]
v_mfma_f32_16x16x32_bf16 a[184:187], v[116:119], v[44:47], a[184:187]
v_mfma_f32_16x16x32_bf16 a[188:191], v[120:123], v[40:43], a[188:191]
s_add_u32 s6, s38, 0x2c000
s_waitcnt lgkmcnt(2)
buffer_store_dwordx4 v[36:39], v24, s[20:23], s6 offen sc1
v_mfma_f32_16x16x32_bf16 a[188:191], v[124:127], v[44:47], a[188:191]
v_mfma_f32_16x16x32_bf16 a[192:195], v[96:99], v[48:51], a[192:195]
ds_read_b128 v[40:43], v2 offset:61440
v_mfma_f32_16x16x32_bf16 a[192:195], v[100:103], v[52:55], a[192:195]
ds_read_b128 v[44:47], v3 offset:61440
v_mfma_f32_16x16x32_bf16 a[196:199], v[104:107], v[48:51], a[196:199]
v_mfma_f32_16x16x32_bf16 a[196:199], v[108:111], v[52:55], a[196:199]
v_mfma_f32_16x16x32_bf16 a[200:203], v[112:115], v[48:51], a[200:203]
v_mfma_f32_16x16x32_bf16 a[200:203], v[116:119], v[52:55], a[200:203]
v_mfma_f32_16x16x32_bf16 a[204:207], v[120:123], v[48:51], a[204:207]
v_mfma_f32_16x16x32_bf16 a[204:207], v[124:127], v[52:55], a[204:207]
s_waitcnt lgkmcnt(2)
v_mfma_f32_16x16x32_bf16 a[208:211], v[96:99], v[56:59], a[208:211]
ds_read_b128 v[48:51], v2 offset:63488
v_mfma_f32_16x16x32_bf16 a[208:211], v[100:103], v[60:63], a[208:211]
ds_read_b128 v[52:55], v3 offset:63488
v_mfma_f32_16x16x32_bf16 a[212:215], v[104:107], v[56:59], a[212:215]
v_mfma_f32_16x16x32_bf16 a[212:215], v[108:111], v[60:63], a[212:215]
v_mfma_f32_16x16x32_bf16 a[216:219], v[112:115], v[56:59], a[216:219]
v_mfma_f32_16x16x32_bf16 a[216:219], v[116:119], v[60:63], a[216:219]
v_mfma_f32_16x16x32_bf16 a[220:223], v[120:123], v[56:59], a[220:223]
v_mfma_f32_16x16x32_bf16 a[220:223], v[124:127], v[60:63], a[220:223]
s_waitcnt lgkmcnt(2)
v_mfma_f32_16x16x32_bf16 a[224:227], v[96:99], v[40:43], a[224:227]
v_mfma_f32_16x16x32_bf16 a[224:227], v[100:103], v[44:47], a[224:227]
v_mfma_f32_16x16x32_bf16 a[228:231], v[104:107], v[40:43], a[228:231]
v_mfma_f32_16x16x32_bf16 a[228:231], v[108:111], v[44:47], a[228:231]
v_mfma_f32_16x16x32_bf16 a[232:235], v[112:115], v[40:43], a[232:235]
v_mfma_f32_16x16x32_bf16 a[232:235], v[116:119], v[44:47], a[232:235]
v_mfma_f32_16x16x32_bf16 a[236:239], v[120:123], v[40:43], a[236:239]
v_mfma_f32_16x16x32_bf16 a[236:239], v[124:127], v[44:47], a[236:239]
s_waitcnt lgkmcnt(0)
s_barrier
v_xor_b32 v2, 0x10000, v2
v_xor_b32 v3, 0x10000, v3
v_mfma_f32_16x16x32_bf16 a[240:243], v[96:99], v[48:51], a[240:243]
ds_read_b128 v[56:59], v2 offset:0
buffer_load_dwordx4 v[96:99], v1, s[12:15], s33 offen offset:0 sc1
v_mfma_f32_16x16x32_bf16 a[240:243], v[100:103], v[52:55], a[240:243]
ds_read_b128 v[60:63], v3 offset:0
v_mfma_f32_16x16x32_bf16 a[244:247], v[104:107], v[48:51], a[244:247]
ds_read_b128 v[40:43], v2 offset:2048
v_mfma_f32_16x16x32_bf16 a[244:247], v[108:111], v[52:55], a[244:247]
ds_read_b128 v[44:47], v3 offset:2048
buffer_load_dwordx4 v[100:103], v1, s[12:15], s33 offen offset:1024 sc1
v_mfma_f32_16x16x32_bf16 a[248:251], v[112:115], v[48:51], a[248:251]
v_mfma_f32_16x16x32_bf16 a[248:251], v[116:119], v[52:55], a[248:251]
v_mfma_f32_16x16x32_bf16 a[252:255], v[120:123], v[48:51], a[252:255]
buffer_load_dwordx4 v[104:107], v1, s[12:15], s33 offen offset:2048 sc1
v_mfma_f32_16x16x32_bf16 a[252:255], v[124:127], v[52:55], a[252:255]
s_waitcnt vmcnt(12) lgkmcnt(2)
v_mfma_f32_16x16x32_bf16 a[0:3], v[64:67], v[56:59], a[0:3]
ds_read_b128 v[48:51], v2 offset:4096
v_mfma_f32_16x16x32_bf16 a[0:3], v[68:71], v[60:63], a[0:3]
ds_read_b128 v[52:55], v3 offset:4096
buffer_load_dwordx4 v[108:111], v1, s[12:15], s33 offen offset:3072 sc1
s_waitcnt vmcnt(11)
v_mfma_f32_16x16x32_bf16 a[4:7], v[72:75], v[56:59], a[4:7]
v_cmp_gt_u32 vcc, 1, v12
s_cbranch_vccz L_pok1
s_mov_b32 s4, 0x40000
L_psp1:
s_sleep 2
buffer_load_dword v12, v11, s[24:27], s42 offen sc1
s_sub_u32 s4, s4, 1
s_cbranch_scc1 L_pok1
s_waitcnt vmcnt(0)
v_cmp_gt_u32 vcc, 1, v12
s_cbranch_vccnz L_psp1
L_pok1:
v_mfma_f32_16x16x32_bf16 a[4:7], v[76:79], v[60:63], a[4:7]
s_add_u32 s35, s38, 0x0
ds_read_b128 v[32:35], v6 offset:12288
s_waitcnt vmcnt(9)
v_mfma_f32_16x16x32_bf16 a[8:11], v[80:83], v[56:59], a[8:11]
buffer_load_dwordx4 v[112:115], v1, s[12:15], s34 offen offset:0 sc1
v_mfma_f32_16x16x32_bf16 a[8:11], v[84:87], v[60:63], a[8:11]
s_waitcnt vmcnt(8)
v_mfma_f32_16x16x32_bf16 a[12:15], v[88:91], v[56:59], a[12:15]
v_mfma_f32_16x16x32_bf16 a[12:15], v[92:95], v[60:63], a[12:15]
buffer_load_dwordx4 v[116:119], v1, s[12:15], s34 offen offset:1024 sc1
s_waitcnt lgkmcnt(3)
v_mfma_f32_16x16x32_bf16 a[16:19], v[64:67], v[40:43], a[16:19]
ds_read_b128 v[56:59], v2 offset:6144
v_mfma_f32_16x16x32_bf16 a[16:19], v[68:71], v[44:47], a[16:19]
ds_read_b128 v[60:63], v3 offset:6144
v_mfma_f32_16x16x32_bf16 a[20:23], v[72:75], v[40:43], a[20:23]
buffer_load_dwordx4 v[120:123], v1, s[12:15], s34 offen offset:2048 sc1
v_mfma_f32_16x16x32_bf16 a[20:23], v[76:79], v[44:47], a[20:23]
ds_read_b128 v[36:39], v7 offset:13312
v_mfma_f32_16x16x32_bf16 a[24:27], v[80:83], v[40:43], a[24:27]
v_mfma_f32_16x16x32_bf16 a[24:27], v[84:87], v[44:47], a[24:27]
buffer_load_dwordx4 v[124:127], v1, s[12:15], s34 offen offset:3072 sc1
s_add_u32 s33, s33, 0x8000
s_add_u32 s34, s34, 0x8000
v_mfma_f32_16x16x32_bf16 a[28:31], v[88:91], v[40:43], a[28:31]
s_add_u32 s6, s38, 0x30000
s_waitcnt lgkmcnt(3)
buffer_store_dwordx4 v[32:35], v24, s[20:23], s6 offen sc1
v_mfma_f32_16x16x32_bf16 a[28:31], v[92:95], v[44:47], a[28:31]
v_mfma_f32_16x16x32_bf16 a[32:35], v[64:67], v[48:51], a[32:35]
ds_read_b128 v[40:43], v2 offset:8192
v_mfma_f32_16x16x32_bf16 a[32:35], v[68:71], v[52:55], a[32:35]
ds_read_b128 v[44:47], v3 offset:8192
v_mfma_f32_16x16x32_bf16 a[36:39], v[72:75], v[48:51], a[36:39]
v_mfma_f32_16x16x32_bf16 a[36:39], v[76:79], v[52:55], a[36:39]
v_mfma_f32_16x16x32_bf16 a[40:43], v[80:83], v[48:51], a[40:43]
s_add_u32 m0, s3, 0x0
v_mfma_f32_16x16x32_bf16 a[40:43], v[84:87], v[52:55], a[40:43]
buffer_load_dwordx4 v8, s[20:23], s35 offen sc1 lds
s_add_u32 s35, s35, 0x10000
v_mfma_f32_16x16x32_bf16 a[44:47], v[88:91], v[48:51], a[44:47]
s_add_u32 s6, s38, 0x34000
s_waitcnt lgkmcnt(2)
buffer_store_dwordx4 v[36:39], v24, s[20:23], s6 offen sc1
v_mfma_f32_16x16x32_bf16 a[44:47], v[92:95], v[52:55], a[44:47]
v_mfma_f32_16x16x32_bf16 a[48:51], v[64:67], v[56:59], a[48:51]
ds_read_b128 v[48:51], v2 offset:10240
v_mfma_f32_16x16x32_bf16 a[48:51], v[68:71], v[60:63], a[48:51]
ds_read_b128 v[52:55], v3 offset:10240
v_mfma_f32_16x16x32_bf16 a[52:55], v[72:75], v[56:59], a[52:55]
v_mfma_f32_16x16x32_bf16 a[52:55], v[76:79], v[60:63], a[52:55]
v_mfma_f32_16x16x32_bf16 a[56:59], v[80:83], v[56:59], a[56:59]
s_add_u32 m0, s3, 0x1000
v_mfma_f32_16x16x32_bf16 a[56:59], v[84:87], v[60:63], a[56:59]
buffer_load_dwordx4 v8, s[20:23], s35 offen sc1 lds
s_add_u32 s35, s35, 0x10000
v_mfma_f32_16x16x32_bf16 a[60:63], v[88:91], v[56:59], a[60:63]
v_mfma_f32_16x16x32_bf16 a[60:63], v[92:95], v[60:63], a[60:63]
s_waitcnt lgkmcnt(2)
v_mfma_f32_16x16x32_bf16 a[64:67], v[64:67], v[40:43], a[64:67]
ds_read_b128 v[56:59], v2 offset:12288
v_mfma_f32_16x16x32_bf16 a[64:67], v[68:71], v[44:47], a[64:67]
ds_read_b128 v[60:63], v3 offset:12288
v_mfma_f32_16x16x32_bf16 a[68:71], v[72:75], v[40:43], a[68:71]
v_mfma_f32_16x16x32_bf16 a[68:71], v[76:79], v[44:47], a[68:71]
v_mfma_f32_16x16x32_bf16 a[72:75], v[80:83], v[40:43], a[72:75]
s_add_u32 m0, s3, 0x2000
v_mfma_f32_16x16x32_bf16 a[72:75], v[84:87], v[44:47], a[72:75]
buffer_load_dwordx4 v8, s[20:23], s35 offen sc1 lds
s_add_u32 s35, s35, 0x10000
v_mfma_f32_16x16x32_bf16 a[76:79], v[88:91], v[40:43], a[76:79]
v_mfma_f32_16x16x32_bf16 a[76:79], v[92:95], v[44:47], a[76:79]
s_waitcnt lgkmcnt(2)
v_mfma_f32_16x16x32_bf16 a[80:83], v[64:67], v[48:51], a[80:83]
ds_read_b128 v[40:43], v2 offset:14336
v_mfma_f32_16x16x32_bf16 a[80:83], v[68:71], v[52:55], a[80:83]
ds_read_b128 v[44:47], v3 offset:14336
v_mfma_f32_16x16x32_bf16 a[84:87], v[72:75], v[48:51], a[84:87]
v_mfma_f32_16x16x32_bf16 a[84:87], v[76:79], v[52:55], a[84:87]
v_mfma_f32_16x16x32_bf16 a[88:91], v[80:83], v[48:51], a[88:91]
v_mfma_f32_16x16x32_bf16 a[88:91], v[84:87], v[52:55], a[88:91]
v_mfma_f32_16x16x32_bf16 a[92:95], v[88:91], v[48:51], a[92:95]
v_mfma_f32_16x16x32_bf16 a[92:95], v[92:95], v[52:55], a[92:95]
s_waitcnt lgkmcnt(2)
v_mfma_f32_16x16x32_bf16 a[96:99], v[64:67], v[56:59], a[96:99]
ds_read_b128 v[48:51], v2 offset:16384
v_mfma_f32_16x16x32_bf16 a[96:99], v[68:71], v[60:63], a[96:99]
ds_read_b128 v[52:55], v3 offset:16384
v_mfma_f32_16x16x32_bf16 a[100:103], v[72:75], v[56:59], a[100:103]
v_mfma_f32_16x16x32_bf16 a[100:103], v[76:79], v[60:63], a[100:103]
v_mfma_f32_16x16x32_bf16 a[104:107], v[80:83], v[56:59], a[104:107]
v_mfma_f32_16x16x32_bf16 a[104:107], v[84:87], v[60:63], a[104:107]
v_mfma_f32_16x16x32_bf16 a[108:111], v[88:91], v[56:59], a[108:111]
v_mfma_f32_16x16x32_bf16 a[108:111], v[92:95], v[60:63], a[108:111]
s_waitcnt lgkmcnt(2)
v_mfma_f32_16x16x32_bf16 a[112:115], v[64:67], v[40:43], a[112:115]
ds_read_b128 v[56:59], v2 offset:18432
buffer_load_dwordx4 v[64:67], v1, s[12:15], s33 offen offset:0 sc1
v_mfma_f32_16x16x32_bf16 a[112:115], v[68:71], v[44:47], a[112:115]
ds_read_b128 v[60:63], v3 offset:18432
v_mfma_f32_16x16x32_bf16 a[116:119], v[72:75], v[40:43], a[116:119]
v_mfma_f32_16x16x32_bf16 a[116:119], v[76:79], v[44:47], a[116:119]
buffer_load_dwordx4 v[68:71], v1, s[12:15], s33 offen offset:1024 sc1
v_mfma_f32_16x16x32_bf16 a[120:123], v[80:83], v[40:43], a[120:123]
v_mfma_f32_16x16x32_bf16 a[120:123], v[84:87], v[44:47], a[120:123]
v_mfma_f32_16x16x32_bf16 a[124:127], v[88:91], v[40:43], a[124:127]
buffer_load_dwordx4 v[72:75], v1, s[12:15], s33 offen offset:2048 sc1
v_mfma_f32_16x16x32_bf16 a[124:127], v[92:95], v[44:47], a[124:127]
s_waitcnt vmcnt(14) lgkmcnt(2)
v_mfma_f32_16x16x32_bf16 a[0:3], v[96:99], v[48:51], a[0:3]
ds_read_b128 v[40:43], v2 offset:20480
v_mfma_f32_16x16x32_bf16 a[0:3], v[100:103], v[52:55], a[0:3]
ds_read_b128 v[44:47], v3 offset:20480
buffer_load_dwordx4 v[76:79], v1, s[12:15], s33 offen offset:3072 sc1
s_waitcnt vmcnt(13)
v_mfma_f32_16x16x32_bf16 a[4:7], v[104:107], v[48:51], a[4:7]
v_mfma_f32_16x16x32_bf16 a[4:7], v[108:111], v[52:55], a[4:7]
ds_read_b128 v[32:35], v6 offset:14336
v_xor_b32 v6, 0x10000, v6
s_waitcnt vmcnt(11)
v_mfma_f32_16x16x32_bf16 a[8:11], v[112:115], v[48:51], a[8:11]
buffer_load_dwordx4 v[80:83], v1, s[12:15], s34 offen offset:0 sc1
v_mfma_f32_16x16x32_bf16 a[8:11], v[116:119], v[52:55], a[8:11]
s_waitcnt vmcnt(10)
v_mfma_f32_16x16x32_bf16 a[12:15], v[120:123], v[48:51], a[12:15]
v_mfma_f32_16x16x32_bf16 a[12:15], v[124:127], v[52:55], a[12:15]
buffer_load_dwordx4 v[84:87], v1, s[12:15], s34 offen offset:1024 sc1
s_waitcnt lgkmcnt(3)
v_mfma_f32_16x16x32_bf16 a[16:19], v[96:99], v[56:59], a[16:19]
ds_read_b128 v[48:51], v2 offset:22528
v_mfma_f32_16x16x32_bf16 a[16:19], v[100:103], v[60:63], a[16:19]
ds_read_b128 v[52:55], v3 offset:22528
v_mfma_f32_16x16x32_bf16 a[20:23], v[104:107], v[56:59], a[20:23]
buffer_load_dwordx4 v[88:91], v1, s[12:15], s34 offen offset:2048 sc1
v_mfma_f32_16x16x32_bf16 a[20:23], v[108:111], v[60:63], a[20:23]
ds_read_b128 v[36:39], v7 offset:15360
v_xor_b32 v7, 0x10000, v7
v_mfma_f32_16x16x32_bf16 a[24:27], v[112:115], v[56:59], a[24:27]
v_mfma_f32_16x16x32_bf16 a[24:27], v[116:119], v[60:63], a[24:27]
buffer_load_dwordx4 v[92:95], v1, s[12:15], s34 offen offset:3072 sc1
s_add_u32 s33, s33, 0x8000
s_add_u32 s34, s34, 0x8000
v_mfma_f32_16x16x32_bf16 a[28:31], v[120:123], v[56:59], a[28:31]
s_add_u32 s6, s38, 0x38000
s_waitcnt lgkmcnt(3)
buffer_store_dwordx4 v[32:35], v24, s[20:23], s6 offen sc1
v_mfma_f32_16x16x32_bf16 a[28:31], v[124:127], v[60:63], a[28:31]
v_mfma_f32_16x16x32_bf16 a[32:35], v[96:99], v[40:43], a[32:35]
ds_read_b128 v[56:59], v2 offset:24576
v_mfma_f32_16x16x32_bf16 a[32:35], v[100:103], v[44:47], a[32:35]
ds_read_b128 v[60:63], v3 offset:24576
v_mfma_f32_16x16x32_bf16 a[36:39], v[104:107], v[40:43], a[36:39]
v_mfma_f32_16x16x32_bf16 a[36:39], v[108:111], v[44:47], a[36:39]
v_mfma_f32_16x16x32_bf16 a[40:43], v[112:115], v[40:43], a[40:43]
s_add_u32 m0, s3, 0x3000
v_mfma_f32_16x16x32_bf16 a[40:43], v[116:119], v[44:47], a[40:43]
buffer_load_dwordx4 v8, s[20:23], s35 offen sc1 lds
s_sub_u32 s35, s35, 196480
v_mfma_f32_16x16x32_bf16 a[44:47], v[120:123], v[40:43], a[44:47]
s_add_u32 s6, s38, 0x3c000
s_waitcnt lgkmcnt(2)
buffer_store_dwordx4 v[36:39], v24, s[20:23], s6 offen sc1
v_xor_b32 v24, 0x200, v24
v_mfma_f32_16x16x32_bf16 a[44:47], v[124:127], v[44:47], a[44:47]
v_mfma_f32_16x16x32_bf16 a[48:51], v[96:99], v[48:51], a[48:51]
ds_read_b128 v[40:43], v2 offset:26624
v_mfma_f32_16x16x32_bf16 a[48:51], v[100:103], v[52:55], a[48:51]
ds_read_b128 v[44:47], v3 offset:26624
v_mfma_f32_16x16x32_bf16 a[52:55], v[104:107], v[48:51], a[52:55]
v_mfma_f32_16x16x32_bf16 a[52:55], v[108:111], v[52:55], a[52:55]
v_mfma_f32_16x16x32_bf16 a[56:59], v[112:115], v[48:51], a[56:59]
s_add_u32 m0, s3, 0x4000
v_mfma_f32_16x16x32_bf16 a[56:59], v[116:119], v[52:55], a[56:59]
buffer_load_dwordx4 v8, s[20:23], s35 offen sc1 lds
s_add_u32 s35, s35, 0x10000
v_mfma_f32_16x16x32_bf16 a[60:63], v[120:123], v[48:51], a[60:63]
v_mfma_f32_16x16x32_bf16 a[60:63], v[124:127], v[52:55], a[60:63]
s_waitcnt lgkmcnt(2)
v_mfma_f32_16x16x32_bf16 a[64:67], v[96:99], v[56:59], a[64:67]
ds_read_b128 v[48:51], v2 offset:28672
v_mfma_f32_16x16x32_bf16 a[64:67], v[100:103], v[60:63], a[64:67]
ds_read_b128 v[52:55], v3 offset:28672
v_mfma_f32_16x16x32_bf16 a[68:71], v[104:107], v[56:59], a[68:71]
v_mfma_f32_16x16x32_bf16 a[68:71], v[108:111], v[60:63], a[68:71]
v_mfma_f32_16x16x32_bf16 a[72:75], v[112:115], v[56:59], a[72:75]
s_add_u32 m0, s3, 0x5000
v_mfma_f32_16x16x32_bf16 a[72:75], v[116:119], v[60:63], a[72:75]
buffer_load_dwordx4 v8, s[20:23], s35 offen sc1 lds
s_add_u32 s35, s35, 0x10000
v_mfma_f32_16x16x32_bf16 a[76:79], v[120:123], v[56:59], a[76:79]
v_mfma_f32_16x16x32_bf16 a[76:79], v[124:127], v[60:63], a[76:79]
s_waitcnt lgkmcnt(2)
v_mfma_f32_16x16x32_bf16 a[80:83], v[96:99], v[40:43], a[80:83]
ds_read_b128 v[56:59], v2 offset:30720
v_mfma_f32_16x16x32_bf16 a[80:83], v[100:103], v[44:47], a[80:83]
ds_read_b128 v[60:63], v3 offset:30720
v_mfma_f32_16x16x32_bf16 a[84:87], v[104:107], v[40:43], a[84:87]
v_mfma_f32_16x16x32_bf16 a[84:87], v[108:111], v[44:47], a[84:87]
v_mfma_f32_16x16x32_bf16 a[88:91], v[112:115], v[40:43], a[88:91]
v_mfma_f32_16x16x32_bf16 a[88:91], v[116:119], v[44:47], a[88:91]
v_mfma_f32_16x16x32_bf16 a[92:95], v[120:123], v[40:43], a[92:95]
v_mfma_f32_16x16x32_bf16 a[92:95], v[124:127], v[44:47], a[92:95]
s_waitcnt lgkmcnt(2)
v_mfma_f32_16x16x32_bf16 a[96:99], v[96:99], v[48:51], a[96:99]
ds_read_b128 v[40:43], v2 offset:32768
v_mfma_f32_16x16x32_bf16 a[96:99], v[100:103], v[52:55], a[96:99]
ds_read_b128 v[44:47], v3 offset:32768
v_mfma_f32_16x16x32_bf16 a[100:103], v[104:107], v[48:51], a[100:103]
v_mfma_f32_16x16x32_bf16 a[100:103], v[108:111], v[52:55], a[100:103]
v_mfma_f32_16x16x32_bf16 a[104:107], v[112:115], v[48:51], a[104:107]
v_mfma_f32_16x16x32_bf16 a[104:107], v[116:119], v[52:55], a[104:107]
v_mfma_f32_16x16x32_bf16 a[108:111], v[120:123], v[48:51], a[108:111]
v_mfma_f32_16x16x32_bf16 a[108:111], v[124:127], v[52:55], a[108:111]
s_waitcnt lgkmcnt(2)
v_mfma_f32_16x16x32_bf16 a[112:115], v[96:99], v[56:59], a[112:115]
ds_read_b128 v[48:51], v2 offset:34816
buffer_load_dwordx4 v[96:99], v1, s[12:15], s33 offen offset:0 sc1
v_mfma_f32_16x16x32_bf16 a[112:115], v[100:103], v[60:63], a[112:115]
ds_read_b128 v[52:55], v3 offset:34816
v_mfma_f32_16x16x32_bf16 a[116:119], v[104:107], v[56:59], a[116:119]
v_mfma_f32_16x16x32_bf16 a[116:119], v[108:111], v[60:63], a[116:119]
buffer_load_dwordx4 v[100:103], v1, s[12:15], s33 offen offset:1024 sc1
v_mfma_f32_16x16x32_bf16 a[120:123], v[112:115], v[56:59], a[120:123]
v_mfma_f32_16x16x32_bf16 a[120:123], v[116:119], v[60:63], a[120:123]
v_mfma_f32_16x16x32_bf16 a[124:127], v[120:123], v[56:59], a[124:127]
buffer_load_dwordx4 v[104:107], v1, s[12:15], s33 offen offset:2048 sc1
v_mfma_f32_16x16x32_bf16 a[124:127], v[124:127], v[60:63], a[124:127]
s_waitcnt vmcnt(14) lgkmcnt(2)
v_mfma_f32_16x16x32_bf16 a[0:3], v[64:67], v[40:43], a[0:3]
ds_read_b128 v[56:59], v2 offset:36864
v_mfma_f32_16x16x32_bf16 a[0:3], v[68:71], v[44:47], a[0:3]
ds_read_b128 v[60:63], v3 offset:36864
buffer_load_dwordx4 v[108:111], v1, s[12:15], s33 offen offset:3072 sc1
s_waitcnt vmcnt(13)
v_mfma_f32_16x16x32_bf16 a[4:7], v[72:75], v[40:43], a[4:7]
v_mfma_f32_16x16x32_bf16 a[4:7], v[76:79], v[44:47], a[4:7]
s_waitcnt vmcnt(11)
v_mfma_f32_16x16x32_bf16 a[8:11], v[80:83], v[40:43], a[8:11]
buffer_load_dwordx4 v[112:115], v1, s[12:15], s34 offen offset:0 sc1
v_mfma_f32_16x16x32_bf16 a[8:11], v[84:87], v[44:47], a[8:11]
s_waitcnt vmcnt(10)
v_mfma_f32_16x16x32_bf16 a[12:15], v[88:91], v[40:43], a[12:15]
v_mfma_f32_16x16x32_bf16 a[12:15], v[92:95], v[44:47], a[12:15]
buffer_load_dwordx4 v[116:119], v1, s[12:15], s34 offen offset:1024 sc1
s_waitcnt lgkmcnt(2)
v_mfma_f32_16x16x32_bf16 a[16:19], v[64:67], v[48:51], a[16:19]
ds_read_b128 v[40:43], v2 offset:38912
v_mfma_f32_16x16x32_bf16 a[16:19], v[68:71], v[52:55], a[16:19]
ds_read_b128 v[44:47], v3 offset:38912
v_mfma_f32_16x16x32_bf16 a[20:23], v[72:75], v[48:51], a[20:23]
buffer_load_dwordx4 v[120:123], v1, s[12:15], s34 offen offset:2048 sc1
v_mfma_f32_16x16x32_bf16 a[20:23], v[76:79], v[52:55], a[20:23]
v_mfma_f32_16x16x32_bf16 a[24:27], v[80:83], v[48:51], a[24:27]
v_mfma_f32_16x16x32_bf16 a[24:27], v[84:87], v[52:55], a[24:27]
buffer_load_dwordx4 v[124:127], v1, s[12:15], s34 offen offset:3072 sc1
s_add_u32 s33, s33, 0x8000
s_add_u32 s34, s34, 0x8000
v_mfma_f32_16x16x32_bf16 a[28:31], v[88:91], v[48:51], a[28:31]
v_mfma_f32_16x16x32_bf16 a[28:31], v[92:95], v[52:55], a[28:31]
s_waitcnt lgkmcnt(2)
v_mfma_f32_16x16x32_bf16 a[32:35], v[64:67], v[56:59], a[32:35]
ds_read_b128 v[48:51], v2 offset:40960
v_mfma_f32_16x16x32_bf16 a[32:35], v[68:71], v[60:63], a[32:35]
ds_read_b128 v[52:55], v3 offset:40960
v_mfma_f32_16x16x32_bf16 a[36:39], v[72:75], v[56:59], a[36:39]
v_mfma_f32_16x16x32_bf16 a[36:39], v[76:79], v[60:63], a[36:39]
v_mfma_f32_16x16x32_bf16 a[40:43], v[80:83], v[56:59], a[40:43]
s_add_u32 m0, s3, 0x6000
v_mfma_f32_16x16x32_bf16 a[40:43], v[84:87], v[60:63], a[40:43]
buffer_load_dwordx4 v8, s[20:23], s35 offen sc1 lds
s_add_u32 s35, s35, 0x10000
v_mfma_f32_16x16x32_bf16 a[44:47], v[88:91], v[56:59], a[44:47]
v_mfma_f32_16x16x32_bf16 a[44:47], v[92:95], v[60:63], a[44:47]
s_waitcnt lgkmcnt(2)
v_mfma_f32_16x16x32_bf16 a[48:51], v[64:67], v[40:43], a[48:51]
ds_read_b128 v[56:59], v2 offset:43008
v_mfma_f32_16x16x32_bf16 a[48:51], v[68:71], v[44:47], a[48:51]
ds_read_b128 v[60:63], v3 offset:43008
v_and_b32 v16, 4, v11
v_lshlrev_b32 v16, 5, v16
buffer_load_dword v12, v16, s[80:83], 0 offen sc1
v_mfma_f32_16x16x32_bf16 a[52:55], v[72:75], v[40:43], a[52:55]
v_mfma_f32_16x16x32_bf16 a[52:55], v[76:79], v[44:47], a[52:55]
v_mfma_f32_16x16x32_bf16 a[56:59], v[80:83], v[40:43], a[56:59]
s_add_u32 m0, s3, 0x7000
v_mfma_f32_16x16x32_bf16 a[56:59], v[84:87], v[44:47], a[56:59]
buffer_load_dwordx4 v8, s[20:23], s35 offen sc1 lds
s_sub_u32 s35, s35, 196480
v_mfma_f32_16x16x32_bf16 a[60:63], v[88:91], v[40:43], a[60:63]
v_mfma_f32_16x16x32_bf16 a[60:63], v[92:95], v[44:47], a[60:63]
s_waitcnt lgkmcnt(2)
v_mfma_f32_16x16x32_bf16 a[64:67], v[64:67], v[48:51], a[64:67]
ds_read_b128 v[40:43], v2 offset:45056
v_mfma_f32_16x16x32_bf16 a[64:67], v[68:71], v[52:55], a[64:67]
ds_read_b128 v[44:47], v3 offset:45056
v_mfma_f32_16x16x32_bf16 a[68:71], v[72:75], v[48:51], a[68:71]
v_mfma_f32_16x16x32_bf16 a[68:71], v[76:79], v[52:55], a[68:71]
v_mfma_f32_16x16x32_bf16 a[72:75], v[80:83], v[48:51], a[72:75]
s_add_u32 m0, s3, 0x8000
v_mfma_f32_16x16x32_bf16 a[72:75], v[84:87], v[52:55], a[72:75]
buffer_load_dwordx4 v8, s[20:23], s35 offen sc1 lds
s_add_u32 s35, s35, 0x10000
v_mfma_f32_16x16x32_bf16 a[76:79], v[88:91], v[48:51], a[76:79]
v_mfma_f32_16x16x32_bf16 a[76:79], v[92:95], v[52:55], a[76:79]
s_waitcnt lgkmcnt(2)
v_mfma_f32_16x16x32_bf16 a[80:83], v[64:67], v[56:59], a[80:83]
ds_read_b128 v[48:51], v2 offset:47104
v_mfma_f32_16x16x32_bf16 a[80:83], v[68:71], v[60:63], a[80:83]
ds_read_b128 v[52:55], v3 offset:47104
v_mfma_f32_16x16x32_bf16 a[84:87], v[72:75], v[56:59], a[84:87]
v_mfma_f32_16x16x32_bf16 a[84:87], v[76:79], v[60:63], a[84:87]
v_mfma_f32_16x16x32_bf16 a[88:91], v[80:83], v[56:59], a[88:91]
v_mfma_f32_16x16x32_bf16 a[88:91], v[84:87], v[60:63], a[88:91]
v_mfma_f32_16x16x32_bf16 a[92:95], v[88:91], v[56:59], a[92:95]
v_mfma_f32_16x16x32_bf16 a[92:95], v[92:95], v[60:63], a[92:95]
s_waitcnt lgkmcnt(2)
v_mfma_f32_16x16x32_bf16 a[96:99], v[64:67], v[40:43], a[96:99]
ds_read_b128 v[56:59], v2 offset:49152
v_mfma_f32_16x16x32_bf16 a[96:99], v[68:71], v[44:47], a[96:99]
ds_read_b128 v[60:63], v3 offset:49152
v_mfma_f32_16x16x32_bf16 a[100:103], v[72:75], v[40:43], a[100:103]
v_mfma_f32_16x16x32_bf16 a[100:103], v[76:79], v[44:47], a[100:103]
v_mfma_f32_16x16x32_bf16 a[104:107], v[80:83], v[40:43], a[104:107]
v_mfma_f32_16x16x32_bf16 a[104:107], v[84:87], v[44:47], a[104:107]
v_mfma_f32_16x16x32_bf16 a[108:111], v[88:91], v[40:43], a[108:111]
v_mfma_f32_16x16x32_bf16 a[108:111], v[92:95], v[44:47], a[108:111]
s_waitcnt lgkmcnt(2)
v_mfma_f32_16x16x32_bf16 a[112:115], v[64:67], v[48:51], a[112:115]
ds_read_b128 v[40:43], v2 offset:51200
buffer_load_dwordx4 v[64:67], v1, s[12:15], s33 offen offset:0 sc1
v_mfma_f32_16x16x32_bf16 a[112:115], v[68:71], v[52:55], a[112:115]
ds_read_b128 v[44:47], v3 offset:51200
v_mfma_f32_16x16x32_bf16 a[116:119], v[72:75], v[48:51], a[116:119]
v_mfma_f32_16x16x32_bf16 a[116:119], v[76:79], v[52:55], a[116:119]
buffer_load_dwordx4 v[68:71], v1, s[12:15], s33 offen offset:1024 sc1
v_mfma_f32_16x16x32_bf16 a[120:123], v[80:83], v[48:51], a[120:123]
v_mfma_f32_16x16x32_bf16 a[120:123], v[84:87], v[52:55], a[120:123]
v_mfma_f32_16x16x32_bf16 a[124:127], v[88:91], v[48:51], a[124:127]
buffer_load_dwordx4 v[72:75], v1, s[12:15], s33 offen offset:2048 sc1
v_mfma_f32_16x16x32_bf16 a[124:127], v[92:95], v[52:55], a[124:127]
s_waitcnt vmcnt(13) lgkmcnt(2)
v_mfma_f32_16x16x32_bf16 a[0:3], v[96:99], v[56:59], a[0:3]
ds_read_b128 v[48:51], v2 offset:53248
v_mfma_f32_16x16x32_bf16 a[0:3], v[100:103], v[60:63], a[0:3]
ds_read_b128 v[52:55], v3 offset:53248
buffer_load_dwordx4 v[76:79], v1, s[12:15], s33 offen offset:3072 sc1
s_waitcnt vmcnt(12)
v_mfma_f32_16x16x32_bf16 a[4:7], v[104:107], v[56:59], a[4:7]
v_mfma_f32_16x16x32_bf16 a[4:7], v[108:111], v[60:63], a[4:7]
s_waitcnt vmcnt(10)
v_mfma_f32_16x16x32_bf16 a[8:11], v[112:115], v[56:59], a[8:11]
buffer_load_dwordx4 v[80:83], v1, s[12:15], s34 offen offset:0 sc1
v_mfma_f32_16x16x32_bf16 a[8:11], v[116:119], v[60:63], a[8:11]
s_waitcnt vmcnt(9)
v_mfma_f32_16x16x32_bf16 a[12:15], v[120:123], v[56:59], a[12:15]
v_mfma_f32_16x16x32_bf16 a[12:15], v[124:127], v[60:63], a[12:15]
buffer_load_dwordx4 v[84:87], v1, s[12:15], s34 offen offset:1024 sc1
v_mov_b32 v0, 2
s_mov_b64 exec, 1
buffer_store_dword v0, off, s[24:27], s41 sc1
s_mov_b64 exec, -1
s_waitcnt lgkmcnt(2)
v_mfma_f32_16x16x32_bf16 a[16:19], v[96:99], v[40:43], a[16:19]
ds_read_b128 v[56:59], v2 offset:55296
v_mfma_f32_16x16x32_bf16 a[16:19], v[100:103], v[44:47], a[16:19]
ds_read_b128 v[60:63], v3 offset:55296
v_mfma_f32_16x16x32_bf16 a[20:23], v[104:107], v[40:43], a[20:23]
buffer_load_dwordx4 v[88:91], v1, s[12:15], s34 offen offset:2048 sc1
v_mfma_f32_16x16x32_bf16 a[20:23], v[108:111], v[44:47], a[20:23]
v_mfma_f32_16x16x32_bf16 a[24:27], v[112:115], v[40:43], a[24:27]
v_mfma_f32_16x16x32_bf16 a[24:27], v[116:119], v[44:47], a[24:27]
buffer_load_dwordx4 v[92:95], v1, s[12:15], s34 offen offset:3072 sc1
s_add_u32 s33, s33, 0x8000
s_add_u32 s34, s34, 0x8000
v_mfma_f32_16x16x32_bf16 a[28:31], v[120:123], v[40:43], a[28:31]
v_mfma_f32_16x16x32_bf16 a[28:31], v[124:127], v[44:47], a[28:31]
s_waitcnt lgkmcnt(2)
v_mfma_f32_16x16x32_bf16 a[32:35], v[96:99], v[48:51], a[32:35]
ds_read_b128 v[40:43], v2 offset:57344
v_mfma_f32_16x16x32_bf16 a[32:35], v[100:103], v[52:55], a[32:35]
ds_read_b128 v[44:47], v3 offset:57344
v_mfma_f32_16x16x32_bf16 a[36:39], v[104:107], v[48:51], a[36:39]
v_mfma_f32_16x16x32_bf16 a[36:39], v[108:111], v[52:55], a[36:39]
v_mfma_f32_16x16x32_bf16 a[40:43], v[112:115], v[48:51], a[40:43]
s_add_u32 m0, s3, 0x9000
v_mfma_f32_16x16x32_bf16 a[40:43], v[116:119], v[52:55], a[40:43]
buffer_load_dwordx4 v8, s[20:23], s35 offen sc1 lds
s_add_u32 s35, s35, 0x10000
v_mfma_f32_16x16x32_bf16 a[44:47], v[120:123], v[48:51], a[44:47]
v_mfma_f32_16x16x32_bf16 a[44:47], v[124:127], v[52:55], a[44:47]
s_waitcnt lgkmcnt(2)
v_mfma_f32_16x16x32_bf16 a[48:51], v[96:99], v[56:59], a[48:51]
ds_read_b128 v[48:51], v2 offset:59392
v_mfma_f32_16x16x32_bf16 a[48:51], v[100:103], v[60:63], a[48:51]
ds_read_b128 v[52:55], v3 offset:59392
v_mfma_f32_16x16x32_bf16 a[52:55], v[104:107], v[56:59], a[52:55]
v_mfma_f32_16x16x32_bf16 a[52:55], v[108:111], v[60:63], a[52:55]
v_mfma_f32_16x16x32_bf16 a[56:59], v[112:115], v[56:59], a[56:59]
s_add_u32 m0, s3, 0xa000
v_mfma_f32_16x16x32_bf16 a[56:59], v[116:119], v[60:63], a[56:59]
buffer_load_dwordx4 v8, s[20:23], s35 offen sc1 lds
s_add_u32 s35, s35, 0x10000
v_mfma_f32_16x16x32_bf16 a[60:63], v[120:123], v[56:59], a[60:63]
v_mfma_f32_16x16x32_bf16 a[60:63], v[124:127], v[60:63], a[60:63]
s_waitcnt lgkmcnt(2)
v_mfma_f32_16x16x32_bf16 a[64:67], v[96:99], v[40:43], a[64:67]
ds_read_b128 v[56:59], v2 offset:61440
v_mfma_f32_16x16x32_bf16 a[64:67], v[100:103], v[44:47], a[64:67]
ds_read_b128 v[60:63], v3 offset:61440
v_mfma_f32_16x16x32_bf16 a[68:71], v[104:107], v[40:43], a[68:71]
v_mfma_f32_16x16x32_bf16 a[68:71], v[108:111], v[44:47], a[68:71]
v_mfma_f32_16x16x32_bf16 a[72:75], v[112:115], v[40:43], a[72:75]
s_add_u32 m0, s3, 0xb000
v_mfma_f32_16x16x32_bf16 a[72:75], v[116:119], v[44:47], a[72:75]
buffer_load_dwordx4 v8, s[20:23], s35 offen sc1 lds
s_sub_u32 s35, s35, 196480
v_mfma_f32_16x16x32_bf16 a[76:79], v[120:123], v[40:43], a[76:79]
v_mfma_f32_16x16x32_bf16 a[76:79], v[124:127], v[44:47], a[76:79]
s_waitcnt lgkmcnt(2)
v_mfma_f32_16x16x32_bf16 a[80:83], v[96:99], v[48:51], a[80:83]
ds_read_b128 v[40:43], v2 offset:63488
v_mfma_f32_16x16x32_bf16 a[80:83], v[100:103], v[52:55], a[80:83]
ds_read_b128 v[44:47], v3 offset:63488
v_mfma_f32_16x16x32_bf16 a[84:87], v[104:107], v[48:51], a[84:87]
v_mfma_f32_16x16x32_bf16 a[84:87], v[108:111], v[52:55], a[84:87]
v_mfma_f32_16x16x32_bf16 a[88:91], v[112:115], v[48:51], a[88:91]
v_mfma_f32_16x16x32_bf16 a[88:91], v[116:119], v[52:55], a[88:91]
v_mfma_f32_16x16x32_bf16 a[92:95], v[120:123], v[48:51], a[92:95]
v_mfma_f32_16x16x32_bf16 a[92:95], v[124:127], v[52:55], a[92:95]
s_waitcnt lgkmcnt(2)
v_mfma_f32_16x16x32_bf16 a[96:99], v[96:99], v[56:59], a[96:99]
ds_read_b128 v[48:51], v2 offset:0
v_mfma_f32_16x16x32_bf16 a[96:99], v[100:103], v[60:63], a[96:99]
ds_read_b128 v[52:55], v3 offset:0
v_mfma_f32_16x16x32_bf16 a[100:103], v[104:107], v[56:59], a[100:103]
v_mfma_f32_16x16x32_bf16 a[100:103], v[108:111], v[60:63], a[100:103]
v_mfma_f32_16x16x32_bf16 a[104:107], v[112:115], v[56:59], a[104:107]
v_mfma_f32_16x16x32_bf16 a[104:107], v[116:119], v[60:63], a[104:107]
v_mfma_f32_16x16x32_bf16 a[108:111], v[120:123], v[56:59], a[108:111]
v_mfma_f32_16x16x32_bf16 a[108:111], v[124:127], v[60:63], a[108:111]
s_waitcnt lgkmcnt(2)
v_mfma_f32_16x16x32_bf16 a[112:115], v[96:99], v[40:43], a[112:115]
ds_read_b128 v[56:59], v2 offset:2048
buffer_load_dwordx4 v[96:99], v1, s[12:15], s33 offen offset:0 sc1
v_mfma_f32_16x16x32_bf16 a[112:115], v[100:103], v[44:47], a[112:115]
ds_read_b128 v[60:63], v3 offset:2048
v_mfma_f32_16x16x32_bf16 a[116:119], v[104:107], v[40:43], a[116:119]
v_mfma_f32_16x16x32_bf16 a[116:119], v[108:111], v[44:47], a[116:119]
buffer_load_dwordx4 v[100:103], v1, s[12:15], s33 offen offset:1024 sc1
v_mfma_f32_16x16x32_bf16 a[120:123], v[112:115], v[40:43], a[120:123]
v_mfma_f32_16x16x32_bf16 a[120:123], v[116:119], v[44:47], a[120:123]
v_mfma_f32_16x16x32_bf16 a[124:127], v[120:123], v[40:43], a[124:127]
buffer_load_dwordx4 v[104:107], v1, s[12:15], s33 offen offset:2048 sc1
v_mfma_f32_16x16x32_bf16 a[124:127], v[124:127], v[44:47], a[124:127]
s_waitcnt vmcnt(13) lgkmcnt(2)
v_mfma_f32_16x16x32_bf16 a[128:131], v[64:67], v[48:51], a[128:131]
ds_read_b128 v[40:43], v2 offset:4096
v_mfma_f32_16x16x32_bf16 a[128:131], v[68:71], v[52:55], a[128:131]
ds_read_b128 v[44:47], v3 offset:4096
buffer_load_dwordx4 v[108:111], v1, s[12:15], s33 offen offset:3072 sc1
s_waitcnt vmcnt(12)
v_mfma_f32_16x16x32_bf16 a[132:135], v[72:75], v[48:51], a[132:135]
v_cmp_gt_u32 vcc, 256, v12
s_cbranch_vccz L_pok2
s_mov_b32 s4, 0x40000
L_psp2:
s_sleep 2
buffer_load_dword v12, v16, s[80:83], 0 offen sc1
s_sub_u32 s4, s4, 1
s_cbranch_scc1 L_pok2
s_waitcnt vmcnt(0)
v_cmp_gt_u32 vcc, 256, v12
s_cbranch_vccnz L_psp2
L_pok2:
v_mfma_f32_16x16x32_bf16 a[132:135], v[76:79], v[52:55], a[132:135]
s_waitcnt vmcnt(10)
v_mfma_f32_16x16x32_bf16 a[136:139], v[80:83], v[48:51], a[136:139]
buffer_load_dwordx4 v[112:115], v1, s[12:15], s34 offen offset:0 sc1
v_mfma_f32_16x16x32_bf16 a[136:139], v[84:87], v[52:55], a[136:139]
s_waitcnt vmcnt(8)
v_mfma_f32_16x16x32_bf16 a[140:143], v[88:91], v[48:51], a[140:143]
v_mfma_f32_16x16x32_bf16 a[140:143], v[92:95], v[52:55], a[140:143]
buffer_load_dwordx4 v[116:119], v1, s[12:15], s34 offen offset:1024 sc1
s_waitcnt lgkmcnt(2)
v_mfma_f32_16x16x32_bf16 a[144:147], v[64:67], v[56:59], a[144:147]
ds_read_b128 v[48:51], v2 offset:6144
v_mfma_f32_16x16x32_bf16 a[144:147], v[68:71], v[60:63], a[144:147]
ds_read_b128 v[52:55], v3 offset:6144
v_mfma_f32_16x16x32_bf16 a[148:151], v[72:75], v[56:59], a[148:151]
buffer_load_dwordx4 v[120:123], v1, s[12:15], s34 offen offset:2048 sc1
v_mfma_f32_16x16x32_bf16 a[148:151], v[76:79], v[60:63], a[148:151]
v_mfma_f32_16x16x32_bf16 a[152:155], v[80:83], v[56:59], a[152:155]
v_mfma_f32_16x16x32_bf16 a[152:155], v[84:87], v[60:63], a[152:155]
buffer_load_dwordx4 v[124:127], v1, s[12:15], s34 offen offset:3072 sc1
s_add_u32 s33, s33, 0x8000
s_add_u32 s34, s34, 0x8000
v_mfma_f32_16x16x32_bf16 a[156:159], v[88:91], v[56:59], a[156:159]
v_mfma_f32_16x16x32_bf16 a[156:159], v[92:95], v[60:63], a[156:159]
s_waitcnt lgkmcnt(2)
v_mfma_f32_16x16x32_bf16 a[160:163], v[64:67], v[40:43], a[160:163]
ds_read_b128 v[56:59], v2 offset:8192
v_mfma_f32_16x16x32_bf16 a[160:163], v[68:71], v[44:47], a[160:163]
ds_read_b128 v[60:63], v3 offset:8192
v_mfma_f32_16x16x32_bf16 a[164:167], v[72:75], v[40:43], a[164:167]
v_mfma_f32_16x16x32_bf16 a[164:167], v[76:79], v[44:47], a[164:167]
v_mfma_f32_16x16x32_bf16 a[168:171], v[80:83], v[40:43], a[168:171]
s_add_u32 m0, s3, 0xc000
v_mfma_f32_16x16x32_bf16 a[168:171], v[84:87], v[44:47], a[168:171]
buffer_load_dwordx4 v8, s[20:23], s35 offen sc1 lds
s_add_u32 s35, s35, 0x10000
v_mfma_f32_16x16x32_bf16 a[172:175], v[88:91], v[40:43], a[172:175]
v_mfma_f32_16x16x32_bf16 a[172:175], v[92:95], v[44:47], a[172:175]
s_waitcnt lgkmcnt(2)
v_mfma_f32_16x16x32_bf16 a[176:179], v[64:67], v[48:51], a[176:179]
ds_read_b128 v[40:43], v2 offset:10240
v_mfma_f32_16x16x32_bf16 a[176:179], v[68:71], v[52:55], a[176:179]
ds_read_b128 v[44:47], v3 offset:10240
v_mfma_f32_16x16x32_bf16 a[180:183], v[72:75], v[48:51], a[180:183]
v_mfma_f32_16x16x32_bf16 a[180:183], v[76:79], v[52:55], a[180:183]
v_mfma_f32_16x16x32_bf16 a[184:187], v[80:83], v[48:51], a[184:187]
s_add_u32 m0, s3, 0xd000
v_mfma_f32_16x16x32_bf16 a[184:187], v[84:87], v[52:55], a[184:187]
buffer_load_dwordx4 v8, s[20:23], s35 offen sc1 lds
s_add_u32 s35, s35, 0x10000
v_mfma_f32_16x16x32_bf16 a[188:191], v[88:91], v[48:51], a[188:191]
v_mfma_f32_16x16x32_bf16 a[188:191], v[92:95], v[52:55], a[188:191]
s_waitcnt lgkmcnt(2)
v_mfma_f32_16x16x32_bf16 a[192:195], v[64:67], v[56:59], a[192:195]
ds_read_b128 v[48:51], v2 offset:12288
v_mfma_f32_16x16x32_bf16 a[192:195], v[68:71], v[60:63], a[192:195]
ds_read_b128 v[52:55], v3 offset:12288
v_mfma_f32_16x16x32_bf16 a[196:199], v[72:75], v[56:59], a[196:199]
v_mfma_f32_16x16x32_bf16 a[196:199], v[76:79], v[60:63], a[196:199]
v_mfma_f32_16x16x32_bf16 a[200:203], v[80:83], v[56:59], a[200:203]
v_mfma_f32_16x16x32_bf16 a[200:203], v[84:87], v[60:63], a[200:203]
v_mfma_f32_16x16x32_bf16 a[204:207], v[88:91], v[56:59], a[204:207]
v_mfma_f32_16x16x32_bf16 a[204:207], v[92:95], v[60:63], a[204:207]
s_waitcnt lgkmcnt(2)
v_mfma_f32_16x16x32_bf16 a[208:211], v[64:67], v[40:43], a[208:211]
ds_read_b128 v[56:59], v2 offset:14336
v_mfma_f32_16x16x32_bf16 a[208:211], v[68:71], v[44:47], a[208:211]
ds_read_b128 v[60:63], v3 offset:14336
v_mfma_f32_16x16x32_bf16 a[212:215], v[72:75], v[40:43], a[212:215]
v_mfma_f32_16x16x32_bf16 a[212:215], v[76:79], v[44:47], a[212:215]
v_mfma_f32_16x16x32_bf16 a[216:219], v[80:83], v[40:43], a[216:219]
v_mfma_f32_16x16x32_bf16 a[216:219], v[84:87], v[44:47], a[216:219]
v_mfma_f32_16x16x32_bf16 a[220:223], v[88:91], v[40:43], a[220:223]
v_mfma_f32_16x16x32_bf16 a[220:223], v[92:95], v[44:47], a[220:223]
s_waitcnt lgkmcnt(2)
v_mfma_f32_16x16x32_bf16 a[224:227], v[64:67], v[48:51], a[224:227]
ds_read_b128 v[40:43], v2 offset:16384
v_mfma_f32_16x16x32_bf16 a[224:227], v[68:71], v[52:55], a[224:227]
ds_read_b128 v[44:47], v3 offset:16384
v_mfma_f32_16x16x32_bf16 a[228:231], v[72:75], v[48:51], a[228:231]
v_mfma_f32_16x16x32_bf16 a[228:231], v[76:79], v[52:55], a[228:231]
v_mfma_f32_16x16x32_bf16 a[232:235], v[80:83], v[48:51], a[232:235]
v_mfma_f32_16x16x32_bf16 a[232:235], v[84:87], v[52:55], a[232:235]
v_mfma_f32_16x16x32_bf16 a[236:239], v[88:91], v[48:51], a[236:239]
v_mfma_f32_16x16x32_bf16 a[236:239], v[92:95], v[52:55], a[236:239]
s_waitcnt lgkmcnt(2)
v_mfma_f32_16x16x32_bf16 a[240:243], v[64:67], v[56:59], a[240:243]
ds_read_b128 v[48:51], v2 offset:18432
buffer_load_dwordx4 v[64:67], v1, s[12:15], s33 offen offset:0 sc1
v_mfma_f32_16x16x32_bf16 a[240:243], v[68:71], v[60:63], a[240:243]
ds_read_b128 v[52:55], v3 offset:18432
v_mfma_f32_16x16x32_bf16 a[244:247], v[72:75], v[56:59], a[244:247]
v_mfma_f32_16x16x32_bf16 a[244:247], v[76:79], v[60:63], a[244:247]
buffer_load_dwordx4 v[68:71], v1, s[12:15], s33 offen offset:1024 sc1
v_mfma_f32_16x16x32_bf16 a[248:251], v[80:83], v[56:59], a[248:251]
v_mfma_f32_16x16x32_bf16 a[248:251], v[84:87], v[60:63], a[248:251]
v_mfma_f32_16x16x32_bf16 a[252:255], v[88:91], v[56:59], a[252:255]
buffer_load_dwordx4 v[72:75], v1, s[12:15], s33 offen offset:2048 sc1
v_mfma_f32_16x16x32_bf16 a[252:255], v[92:95], v[60:63], a[252:255]
s_waitcnt vmcnt(11) lgkmcnt(2)
v_mfma_f32_16x16x32_bf16 a[128:131], v[96:99], v[40:43], a[128:131]
ds_read_b128 v[56:59], v2 offset:20480
v_mfma_f32_16x16x32_bf16 a[128:131], v[100:103], v[44:47], a[128:131]
ds_read_b128 v[60:63], v3 offset:20480
buffer_load_dwordx4 v[76:79], v1, s[12:15], s33 offen offset:3072 sc1
s_waitcnt vmcnt(10)
v_mfma_f32_16x16x32_bf16 a[132:135], v[104:107], v[40:43], a[132:135]
v_mfma_f32_16x16x32_bf16 a[132:135], v[108:111], v[44:47], a[132:135]
s_waitcnt vmcnt(8)
v_mfma_f32_16x16x32_bf16 a[136:139], v[112:115], v[40:43], a[136:139]
buffer_load_dwordx4 v[80:83], v1, s[12:15], s34 offen offset:0 sc1
v_mfma_f32_16x16x32_bf16 a[136:139], v[116:119], v[44:47], a[136:139]
s_waitcnt vmcnt(7)
v_mfma_f32_16x16x32_bf16 a[140:143], v[120:123], v[40:43], a[140:143]
v_mfma_f32_16x16x32_bf16 a[140:143], v[124:127], v[44:47], a[140:143]
buffer_load_dwordx4 v[84:87], v1, s[12:15], s34 offen offset:1024 sc1
s_waitcnt lgkmcnt(2)
v_mfma_f32_16x16x32_bf16 a[144:147], v[96:99], v[48:51], a[144:147]
ds_read_b128 v[40:43], v2 offset:22528
v_mfma_f32_16x16x32_bf16 a[144:147], v[100:103], v[52:55], a[144:147]
ds_read_b128 v[44:47], v3 offset:22528
v_mfma_f32_16x16x32_bf16 a[148:151], v[104:107], v[48:51], a[148:151]
buffer_load_dwordx4 v[88:91], v1, s[12:15], s34 offen offset:2048 sc1
v_mfma_f32_16x16x32_bf16 a[148:151], v[108:111], v[52:55], a[148:151]
v_mfma_f32_16x16x32_bf16 a[152:155], v[112:115], v[48:51], a[152:155]
v_mfma_f32_16x16x32_bf16 a[152:155], v[116:119], v[52:55], a[152:155]
buffer_load_dwordx4 v[92:95], v1, s[12:15], s34 offen offset:3072 sc1
s_add_u32 s33, s33, 0x8000
s_add_u32 s34, s34, 0x8000
v_mfma_f32_16x16x32_bf16 a[156:159], v[120:123], v[48:51], a[156:159]
v_mfma_f32_16x16x32_bf16 a[156:159], v[124:127], v[52:55], a[156:159]
s_waitcnt lgkmcnt(2)
v_mfma_f32_16x16x32_bf16 a[160:163], v[96:99], v[56:59], a[160:163]
ds_read_b128 v[48:51], v2 offset:24576
v_mfma_f32_16x16x32_bf16 a[160:163], v[100:103], v[60:63], a[160:163]
ds_read_b128 v[52:55], v3 offset:24576
v_mfma_f32_16x16x32_bf16 a[164:167], v[104:107], v[56:59], a[164:167]
v_mfma_f32_16x16x32_bf16 a[164:167], v[108:111], v[60:63], a[164:167]
v_mfma_f32_16x16x32_bf16 a[168:171], v[112:115], v[56:59], a[168:171]
s_add_u32 m0, s3, 0xe000
v_mfma_f32_16x16x32_bf16 a[168:171], v[116:119], v[60:63], a[168:171]
buffer_load_dwordx4 v8, s[20:23], s35 offen sc1 lds
s_add_u32 s35, s35, 0x10000
v_mfma_f32_16x16x32_bf16 a[172:175], v[120:123], v[56:59], a[172:175]
v_mfma_f32_16x16x32_bf16 a[172:175], v[124:127], v[60:63], a[172:175]
s_waitcnt lgkmcnt(2)
v_mfma_f32_16x16x32_bf16 a[176:179], v[96:99], v[40:43], a[176:179]
ds_read_b128 v[56:59], v2 offset:26624
v_mfma_f32_16x16x32_bf16 a[176:179], v[100:103], v[44:47], a[176:179]
ds_read_b128 v[60:63], v3 offset:26624
v_mfma_f32_16x16x32_bf16 a[180:183], v[104:107], v[40:43], a[180:183]
v_mfma_f32_16x16x32_bf16 a[180:183], v[108:111], v[44:47], a[180:183]
v_mfma_f32_16x16x32_bf16 a[184:187], v[112:115], v[40:43], a[184:187]
s_add_u32 m0, s3, 0xf000
v_mfma_f32_16x16x32_bf16 a[184:187], v[116:119], v[44:47], a[184:187]
buffer_load_dwordx4 v8, s[20:23], s35 offen sc1 lds
v_xor_b32 v8, 0x200, v8
v_mfma_f32_16x16x32_bf16 a[188:191], v[120:123], v[40:43], a[188:191]
v_mfma_f32_16x16x32_bf16 a[188:191], v[124:127], v[44:47], a[188:191]
s_waitcnt lgkmcnt(2)
v_mfma_f32_16x16x32_bf16 a[192:195], v[96:99], v[48:51], a[192:195]
ds_read_b128 v[40:43], v2 offset:28672
v_mfma_f32_16x16x32_bf16 a[192:195], v[100:103], v[52:55], a[192:195]
ds_read_b128 v[44:47], v3 offset:28672
v_mfma_f32_16x16x32_bf16 a[196:199], v[104:107], v[48:51], a[196:199]
v_mfma_f32_16x16x32_bf16 a[196:199], v[108:111], v[52:55], a[196:199]
v_mfma_f32_16x16x32_bf16 a[200:203], v[112:115], v[48:51], a[200:203]
v_mfma_f32_16x16x32_bf16 a[200:203], v[116:119], v[52:55], a[200:203]
v_mfma_f32_16x16x32_bf16 a[204:207], v[120:123], v[48:51], a[204:207]
v_mfma_f32_16x16x32_bf16 a[204:207], v[124:127], v[52:55], a[204:207]
s_waitcnt lgkmcnt(2)
v_mfma_f32_16x16x32_bf16 a[208:211], v[96:99], v[56:59], a[208:211]
ds_read_b128 v[48:51], v2 offset:30720
v_mfma_f32_16x16x32_bf16 a[208:211], v[100:103], v[60:63], a[208:211]
ds_read_b128 v[52:55], v3 offset:30720
v_mfma_f32_16x16x32_bf16 a[212:215], v[104:107], v[56:59], a[212:215]
v_mfma_f32_16x16x32_bf16 a[212:215], v[108:111], v[60:63], a[212:215]
v_mfma_f32_16x16x32_bf16 a[216:219], v[112:115], v[56:59], a[216:219]
v_mfma_f32_16x16x32_bf16 a[216:219], v[116:119], v[60:63], a[216:219]
v_mfma_f32_16x16x32_bf16 a[220:223], v[120:123], v[56:59], a[220:223]
v_mfma_f32_16x16x32_bf16 a[220:223], v[124:127], v[60:63], a[220:223]
s_waitcnt lgkmcnt(2)
v_mfma_f32_16x16x32_bf16 a[224:227], v[96:99], v[40:43], a[224:227]
ds_read_b128 v[56:59], v2 offset:32768
v_mfma_f32_16x16x32_bf16 a[224:227], v[100:103], v[44:47], a[224:227]
ds_read_b128 v[60:63], v3 offset:32768
v_mfma_f32_16x16x32_bf16 a[228:231], v[104:107], v[40:43], a[228:231]
v_mfma_f32_16x16x32_bf16 a[228:231], v[108:111], v[44:47], a[228:231]
v_mfma_f32_16x16x32_bf16 a[232:235], v[112:115], v[40:43], a[232:235]
v_mfma_f32_16x16x32_bf16 a[232:235], v[116:119], v[44:47], a[232:235]
v_mfma_f32_16x16x32_bf16 a[236:239], v[120:123], v[40:43], a[236:239]
v_mfma_f32_16x16x32_bf16 a[236:239], v[124:127], v[44:47], a[236:239]
s_waitcnt lgkmcnt(2)
v_mfma_f32_16x16x32_bf16 a[240:243], v[96:99], v[48:51], a[240:243]
ds_read_b128 v[40:43], v2 offset:34816
buffer_load_dwordx4 v[96:99], v1, s[12:15], s33 offen offset:0 sc1
v_mfma_f32_16x16x32_bf16 a[240:243], v[100:103], v[52:55], a[240:243]
ds_read_b128 v[44:47], v3 offset:34816
v_mfma_f32_16x16x32_bf16 a[244:247], v[104:107], v[48:51], a[244:247]
v_mfma_f32_16x16x32_bf16 a[244:247], v[108:111], v[52:55], a[244:247]
buffer_load_dwordx4 v[100:103], v1, s[12:15], s33 offen offset:1024 sc1
v_mfma_f32_16x16x32_bf16 a[248:251], v[112:115], v[48:51], a[248:251]
v_mfma_f32_16x16x32_bf16 a[248:251], v[116:119], v[52:55], a[248:251]
v_mfma_f32_16x16x32_bf16 a[252:255], v[120:123], v[48:51], a[252:255]
buffer_load_dwordx4 v[104:107], v1, s[12:15], s33 offen offset:2048 sc1
v_mfma_f32_16x16x32_bf16 a[252:255], v[124:127], v[52:55], a[252:255]
s_waitcnt vmcnt(11) lgkmcnt(2)
v_mfma_f32_16x16x32_bf16 a[128:131], v[64:67], v[56:59], a[128:131]
ds_read_b128 v[48:51], v2 offset:36864
v_mfma_f32_16x16x32_bf16 a[128:131], v[68:71], v[60:63], a[128:131]
ds_read_b128 v[52:55], v3 offset:36864
buffer_load_dwordx4 v[108:111], v1, s[12:15], s33 offen offset:3072 sc1
buffer_load_dword v12, v11, s[24:27], s42 offen sc1
s_waitcnt vmcnt(11)
v_mfma_f32_16x16x32_bf16 a[132:135], v[72:75], v[56:59], a[132:135]
v_mfma_f32_16x16x32_bf16 a[132:135], v[76:79], v[60:63], a[132:135]
v_lshlrev_b32 v20, 2, v1
s_add_u32 s5, s43, 0x200000
buffer_load_dword v21, v20, s[12:15], s5 offen sc1
s_waitcnt vmcnt(10)
v_mfma_f32_16x16x32_bf16 a[136:139], v[80:83], v[56:59], a[136:139]
buffer_load_dwordx4 v[112:115], v1, s[12:15], s34 offen offset:0 sc1
v_mfma_f32_16x16x32_bf16 a[136:139], v[84:87], v[60:63], a[136:139]
s_waitcnt vmcnt(9)
v_mfma_f32_16x16x32_bf16 a[140:143], v[88:91], v[56:59], a[140:143]
v_mfma_f32_16x16x32_bf16 a[140:143], v[92:95], v[60:63], a[140:143]
buffer_load_dwordx4 v[116:119], v1, s[12:15], s34 offen offset:1024 sc1
s_waitcnt lgkmcnt(2)
v_mfma_f32_16x16x32_bf16 a[144:147], v[64:67], v[40:43], a[144:147]
ds_read_b128 v[56:59], v2 offset:38912
v_mfma_f32_16x16x32_bf16 a[144:147], v[68:71], v[44:47], a[144:147]
ds_read_b128 v[60:63], v3 offset:38912
v_mfma_f32_16x16x32_bf16 a[148:151], v[72:75], v[40:43], a[148:151]
buffer_load_dwordx4 v[120:123], v1, s[12:15], s34 offen offset:2048 sc1
v_mfma_f32_16x16x32_bf16 a[148:151], v[76:79], v[44:47], a[148:151]
v_mfma_f32_16x16x32_bf16 a[152:155], v[80:83], v[40:43], a[152:155]
v_mfma_f32_16x16x32_bf16 a[152:155], v[84:87], v[44:47], a[152:155]
buffer_load_dwordx4 v[124:127], v1, s[12:15], s34 offen offset:3072 sc1
s_add_u32 s33, s33, 0x8000
s_add_u32 s34, s34, 0x8000
v_mfma_f32_16x16x32_bf16 a[156:159], v[88:91], v[40:43], a[156:159]
v_mfma_f32_16x16x32_bf16 a[156:159], v[92:95], v[44:47], a[156:159]
s_waitcnt lgkmcnt(2)
v_mfma_f32_16x16x32_bf16 a[160:163], v[64:67], v[48:51], a[160:163]
ds_read_b128 v[40:43], v2 offset:40960
v_mfma_f32_16x16x32_bf16 a[160:163], v[68:71], v[52:55], a[160:163]
ds_read_b128 v[44:47], v3 offset:40960
v_mfma_f32_16x16x32_bf16 a[164:167], v[72:75], v[48:51], a[164:167]
v_mfma_f32_16x16x32_bf16 a[164:167], v[76:79], v[52:55], a[164:167]
v_mfma_f32_16x16x32_bf16 a[168:171], v[80:83], v[48:51], a[168:171]
v_mfma_f32_16x16x32_bf16 a[168:171], v[84:87], v[52:55], a[168:171]
v_mfma_f32_16x16x32_bf16 a[172:175], v[88:91], v[48:51], a[172:175]
v_mfma_f32_16x16x32_bf16 a[172:175], v[92:95], v[52:55], a[172:175]
s_waitcnt lgkmcnt(2)
v_mfma_f32_16x16x32_bf16 a[176:179], v[64:67], v[56:59], a[176:179]
ds_read_b128 v[48:51], v2 offset:43008
v_mfma_f32_16x16x32_bf16 a[176:179], v[68:71], v[60:63], a[176:179]
ds_read_b128 v[52:55], v3 offset:43008
v_mfma_f32_16x16x32_bf16 a[180:183], v[72:75], v[56:59], a[180:183]
v_mfma_f32_16x16x32_bf16 a[180:183], v[76:79], v[60:63], a[180:183]
v_mfma_f32_16x16x32_bf16 a[184:187], v[80:83], v[56:59], a[184:187]
v_mfma_f32_16x16x32_bf16 a[184:187], v[84:87], v[60:63], a[184:187]
v_mfma_f32_16x16x32_bf16 a[188:191], v[88:91], v[56:59], a[188:191]
v_mfma_f32_16x16x32_bf16 a[188:191], v[92:95], v[60:63], a[188:191]
s_waitcnt lgkmcnt(2)
v_mfma_f32_16x16x32_bf16 a[192:195], v[64:67], v[40:43], a[192:195]
ds_read_b128 v[56:59], v2 offset:45056
v_mfma_f32_16x16x32_bf16 a[192:195], v[68:71], v[44:47], a[192:195]
ds_read_b128 v[60:63], v3 offset:45056
v_mfma_f32_16x16x32_bf16 a[196:199], v[72:75], v[40:43], a[196:199]
v_mfma_f32_16x16x32_bf16 a[196:199], v[76:79], v[44:47], a[196:199]
v_mfma_f32_16x16x32_bf16 a[200:203], v[80:83], v[40:43], a[200:203]
v_mfma_f32_16x16x32_bf16 a[200:203], v[84:87], v[44:47], a[200:203]
v_mfma_f32_16x16x32_bf16 a[204:207], v[88:91], v[40:43], a[204:207]
v_mfma_f32_16x16x32_bf16 a[204:207], v[92:95], v[44:47], a[204:207]
s_waitcnt lgkmcnt(2)
v_mfma_f32_16x16x32_bf16 a[208:211], v[64:67], v[48:51], a[208:211]
ds_read_b128 v[40:43], v2 offset:47104
v_mfma_f32_16x16x32_bf16 a[208:211], v[68:71], v[52:55], a[208:211]
ds_read_b128 v[44:47], v3 offset:47104
v_mfma_f32_16x16x32_bf16 a[212:215], v[72:75], v[48:51], a[212:215]
v_mfma_f32_16x16x32_bf16 a[212:215], v[76:79], v[52:55], a[212:215]
v_mfma_f32_16x16x32_bf16 a[216:219], v[80:83], v[48:51], a[216:219]
v_mfma_f32_16x16x32_bf16 a[216:219], v[84:87], v[52:55], a[216:219]
v_mfma_f32_16x16x32_bf16 a[220:223], v[88:91], v[48:51], a[220:223]
v_mfma_f32_16x16x32_bf16 a[220:223], v[92:95], v[52:55], a[220:223]
s_waitcnt lgkmcnt(2)
v_mfma_f32_16x16x32_bf16 a[224:227], v[64:67], v[56:59], a[224:227]
ds_read_b128 v[48:51], v2 offset:49152
v_mfma_f32_16x16x32_bf16 a[224:227], v[68:71], v[60:63], a[224:227]
ds_read_b128 v[52:55], v3 offset:49152
v_mfma_f32_16x16x32_bf16 a[228:231], v[72:75], v[56:59], a[228:231]
v_mfma_f32_16x16x32_bf16 a[228:231], v[76:79], v[60:63], a[228:231]
v_mfma_f32_16x16x32_bf16 a[232:235], v[80:83], v[56:59], a[232:235]
v_mfma_f32_16x16x32_bf16 a[232:235], v[84:87], v[60:63], a[232:235]
v_mfma_f32_16x16x32_bf16 a[236:239], v[88:91], v[56:59], a[236:239]
v_mfma_f32_16x16x32_bf16 a[236:239], v[92:95], v[60:63], a[236:239]
s_waitcnt lgkmcnt(2)
v_mfma_f32_16x16x32_bf16 a[240:243], v[64:67], v[40:43], a[240:243]
ds_read_b128 v[56:59], v2 offset:51200
buffer_load_dwordx4 v[64:67], v1, s[12:15], s33 offen offset:0 sc1
v_mfma_f32_16x16x32_bf16 a[240:243], v[68:71], v[44:47], a[240:243]
ds_read_b128 v[60:63], v3 offset:51200
v_mfma_f32_16x16x32_bf16 a[244:247], v[72:75], v[40:43], a[244:247]
v_mfma_f32_16x16x32_bf16 a[244:247], v[76:79], v[44:47], a[244:247]
buffer_load_dwordx4 v[68:71], v1, s[12:15], s33 offen offset:1024 sc1
v_mfma_f32_16x16x32_bf16 a[248:251], v[80:83], v[40:43], a[248:251]
v_mfma_f32_16x16x32_bf16 a[248:251], v[84:87], v[44:47], a[248:251]
v_mfma_f32_16x16x32_bf16 a[252:255], v[88:91], v[40:43], a[252:255]
buffer_load_dwordx4 v[72:75], v1, s[12:15], s33 offen offset:2048 sc1
v_mfma_f32_16x16x32_bf16 a[252:255], v[92:95], v[44:47], a[252:255]
s_waitcnt vmcnt(11) lgkmcnt(2)
v_mfma_f32_16x16x32_bf16 a[128:131], v[96:99], v[48:51], a[128:131]
ds_read_b128 v[40:43], v2 offset:53248
v_mfma_f32_16x16x32_bf16 a[128:131], v[100:103], v[52:55], a[128:131]
ds_read_b128 v[44:47], v3 offset:53248
buffer_load_dwordx4 v[76:79], v1, s[12:15], s33 offen offset:3072 sc1
s_waitcnt vmcnt(10)
v_mfma_f32_16x16x32_bf16 a[132:135], v[104:107], v[48:51], a[132:135]
v_mfma_f32_16x16x32_bf16 a[132:135], v[108:111], v[52:55], a[132:135]
s_waitcnt vmcnt(6)
v_mfma_f32_16x16x32_bf16 a[136:139], v[112:115], v[48:51], a[136:139]
buffer_load_dwordx4 v[80:83], v1, s[12:15], s34 offen offset:0 sc1
v_mfma_f32_16x16x32_bf16 a[136:139], v[116:119], v[52:55], a[136:139]
s_waitcnt vmcnt(5)
v_mfma_f32_16x16x32_bf16 a[140:143], v[120:123], v[48:51], a[140:143]
v_mfma_f32_16x16x32_bf16 a[140:143], v[124:127], v[52:55], a[140:143]
buffer_load_dwordx4 v[84:87], v1, s[12:15], s34 offen offset:1024 sc1
s_waitcnt lgkmcnt(2)
v_mfma_f32_16x16x32_bf16 a[144:147], v[96:99], v[56:59], a[144:147]
ds_read_b128 v[48:51], v2 offset:55296
v_mfma_f32_16x16x32_bf16 a[144:147], v[100:103], v[60:63], a[144:147]
ds_read_b128 v[52:55], v3 offset:55296
v_mfma_f32_16x16x32_bf16 a[148:151], v[104:107], v[56:59], a[148:151]
buffer_load_dwordx4 v[88:91], v1, s[12:15], s34 offen offset:2048 sc1
v_mfma_f32_16x16x32_bf16 a[148:151], v[108:111], v[60:63], a[148:151]
v_lshlrev_b32 v20, 2, v1
s_add_u32 s5, s7, L_cs3-standalone__cross_network_dcn__recsys_kernel
buffer_load_dword v22, v20, s[28:31], s5 offen
v_mfma_f32_16x16x32_bf16 a[152:155], v[112:115], v[56:59], a[152:155]
v_mfma_f32_16x16x32_bf16 a[152:155], v[116:119], v[60:63], a[152:155]
buffer_load_dwordx4 v[92:95], v1, s[12:15], s34 offen offset:3072 sc1
s_add_u32 s33, s33, 0x8000
s_add_u32 s34, s34, 0x8000
v_mfma_f32_16x16x32_bf16 a[156:159], v[120:123], v[56:59], a[156:159]
v_mfma_f32_16x16x32_bf16 a[156:159], v[124:127], v[60:63], a[156:159]
s_waitcnt lgkmcnt(2)
v_mfma_f32_16x16x32_bf16 a[160:163], v[96:99], v[40:43], a[160:163]
ds_read_b128 v[56:59], v2 offset:57344
v_mfma_f32_16x16x32_bf16 a[160:163], v[100:103], v[44:47], a[160:163]
ds_read_b128 v[60:63], v3 offset:57344
v_mfma_f32_16x16x32_bf16 a[164:167], v[104:107], v[40:43], a[164:167]
v_mfma_f32_16x16x32_bf16 a[164:167], v[108:111], v[44:47], a[164:167]
v_mfma_f32_16x16x32_bf16 a[168:171], v[112:115], v[40:43], a[168:171]
v_mfma_f32_16x16x32_bf16 a[168:171], v[116:119], v[44:47], a[168:171]
v_mfma_f32_16x16x32_bf16 a[172:175], v[120:123], v[40:43], a[172:175]
v_mfma_f32_16x16x32_bf16 a[172:175], v[124:127], v[44:47], a[172:175]
s_waitcnt lgkmcnt(2)
v_mfma_f32_16x16x32_bf16 a[176:179], v[96:99], v[48:51], a[176:179]
ds_read_b128 v[40:43], v2 offset:59392
v_mfma_f32_16x16x32_bf16 a[176:179], v[100:103], v[52:55], a[176:179]
ds_read_b128 v[44:47], v3 offset:59392
v_mfma_f32_16x16x32_bf16 a[180:183], v[104:107], v[48:51], a[180:183]
v_mfma_f32_16x16x32_bf16 a[180:183], v[108:111], v[52:55], a[180:183]
v_mfma_f32_16x16x32_bf16 a[184:187], v[112:115], v[48:51], a[184:187]
v_mfma_f32_16x16x32_bf16 a[184:187], v[116:119], v[52:55], a[184:187]
v_mfma_f32_16x16x32_bf16 a[188:191], v[120:123], v[48:51], a[188:191]
v_mfma_f32_16x16x32_bf16 a[188:191], v[124:127], v[52:55], a[188:191]
s_waitcnt lgkmcnt(2)
v_mfma_f32_16x16x32_bf16 a[192:195], v[96:99], v[56:59], a[192:195]
ds_read_b128 v[48:51], v2 offset:61440
v_mfma_f32_16x16x32_bf16 a[192:195], v[100:103], v[60:63], a[192:195]
ds_read_b128 v[52:55], v3 offset:61440
v_mfma_f32_16x16x32_bf16 a[196:199], v[104:107], v[56:59], a[196:199]
v_mfma_f32_16x16x32_bf16 a[196:199], v[108:111], v[60:63], a[196:199]
v_mfma_f32_16x16x32_bf16 a[200:203], v[112:115], v[56:59], a[200:203]
v_mfma_f32_16x16x32_bf16 a[200:203], v[116:119], v[60:63], a[200:203]
v_mfma_f32_16x16x32_bf16 a[204:207], v[120:123], v[56:59], a[204:207]
v_mfma_f32_16x16x32_bf16 a[204:207], v[124:127], v[60:63], a[204:207]
s_waitcnt lgkmcnt(2)
v_mfma_f32_16x16x32_bf16 a[208:211], v[96:99], v[40:43], a[208:211]
ds_read_b128 v[56:59], v2 offset:63488
v_mfma_f32_16x16x32_bf16 a[208:211], v[100:103], v[44:47], a[208:211]
ds_read_b128 v[60:63], v3 offset:63488
v_mfma_f32_16x16x32_bf16 a[212:215], v[104:107], v[40:43], a[212:215]
v_mfma_f32_16x16x32_bf16 a[212:215], v[108:111], v[44:47], a[212:215]
v_mfma_f32_16x16x32_bf16 a[216:219], v[112:115], v[40:43], a[216:219]
v_mfma_f32_16x16x32_bf16 a[216:219], v[116:119], v[44:47], a[216:219]
v_mfma_f32_16x16x32_bf16 a[220:223], v[120:123], v[40:43], a[220:223]
v_mfma_f32_16x16x32_bf16 a[220:223], v[124:127], v[44:47], a[220:223]
s_waitcnt lgkmcnt(2)
v_mfma_f32_16x16x32_bf16 a[224:227], v[96:99], v[48:51], a[224:227]
v_mfma_f32_16x16x32_bf16 a[224:227], v[100:103], v[52:55], a[224:227]
v_mfma_f32_16x16x32_bf16 a[228:231], v[104:107], v[48:51], a[228:231]
v_mfma_f32_16x16x32_bf16 a[228:231], v[108:111], v[52:55], a[228:231]
v_mfma_f32_16x16x32_bf16 a[232:235], v[112:115], v[48:51], a[232:235]
v_mfma_f32_16x16x32_bf16 a[232:235], v[116:119], v[52:55], a[232:235]
v_mfma_f32_16x16x32_bf16 a[236:239], v[120:123], v[48:51], a[236:239]
v_mfma_f32_16x16x32_bf16 a[236:239], v[124:127], v[52:55], a[236:239]
s_waitcnt lgkmcnt(0)
s_barrier
v_xor_b32 v2, 0x10000, v2
v_xor_b32 v3, 0x10000, v3
v_mfma_f32_16x16x32_bf16 a[240:243], v[96:99], v[56:59], a[240:243]
ds_read_b128 v[40:43], v2 offset:0
buffer_load_dwordx4 v[96:99], v1, s[12:15], s33 offen offset:0 sc1
v_mfma_f32_16x16x32_bf16 a[240:243], v[100:103], v[60:63], a[240:243]
ds_read_b128 v[44:47], v3 offset:0
v_mfma_f32_16x16x32_bf16 a[244:247], v[104:107], v[56:59], a[244:247]
ds_read_b128 v[48:51], v2 offset:2048
v_mfma_f32_16x16x32_bf16 a[244:247], v[108:111], v[60:63], a[244:247]
ds_read_b128 v[52:55], v3 offset:2048
buffer_load_dwordx4 v[100:103], v1, s[12:15], s33 offen offset:1024 sc1
v_mfma_f32_16x16x32_bf16 a[248:251], v[112:115], v[56:59], a[248:251]
v_mfma_f32_16x16x32_bf16 a[248:251], v[116:119], v[60:63], a[248:251]
v_mfma_f32_16x16x32_bf16 a[252:255], v[120:123], v[56:59], a[252:255]
buffer_load_dwordx4 v[104:107], v1, s[12:15], s33 offen offset:2048 sc1
v_mfma_f32_16x16x32_bf16 a[252:255], v[124:127], v[60:63], a[252:255]
s_waitcnt vmcnt(10) lgkmcnt(2)
L_cs3:
v_mfma_f32_16x16x32_bf16 a[0:3], v[64:67], v[40:43], a[0:3]
ds_read_b128 v[56:59], v2 offset:4096
v_mfma_f32_16x16x32_bf16 a[0:3], v[68:71], v[44:47], a[0:3]
ds_read_b128 v[60:63], v3 offset:4096
buffer_load_dwordx4 v[108:111], v1, s[12:15], s33 offen offset:3072 sc1
s_waitcnt vmcnt(9)
v_mfma_f32_16x16x32_bf16 a[4:7], v[72:75], v[40:43], a[4:7]
v_cmp_gt_u32 vcc, 2, v12
s_cbranch_vccz L_pok3
s_mov_b32 s4, 0x40000
L_psp3:
s_sleep 2
buffer_load_dword v12, v11, s[24:27], s42 offen sc1
s_sub_u32 s4, s4, 1
s_cbranch_scc1 L_pok3
s_waitcnt vmcnt(0)
v_cmp_gt_u32 vcc, 2, v12
s_cbranch_vccnz L_psp3
L_pok3:
v_mfma_f32_16x16x32_bf16 a[4:7], v[76:79], v[44:47], a[4:7]
s_add_u32 s35, s38, 0x0
s_waitcnt vmcnt(7)
v_mfma_f32_16x16x32_bf16 a[8:11], v[80:83], v[40:43], a[8:11]
buffer_load_dwordx4 v[112:115], v1, s[12:15], s34 offen offset:0 sc1
v_mfma_f32_16x16x32_bf16 a[8:11], v[84:87], v[44:47], a[8:11]
s_waitcnt vmcnt(5)
v_mfma_f32_16x16x32_bf16 a[12:15], v[88:91], v[40:43], a[12:15]
v_mfma_f32_16x16x32_bf16 a[12:15], v[92:95], v[44:47], a[12:15]
buffer_load_dwordx4 v[116:119], v1, s[12:15], s34 offen offset:1024 sc1
s_waitcnt lgkmcnt(2)
v_mfma_f32_16x16x32_bf16 a[16:19], v[64:67], v[48:51], a[16:19]
ds_read_b128 v[40:43], v2 offset:6144
v_mfma_f32_16x16x32_bf16 a[16:19], v[68:71], v[52:55], a[16:19]
ds_read_b128 v[44:47], v3 offset:6144
v_mfma_f32_16x16x32_bf16 a[20:23], v[72:75], v[48:51], a[20:23]
buffer_load_dwordx4 v[120:123], v1, s[12:15], s34 offen offset:2048 sc1
v_mfma_f32_16x16x32_bf16 a[20:23], v[76:79], v[52:55], a[20:23]
v_mfma_f32_16x16x32_bf16 a[24:27], v[80:83], v[48:51], a[24:27]
v_mfma_f32_16x16x32_bf16 a[24:27], v[84:87], v[52:55], a[24:27]
buffer_load_dwordx4 v[124:127], v1, s[12:15], s34 offen offset:3072 sc1
s_add_u32 s33, s33, 0x8000
s_add_u32 s34, s34, 0x8000
v_mfma_f32_16x16x32_bf16 a[28:31], v[88:91], v[48:51], a[28:31]
v_mfma_f32_16x16x32_bf16 a[28:31], v[92:95], v[52:55], a[28:31]
s_waitcnt lgkmcnt(2)
v_mfma_f32_16x16x32_bf16 a[32:35], v[64:67], v[56:59], a[32:35]
ds_read_b128 v[48:51], v2 offset:8192
v_mfma_f32_16x16x32_bf16 a[32:35], v[68:71], v[60:63], a[32:35]
ds_read_b128 v[52:55], v3 offset:8192
v_mfma_f32_16x16x32_bf16 a[36:39], v[72:75], v[56:59], a[36:39]
v_mfma_f32_16x16x32_bf16 a[36:39], v[76:79], v[60:63], a[36:39]
v_mfma_f32_16x16x32_bf16 a[40:43], v[80:83], v[56:59], a[40:43]
s_add_u32 m0, s3, 0x10000
v_mfma_f32_16x16x32_bf16 a[40:43], v[84:87], v[60:63], a[40:43]
buffer_load_dwordx4 v8, s[20:23], s35 offen sc1 lds
s_add_u32 s35, s35, 0x10000
v_mfma_f32_16x16x32_bf16 a[44:47], v[88:91], v[56:59], a[44:47]
v_mfma_f32_16x16x32_bf16 a[44:47], v[92:95], v[60:63], a[44:47]
s_waitcnt lgkmcnt(2)
v_mfma_f32_16x16x32_bf16 a[48:51], v[64:67], v[40:43], a[48:51]
ds_read_b128 v[56:59], v2 offset:10240
v_mfma_f32_16x16x32_bf16 a[48:51], v[68:71], v[44:47], a[48:51]
ds_read_b128 v[60:63], v3 offset:10240
v_mfma_f32_16x16x32_bf16 a[52:55], v[72:75], v[40:43], a[52:55]
v_mfma_f32_16x16x32_bf16 a[52:55], v[76:79], v[44:47], a[52:55]
v_mfma_f32_16x16x32_bf16 a[56:59], v[80:83], v[40:43], a[56:59]
s_add_u32 m0, s3, 0x11000
v_mfma_f32_16x16x32_bf16 a[56:59], v[84:87], v[44:47], a[56:59]
buffer_load_dwordx4 v8, s[20:23], s35 offen sc1 lds
s_add_u32 s35, s35, 0x10000
v_mfma_f32_16x16x32_bf16 a[60:63], v[88:91], v[40:43], a[60:63]
v_mfma_f32_16x16x32_bf16 a[60:63], v[92:95], v[44:47], a[60:63]
s_waitcnt lgkmcnt(2)
v_mfma_f32_16x16x32_bf16 a[64:67], v[64:67], v[48:51], a[64:67]
ds_read_b128 v[40:43], v2 offset:12288
v_mfma_f32_16x16x32_bf16 a[64:67], v[68:71], v[52:55], a[64:67]
ds_read_b128 v[44:47], v3 offset:12288
v_mfma_f32_16x16x32_bf16 a[68:71], v[72:75], v[48:51], a[68:71]
v_mfma_f32_16x16x32_bf16 a[68:71], v[76:79], v[52:55], a[68:71]
v_mfma_f32_16x16x32_bf16 a[72:75], v[80:83], v[48:51], a[72:75]
s_add_u32 m0, s3, 0x12000
v_mfma_f32_16x16x32_bf16 a[72:75], v[84:87], v[52:55], a[72:75]
buffer_load_dwordx4 v8, s[20:23], s35 offen sc1 lds
s_add_u32 s35, s35, 0x10000
v_mfma_f32_16x16x32_bf16 a[76:79], v[88:91], v[48:51], a[76:79]
v_mfma_f32_16x16x32_bf16 a[76:79], v[92:95], v[52:55], a[76:79]
s_waitcnt lgkmcnt(2)
v_mfma_f32_16x16x32_bf16 a[80:83], v[64:67], v[56:59], a[80:83]
ds_read_b128 v[48:51], v2 offset:14336
v_mfma_f32_16x16x32_bf16 a[80:83], v[68:71], v[60:63], a[80:83]
ds_read_b128 v[52:55], v3 offset:14336
v_mfma_f32_16x16x32_bf16 a[84:87], v[72:75], v[56:59], a[84:87]
v_mfma_f32_16x16x32_bf16 a[84:87], v[76:79], v[60:63], a[84:87]
v_mfma_f32_16x16x32_bf16 a[88:91], v[80:83], v[56:59], a[88:91]
v_mfma_f32_16x16x32_bf16 a[88:91], v[84:87], v[60:63], a[88:91]
v_mfma_f32_16x16x32_bf16 a[92:95], v[88:91], v[56:59], a[92:95]
v_mfma_f32_16x16x32_bf16 a[92:95], v[92:95], v[60:63], a[92:95]
s_waitcnt lgkmcnt(2)
v_mfma_f32_16x16x32_bf16 a[96:99], v[64:67], v[40:43], a[96:99]
ds_read_b128 v[56:59], v2 offset:16384
v_mfma_f32_16x16x32_bf16 a[96:99], v[68:71], v[44:47], a[96:99]
ds_read_b128 v[60:63], v3 offset:16384
v_mfma_f32_16x16x32_bf16 a[100:103], v[72:75], v[40:43], a[100:103]
v_mfma_f32_16x16x32_bf16 a[100:103], v[76:79], v[44:47], a[100:103]
v_mfma_f32_16x16x32_bf16 a[104:107], v[80:83], v[40:43], a[104:107]
v_mfma_f32_16x16x32_bf16 a[104:107], v[84:87], v[44:47], a[104:107]
v_mfma_f32_16x16x32_bf16 a[108:111], v[88:91], v[40:43], a[108:111]
v_mfma_f32_16x16x32_bf16 a[108:111], v[92:95], v[44:47], a[108:111]
s_waitcnt lgkmcnt(2)
v_mfma_f32_16x16x32_bf16 a[112:115], v[64:67], v[48:51], a[112:115]
ds_read_b128 v[40:43], v2 offset:18432
buffer_load_dwordx4 v[64:67], v1, s[12:15], s33 offen offset:0 sc1
v_mfma_f32_16x16x32_bf16 a[112:115], v[68:71], v[52:55], a[112:115]
ds_read_b128 v[44:47], v3 offset:18432
v_mfma_f32_16x16x32_bf16 a[116:119], v[72:75], v[48:51], a[116:119]
v_mfma_f32_16x16x32_bf16 a[116:119], v[76:79], v[52:55], a[116:119]
buffer_load_dwordx4 v[68:71], v1, s[12:15], s33 offen offset:1024 sc1
v_mfma_f32_16x16x32_bf16 a[120:123], v[80:83], v[48:51], a[120:123]
v_mfma_f32_16x16x32_bf16 a[120:123], v[84:87], v[52:55], a[120:123]
v_mfma_f32_16x16x32_bf16 a[124:127], v[88:91], v[48:51], a[124:127]
buffer_load_dwordx4 v[72:75], v1, s[12:15], s33 offen offset:2048 sc1
v_mfma_f32_16x16x32_bf16 a[124:127], v[92:95], v[52:55], a[124:127]
s_waitcnt vmcnt(12) lgkmcnt(2)
v_mfma_f32_16x16x32_bf16 a[0:3], v[96:99], v[56:59], a[0:3]
ds_read_b128 v[48:51], v2 offset:20480
v_mfma_f32_16x16x32_bf16 a[0:3], v[100:103], v[60:63], a[0:3]
ds_read_b128 v[52:55], v3 offset:20480
buffer_load_dwordx4 v[76:79], v1, s[12:15], s33 offen offset:3072 sc1
s_waitcnt vmcnt(11)
v_mfma_f32_16x16x32_bf16 a[4:7], v[104:107], v[56:59], a[4:7]
v_mfma_f32_16x16x32_bf16 a[4:7], v[108:111], v[60:63], a[4:7]
s_waitcnt vmcnt(9)
v_mfma_f32_16x16x32_bf16 a[8:11], v[112:115], v[56:59], a[8:11]
buffer_load_dwordx4 v[80:83], v1, s[12:15], s34 offen offset:0 sc1
v_mfma_f32_16x16x32_bf16 a[8:11], v[116:119], v[60:63], a[8:11]
s_waitcnt vmcnt(8)
v_mfma_f32_16x16x32_bf16 a[12:15], v[120:123], v[56:59], a[12:15]
v_mfma_f32_16x16x32_bf16 a[12:15], v[124:127], v[60:63], a[12:15]
buffer_load_dwordx4 v[84:87], v1, s[12:15], s34 offen offset:1024 sc1
s_waitcnt lgkmcnt(2)
v_mfma_f32_16x16x32_bf16 a[16:19], v[96:99], v[40:43], a[16:19]
ds_read_b128 v[56:59], v2 offset:22528
v_mfma_f32_16x16x32_bf16 a[16:19], v[100:103], v[44:47], a[16:19]
ds_read_b128 v[60:63], v3 offset:22528
v_mfma_f32_16x16x32_bf16 a[20:23], v[104:107], v[40:43], a[20:23]
buffer_load_dwordx4 v[88:91], v1, s[12:15], s34 offen offset:2048 sc1
v_mfma_f32_16x16x32_bf16 a[20:23], v[108:111], v[44:47], a[20:23]
v_mfma_f32_16x16x32_bf16 a[24:27], v[112:115], v[40:43], a[24:27]
v_mfma_f32_16x16x32_bf16 a[24:27], v[116:119], v[44:47], a[24:27]
buffer_load_dwordx4 v[92:95], v1, s[12:15], s34 offen offset:3072 sc1
s_add_u32 s33, s33, 0x8000
s_add_u32 s34, s34, 0x8000
v_mfma_f32_16x16x32_bf16 a[28:31], v[120:123], v[40:43], a[28:31]
v_mfma_f32_16x16x32_bf16 a[28:31], v[124:127], v[44:47], a[28:31]
s_waitcnt lgkmcnt(2)
v_mfma_f32_16x16x32_bf16 a[32:35], v[96:99], v[48:51], a[32:35]
ds_read_b128 v[40:43], v2 offset:24576
v_mfma_f32_16x16x32_bf16 a[32:35], v[100:103], v[52:55], a[32:35]
ds_read_b128 v[44:47], v3 offset:24576
v_mfma_f32_16x16x32_bf16 a[36:39], v[104:107], v[48:51], a[36:39]
v_mfma_f32_16x16x32_bf16 a[36:39], v[108:111], v[52:55], a[36:39]
v_mfma_f32_16x16x32_bf16 a[40:43], v[112:115], v[48:51], a[40:43]
s_add_u32 m0, s3, 0x13000
v_mfma_f32_16x16x32_bf16 a[40:43], v[116:119], v[52:55], a[40:43]
buffer_load_dwordx4 v8, s[20:23], s35 offen sc1 lds
s_sub_u32 s35, s35, 196480
v_mfma_f32_16x16x32_bf16 a[44:47], v[120:123], v[48:51], a[44:47]
v_mfma_f32_16x16x32_bf16 a[44:47], v[124:127], v[52:55], a[44:47]
s_waitcnt lgkmcnt(2)
v_mfma_f32_16x16x32_bf16 a[48:51], v[96:99], v[56:59], a[48:51]
ds_read_b128 v[48:51], v2 offset:26624
v_mfma_f32_16x16x32_bf16 a[48:51], v[100:103], v[60:63], a[48:51]
ds_read_b128 v[52:55], v3 offset:26624
v_mfma_f32_16x16x32_bf16 a[52:55], v[104:107], v[56:59], a[52:55]
v_mfma_f32_16x16x32_bf16 a[52:55], v[108:111], v[60:63], a[52:55]
v_mfma_f32_16x16x32_bf16 a[56:59], v[112:115], v[56:59], a[56:59]
s_add_u32 m0, s3, 0x14000
v_mfma_f32_16x16x32_bf16 a[56:59], v[116:119], v[60:63], a[56:59]
buffer_load_dwordx4 v8, s[20:23], s35 offen sc1 lds
s_add_u32 s35, s35, 0x10000
v_mfma_f32_16x16x32_bf16 a[60:63], v[120:123], v[56:59], a[60:63]
v_mfma_f32_16x16x32_bf16 a[60:63], v[124:127], v[60:63], a[60:63]
s_waitcnt lgkmcnt(2)
v_mfma_f32_16x16x32_bf16 a[64:67], v[96:99], v[40:43], a[64:67]
ds_read_b128 v[56:59], v2 offset:28672
v_mfma_f32_16x16x32_bf16 a[64:67], v[100:103], v[44:47], a[64:67]
ds_read_b128 v[60:63], v3 offset:28672
v_mfma_f32_16x16x32_bf16 a[68:71], v[104:107], v[40:43], a[68:71]
v_mfma_f32_16x16x32_bf16 a[68:71], v[108:111], v[44:47], a[68:71]
v_mfma_f32_16x16x32_bf16 a[72:75], v[112:115], v[40:43], a[72:75]
s_add_u32 m0, s3, 0x15000
v_mfma_f32_16x16x32_bf16 a[72:75], v[116:119], v[44:47], a[72:75]
buffer_load_dwordx4 v8, s[20:23], s35 offen sc1 lds
s_add_u32 s35, s35, 0x10000
v_mfma_f32_16x16x32_bf16 a[76:79], v[120:123], v[40:43], a[76:79]
v_mfma_f32_16x16x32_bf16 a[76:79], v[124:127], v[44:47], a[76:79]
s_waitcnt lgkmcnt(2)
v_mfma_f32_16x16x32_bf16 a[80:83], v[96:99], v[48:51], a[80:83]
ds_read_b128 v[40:43], v2 offset:30720
v_mfma_f32_16x16x32_bf16 a[80:83], v[100:103], v[52:55], a[80:83]
ds_read_b128 v[44:47], v3 offset:30720
v_mfma_f32_16x16x32_bf16 a[84:87], v[104:107], v[48:51], a[84:87]
v_mfma_f32_16x16x32_bf16 a[84:87], v[108:111], v[52:55], a[84:87]
v_mfma_f32_16x16x32_bf16 a[88:91], v[112:115], v[48:51], a[88:91]
v_mfma_f32_16x16x32_bf16 a[88:91], v[116:119], v[52:55], a[88:91]
v_mfma_f32_16x16x32_bf16 a[92:95], v[120:123], v[48:51], a[92:95]
v_mfma_f32_16x16x32_bf16 a[92:95], v[124:127], v[52:55], a[92:95]
s_waitcnt lgkmcnt(2)
v_mfma_f32_16x16x32_bf16 a[96:99], v[96:99], v[56:59], a[96:99]
ds_read_b128 v[48:51], v2 offset:32768
v_mfma_f32_16x16x32_bf16 a[96:99], v[100:103], v[60:63], a[96:99]
ds_read_b128 v[52:55], v3 offset:32768
v_mfma_f32_16x16x32_bf16 a[100:103], v[104:107], v[56:59], a[100:103]
v_mfma_f32_16x16x32_bf16 a[100:103], v[108:111], v[60:63], a[100:103]
v_mfma_f32_16x16x32_bf16 a[104:107], v[112:115], v[56:59], a[104:107]
v_mfma_f32_16x16x32_bf16 a[104:107], v[116:119], v[60:63], a[104:107]
v_mfma_f32_16x16x32_bf16 a[108:111], v[120:123], v[56:59], a[108:111]
v_mfma_f32_16x16x32_bf16 a[108:111], v[124:127], v[60:63], a[108:111]
s_waitcnt lgkmcnt(2)
v_mfma_f32_16x16x32_bf16 a[112:115], v[96:99], v[40:43], a[112:115]
ds_read_b128 v[56:59], v2 offset:34816
buffer_load_dwordx4 v[96:99], v1, s[12:15], s33 offen offset:0 sc1
v_mfma_f32_16x16x32_bf16 a[112:115], v[100:103], v[44:47], a[112:115]
ds_read_b128 v[60:63], v3 offset:34816
v_mfma_f32_16x16x32_bf16 a[116:119], v[104:107], v[40:43], a[116:119]
v_mfma_f32_16x16x32_bf16 a[116:119], v[108:111], v[44:47], a[116:119]
buffer_load_dwordx4 v[100:103], v1, s[12:15], s33 offen offset:1024 sc1
v_mfma_f32_16x16x32_bf16 a[120:123], v[112:115], v[40:43], a[120:123]
v_mfma_f32_16x16x32_bf16 a[120:123], v[116:119], v[44:47], a[120:123]
v_mfma_f32_16x16x32_bf16 a[124:127], v[120:123], v[40:43], a[124:127]
buffer_load_dwordx4 v[104:107], v1, s[12:15], s33 offen offset:2048 sc1
v_mfma_f32_16x16x32_bf16 a[124:127], v[124:127], v[44:47], a[124:127]
s_waitcnt vmcnt(12) lgkmcnt(2)
v_mfma_f32_16x16x32_bf16 a[0:3], v[64:67], v[48:51], a[0:3]
ds_read_b128 v[40:43], v2 offset:36864
v_mfma_f32_16x16x32_bf16 a[0:3], v[68:71], v[52:55], a[0:3]
ds_read_b128 v[44:47], v3 offset:36864
buffer_load_dwordx4 v[108:111], v1, s[12:15], s33 offen offset:3072 sc1
s_waitcnt vmcnt(11)
v_mfma_f32_16x16x32_bf16 a[4:7], v[72:75], v[48:51], a[4:7]
v_mfma_f32_16x16x32_bf16 a[4:7], v[76:79], v[52:55], a[4:7]
s_waitcnt vmcnt(9)
v_mfma_f32_16x16x32_bf16 a[8:11], v[80:83], v[48:51], a[8:11]
buffer_load_dwordx4 v[112:115], v1, s[12:15], s34 offen offset:0 sc1
v_mfma_f32_16x16x32_bf16 a[8:11], v[84:87], v[52:55], a[8:11]
s_waitcnt vmcnt(8)
v_mfma_f32_16x16x32_bf16 a[12:15], v[88:91], v[48:51], a[12:15]
v_mfma_f32_16x16x32_bf16 a[12:15], v[92:95], v[52:55], a[12:15]
buffer_load_dwordx4 v[116:119], v1, s[12:15], s34 offen offset:1024 sc1
s_waitcnt lgkmcnt(2)
v_mfma_f32_16x16x32_bf16 a[16:19], v[64:67], v[56:59], a[16:19]
ds_read_b128 v[48:51], v2 offset:38912
v_mfma_f32_16x16x32_bf16 a[16:19], v[68:71], v[60:63], a[16:19]
ds_read_b128 v[52:55], v3 offset:38912
v_mfma_f32_16x16x32_bf16 a[20:23], v[72:75], v[56:59], a[20:23]
buffer_load_dwordx4 v[120:123], v1, s[12:15], s34 offen offset:2048 sc1
v_mfma_f32_16x16x32_bf16 a[20:23], v[76:79], v[60:63], a[20:23]
v_mfma_f32_16x16x32_bf16 a[24:27], v[80:83], v[56:59], a[24:27]
v_mfma_f32_16x16x32_bf16 a[24:27], v[84:87], v[60:63], a[24:27]
buffer_load_dwordx4 v[124:127], v1, s[12:15], s34 offen offset:3072 sc1
s_add_u32 s33, s33, 0x8000
s_add_u32 s34, s34, 0x8000
v_mfma_f32_16x16x32_bf16 a[28:31], v[88:91], v[56:59], a[28:31]
v_mfma_f32_16x16x32_bf16 a[28:31], v[92:95], v[60:63], a[28:31]
s_waitcnt lgkmcnt(2)
v_mfma_f32_16x16x32_bf16 a[32:35], v[64:67], v[40:43], a[32:35]
ds_read_b128 v[56:59], v2 offset:40960
v_mfma_f32_16x16x32_bf16 a[32:35], v[68:71], v[44:47], a[32:35]
ds_read_b128 v[60:63], v3 offset:40960
v_mfma_f32_16x16x32_bf16 a[36:39], v[72:75], v[40:43], a[36:39]
v_mfma_f32_16x16x32_bf16 a[36:39], v[76:79], v[44:47], a[36:39]
v_mfma_f32_16x16x32_bf16 a[40:43], v[80:83], v[40:43], a[40:43]
s_add_u32 m0, s3, 0x16000
v_mfma_f32_16x16x32_bf16 a[40:43], v[84:87], v[44:47], a[40:43]
buffer_load_dwordx4 v8, s[20:23], s35 offen sc1 lds
s_add_u32 s35, s35, 0x10000
v_mfma_f32_16x16x32_bf16 a[44:47], v[88:91], v[40:43], a[44:47]
v_mfma_f32_16x16x32_bf16 a[44:47], v[92:95], v[44:47], a[44:47]
s_waitcnt lgkmcnt(2)
v_mfma_f32_16x16x32_bf16 a[48:51], v[64:67], v[48:51], a[48:51]
ds_read_b128 v[40:43], v2 offset:43008
v_mfma_f32_16x16x32_bf16 a[48:51], v[68:71], v[52:55], a[48:51]
ds_read_b128 v[44:47], v3 offset:43008
v_mfma_f32_16x16x32_bf16 a[52:55], v[72:75], v[48:51], a[52:55]
v_mfma_f32_16x16x32_bf16 a[52:55], v[76:79], v[52:55], a[52:55]
v_mfma_f32_16x16x32_bf16 a[56:59], v[80:83], v[48:51], a[56:59]
s_add_u32 m0, s3, 0x17000
v_mfma_f32_16x16x32_bf16 a[56:59], v[84:87], v[52:55], a[56:59]
buffer_load_dwordx4 v8, s[20:23], s35 offen sc1 lds
s_sub_u32 s35, s35, 196480
v_mfma_f32_16x16x32_bf16 a[60:63], v[88:91], v[48:51], a[60:63]
v_mfma_f32_16x16x32_bf16 a[60:63], v[92:95], v[52:55], a[60:63]
s_waitcnt lgkmcnt(2)
v_mfma_f32_16x16x32_bf16 a[64:67], v[64:67], v[56:59], a[64:67]
ds_read_b128 v[48:51], v2 offset:45056
v_mfma_f32_16x16x32_bf16 a[64:67], v[68:71], v[60:63], a[64:67]
ds_read_b128 v[52:55], v3 offset:45056
v_mfma_f32_16x16x32_bf16 a[68:71], v[72:75], v[56:59], a[68:71]
v_mfma_f32_16x16x32_bf16 a[68:71], v[76:79], v[60:63], a[68:71]
v_mfma_f32_16x16x32_bf16 a[72:75], v[80:83], v[56:59], a[72:75]
s_add_u32 m0, s3, 0x18000
v_mfma_f32_16x16x32_bf16 a[72:75], v[84:87], v[60:63], a[72:75]
buffer_load_dwordx4 v8, s[20:23], s35 offen sc1 lds
s_add_u32 s35, s35, 0x10000
v_mfma_f32_16x16x32_bf16 a[76:79], v[88:91], v[56:59], a[76:79]
v_mfma_f32_16x16x32_bf16 a[76:79], v[92:95], v[60:63], a[76:79]
s_waitcnt lgkmcnt(2)
v_mfma_f32_16x16x32_bf16 a[80:83], v[64:67], v[40:43], a[80:83]
ds_read_b128 v[56:59], v2 offset:47104
v_mfma_f32_16x16x32_bf16 a[80:83], v[68:71], v[44:47], a[80:83]
ds_read_b128 v[60:63], v3 offset:47104
v_mfma_f32_16x16x32_bf16 a[84:87], v[72:75], v[40:43], a[84:87]
v_mfma_f32_16x16x32_bf16 a[84:87], v[76:79], v[44:47], a[84:87]
v_mfma_f32_16x16x32_bf16 a[88:91], v[80:83], v[40:43], a[88:91]
v_mfma_f32_16x16x32_bf16 a[88:91], v[84:87], v[44:47], a[88:91]
v_mfma_f32_16x16x32_bf16 a[92:95], v[88:91], v[40:43], a[92:95]
v_mfma_f32_16x16x32_bf16 a[92:95], v[92:95], v[44:47], a[92:95]
s_waitcnt lgkmcnt(2)
v_mfma_f32_16x16x32_bf16 a[96:99], v[64:67], v[48:51], a[96:99]
ds_read_b128 v[40:43], v2 offset:49152
v_mfma_f32_16x16x32_bf16 a[96:99], v[68:71], v[52:55], a[96:99]
ds_read_b128 v[44:47], v3 offset:49152
v_mfma_f32_16x16x32_bf16 a[100:103], v[72:75], v[48:51], a[100:103]
v_mfma_f32_16x16x32_bf16 a[100:103], v[76:79], v[52:55], a[100:103]
v_mfma_f32_16x16x32_bf16 a[104:107], v[80:83], v[48:51], a[104:107]
v_mfma_f32_16x16x32_bf16 a[104:107], v[84:87], v[52:55], a[104:107]
v_mfma_f32_16x16x32_bf16 a[108:111], v[88:91], v[48:51], a[108:111]
v_mfma_f32_16x16x32_bf16 a[108:111], v[92:95], v[52:55], a[108:111]
s_waitcnt lgkmcnt(2)
v_mfma_f32_16x16x32_bf16 a[112:115], v[64:67], v[56:59], a[112:115]
ds_read_b128 v[48:51], v2 offset:51200
buffer_load_dwordx4 v[64:67], v1, s[12:15], s33 offen offset:0 sc1
v_mfma_f32_16x16x32_bf16 a[112:115], v[68:71], v[60:63], a[112:115]
ds_read_b128 v[52:55], v3 offset:51200
v_mfma_f32_16x16x32_bf16 a[116:119], v[72:75], v[56:59], a[116:119]
v_mfma_f32_16x16x32_bf16 a[116:119], v[76:79], v[60:63], a[116:119]
buffer_load_dwordx4 v[68:71], v1, s[12:15], s33 offen offset:1024 sc1
v_mfma_f32_16x16x32_bf16 a[120:123], v[80:83], v[56:59], a[120:123]
v_mfma_f32_16x16x32_bf16 a[120:123], v[84:87], v[60:63], a[120:123]
v_mfma_f32_16x16x32_bf16 a[124:127], v[88:91], v[56:59], a[124:127]
buffer_load_dwordx4 v[72:75], v1, s[12:15], s33 offen offset:2048 sc1
v_mfma_f32_16x16x32_bf16 a[124:127], v[92:95], v[60:63], a[124:127]
s_waitcnt vmcnt(12) lgkmcnt(2)
v_mfma_f32_16x16x32_bf16 a[0:3], v[96:99], v[40:43], a[0:3]
ds_read_b128 v[56:59], v2 offset:53248
v_mfma_f32_16x16x32_bf16 a[0:3], v[100:103], v[44:47], a[0:3]
ds_read_b128 v[60:63], v3 offset:53248
buffer_load_dwordx4 v[76:79], v1, s[12:15], s33 offen offset:3072 sc1
s_waitcnt vmcnt(11)
v_mfma_f32_16x16x32_bf16 a[4:7], v[104:107], v[40:43], a[4:7]
v_mfma_f32_16x16x32_bf16 a[4:7], v[108:111], v[44:47], a[4:7]
s_waitcnt vmcnt(9)
v_mfma_f32_16x16x32_bf16 a[8:11], v[112:115], v[40:43], a[8:11]
buffer_load_dwordx4 v[80:83], v1, s[12:15], s34 offen offset:0 sc1
v_mfma_f32_16x16x32_bf16 a[8:11], v[116:119], v[44:47], a[8:11]
s_waitcnt vmcnt(8)
v_mfma_f32_16x16x32_bf16 a[12:15], v[120:123], v[40:43], a[12:15]
v_mfma_f32_16x16x32_bf16 a[12:15], v[124:127], v[44:47], a[12:15]
buffer_load_dwordx4 v[84:87], v1, s[12:15], s34 offen offset:1024 sc1
s_waitcnt lgkmcnt(2)
v_mfma_f32_16x16x32_bf16 a[16:19], v[96:99], v[48:51], a[16:19]
ds_read_b128 v[40:43], v2 offset:55296
v_mfma_f32_16x16x32_bf16 a[16:19], v[100:103], v[52:55], a[16:19]
ds_read_b128 v[44:47], v3 offset:55296
v_mfma_f32_16x16x32_bf16 a[20:23], v[104:107], v[48:51], a[20:23]
buffer_load_dwordx4 v[88:91], v1, s[12:15], s34 offen offset:2048 sc1
v_mfma_f32_16x16x32_bf16 a[20:23], v[108:111], v[52:55], a[20:23]
v_mfma_f32_16x16x32_bf16 a[24:27], v[112:115], v[48:51], a[24:27]
v_mfma_f32_16x16x32_bf16 a[24:27], v[116:119], v[52:55], a[24:27]
buffer_load_dwordx4 v[92:95], v1, s[12:15], s34 offen offset:3072 sc1
s_add_u32 s33, s33, 0x8000
s_add_u32 s34, s34, 0x8000
v_mfma_f32_16x16x32_bf16 a[28:31], v[120:123], v[48:51], a[28:31]
v_mfma_f32_16x16x32_bf16 a[28:31], v[124:127], v[52:55], a[28:31]
s_waitcnt lgkmcnt(2)
v_mfma_f32_16x16x32_bf16 a[32:35], v[96:99], v[56:59], a[32:35]
ds_read_b128 v[48:51], v2 offset:57344
v_mfma_f32_16x16x32_bf16 a[32:35], v[100:103], v[60:63], a[32:35]
ds_read_b128 v[52:55], v3 offset:57344
v_mfma_f32_16x16x32_bf16 a[36:39], v[104:107], v[56:59], a[36:39]
v_mfma_f32_16x16x32_bf16 a[36:39], v[108:111], v[60:63], a[36:39]
v_mfma_f32_16x16x32_bf16 a[40:43], v[112:115], v[56:59], a[40:43]
s_add_u32 m0, s3, 0x19000
v_mfma_f32_16x16x32_bf16 a[40:43], v[116:119], v[60:63], a[40:43]
buffer_load_dwordx4 v8, s[20:23], s35 offen sc1 lds
s_add_u32 s35, s35, 0x10000
v_mfma_f32_16x16x32_bf16 a[44:47], v[120:123], v[56:59], a[44:47]
v_mfma_f32_16x16x32_bf16 a[44:47], v[124:127], v[60:63], a[44:47]
s_waitcnt lgkmcnt(2)
v_mfma_f32_16x16x32_bf16 a[48:51], v[96:99], v[40:43], a[48:51]
ds_read_b128 v[56:59], v2 offset:59392
v_mfma_f32_16x16x32_bf16 a[48:51], v[100:103], v[44:47], a[48:51]
ds_read_b128 v[60:63], v3 offset:59392
v_mfma_f32_16x16x32_bf16 a[52:55], v[104:107], v[40:43], a[52:55]
v_mfma_f32_16x16x32_bf16 a[52:55], v[108:111], v[44:47], a[52:55]
v_mfma_f32_16x16x32_bf16 a[56:59], v[112:115], v[40:43], a[56:59]
s_add_u32 m0, s3, 0x1a000
v_mfma_f32_16x16x32_bf16 a[56:59], v[116:119], v[44:47], a[56:59]
buffer_load_dwordx4 v8, s[20:23], s35 offen sc1 lds
s_add_u32 s35, s35, 0x10000
v_mfma_f32_16x16x32_bf16 a[60:63], v[120:123], v[40:43], a[60:63]
v_mfma_f32_16x16x32_bf16 a[60:63], v[124:127], v[44:47], a[60:63]
s_waitcnt lgkmcnt(2)
v_mfma_f32_16x16x32_bf16 a[64:67], v[96:99], v[48:51], a[64:67]
ds_read_b128 v[40:43], v2 offset:61440
v_mfma_f32_16x16x32_bf16 a[64:67], v[100:103], v[52:55], a[64:67]
ds_read_b128 v[44:47], v3 offset:61440
v_mfma_f32_16x16x32_bf16 a[68:71], v[104:107], v[48:51], a[68:71]
v_mfma_f32_16x16x32_bf16 a[68:71], v[108:111], v[52:55], a[68:71]
v_mfma_f32_16x16x32_bf16 a[72:75], v[112:115], v[48:51], a[72:75]
s_add_u32 m0, s3, 0x1b000
v_mfma_f32_16x16x32_bf16 a[72:75], v[116:119], v[52:55], a[72:75]
buffer_load_dwordx4 v8, s[20:23], s35 offen sc1 lds
s_sub_u32 s35, s35, 196480
v_mfma_f32_16x16x32_bf16 a[76:79], v[120:123], v[48:51], a[76:79]
v_mfma_f32_16x16x32_bf16 a[76:79], v[124:127], v[52:55], a[76:79]
s_waitcnt lgkmcnt(2)
v_mfma_f32_16x16x32_bf16 a[80:83], v[96:99], v[56:59], a[80:83]
ds_read_b128 v[48:51], v2 offset:63488
v_mfma_f32_16x16x32_bf16 a[80:83], v[100:103], v[60:63], a[80:83]
ds_read_b128 v[52:55], v3 offset:63488
v_mfma_f32_16x16x32_bf16 a[84:87], v[104:107], v[56:59], a[84:87]
v_mfma_f32_16x16x32_bf16 a[84:87], v[108:111], v[60:63], a[84:87]
v_mfma_f32_16x16x32_bf16 a[88:91], v[112:115], v[56:59], a[88:91]
v_mfma_f32_16x16x32_bf16 a[88:91], v[116:119], v[60:63], a[88:91]
v_mfma_f32_16x16x32_bf16 a[92:95], v[120:123], v[56:59], a[92:95]
v_mfma_f32_16x16x32_bf16 a[92:95], v[124:127], v[60:63], a[92:95]
s_waitcnt lgkmcnt(2)
v_mfma_f32_16x16x32_bf16 a[96:99], v[96:99], v[40:43], a[96:99]
ds_read_b128 v[56:59], v2 offset:0
v_mfma_f32_16x16x32_bf16 a[96:99], v[100:103], v[44:47], a[96:99]
ds_read_b128 v[60:63], v3 offset:0
v_mfma_f32_16x16x32_bf16 a[100:103], v[104:107], v[40:43], a[100:103]
v_mfma_f32_16x16x32_bf16 a[100:103], v[108:111], v[44:47], a[100:103]
v_mfma_f32_16x16x32_bf16 a[104:107], v[112:115], v[40:43], a[104:107]
v_mfma_f32_16x16x32_bf16 a[104:107], v[116:119], v[44:47], a[104:107]
v_mfma_f32_16x16x32_bf16 a[108:111], v[120:123], v[40:43], a[108:111]
v_mfma_f32_16x16x32_bf16 a[108:111], v[124:127], v[44:47], a[108:111]
s_waitcnt lgkmcnt(2)
v_mfma_f32_16x16x32_bf16 a[112:115], v[96:99], v[48:51], a[112:115]
ds_read_b128 v[40:43], v2 offset:2048
buffer_load_dwordx4 v[96:99], v1, s[12:15], s33 offen offset:0 sc1
v_mfma_f32_16x16x32_bf16 a[112:115], v[100:103], v[52:55], a[112:115]
ds_read_b128 v[44:47], v3 offset:2048
v_mfma_f32_16x16x32_bf16 a[116:119], v[104:107], v[48:51], a[116:119]
v_mfma_f32_16x16x32_bf16 a[116:119], v[108:111], v[52:55], a[116:119]
buffer_load_dwordx4 v[100:103], v1, s[12:15], s33 offen offset:1024 sc1
v_mfma_f32_16x16x32_bf16 a[120:123], v[112:115], v[48:51], a[120:123]
v_mfma_f32_16x16x32_bf16 a[120:123], v[116:119], v[52:55], a[120:123]
v_mfma_f32_16x16x32_bf16 a[124:127], v[120:123], v[48:51], a[124:127]
buffer_load_dwordx4 v[104:107], v1, s[12:15], s33 offen offset:2048 sc1
v_mfma_f32_16x16x32_bf16 a[124:127], v[124:127], v[52:55], a[124:127]
s_waitcnt vmcnt(12) lgkmcnt(2)
v_mfma_f32_16x16x32_bf16 a[128:131], v[64:67], v[56:59], a[128:131]
ds_read_b128 v[48:51], v2 offset:4096
v_mfma_f32_16x16x32_bf16 a[128:131], v[68:71], v[60:63], a[128:131]
ds_read_b128 v[52:55], v3 offset:4096
buffer_load_dwordx4 v[108:111], v1, s[12:15], s33 offen offset:3072 sc1
s_waitcnt vmcnt(11)
v_mfma_f32_16x16x32_bf16 a[132:135], v[72:75], v[56:59], a[132:135]
v_mfma_f32_16x16x32_bf16 a[132:135], v[76:79], v[60:63], a[132:135]
s_waitcnt vmcnt(9)
v_mfma_f32_16x16x32_bf16 a[136:139], v[80:83], v[56:59], a[136:139]
buffer_load_dwordx4 v[112:115], v1, s[12:15], s34 offen offset:0 sc1
v_mfma_f32_16x16x32_bf16 a[136:139], v[84:87], v[60:63], a[136:139]
s_waitcnt vmcnt(8)
v_mfma_f32_16x16x32_bf16 a[140:143], v[88:91], v[56:59], a[140:143]
v_mfma_f32_16x16x32_bf16 a[140:143], v[92:95], v[60:63], a[140:143]
buffer_load_dwordx4 v[116:119], v1, s[12:15], s34 offen offset:1024 sc1
s_waitcnt lgkmcnt(2)
v_mfma_f32_16x16x32_bf16 a[144:147], v[64:67], v[40:43], a[144:147]
ds_read_b128 v[56:59], v2 offset:6144
v_mfma_f32_16x16x32_bf16 a[144:147], v[68:71], v[44:47], a[144:147]
ds_read_b128 v[60:63], v3 offset:6144
v_mfma_f32_16x16x32_bf16 a[148:151], v[72:75], v[40:43], a[148:151]
buffer_load_dwordx4 v[120:123], v1, s[12:15], s34 offen offset:2048 sc1
v_mfma_f32_16x16x32_bf16 a[148:151], v[76:79], v[44:47], a[148:151]
v_mfma_f32_16x16x32_bf16 a[152:155], v[80:83], v[40:43], a[152:155]
v_mfma_f32_16x16x32_bf16 a[152:155], v[84:87], v[44:47], a[152:155]
buffer_load_dwordx4 v[124:127], v1, s[12:15], s34 offen offset:3072 sc1
s_add_u32 s33, s33, 0x8000
s_add_u32 s34, s34, 0x8000
v_mfma_f32_16x16x32_bf16 a[156:159], v[88:91], v[40:43], a[156:159]
v_mfma_f32_16x16x32_bf16 a[156:159], v[92:95], v[44:47], a[156:159]
s_waitcnt lgkmcnt(2)
v_mfma_f32_16x16x32_bf16 a[160:163], v[64:67], v[48:51], a[160:163]
ds_read_b128 v[40:43], v2 offset:8192
v_mfma_f32_16x16x32_bf16 a[160:163], v[68:71], v[52:55], a[160:163]
ds_read_b128 v[44:47], v3 offset:8192
v_mfma_f32_16x16x32_bf16 a[164:167], v[72:75], v[48:51], a[164:167]
v_mfma_f32_16x16x32_bf16 a[164:167], v[76:79], v[52:55], a[164:167]
v_mfma_f32_16x16x32_bf16 a[168:171], v[80:83], v[48:51], a[168:171]
s_add_u32 m0, s3, 0x1c000
v_mfma_f32_16x16x32_bf16 a[168:171], v[84:87], v[52:55], a[168:171]
buffer_load_dwordx4 v8, s[20:23], s35 offen sc1 lds
s_add_u32 s35, s35, 0x10000
v_mfma_f32_16x16x32_bf16 a[172:175], v[88:91], v[48:51], a[172:175]
v_mfma_f32_16x16x32_bf16 a[172:175], v[92:95], v[52:55], a[172:175]
s_waitcnt lgkmcnt(2)
v_mfma_f32_16x16x32_bf16 a[176:179], v[64:67], v[56:59], a[176:179]
ds_read_b128 v[48:51], v2 offset:10240
v_mfma_f32_16x16x32_bf16 a[176:179], v[68:71], v[60:63], a[176:179]
ds_read_b128 v[52:55], v3 offset:10240
v_mfma_f32_16x16x32_bf16 a[180:183], v[72:75], v[56:59], a[180:183]
v_mfma_f32_16x16x32_bf16 a[180:183], v[76:79], v[60:63], a[180:183]
v_mfma_f32_16x16x32_bf16 a[184:187], v[80:83], v[56:59], a[184:187]
s_add_u32 m0, s3, 0x1d000
v_mfma_f32_16x16x32_bf16 a[184:187], v[84:87], v[60:63], a[184:187]
buffer_load_dwordx4 v8, s[20:23], s35 offen sc1 lds
s_add_u32 s35, s35, 0x10000
v_mfma_f32_16x16x32_bf16 a[188:191], v[88:91], v[56:59], a[188:191]
v_mfma_f32_16x16x32_bf16 a[188:191], v[92:95], v[60:63], a[188:191]
s_waitcnt lgkmcnt(2)
v_mfma_f32_16x16x32_bf16 a[192:195], v[64:67], v[40:43], a[192:195]
ds_read_b128 v[56:59], v2 offset:12288
v_mfma_f32_16x16x32_bf16 a[192:195], v[68:71], v[44:47], a[192:195]
ds_read_b128 v[60:63], v3 offset:12288
v_mfma_f32_16x16x32_bf16 a[196:199], v[72:75], v[40:43], a[196:199]
v_mfma_f32_16x16x32_bf16 a[196:199], v[76:79], v[44:47], a[196:199]
v_mfma_f32_16x16x32_bf16 a[200:203], v[80:83], v[40:43], a[200:203]
v_mfma_f32_16x16x32_bf16 a[200:203], v[84:87], v[44:47], a[200:203]
v_mfma_f32_16x16x32_bf16 a[204:207], v[88:91], v[40:43], a[204:207]
v_mfma_f32_16x16x32_bf16 a[204:207], v[92:95], v[44:47], a[204:207]
s_waitcnt lgkmcnt(2)
v_mfma_f32_16x16x32_bf16 a[208:211], v[64:67], v[48:51], a[208:211]
ds_read_b128 v[40:43], v2 offset:14336
v_mfma_f32_16x16x32_bf16 a[208:211], v[68:71], v[52:55], a[208:211]
ds_read_b128 v[44:47], v3 offset:14336
v_mfma_f32_16x16x32_bf16 a[212:215], v[72:75], v[48:51], a[212:215]
v_mfma_f32_16x16x32_bf16 a[212:215], v[76:79], v[52:55], a[212:215]
v_mfma_f32_16x16x32_bf16 a[216:219], v[80:83], v[48:51], a[216:219]
v_mfma_f32_16x16x32_bf16 a[216:219], v[84:87], v[52:55], a[216:219]
v_mfma_f32_16x16x32_bf16 a[220:223], v[88:91], v[48:51], a[220:223]
v_mfma_f32_16x16x32_bf16 a[220:223], v[92:95], v[52:55], a[220:223]
s_waitcnt lgkmcnt(2)
v_mfma_f32_16x16x32_bf16 a[224:227], v[64:67], v[56:59], a[224:227]
ds_read_b128 v[48:51], v2 offset:16384
v_mfma_f32_16x16x32_bf16 a[224:227], v[68:71], v[60:63], a[224:227]
ds_read_b128 v[52:55], v3 offset:16384
v_mfma_f32_16x16x32_bf16 a[228:231], v[72:75], v[56:59], a[228:231]
v_mfma_f32_16x16x32_bf16 a[228:231], v[76:79], v[60:63], a[228:231]
v_mfma_f32_16x16x32_bf16 a[232:235], v[80:83], v[56:59], a[232:235]
v_mfma_f32_16x16x32_bf16 a[232:235], v[84:87], v[60:63], a[232:235]
v_mfma_f32_16x16x32_bf16 a[236:239], v[88:91], v[56:59], a[236:239]
v_mfma_f32_16x16x32_bf16 a[236:239], v[92:95], v[60:63], a[236:239]
s_waitcnt lgkmcnt(2)
v_mfma_f32_16x16x32_bf16 a[240:243], v[64:67], v[40:43], a[240:243]
ds_read_b128 v[56:59], v2 offset:18432
buffer_load_dwordx4 v[64:67], v1, s[12:15], s33 offen offset:0 sc1
v_mfma_f32_16x16x32_bf16 a[240:243], v[68:71], v[44:47], a[240:243]
ds_read_b128 v[60:63], v3 offset:18432
v_mfma_f32_16x16x32_bf16 a[244:247], v[72:75], v[40:43], a[244:247]
v_mfma_f32_16x16x32_bf16 a[244:247], v[76:79], v[44:47], a[244:247]
buffer_load_dwordx4 v[68:71], v1, s[12:15], s33 offen offset:1024 sc1
v_mfma_f32_16x16x32_bf16 a[248:251], v[80:83], v[40:43], a[248:251]
v_mfma_f32_16x16x32_bf16 a[248:251], v[84:87], v[44:47], a[248:251]
v_mfma_f32_16x16x32_bf16 a[252:255], v[88:91], v[40:43], a[252:255]
buffer_load_dwordx4 v[72:75], v1, s[12:15], s33 offen offset:2048 sc1
v_mfma_f32_16x16x32_bf16 a[252:255], v[92:95], v[44:47], a[252:255]
s_waitcnt vmcnt(11) lgkmcnt(2)
v_mfma_f32_16x16x32_bf16 a[128:131], v[96:99], v[48:51], a[128:131]
ds_read_b128 v[40:43], v2 offset:20480
v_mfma_f32_16x16x32_bf16 a[128:131], v[100:103], v[52:55], a[128:131]
ds_read_b128 v[44:47], v3 offset:20480
buffer_load_dwordx4 v[76:79], v1, s[12:15], s33 offen offset:3072 sc1
s_waitcnt vmcnt(10)
v_mfma_f32_16x16x32_bf16 a[132:135], v[104:107], v[48:51], a[132:135]
v_mfma_f32_16x16x32_bf16 a[132:135], v[108:111], v[52:55], a[132:135]
s_waitcnt vmcnt(8)
v_mfma_f32_16x16x32_bf16 a[136:139], v[112:115], v[48:51], a[136:139]
buffer_load_dwordx4 v[80:83], v1, s[12:15], s34 offen offset:0 sc1
v_mfma_f32_16x16x32_bf16 a[136:139], v[116:119], v[52:55], a[136:139]
s_waitcnt vmcnt(7)
v_mfma_f32_16x16x32_bf16 a[140:143], v[120:123], v[48:51], a[140:143]
v_mfma_f32_16x16x32_bf16 a[140:143], v[124:127], v[52:55], a[140:143]
buffer_load_dwordx4 v[84:87], v1, s[12:15], s34 offen offset:1024 sc1
s_waitcnt lgkmcnt(2)
v_mfma_f32_16x16x32_bf16 a[144:147], v[96:99], v[56:59], a[144:147]
ds_read_b128 v[48:51], v2 offset:22528
v_mfma_f32_16x16x32_bf16 a[144:147], v[100:103], v[60:63], a[144:147]
ds_read_b128 v[52:55], v3 offset:22528
v_mfma_f32_16x16x32_bf16 a[148:151], v[104:107], v[56:59], a[148:151]
buffer_load_dwordx4 v[88:91], v1, s[12:15], s34 offen offset:2048 sc1
v_mfma_f32_16x16x32_bf16 a[148:151], v[108:111], v[60:63], a[148:151]
v_mfma_f32_16x16x32_bf16 a[152:155], v[112:115], v[56:59], a[152:155]
v_mfma_f32_16x16x32_bf16 a[152:155], v[116:119], v[60:63], a[152:155]
buffer_load_dwordx4 v[92:95], v1, s[12:15], s34 offen offset:3072 sc1
s_add_u32 s33, s33, 0x8000
s_add_u32 s34, s34, 0x8000
v_mfma_f32_16x16x32_bf16 a[156:159], v[120:123], v[56:59], a[156:159]
v_mfma_f32_16x16x32_bf16 a[156:159], v[124:127], v[60:63], a[156:159]
s_waitcnt lgkmcnt(2)
v_mfma_f32_16x16x32_bf16 a[160:163], v[96:99], v[40:43], a[160:163]
ds_read_b128 v[56:59], v2 offset:24576
v_mfma_f32_16x16x32_bf16 a[160:163], v[100:103], v[44:47], a[160:163]
ds_read_b128 v[60:63], v3 offset:24576
v_mfma_f32_16x16x32_bf16 a[164:167], v[104:107], v[40:43], a[164:167]
v_mfma_f32_16x16x32_bf16 a[164:167], v[108:111], v[44:47], a[164:167]
v_mfma_f32_16x16x32_bf16 a[168:171], v[112:115], v[40:43], a[168:171]
s_add_u32 m0, s3, 0x1e000
v_mfma_f32_16x16x32_bf16 a[168:171], v[116:119], v[44:47], a[168:171]
buffer_load_dwordx4 v8, s[20:23], s35 offen sc1 lds
s_add_u32 s35, s35, 0x10000
v_mfma_f32_16x16x32_bf16 a[172:175], v[120:123], v[40:43], a[172:175]
v_mfma_f32_16x16x32_bf16 a[172:175], v[124:127], v[44:47], a[172:175]
s_waitcnt lgkmcnt(2)
v_mfma_f32_16x16x32_bf16 a[176:179], v[96:99], v[48:51], a[176:179]
ds_read_b128 v[40:43], v2 offset:26624
v_mfma_f32_16x16x32_bf16 a[176:179], v[100:103], v[52:55], a[176:179]
ds_read_b128 v[44:47], v3 offset:26624
v_mfma_f32_16x16x32_bf16 a[180:183], v[104:107], v[48:51], a[180:183]
v_mfma_f32_16x16x32_bf16 a[180:183], v[108:111], v[52:55], a[180:183]
v_mfma_f32_16x16x32_bf16 a[184:187], v[112:115], v[48:51], a[184:187]
s_add_u32 m0, s3, 0x1f000
v_mfma_f32_16x16x32_bf16 a[184:187], v[116:119], v[52:55], a[184:187]
buffer_load_dwordx4 v8, s[20:23], s35 offen sc1 lds
v_xor_b32 v8, 0x200, v8
v_mfma_f32_16x16x32_bf16 a[188:191], v[120:123], v[48:51], a[188:191]
v_mfma_f32_16x16x32_bf16 a[188:191], v[124:127], v[52:55], a[188:191]
s_waitcnt lgkmcnt(2)
v_mfma_f32_16x16x32_bf16 a[192:195], v[96:99], v[56:59], a[192:195]
ds_read_b128 v[48:51], v2 offset:28672
v_mfma_f32_16x16x32_bf16 a[192:195], v[100:103], v[60:63], a[192:195]
ds_read_b128 v[52:55], v3 offset:28672
v_mfma_f32_16x16x32_bf16 a[196:199], v[104:107], v[56:59], a[196:199]
v_mfma_f32_16x16x32_bf16 a[196:199], v[108:111], v[60:63], a[196:199]
v_mfma_f32_16x16x32_bf16 a[200:203], v[112:115], v[56:59], a[200:203]
v_mfma_f32_16x16x32_bf16 a[200:203], v[116:119], v[60:63], a[200:203]
v_mfma_f32_16x16x32_bf16 a[204:207], v[120:123], v[56:59], a[204:207]
v_mfma_f32_16x16x32_bf16 a[204:207], v[124:127], v[60:63], a[204:207]
s_waitcnt lgkmcnt(2)
v_mfma_f32_16x16x32_bf16 a[208:211], v[96:99], v[40:43], a[208:211]
ds_read_b128 v[56:59], v2 offset:30720
v_mfma_f32_16x16x32_bf16 a[208:211], v[100:103], v[44:47], a[208:211]
ds_read_b128 v[60:63], v3 offset:30720
v_mfma_f32_16x16x32_bf16 a[212:215], v[104:107], v[40:43], a[212:215]
v_mfma_f32_16x16x32_bf16 a[212:215], v[108:111], v[44:47], a[212:215]
v_mfma_f32_16x16x32_bf16 a[216:219], v[112:115], v[40:43], a[216:219]
v_mfma_f32_16x16x32_bf16 a[216:219], v[116:119], v[44:47], a[216:219]
v_mfma_f32_16x16x32_bf16 a[220:223], v[120:123], v[40:43], a[220:223]
v_mfma_f32_16x16x32_bf16 a[220:223], v[124:127], v[44:47], a[220:223]
s_waitcnt lgkmcnt(2)
v_mfma_f32_16x16x32_bf16 a[224:227], v[96:99], v[48:51], a[224:227]
ds_read_b128 v[40:43], v2 offset:32768
v_mfma_f32_16x16x32_bf16 a[224:227], v[100:103], v[52:55], a[224:227]
ds_read_b128 v[44:47], v3 offset:32768
v_mfma_f32_16x16x32_bf16 a[228:231], v[104:107], v[48:51], a[228:231]
v_mfma_f32_16x16x32_bf16 a[228:231], v[108:111], v[52:55], a[228:231]
v_mfma_f32_16x16x32_bf16 a[232:235], v[112:115], v[48:51], a[232:235]
v_mfma_f32_16x16x32_bf16 a[232:235], v[116:119], v[52:55], a[232:235]
v_mfma_f32_16x16x32_bf16 a[236:239], v[120:123], v[48:51], a[236:239]
v_mfma_f32_16x16x32_bf16 a[236:239], v[124:127], v[52:55], a[236:239]
s_waitcnt lgkmcnt(2)
v_mfma_f32_16x16x32_bf16 a[240:243], v[96:99], v[56:59], a[240:243]
ds_read_b128 v[48:51], v2 offset:34816
buffer_load_dwordx4 v[96:99], v1, s[12:15], s33 offen offset:0 sc1
v_mfma_f32_16x16x32_bf16 a[240:243], v[100:103], v[60:63], a[240:243]
ds_read_b128 v[52:55], v3 offset:34816
v_mfma_f32_16x16x32_bf16 a[244:247], v[104:107], v[56:59], a[244:247]
v_mfma_f32_16x16x32_bf16 a[244:247], v[108:111], v[60:63], a[244:247]
buffer_load_dwordx4 v[100:103], v1, s[12:15], s33 offen offset:1024 sc1
v_mfma_f32_16x16x32_bf16 a[248:251], v[112:115], v[56:59], a[248:251]
v_mfma_f32_16x16x32_bf16 a[248:251], v[116:119], v[60:63], a[248:251]
v_mfma_f32_16x16x32_bf16 a[252:255], v[120:123], v[56:59], a[252:255]
buffer_load_dwordx4 v[104:107], v1, s[12:15], s33 offen offset:2048 sc1
v_mfma_f32_16x16x32_bf16 a[252:255], v[124:127], v[60:63], a[252:255]
s_waitcnt vmcnt(11) lgkmcnt(2)
v_mfma_f32_16x16x32_bf16 a[128:131], v[64:67], v[40:43], a[128:131]
ds_read_b128 v[56:59], v2 offset:36864
v_mfma_f32_16x16x32_bf16 a[128:131], v[68:71], v[44:47], a[128:131]
ds_read_b128 v[60:63], v3 offset:36864
buffer_load_dwordx4 v[108:111], v1, s[12:15], s33 offen offset:3072 sc1
s_waitcnt vmcnt(10)
v_mfma_f32_16x16x32_bf16 a[132:135], v[72:75], v[40:43], a[132:135]
v_mfma_f32_16x16x32_bf16 a[132:135], v[76:79], v[44:47], a[132:135]
s_waitcnt vmcnt(8)
v_mfma_f32_16x16x32_bf16 a[136:139], v[80:83], v[40:43], a[136:139]
buffer_load_dwordx4 v[112:115], v1, s[12:15], s34 offen offset:0 sc1
v_mfma_f32_16x16x32_bf16 a[136:139], v[84:87], v[44:47], a[136:139]
s_waitcnt vmcnt(7)
v_mfma_f32_16x16x32_bf16 a[140:143], v[88:91], v[40:43], a[140:143]
v_mfma_f32_16x16x32_bf16 a[140:143], v[92:95], v[44:47], a[140:143]
buffer_load_dwordx4 v[116:119], v1, s[12:15], s34 offen offset:1024 sc1
s_waitcnt lgkmcnt(2)
v_mfma_f32_16x16x32_bf16 a[144:147], v[64:67], v[48:51], a[144:147]
ds_read_b128 v[40:43], v2 offset:38912
v_mfma_f32_16x16x32_bf16 a[144:147], v[68:71], v[52:55], a[144:147]
ds_read_b128 v[44:47], v3 offset:38912
v_mfma_f32_16x16x32_bf16 a[148:151], v[72:75], v[48:51], a[148:151]
buffer_load_dwordx4 v[120:123], v1, s[12:15], s34 offen offset:2048 sc1
v_mfma_f32_16x16x32_bf16 a[148:151], v[76:79], v[52:55], a[148:151]
v_mfma_f32_16x16x32_bf16 a[152:155], v[80:83], v[48:51], a[152:155]
v_mfma_f32_16x16x32_bf16 a[152:155], v[84:87], v[52:55], a[152:155]
buffer_load_dwordx4 v[124:127], v1, s[12:15], s34 offen offset:3072 sc1
s_add_u32 s33, s33, 0x8000
s_add_u32 s34, s34, 0x8000
v_mfma_f32_16x16x32_bf16 a[156:159], v[88:91], v[48:51], a[156:159]
v_mfma_f32_16x16x32_bf16 a[156:159], v[92:95], v[52:55], a[156:159]
s_waitcnt lgkmcnt(2)
v_mfma_f32_16x16x32_bf16 a[160:163], v[64:67], v[56:59], a[160:163]
ds_read_b128 v[48:51], v2 offset:40960
v_mfma_f32_16x16x32_bf16 a[160:163], v[68:71], v[60:63], a[160:163]
ds_read_b128 v[52:55], v3 offset:40960
v_mfma_f32_16x16x32_bf16 a[164:167], v[72:75], v[56:59], a[164:167]
v_mfma_f32_16x16x32_bf16 a[164:167], v[76:79], v[60:63], a[164:167]
v_mfma_f32_16x16x32_bf16 a[168:171], v[80:83], v[56:59], a[168:171]
v_mfma_f32_16x16x32_bf16 a[168:171], v[84:87], v[60:63], a[168:171]
v_mfma_f32_16x16x32_bf16 a[172:175], v[88:91], v[56:59], a[172:175]
v_mfma_f32_16x16x32_bf16 a[172:175], v[92:95], v[60:63], a[172:175]
s_waitcnt lgkmcnt(2)
v_mfma_f32_16x16x32_bf16 a[176:179], v[64:67], v[40:43], a[176:179]
ds_read_b128 v[56:59], v2 offset:43008
v_mfma_f32_16x16x32_bf16 a[176:179], v[68:71], v[44:47], a[176:179]
ds_read_b128 v[60:63], v3 offset:43008
v_mfma_f32_16x16x32_bf16 a[180:183], v[72:75], v[40:43], a[180:183]
v_mfma_f32_16x16x32_bf16 a[180:183], v[76:79], v[44:47], a[180:183]
v_mfma_f32_16x16x32_bf16 a[184:187], v[80:83], v[40:43], a[184:187]
v_mfma_f32_16x16x32_bf16 a[184:187], v[84:87], v[44:47], a[184:187]
v_mfma_f32_16x16x32_bf16 a[188:191], v[88:91], v[40:43], a[188:191]
v_mfma_f32_16x16x32_bf16 a[188:191], v[92:95], v[44:47], a[188:191]
s_waitcnt lgkmcnt(2)
v_mfma_f32_16x16x32_bf16 a[192:195], v[64:67], v[48:51], a[192:195]
ds_read_b128 v[40:43], v2 offset:45056
v_mfma_f32_16x16x32_bf16 a[192:195], v[68:71], v[52:55], a[192:195]
ds_read_b128 v[44:47], v3 offset:45056
v_mfma_f32_16x16x32_bf16 a[196:199], v[72:75], v[48:51], a[196:199]
v_mfma_f32_16x16x32_bf16 a[196:199], v[76:79], v[52:55], a[196:199]
v_mfma_f32_16x16x32_bf16 a[200:203], v[80:83], v[48:51], a[200:203]
v_mfma_f32_16x16x32_bf16 a[200:203], v[84:87], v[52:55], a[200:203]
v_mfma_f32_16x16x32_bf16 a[204:207], v[88:91], v[48:51], a[204:207]
v_mfma_f32_16x16x32_bf16 a[204:207], v[92:95], v[52:55], a[204:207]
s_waitcnt lgkmcnt(2)
v_mfma_f32_16x16x32_bf16 a[208:211], v[64:67], v[56:59], a[208:211]
ds_read_b128 v[48:51], v2 offset:47104
v_mfma_f32_16x16x32_bf16 a[208:211], v[68:71], v[60:63], a[208:211]
ds_read_b128 v[52:55], v3 offset:47104
v_mfma_f32_16x16x32_bf16 a[212:215], v[72:75], v[56:59], a[212:215]
v_mfma_f32_16x16x32_bf16 a[212:215], v[76:79], v[60:63], a[212:215]
v_mfma_f32_16x16x32_bf16 a[216:219], v[80:83], v[56:59], a[216:219]
v_mfma_f32_16x16x32_bf16 a[216:219], v[84:87], v[60:63], a[216:219]
v_mfma_f32_16x16x32_bf16 a[220:223], v[88:91], v[56:59], a[220:223]
v_mfma_f32_16x16x32_bf16 a[220:223], v[92:95], v[60:63], a[220:223]
s_waitcnt lgkmcnt(2)
v_mfma_f32_16x16x32_bf16 a[224:227], v[64:67], v[40:43], a[224:227]
ds_read_b128 v[56:59], v2 offset:49152
v_mfma_f32_16x16x32_bf16 a[224:227], v[68:71], v[44:47], a[224:227]
ds_read_b128 v[60:63], v3 offset:49152
v_mfma_f32_16x16x32_bf16 a[228:231], v[72:75], v[40:43], a[228:231]
v_mfma_f32_16x16x32_bf16 a[228:231], v[76:79], v[44:47], a[228:231]
v_mfma_f32_16x16x32_bf16 a[232:235], v[80:83], v[40:43], a[232:235]
v_mfma_f32_16x16x32_bf16 a[232:235], v[84:87], v[44:47], a[232:235]
v_mfma_f32_16x16x32_bf16 a[236:239], v[88:91], v[40:43], a[236:239]
v_mfma_f32_16x16x32_bf16 a[236:239], v[92:95], v[44:47], a[236:239]
s_waitcnt lgkmcnt(2)
v_mfma_f32_16x16x32_bf16 a[240:243], v[64:67], v[48:51], a[240:243]
ds_read_b128 v[40:43], v2 offset:51200
buffer_load_dwordx4 v[64:67], v1, s[12:15], s33 offen offset:0 sc1
v_mfma_f32_16x16x32_bf16 a[240:243], v[68:71], v[52:55], a[240:243]
ds_read_b128 v[44:47], v3 offset:51200
v_mfma_f32_16x16x32_bf16 a[244:247], v[72:75], v[48:51], a[244:247]
v_mfma_f32_16x16x32_bf16 a[244:247], v[76:79], v[52:55], a[244:247]
buffer_load_dwordx4 v[68:71], v1, s[12:15], s33 offen offset:1024 sc1
v_mfma_f32_16x16x32_bf16 a[248:251], v[80:83], v[48:51], a[248:251]
v_mfma_f32_16x16x32_bf16 a[248:251], v[84:87], v[52:55], a[248:251]
v_mfma_f32_16x16x32_bf16 a[252:255], v[88:91], v[48:51], a[252:255]
buffer_load_dwordx4 v[72:75], v1, s[12:15], s33 offen offset:2048 sc1
v_mfma_f32_16x16x32_bf16 a[252:255], v[92:95], v[52:55], a[252:255]
s_waitcnt vmcnt(9) lgkmcnt(2)
v_mfma_f32_16x16x32_bf16 a[128:131], v[96:99], v[56:59], a[128:131]
ds_read_b128 v[48:51], v2 offset:53248
v_mfma_f32_16x16x32_bf16 a[128:131], v[100:103], v[60:63], a[128:131]
ds_read_b128 v[52:55], v3 offset:53248
buffer_load_dwordx4 v[76:79], v1, s[12:15], s33 offen offset:3072 sc1
s_waitcnt vmcnt(8)
v_mfma_f32_16x16x32_bf16 a[132:135], v[104:107], v[56:59], a[132:135]
v_mfma_f32_16x16x32_bf16 a[132:135], v[108:111], v[60:63], a[132:135]
s_waitcnt vmcnt(6)
v_mfma_f32_16x16x32_bf16 a[136:139], v[112:115], v[56:59], a[136:139]
buffer_load_dwordx4 v[80:83], v1, s[12:15], s34 offen offset:0 sc1
v_mfma_f32_16x16x32_bf16 a[136:139], v[116:119], v[60:63], a[136:139]
s_waitcnt vmcnt(5)
v_mfma_f32_16x16x32_bf16 a[140:143], v[120:123], v[56:59], a[140:143]
v_mfma_f32_16x16x32_bf16 a[140:143], v[124:127], v[60:63], a[140:143]
buffer_load_dwordx4 v[84:87], v1, s[12:15], s34 offen offset:1024 sc1
s_waitcnt lgkmcnt(2)
v_mfma_f32_16x16x32_bf16 a[144:147], v[96:99], v[40:43], a[144:147]
ds_read_b128 v[56:59], v2 offset:55296
v_mfma_f32_16x16x32_bf16 a[144:147], v[100:103], v[44:47], a[144:147]
ds_read_b128 v[60:63], v3 offset:55296
v_mfma_f32_16x16x32_bf16 a[148:151], v[104:107], v[40:43], a[148:151]
buffer_load_dwordx4 v[88:91], v1, s[12:15], s34 offen offset:2048 sc1
v_mfma_f32_16x16x32_bf16 a[148:151], v[108:111], v[44:47], a[148:151]
v_mfma_f32_16x16x32_bf16 a[152:155], v[112:115], v[40:43], a[152:155]
v_mfma_f32_16x16x32_bf16 a[152:155], v[116:119], v[44:47], a[152:155]
buffer_load_dwordx4 v[92:95], v1, s[12:15], s34 offen offset:3072 sc1
s_add_u32 s33, s33, 0x8000
s_add_u32 s34, s34, 0x8000
v_mfma_f32_16x16x32_bf16 a[156:159], v[120:123], v[40:43], a[156:159]
v_mfma_f32_16x16x32_bf16 a[156:159], v[124:127], v[44:47], a[156:159]
s_waitcnt lgkmcnt(2)
v_mfma_f32_16x16x32_bf16 a[160:163], v[96:99], v[48:51], a[160:163]
ds_read_b128 v[40:43], v2 offset:57344
v_mfma_f32_16x16x32_bf16 a[160:163], v[100:103], v[52:55], a[160:163]
ds_read_b128 v[44:47], v3 offset:57344
v_mfma_f32_16x16x32_bf16 a[164:167], v[104:107], v[48:51], a[164:167]
v_mfma_f32_16x16x32_bf16 a[164:167], v[108:111], v[52:55], a[164:167]
v_mfma_f32_16x16x32_bf16 a[168:171], v[112:115], v[48:51], a[168:171]
v_mfma_f32_16x16x32_bf16 a[168:171], v[116:119], v[52:55], a[168:171]
v_mfma_f32_16x16x32_bf16 a[172:175], v[120:123], v[48:51], a[172:175]
v_mfma_f32_16x16x32_bf16 a[172:175], v[124:127], v[52:55], a[172:175]
s_waitcnt lgkmcnt(2)
v_mfma_f32_16x16x32_bf16 a[176:179], v[96:99], v[56:59], a[176:179]
ds_read_b128 v[48:51], v2 offset:59392
v_mfma_f32_16x16x32_bf16 a[176:179], v[100:103], v[60:63], a[176:179]
ds_read_b128 v[52:55], v3 offset:59392
v_mfma_f32_16x16x32_bf16 a[180:183], v[104:107], v[56:59], a[180:183]
v_mfma_f32_16x16x32_bf16 a[180:183], v[108:111], v[60:63], a[180:183]
v_mfma_f32_16x16x32_bf16 a[184:187], v[112:115], v[56:59], a[184:187]
v_mfma_f32_16x16x32_bf16 a[184:187], v[116:119], v[60:63], a[184:187]
v_mfma_f32_16x16x32_bf16 a[188:191], v[120:123], v[56:59], a[188:191]
v_mfma_f32_16x16x32_bf16 a[188:191], v[124:127], v[60:63], a[188:191]
s_waitcnt lgkmcnt(2)
v_mfma_f32_16x16x32_bf16 a[192:195], v[96:99], v[40:43], a[192:195]
ds_read_b128 v[56:59], v2 offset:61440
v_mfma_f32_16x16x32_bf16 a[192:195], v[100:103], v[44:47], a[192:195]
ds_read_b128 v[60:63], v3 offset:61440
v_mfma_f32_16x16x32_bf16 a[196:199], v[104:107], v[40:43], a[196:199]
v_mfma_f32_16x16x32_bf16 a[196:199], v[108:111], v[44:47], a[196:199]
v_mfma_f32_16x16x32_bf16 a[200:203], v[112:115], v[40:43], a[200:203]
v_mfma_f32_16x16x32_bf16 a[200:203], v[116:119], v[44:47], a[200:203]
v_mfma_f32_16x16x32_bf16 a[204:207], v[120:123], v[40:43], a[204:207]
v_mfma_f32_16x16x32_bf16 a[204:207], v[124:127], v[44:47], a[204:207]
s_waitcnt lgkmcnt(2)
v_mfma_f32_16x16x32_bf16 a[208:211], v[96:99], v[48:51], a[208:211]
ds_read_b128 v[40:43], v2 offset:63488
v_mfma_f32_16x16x32_bf16 a[208:211], v[100:103], v[52:55], a[208:211]
ds_read_b128 v[44:47], v3 offset:63488
v_mfma_f32_16x16x32_bf16 a[212:215], v[104:107], v[48:51], a[212:215]
v_mfma_f32_16x16x32_bf16 a[212:215], v[108:111], v[52:55], a[212:215]
v_mfma_f32_16x16x32_bf16 a[216:219], v[112:115], v[48:51], a[216:219]
v_mfma_f32_16x16x32_bf16 a[216:219], v[116:119], v[52:55], a[216:219]
v_mfma_f32_16x16x32_bf16 a[220:223], v[120:123], v[48:51], a[220:223]
v_mfma_f32_16x16x32_bf16 a[220:223], v[124:127], v[52:55], a[220:223]
s_waitcnt lgkmcnt(2)
v_mfma_f32_16x16x32_bf16 a[224:227], v[96:99], v[56:59], a[224:227]
v_mfma_f32_16x16x32_bf16 a[224:227], v[100:103], v[60:63], a[224:227]
v_mfma_f32_16x16x32_bf16 a[228:231], v[104:107], v[56:59], a[228:231]
v_mfma_f32_16x16x32_bf16 a[228:231], v[108:111], v[60:63], a[228:231]
v_mfma_f32_16x16x32_bf16 a[232:235], v[112:115], v[56:59], a[232:235]
v_mfma_f32_16x16x32_bf16 a[232:235], v[116:119], v[60:63], a[232:235]
v_mfma_f32_16x16x32_bf16 a[236:239], v[120:123], v[56:59], a[236:239]
v_mfma_f32_16x16x32_bf16 a[236:239], v[124:127], v[60:63], a[236:239]
s_waitcnt lgkmcnt(0)
s_barrier
v_xor_b32 v2, 0x10000, v2
v_xor_b32 v3, 0x10000, v3
v_mfma_f32_16x16x32_bf16 a[240:243], v[96:99], v[40:43], a[240:243]
ds_read_b128 v[48:51], v2 offset:0
buffer_load_dwordx4 v[96:99], v1, s[12:15], s33 offen offset:0 sc1
v_mfma_f32_16x16x32_bf16 a[240:243], v[100:103], v[44:47], a[240:243]
ds_read_b128 v[52:55], v3 offset:0
v_mfma_f32_16x16x32_bf16 a[244:247], v[104:107], v[40:43], a[244:247]
ds_read_b128 v[56:59], v2 offset:2048
v_mfma_f32_16x16x32_bf16 a[244:247], v[108:111], v[44:47], a[244:247]
ds_read_b128 v[60:63], v3 offset:2048
buffer_load_dwordx4 v[100:103], v1, s[12:15], s33 offen offset:1024 sc1
v_mfma_f32_16x16x32_bf16 a[248:251], v[112:115], v[40:43], a[248:251]
v_mfma_f32_16x16x32_bf16 a[248:251], v[116:119], v[44:47], a[248:251]
v_mfma_f32_16x16x32_bf16 a[252:255], v[120:123], v[40:43], a[252:255]
buffer_load_dwordx4 v[104:107], v1, s[12:15], s33 offen offset:2048 sc1
v_mfma_f32_16x16x32_bf16 a[252:255], v[124:127], v[44:47], a[252:255]
s_waitcnt vmcnt(9) lgkmcnt(2)
v_mfma_f32_16x16x32_bf16 a[0:3], v[64:67], v[48:51], a[0:3]
ds_read_b128 v[40:43], v2 offset:4096
v_mfma_f32_16x16x32_bf16 a[0:3], v[68:71], v[52:55], a[0:3]
ds_read_b128 v[44:47], v3 offset:4096
buffer_load_dwordx4 v[108:111], v1, s[12:15], s33 offen offset:3072 sc1
s_waitcnt vmcnt(8)
v_mfma_f32_16x16x32_bf16 a[4:7], v[72:75], v[48:51], a[4:7]
v_mfma_f32_16x16x32_bf16 a[4:7], v[76:79], v[52:55], a[4:7]
s_waitcnt vmcnt(6)
v_mfma_f32_16x16x32_bf16 a[8:11], v[80:83], v[48:51], a[8:11]
buffer_load_dwordx4 v[112:115], v1, s[12:15], s34 offen offset:0 sc1
v_mfma_f32_16x16x32_bf16 a[8:11], v[84:87], v[52:55], a[8:11]
s_waitcnt vmcnt(5)
v_mfma_f32_16x16x32_bf16 a[12:15], v[88:91], v[48:51], a[12:15]
v_mfma_f32_16x16x32_bf16 a[12:15], v[92:95], v[52:55], a[12:15]
buffer_load_dwordx4 v[116:119], v1, s[12:15], s34 offen offset:1024 sc1
s_waitcnt lgkmcnt(2)
v_mfma_f32_16x16x32_bf16 a[16:19], v[64:67], v[56:59], a[16:19]
ds_read_b128 v[48:51], v2 offset:6144
v_mfma_f32_16x16x32_bf16 a[16:19], v[68:71], v[60:63], a[16:19]
ds_read_b128 v[52:55], v3 offset:6144
v_mfma_f32_16x16x32_bf16 a[20:23], v[72:75], v[56:59], a[20:23]
buffer_load_dwordx4 v[120:123], v1, s[12:15], s34 offen offset:2048 sc1
v_mfma_f32_16x16x32_bf16 a[20:23], v[76:79], v[60:63], a[20:23]
v_lshlrev_b32 v20, 2, v1
s_add_u32 s5, s7, L_cs4-standalone__cross_network_dcn__recsys_kernel
buffer_load_dword v22, v20, s[28:31], s5 offen
v_mfma_f32_16x16x32_bf16 a[24:27], v[80:83], v[56:59], a[24:27]
v_mfma_f32_16x16x32_bf16 a[24:27], v[84:87], v[60:63], a[24:27]
buffer_load_dwordx4 v[124:127], v1, s[12:15], s34 offen offset:3072 sc1
s_add_u32 s33, s33, 0x8000
s_add_u32 s34, s34, 0x8000
v_mfma_f32_16x16x32_bf16 a[28:31], v[88:91], v[56:59], a[28:31]
v_mfma_f32_16x16x32_bf16 a[28:31], v[92:95], v[60:63], a[28:31]
s_waitcnt lgkmcnt(2)
v_mfma_f32_16x16x32_bf16 a[32:35], v[64:67], v[40:43], a[32:35]
ds_read_b128 v[56:59], v2 offset:8192
v_mfma_f32_16x16x32_bf16 a[32:35], v[68:71], v[44:47], a[32:35]
ds_read_b128 v[60:63], v3 offset:8192
v_mfma_f32_16x16x32_bf16 a[36:39], v[72:75], v[40:43], a[36:39]
v_mfma_f32_16x16x32_bf16 a[36:39], v[76:79], v[44:47], a[36:39]
v_mfma_f32_16x16x32_bf16 a[40:43], v[80:83], v[40:43], a[40:43]
v_mfma_f32_16x16x32_bf16 a[40:43], v[84:87], v[44:47], a[40:43]
v_mfma_f32_16x16x32_bf16 a[44:47], v[88:91], v[40:43], a[44:47]
v_mfma_f32_16x16x32_bf16 a[44:47], v[92:95], v[44:47], a[44:47]
s_waitcnt lgkmcnt(2)
v_mfma_f32_16x16x32_bf16 a[48:51], v[64:67], v[48:51], a[48:51]
ds_read_b128 v[40:43], v2 offset:10240
v_mfma_f32_16x16x32_bf16 a[48:51], v[68:71], v[52:55], a[48:51]
ds_read_b128 v[44:47], v3 offset:10240
v_mfma_f32_16x16x32_bf16 a[52:55], v[72:75], v[48:51], a[52:55]
v_mfma_f32_16x16x32_bf16 a[52:55], v[76:79], v[52:55], a[52:55]
v_mfma_f32_16x16x32_bf16 a[56:59], v[80:83], v[48:51], a[56:59]
v_mfma_f32_16x16x32_bf16 a[56:59], v[84:87], v[52:55], a[56:59]
v_mfma_f32_16x16x32_bf16 a[60:63], v[88:91], v[48:51], a[60:63]
v_mfma_f32_16x16x32_bf16 a[60:63], v[92:95], v[52:55], a[60:63]
s_waitcnt lgkmcnt(2)
v_mfma_f32_16x16x32_bf16 a[64:67], v[64:67], v[56:59], a[64:67]
ds_read_b128 v[48:51], v2 offset:12288
v_mfma_f32_16x16x32_bf16 a[64:67], v[68:71], v[60:63], a[64:67]
ds_read_b128 v[52:55], v3 offset:12288
v_mfma_f32_16x16x32_bf16 a[68:71], v[72:75], v[56:59], a[68:71]
v_mfma_f32_16x16x32_bf16 a[68:71], v[76:79], v[60:63], a[68:71]
v_mfma_f32_16x16x32_bf16 a[72:75], v[80:83], v[56:59], a[72:75]
v_mfma_f32_16x16x32_bf16 a[72:75], v[84:87], v[60:63], a[72:75]
v_mfma_f32_16x16x32_bf16 a[76:79], v[88:91], v[56:59], a[76:79]
v_mfma_f32_16x16x32_bf16 a[76:79], v[92:95], v[60:63], a[76:79]
s_waitcnt lgkmcnt(2)
v_mfma_f32_16x16x32_bf16 a[80:83], v[64:67], v[40:43], a[80:83]
ds_read_b128 v[56:59], v2 offset:14336
v_mfma_f32_16x16x32_bf16 a[80:83], v[68:71], v[44:47], a[80:83]
ds_read_b128 v[60:63], v3 offset:14336
v_mfma_f32_16x16x32_bf16 a[84:87], v[72:75], v[40:43], a[84:87]
v_mfma_f32_16x16x32_bf16 a[84:87], v[76:79], v[44:47], a[84:87]
v_mfma_f32_16x16x32_bf16 a[88:91], v[80:83], v[40:43], a[88:91]
v_mfma_f32_16x16x32_bf16 a[88:91], v[84:87], v[44:47], a[88:91]
v_mfma_f32_16x16x32_bf16 a[92:95], v[88:91], v[40:43], a[92:95]
v_mfma_f32_16x16x32_bf16 a[92:95], v[92:95], v[44:47], a[92:95]
s_waitcnt lgkmcnt(2)
v_mfma_f32_16x16x32_bf16 a[96:99], v[64:67], v[48:51], a[96:99]
ds_read_b128 v[40:43], v2 offset:16384
v_mfma_f32_16x16x32_bf16 a[96:99], v[68:71], v[52:55], a[96:99]
ds_read_b128 v[44:47], v3 offset:16384
v_mfma_f32_16x16x32_bf16 a[100:103], v[72:75], v[48:51], a[100:103]
v_mfma_f32_16x16x32_bf16 a[100:103], v[76:79], v[52:55], a[100:103]
v_mfma_f32_16x16x32_bf16 a[104:107], v[80:83], v[48:51], a[104:107]
v_mfma_f32_16x16x32_bf16 a[104:107], v[84:87], v[52:55], a[104:107]
v_mfma_f32_16x16x32_bf16 a[108:111], v[88:91], v[48:51], a[108:111]
v_mfma_f32_16x16x32_bf16 a[108:111], v[92:95], v[52:55], a[108:111]
s_waitcnt lgkmcnt(2)
v_mfma_f32_16x16x32_bf16 a[112:115], v[64:67], v[56:59], a[112:115]
ds_read_b128 v[48:51], v2 offset:18432
buffer_load_dwordx4 v[64:67], v1, s[12:15], s33 offen offset:0 sc1
v_mfma_f32_16x16x32_bf16 a[112:115], v[68:71], v[60:63], a[112:115]
ds_read_b128 v[52:55], v3 offset:18432
v_mfma_f32_16x16x32_bf16 a[116:119], v[72:75], v[56:59], a[116:119]
v_mfma_f32_16x16x32_bf16 a[116:119], v[76:79], v[60:63], a[116:119]
buffer_load_dwordx4 v[68:71], v1, s[12:15], s33 offen offset:1024 sc1
v_mfma_f32_16x16x32_bf16 a[120:123], v[80:83], v[56:59], a[120:123]
v_mfma_f32_16x16x32_bf16 a[120:123], v[84:87], v[60:63], a[120:123]
v_mfma_f32_16x16x32_bf16 a[124:127], v[88:91], v[56:59], a[124:127]
buffer_load_dwordx4 v[72:75], v1, s[12:15], s33 offen offset:2048 sc1
v_mfma_f32_16x16x32_bf16 a[124:127], v[92:95], v[60:63], a[124:127]
s_waitcnt vmcnt(10) lgkmcnt(2)
v_mfma_f32_16x16x32_bf16 a[0:3], v[96:99], v[40:43], a[0:3]
ds_read_b128 v[56:59], v2 offset:20480
v_mfma_f32_16x16x32_bf16 a[0:3], v[100:103], v[44:47], a[0:3]
ds_read_b128 v[60:63], v3 offset:20480
buffer_load_dwordx4 v[76:79], v1, s[12:15], s33 offen offset:3072 sc1
s_waitcnt vmcnt(9)
v_mfma_f32_16x16x32_bf16 a[4:7], v[104:107], v[40:43], a[4:7]
v_mfma_f32_16x16x32_bf16 a[4:7], v[108:111], v[44:47], a[4:7]
v_lshlrev_b32 v20, 2, v1
s_add_u32 s5, s43, 0x280000
buffer_load_dword v21, v20, s[12:15], s5 offen sc1
s_waitcnt vmcnt(8)
v_mfma_f32_16x16x32_bf16 a[8:11], v[112:115], v[40:43], a[8:11]
buffer_load_dwordx4 v[80:83], v1, s[12:15], s34 offen offset:0 sc1
v_mfma_f32_16x16x32_bf16 a[8:11], v[116:119], v[44:47], a[8:11]
s_waitcnt vmcnt(6)
v_mfma_f32_16x16x32_bf16 a[12:15], v[120:123], v[40:43], a[12:15]
v_mfma_f32_16x16x32_bf16 a[12:15], v[124:127], v[44:47], a[12:15]
buffer_load_dwordx4 v[84:87], v1, s[12:15], s34 offen offset:1024 sc1
s_waitcnt lgkmcnt(2)
v_mfma_f32_16x16x32_bf16 a[16:19], v[96:99], v[48:51], a[16:19]
ds_read_b128 v[40:43], v2 offset:22528
v_mfma_f32_16x16x32_bf16 a[16:19], v[100:103], v[52:55], a[16:19]
ds_read_b128 v[44:47], v3 offset:22528
v_mfma_f32_16x16x32_bf16 a[20:23], v[104:107], v[48:51], a[20:23]
buffer_load_dwordx4 v[88:91], v1, s[12:15], s34 offen offset:2048 sc1
v_mfma_f32_16x16x32_bf16 a[20:23], v[108:111], v[52:55], a[20:23]
v_mfma_f32_16x16x32_bf16 a[24:27], v[112:115], v[48:51], a[24:27]
v_mfma_f32_16x16x32_bf16 a[24:27], v[116:119], v[52:55], a[24:27]
buffer_load_dwordx4 v[92:95], v1, s[12:15], s34 offen offset:3072 sc1
s_add_u32 s33, s33, 0x8000
s_add_u32 s34, s34, 0x8000
v_mfma_f32_16x16x32_bf16 a[28:31], v[120:123], v[48:51], a[28:31]
v_mfma_f32_16x16x32_bf16 a[28:31], v[124:127], v[52:55], a[28:31]
s_waitcnt lgkmcnt(2)
v_mfma_f32_16x16x32_bf16 a[32:35], v[96:99], v[56:59], a[32:35]
ds_read_b128 v[48:51], v2 offset:24576
v_mfma_f32_16x16x32_bf16 a[32:35], v[100:103], v[60:63], a[32:35]
ds_read_b128 v[52:55], v3 offset:24576
v_mfma_f32_16x16x32_bf16 a[36:39], v[104:107], v[56:59], a[36:39]
v_mfma_f32_16x16x32_bf16 a[36:39], v[108:111], v[60:63], a[36:39]
v_mfma_f32_16x16x32_bf16 a[40:43], v[112:115], v[56:59], a[40:43]
v_mfma_f32_16x16x32_bf16 a[40:43], v[116:119], v[60:63], a[40:43]
v_mfma_f32_16x16x32_bf16 a[44:47], v[120:123], v[56:59], a[44:47]
v_mfma_f32_16x16x32_bf16 a[44:47], v[124:127], v[60:63], a[44:47]
s_waitcnt lgkmcnt(2)
v_mfma_f32_16x16x32_bf16 a[48:51], v[96:99], v[40:43], a[48:51]
ds_read_b128 v[56:59], v2 offset:26624
v_mfma_f32_16x16x32_bf16 a[48:51], v[100:103], v[44:47], a[48:51]
ds_read_b128 v[60:63], v3 offset:26624
v_mfma_f32_16x16x32_bf16 a[52:55], v[104:107], v[40:43], a[52:55]
v_mfma_f32_16x16x32_bf16 a[52:55], v[108:111], v[44:47], a[52:55]
v_mfma_f32_16x16x32_bf16 a[56:59], v[112:115], v[40:43], a[56:59]
v_mfma_f32_16x16x32_bf16 a[56:59], v[116:119], v[44:47], a[56:59]
v_mfma_f32_16x16x32_bf16 a[60:63], v[120:123], v[40:43], a[60:63]
v_mfma_f32_16x16x32_bf16 a[60:63], v[124:127], v[44:47], a[60:63]
s_waitcnt lgkmcnt(2)
v_mfma_f32_16x16x32_bf16 a[64:67], v[96:99], v[48:51], a[64:67]
ds_read_b128 v[40:43], v2 offset:28672
v_mfma_f32_16x16x32_bf16 a[64:67], v[100:103], v[52:55], a[64:67]
ds_read_b128 v[44:47], v3 offset:28672
v_mfma_f32_16x16x32_bf16 a[68:71], v[104:107], v[48:51], a[68:71]
v_mfma_f32_16x16x32_bf16 a[68:71], v[108:111], v[52:55], a[68:71]
v_mfma_f32_16x16x32_bf16 a[72:75], v[112:115], v[48:51], a[72:75]
v_mfma_f32_16x16x32_bf16 a[72:75], v[116:119], v[52:55], a[72:75]
v_mfma_f32_16x16x32_bf16 a[76:79], v[120:123], v[48:51], a[76:79]
v_mfma_f32_16x16x32_bf16 a[76:79], v[124:127], v[52:55], a[76:79]
s_waitcnt lgkmcnt(2)
v_mfma_f32_16x16x32_bf16 a[80:83], v[96:99], v[56:59], a[80:83]
ds_read_b128 v[48:51], v2 offset:30720
v_mfma_f32_16x16x32_bf16 a[80:83], v[100:103], v[60:63], a[80:83]
ds_read_b128 v[52:55], v3 offset:30720
v_mfma_f32_16x16x32_bf16 a[84:87], v[104:107], v[56:59], a[84:87]
v_mfma_f32_16x16x32_bf16 a[84:87], v[108:111], v[60:63], a[84:87]
v_mfma_f32_16x16x32_bf16 a[88:91], v[112:115], v[56:59], a[88:91]
v_mfma_f32_16x16x32_bf16 a[88:91], v[116:119], v[60:63], a[88:91]
v_mfma_f32_16x16x32_bf16 a[92:95], v[120:123], v[56:59], a[92:95]
v_mfma_f32_16x16x32_bf16 a[92:95], v[124:127], v[60:63], a[92:95]
s_waitcnt lgkmcnt(2)
v_mfma_f32_16x16x32_bf16 a[96:99], v[96:99], v[40:43], a[96:99]
ds_read_b128 v[56:59], v2 offset:32768
v_mfma_f32_16x16x32_bf16 a[96:99], v[100:103], v[44:47], a[96:99]
ds_read_b128 v[60:63], v3 offset:32768
v_mfma_f32_16x16x32_bf16 a[100:103], v[104:107], v[40:43], a[100:103]
v_mfma_f32_16x16x32_bf16 a[100:103], v[108:111], v[44:47], a[100:103]
v_mfma_f32_16x16x32_bf16 a[104:107], v[112:115], v[40:43], a[104:107]
v_mfma_f32_16x16x32_bf16 a[104:107], v[116:119], v[44:47], a[104:107]
v_mfma_f32_16x16x32_bf16 a[108:111], v[120:123], v[40:43], a[108:111]
v_mfma_f32_16x16x32_bf16 a[108:111], v[124:127], v[44:47], a[108:111]
s_waitcnt lgkmcnt(2)
v_mfma_f32_16x16x32_bf16 a[112:115], v[96:99], v[48:51], a[112:115]
ds_read_b128 v[40:43], v2 offset:34816
buffer_load_dwordx4 v[96:99], v1, s[12:15], s33 offen offset:0 sc1
v_mfma_f32_16x16x32_bf16 a[112:115], v[100:103], v[52:55], a[112:115]
ds_read_b128 v[44:47], v3 offset:34816
v_mfma_f32_16x16x32_bf16 a[116:119], v[104:107], v[48:51], a[116:119]
v_mfma_f32_16x16x32_bf16 a[116:119], v[108:111], v[52:55], a[116:119]
buffer_load_dwordx4 v[100:103], v1, s[12:15], s33 offen offset:1024 sc1
v_mfma_f32_16x16x32_bf16 a[120:123], v[112:115], v[48:51], a[120:123]
v_mfma_f32_16x16x32_bf16 a[120:123], v[116:119], v[52:55], a[120:123]
v_mfma_f32_16x16x32_bf16 a[124:127], v[120:123], v[48:51], a[124:127]
buffer_load_dwordx4 v[104:107], v1, s[12:15], s33 offen offset:2048 sc1
v_mfma_f32_16x16x32_bf16 a[124:127], v[124:127], v[52:55], a[124:127]
s_waitcnt vmcnt(10) lgkmcnt(2)
v_mfma_f32_16x16x32_bf16 a[0:3], v[64:67], v[56:59], a[0:3]
ds_read_b128 v[48:51], v2 offset:36864
v_mfma_f32_16x16x32_bf16 a[0:3], v[68:71], v[60:63], a[0:3]
ds_read_b128 v[52:55], v3 offset:36864
buffer_load_dwordx4 v[108:111], v1, s[12:15], s33 offen offset:3072 sc1
s_waitcnt vmcnt(9)
v_mfma_f32_16x16x32_bf16 a[4:7], v[72:75], v[56:59], a[4:7]
v_mfma_f32_16x16x32_bf16 a[4:7], v[76:79], v[60:63], a[4:7]
s_waitcnt vmcnt(6)
v_mfma_f32_16x16x32_bf16 a[8:11], v[80:83], v[56:59], a[8:11]
buffer_load_dwordx4 v[112:115], v1, s[12:15], s34 offen offset:0 sc1
v_mfma_f32_16x16x32_bf16 a[8:11], v[84:87], v[60:63], a[8:11]
s_waitcnt vmcnt(5)
v_mfma_f32_16x16x32_bf16 a[12:15], v[88:91], v[56:59], a[12:15]
v_mfma_f32_16x16x32_bf16 a[12:15], v[92:95], v[60:63], a[12:15]
buffer_load_dwordx4 v[116:119], v1, s[12:15], s34 offen offset:1024 sc1
s_waitcnt lgkmcnt(2)
v_mfma_f32_16x16x32_bf16 a[16:19], v[64:67], v[40:43], a[16:19]
ds_read_b128 v[56:59], v2 offset:38912
v_mfma_f32_16x16x32_bf16 a[16:19], v[68:71], v[44:47], a[16:19]
ds_read_b128 v[60:63], v3 offset:38912
v_mfma_f32_16x16x32_bf16 a[20:23], v[72:75], v[40:43], a[20:23]
buffer_load_dwordx4 v[120:123], v1, s[12:15], s34 offen offset:2048 sc1
v_mfma_f32_16x16x32_bf16 a[20:23], v[76:79], v[44:47], a[20:23]
v_mfma_f32_16x16x32_bf16 a[24:27], v[80:83], v[40:43], a[24:27]
v_mfma_f32_16x16x32_bf16 a[24:27], v[84:87], v[44:47], a[24:27]
buffer_load_dwordx4 v[124:127], v1, s[12:15], s34 offen offset:3072 sc1
s_add_u32 s33, s33, 0x8000
s_add_u32 s34, s34, 0x8000
v_mfma_f32_16x16x32_bf16 a[28:31], v[88:91], v[40:43], a[28:31]
v_mfma_f32_16x16x32_bf16 a[28:31], v[92:95], v[44:47], a[28:31]
s_waitcnt lgkmcnt(2)
v_mfma_f32_16x16x32_bf16 a[32:35], v[64:67], v[48:51], a[32:35]
ds_read_b128 v[40:43], v2 offset:40960
v_mfma_f32_16x16x32_bf16 a[32:35], v[68:71], v[52:55], a[32:35]
ds_read_b128 v[44:47], v3 offset:40960
v_mfma_f32_16x16x32_bf16 a[36:39], v[72:75], v[48:51], a[36:39]
v_mfma_f32_16x16x32_bf16 a[36:39], v[76:79], v[52:55], a[36:39]
v_mfma_f32_16x16x32_bf16 a[40:43], v[80:83], v[48:51], a[40:43]
v_mfma_f32_16x16x32_bf16 a[40:43], v[84:87], v[52:55], a[40:43]
v_mfma_f32_16x16x32_bf16 a[44:47], v[88:91], v[48:51], a[44:47]
v_mfma_f32_16x16x32_bf16 a[44:47], v[92:95], v[52:55], a[44:47]
s_waitcnt lgkmcnt(2)
v_mfma_f32_16x16x32_bf16 a[48:51], v[64:67], v[56:59], a[48:51]
ds_read_b128 v[48:51], v2 offset:43008
v_mfma_f32_16x16x32_bf16 a[48:51], v[68:71], v[60:63], a[48:51]
ds_read_b128 v[52:55], v3 offset:43008
v_mfma_f32_16x16x32_bf16 a[52:55], v[72:75], v[56:59], a[52:55]
v_mfma_f32_16x16x32_bf16 a[52:55], v[76:79], v[60:63], a[52:55]
v_mfma_f32_16x16x32_bf16 a[56:59], v[80:83], v[56:59], a[56:59]
v_mfma_f32_16x16x32_bf16 a[56:59], v[84:87], v[60:63], a[56:59]
v_mfma_f32_16x16x32_bf16 a[60:63], v[88:91], v[56:59], a[60:63]
v_mfma_f32_16x16x32_bf16 a[60:63], v[92:95], v[60:63], a[60:63]
s_waitcnt lgkmcnt(2)
v_mfma_f32_16x16x32_bf16 a[64:67], v[64:67], v[40:43], a[64:67]
ds_read_b128 v[56:59], v2 offset:45056
v_mfma_f32_16x16x32_bf16 a[64:67], v[68:71], v[44:47], a[64:67]
ds_read_b128 v[60:63], v3 offset:45056
v_mfma_f32_16x16x32_bf16 a[68:71], v[72:75], v[40:43], a[68:71]
v_mfma_f32_16x16x32_bf16 a[68:71], v[76:79], v[44:47], a[68:71]
v_mfma_f32_16x16x32_bf16 a[72:75], v[80:83], v[40:43], a[72:75]
v_mfma_f32_16x16x32_bf16 a[72:75], v[84:87], v[44:47], a[72:75]
v_mfma_f32_16x16x32_bf16 a[76:79], v[88:91], v[40:43], a[76:79]
v_mfma_f32_16x16x32_bf16 a[76:79], v[92:95], v[44:47], a[76:79]
s_waitcnt lgkmcnt(2)
v_mfma_f32_16x16x32_bf16 a[80:83], v[64:67], v[48:51], a[80:83]
ds_read_b128 v[40:43], v2 offset:47104
v_mfma_f32_16x16x32_bf16 a[80:83], v[68:71], v[52:55], a[80:83]
ds_read_b128 v[44:47], v3 offset:47104
v_mfma_f32_16x16x32_bf16 a[84:87], v[72:75], v[48:51], a[84:87]
v_mfma_f32_16x16x32_bf16 a[84:87], v[76:79], v[52:55], a[84:87]
v_mfma_f32_16x16x32_bf16 a[88:91], v[80:83], v[48:51], a[88:91]
v_mfma_f32_16x16x32_bf16 a[88:91], v[84:87], v[52:55], a[88:91]
v_mfma_f32_16x16x32_bf16 a[92:95], v[88:91], v[48:51], a[92:95]
v_mfma_f32_16x16x32_bf16 a[92:95], v[92:95], v[52:55], a[92:95]
s_waitcnt lgkmcnt(2)
v_mfma_f32_16x16x32_bf16 a[96:99], v[64:67], v[56:59], a[96:99]
ds_read_b128 v[48:51], v2 offset:49152
v_mfma_f32_16x16x32_bf16 a[96:99], v[68:71], v[60:63], a[96:99]
ds_read_b128 v[52:55], v3 offset:49152
v_mfma_f32_16x16x32_bf16 a[100:103], v[72:75], v[56:59], a[100:103]
v_mfma_f32_16x16x32_bf16 a[100:103], v[76:79], v[60:63], a[100:103]
v_mfma_f32_16x16x32_bf16 a[104:107], v[80:83], v[56:59], a[104:107]
v_mfma_f32_16x16x32_bf16 a[104:107], v[84:87], v[60:63], a[104:107]
v_mfma_f32_16x16x32_bf16 a[108:111], v[88:91], v[56:59], a[108:111]
v_mfma_f32_16x16x32_bf16 a[108:111], v[92:95], v[60:63], a[108:111]
s_waitcnt lgkmcnt(2)
v_mfma_f32_16x16x32_bf16 a[112:115], v[64:67], v[40:43], a[112:115]
ds_read_b128 v[56:59], v2 offset:51200
buffer_load_dwordx4 v[64:67], v1, s[12:15], s33 offen offset:0 sc1
v_mfma_f32_16x16x32_bf16 a[112:115], v[68:71], v[44:47], a[112:115]
ds_read_b128 v[60:63], v3 offset:51200
v_mfma_f32_16x16x32_bf16 a[116:119], v[72:75], v[40:43], a[116:119]
v_mfma_f32_16x16x32_bf16 a[116:119], v[76:79], v[44:47], a[116:119]
buffer_load_dwordx4 v[68:71], v1, s[12:15], s33 offen offset:1024 sc1
v_mfma_f32_16x16x32_bf16 a[120:123], v[80:83], v[40:43], a[120:123]
v_mfma_f32_16x16x32_bf16 a[120:123], v[84:87], v[44:47], a[120:123]
v_mfma_f32_16x16x32_bf16 a[124:127], v[88:91], v[40:43], a[124:127]
buffer_load_dwordx4 v[72:75], v1, s[12:15], s33 offen offset:2048 sc1
v_mfma_f32_16x16x32_bf16 a[124:127], v[92:95], v[44:47], a[124:127]
s_waitcnt vmcnt(9) lgkmcnt(2)
v_mfma_f32_16x16x32_bf16 a[0:3], v[96:99], v[48:51], a[0:3]
ds_read_b128 v[40:43], v2 offset:53248
v_mfma_f32_16x16x32_bf16 a[0:3], v[100:103], v[52:55], a[0:3]
ds_read_b128 v[44:47], v3 offset:53248
buffer_load_dwordx4 v[76:79], v1, s[12:15], s33 offen offset:3072 sc1
s_waitcnt vmcnt(8)
v_mfma_f32_16x16x32_bf16 a[4:7], v[104:107], v[48:51], a[4:7]
v_mfma_f32_16x16x32_bf16 a[4:7], v[108:111], v[52:55], a[4:7]
s_waitcnt vmcnt(6)
v_mfma_f32_16x16x32_bf16 a[8:11], v[112:115], v[48:51], a[8:11]
buffer_load_dwordx4 v[80:83], v1, s[12:15], s34 offen offset:0 sc1
v_mfma_f32_16x16x32_bf16 a[8:11], v[116:119], v[52:55], a[8:11]
s_waitcnt vmcnt(5)
v_mfma_f32_16x16x32_bf16 a[12:15], v[120:123], v[48:51], a[12:15]
v_mfma_f32_16x16x32_bf16 a[12:15], v[124:127], v[52:55], a[12:15]
buffer_load_dwordx4 v[84:87], v1, s[12:15], s34 offen offset:1024 sc1
s_waitcnt lgkmcnt(2)
v_mfma_f32_16x16x32_bf16 a[16:19], v[96:99], v[56:59], a[16:19]
ds_read_b128 v[48:51], v2 offset:55296
v_mfma_f32_16x16x32_bf16 a[16:19], v[100:103], v[60:63], a[16:19]
ds_read_b128 v[52:55], v3 offset:55296
v_mfma_f32_16x16x32_bf16 a[20:23], v[104:107], v[56:59], a[20:23]
buffer_load_dwordx4 v[88:91], v1, s[12:15], s34 offen offset:2048 sc1
v_mfma_f32_16x16x32_bf16 a[20:23], v[108:111], v[60:63], a[20:23]
v_xor_b32 v4, 0x10000, v4
v_xor_b32 v5, 0x10000, v5
v_mfma_f32_16x16x32_bf16 a[24:27], v[112:115], v[56:59], a[24:27]
v_accvgpr_read_b32 v12, a0
v_accvgpr_read_b32 v13, a4
v_mfma_f32_16x16x32_bf16 a[24:27], v[116:119], v[60:63], a[24:27]
buffer_load_dwordx4 v[92:95], v1, s[12:15], s34 offen offset:3072 sc1
s_add_u32 s33, s33, 0x8000
s_add_u32 s34, s34, 0x8000
v_mfma_f32_16x16x32_bf16 a[28:31], v[120:123], v[56:59], a[28:31]
v_lshlrev_b32 v16, 16, v128
v_mfma_f32_16x16x32_bf16 a[28:31], v[124:127], v[60:63], a[28:31]
v_and_b32 v17, 0xffff0000, v128
v_mul_f32 v12, v12, v16
s_waitcnt lgkmcnt(2)
v_mfma_f32_16x16x32_bf16 a[32:35], v[96:99], v[40:43], a[32:35]
ds_read_b128 v[56:59], v2 offset:57344
v_mfma_f32_16x16x32_bf16 a[32:35], v[100:103], v[44:47], a[32:35]
ds_read_b128 v[60:63], v3 offset:57344
v_mfma_f32_16x16x32_bf16 a[36:39], v[104:107], v[40:43], a[36:39]
v_mul_f32 v13, v13, v17
v_cvt_pk_bf16_f32 v20, v12, v13
v_mfma_f32_16x16x32_bf16 a[36:39], v[108:111], v[44:47], a[36:39]
v_accvgpr_read_b32 v14, a8
v_accvgpr_read_b32 v15, a12
v_mfma_f32_16x16x32_bf16 a[40:43], v[112:115], v[40:43], a[40:43]
v_lshlrev_b32 v18, 16, v129
v_and_b32 v19, 0xffff0000, v129
v_mfma_f32_16x16x32_bf16 a[40:43], v[116:119], v[44:47], a[40:43]
v_mul_f32 v14, v14, v18
v_mul_f32 v15, v15, v19
v_mfma_f32_16x16x32_bf16 a[44:47], v[120:123], v[40:43], a[44:47]
v_cvt_pk_bf16_f32 v21, v14, v15
v_accvgpr_read_b32 v12, a1
v_mfma_f32_16x16x32_bf16 a[44:47], v[124:127], v[44:47], a[44:47]
v_accvgpr_read_b32 v13, a5
v_lshlrev_b32 v16, 16, v130
s_waitcnt lgkmcnt(2)
v_mfma_f32_16x16x32_bf16 a[48:51], v[96:99], v[48:51], a[48:51]
ds_read_b128 v[40:43], v2 offset:59392
v_mfma_f32_16x16x32_bf16 a[48:51], v[100:103], v[52:55], a[48:51]
ds_read_b128 v[44:47], v3 offset:59392
v_mfma_f32_16x16x32_bf16 a[52:55], v[104:107], v[48:51], a[52:55]
v_and_b32 v17, 0xffff0000, v130
v_mul_f32 v12, v12, v16
v_mfma_f32_16x16x32_bf16 a[52:55], v[108:111], v[52:55], a[52:55]
v_mul_f32 v13, v13, v17
v_cvt_pk_bf16_f32 v22, v12, v13
v_mfma_f32_16x16x32_bf16 a[56:59], v[112:115], v[48:51], a[56:59]
v_accvgpr_read_b32 v14, a9
v_accvgpr_read_b32 v15, a13
v_mfma_f32_16x16x32_bf16 a[56:59], v[116:119], v[52:55], a[56:59]
v_lshlrev_b32 v18, 16, v131
v_and_b32 v19, 0xffff0000, v131
v_mfma_f32_16x16x32_bf16 a[60:63], v[120:123], v[48:51], a[60:63]
v_mul_f32 v14, v14, v18
v_mul_f32 v15, v15, v19
v_mfma_f32_16x16x32_bf16 a[60:63], v[124:127], v[52:55], a[60:63]
v_cvt_pk_bf16_f32 v23, v14, v15
ds_write_b128 v4, v[20:23] offset:0
s_waitcnt lgkmcnt(3)
v_mfma_f32_16x16x32_bf16 a[64:67], v[96:99], v[56:59], a[64:67]
ds_read_b128 v[48:51], v2 offset:61440
v_mfma_f32_16x16x32_bf16 a[64:67], v[100:103], v[60:63], a[64:67]
ds_read_b128 v[52:55], v3 offset:61440
v_mfma_f32_16x16x32_bf16 a[68:71], v[104:107], v[56:59], a[68:71]
v_accvgpr_read_b32 v12, a16
v_accvgpr_read_b32 v13, a20
v_mfma_f32_16x16x32_bf16 a[68:71], v[108:111], v[60:63], a[68:71]
v_lshlrev_b32 v16, 16, v136
v_and_b32 v17, 0xffff0000, v136
v_mfma_f32_16x16x32_bf16 a[72:75], v[112:115], v[56:59], a[72:75]
v_mul_f32 v12, v12, v16
v_mul_f32 v13, v13, v17
v_mfma_f32_16x16x32_bf16 a[72:75], v[116:119], v[60:63], a[72:75]
ds_read_b32 v28, v10 offset:3072
v_cvt_pk_bf16_f32 v20, v12, v13
v_mfma_f32_16x16x32_bf16 a[76:79], v[120:123], v[56:59], a[76:79]
v_accvgpr_read_b32 v14, a24
v_accvgpr_read_b32 v15, a28
v_mfma_f32_16x16x32_bf16 a[76:79], v[124:127], v[60:63], a[76:79]
v_lshlrev_b32 v18, 16, v137
s_waitcnt lgkmcnt(4)
v_mfma_f32_16x16x32_bf16 a[80:83], v[96:99], v[40:43], a[80:83]
ds_read_b128 v[56:59], v2 offset:63488
v_mfma_f32_16x16x32_bf16 a[80:83], v[100:103], v[44:47], a[80:83]
ds_read_b128 v[60:63], v3 offset:63488
v_and_b32 v19, 0xffff0000, v137
v_mfma_f32_16x16x32_bf16 a[84:87], v[104:107], v[40:43], a[84:87]
v_mul_f32 v14, v14, v18
v_mul_f32 v15, v15, v19
v_mfma_f32_16x16x32_bf16 a[84:87], v[108:111], v[44:47], a[84:87]
v_cvt_pk_bf16_f32 v21, v14, v15
v_accvgpr_read_b32 v12, a17
v_mfma_f32_16x16x32_bf16 a[88:91], v[112:115], v[40:43], a[88:91]
v_accvgpr_read_b32 v13, a21
v_lshlrev_b32 v16, 16, v138
v_mfma_f32_16x16x32_bf16 a[88:91], v[116:119], v[44:47], a[88:91]
v_and_b32 v17, 0xffff0000, v138
v_mul_f32 v12, v12, v16
v_mfma_f32_16x16x32_bf16 a[92:95], v[120:123], v[40:43], a[92:95]
v_mul_f32 v13, v13, v17
v_mfma_f32_16x16x32_bf16 a[92:95], v[124:127], v[44:47], a[92:95]
v_cvt_pk_bf16_f32 v22, v12, v13
v_accvgpr_read_b32 v14, a25
s_waitcnt lgkmcnt(3)
v_mfma_f32_16x16x32_bf16 a[96:99], v[96:99], v[48:51], a[96:99]
ds_read_b128 v[40:43], v2 offset:0
v_mfma_f32_16x16x32_bf16 a[96:99], v[100:103], v[52:55], a[96:99]
ds_read_b128 v[44:47], v3 offset:0
v_accvgpr_read_b32 v15, a29
v_mfma_f32_16x16x32_bf16 a[100:103], v[104:107], v[48:51], a[100:103]
v_lshlrev_b32 v18, 16, v139
v_and_b32 v19, 0xffff0000, v139
v_mfma_f32_16x16x32_bf16 a[100:103], v[108:111], v[52:55], a[100:103]
v_mul_f32 v14, v14, v18
v_mul_f32 v15, v15, v19
v_mfma_f32_16x16x32_bf16 a[104:107], v[112:115], v[48:51], a[104:107]
v_cvt_pk_bf16_f32 v23, v14, v15
ds_write_b128 v4, v[20:23] offset:2048
v_mfma_f32_16x16x32_bf16 a[104:107], v[116:119], v[52:55], a[104:107]
v_accvgpr_read_b32 v12, a32
v_accvgpr_read_b32 v13, a36
v_mfma_f32_16x16x32_bf16 a[108:111], v[120:123], v[48:51], a[108:111]
v_lshlrev_b32 v16, 16, v144
v_mfma_f32_16x16x32_bf16 a[108:111], v[124:127], v[52:55], a[108:111]
v_and_b32 v17, 0xffff0000, v144
v_mul_f32 v12, v12, v16
s_waitcnt lgkmcnt(3)
v_mfma_f32_16x16x32_bf16 a[112:115], v[96:99], v[56:59], a[112:115]
ds_read_b128 v[48:51], v2 offset:2048
buffer_load_dwordx4 v[96:99], v1, s[12:15], s33 offen offset:0 sc1
v_mfma_f32_16x16x32_bf16 a[112:115], v[100:103], v[60:63], a[112:115]
ds_read_b128 v[52:55], v3 offset:2048
v_mfma_f32_16x16x32_bf16 a[116:119], v[104:107], v[56:59], a[116:119]
v_mul_f32 v13, v13, v17
v_cvt_pk_bf16_f32 v20, v12, v13
v_mfma_f32_16x16x32_bf16 a[116:119], v[108:111], v[60:63], a[116:119]
buffer_load_dwordx4 v[100:103], v1, s[12:15], s33 offen offset:1024 sc1
v_accvgpr_read_b32 v14, a40
v_mfma_f32_16x16x32_bf16 a[120:123], v[112:115], v[56:59], a[120:123]
v_accvgpr_read_b32 v15, a44
v_lshlrev_b32 v18, 16, v145
v_mfma_f32_16x16x32_bf16 a[120:123], v[116:119], v[60:63], a[120:123]
v_and_b32 v19, 0xffff0000, v145
v_mfma_f32_16x16x32_bf16 a[124:127], v[120:123], v[56:59], a[124:127]
buffer_load_dwordx4 v[104:107], v1, s[12:15], s33 offen offset:2048 sc1
v_mul_f32 v14, v14, v18
v_mfma_f32_16x16x32_bf16 a[124:127], v[124:127], v[60:63], a[124:127]
v_mul_f32 v15, v15, v19
v_cvt_pk_bf16_f32 v21, v14, v15
s_waitcnt vmcnt(9) lgkmcnt(3)
v_mfma_f32_16x16x32_bf16 a[128:131], v[64:67], v[40:43], a[128:131]
ds_read_b128 v[56:59], v2 offset:4096
v_mfma_f32_16x16x32_bf16 a[128:131], v[68:71], v[44:47], a[128:131]
ds_read_b128 v[60:63], v3 offset:4096
buffer_load_dwordx4 v[108:111], v1, s[12:15], s33 offen offset:3072 sc1
s_waitcnt vmcnt(8)
v_mfma_f32_16x16x32_bf16 a[132:135], v[72:75], v[40:43], a[132:135]
v_accvgpr_read_b32 v12, a33
v_mfma_f32_16x16x32_bf16 a[132:135], v[76:79], v[44:47], a[132:135]
v_accvgpr_read_b32 v13, a37
v_lshlrev_b32 v16, 16, v146
s_waitcnt vmcnt(6)
v_mfma_f32_16x16x32_bf16 a[136:139], v[80:83], v[40:43], a[136:139]
buffer_load_dwordx4 v[112:115], v1, s[12:15], s34 offen offset:0 sc1
v_mfma_f32_16x16x32_bf16 a[136:139], v[84:87], v[44:47], a[136:139]
v_and_b32 v17, 0xffff0000, v146
v_mfma_f32_16x16x4_4b_bf16 a[192:207], v[28:29], v[30:31], a[192:207]
v_mul_f32 v12, v12, v16
v_mul_f32 v13, v13, v17
v_cvt_pk_bf16_f32 v22, v12, v13
v_accvgpr_read_b32 v14, a41
v_accvgpr_read_b32 v15, a45
v_lshlrev_b32 v18, 16, v147
v_and_b32 v19, 0xffff0000, v147
v_mul_f32 v14, v14, v18
v_mul_f32 v15, v15, v19
v_cvt_pk_bf16_f32 v23, v14, v15
s_waitcnt vmcnt(5)
v_mfma_f32_16x16x32_bf16 a[140:143], v[88:91], v[40:43], a[140:143]
ds_write_b128 v4, v[20:23] offset:4096
v_mfma_f32_16x16x32_bf16 a[140:143], v[92:95], v[44:47], a[140:143]
buffer_load_dwordx4 v[116:119], v1, s[12:15], s34 offen offset:1024 sc1
v_accvgpr_read_b32 v12, a48
s_waitcnt lgkmcnt(3)
v_mfma_f32_16x16x32_bf16 a[144:147], v[64:67], v[48:51], a[144:147]
ds_read_b128 v[40:43], v2 offset:6144
v_mfma_f32_16x16x32_bf16 a[144:147], v[68:71], v[52:55], a[144:147]
ds_read_b128 v[44:47], v3 offset:6144
v_accvgpr_read_b32 v13, a52
v_mfma_f32_16x16x32_bf16 a[148:151], v[72:75], v[48:51], a[148:151]
buffer_load_dwordx4 v[120:123], v1, s[12:15], s34 offen offset:2048 sc1
v_lshlrev_b32 v16, 16, v152
v_mfma_f32_16x16x32_bf16 a[148:151], v[76:79], v[52:55], a[148:151]
v_and_b32 v17, 0xffff0000, v152
v_mul_f32 v12, v12, v16
v_mfma_f32_16x16x32_bf16 a[152:155], v[80:83], v[48:51], a[152:155]
v_mul_f32 v13, v13, v17
v_mfma_f32_16x16x32_bf16 a[152:155], v[84:87], v[52:55], a[152:155]
buffer_load_dwordx4 v[124:127], v1, s[12:15], s34 offen offset:3072 sc1
s_add_u32 s33, s33, 0x8000
s_add_u32 s34, s34, 0x8000
v_mfma_f32_16x16x4_4b_bf16 a[208:223], v[28:29], v[30:31], a[208:223]
v_cvt_pk_bf16_f32 v20, v12, v13
v_accvgpr_read_b32 v14, a56
v_accvgpr_read_b32 v15, a60
v_lshlrev_b32 v18, 16, v153
v_and_b32 v19, 0xffff0000, v153
v_mul_f32 v14, v14, v18
v_mul_f32 v15, v15, v19
v_cvt_pk_bf16_f32 v21, v14, v15
v_accvgpr_read_b32 v12, a49
v_mfma_f32_16x16x32_bf16 a[156:159], v[88:91], v[48:51], a[156:159]
v_accvgpr_read_b32 v13, a53
v_lshlrev_b32 v16, 16, v154
v_mfma_f32_16x16x32_bf16 a[156:159], v[92:95], v[52:55], a[156:159]
v_and_b32 v17, 0xffff0000, v154
v_mul_f32 v12, v12, v16
s_waitcnt lgkmcnt(3)
v_mfma_f32_16x16x32_bf16 a[160:163], v[64:67], v[56:59], a[160:163]
ds_read_b128 v[48:51], v2 offset:8192
v_mfma_f32_16x16x32_bf16 a[160:163], v[68:71], v[60:63], a[160:163]
ds_read_b128 v[52:55], v3 offset:8192
v_mul_f32 v13, v13, v17
v_mfma_f32_16x16x32_bf16 a[164:167], v[72:75], v[56:59], a[164:167]
v_cvt_pk_bf16_f32 v22, v12, v13
v_accvgpr_read_b32 v14, a57
v_mfma_f32_16x16x32_bf16 a[164:167], v[76:79], v[60:63], a[164:167]
v_accvgpr_read_b32 v15, a61
v_mfma_f32_16x16x32_bf16 a[168:171], v[80:83], v[56:59], a[168:171]
v_lshlrev_b32 v18, 16, v155
v_and_b32 v19, 0xffff0000, v155
v_mfma_f32_16x16x32_bf16 a[168:171], v[84:87], v[60:63], a[168:171]
v_mul_f32 v14, v14, v18
v_mul_f32 v15, v15, v19
v_mfma_f32_16x16x4_4b_bf16 a[224:239], v[28:29], v[30:31], a[224:239]
v_cvt_pk_bf16_f32 v23, v14, v15
ds_write_b128 v4, v[20:23] offset:6144
v_accvgpr_read_b32 v12, a64
v_accvgpr_read_b32 v13, a68
v_lshlrev_b32 v16, 16, v160
v_and_b32 v17, 0xffff0000, v160
v_mul_f32 v12, v12, v16
v_mul_f32 v13, v13, v17
v_cvt_pk_bf16_f32 v20, v12, v13
v_accvgpr_read_b32 v14, a72
v_mfma_f32_16x16x32_bf16 a[172:175], v[88:91], v[56:59], a[172:175]
v_accvgpr_read_b32 v15, a76
v_lshlrev_b32 v18, 16, v161
v_mfma_f32_16x16x32_bf16 a[172:175], v[92:95], v[60:63], a[172:175]
v_and_b32 v19, 0xffff0000, v161
v_mul_f32 v14, v14, v18
s_waitcnt lgkmcnt(3)
v_mfma_f32_16x16x32_bf16 a[176:179], v[64:67], v[40:43], a[176:179]
ds_read_b128 v[56:59], v2 offset:10240
v_mfma_f32_16x16x32_bf16 a[176:179], v[68:71], v[44:47], a[176:179]
ds_read_b128 v[60:63], v3 offset:10240
v_mul_f32 v15, v15, v19
v_mfma_f32_16x16x32_bf16 a[180:183], v[72:75], v[40:43], a[180:183]
v_cvt_pk_bf16_f32 v21, v14, v15
v_mfma_f32_16x16x32_bf16 a[180:183], v[76:79], v[44:47], a[180:183]
v_accvgpr_read_b32 v12, a65
v_accvgpr_read_b32 v13, a69
v_mfma_f32_16x16x32_bf16 a[184:187], v[80:83], v[40:43], a[184:187]
v_lshlrev_b32 v16, 16, v162
v_and_b32 v17, 0xffff0000, v162
v_mfma_f32_16x16x32_bf16 a[184:187], v[84:87], v[44:47], a[184:187]
v_mul_f32 v12, v12, v16
v_mul_f32 v13, v13, v17
v_mfma_f32_16x16x4_4b_bf16 a[240:255], v[28:29], v[30:31], a[240:255]
v_cvt_pk_bf16_f32 v22, v12, v13
v_accvgpr_read_b32 v14, a73
v_accvgpr_read_b32 v15, a77
v_lshlrev_b32 v18, 16, v163
v_and_b32 v19, 0xffff0000, v163
v_mul_f32 v14, v14, v18
v_mul_f32 v15, v15, v19
v_cvt_pk_bf16_f32 v23, v14, v15
ds_write_b128 v4, v[20:23] offset:8192
v_accvgpr_read_b32 v12, a80
v_mfma_f32_16x16x32_bf16 a[188:191], v[88:91], v[40:43], a[188:191]
v_accvgpr_read_b32 v13, a84
v_lshlrev_b32 v16, 16, v168
v_mfma_f32_16x16x32_bf16 a[188:191], v[92:95], v[44:47], a[188:191]
v_and_b32 v17, 0xffff0000, v168
v_mul_f32 v12, v12, v16
s_waitcnt lgkmcnt(4)
v_mfma_f32_16x16x32_bf16 a[192:195], v[64:67], v[48:51], a[192:195]
ds_read_b128 v[40:43], v2 offset:12288
v_mfma_f32_16x16x32_bf16 a[192:195], v[68:71], v[52:55], a[192:195]
ds_read_b128 v[44:47], v3 offset:12288
v_mul_f32 v13, v13, v17
v_mfma_f32_16x16x32_bf16 a[196:199], v[72:75], v[48:51], a[196:199]
v_cvt_pk_bf16_f32 v20, v12, v13
v_mfma_f32_16x16x32_bf16 a[196:199], v[76:79], v[52:55], a[196:199]
v_accvgpr_read_b32 v14, a88
v_accvgpr_read_b32 v15, a92
v_mfma_f32_16x16x32_bf16 a[200:203], v[80:83], v[48:51], a[200:203]
v_lshlrev_b32 v18, 16, v169
v_and_b32 v19, 0xffff0000, v169
v_mfma_f32_16x16x32_bf16 a[200:203], v[84:87], v[52:55], a[200:203]
v_mul_f32 v14, v14, v18
v_mul_f32 v15, v15, v19
v_mfma_f32_16x16x4_4b_bf16 a[128:143], v[28:29], v[30:31], a[128:143]
v_cvt_pk_bf16_f32 v21, v14, v15
v_accvgpr_read_b32 v12, a81
v_accvgpr_read_b32 v13, a85
v_lshlrev_b32 v16, 16, v170
v_and_b32 v17, 0xffff0000, v170
v_mul_f32 v12, v12, v16
v_mul_f32 v13, v13, v17
v_cvt_pk_bf16_f32 v22, v12, v13
v_accvgpr_read_b32 v14, a89
v_accvgpr_read_b32 v15, a93
v_mfma_f32_16x16x32_bf16 a[204:207], v[88:91], v[48:51], a[204:207]
v_lshlrev_b32 v18, 16, v171
v_and_b32 v19, 0xffff0000, v171
v_mfma_f32_16x16x32_bf16 a[204:207], v[92:95], v[52:55], a[204:207]
v_mul_f32 v14, v14, v18
v_mul_f32 v15, v15, v19
s_waitcnt lgkmcnt(3)
v_mfma_f32_16x16x32_bf16 a[208:211], v[64:67], v[56:59], a[208:211]
ds_read_b128 v[48:51], v2 offset:14336
v_mfma_f32_16x16x32_bf16 a[208:211], v[68:71], v[60:63], a[208:211]
ds_read_b128 v[52:55], v3 offset:14336
v_mfma_f32_16x16x32_bf16 a[212:215], v[72:75], v[56:59], a[212:215]
v_cvt_pk_bf16_f32 v23, v14, v15
ds_write_b128 v4, v[20:23] offset:10240
v_mfma_f32_16x16x32_bf16 a[212:215], v[76:79], v[60:63], a[212:215]
v_accvgpr_read_b32 v12, a96
v_accvgpr_read_b32 v13, a100
v_mfma_f32_16x16x32_bf16 a[216:219], v[80:83], v[56:59], a[216:219]
v_lshlrev_b32 v16, 16, v176
v_and_b32 v17, 0xffff0000, v176
v_mfma_f32_16x16x32_bf16 a[216:219], v[84:87], v[60:63], a[216:219]
v_mul_f32 v12, v12, v16
v_mul_f32 v13, v13, v17
v_mfma_f32_16x16x4_4b_bf16 a[144:159], v[28:29], v[30:31], a[144:159]
v_cvt_pk_bf16_f32 v20, v12, v13
v_accvgpr_read_b32 v14, a104
v_accvgpr_read_b32 v15, a108
v_lshlrev_b32 v18, 16, v177
v_and_b32 v19, 0xffff0000, v177
v_mul_f32 v14, v14, v18
v_mul_f32 v15, v15, v19
v_cvt_pk_bf16_f32 v21, v14, v15
v_accvgpr_read_b32 v12, a97
v_accvgpr_read_b32 v13, a101
v_mfma_f32_16x16x32_bf16 a[220:223], v[88:91], v[56:59], a[220:223]
v_lshlrev_b32 v16, 16, v178
v_and_b32 v17, 0xffff0000, v178
v_mfma_f32_16x16x32_bf16 a[220:223], v[92:95], v[60:63], a[220:223]
v_mul_f32 v12, v12, v16
v_mul_f32 v13, v13, v17
s_waitcnt lgkmcnt(3)
v_mfma_f32_16x16x32_bf16 a[224:227], v[64:67], v[40:43], a[224:227]
ds_read_b128 v[56:59], v2 offset:16384
v_mfma_f32_16x16x32_bf16 a[224:227], v[68:71], v[44:47], a[224:227]
ds_read_b128 v[60:63], v3 offset:16384
v_mfma_f32_16x16x32_bf16 a[228:231], v[72:75], v[40:43], a[228:231]
v_cvt_pk_bf16_f32 v22, v12, v13
v_accvgpr_read_b32 v14, a105
v_mfma_f32_16x16x32_bf16 a[228:231], v[76:79], v[44:47], a[228:231]
v_accvgpr_read_b32 v15, a109
v_lshlrev_b32 v18, 16, v179
v_mfma_f32_16x16x32_bf16 a[232:235], v[80:83], v[40:43], a[232:235]
v_and_b32 v19, 0xffff0000, v179
v_mul_f32 v14, v14, v18
v_mfma_f32_16x16x32_bf16 a[232:235], v[84:87], v[44:47], a[232:235]
v_mul_f32 v15, v15, v19
v_cvt_pk_bf16_f32 v23, v14, v15
v_mfma_f32_16x16x4_4b_bf16 a[160:175], v[28:29], v[30:31], a[160:175]
ds_write_b128 v4, v[20:23] offset:12288
v_accvgpr_read_b32 v12, a112
v_accvgpr_read_b32 v13, a116
v_lshlrev_b32 v16, 16, v184
v_and_b32 v17, 0xffff0000, v184
v_mul_f32 v12, v12, v16
v_mul_f32 v13, v13, v17
v_cvt_pk_bf16_f32 v20, v12, v13
v_accvgpr_read_b32 v14, a120
v_accvgpr_read_b32 v15, a124
v_mfma_f32_16x16x32_bf16 a[236:239], v[88:91], v[40:43], a[236:239]
v_lshlrev_b32 v18, 16, v185
v_and_b32 v19, 0xffff0000, v185
v_mfma_f32_16x16x32_bf16 a[236:239], v[92:95], v[44:47], a[236:239]
v_mul_f32 v14, v14, v18
v_mul_f32 v15, v15, v19
s_waitcnt lgkmcnt(4)
v_mfma_f32_16x16x32_bf16 a[240:243], v[64:67], v[48:51], a[240:243]
ds_read_b128 v[40:43], v2 offset:18432
buffer_load_dwordx4 v[64:67], v1, s[12:15], s33 offen offset:0 sc1
v_mfma_f32_16x16x32_bf16 a[240:243], v[68:71], v[52:55], a[240:243]
ds_read_b128 v[44:47], v3 offset:18432
v_mfma_f32_16x16x32_bf16 a[244:247], v[72:75], v[48:51], a[244:247]
v_cvt_pk_bf16_f32 v21, v14, v15
v_mfma_f32_16x16x32_bf16 a[244:247], v[76:79], v[52:55], a[244:247]
buffer_load_dwordx4 v[68:71], v1, s[12:15], s33 offen offset:1024 sc1
v_accvgpr_read_b32 v12, a113
v_mfma_f32_16x16x32_bf16 a[248:251], v[80:83], v[48:51], a[248:251]
v_accvgpr_read_b32 v13, a117
v_lshlrev_b32 v16, 16, v186
v_mfma_f32_16x16x32_bf16 a[248:251], v[84:87], v[52:55], a[248:251]
v_and_b32 v17, 0xffff0000, v186
v_mul_f32 v12, v12, v16
v_mfma_f32_16x16x4_4b_bf16 a[176:191], v[28:29], v[30:31], a[176:191]
v_mul_f32 v13, v13, v17
v_cvt_pk_bf16_f32 v22, v12, v13
v_accvgpr_read_b32 v14, a121
v_accvgpr_read_b32 v15, a125
v_lshlrev_b32 v18, 16, v187
v_and_b32 v19, 0xffff0000, v187
v_mul_f32 v14, v14, v18
v_mul_f32 v15, v15, v19
v_cvt_pk_bf16_f32 v23, v14, v15
ds_write_b128 v4, v[20:23] offset:14336
v_mfma_f32_16x16x32_bf16 a[252:255], v[88:91], v[48:51], a[252:255]
buffer_load_dwordx4 v[72:75], v1, s[12:15], s33 offen offset:2048 sc1
v_accvgpr_read_b32 v12, a2
v_mfma_f32_16x16x32_bf16 a[252:255], v[92:95], v[52:55], a[252:255]
v_accvgpr_read_b32 v13, a6
s_waitcnt vmcnt(9) lgkmcnt(4)
v_mfma_f32_16x16x32_bf16 a[128:131], v[96:99], v[56:59], a[128:131]
ds_read_b128 v[48:51], v2 offset:20480
v_mfma_f32_16x16x32_bf16 a[128:131], v[100:103], v[60:63], a[128:131]
ds_read_b128 v[52:55], v3 offset:20480
buffer_load_dwordx4 v[76:79], v1, s[12:15], s33 offen offset:3072 sc1
s_waitcnt vmcnt(8)
v_mfma_f32_16x16x32_bf16 a[132:135], v[104:107], v[56:59], a[132:135]
v_lshlrev_b32 v16, 16, v132
v_mfma_f32_16x16x32_bf16 a[132:135], v[108:111], v[60:63], a[132:135]
v_and_b32 v17, 0xffff0000, v132
v_mul_f32 v12, v12, v16
s_waitcnt vmcnt(6)
v_mfma_f32_16x16x32_bf16 a[136:139], v[112:115], v[56:59], a[136:139]
buffer_load_dwordx4 v[80:83], v1, s[12:15], s34 offen offset:0 sc1
v_mfma_f32_16x16x32_bf16 a[136:139], v[116:119], v[60:63], a[136:139]
v_mul_f32 v13, v13, v17
v_cvt_pk_bf16_f32 v20, v12, v13
s_waitcnt vmcnt(5)
v_mfma_f32_16x16x32_bf16 a[140:143], v[120:123], v[56:59], a[140:143]
v_accvgpr_read_b32 v14, a10
v_mfma_f32_16x16x32_bf16 a[140:143], v[124:127], v[60:63], a[140:143]
buffer_load_dwordx4 v[84:87], v1, s[12:15], s34 offen offset:1024 sc1
s_waitcnt lgkmcnt(3)
v_mfma_f32_16x16x32_bf16 a[144:147], v[96:99], v[40:43], a[144:147]
ds_read_b128 v[56:59], v2 offset:22528
v_mfma_f32_16x16x32_bf16 a[144:147], v[100:103], v[44:47], a[144:147]
ds_read_b128 v[60:63], v3 offset:22528
v_accvgpr_read_b32 v15, a14
v_mfma_f32_16x16x32_bf16 a[148:151], v[104:107], v[40:43], a[148:151]
buffer_load_dwordx4 v[88:91], v1, s[12:15], s34 offen offset:2048 sc1
v_lshlrev_b32 v18, 16, v133
v_mfma_f32_16x16x32_bf16 a[148:151], v[108:111], v[44:47], a[148:151]
v_and_b32 v19, 0xffff0000, v133
v_mul_f32 v14, v14, v18
v_mfma_f32_16x16x32_bf16 a[152:155], v[112:115], v[40:43], a[152:155]
v_mul_f32 v15, v15, v19
v_cvt_pk_bf16_f32 v21, v14, v15
v_mfma_f32_16x16x32_bf16 a[152:155], v[116:119], v[44:47], a[152:155]
buffer_load_dwordx4 v[92:95], v1, s[12:15], s34 offen offset:3072 sc1
s_add_u32 s33, s33, 0x8000
s_add_u32 s34, s34, 0x8000
v_mfma_f32_16x16x32_bf16 a[156:159], v[120:123], v[40:43], a[156:159]
v_mfma_f32_16x16x32_bf16 a[156:159], v[124:127], v[44:47], a[156:159]
v_accvgpr_read_b32 v12, a3
v_accvgpr_read_b32 v13, a7
s_waitcnt lgkmcnt(2)
v_mfma_f32_16x16x32_bf16 a[160:163], v[96:99], v[48:51], a[160:163]
ds_read_b128 v[40:43], v2 offset:24576
v_mfma_f32_16x16x32_bf16 a[160:163], v[100:103], v[52:55], a[160:163]
ds_read_b128 v[44:47], v3 offset:24576
v_lshlrev_b32 v16, 16, v134
v_mfma_f32_16x16x32_bf16 a[164:167], v[104:107], v[48:51], a[164:167]
v_and_b32 v17, 0xffff0000, v134
v_mul_f32 v12, v12, v16
v_mfma_f32_16x16x32_bf16 a[164:167], v[108:111], v[52:55], a[164:167]
v_mul_f32 v13, v13, v17
v_cvt_pk_bf16_f32 v22, v12, v13
v_mfma_f32_16x16x32_bf16 a[168:171], v[112:115], v[48:51], a[168:171]
v_accvgpr_read_b32 v14, a11
v_accvgpr_read_b32 v15, a15
v_mfma_f32_16x16x32_bf16 a[168:171], v[116:119], v[52:55], a[168:171]
v_lshlrev_b32 v18, 16, v135
v_and_b32 v19, 0xffff0000, v135
v_mfma_f32_16x16x32_bf16 a[172:175], v[120:123], v[48:51], a[172:175]
v_mul_f32 v14, v14, v18
v_mfma_f32_16x16x32_bf16 a[172:175], v[124:127], v[52:55], a[172:175]
v_mul_f32 v15, v15, v19
v_cvt_pk_bf16_f32 v23, v14, v15
s_waitcnt lgkmcnt(2)
v_mfma_f32_16x16x32_bf16 a[176:179], v[96:99], v[56:59], a[176:179]
ds_read_b128 v[48:51], v2 offset:26624
v_mfma_f32_16x16x32_bf16 a[176:179], v[100:103], v[60:63], a[176:179]
ds_read_b128 v[52:55], v3 offset:26624
ds_write_b128 v5, v[20:23] offset:0
v_mfma_f32_16x16x32_bf16 a[180:183], v[104:107], v[56:59], a[180:183]
v_accvgpr_read_b32 v12, a18
v_accvgpr_read_b32 v13, a22
v_mfma_f32_16x16x32_bf16 a[180:183], v[108:111], v[60:63], a[180:183]
v_lshlrev_b32 v16, 16, v140
v_and_b32 v17, 0xffff0000, v140
v_mfma_f32_16x16x32_bf16 a[184:187], v[112:115], v[56:59], a[184:187]
v_mul_f32 v12, v12, v16
v_mul_f32 v13, v13, v17
v_mfma_f32_16x16x32_bf16 a[184:187], v[116:119], v[60:63], a[184:187]
v_cvt_pk_bf16_f32 v20, v12, v13
v_accvgpr_read_b32 v14, a26
v_mfma_f32_16x16x32_bf16 a[188:191], v[120:123], v[56:59], a[188:191]
v_accvgpr_read_b32 v15, a30
v_mfma_f32_16x16x32_bf16 a[188:191], v[124:127], v[60:63], a[188:191]
v_lshlrev_b32 v18, 16, v141
v_and_b32 v19, 0xffff0000, v141
s_waitcnt lgkmcnt(3)
v_mfma_f32_16x16x32_bf16 a[192:195], v[96:99], v[40:43], a[192:195]
ds_read_b128 v[56:59], v2 offset:28672
v_mfma_f32_16x16x32_bf16 a[192:195], v[100:103], v[44:47], a[192:195]
ds_read_b128 v[60:63], v3 offset:28672
v_mul_f32 v14, v14, v18
v_mfma_f32_16x16x32_bf16 a[196:199], v[104:107], v[40:43], a[196:199]
v_mul_f32 v15, v15, v19
v_cvt_pk_bf16_f32 v21, v14, v15
v_mfma_f32_16x16x32_bf16 a[196:199], v[108:111], v[44:47], a[196:199]
v_accvgpr_read_b32 v12, a19
v_accvgpr_read_b32 v13, a23
v_mfma_f32_16x16x32_bf16 a[200:203], v[112:115], v[40:43], a[200:203]
v_lshlrev_b32 v16, 16, v142
v_and_b32 v17, 0xffff0000, v142
v_mfma_f32_16x16x32_bf16 a[200:203], v[116:119], v[44:47], a[200:203]
v_mul_f32 v12, v12, v16
v_mul_f32 v13, v13, v17
v_mfma_f32_16x16x32_bf16 a[204:207], v[120:123], v[40:43], a[204:207]
v_cvt_pk_bf16_f32 v22, v12, v13
v_mfma_f32_16x16x32_bf16 a[204:207], v[124:127], v[44:47], a[204:207]
v_accvgpr_read_b32 v14, a27
v_accvgpr_read_b32 v15, a31
s_waitcnt lgkmcnt(3)
v_mfma_f32_16x16x32_bf16 a[208:211], v[96:99], v[48:51], a[208:211]
ds_read_b128 v[40:43], v2 offset:30720
v_mfma_f32_16x16x32_bf16 a[208:211], v[100:103], v[52:55], a[208:211]
ds_read_b128 v[44:47], v3 offset:30720
v_lshlrev_b32 v18, 16, v143
v_mfma_f32_16x16x32_bf16 a[212:215], v[104:107], v[48:51], a[212:215]
v_and_b32 v19, 0xffff0000, v143
v_mul_f32 v14, v14, v18
v_mfma_f32_16x16x32_bf16 a[212:215], v[108:111], v[52:55], a[212:215]
v_mul_f32 v15, v15, v19
v_cvt_pk_bf16_f32 v23, v14, v15
v_mfma_f32_16x16x32_bf16 a[216:219], v[112:115], v[48:51], a[216:219]
ds_write_b128 v5, v[20:23] offset:2048
v_accvgpr_read_b32 v12, a34
v_mfma_f32_16x16x32_bf16 a[216:219], v[116:119], v[52:55], a[216:219]
v_accvgpr_read_b32 v13, a38
v_mfma_f32_16x16x32_bf16 a[220:223], v[120:123], v[48:51], a[220:223]
v_lshlrev_b32 v16, 16, v148
v_and_b32 v17, 0xffff0000, v148
v_mfma_f32_16x16x32_bf16 a[220:223], v[124:127], v[52:55], a[220:223]
v_mul_f32 v12, v12, v16
v_mul_f32 v13, v13, v17
s_waitcnt lgkmcnt(3)
v_mfma_f32_16x16x32_bf16 a[224:227], v[96:99], v[56:59], a[224:227]
ds_read_b128 v[48:51], v2 offset:32768
v_mfma_f32_16x16x32_bf16 a[224:227], v[100:103], v[60:63], a[224:227]
ds_read_b128 v[52:55], v3 offset:32768
v_cvt_pk_bf16_f32 v20, v12, v13
v_mfma_f32_16x16x32_bf16 a[228:231], v[104:107], v[56:59], a[228:231]
v_accvgpr_read_b32 v14, a42
v_accvgpr_read_b32 v15, a46
v_mfma_f32_16x16x32_bf16 a[228:231], v[108:111], v[60:63], a[228:231]
v_lshlrev_b32 v18, 16, v149
v_and_b32 v19, 0xffff0000, v149
v_mfma_f32_16x16x32_bf16 a[232:235], v[112:115], v[56:59], a[232:235]
v_mul_f32 v14, v14, v18
v_mul_f32 v15, v15, v19
v_mfma_f32_16x16x32_bf16 a[232:235], v[116:119], v[60:63], a[232:235]
v_cvt_pk_bf16_f32 v21, v14, v15
v_mfma_f32_16x16x32_bf16 a[236:239], v[120:123], v[56:59], a[236:239]
v_accvgpr_read_b32 v12, a35
v_accvgpr_read_b32 v13, a39
v_mfma_f32_16x16x32_bf16 a[236:239], v[124:127], v[60:63], a[236:239]
v_lshlrev_b32 v16, 16, v150
v_and_b32 v17, 0xffff0000, v150
s_waitcnt lgkmcnt(3)
v_mfma_f32_16x16x32_bf16 a[240:243], v[96:99], v[40:43], a[240:243]
ds_read_b128 v[56:59], v2 offset:34816
buffer_load_dwordx4 v[96:99], v1, s[12:15], s33 offen offset:0 sc1
v_mfma_f32_16x16x32_bf16 a[240:243], v[100:103], v[44:47], a[240:243]
ds_read_b128 v[60:63], v3 offset:34816
v_mfma_f32_16x16x32_bf16 a[244:247], v[104:107], v[40:43], a[244:247]
v_mul_f32 v12, v12, v16
v_mul_f32 v13, v13, v17
v_mfma_f32_16x16x32_bf16 a[244:247], v[108:111], v[44:47], a[244:247]
buffer_load_dwordx4 v[100:103], v1, s[12:15], s33 offen offset:1024 sc1
v_cvt_pk_bf16_f32 v22, v12, v13
v_mfma_f32_16x16x32_bf16 a[248:251], v[112:115], v[40:43], a[248:251]
v_accvgpr_read_b32 v14, a43
v_accvgpr_read_b32 v15, a47
v_mfma_f32_16x16x32_bf16 a[248:251], v[116:119], v[44:47], a[248:251]
v_lshlrev_b32 v18, 16, v151
v_mfma_f32_16x16x32_bf16 a[252:255], v[120:123], v[40:43], a[252:255]
buffer_load_dwordx4 v[104:107], v1, s[12:15], s33 offen offset:2048 sc1
v_and_b32 v19, 0xffff0000, v151
v_mfma_f32_16x16x32_bf16 a[252:255], v[124:127], v[44:47], a[252:255]
v_mul_f32 v14, v14, v18
v_mul_f32 v15, v15, v19
s_waitcnt vmcnt(9) lgkmcnt(2)
v_mfma_f32_16x16x32_bf16 a[128:131], v[64:67], v[48:51], a[128:131]
ds_read_b128 v[40:43], v2 offset:36864
v_mfma_f32_16x16x32_bf16 a[128:131], v[68:71], v[52:55], a[128:131]
ds_read_b128 v[44:47], v3 offset:36864
buffer_load_dwordx4 v[108:111], v1, s[12:15], s33 offen offset:3072 sc1
s_waitcnt vmcnt(8)
v_mfma_f32_16x16x32_bf16 a[132:135], v[72:75], v[48:51], a[132:135]
v_cvt_pk_bf16_f32 v23, v14, v15
v_mfma_f32_16x16x32_bf16 a[132:135], v[76:79], v[52:55], a[132:135]
ds_read_b128 v[32:35], v6 offset:0
ds_write_b128 v5, v[20:23] offset:4096
s_waitcnt vmcnt(6)
v_mfma_f32_16x16x32_bf16 a[136:139], v[80:83], v[48:51], a[136:139]
buffer_load_dwordx4 v[112:115], v1, s[12:15], s34 offen offset:0 sc1
v_mfma_f32_16x16x32_bf16 a[136:139], v[84:87], v[52:55], a[136:139]
v_accvgpr_read_b32 v12, a50
s_waitcnt vmcnt(5)
v_mfma_f32_16x16x32_bf16 a[140:143], v[88:91], v[48:51], a[140:143]
v_accvgpr_read_b32 v13, a54
v_mfma_f32_16x16x32_bf16 a[140:143], v[92:95], v[52:55], a[140:143]
buffer_load_dwordx4 v[116:119], v1, s[12:15], s34 offen offset:1024 sc1
v_lshlrev_b32 v16, 16, v156
s_waitcnt lgkmcnt(4)
v_mfma_f32_16x16x32_bf16 a[144:147], v[64:67], v[56:59], a[144:147]
ds_read_b128 v[48:51], v2 offset:38912
v_mfma_f32_16x16x32_bf16 a[144:147], v[68:71], v[60:63], a[144:147]
ds_read_b128 v[52:55], v3 offset:38912
v_and_b32 v17, 0xffff0000, v156
v_mfma_f32_16x16x32_bf16 a[148:151], v[72:75], v[56:59], a[148:151]
buffer_load_dwordx4 v[120:123], v1, s[12:15], s34 offen offset:2048 sc1
v_mul_f32 v12, v12, v16
v_mfma_f32_16x16x32_bf16 a[148:151], v[76:79], v[60:63], a[148:151]
ds_read_b128 v[36:39], v7 offset:1024
v_mul_f32 v13, v13, v17
v_mfma_f32_16x16x32_bf16 a[152:155], v[80:83], v[56:59], a[152:155]
v_cvt_pk_bf16_f32 v20, v12, v13
v_mfma_f32_16x16x32_bf16 a[152:155], v[84:87], v[60:63], a[152:155]
buffer_load_dwordx4 v[124:127], v1, s[12:15], s34 offen offset:3072 sc1
s_add_u32 s33, s33, 0x8000
s_add_u32 s34, s34, 0x8000
v_mfma_f32_16x16x32_bf16 a[156:159], v[88:91], v[56:59], a[156:159]
s_add_u32 s6, s38, 0x2000000
s_waitcnt lgkmcnt(4)
buffer_store_dwordx4 v[32:35], v24, s[20:23], s6 offen sc1
v_mfma_f32_16x16x32_bf16 a[156:159], v[92:95], v[60:63], a[156:159]
v_mfma_f32_16x16x32_bf16 a[160:163], v[64:67], v[40:43], a[160:163]
ds_read_b128 v[56:59], v2 offset:40960
v_accvgpr_read_b32 v14, a58
v_mfma_f32_16x16x32_bf16 a[160:163], v[68:71], v[44:47], a[160:163]
ds_read_b128 v[60:63], v3 offset:40960
v_accvgpr_read_b32 v15, a62
v_mfma_f32_16x16x32_bf16 a[164:167], v[72:75], v[40:43], a[164:167]
v_lshlrev_b32 v18, 16, v157
v_and_b32 v19, 0xffff0000, v157
v_mfma_f32_16x16x32_bf16 a[164:167], v[76:79], v[44:47], a[164:167]
v_mul_f32 v14, v14, v18
v_mul_f32 v15, v15, v19
v_mfma_f32_16x16x32_bf16 a[168:171], v[80:83], v[40:43], a[168:171]
v_cvt_pk_bf16_f32 v21, v14, v15
v_accvgpr_read_b32 v12, a51
v_mfma_f32_16x16x32_bf16 a[168:171], v[84:87], v[44:47], a[168:171]
v_accvgpr_read_b32 v13, a55
v_mfma_f32_16x16x32_bf16 a[172:175], v[88:91], v[40:43], a[172:175]
s_add_u32 s6, s38, 0x2004000
s_waitcnt lgkmcnt(2)
buffer_store_dwordx4 v[36:39], v24, s[20:23], s6 offen sc1
v_mfma_f32_16x16x32_bf16 a[172:175], v[92:95], v[44:47], a[172:175]
v_lshlrev_b32 v16, 16, v158
v_mfma_f32_16x16x32_bf16 a[176:179], v[64:67], v[48:51], a[176:179]
ds_read_b128 v[40:43], v2 offset:43008
v_and_b32 v17, 0xffff0000, v158
v_mfma_f32_16x16x32_bf16 a[176:179], v[68:71], v[52:55], a[176:179]
ds_read_b128 v[44:47], v3 offset:43008
v_mul_f32 v12, v12, v16
v_mfma_f32_16x16x32_bf16 a[180:183], v[72:75], v[48:51], a[180:183]
v_mul_f32 v13, v13, v17
v_cvt_pk_bf16_f32 v22, v12, v13
v_mfma_f32_16x16x32_bf16 a[180:183], v[76:79], v[52:55], a[180:183]
v_accvgpr_read_b32 v14, a59
v_accvgpr_read_b32 v15, a63
v_mfma_f32_16x16x32_bf16 a[184:187], v[80:83], v[48:51], a[184:187]
v_lshlrev_b32 v18, 16, v159
v_and_b32 v19, 0xffff0000, v159
v_mfma_f32_16x16x32_bf16 a[184:187], v[84:87], v[52:55], a[184:187]
v_mul_f32 v14, v14, v18
v_mul_f32 v15, v15, v19
v_mfma_f32_16x16x32_bf16 a[188:191], v[88:91], v[48:51], a[188:191]
v_cvt_pk_bf16_f32 v23, v14, v15
ds_write_b128 v5, v[20:23] offset:6144
v_mfma_f32_16x16x32_bf16 a[188:191], v[92:95], v[52:55], a[188:191]
v_accvgpr_read_b32 v12, a66
s_waitcnt lgkmcnt(3)
v_mfma_f32_16x16x32_bf16 a[192:195], v[64:67], v[56:59], a[192:195]
ds_read_b128 v[48:51], v2 offset:45056
v_mfma_f32_16x16x32_bf16 a[192:195], v[68:71], v[60:63], a[192:195]
ds_read_b128 v[52:55], v3 offset:45056
v_accvgpr_read_b32 v13, a70
v_mfma_f32_16x16x32_bf16 a[196:199], v[72:75], v[56:59], a[196:199]
v_lshlrev_b32 v16, 16, v164
v_and_b32 v17, 0xffff0000, v164
v_mfma_f32_16x16x32_bf16 a[196:199], v[76:79], v[60:63], a[196:199]
v_mul_f32 v12, v12, v16
v_mul_f32 v13, v13, v17
v_mfma_f32_16x16x32_bf16 a[200:203], v[80:83], v[56:59], a[200:203]
v_cvt_pk_bf16_f32 v20, v12, v13
v_accvgpr_read_b32 v14, a74
v_mfma_f32_16x16x32_bf16 a[200:203], v[84:87], v[60:63], a[200:203]
v_accvgpr_read_b32 v15, a78
v_lshlrev_b32 v18, 16, v165
v_mfma_f32_16x16x32_bf16 a[204:207], v[88:91], v[56:59], a[204:207]
v_and_b32 v19, 0xffff0000, v165
v_mul_f32 v14, v14, v18
v_mfma_f32_16x16x32_bf16 a[204:207], v[92:95], v[60:63], a[204:207]
v_mul_f32 v15, v15, v19
v_cvt_pk_bf16_f32 v21, v14, v15
s_waitcnt lgkmcnt(3)
v_mfma_f32_16x16x32_bf16 a[208:211], v[64:67], v[40:43], a[208:211]
ds_read_b128 v[56:59], v2 offset:47104
v_mfma_f32_16x16x32_bf16 a[208:211], v[68:71], v[44:47], a[208:211]
ds_read_b128 v[60:63], v3 offset:47104
v_accvgpr_read_b32 v12, a67
v_mfma_f32_16x16x32_bf16 a[212:215], v[72:75], v[40:43], a[212:215]
v_accvgpr_read_b32 v13, a71
v_mfma_f32_16x16x32_bf16 a[212:215], v[76:79], v[44:47], a[212:215]
v_lshlrev_b32 v16, 16, v166
v_and_b32 v17, 0xffff0000, v166
v_mfma_f32_16x16x32_bf16 a[216:219], v[80:83], v[40:43], a[216:219]
v_mul_f32 v12, v12, v16
v_mul_f32 v13, v13, v17
v_mfma_f32_16x16x32_bf16 a[216:219], v[84:87], v[44:47], a[216:219]
v_cvt_pk_bf16_f32 v22, v12, v13
v_accvgpr_read_b32 v14, a75
v_mfma_f32_16x16x32_bf16 a[220:223], v[88:91], v[40:43], a[220:223]
v_accvgpr_read_b32 v15, a79
v_lshlrev_b32 v18, 16, v167
v_mfma_f32_16x16x32_bf16 a[220:223], v[92:95], v[44:47], a[220:223]
v_and_b32 v19, 0xffff0000, v167
v_mul_f32 v14, v14, v18
s_waitcnt lgkmcnt(2)
v_mfma_f32_16x16x32_bf16 a[224:227], v[64:67], v[48:51], a[224:227]
ds_read_b128 v[40:43], v2 offset:49152
v_mfma_f32_16x16x32_bf16 a[224:227], v[68:71], v[52:55], a[224:227]
ds_read_b128 v[44:47], v3 offset:49152
v_mul_f32 v15, v15, v19
v_mfma_f32_16x16x32_bf16 a[228:231], v[72:75], v[48:51], a[228:231]
v_cvt_pk_bf16_f32 v23, v14, v15
ds_write_b128 v5, v[20:23] offset:8192
v_mfma_f32_16x16x32_bf16 a[228:231], v[76:79], v[52:55], a[228:231]
v_accvgpr_read_b32 v12, a82
v_accvgpr_read_b32 v13, a86
v_mfma_f32_16x16x32_bf16 a[232:235], v[80:83], v[48:51], a[232:235]
v_lshlrev_b32 v16, 16, v172
v_mfma_f32_16x16x32_bf16 a[232:235], v[84:87], v[52:55], a[232:235]
v_and_b32 v17, 0xffff0000, v172
v_mul_f32 v12, v12, v16
v_mfma_f32_16x16x32_bf16 a[236:239], v[88:91], v[48:51], a[236:239]
v_mul_f32 v13, v13, v17
v_cvt_pk_bf16_f32 v20, v12, v13
v_mfma_f32_16x16x32_bf16 a[236:239], v[92:95], v[52:55], a[236:239]
v_accvgpr_read_b32 v14, a90
v_accvgpr_read_b32 v15, a94
s_waitcnt lgkmcnt(3)
v_mfma_f32_16x16x32_bf16 a[240:243], v[64:67], v[56:59], a[240:243]
ds_read_b128 v[48:51], v2 offset:51200
buffer_load_dwordx4 v[64:67], v1, s[12:15], s33 offen offset:0 sc1
v_mfma_f32_16x16x32_bf16 a[240:243], v[68:71], v[60:63], a[240:243]
ds_read_b128 v[52:55], v3 offset:51200
v_mfma_f32_16x16x32_bf16 a[244:247], v[72:75], v[56:59], a[244:247]
v_lshlrev_b32 v18, 16, v173
v_and_b32 v19, 0xffff0000, v173
v_mfma_f32_16x16x32_bf16 a[244:247], v[76:79], v[60:63], a[244:247]
buffer_load_dwordx4 v[68:71], v1, s[12:15], s33 offen offset:1024 sc1
v_mul_f32 v14, v14, v18
v_mfma_f32_16x16x32_bf16 a[248:251], v[80:83], v[56:59], a[248:251]
v_mul_f32 v15, v15, v19
v_cvt_pk_bf16_f32 v21, v14, v15
v_mfma_f32_16x16x32_bf16 a[248:251], v[84:87], v[60:63], a[248:251]
v_accvgpr_read_b32 v12, a83
v_accvgpr_read_b32 v13, a87
v_mfma_f32_16x16x32_bf16 a[252:255], v[88:91], v[56:59], a[252:255]
buffer_load_dwordx4 v[72:75], v1, s[12:15], s33 offen offset:2048 sc1
v_mfma_f32_16x16x32_bf16 a[252:255], v[92:95], v[60:63], a[252:255]
v_lshlrev_b32 v16, 16, v174
v_and_b32 v17, 0xffff0000, v174
s_waitcnt vmcnt(11) lgkmcnt(3)
v_mfma_f32_16x16x32_bf16 a[128:131], v[96:99], v[40:43], a[128:131]
ds_read_b128 v[56:59], v2 offset:53248
v_mfma_f32_16x16x32_bf16 a[128:131], v[100:103], v[44:47], a[128:131]
ds_read_b128 v[60:63], v3 offset:53248
buffer_load_dwordx4 v[76:79], v1, s[12:15], s33 offen offset:3072 sc1
s_waitcnt vmcnt(10)
v_mfma_f32_16x16x32_bf16 a[132:135], v[104:107], v[40:43], a[132:135]
v_mul_f32 v12, v12, v16
v_mfma_f32_16x16x32_bf16 a[132:135], v[108:111], v[44:47], a[132:135]
ds_read_b128 v[32:35], v6 offset:2048
v_mul_f32 v13, v13, v17
s_waitcnt vmcnt(8)
v_mfma_f32_16x16x32_bf16 a[136:139], v[112:115], v[40:43], a[136:139]
buffer_load_dwordx4 v[80:83], v1, s[12:15], s34 offen offset:0 sc1
v_mfma_f32_16x16x32_bf16 a[136:139], v[116:119], v[44:47], a[136:139]
v_cvt_pk_bf16_f32 v22, v12, v13
v_accvgpr_read_b32 v14, a91
s_waitcnt vmcnt(7)
v_mfma_f32_16x16x32_bf16 a[140:143], v[120:123], v[40:43], a[140:143]
v_accvgpr_read_b32 v15, a95
v_mfma_f32_16x16x32_bf16 a[140:143], v[124:127], v[44:47], a[140:143]
buffer_load_dwordx4 v[84:87], v1, s[12:15], s34 offen offset:1024 sc1
v_lshlrev_b32 v18, 16, v175
s_waitcnt lgkmcnt(3)
v_mfma_f32_16x16x32_bf16 a[144:147], v[96:99], v[48:51], a[144:147]
ds_read_b128 v[40:43], v2 offset:55296
v_mfma_f32_16x16x32_bf16 a[144:147], v[100:103], v[52:55], a[144:147]
ds_read_b128 v[44:47], v3 offset:55296
v_mfma_f32_16x16x32_bf16 a[148:151], v[104:107], v[48:51], a[148:151]
buffer_load_dwordx4 v[88:91], v1, s[12:15], s34 offen offset:2048 sc1
v_and_b32 v19, 0xffff0000, v175
v_mfma_f32_16x16x32_bf16 a[148:151], v[108:111], v[52:55], a[148:151]
ds_read_b128 v[36:39], v7 offset:3072
v_mul_f32 v14, v14, v18
v_mfma_f32_16x16x32_bf16 a[152:155], v[112:115], v[48:51], a[152:155]
v_mul_f32 v15, v15, v19
v_cvt_pk_bf16_f32 v23, v14, v15
v_mfma_f32_16x16x32_bf16 a[152:155], v[116:119], v[52:55], a[152:155]
buffer_load_dwordx4 v[92:95], v1, s[12:15], s34 offen offset:3072 sc1
s_add_u32 s33, s33, 0x8000
s_add_u32 s34, s34, 0x8000
v_mfma_f32_16x16x32_bf16 a[156:159], v[120:123], v[48:51], a[156:159]
s_add_u32 s6, s38, 0x2008000
s_waitcnt lgkmcnt(3)
buffer_store_dwordx4 v[32:35], v24, s[20:23], s6 offen sc1
v_mfma_f32_16x16x32_bf16 a[156:159], v[124:127], v[52:55], a[156:159]
v_mfma_f32_16x16x32_bf16 a[160:163], v[96:99], v[56:59], a[160:163]
ds_read_b128 v[48:51], v2 offset:57344
ds_write_b128 v5, v[20:23] offset:10240
v_mfma_f32_16x16x32_bf16 a[160:163], v[100:103], v[60:63], a[160:163]
ds_read_b128 v[52:55], v3 offset:57344
v_accvgpr_read_b32 v12, a98
v_mfma_f32_16x16x32_bf16 a[164:167], v[104:107], v[56:59], a[164:167]
v_accvgpr_read_b32 v13, a102
v_lshlrev_b32 v16, 16, v180
v_mfma_f32_16x16x32_bf16 a[164:167], v[108:111], v[60:63], a[164:167]
ds_read_b128 v[32:35], v6 offset:4096
v_and_b32 v17, 0xffff0000, v180
v_mfma_f32_16x16x32_bf16 a[168:171], v[112:115], v[56:59], a[168:171]
v_mul_f32 v12, v12, v16
v_mfma_f32_16x16x32_bf16 a[168:171], v[116:119], v[60:63], a[168:171]
v_mul_f32 v13, v13, v17
v_cvt_pk_bf16_f32 v20, v12, v13
v_mfma_f32_16x16x32_bf16 a[172:175], v[120:123], v[56:59], a[172:175]
s_add_u32 s6, s38, 0x200c000
s_waitcnt lgkmcnt(4)
buffer_store_dwordx4 v[36:39], v24, s[20:23], s6 offen sc1
v_mfma_f32_16x16x32_bf16 a[172:175], v[124:127], v[60:63], a[172:175]
v_accvgpr_read_b32 v14, a106
v_mfma_f32_16x16x32_bf16 a[176:179], v[96:99], v[40:43], a[176:179]
ds_read_b128 v[56:59], v2 offset:59392
v_accvgpr_read_b32 v15, a110
v_mfma_f32_16x16x32_bf16 a[176:179], v[100:103], v[44:47], a[176:179]
ds_read_b128 v[60:63], v3 offset:59392
v_lshlrev_b32 v18, 16, v181
v_mfma_f32_16x16x32_bf16 a[180:183], v[104:107], v[40:43], a[180:183]
v_and_b32 v19, 0xffff0000, v181
v_mul_f32 v14, v14, v18
v_mfma_f32_16x16x32_bf16 a[180:183], v[108:111], v[44:47], a[180:183]
v_mul_f32 v15, v15, v19
v_cvt_pk_bf16_f32 v21, v14, v15
v_mfma_f32_16x16x32_bf16 a[184:187], v[112:115], v[40:43], a[184:187]
v_accvgpr_read_b32 v12, a99
v_accvgpr_read_b32 v13, a103
v_mfma_f32_16x16x32_bf16 a[184:187], v[116:119], v[44:47], a[184:187]
v_lshlrev_b32 v16, 16, v182
v_and_b32 v17, 0xffff0000, v182
v_mfma_f32_16x16x32_bf16 a[188:191], v[120:123], v[40:43], a[188:191]
s_add_u32 s6, s38, 0x2010000
s_waitcnt lgkmcnt(2)
buffer_store_dwordx4 v[32:35], v24, s[20:23], s6 offen sc1
v_mfma_f32_16x16x32_bf16 a[188:191], v[124:127], v[44:47], a[188:191]
v_mul_f32 v12, v12, v16
v_mul_f32 v13, v13, v17
v_mfma_f32_16x16x32_bf16 a[192:195], v[96:99], v[48:51], a[192:195]
ds_read_b128 v[40:43], v2 offset:61440
v_cvt_pk_bf16_f32 v22, v12, v13
v_mfma_f32_16x16x32_bf16 a[192:195], v[100:103], v[52:55], a[192:195]
ds_read_b128 v[44:47], v3 offset:61440
v_accvgpr_read_b32 v14, a107
v_mfma_f32_16x16x32_bf16 a[196:199], v[104:107], v[48:51], a[196:199]
v_accvgpr_read_b32 v15, a111
v_lshlrev_b32 v18, 16, v183
v_mfma_f32_16x16x32_bf16 a[196:199], v[108:111], v[52:55], a[196:199]
v_and_b32 v19, 0xffff0000, v183
v_mul_f32 v14, v14, v18
v_mfma_f32_16x16x32_bf16 a[200:203], v[112:115], v[48:51], a[200:203]
v_mul_f32 v15, v15, v19
v_cvt_pk_bf16_f32 v23, v14, v15
v_mfma_f32_16x16x32_bf16 a[200:203], v[116:119], v[52:55], a[200:203]
ds_write_b128 v5, v[20:23] offset:12288
v_accvgpr_read_b32 v12, a114
v_mfma_f32_16x16x32_bf16 a[204:207], v[120:123], v[48:51], a[204:207]
v_accvgpr_read_b32 v13, a118
v_lshlrev_b32 v16, 16, v188
v_mfma_f32_16x16x32_bf16 a[204:207], v[124:127], v[52:55], a[204:207]
v_and_b32 v17, 0xffff0000, v188
v_mul_f32 v12, v12, v16
s_waitcnt lgkmcnt(3)
v_mfma_f32_16x16x32_bf16 a[208:211], v[96:99], v[56:59], a[208:211]
ds_read_b128 v[48:51], v2 offset:63488
v_mfma_f32_16x16x32_bf16 a[208:211], v[100:103], v[60:63], a[208:211]
ds_read_b128 v[52:55], v3 offset:63488
v_mul_f32 v13, v13, v17
v_mfma_f32_16x16x32_bf16 a[212:215], v[104:107], v[56:59], a[212:215]
v_cvt_pk_bf16_f32 v20, v12, v13
v_accvgpr_read_b32 v14, a122
v_mfma_f32_16x16x32_bf16 a[212:215], v[108:111], v[60:63], a[212:215]
v_accvgpr_read_b32 v15, a126
v_lshlrev_b32 v18, 16, v189
v_mfma_f32_16x16x32_bf16 a[216:219], v[112:115], v[56:59], a[216:219]
v_and_b32 v19, 0xffff0000, v189
v_mul_f32 v14, v14, v18
v_mfma_f32_16x16x32_bf16 a[216:219], v[116:119], v[60:63], a[216:219]
v_mul_f32 v15, v15, v19
v_cvt_pk_bf16_f32 v21, v14, v15
v_mfma_f32_16x16x32_bf16 a[220:223], v[120:123], v[56:59], a[220:223]
v_accvgpr_read_b32 v12, a115
v_accvgpr_read_b32 v13, a119
v_mfma_f32_16x16x32_bf16 a[220:223], v[124:127], v[60:63], a[220:223]
v_lshlrev_b32 v16, 16, v190
v_and_b32 v17, 0xffff0000, v190
s_waitcnt lgkmcnt(3)
v_mfma_f32_16x16x32_bf16 a[224:227], v[96:99], v[40:43], a[224:227]
v_mul_f32 v12, v12, v16
v_mfma_f32_16x16x32_bf16 a[224:227], v[100:103], v[44:47], a[224:227]
v_mul_f32 v13, v13, v17
v_cvt_pk_bf16_f32 v22, v12, v13
v_mfma_f32_16x16x32_bf16 a[228:231], v[104:107], v[40:43], a[228:231]
v_accvgpr_read_b32 v14, a123
v_accvgpr_read_b32 v15, a127
v_mfma_f32_16x16x32_bf16 a[228:231], v[108:111], v[44:47], a[228:231]
v_lshlrev_b32 v18, 16, v191
v_and_b32 v19, 0xffff0000, v191
v_mfma_f32_16x16x32_bf16 a[232:235], v[112:115], v[40:43], a[232:235]
v_mul_f32 v14, v14, v18
v_mul_f32 v15, v15, v19
v_mfma_f32_16x16x32_bf16 a[232:235], v[116:119], v[44:47], a[232:235]
v_cvt_pk_bf16_f32 v23, v14, v15
ds_write_b128 v5, v[20:23] offset:14336
v_mfma_f32_16x16x32_bf16 a[236:239], v[120:123], v[40:43], a[236:239]
v_mfma_f32_16x16x32_bf16 a[236:239], v[124:127], v[44:47], a[236:239]
s_waitcnt lgkmcnt(1)
s_waitcnt lgkmcnt(0)
s_barrier
v_xor_b32 v2, 0x10000, v2
v_xor_b32 v3, 0x10000, v3
v_mfma_f32_16x16x32_bf16 a[240:243], v[96:99], v[48:51], a[240:243]
ds_read_b128 v[56:59], v2 offset:0
buffer_load_dwordx4 v[96:99], v1, s[12:15], s33 offen offset:0 sc1
v_mfma_f32_16x16x32_bf16 a[240:243], v[100:103], v[52:55], a[240:243]
ds_read_b128 v[60:63], v3 offset:0
v_mfma_f32_16x16x32_bf16 a[244:247], v[104:107], v[48:51], a[244:247]
ds_read_b128 v[40:43], v2 offset:2048
v_mfma_f32_16x16x32_bf16 a[244:247], v[108:111], v[52:55], a[244:247]
ds_read_b128 v[44:47], v3 offset:2048
buffer_load_dwordx4 v[100:103], v1, s[12:15], s33 offen offset:1024 sc1
v_mfma_f32_16x16x32_bf16 a[248:251], v[112:115], v[48:51], a[248:251]
v_xor_b32 v4, 0x10000, v4
v_mfma_f32_16x16x32_bf16 a[248:251], v[116:119], v[52:55], a[248:251]
v_xor_b32 v5, 0x10000, v5
v_accvgpr_read_b32 v12, a128
v_mfma_f32_16x16x32_bf16 a[252:255], v[120:123], v[48:51], a[252:255]
buffer_load_dwordx4 v[104:107], v1, s[12:15], s33 offen offset:2048 sc1
v_accvgpr_read_b32 v13, a132
v_mfma_f32_16x16x32_bf16 a[252:255], v[124:127], v[52:55], a[252:255]
v_lshlrev_b32 v16, 16, v192
v_and_b32 v17, 0xffff0000, v192
s_waitcnt vmcnt(12) lgkmcnt(2)
L_cs4:
v_mfma_f32_16x16x32_bf16 a[0:3], v[64:67], v[56:59], a[0:3]
ds_read_b128 v[48:51], v2 offset:4096
v_mfma_f32_16x16x32_bf16 a[0:3], v[68:71], v[60:63], a[0:3]
ds_read_b128 v[52:55], v3 offset:4096
buffer_load_dwordx4 v[108:111], v1, s[12:15], s33 offen offset:3072 sc1
s_waitcnt vmcnt(11)
v_mfma_f32_16x16x32_bf16 a[4:7], v[72:75], v[56:59], a[4:7]
v_mul_f32 v12, v12, v16
v_mfma_f32_16x16x32_bf16 a[4:7], v[76:79], v[60:63], a[4:7]
ds_read_b128 v[36:39], v7 offset:5120
v_mul_f32 v13, v13, v17
s_waitcnt vmcnt(9)
v_mfma_f32_16x16x32_bf16 a[8:11], v[80:83], v[56:59], a[8:11]
buffer_load_dwordx4 v[112:115], v1, s[12:15], s34 offen offset:0 sc1
v_mfma_f32_16x16x32_bf16 a[8:11], v[84:87], v[60:63], a[8:11]
v_cvt_pk_bf16_f32 v20, v12, v13
v_accvgpr_read_b32 v14, a136
s_waitcnt vmcnt(8)
v_mfma_f32_16x16x32_bf16 a[12:15], v[88:91], v[56:59], a[12:15]
v_accvgpr_read_b32 v15, a140
v_mfma_f32_16x16x32_bf16 a[12:15], v[92:95], v[60:63], a[12:15]
buffer_load_dwordx4 v[116:119], v1, s[12:15], s34 offen offset:1024 sc1
s_waitcnt lgkmcnt(3)
v_mfma_f32_16x16x32_bf16 a[16:19], v[64:67], v[40:43], a[16:19]
ds_read_b128 v[56:59], v2 offset:6144
v_mfma_f32_16x16x32_bf16 a[16:19], v[68:71], v[44:47], a[16:19]
ds_read_b128 v[60:63], v3 offset:6144
v_lshlrev_b32 v18, 16, v193
v_mfma_f32_16x16x32_bf16 a[20:23], v[72:75], v[40:43], a[20:23]
buffer_load_dwordx4 v[120:123], v1, s[12:15], s34 offen offset:2048 sc1
v_and_b32 v19, 0xffff0000, v193
v_mfma_f32_16x16x32_bf16 a[20:23], v[76:79], v[44:47], a[20:23]
ds_read_b128 v[32:35], v6 offset:6144
v_mul_f32 v14, v14, v18
v_mfma_f32_16x16x32_bf16 a[24:27], v[80:83], v[40:43], a[24:27]
v_mul_f32 v15, v15, v19
v_cvt_pk_bf16_f32 v21, v14, v15
v_mfma_f32_16x16x32_bf16 a[24:27], v[84:87], v[44:47], a[24:27]
buffer_load_dwordx4 v[124:127], v1, s[12:15], s34 offen offset:3072 sc1
s_add_u32 s33, s33, 0x8000
s_add_u32 s34, s34, 0x8000
v_mfma_f32_16x16x32_bf16 a[28:31], v[88:91], v[40:43], a[28:31]
s_add_u32 s6, s38, 0x2014000
s_waitcnt lgkmcnt(3)
buffer_store_dwordx4 v[36:39], v24, s[20:23], s6 offen sc1
v_mfma_f32_16x16x32_bf16 a[28:31], v[92:95], v[44:47], a[28:31]
v_mfma_f32_16x16x32_bf16 a[32:35], v[64:67], v[48:51], a[32:35]
ds_read_b128 v[40:43], v2 offset:8192
v_accvgpr_read_b32 v12, a129
v_mfma_f32_16x16x32_bf16 a[32:35], v[68:71], v[52:55], a[32:35]
ds_read_b128 v[44:47], v3 offset:8192
v_accvgpr_read_b32 v13, a133
v_mfma_f32_16x16x32_bf16 a[36:39], v[72:75], v[48:51], a[36:39]
v_lshlrev_b32 v16, 16, v194
v_and_b32 v17, 0xffff0000, v194
v_mfma_f32_16x16x32_bf16 a[36:39], v[76:79], v[52:55], a[36:39]
ds_read_b128 v[36:39], v7 offset:7168
v_mfma_f32_16x16x32_bf16 a[40:43], v[80:83], v[48:51], a[40:43]
v_mul_f32 v12, v12, v16
v_mul_f32 v13, v13, v17
v_mfma_f32_16x16x32_bf16 a[40:43], v[84:87], v[52:55], a[40:43]
v_cvt_pk_bf16_f32 v22, v12, v13
v_accvgpr_read_b32 v14, a137
v_mfma_f32_16x16x32_bf16 a[44:47], v[88:91], v[48:51], a[44:47]
s_add_u32 s6, s38, 0x2018000
s_waitcnt lgkmcnt(3)
buffer_store_dwordx4 v[32:35], v24, s[20:23], s6 offen sc1
v_mfma_f32_16x16x32_bf16 a[44:47], v[92:95], v[52:55], a[44:47]
v_accvgpr_read_b32 v15, a141
v_mfma_f32_16x16x32_bf16 a[48:51], v[64:67], v[56:59], a[48:51]
ds_read_b128 v[48:51], v2 offset:10240
v_lshlrev_b32 v18, 16, v195
v_mfma_f32_16x16x32_bf16 a[48:51], v[68:71], v[60:63], a[48:51]
ds_read_b128 v[52:55], v3 offset:10240
v_and_b32 v19, 0xffff0000, v195
v_mfma_f32_16x16x32_bf16 a[52:55], v[72:75], v[56:59], a[52:55]
v_mul_f32 v14, v14, v18
v_mul_f32 v15, v15, v19
v_mfma_f32_16x16x32_bf16 a[52:55], v[76:79], v[60:63], a[52:55]
v_cvt_pk_bf16_f32 v23, v14, v15
ds_write_b128 v4, v[20:23] offset:0
v_mfma_f32_16x16x32_bf16 a[56:59], v[80:83], v[56:59], a[56:59]
v_accvgpr_read_b32 v12, a144
v_accvgpr_read_b32 v13, a148
v_mfma_f32_16x16x32_bf16 a[56:59], v[84:87], v[60:63], a[56:59]
v_lshlrev_b32 v16, 16, v200
v_and_b32 v17, 0xffff0000, v200
v_mfma_f32_16x16x32_bf16 a[60:63], v[88:91], v[56:59], a[60:63]
s_add_u32 s6, s38, 0x201c000
s_waitcnt lgkmcnt(3)
buffer_store_dwordx4 v[36:39], v24, s[20:23], s6 offen sc1
v_mfma_f32_16x16x32_bf16 a[60:63], v[92:95], v[60:63], a[60:63]
v_mfma_f32_16x16x32_bf16 a[64:67], v[64:67], v[40:43], a[64:67]
ds_read_b128 v[56:59], v2 offset:12288
v_mul_f32 v12, v12, v16
v_mfma_f32_16x16x32_bf16 a[64:67], v[68:71], v[44:47], a[64:67]
ds_read_b128 v[60:63], v3 offset:12288
v_mul_f32 v13, v13, v17
v_mfma_f32_16x16x32_bf16 a[68:71], v[72:75], v[40:43], a[68:71]
v_cvt_pk_bf16_f32 v20, v12, v13
v_accvgpr_read_b32 v14, a152
v_mfma_f32_16x16x32_bf16 a[68:71], v[76:79], v[44:47], a[68:71]
v_accvgpr_read_b32 v15, a156
v_lshlrev_b32 v18, 16, v201
v_mfma_f32_16x16x32_bf16 a[72:75], v[80:83], v[40:43], a[72:75]
v_and_b32 v19, 0xffff0000, v201
v_mul_f32 v14, v14, v18
v_mfma_f32_16x16x32_bf16 a[72:75], v[84:87], v[44:47], a[72:75]
ds_read_b32 v28, v10 offset:4096
v_mul_f32 v15, v15, v19
v_mfma_f32_16x16x32_bf16 a[76:79], v[88:91], v[40:43], a[76:79]
v_cvt_pk_bf16_f32 v21, v14, v15
v_accvgpr_read_b32 v12, a145
v_mfma_f32_16x16x32_bf16 a[76:79], v[92:95], v[44:47], a[76:79]
v_accvgpr_read_b32 v13, a149
v_lshlrev_b32 v16, 16, v202
s_waitcnt lgkmcnt(4)
v_mfma_f32_16x16x32_bf16 a[80:83], v[64:67], v[48:51], a[80:83]
ds_read_b128 v[40:43], v2 offset:14336
v_mfma_f32_16x16x32_bf16 a[80:83], v[68:71], v[52:55], a[80:83]
ds_read_b128 v[44:47], v3 offset:14336
v_and_b32 v17, 0xffff0000, v202
v_mfma_f32_16x16x32_bf16 a[84:87], v[72:75], v[48:51], a[84:87]
v_mul_f32 v12, v12, v16
v_mul_f32 v13, v13, v17
v_mfma_f32_16x16x32_bf16 a[84:87], v[76:79], v[52:55], a[84:87]
v_cvt_pk_bf16_f32 v22, v12, v13
v_accvgpr_read_b32 v14, a153
v_mfma_f32_16x16x32_bf16 a[88:91], v[80:83], v[48:51], a[88:91]
v_accvgpr_read_b32 v15, a157
v_mfma_f32_16x16x32_bf16 a[88:91], v[84:87], v[52:55], a[88:91]
v_lshlrev_b32 v18, 16, v203
v_and_b32 v19, 0xffff0000, v203
v_mfma_f32_16x16x32_bf16 a[92:95], v[88:91], v[48:51], a[92:95]
v_mul_f32 v14, v14, v18
v_mul_f32 v15, v15, v19
v_mfma_f32_16x16x32_bf16 a[92:95], v[92:95], v[52:55], a[92:95]
v_cvt_pk_bf16_f32 v23, v14, v15
ds_write_b128 v4, v[20:23] offset:2048
s_waitcnt lgkmcnt(4)
v_mfma_f32_16x16x32_bf16 a[96:99], v[64:67], v[56:59], a[96:99]
ds_read_b128 v[48:51], v2 offset:16384
v_mfma_f32_16x16x32_bf16 a[96:99], v[68:71], v[60:63], a[96:99]
ds_read_b128 v[52:55], v3 offset:16384
v_accvgpr_read_b32 v12, a160
v_mfma_f32_16x16x32_bf16 a[100:103], v[72:75], v[56:59], a[100:103]
v_accvgpr_read_b32 v13, a164
v_lshlrev_b32 v16, 16, v208
v_mfma_f32_16x16x32_bf16 a[100:103], v[76:79], v[60:63], a[100:103]
v_and_b32 v17, 0xffff0000, v208
v_mul_f32 v12, v12, v16
v_mfma_f32_16x16x32_bf16 a[104:107], v[80:83], v[56:59], a[104:107]
v_mul_f32 v13, v13, v17
v_cvt_pk_bf16_f32 v20, v12, v13
v_mfma_f32_16x16x32_bf16 a[104:107], v[84:87], v[60:63], a[104:107]
v_accvgpr_read_b32 v14, a168
v_accvgpr_read_b32 v15, a172
v_mfma_f32_16x16x32_bf16 a[108:111], v[88:91], v[56:59], a[108:111]
v_lshlrev_b32 v18, 16, v209
v_and_b32 v19, 0xffff0000, v209
v_mfma_f32_16x16x32_bf16 a[108:111], v[92:95], v[60:63], a[108:111]
v_mul_f32 v14, v14, v18
v_mul_f32 v15, v15, v19
s_waitcnt lgkmcnt(3)
v_mfma_f32_16x16x32_bf16 a[112:115], v[64:67], v[40:43], a[112:115]
ds_read_b128 v[56:59], v2 offset:18432
buffer_load_dwordx4 v[64:67], v1, s[12:15], s33 offen offset:0 sc1
v_mfma_f32_16x16x32_bf16 a[112:115], v[68:71], v[44:47], a[112:115]
ds_read_b128 v[60:63], v3 offset:18432
v_mfma_f32_16x16x32_bf16 a[116:119], v[72:75], v[40:43], a[116:119]
v_cvt_pk_bf16_f32 v21, v14, v15
v_mfma_f32_16x16x32_bf16 a[116:119], v[76:79], v[44:47], a[116:119]
buffer_load_dwordx4 v[68:71], v1, s[12:15], s33 offen offset:1024 sc1
v_accvgpr_read_b32 v12, a161
v_mfma_f32_16x16x32_bf16 a[120:123], v[80:83], v[40:43], a[120:123]
v_accvgpr_read_b32 v13, a165
v_lshlrev_b32 v16, 16, v210
v_mfma_f32_16x16x32_bf16 a[120:123], v[84:87], v[44:47], a[120:123]
v_and_b32 v17, 0xffff0000, v210
v_mul_f32 v12, v12, v16
v_mfma_f32_16x16x32_bf16 a[124:127], v[88:91], v[40:43], a[124:127]
buffer_load_dwordx4 v[72:75], v1, s[12:15], s33 offen offset:2048 sc1
v_mul_f32 v13, v13, v17
v_mfma_f32_16x16x32_bf16 a[124:127], v[92:95], v[44:47], a[124:127]
v_cvt_pk_bf16_f32 v22, v12, v13
v_accvgpr_read_b32 v14, a169
s_waitcnt vmcnt(12) lgkmcnt(2)
v_mfma_f32_16x16x32_bf16 a[0:3], v[96:99], v[48:51], a[0:3]
ds_read_b128 v[40:43], v2 offset:20480
v_mfma_f32_16x16x32_bf16 a[0:3], v[100:103], v[52:55], a[0:3]
ds_read_b128 v[44:47], v3 offset:20480
buffer_load_dwordx4 v[76:79], v1, s[12:15], s33 offen offset:3072 sc1
s_waitcnt vmcnt(11)
v_mfma_f32_16x16x32_bf16 a[4:7], v[104:107], v[48:51], a[4:7]
v_accvgpr_read_b32 v15, a173
v_mfma_f32_16x16x32_bf16 a[4:7], v[108:111], v[52:55], a[4:7]
ds_read_b128 v[32:35], v6 offset:8192
v_lshlrev_b32 v18, 16, v211
s_waitcnt vmcnt(9)
v_mfma_f32_16x16x32_bf16 a[8:11], v[112:115], v[48:51], a[8:11]
buffer_load_dwordx4 v[80:83], v1, s[12:15], s34 offen offset:0 sc1
v_mfma_f32_16x16x32_bf16 a[8:11], v[116:119], v[52:55], a[8:11]
v_and_b32 v19, 0xffff0000, v211
v_mul_f32 v14, v14, v18
v_mfma_f32_16x16x4_4b_bf16 a[64:79], v[28:29], v[30:31], a[64:79]
v_mul_f32 v15, v15, v19
v_cvt_pk_bf16_f32 v23, v14, v15
ds_write_b128 v4, v[20:23] offset:4096
v_accvgpr_read_b32 v12, a176
v_accvgpr_read_b32 v13, a180
v_lshlrev_b32 v16, 16, v216
v_and_b32 v17, 0xffff0000, v216
v_mul_f32 v12, v12, v16
v_mul_f32 v13, v13, v17
v_cvt_pk_bf16_f32 v20, v12, v13
s_waitcnt vmcnt(8)
v_mfma_f32_16x16x32_bf16 a[12:15], v[120:123], v[48:51], a[12:15]
v_accvgpr_read_b32 v14, a184
v_mfma_f32_16x16x32_bf16 a[12:15], v[124:127], v[52:55], a[12:15]
buffer_load_dwordx4 v[84:87], v1, s[12:15], s34 offen offset:1024 sc1
s_waitcnt lgkmcnt(4)
v_mfma_f32_16x16x32_bf16 a[16:19], v[96:99], v[56:59], a[16:19]
ds_read_b128 v[48:51], v2 offset:22528
v_mfma_f32_16x16x32_bf16 a[16:19], v[100:103], v[60:63], a[16:19]
ds_read_b128 v[52:55], v3 offset:22528
v_accvgpr_read_b32 v15, a188
v_mfma_f32_16x16x32_bf16 a[20:23], v[104:107], v[56:59], a[20:23]
buffer_load_dwordx4 v[88:91], v1, s[12:15], s34 offen offset:2048 sc1
v_lshlrev_b32 v18, 16, v217
v_mfma_f32_16x16x32_bf16 a[20:23], v[108:111], v[60:63], a[20:23]
ds_read_b128 v[36:39], v7 offset:9216
v_and_b32 v19, 0xffff0000, v217
v_mfma_f32_16x16x32_bf16 a[24:27], v[112:115], v[56:59], a[24:27]
v_mul_f32 v14, v14, v18
v_mul_f32 v15, v15, v19
v_mfma_f32_16x16x32_bf16 a[24:27], v[116:119], v[60:63], a[24:27]
buffer_load_dwordx4 v[92:95], v1, s[12:15], s34 offen offset:3072 sc1
s_add_u32 s33, s33, 0x8000
s_add_u32 s34, s34, 0x8000
v_mfma_f32_16x16x4_4b_bf16 a[80:95], v[28:29], v[30:31], a[80:95]
v_cvt_pk_bf16_f32 v21, v14, v15
v_accvgpr_read_b32 v12, a177
v_accvgpr_read_b32 v13, a181
v_lshlrev_b32 v16, 16, v218
v_and_b32 v17, 0xffff0000, v218
v_mul_f32 v12, v12, v16
v_mul_f32 v13, v13, v17
v_cvt_pk_bf16_f32 v22, v12, v13
v_accvgpr_read_b32 v14, a185
v_mfma_f32_16x16x32_bf16 a[28:31], v[120:123], v[56:59], a[28:31]
s_add_u32 s6, s38, 0x2020000
s_waitcnt lgkmcnt(4)
buffer_store_dwordx4 v[32:35], v24, s[20:23], s6 offen sc1
v_mfma_f32_16x16x32_bf16 a[28:31], v[124:127], v[60:63], a[28:31]
v_accvgpr_read_b32 v15, a189
v_mfma_f32_16x16x32_bf16 a[32:35], v[96:99], v[40:43], a[32:35]
ds_read_b128 v[56:59], v2 offset:24576
v_lshlrev_b32 v18, 16, v219
v_mfma_f32_16x16x32_bf16 a[32:35], v[100:103], v[44:47], a[32:35]
ds_read_b128 v[60:63], v3 offset:24576
v_and_b32 v19, 0xffff0000, v219
v_mfma_f32_16x16x32_bf16 a[36:39], v[104:107], v[40:43], a[36:39]
v_mul_f32 v14, v14, v18
v_mul_f32 v15, v15, v19
v_mfma_f32_16x16x32_bf16 a[36:39], v[108:111], v[44:47], a[36:39]
ds_read_b128 v[32:35], v6 offset:10240
v_cvt_pk_bf16_f32 v23, v14, v15
v_mfma_f32_16x16x32_bf16 a[40:43], v[112:115], v[40:43], a[40:43]
ds_write_b128 v4, v[20:23] offset:6144
v_accvgpr_read_b32 v12, a192
v_mfma_f32_16x16x32_bf16 a[40:43], v[116:119], v[44:47], a[40:43]
v_accvgpr_read_b32 v13, a196
v_mfma_f32_16x16x4_4b_bf16 a[96:111], v[28:29], v[30:31], a[96:111]
v_lshlrev_b32 v16, 16, v224
v_and_b32 v17, 0xffff0000, v224
v_mul_f32 v12, v12, v16
v_mul_f32 v13, v13, v17
v_cvt_pk_bf16_f32 v20, v12, v13
v_accvgpr_read_b32 v14, a200
v_accvgpr_read_b32 v15, a204
v_lshlrev_b32 v18, 16, v225
v_and_b32 v19, 0xffff0000, v225
v_mul_f32 v14, v14, v18
v_mfma_f32_16x16x32_bf16 a[44:47], v[120:123], v[40:43], a[44:47]
s_add_u32 s6, s38, 0x2024000
s_waitcnt lgkmcnt(4)
buffer_store_dwordx4 v[36:39], v24, s[20:23], s6 offen sc1
v_mfma_f32_16x16x32_bf16 a[44:47], v[124:127], v[44:47], a[44:47]
v_mul_f32 v15, v15, v19
v_mfma_f32_16x16x32_bf16 a[48:51], v[96:99], v[48:51], a[48:51]
ds_read_b128 v[40:43], v2 offset:26624
v_cvt_pk_bf16_f32 v21, v14, v15
v_mfma_f32_16x16x32_bf16 a[48:51], v[100:103], v[52:55], a[48:51]
ds_read_b128 v[44:47], v3 offset:26624
v_accvgpr_read_b32 v12, a193
v_mfma_f32_16x16x32_bf16 a[52:55], v[104:107], v[48:51], a[52:55]
v_accvgpr_read_b32 v13, a197
v_lshlrev_b32 v16, 16, v226
v_mfma_f32_16x16x32_bf16 a[52:55], v[108:111], v[52:55], a[52:55]
v_and_b32 v17, 0xffff0000, v226
v_mul_f32 v12, v12, v16
v_mfma_f32_16x16x32_bf16 a[56:59], v[112:115], v[48:51], a[56:59]
v_mul_f32 v13, v13, v17
v_cvt_pk_bf16_f32 v22, v12, v13
v_mfma_f32_16x16x32_bf16 a[56:59], v[116:119], v[52:55], a[56:59]
v_accvgpr_read_b32 v14, a201
v_accvgpr_read_b32 v15, a205
v_mfma_f32_16x16x4_4b_bf16 a[112:127], v[28:29], v[30:31], a[112:127]
v_lshlrev_b32 v18, 16, v227
v_and_b32 v19, 0xffff0000, v227
v_mul_f32 v14, v14, v18
v_mul_f32 v15, v15, v19
v_cvt_pk_bf16_f32 v23, v14, v15
ds_write_b128 v4, v[20:23] offset:8192
v_accvgpr_read_b32 v12, a208
v_accvgpr_read_b32 v13, a212
v_lshlrev_b32 v16, 16, v232
v_and_b32 v17, 0xffff0000, v232
v_mfma_f32_16x16x32_bf16 a[60:63], v[120:123], v[48:51], a[60:63]
s_add_u32 s6, s38, 0x2028000
s_waitcnt lgkmcnt(4)
buffer_store_dwordx4 v[32:35], v24, s[20:23], s6 offen sc1
v_mfma_f32_16x16x32_bf16 a[60:63], v[124:127], v[52:55], a[60:63]
v_mul_f32 v12, v12, v16
v_mfma_f32_16x16x32_bf16 a[64:67], v[96:99], v[56:59], a[64:67]
ds_read_b128 v[48:51], v2 offset:28672
v_mul_f32 v13, v13, v17
v_mfma_f32_16x16x32_bf16 a[64:67], v[100:103], v[60:63], a[64:67]
ds_read_b128 v[52:55], v3 offset:28672
v_cvt_pk_bf16_f32 v20, v12, v13
v_mfma_f32_16x16x32_bf16 a[68:71], v[104:107], v[56:59], a[68:71]
v_accvgpr_read_b32 v14, a216
v_accvgpr_read_b32 v15, a220
v_mfma_f32_16x16x32_bf16 a[68:71], v[108:111], v[60:63], a[68:71]
v_lshlrev_b32 v18, 16, v233
v_and_b32 v19, 0xffff0000, v233
v_mfma_f32_16x16x32_bf16 a[72:75], v[112:115], v[56:59], a[72:75]
v_mul_f32 v14, v14, v18
v_mul_f32 v15, v15, v19
v_mfma_f32_16x16x32_bf16 a[72:75], v[116:119], v[60:63], a[72:75]
v_cvt_pk_bf16_f32 v21, v14, v15
v_accvgpr_read_b32 v12, a209
v_mfma_f32_16x16x4_4b_bf16 a[0:15], v[28:29], v[30:31], a[0:15]
v_accvgpr_read_b32 v13, a213
v_lshlrev_b32 v16, 16, v234
v_and_b32 v17, 0xffff0000, v234
v_mul_f32 v12, v12, v16
v_mul_f32 v13, v13, v17
v_cvt_pk_bf16_f32 v22, v12, v13
v_accvgpr_read_b32 v14, a217
v_accvgpr_read_b32 v15, a221
v_lshlrev_b32 v18, 16, v235
v_and_b32 v19, 0xffff0000, v235
v_mfma_f32_16x16x32_bf16 a[76:79], v[120:123], v[56:59], a[76:79]
v_mul_f32 v14, v14, v18
v_mfma_f32_16x16x32_bf16 a[76:79], v[124:127], v[60:63], a[76:79]
v_mul_f32 v15, v15, v19
v_cvt_pk_bf16_f32 v23, v14, v15
s_waitcnt lgkmcnt(3)
v_mfma_f32_16x16x32_bf16 a[80:83], v[96:99], v[40:43], a[80:83]
ds_read_b128 v[56:59], v2 offset:30720
v_mfma_f32_16x16x32_bf16 a[80:83], v[100:103], v[44:47], a[80:83]
ds_read_b128 v[60:63], v3 offset:30720
ds_write_b128 v4, v[20:23] offset:10240
v_mfma_f32_16x16x32_bf16 a[84:87], v[104:107], v[40:43], a[84:87]
v_accvgpr_read_b32 v12, a224
v_accvgpr_read_b32 v13, a228
v_mfma_f32_16x16x32_bf16 a[84:87], v[108:111], v[44:47], a[84:87]
v_lshlrev_b32 v16, 16, v240
v_and_b32 v17, 0xffff0000, v240
v_mfma_f32_16x16x32_bf16 a[88:91], v[112:115], v[40:43], a[88:91]
v_mul_f32 v12, v12, v16
v_mul_f32 v13, v13, v17
v_mfma_f32_16x16x32_bf16 a[88:91], v[116:119], v[44:47], a[88:91]
v_cvt_pk_bf16_f32 v20, v12, v13
v_accvgpr_read_b32 v14, a232
v_mfma_f32_16x16x4_4b_bf16 a[16:31], v[28:29], v[30:31], a[16:31]
v_accvgpr_read_b32 v15, a236
v_lshlrev_b32 v18, 16, v241
v_and_b32 v19, 0xffff0000, v241
v_mul_f32 v14, v14, v18
v_mul_f32 v15, v15, v19
v_cvt_pk_bf16_f32 v21, v14, v15
v_accvgpr_read_b32 v12, a225
v_accvgpr_read_b32 v13, a229
v_lshlrev_b32 v16, 16, v242
v_and_b32 v17, 0xffff0000, v242
v_mfma_f32_16x16x32_bf16 a[92:95], v[120:123], v[40:43], a[92:95]
v_mul_f32 v12, v12, v16
v_mul_f32 v13, v13, v17
v_mfma_f32_16x16x32_bf16 a[92:95], v[124:127], v[44:47], a[92:95]
v_cvt_pk_bf16_f32 v22, v12, v13
v_accvgpr_read_b32 v14, a233
s_waitcnt lgkmcnt(3)
v_mfma_f32_16x16x32_bf16 a[96:99], v[96:99], v[48:51], a[96:99]
ds_read_b128 v[40:43], v2 offset:32768
v_mfma_f32_16x16x32_bf16 a[96:99], v[100:103], v[52:55], a[96:99]
ds_read_b128 v[44:47], v3 offset:32768
v_accvgpr_read_b32 v15, a237
v_mfma_f32_16x16x32_bf16 a[100:103], v[104:107], v[48:51], a[100:103]
v_lshlrev_b32 v18, 16, v243
v_and_b32 v19, 0xffff0000, v243
v_mfma_f32_16x16x32_bf16 a[100:103], v[108:111], v[52:55], a[100:103]
v_mul_f32 v14, v14, v18
v_mul_f32 v15, v15, v19
v_mfma_f32_16x16x32_bf16 a[104:107], v[112:115], v[48:51], a[104:107]
v_cvt_pk_bf16_f32 v23, v14, v15
ds_write_b128 v4, v[20:23] offset:12288
v_mfma_f32_16x16x32_bf16 a[104:107], v[116:119], v[52:55], a[104:107]
v_accvgpr_read_b32 v12, a240
v_accvgpr_read_b32 v13, a244
v_mfma_f32_16x16x4_4b_bf16 a[32:47], v[28:29], v[30:31], a[32:47]
v_lshlrev_b32 v16, 16, v248
v_and_b32 v17, 0xffff0000, v248
v_mul_f32 v12, v12, v16
v_mul_f32 v13, v13, v17
v_cvt_pk_bf16_f32 v20, v12, v13
v_accvgpr_read_b32 v14, a248
v_accvgpr_read_b32 v15, a252
v_lshlrev_b32 v18, 16, v249
v_and_b32 v19, 0xffff0000, v249
v_mul_f32 v14, v14, v18
v_mfma_f32_16x16x32_bf16 a[108:111], v[120:123], v[48:51], a[108:111]
v_mul_f32 v15, v15, v19
v_cvt_pk_bf16_f32 v21, v14, v15
v_mfma_f32_16x16x32_bf16 a[108:111], v[124:127], v[52:55], a[108:111]
v_accvgpr_read_b32 v12, a241
s_waitcnt lgkmcnt(4)
v_mfma_f32_16x16x32_bf16 a[112:115], v[96:99], v[56:59], a[112:115]
ds_read_b128 v[48:51], v2 offset:34816
buffer_load_dwordx4 v[96:99], v1, s[12:15], s33 offen offset:0 sc1
v_mfma_f32_16x16x32_bf16 a[112:115], v[100:103], v[60:63], a[112:115]
ds_read_b128 v[52:55], v3 offset:34816
v_mfma_f32_16x16x32_bf16 a[116:119], v[104:107], v[56:59], a[116:119]
v_accvgpr_read_b32 v13, a245
v_lshlrev_b32 v16, 16, v250
v_mfma_f32_16x16x32_bf16 a[116:119], v[108:111], v[60:63], a[116:119]
buffer_load_dwordx4 v[100:103], v1, s[12:15], s33 offen offset:1024 sc1
v_and_b32 v17, 0xffff0000, v250
v_mfma_f32_16x16x32_bf16 a[120:123], v[112:115], v[56:59], a[120:123]
v_mul_f32 v12, v12, v16
v_mul_f32 v13, v13, v17
v_mfma_f32_16x16x32_bf16 a[120:123], v[116:119], v[60:63], a[120:123]
v_cvt_pk_bf16_f32 v22, v12, v13
v_accvgpr_read_b32 v14, a249
v_mfma_f32_16x16x4_4b_bf16 a[48:63], v[28:29], v[30:31], a[48:63]
v_accvgpr_read_b32 v15, a253
v_lshlrev_b32 v18, 16, v251
v_and_b32 v19, 0xffff0000, v251
v_mul_f32 v14, v14, v18
v_mul_f32 v15, v15, v19
v_cvt_pk_bf16_f32 v23, v14, v15
ds_write_b128 v4, v[20:23] offset:14336
v_accvgpr_read_b32 v12, a130
v_accvgpr_read_b32 v13, a134
v_lshlrev_b32 v16, 16, v196
v_mfma_f32_16x16x32_bf16 a[124:127], v[120:123], v[56:59], a[124:127]
buffer_load_dwordx4 v[104:107], v1, s[12:15], s33 offen offset:2048 sc1
v_and_b32 v17, 0xffff0000, v196
v_mfma_f32_16x16x32_bf16 a[124:127], v[124:127], v[60:63], a[124:127]
v_mul_f32 v12, v12, v16
v_mul_f32 v13, v13, v17
s_waitcnt vmcnt(12) lgkmcnt(4)
v_mfma_f32_16x16x32_bf16 a[0:3], v[64:67], v[40:43], a[0:3]
ds_read_b128 v[56:59], v2 offset:36864
v_mfma_f32_16x16x32_bf16 a[0:3], v[68:71], v[44:47], a[0:3]
ds_read_b128 v[60:63], v3 offset:36864
buffer_load_dwordx4 v[108:111], v1, s[12:15], s33 offen offset:3072 sc1
s_waitcnt vmcnt(11)
v_mfma_f32_16x16x32_bf16 a[4:7], v[72:75], v[40:43], a[4:7]
v_cvt_pk_bf16_f32 v20, v12, v13
v_mfma_f32_16x16x32_bf16 a[4:7], v[76:79], v[44:47], a[4:7]
ds_read_b128 v[36:39], v7 offset:11264
v_accvgpr_read_b32 v14, a138
s_waitcnt vmcnt(9)
v_mfma_f32_16x16x32_bf16 a[8:11], v[80:83], v[40:43], a[8:11]
buffer_load_dwordx4 v[112:115], v1, s[12:15], s34 offen offset:0 sc1
v_mfma_f32_16x16x32_bf16 a[8:11], v[84:87], v[44:47], a[8:11]
v_accvgpr_read_b32 v15, a142
v_lshlrev_b32 v18, 16, v197
s_waitcnt vmcnt(8)
v_mfma_f32_16x16x32_bf16 a[12:15], v[88:91], v[40:43], a[12:15]
v_and_b32 v19, 0xffff0000, v197
v_mfma_f32_16x16x32_bf16 a[12:15], v[92:95], v[44:47], a[12:15]
buffer_load_dwordx4 v[116:119], v1, s[12:15], s34 offen offset:1024 sc1
v_mul_f32 v14, v14, v18
s_waitcnt lgkmcnt(4)
v_mfma_f32_16x16x32_bf16 a[16:19], v[64:67], v[48:51], a[16:19]
ds_read_b128 v[40:43], v2 offset:38912
v_mfma_f32_16x16x32_bf16 a[16:19], v[68:71], v[52:55], a[16:19]
ds_read_b128 v[44:47], v3 offset:38912
v_mfma_f32_16x16x32_bf16 a[20:23], v[72:75], v[48:51], a[20:23]
buffer_load_dwordx4 v[120:123], v1, s[12:15], s34 offen offset:2048 sc1
v_mul_f32 v15, v15, v19
v_mfma_f32_16x16x32_bf16 a[20:23], v[76:79], v[52:55], a[20:23]
ds_read_b128 v[32:35], v6 offset:12288
v_cvt_pk_bf16_f32 v21, v14, v15
v_mfma_f32_16x16x32_bf16 a[24:27], v[80:83], v[48:51], a[24:27]
v_accvgpr_read_b32 v12, a131
v_accvgpr_read_b32 v13, a135
v_mfma_f32_16x16x32_bf16 a[24:27], v[84:87], v[52:55], a[24:27]
buffer_load_dwordx4 v[124:127], v1, s[12:15], s34 offen offset:3072 sc1
s_add_u32 s33, s33, 0x8000
s_add_u32 s34, s34, 0x8000
v_mfma_f32_16x16x32_bf16 a[28:31], v[88:91], v[48:51], a[28:31]
s_add_u32 s6, s38, 0x202c000
s_waitcnt lgkmcnt(3)
buffer_store_dwordx4 v[36:39], v24, s[20:23], s6 offen sc1
v_mfma_f32_16x16x32_bf16 a[28:31], v[92:95], v[52:55], a[28:31]
v_mfma_f32_16x16x32_bf16 a[32:35], v[64:67], v[56:59], a[32:35]
ds_read_b128 v[48:51], v2 offset:40960
v_lshlrev_b32 v16, 16, v198
v_mfma_f32_16x16x32_bf16 a[32:35], v[68:71], v[60:63], a[32:35]
ds_read_b128 v[52:55], v3 offset:40960
v_and_b32 v17, 0xffff0000, v198
v_mfma_f32_16x16x32_bf16 a[36:39], v[72:75], v[56:59], a[36:39]
v_mul_f32 v12, v12, v16
v_mul_f32 v13, v13, v17
v_mfma_f32_16x16x32_bf16 a[36:39], v[76:79], v[60:63], a[36:39]
ds_read_b128 v[36:39], v7 offset:13312
v_cvt_pk_bf16_f32 v22, v12, v13
v_mfma_f32_16x16x32_bf16 a[40:43], v[80:83], v[56:59], a[40:43]
v_accvgpr_read_b32 v14, a139
v_accvgpr_read_b32 v15, a143
v_mfma_f32_16x16x32_bf16 a[40:43], v[84:87], v[60:63], a[40:43]
v_lshlrev_b32 v18, 16, v199
v_and_b32 v19, 0xffff0000, v199
v_mfma_f32_16x16x32_bf16 a[44:47], v[88:91], v[56:59], a[44:47]
s_add_u32 s6, s38, 0x2030000
s_waitcnt lgkmcnt(3)
buffer_store_dwordx4 v[32:35], v24, s[20:23], s6 offen sc1
v_mfma_f32_16x16x32_bf16 a[44:47], v[92:95], v[60:63], a[44:47]
v_mul_f32 v14, v14, v18
v_mfma_f32_16x16x32_bf16 a[48:51], v[64:67], v[40:43], a[48:51]
ds_read_b128 v[56:59], v2 offset:43008
v_mul_f32 v15, v15, v19
v_mfma_f32_16x16x32_bf16 a[48:51], v[68:71], v[44:47], a[48:51]
ds_read_b128 v[60:63], v3 offset:43008
v_cvt_pk_bf16_f32 v23, v14, v15
v_mfma_f32_16x16x32_bf16 a[52:55], v[72:75], v[40:43], a[52:55]
ds_write_b128 v5, v[20:23] offset:0
v_accvgpr_read_b32 v12, a146
v_mfma_f32_16x16x32_bf16 a[52:55], v[76:79], v[44:47], a[52:55]
v_accvgpr_read_b32 v13, a150
v_lshlrev_b32 v16, 16, v204
v_mfma_f32_16x16x32_bf16 a[56:59], v[80:83], v[40:43], a[56:59]
v_and_b32 v17, 0xffff0000, v204
v_mul_f32 v12, v12, v16
v_mfma_f32_16x16x32_bf16 a[56:59], v[84:87], v[44:47], a[56:59]
v_mul_f32 v13, v13, v17
v_cvt_pk_bf16_f32 v20, v12, v13
v_mfma_f32_16x16x32_bf16 a[60:63], v[88:91], v[40:43], a[60:63]
s_add_u32 s6, s38, 0x2034000
s_waitcnt lgkmcnt(3)
buffer_store_dwordx4 v[36:39], v24, s[20:23], s6 offen sc1
v_mfma_f32_16x16x32_bf16 a[60:63], v[92:95], v[44:47], a[60:63]
v_mfma_f32_16x16x32_bf16 a[64:67], v[64:67], v[48:51], a[64:67]
ds_read_b128 v[40:43], v2 offset:45056
v_accvgpr_read_b32 v14, a154
v_mfma_f32_16x16x32_bf16 a[64:67], v[68:71], v[52:55], a[64:67]
ds_read_b128 v[44:47], v3 offset:45056
v_accvgpr_read_b32 v15, a158
v_mfma_f32_16x16x32_bf16 a[68:71], v[72:75], v[48:51], a[68:71]
v_lshlrev_b32 v18, 16, v205
v_and_b32 v19, 0xffff0000, v205
v_mfma_f32_16x16x32_bf16 a[68:71], v[76:79], v[52:55], a[68:71]
v_mul_f32 v14, v14, v18
v_mul_f32 v15, v15, v19
v_mfma_f32_16x16x32_bf16 a[72:75], v[80:83], v[48:51], a[72:75]
v_cvt_pk_bf16_f32 v21, v14, v15
v_accvgpr_read_b32 v12, a147
v_mfma_f32_16x16x32_bf16 a[72:75], v[84:87], v[52:55], a[72:75]
v_accvgpr_read_b32 v13, a151
v_lshlrev_b32 v16, 16, v206
v_mfma_f32_16x16x32_bf16 a[76:79], v[88:91], v[48:51], a[76:79]
v_and_b32 v17, 0xffff0000, v206
v_mul_f32 v12, v12, v16
v_mfma_f32_16x16x32_bf16 a[76:79], v[92:95], v[52:55], a[76:79]
v_mul_f32 v13, v13, v17
v_cvt_pk_bf16_f32 v22, v12, v13
s_waitcnt lgkmcnt(3)
v_mfma_f32_16x16x32_bf16 a[80:83], v[64:67], v[56:59], a[80:83]
ds_read_b128 v[48:51], v2 offset:47104
v_mfma_f32_16x16x32_bf16 a[80:83], v[68:71], v[60:63], a[80:83]
ds_read_b128 v[52:55], v3 offset:47104
v_accvgpr_read_b32 v14, a155
v_mfma_f32_16x16x32_bf16 a[84:87], v[72:75], v[56:59], a[84:87]
v_accvgpr_read_b32 v15, a159
v_lshlrev_b32 v18, 16, v207
v_mfma_f32_16x16x32_bf16 a[84:87], v[76:79], v[60:63], a[84:87]
v_and_b32 v19, 0xffff0000, v207
v_mul_f32 v14, v14, v18
v_mfma_f32_16x16x32_bf16 a[88:91], v[80:83], v[56:59], a[88:91]
v_mul_f32 v15, v15, v19
v_cvt_pk_bf16_f32 v23, v14, v15
v_mfma_f32_16x16x32_bf16 a[88:91], v[84:87], v[60:63], a[88:91]
ds_write_b128 v5, v[20:23] offset:2048
v_accvgpr_read_b32 v12, a162
v_mfma_f32_16x16x32_bf16 a[92:95], v[88:91], v[56:59], a[92:95]
v_accvgpr_read_b32 v13, a166
v_lshlrev_b32 v16, 16, v212
v_mfma_f32_16x16x32_bf16 a[92:95], v[92:95], v[60:63], a[92:95]
v_and_b32 v17, 0xffff0000, v212
v_mul_f32 v12, v12, v16
s_waitcnt lgkmcnt(3)
v_mfma_f32_16x16x32_bf16 a[96:99], v[64:67], v[40:43], a[96:99]
ds_read_b128 v[56:59], v2 offset:49152
v_mfma_f32_16x16x32_bf16 a[96:99], v[68:71], v[44:47], a[96:99]
ds_read_b128 v[60:63], v3 offset:49152
v_mul_f32 v13, v13, v17
v_mfma_f32_16x16x32_bf16 a[100:103], v[72:75], v[40:43], a[100:103]
v_cvt_pk_bf16_f32 v20, v12, v13
v_accvgpr_read_b32 v14, a170
v_mfma_f32_16x16x32_bf16 a[100:103], v[76:79], v[44:47], a[100:103]
v_accvgpr_read_b32 v15, a174
v_lshlrev_b32 v18, 16, v213
v_mfma_f32_16x16x32_bf16 a[104:107], v[80:83], v[40:43], a[104:107]
v_and_b32 v19, 0xffff0000, v213
v_mul_f32 v14, v14, v18
v_mfma_f32_16x16x32_bf16 a[104:107], v[84:87], v[44:47], a[104:107]
v_mul_f32 v15, v15, v19
v_cvt_pk_bf16_f32 v21, v14, v15
v_mfma_f32_16x16x32_bf16 a[108:111], v[88:91], v[40:43], a[108:111]
v_accvgpr_read_b32 v12, a163
v_accvgpr_read_b32 v13, a167
v_mfma_f32_16x16x32_bf16 a[108:111], v[92:95], v[44:47], a[108:111]
v_lshlrev_b32 v16, 16, v214
v_and_b32 v17, 0xffff0000, v214
s_waitcnt lgkmcnt(3)
v_mfma_f32_16x16x32_bf16 a[112:115], v[64:67], v[48:51], a[112:115]
ds_read_b128 v[40:43], v2 offset:51200
buffer_load_dwordx4 v[64:67], v1, s[12:15], s33 offen offset:0 sc1
v_mfma_f32_16x16x32_bf16 a[112:115], v[68:71], v[52:55], a[112:115]
ds_read_b128 v[44:47], v3 offset:51200
v_mfma_f32_16x16x32_bf16 a[116:119], v[72:75], v[48:51], a[116:119]
v_mul_f32 v12, v12, v16
v_mul_f32 v13, v13, v17
v_mfma_f32_16x16x32_bf16 a[116:119], v[76:79], v[52:55], a[116:119]
buffer_load_dwordx4 v[68:71], v1, s[12:15], s33 offen offset:1024 sc1
v_cvt_pk_bf16_f32 v22, v12, v13
v_mfma_f32_16x16x32_bf16 a[120:123], v[80:83], v[48:51], a[120:123]
v_accvgpr_read_b32 v14, a171
v_accvgpr_read_b32 v15, a175
v_mfma_f32_16x16x32_bf16 a[120:123], v[84:87], v[52:55], a[120:123]
v_lshlrev_b32 v18, 16, v215
v_and_b32 v19, 0xffff0000, v215
v_mfma_f32_16x16x32_bf16 a[124:127], v[88:91], v[48:51], a[124:127]
buffer_load_dwordx4 v[72:75], v1, s[12:15], s33 offen offset:2048 sc1
v_mul_f32 v14, v14, v18
v_mfma_f32_16x16x32_bf16 a[124:127], v[92:95], v[52:55], a[124:127]
v_mul_f32 v15, v15, v19
s_waitcnt vmcnt(12) lgkmcnt(2)
v_mfma_f32_16x16x32_bf16 a[0:3], v[96:99], v[56:59], a[0:3]
ds_read_b128 v[48:51], v2 offset:53248
v_mfma_f32_16x16x32_bf16 a[0:3], v[100:103], v[60:63], a[0:3]
ds_read_b128 v[52:55], v3 offset:53248
buffer_load_dwordx4 v[76:79], v1, s[12:15], s33 offen offset:3072 sc1
s_waitcnt vmcnt(11)
v_mfma_f32_16x16x32_bf16 a[4:7], v[104:107], v[56:59], a[4:7]
v_cvt_pk_bf16_f32 v23, v14, v15
v_mfma_f32_16x16x32_bf16 a[4:7], v[108:111], v[60:63], a[4:7]
ds_read_b128 v[32:35], v6 offset:14336
v_xor_b32 v6, 0x10000, v6
s_waitcnt vmcnt(9)
v_mfma_f32_16x16x32_bf16 a[8:11], v[112:115], v[56:59], a[8:11]
buffer_load_dwordx4 v[80:83], v1, s[12:15], s34 offen offset:0 sc1
v_mfma_f32_16x16x32_bf16 a[8:11], v[116:119], v[60:63], a[8:11]
ds_write_b128 v5, v[20:23] offset:4096
v_accvgpr_read_b32 v12, a178
s_waitcnt vmcnt(8)
v_mfma_f32_16x16x32_bf16 a[12:15], v[120:123], v[56:59], a[12:15]
v_accvgpr_read_b32 v13, a182
v_mfma_f32_16x16x32_bf16 a[12:15], v[124:127], v[60:63], a[12:15]
buffer_load_dwordx4 v[84:87], v1, s[12:15], s34 offen offset:1024 sc1
v_lshlrev_b32 v16, 16, v220
s_waitcnt lgkmcnt(4)
v_mfma_f32_16x16x32_bf16 a[16:19], v[96:99], v[40:43], a[16:19]
ds_read_b128 v[56:59], v2 offset:55296
v_mfma_f32_16x16x32_bf16 a[16:19], v[100:103], v[44:47], a[16:19]
ds_read_b128 v[60:63], v3 offset:55296
v_and_b32 v17, 0xffff0000, v220
v_mfma_f32_16x16x32_bf16 a[20:23], v[104:107], v[40:43], a[20:23]
buffer_load_dwordx4 v[88:91], v1, s[12:15], s34 offen offset:2048 sc1
v_mul_f32 v12, v12, v16
v_mfma_f32_16x16x32_bf16 a[20:23], v[108:111], v[44:47], a[20:23]
ds_read_b128 v[36:39], v7 offset:15360
v_xor_b32 v7, 0x10000, v7
v_mfma_f32_16x16x32_bf16 a[24:27], v[112:115], v[40:43], a[24:27]
v_mul_f32 v13, v13, v17
v_cvt_pk_bf16_f32 v20, v12, v13
v_mfma_f32_16x16x32_bf16 a[24:27], v[116:119], v[44:47], a[24:27]
buffer_load_dwordx4 v[92:95], v1, s[12:15], s34 offen offset:3072 sc1
s_add_u32 s33, s33, 0x8000
s_add_u32 s34, s34, 0x8000
v_mfma_f32_16x16x32_bf16 a[28:31], v[120:123], v[40:43], a[28:31]
s_add_u32 s6, s38, 0x2038000
s_waitcnt lgkmcnt(4)
buffer_store_dwordx4 v[32:35], v24, s[20:23], s6 offen sc1
v_mfma_f32_16x16x32_bf16 a[28:31], v[124:127], v[44:47], a[28:31]
v_mfma_f32_16x16x32_bf16 a[32:35], v[96:99], v[48:51], a[32:35]
ds_read_b128 v[40:43], v2 offset:57344
v_accvgpr_read_b32 v14, a186
v_mfma_f32_16x16x32_bf16 a[32:35], v[100:103], v[52:55], a[32:35]
ds_read_b128 v[44:47], v3 offset:57344
v_accvgpr_read_b32 v15, a190
v_mfma_f32_16x16x32_bf16 a[36:39], v[104:107], v[48:51], a[36:39]
v_lshlrev_b32 v18, 16, v221
v_and_b32 v19, 0xffff0000, v221
v_mfma_f32_16x16x32_bf16 a[36:39], v[108:111], v[52:55], a[36:39]
v_mul_f32 v14, v14, v18
v_mul_f32 v15, v15, v19
v_mfma_f32_16x16x32_bf16 a[40:43], v[112:115], v[48:51], a[40:43]
v_cvt_pk_bf16_f32 v21, v14, v15
v_accvgpr_read_b32 v12, a179
v_mfma_f32_16x16x32_bf16 a[40:43], v[116:119], v[52:55], a[40:43]
v_accvgpr_read_b32 v13, a183
v_lshlrev_b32 v16, 16, v222
v_mfma_f32_16x16x32_bf16 a[44:47], v[120:123], v[48:51], a[44:47]
s_add_u32 s6, s38, 0x203c000
s_waitcnt lgkmcnt(2)
buffer_store_dwordx4 v[36:39], v24, s[20:23], s6 offen sc1
v_xor_b32 v24, 0x200, v24
v_mfma_f32_16x16x32_bf16 a[44:47], v[124:127], v[52:55], a[44:47]
v_mfma_f32_16x16x32_bf16 a[48:51], v[96:99], v[56:59], a[48:51]
ds_read_b128 v[48:51], v2 offset:59392
v_and_b32 v17, 0xffff0000, v222
v_mfma_f32_16x16x32_bf16 a[48:51], v[100:103], v[60:63], a[48:51]
ds_read_b128 v[52:55], v3 offset:59392
v_mul_f32 v12, v12, v16
v_mfma_f32_16x16x32_bf16 a[52:55], v[104:107], v[56:59], a[52:55]
v_mul_f32 v13, v13, v17
v_cvt_pk_bf16_f32 v22, v12, v13
v_mfma_f32_16x16x32_bf16 a[52:55], v[108:111], v[60:63], a[52:55]
v_accvgpr_read_b32 v14, a187
v_accvgpr_read_b32 v15, a191
v_mfma_f32_16x16x32_bf16 a[56:59], v[112:115], v[56:59], a[56:59]
v_lshlrev_b32 v18, 16, v223
v_and_b32 v19, 0xffff0000, v223
v_mfma_f32_16x16x32_bf16 a[56:59], v[116:119], v[60:63], a[56:59]
v_mul_f32 v14, v14, v18
v_mul_f32 v15, v15, v19
v_cvt_pk_bf16_f32 v23, v14, v15
v_mfma_f32_16x16x32_bf16 a[60:63], v[120:123], v[56:59], a[60:63]
ds_write_b128 v5, v[20:23] offset:6144
v_accvgpr_read_b32 v12, a194
v_mfma_f32_16x16x32_bf16 a[60:63], v[124:127], v[60:63], a[60:63]
v_accvgpr_read_b32 v13, a198
v_lshlrev_b32 v16, 16, v228
s_waitcnt lgkmcnt(3)
v_mfma_f32_16x16x32_bf16 a[64:67], v[96:99], v[40:43], a[64:67]
ds_read_b128 v[56:59], v2 offset:61440
v_mfma_f32_16x16x32_bf16 a[64:67], v[100:103], v[44:47], a[64:67]
ds_read_b128 v[60:63], v3 offset:61440
v_and_b32 v17, 0xffff0000, v228
v_mfma_f32_16x16x32_bf16 a[68:71], v[104:107], v[40:43], a[68:71]
v_mul_f32 v12, v12, v16
v_mul_f32 v13, v13, v17
v_mfma_f32_16x16x32_bf16 a[68:71], v[108:111], v[44:47], a[68:71]
v_cvt_pk_bf16_f32 v20, v12, v13
v_accvgpr_read_b32 v14, a202
v_mfma_f32_16x16x32_bf16 a[72:75], v[112:115], v[40:43], a[72:75]
v_accvgpr_read_b32 v15, a206
v_lshlrev_b32 v18, 16, v229
v_mfma_f32_16x16x32_bf16 a[72:75], v[116:119], v[44:47], a[72:75]
v_and_b32 v19, 0xffff0000, v229
v_mul_f32 v14, v14, v18
v_mfma_f32_16x16x32_bf16 a[76:79], v[120:123], v[40:43], a[76:79]
v_mul_f32 v15, v15, v19
v_cvt_pk_bf16_f32 v21, v14, v15
v_mfma_f32_16x16x32_bf16 a[76:79], v[124:127], v[44:47], a[76:79]
v_accvgpr_read_b32 v12, a195
v_accvgpr_read_b32 v13, a199
s_waitcnt lgkmcnt(3)
v_mfma_f32_16x16x32_bf16 a[80:83], v[96:99], v[48:51], a[80:83]
ds_read_b128 v[40:43], v2 offset:63488
v_mfma_f32_16x16x32_bf16 a[80:83], v[100:103], v[52:55], a[80:83]
ds_read_b128 v[44:47], v3 offset:63488
v_lshlrev_b32 v16, 16, v230
v_mfma_f32_16x16x32_bf16 a[84:87], v[104:107], v[48:51], a[84:87]
v_and_b32 v17, 0xffff0000, v230
v_mul_f32 v12, v12, v16
v_mfma_f32_16x16x32_bf16 a[84:87], v[108:111], v[52:55], a[84:87]
v_mul_f32 v13, v13, v17
v_cvt_pk_bf16_f32 v22, v12, v13
v_mfma_f32_16x16x32_bf16 a[88:91], v[112:115], v[48:51], a[88:91]
v_accvgpr_read_b32 v14, a203
v_accvgpr_read_b32 v15, a207
v_mfma_f32_16x16x32_bf16 a[88:91], v[116:119], v[52:55], a[88:91]
v_lshlrev_b32 v18, 16, v231
v_and_b32 v19, 0xffff0000, v231
v_mfma_f32_16x16x32_bf16 a[92:95], v[120:123], v[48:51], a[92:95]
v_mul_f32 v14, v14, v18
v_mul_f32 v15, v15, v19
v_mfma_f32_16x16x32_bf16 a[92:95], v[124:127], v[52:55], a[92:95]
v_cvt_pk_bf16_f32 v23, v14, v15
ds_write_b128 v5, v[20:23] offset:8192
s_waitcnt lgkmcnt(3)
v_mfma_f32_16x16x32_bf16 a[96:99], v[96:99], v[56:59], a[96:99]
ds_read_b128 v[48:51], v2 offset:0
v_mfma_f32_16x16x32_bf16 a[96:99], v[100:103], v[60:63], a[96:99]
ds_read_b128 v[52:55], v3 offset:0
v_accvgpr_read_b32 v12, a210
v_mfma_f32_16x16x32_bf16 a[100:103], v[104:107], v[56:59], a[100:103]
v_accvgpr_read_b32 v13, a214
v_lshlrev_b32 v16, 16, v236
v_mfma_f32_16x16x32_bf16 a[100:103], v[108:111], v[60:63], a[100:103]
v_and_b32 v17, 0xffff0000, v236
v_mul_f32 v12, v12, v16
v_mfma_f32_16x16x32_bf16 a[104:107], v[112:115], v[56:59], a[104:107]
v_mul_f32 v13, v13, v17
v_cvt_pk_bf16_f32 v20, v12, v13
v_mfma_f32_16x16x32_bf16 a[104:107], v[116:119], v[60:63], a[104:107]
v_accvgpr_read_b32 v14, a218
v_accvgpr_read_b32 v15, a222
v_mfma_f32_16x16x32_bf16 a[108:111], v[120:123], v[56:59], a[108:111]
v_lshlrev_b32 v18, 16, v237
v_and_b32 v19, 0xffff0000, v237
v_mfma_f32_16x16x32_bf16 a[108:111], v[124:127], v[60:63], a[108:111]
v_mul_f32 v14, v14, v18
v_mul_f32 v15, v15, v19
s_waitcnt lgkmcnt(3)
v_mfma_f32_16x16x32_bf16 a[112:115], v[96:99], v[40:43], a[112:115]
ds_read_b128 v[56:59], v2 offset:2048
buffer_load_dwordx4 v[96:99], v1, s[12:15], s33 offen offset:0 sc1
v_mfma_f32_16x16x32_bf16 a[112:115], v[100:103], v[44:47], a[112:115]
ds_read_b128 v[60:63], v3 offset:2048
v_mfma_f32_16x16x32_bf16 a[116:119], v[104:107], v[40:43], a[116:119]
v_cvt_pk_bf16_f32 v21, v14, v15
v_accvgpr_read_b32 v12, a211
v_mfma_f32_16x16x32_bf16 a[116:119], v[108:111], v[44:47], a[116:119]
buffer_load_dwordx4 v[100:103], v1, s[12:15], s33 offen offset:1024 sc1
v_accvgpr_read_b32 v13, a215
v_mfma_f32_16x16x32_bf16 a[120:123], v[112:115], v[40:43], a[120:123]
v_lshlrev_b32 v16, 16, v238
v_and_b32 v17, 0xffff0000, v238
v_mfma_f32_16x16x32_bf16 a[120:123], v[116:119], v[44:47], a[120:123]
v_mul_f32 v12, v12, v16
v_mul_f32 v13, v13, v17
v_mfma_f32_16x16x32_bf16 a[124:127], v[120:123], v[40:43], a[124:127]
buffer_load_dwordx4 v[104:107], v1, s[12:15], s33 offen offset:2048 sc1
v_cvt_pk_bf16_f32 v22, v12, v13
v_accvgpr_read_b32 v14, a219
v_mfma_f32_16x16x32_bf16 a[124:127], v[124:127], v[44:47], a[124:127]
v_accvgpr_read_b32 v15, a223
v_lshlrev_b32 v18, 16, v239
s_waitcnt vmcnt(11) lgkmcnt(2)
v_mfma_f32_16x16x32_bf16 a[128:131], v[64:67], v[48:51], a[128:131]
ds_read_b128 v[40:43], v2 offset:4096
v_mfma_f32_16x16x32_bf16 a[128:131], v[68:71], v[52:55], a[128:131]
ds_read_b128 v[44:47], v3 offset:4096
buffer_load_dwordx4 v[108:111], v1, s[12:15], s33 offen offset:3072 sc1
s_waitcnt vmcnt(10)
v_mfma_f32_16x16x32_bf16 a[132:135], v[72:75], v[48:51], a[132:135]
v_and_b32 v19, 0xffff0000, v239
v_mfma_f32_16x16x32_bf16 a[132:135], v[76:79], v[52:55], a[132:135]
ds_read_b128 v[32:35], v6 offset:0
v_mul_f32 v14, v14, v18
s_waitcnt vmcnt(8)
v_mfma_f32_16x16x32_bf16 a[136:139], v[80:83], v[48:51], a[136:139]
buffer_load_dwordx4 v[112:115], v1, s[12:15], s34 offen offset:0 sc1
v_mfma_f32_16x16x32_bf16 a[136:139], v[84:87], v[52:55], a[136:139]
v_mul_f32 v15, v15, v19
v_cvt_pk_bf16_f32 v23, v14, v15
s_waitcnt vmcnt(7)
v_mfma_f32_16x16x32_bf16 a[140:143], v[88:91], v[48:51], a[140:143]
ds_write_b128 v5, v[20:23] offset:10240
v_mfma_f32_16x16x32_bf16 a[140:143], v[92:95], v[52:55], a[140:143]
buffer_load_dwordx4 v[116:119], v1, s[12:15], s34 offen offset:1024 sc1
v_accvgpr_read_b32 v12, a226
s_waitcnt lgkmcnt(4)
v_mfma_f32_16x16x32_bf16 a[144:147], v[64:67], v[56:59], a[144:147]
ds_read_b128 v[48:51], v2 offset:6144
v_mfma_f32_16x16x32_bf16 a[144:147], v[68:71], v[60:63], a[144:147]
ds_read_b128 v[52:55], v3 offset:6144
v_accvgpr_read_b32 v13, a230
v_mfma_f32_16x16x32_bf16 a[148:151], v[72:75], v[56:59], a[148:151]
buffer_load_dwordx4 v[120:123], v1, s[12:15], s34 offen offset:2048 sc1
v_lshlrev_b32 v16, 16, v244
v_mfma_f32_16x16x32_bf16 a[148:151], v[76:79], v[60:63], a[148:151]
ds_read_b128 v[36:39], v7 offset:1024
v_and_b32 v17, 0xffff0000, v244
v_mfma_f32_16x16x32_bf16 a[152:155], v[80:83], v[56:59], a[152:155]
v_mul_f32 v12, v12, v16
v_mul_f32 v13, v13, v17
v_mfma_f32_16x16x32_bf16 a[152:155], v[84:87], v[60:63], a[152:155]
buffer_load_dwordx4 v[124:127], v1, s[12:15], s34 offen offset:3072 sc1
s_add_u32 s33, s33, 0x8000
s_add_u32 s34, s34, 0x8000
v_mfma_f32_16x16x32_bf16 a[156:159], v[88:91], v[56:59], a[156:159]
s_add_u32 s6, s38, 0x2000000
s_waitcnt lgkmcnt(4)
buffer_store_dwordx4 v[32:35], v24, s[20:23], s6 offen sc1
v_mfma_f32_16x16x32_bf16 a[156:159], v[92:95], v[60:63], a[156:159]
v_mfma_f32_16x16x32_bf16 a[160:163], v[64:67], v[40:43], a[160:163]
ds_read_b128 v[56:59], v2 offset:8192
v_cvt_pk_bf16_f32 v20, v12, v13
v_mfma_f32_16x16x32_bf16 a[160:163], v[68:71], v[44:47], a[160:163]
ds_read_b128 v[60:63], v3 offset:8192
v_accvgpr_read_b32 v14, a234
v_mfma_f32_16x16x32_bf16 a[164:167], v[72:75], v[40:43], a[164:167]
v_accvgpr_read_b32 v15, a238
v_lshlrev_b32 v18, 16, v245
v_mfma_f32_16x16x32_bf16 a[164:167], v[76:79], v[44:47], a[164:167]
ds_read_b128 v[32:35], v6 offset:2048
v_and_b32 v19, 0xffff0000, v245
v_mfma_f32_16x16x32_bf16 a[168:171], v[80:83], v[40:43], a[168:171]
v_mul_f32 v14, v14, v18
v_mul_f32 v15, v15, v19
v_mfma_f32_16x16x32_bf16 a[168:171], v[84:87], v[44:47], a[168:171]
v_cvt_pk_bf16_f32 v21, v14, v15
v_accvgpr_read_b32 v12, a227
v_mfma_f32_16x16x32_bf16 a[172:175], v[88:91], v[40:43], a[172:175]
s_add_u32 s6, s38, 0x2004000
s_waitcnt lgkmcnt(3)
buffer_store_dwordx4 v[36:39], v24, s[20:23], s6 offen sc1
v_mfma_f32_16x16x32_bf16 a[172:175], v[92:95], v[44:47], a[172:175]
v_accvgpr_read_b32 v13, a231
v_mfma_f32_16x16x32_bf16 a[176:179], v[64:67], v[48:51], a[176:179]
ds_read_b128 v[40:43], v2 offset:10240
v_lshlrev_b32 v16, 16, v246
v_mfma_f32_16x16x32_bf16 a[176:179], v[68:71], v[52:55], a[176:179]
ds_read_b128 v[44:47], v3 offset:10240
v_and_b32 v17, 0xffff0000, v246
v_mul_f32 v12, v12, v16
v_mfma_f32_16x16x32_bf16 a[180:183], v[72:75], v[48:51], a[180:183]
v_mul_f32 v13, v13, v17
v_cvt_pk_bf16_f32 v22, v12, v13
v_mfma_f32_16x16x32_bf16 a[180:183], v[76:79], v[52:55], a[180:183]
v_accvgpr_read_b32 v14, a235
v_accvgpr_read_b32 v15, a239
v_mfma_f32_16x16x32_bf16 a[184:187], v[80:83], v[48:51], a[184:187]
v_lshlrev_b32 v18, 16, v247
v_and_b32 v19, 0xffff0000, v247
v_mfma_f32_16x16x32_bf16 a[184:187], v[84:87], v[52:55], a[184:187]
v_mul_f32 v14, v14, v18
v_mul_f32 v15, v15, v19
v_mfma_f32_16x16x32_bf16 a[188:191], v[88:91], v[48:51], a[188:191]
s_add_u32 s6, s38, 0x2008000
s_waitcnt lgkmcnt(2)
buffer_store_dwordx4 v[32:35], v24, s[20:23], s6 offen sc1
v_mfma_f32_16x16x32_bf16 a[188:191], v[92:95], v[52:55], a[188:191]
v_cvt_pk_bf16_f32 v23, v14, v15
v_mfma_f32_16x16x32_bf16 a[192:195], v[64:67], v[56:59], a[192:195]
ds_read_b128 v[48:51], v2 offset:12288
ds_write_b128 v5, v[20:23] offset:12288
v_mfma_f32_16x16x32_bf16 a[192:195], v[68:71], v[60:63], a[192:195]
ds_read_b128 v[52:55], v3 offset:12288
v_accvgpr_read_b32 v12, a242
v_accvgpr_read_b32 v13, a246
v_mfma_f32_16x16x32_bf16 a[196:199], v[72:75], v[56:59], a[196:199]
v_lshlrev_b32 v16, 16, v252
v_and_b32 v17, 0xffff0000, v252
v_mfma_f32_16x16x32_bf16 a[196:199], v[76:79], v[60:63], a[196:199]
v_mul_f32 v12, v12, v16
v_mul_f32 v13, v13, v17
v_mfma_f32_16x16x32_bf16 a[200:203], v[80:83], v[56:59], a[200:203]
v_cvt_pk_bf16_f32 v20, v12, v13
v_accvgpr_read_b32 v14, a250
v_mfma_f32_16x16x32_bf16 a[200:203], v[84:87], v[60:63], a[200:203]
v_accvgpr_read_b32 v15, a254
v_lshlrev_b32 v18, 16, v253
v_mfma_f32_16x16x32_bf16 a[204:207], v[88:91], v[56:59], a[204:207]
v_and_b32 v19, 0xffff0000, v253
v_mul_f32 v14, v14, v18
v_mul_f32 v15, v15, v19
v_mfma_f32_16x16x32_bf16 a[204:207], v[92:95], v[60:63], a[204:207]
v_cvt_pk_bf16_f32 v21, v14, v15
v_accvgpr_read_b32 v12, a243
s_waitcnt lgkmcnt(3)
v_mfma_f32_16x16x32_bf16 a[208:211], v[64:67], v[40:43], a[208:211]
ds_read_b128 v[56:59], v2 offset:14336
v_mfma_f32_16x16x32_bf16 a[208:211], v[68:71], v[44:47], a[208:211]
ds_read_b128 v[60:63], v3 offset:14336
v_accvgpr_read_b32 v13, a247
v_mfma_f32_16x16x32_bf16 a[212:215], v[72:75], v[40:43], a[212:215]
v_lshlrev_b32 v16, 16, v254
v_and_b32 v17, 0xffff0000, v254
v_mfma_f32_16x16x32_bf16 a[212:215], v[76:79], v[44:47], a[212:215]
v_mul_f32 v12, v12, v16
v_mul_f32 v13, v13, v17
v_mfma_f32_16x16x32_bf16 a[216:219], v[80:83], v[40:43], a[216:219]
v_cvt_pk_bf16_f32 v22, v12, v13
v_accvgpr_read_b32 v14, a251
v_mfma_f32_16x16x32_bf16 a[216:219], v[84:87], v[44:47], a[216:219]
v_accvgpr_read_b32 v15, a255
v_lshlrev_b32 v18, 16, v255
v_and_b32 v19, 0xffff0000, v255
v_mfma_f32_16x16x32_bf16 a[220:223], v[88:91], v[40:43], a[220:223]
v_mul_f32 v14, v14, v18
v_mul_f32 v15, v15, v19
v_mfma_f32_16x16x32_bf16 a[220:223], v[92:95], v[44:47], a[220:223]
v_cvt_pk_bf16_f32 v23, v14, v15
ds_write_b128 v5, v[20:23] offset:14336
s_waitcnt lgkmcnt(3)
v_mfma_f32_16x16x32_bf16 a[224:227], v[64:67], v[48:51], a[224:227]
ds_read_b128 v[40:43], v2 offset:16384
v_mfma_f32_16x16x32_bf16 a[224:227], v[68:71], v[52:55], a[224:227]
ds_read_b128 v[44:47], v3 offset:16384
v_mfma_f32_16x16x32_bf16 a[228:231], v[72:75], v[48:51], a[228:231]
v_mfma_f32_16x16x32_bf16 a[228:231], v[76:79], v[52:55], a[228:231]
v_mfma_f32_16x16x32_bf16 a[232:235], v[80:83], v[48:51], a[232:235]
v_mfma_f32_16x16x32_bf16 a[232:235], v[84:87], v[52:55], a[232:235]
v_mfma_f32_16x16x32_bf16 a[236:239], v[88:91], v[48:51], a[236:239]
v_mfma_f32_16x16x32_bf16 a[236:239], v[92:95], v[52:55], a[236:239]
s_waitcnt lgkmcnt(3)
v_mfma_f32_16x16x32_bf16 a[240:243], v[64:67], v[56:59], a[240:243]
ds_read_b128 v[48:51], v2 offset:18432
buffer_load_dwordx4 v[64:67], v1, s[12:15], s33 offen offset:0 sc1
v_mfma_f32_16x16x32_bf16 a[240:243], v[68:71], v[60:63], a[240:243]
ds_read_b128 v[52:55], v3 offset:18432
v_mfma_f32_16x16x32_bf16 a[244:247], v[72:75], v[56:59], a[244:247]
v_mfma_f32_16x16x32_bf16 a[244:247], v[76:79], v[60:63], a[244:247]
buffer_load_dwordx4 v[68:71], v1, s[12:15], s33 offen offset:1024 sc1
v_mfma_f32_16x16x32_bf16 a[248:251], v[80:83], v[56:59], a[248:251]
v_mfma_f32_16x16x32_bf16 a[248:251], v[84:87], v[60:63], a[248:251]
v_mfma_f32_16x16x32_bf16 a[252:255], v[88:91], v[56:59], a[252:255]
buffer_load_dwordx4 v[72:75], v1, s[12:15], s33 offen offset:2048 sc1
v_mfma_f32_16x16x32_bf16 a[252:255], v[92:95], v[60:63], a[252:255]
s_waitcnt vmcnt(12) lgkmcnt(2)
v_mfma_f32_16x16x32_bf16 a[128:131], v[96:99], v[40:43], a[128:131]
ds_read_b128 v[56:59], v2 offset:20480
v_mfma_f32_16x16x32_bf16 a[128:131], v[100:103], v[44:47], a[128:131]
ds_read_b128 v[60:63], v3 offset:20480
buffer_load_dwordx4 v[76:79], v1, s[12:15], s33 offen offset:3072 sc1
s_waitcnt vmcnt(11)
v_mfma_f32_16x16x32_bf16 a[132:135], v[104:107], v[40:43], a[132:135]
v_mfma_f32_16x16x32_bf16 a[132:135], v[108:111], v[44:47], a[132:135]
ds_read_b128 v[36:39], v7 offset:3072
s_waitcnt vmcnt(9)
v_mfma_f32_16x16x32_bf16 a[136:139], v[112:115], v[40:43], a[136:139]
buffer_load_dwordx4 v[80:83], v1, s[12:15], s34 offen offset:0 sc1
v_mfma_f32_16x16x32_bf16 a[136:139], v[116:119], v[44:47], a[136:139]
s_waitcnt vmcnt(8)
v_mfma_f32_16x16x32_bf16 a[140:143], v[120:123], v[40:43], a[140:143]
v_mfma_f32_16x16x32_bf16 a[140:143], v[124:127], v[44:47], a[140:143]
buffer_load_dwordx4 v[84:87], v1, s[12:15], s34 offen offset:1024 sc1
v_mov_b32 v0, 5
s_mov_b64 exec, 1
buffer_store_dword v0, off, s[24:27], s41 sc1
s_mov_b64 exec, -1
s_waitcnt lgkmcnt(3)
v_mfma_f32_16x16x32_bf16 a[144:147], v[96:99], v[48:51], a[144:147]
ds_read_b128 v[40:43], v2 offset:22528
v_mfma_f32_16x16x32_bf16 a[144:147], v[100:103], v[52:55], a[144:147]
ds_read_b128 v[44:47], v3 offset:22528
v_mfma_f32_16x16x32_bf16 a[148:151], v[104:107], v[48:51], a[148:151]
buffer_load_dwordx4 v[88:91], v1, s[12:15], s34 offen offset:2048 sc1
v_mfma_f32_16x16x32_bf16 a[148:151], v[108:111], v[52:55], a[148:151]
ds_read_b128 v[32:35], v6 offset:4096
v_mfma_f32_16x16x32_bf16 a[152:155], v[112:115], v[48:51], a[152:155]
v_mfma_f32_16x16x32_bf16 a[152:155], v[116:119], v[52:55], a[152:155]
buffer_load_dwordx4 v[92:95], v1, s[12:15], s34 offen offset:3072 sc1
s_add_u32 s33, s33, 0x8000
s_add_u32 s34, s34, 0x8000
v_mfma_f32_16x16x32_bf16 a[156:159], v[120:123], v[48:51], a[156:159]
s_add_u32 s6, s38, 0x200c000
s_waitcnt lgkmcnt(3)
buffer_store_dwordx4 v[36:39], v24, s[20:23], s6 offen sc1
v_mfma_f32_16x16x32_bf16 a[156:159], v[124:127], v[52:55], a[156:159]
v_mfma_f32_16x16x32_bf16 a[160:163], v[96:99], v[56:59], a[160:163]
ds_read_b128 v[48:51], v2 offset:24576
v_mfma_f32_16x16x32_bf16 a[160:163], v[100:103], v[60:63], a[160:163]
ds_read_b128 v[52:55], v3 offset:24576
v_mfma_f32_16x16x32_bf16 a[164:167], v[104:107], v[56:59], a[164:167]
v_mfma_f32_16x16x32_bf16 a[164:167], v[108:111], v[60:63], a[164:167]
ds_read_b128 v[36:39], v7 offset:5120
v_mfma_f32_16x16x32_bf16 a[168:171], v[112:115], v[56:59], a[168:171]
v_mfma_f32_16x16x32_bf16 a[168:171], v[116:119], v[60:63], a[168:171]
v_mfma_f32_16x16x32_bf16 a[172:175], v[120:123], v[56:59], a[172:175]
s_add_u32 s6, s38, 0x2010000
s_waitcnt lgkmcnt(3)
buffer_store_dwordx4 v[32:35], v24, s[20:23], s6 offen sc1
v_mfma_f32_16x16x32_bf16 a[172:175], v[124:127], v[60:63], a[172:175]
v_mfma_f32_16x16x32_bf16 a[176:179], v[96:99], v[40:43], a[176:179]
ds_read_b128 v[56:59], v2 offset:26624
v_mfma_f32_16x16x32_bf16 a[176:179], v[100:103], v[44:47], a[176:179]
ds_read_b128 v[60:63], v3 offset:26624
v_mfma_f32_16x16x32_bf16 a[180:183], v[104:107], v[40:43], a[180:183]
v_mfma_f32_16x16x32_bf16 a[180:183], v[108:111], v[44:47], a[180:183]
v_mfma_f32_16x16x32_bf16 a[184:187], v[112:115], v[40:43], a[184:187]
v_mfma_f32_16x16x32_bf16 a[184:187], v[116:119], v[44:47], a[184:187]
v_mfma_f32_16x16x32_bf16 a[188:191], v[120:123], v[40:43], a[188:191]
s_add_u32 s6, s38, 0x2014000
s_waitcnt lgkmcnt(2)
buffer_store_dwordx4 v[36:39], v24, s[20:23], s6 offen sc1
v_mfma_f32_16x16x32_bf16 a[188:191], v[124:127], v[44:47], a[188:191]
v_mfma_f32_16x16x32_bf16 a[192:195], v[96:99], v[48:51], a[192:195]
ds_read_b128 v[40:43], v2 offset:28672
v_mfma_f32_16x16x32_bf16 a[192:195], v[100:103], v[52:55], a[192:195]
ds_read_b128 v[44:47], v3 offset:28672
v_mfma_f32_16x16x32_bf16 a[196:199], v[104:107], v[48:51], a[196:199]
v_mfma_f32_16x16x32_bf16 a[196:199], v[108:111], v[52:55], a[196:199]
v_mfma_f32_16x16x32_bf16 a[200:203], v[112:115], v[48:51], a[200:203]
v_mfma_f32_16x16x32_bf16 a[200:203], v[116:119], v[52:55], a[200:203]
v_mfma_f32_16x16x32_bf16 a[204:207], v[120:123], v[48:51], a[204:207]
v_mfma_f32_16x16x32_bf16 a[204:207], v[124:127], v[52:55], a[204:207]
s_waitcnt lgkmcnt(2)
v_mfma_f32_16x16x32_bf16 a[208:211], v[96:99], v[56:59], a[208:211]
ds_read_b128 v[48:51], v2 offset:30720
v_mfma_f32_16x16x32_bf16 a[208:211], v[100:103], v[60:63], a[208:211]
ds_read_b128 v[52:55], v3 offset:30720
v_mfma_f32_16x16x32_bf16 a[212:215], v[104:107], v[56:59], a[212:215]
v_mfma_f32_16x16x32_bf16 a[212:215], v[108:111], v[60:63], a[212:215]
v_mfma_f32_16x16x32_bf16 a[216:219], v[112:115], v[56:59], a[216:219]
v_mfma_f32_16x16x32_bf16 a[216:219], v[116:119], v[60:63], a[216:219]
v_mfma_f32_16x16x32_bf16 a[220:223], v[120:123], v[56:59], a[220:223]
v_mfma_f32_16x16x32_bf16 a[220:223], v[124:127], v[60:63], a[220:223]
s_waitcnt lgkmcnt(2)
v_mfma_f32_16x16x32_bf16 a[224:227], v[96:99], v[40:43], a[224:227]
ds_read_b128 v[56:59], v2 offset:32768
v_mfma_f32_16x16x32_bf16 a[224:227], v[100:103], v[44:47], a[224:227]
ds_read_b128 v[60:63], v3 offset:32768
v_mfma_f32_16x16x32_bf16 a[228:231], v[104:107], v[40:43], a[228:231]
v_mfma_f32_16x16x32_bf16 a[228:231], v[108:111], v[44:47], a[228:231]
v_mfma_f32_16x16x32_bf16 a[232:235], v[112:115], v[40:43], a[232:235]
v_mfma_f32_16x16x32_bf16 a[232:235], v[116:119], v[44:47], a[232:235]
v_mfma_f32_16x16x32_bf16 a[236:239], v[120:123], v[40:43], a[236:239]
v_mfma_f32_16x16x32_bf16 a[236:239], v[124:127], v[44:47], a[236:239]
s_waitcnt lgkmcnt(2)
v_mfma_f32_16x16x32_bf16 a[240:243], v[96:99], v[48:51], a[240:243]
ds_read_b128 v[40:43], v2 offset:34816
buffer_load_dwordx4 v[96:99], v1, s[12:15], s33 offen offset:0 sc1
v_mfma_f32_16x16x32_bf16 a[240:243], v[100:103], v[52:55], a[240:243]
ds_read_b128 v[44:47], v3 offset:34816
v_mfma_f32_16x16x32_bf16 a[244:247], v[104:107], v[48:51], a[244:247]
v_mfma_f32_16x16x32_bf16 a[244:247], v[108:111], v[52:55], a[244:247]
buffer_load_dwordx4 v[100:103], v1, s[12:15], s33 offen offset:1024 sc1
v_mfma_f32_16x16x32_bf16 a[248:251], v[112:115], v[48:51], a[248:251]
v_mfma_f32_16x16x32_bf16 a[248:251], v[116:119], v[52:55], a[248:251]
v_mfma_f32_16x16x32_bf16 a[252:255], v[120:123], v[48:51], a[252:255]
buffer_load_dwordx4 v[104:107], v1, s[12:15], s33 offen offset:2048 sc1
v_mfma_f32_16x16x32_bf16 a[252:255], v[124:127], v[52:55], a[252:255]
s_waitcnt vmcnt(13) lgkmcnt(2)
v_mfma_f32_16x16x32_bf16 a[128:131], v[64:67], v[56:59], a[128:131]
ds_read_b128 v[48:51], v2 offset:36864
v_mfma_f32_16x16x32_bf16 a[128:131], v[68:71], v[60:63], a[128:131]
ds_read_b128 v[52:55], v3 offset:36864
buffer_load_dwordx4 v[108:111], v1, s[12:15], s33 offen offset:3072 sc1
buffer_load_dword v12, v11, s[24:27], s42 offen sc1
s_waitcnt vmcnt(13)
v_mfma_f32_16x16x32_bf16 a[132:135], v[72:75], v[56:59], a[132:135]
v_mfma_f32_16x16x32_bf16 a[132:135], v[76:79], v[60:63], a[132:135]
ds_read_b128 v[32:35], v6 offset:6144
s_waitcnt vmcnt(11)
v_mfma_f32_16x16x32_bf16 a[136:139], v[80:83], v[56:59], a[136:139]
buffer_load_dwordx4 v[112:115], v1, s[12:15], s34 offen offset:0 sc1
v_mfma_f32_16x16x32_bf16 a[136:139], v[84:87], v[60:63], a[136:139]
s_waitcnt vmcnt(9)
v_mfma_f32_16x16x32_bf16 a[140:143], v[88:91], v[56:59], a[140:143]
v_mfma_f32_16x16x32_bf16 a[140:143], v[92:95], v[60:63], a[140:143]
buffer_load_dwordx4 v[116:119], v1, s[12:15], s34 offen offset:1024 sc1
s_waitcnt lgkmcnt(3)
v_mfma_f32_16x16x32_bf16 a[144:147], v[64:67], v[40:43], a[144:147]
ds_read_b128 v[56:59], v2 offset:38912
v_mfma_f32_16x16x32_bf16 a[144:147], v[68:71], v[44:47], a[144:147]
ds_read_b128 v[60:63], v3 offset:38912
v_mfma_f32_16x16x32_bf16 a[148:151], v[72:75], v[40:43], a[148:151]
buffer_load_dwordx4 v[120:123], v1, s[12:15], s34 offen offset:2048 sc1
v_mfma_f32_16x16x32_bf16 a[148:151], v[76:79], v[44:47], a[148:151]
ds_read_b128 v[36:39], v7 offset:7168
v_mfma_f32_16x16x32_bf16 a[152:155], v[80:83], v[40:43], a[152:155]
v_mfma_f32_16x16x32_bf16 a[152:155], v[84:87], v[44:47], a[152:155]
buffer_load_dwordx4 v[124:127], v1, s[12:15], s34 offen offset:3072 sc1
s_add_u32 s33, s33, 0x8000
s_add_u32 s34, s34, 0x8000
v_mfma_f32_16x16x32_bf16 a[156:159], v[88:91], v[40:43], a[156:159]
s_add_u32 s6, s38, 0x2018000
s_waitcnt lgkmcnt(3)
buffer_store_dwordx4 v[32:35], v24, s[20:23], s6 offen sc1
v_mfma_f32_16x16x32_bf16 a[156:159], v[92:95], v[44:47], a[156:159]
v_mfma_f32_16x16x32_bf16 a[160:163], v[64:67], v[48:51], a[160:163]
ds_read_b128 v[40:43], v2 offset:40960
v_mfma_f32_16x16x32_bf16 a[160:163], v[68:71], v[52:55], a[160:163]
ds_read_b128 v[44:47], v3 offset:40960
v_mfma_f32_16x16x32_bf16 a[164:167], v[72:75], v[48:51], a[164:167]
v_mfma_f32_16x16x32_bf16 a[164:167], v[76:79], v[52:55], a[164:167]
ds_read_b128 v[32:35], v6 offset:8192
v_mfma_f32_16x16x32_bf16 a[168:171], v[80:83], v[48:51], a[168:171]
v_mfma_f32_16x16x32_bf16 a[168:171], v[84:87], v[52:55], a[168:171]
v_mfma_f32_16x16x32_bf16 a[172:175], v[88:91], v[48:51], a[172:175]
s_add_u32 s6, s38, 0x201c000
s_waitcnt lgkmcnt(3)
buffer_store_dwordx4 v[36:39], v24, s[20:23], s6 offen sc1
v_mfma_f32_16x16x32_bf16 a[172:175], v[92:95], v[52:55], a[172:175]
v_mfma_f32_16x16x32_bf16 a[176:179], v[64:67], v[56:59], a[176:179]
ds_read_b128 v[48:51], v2 offset:43008
v_mfma_f32_16x16x32_bf16 a[176:179], v[68:71], v[60:63], a[176:179]
ds_read_b128 v[52:55], v3 offset:43008
v_mfma_f32_16x16x32_bf16 a[180:183], v[72:75], v[56:59], a[180:183]
v_mfma_f32_16x16x32_bf16 a[180:183], v[76:79], v[60:63], a[180:183]
v_mfma_f32_16x16x32_bf16 a[184:187], v[80:83], v[56:59], a[184:187]
v_mfma_f32_16x16x32_bf16 a[184:187], v[84:87], v[60:63], a[184:187]
v_mfma_f32_16x16x32_bf16 a[188:191], v[88:91], v[56:59], a[188:191]
s_add_u32 s6, s38, 0x2020000
s_waitcnt lgkmcnt(2)
buffer_store_dwordx4 v[32:35], v24, s[20:23], s6 offen sc1
v_mfma_f32_16x16x32_bf16 a[188:191], v[92:95], v[60:63], a[188:191]
v_mfma_f32_16x16x32_bf16 a[192:195], v[64:67], v[40:43], a[192:195]
ds_read_b128 v[56:59], v2 offset:45056
v_mfma_f32_16x16x32_bf16 a[192:195], v[68:71], v[44:47], a[192:195]
ds_read_b128 v[60:63], v3 offset:45056
v_mfma_f32_16x16x32_bf16 a[196:199], v[72:75], v[40:43], a[196:199]
v_mfma_f32_16x16x32_bf16 a[196:199], v[76:79], v[44:47], a[196:199]
v_mfma_f32_16x16x32_bf16 a[200:203], v[80:83], v[40:43], a[200:203]
v_mfma_f32_16x16x32_bf16 a[200:203], v[84:87], v[44:47], a[200:203]
v_mfma_f32_16x16x32_bf16 a[204:207], v[88:91], v[40:43], a[204:207]
v_mfma_f32_16x16x32_bf16 a[204:207], v[92:95], v[44:47], a[204:207]
s_waitcnt lgkmcnt(2)
v_mfma_f32_16x16x32_bf16 a[208:211], v[64:67], v[48:51], a[208:211]
ds_read_b128 v[40:43], v2 offset:47104
v_mfma_f32_16x16x32_bf16 a[208:211], v[68:71], v[52:55], a[208:211]
ds_read_b128 v[44:47], v3 offset:47104
v_mfma_f32_16x16x32_bf16 a[212:215], v[72:75], v[48:51], a[212:215]
v_mfma_f32_16x16x32_bf16 a[212:215], v[76:79], v[52:55], a[212:215]
v_mfma_f32_16x16x32_bf16 a[216:219], v[80:83], v[48:51], a[216:219]
v_mfma_f32_16x16x32_bf16 a[216:219], v[84:87], v[52:55], a[216:219]
v_mfma_f32_16x16x32_bf16 a[220:223], v[88:91], v[48:51], a[220:223]
v_mfma_f32_16x16x32_bf16 a[220:223], v[92:95], v[52:55], a[220:223]
s_waitcnt lgkmcnt(2)
v_mfma_f32_16x16x32_bf16 a[224:227], v[64:67], v[56:59], a[224:227]
ds_read_b128 v[48:51], v2 offset:49152
v_mfma_f32_16x16x32_bf16 a[224:227], v[68:71], v[60:63], a[224:227]
ds_read_b128 v[52:55], v3 offset:49152
v_mfma_f32_16x16x32_bf16 a[228:231], v[72:75], v[56:59], a[228:231]
v_mfma_f32_16x16x32_bf16 a[228:231], v[76:79], v[60:63], a[228:231]
v_mfma_f32_16x16x32_bf16 a[232:235], v[80:83], v[56:59], a[232:235]
v_mfma_f32_16x16x32_bf16 a[232:235], v[84:87], v[60:63], a[232:235]
v_mfma_f32_16x16x32_bf16 a[236:239], v[88:91], v[56:59], a[236:239]
v_mfma_f32_16x16x32_bf16 a[236:239], v[92:95], v[60:63], a[236:239]
s_waitcnt lgkmcnt(2)
v_mfma_f32_16x16x32_bf16 a[240:243], v[64:67], v[40:43], a[240:243]
ds_read_b128 v[56:59], v2 offset:51200
buffer_load_dwordx4 v[64:67], v1, s[12:15], s33 offen offset:0 sc1
v_mfma_f32_16x16x32_bf16 a[240:243], v[68:71], v[44:47], a[240:243]
ds_read_b128 v[60:63], v3 offset:51200
v_mfma_f32_16x16x32_bf16 a[244:247], v[72:75], v[40:43], a[244:247]
v_mfma_f32_16x16x32_bf16 a[244:247], v[76:79], v[44:47], a[244:247]
buffer_load_dwordx4 v[68:71], v1, s[12:15], s33 offen offset:1024 sc1
v_mfma_f32_16x16x32_bf16 a[248:251], v[80:83], v[40:43], a[248:251]
v_mfma_f32_16x16x32_bf16 a[248:251], v[84:87], v[44:47], a[248:251]
v_mfma_f32_16x16x32_bf16 a[252:255], v[88:91], v[40:43], a[252:255]
buffer_load_dwordx4 v[72:75], v1, s[12:15], s33 offen offset:2048 sc1
v_mfma_f32_16x16x32_bf16 a[252:255], v[92:95], v[44:47], a[252:255]
s_waitcnt vmcnt(13) lgkmcnt(2)
v_mfma_f32_16x16x32_bf16 a[128:131], v[96:99], v[48:51], a[128:131]
ds_read_b128 v[40:43], v2 offset:53248
v_mfma_f32_16x16x32_bf16 a[128:131], v[100:103], v[52:55], a[128:131]
ds_read_b128 v[44:47], v3 offset:53248
buffer_load_dwordx4 v[76:79], v1, s[12:15], s33 offen offset:3072 sc1
s_waitcnt vmcnt(12)
v_mfma_f32_16x16x32_bf16 a[132:135], v[104:107], v[48:51], a[132:135]
v_mfma_f32_16x16x32_bf16 a[132:135], v[108:111], v[52:55], a[132:135]
ds_read_b128 v[36:39], v7 offset:9216
s_waitcnt vmcnt(9)
v_mfma_f32_16x16x32_bf16 a[136:139], v[112:115], v[48:51], a[136:139]
buffer_load_dwordx4 v[80:83], v1, s[12:15], s34 offen offset:0 sc1
v_mfma_f32_16x16x32_bf16 a[136:139], v[116:119], v[52:55], a[136:139]
s_waitcnt vmcnt(8)
v_mfma_f32_16x16x32_bf16 a[140:143], v[120:123], v[48:51], a[140:143]
v_mfma_f32_16x16x32_bf16 a[140:143], v[124:127], v[52:55], a[140:143]
buffer_load_dwordx4 v[84:87], v1, s[12:15], s34 offen offset:1024 sc1
s_waitcnt lgkmcnt(3)
v_mfma_f32_16x16x32_bf16 a[144:147], v[96:99], v[56:59], a[144:147]
ds_read_b128 v[48:51], v2 offset:55296
v_mfma_f32_16x16x32_bf16 a[144:147], v[100:103], v[60:63], a[144:147]
ds_read_b128 v[52:55], v3 offset:55296
v_mfma_f32_16x16x32_bf16 a[148:151], v[104:107], v[56:59], a[148:151]
buffer_load_dwordx4 v[88:91], v1, s[12:15], s34 offen offset:2048 sc1
v_mfma_f32_16x16x32_bf16 a[148:151], v[108:111], v[60:63], a[148:151]
ds_read_b128 v[32:35], v6 offset:10240
v_mfma_f32_16x16x32_bf16 a[152:155], v[112:115], v[56:59], a[152:155]
v_mfma_f32_16x16x32_bf16 a[152:155], v[116:119], v[60:63], a[152:155]
buffer_load_dwordx4 v[92:95], v1, s[12:15], s34 offen offset:3072 sc1
s_add_u32 s33, s33, 0x8000
s_add_u32 s34, s34, 0x8000
v_mfma_f32_16x16x32_bf16 a[156:159], v[120:123], v[56:59], a[156:159]
s_add_u32 s6, s38, 0x2024000
s_waitcnt lgkmcnt(3)
buffer_store_dwordx4 v[36:39], v24, s[20:23], s6 offen sc1
v_mfma_f32_16x16x32_bf16 a[156:159], v[124:127], v[60:63], a[156:159]
v_mfma_f32_16x16x32_bf16 a[160:163], v[96:99], v[40:43], a[160:163]
ds_read_b128 v[56:59], v2 offset:57344
v_mfma_f32_16x16x32_bf16 a[160:163], v[100:103], v[44:47], a[160:163]
ds_read_b128 v[60:63], v3 offset:57344
v_mfma_f32_16x16x32_bf16 a[164:167], v[104:107], v[40:43], a[164:167]
v_mfma_f32_16x16x32_bf16 a[164:167], v[108:111], v[44:47], a[164:167]
ds_read_b128 v[36:39], v7 offset:11264
v_mfma_f32_16x16x32_bf16 a[168:171], v[112:115], v[40:43], a[168:171]
v_mfma_f32_16x16x32_bf16 a[168:171], v[116:119], v[44:47], a[168:171]
v_mfma_f32_16x16x32_bf16 a[172:175], v[120:123], v[40:43], a[172:175]
s_add_u32 s6, s38, 0x2028000
s_waitcnt lgkmcnt(3)
buffer_store_dwordx4 v[32:35], v24, s[20:23], s6 offen sc1
v_mfma_f32_16x16x32_bf16 a[172:175], v[124:127], v[44:47], a[172:175]
v_mfma_f32_16x16x32_bf16 a[176:179], v[96:99], v[48:51], a[176:179]
ds_read_b128 v[40:43], v2 offset:59392
v_mfma_f32_16x16x32_bf16 a[176:179], v[100:103], v[52:55], a[176:179]
ds_read_b128 v[44:47], v3 offset:59392
v_mfma_f32_16x16x32_bf16 a[180:183], v[104:107], v[48:51], a[180:183]
v_mfma_f32_16x16x32_bf16 a[180:183], v[108:111], v[52:55], a[180:183]
v_mfma_f32_16x16x32_bf16 a[184:187], v[112:115], v[48:51], a[184:187]
v_mfma_f32_16x16x32_bf16 a[184:187], v[116:119], v[52:55], a[184:187]
v_mfma_f32_16x16x32_bf16 a[188:191], v[120:123], v[48:51], a[188:191]
s_add_u32 s6, s38, 0x202c000
s_waitcnt lgkmcnt(2)
buffer_store_dwordx4 v[36:39], v24, s[20:23], s6 offen sc1
v_mfma_f32_16x16x32_bf16 a[188:191], v[124:127], v[52:55], a[188:191]
v_mfma_f32_16x16x32_bf16 a[192:195], v[96:99], v[56:59], a[192:195]
ds_read_b128 v[48:51], v2 offset:61440
v_mfma_f32_16x16x32_bf16 a[192:195], v[100:103], v[60:63], a[192:195]
ds_read_b128 v[52:55], v3 offset:61440
v_mfma_f32_16x16x32_bf16 a[196:199], v[104:107], v[56:59], a[196:199]
v_mfma_f32_16x16x32_bf16 a[196:199], v[108:111], v[60:63], a[196:199]
v_mfma_f32_16x16x32_bf16 a[200:203], v[112:115], v[56:59], a[200:203]
v_mfma_f32_16x16x32_bf16 a[200:203], v[116:119], v[60:63], a[200:203]
v_mfma_f32_16x16x32_bf16 a[204:207], v[120:123], v[56:59], a[204:207]
v_mfma_f32_16x16x32_bf16 a[204:207], v[124:127], v[60:63], a[204:207]
s_waitcnt lgkmcnt(2)
v_mfma_f32_16x16x32_bf16 a[208:211], v[96:99], v[40:43], a[208:211]
ds_read_b128 v[56:59], v2 offset:63488
v_mfma_f32_16x16x32_bf16 a[208:211], v[100:103], v[44:47], a[208:211]
ds_read_b128 v[60:63], v3 offset:63488
v_mfma_f32_16x16x32_bf16 a[212:215], v[104:107], v[40:43], a[212:215]
v_mfma_f32_16x16x32_bf16 a[212:215], v[108:111], v[44:47], a[212:215]
v_mfma_f32_16x16x32_bf16 a[216:219], v[112:115], v[40:43], a[216:219]
v_mfma_f32_16x16x32_bf16 a[216:219], v[116:119], v[44:47], a[216:219]
v_mfma_f32_16x16x32_bf16 a[220:223], v[120:123], v[40:43], a[220:223]
v_mfma_f32_16x16x32_bf16 a[220:223], v[124:127], v[44:47], a[220:223]
s_waitcnt lgkmcnt(2)
v_mfma_f32_16x16x32_bf16 a[224:227], v[96:99], v[48:51], a[224:227]
v_mfma_f32_16x16x32_bf16 a[224:227], v[100:103], v[52:55], a[224:227]
v_mfma_f32_16x16x32_bf16 a[228:231], v[104:107], v[48:51], a[228:231]
v_mfma_f32_16x16x32_bf16 a[228:231], v[108:111], v[52:55], a[228:231]
v_mfma_f32_16x16x32_bf16 a[232:235], v[112:115], v[48:51], a[232:235]
v_mfma_f32_16x16x32_bf16 a[232:235], v[116:119], v[52:55], a[232:235]
v_mfma_f32_16x16x32_bf16 a[236:239], v[120:123], v[48:51], a[236:239]
v_mfma_f32_16x16x32_bf16 a[236:239], v[124:127], v[52:55], a[236:239]
s_waitcnt lgkmcnt(0)
s_barrier
v_xor_b32 v2, 0x10000, v2
v_xor_b32 v3, 0x10000, v3
v_mfma_f32_16x16x32_bf16 a[240:243], v[96:99], v[56:59], a[240:243]
ds_read_b128 v[40:43], v2 offset:0
buffer_load_dwordx4 v[96:99], v1, s[12:15], s33 offen offset:0 sc1
v_mfma_f32_16x16x32_bf16 a[240:243], v[100:103], v[60:63], a[240:243]
ds_read_b128 v[44:47], v3 offset:0
v_mfma_f32_16x16x32_bf16 a[244:247], v[104:107], v[56:59], a[244:247]
ds_read_b128 v[48:51], v2 offset:2048
v_mfma_f32_16x16x32_bf16 a[244:247], v[108:111], v[60:63], a[244:247]
ds_read_b128 v[52:55], v3 offset:2048
buffer_load_dwordx4 v[100:103], v1, s[12:15], s33 offen offset:1024 sc1
v_mfma_f32_16x16x32_bf16 a[248:251], v[112:115], v[56:59], a[248:251]
v_mfma_f32_16x16x32_bf16 a[248:251], v[116:119], v[60:63], a[248:251]
v_mfma_f32_16x16x32_bf16 a[252:255], v[120:123], v[56:59], a[252:255]
buffer_load_dwordx4 v[104:107], v1, s[12:15], s33 offen offset:2048 sc1
v_mfma_f32_16x16x32_bf16 a[252:255], v[124:127], v[60:63], a[252:255]
s_waitcnt vmcnt(12) lgkmcnt(2)
v_mfma_f32_16x16x32_bf16 a[0:3], v[64:67], v[40:43], a[0:3]
ds_read_b128 v[56:59], v2 offset:4096
v_mfma_f32_16x16x32_bf16 a[0:3], v[68:71], v[44:47], a[0:3]
ds_read_b128 v[60:63], v3 offset:4096
buffer_load_dwordx4 v[108:111], v1, s[12:15], s33 offen offset:3072 sc1
s_waitcnt vmcnt(11)
v_mfma_f32_16x16x32_bf16 a[4:7], v[72:75], v[40:43], a[4:7]
v_cmp_gt_u32 vcc, 5, v12
s_cbranch_vccz L_pok4
s_mov_b32 s4, 0x40000
L_psp4:
s_sleep 2
buffer_load_dword v12, v11, s[24:27], s42 offen sc1
s_sub_u32 s4, s4, 1
s_cbranch_scc1 L_pok4
s_waitcnt vmcnt(0)
v_cmp_gt_u32 vcc, 5, v12
s_cbranch_vccnz L_psp4
L_pok4:
v_mfma_f32_16x16x32_bf16 a[4:7], v[76:79], v[44:47], a[4:7]
s_add_u32 s35, s38, 0x2000000
ds_read_b128 v[32:35], v6 offset:12288
s_waitcnt vmcnt(9)
v_mfma_f32_16x16x32_bf16 a[8:11], v[80:83], v[40:43], a[8:11]
buffer_load_dwordx4 v[112:115], v1, s[12:15], s34 offen offset:0 sc1
v_mfma_f32_16x16x32_bf16 a[8:11], v[84:87], v[44:47], a[8:11]
s_waitcnt vmcnt(8)
v_mfma_f32_16x16x32_bf16 a[12:15], v[88:91], v[40:43], a[12:15]
v_mfma_f32_16x16x32_bf16 a[12:15], v[92:95], v[44:47], a[12:15]
buffer_load_dwordx4 v[116:119], v1, s[12:15], s34 offen offset:1024 sc1
s_waitcnt lgkmcnt(3)
v_mfma_f32_16x16x32_bf16 a[16:19], v[64:67], v[48:51], a[16:19]
ds_read_b128 v[40:43], v2 offset:6144
v_mfma_f32_16x16x32_bf16 a[16:19], v[68:71], v[52:55], a[16:19]
ds_read_b128 v[44:47], v3 offset:6144
v_mfma_f32_16x16x32_bf16 a[20:23], v[72:75], v[48:51], a[20:23]
buffer_load_dwordx4 v[120:123], v1, s[12:15], s34 offen offset:2048 sc1
v_mfma_f32_16x16x32_bf16 a[20:23], v[76:79], v[52:55], a[20:23]
ds_read_b128 v[36:39], v7 offset:13312
v_mfma_f32_16x16x32_bf16 a[24:27], v[80:83], v[48:51], a[24:27]
v_mfma_f32_16x16x32_bf16 a[24:27], v[84:87], v[52:55], a[24:27]
buffer_load_dwordx4 v[124:127], v1, s[12:15], s34 offen offset:3072 sc1
s_add_u32 s33, s33, 0x8000
s_add_u32 s34, s34, 0x8000
v_mfma_f32_16x16x32_bf16 a[28:31], v[88:91], v[48:51], a[28:31]
s_add_u32 s6, s38, 0x2030000
s_waitcnt lgkmcnt(3)
buffer_store_dwordx4 v[32:35], v24, s[20:23], s6 offen sc1
v_mfma_f32_16x16x32_bf16 a[28:31], v[92:95], v[52:55], a[28:31]
v_mfma_f32_16x16x32_bf16 a[32:35], v[64:67], v[56:59], a[32:35]
ds_read_b128 v[48:51], v2 offset:8192
v_mfma_f32_16x16x32_bf16 a[32:35], v[68:71], v[60:63], a[32:35]
ds_read_b128 v[52:55], v3 offset:8192
v_mfma_f32_16x16x32_bf16 a[36:39], v[72:75], v[56:59], a[36:39]
v_mfma_f32_16x16x32_bf16 a[36:39], v[76:79], v[60:63], a[36:39]
v_mfma_f32_16x16x32_bf16 a[40:43], v[80:83], v[56:59], a[40:43]
s_add_u32 m0, s3, 0x0
v_mfma_f32_16x16x32_bf16 a[40:43], v[84:87], v[60:63], a[40:43]
buffer_load_dwordx4 v8, s[20:23], s35 offen sc1 lds
s_add_u32 s35, s35, 0x10000
v_mfma_f32_16x16x32_bf16 a[44:47], v[88:91], v[56:59], a[44:47]
s_add_u32 s6, s38, 0x2034000
s_waitcnt lgkmcnt(2)
buffer_store_dwordx4 v[36:39], v24, s[20:23], s6 offen sc1
v_mfma_f32_16x16x32_bf16 a[44:47], v[92:95], v[60:63], a[44:47]
v_mfma_f32_16x16x32_bf16 a[48:51], v[64:67], v[40:43], a[48:51]
ds_read_b128 v[56:59], v2 offset:10240
v_mfma_f32_16x16x32_bf16 a[48:51], v[68:71], v[44:47], a[48:51]
ds_read_b128 v[60:63], v3 offset:10240
v_mfma_f32_16x16x32_bf16 a[52:55], v[72:75], v[40:43], a[52:55]
v_mfma_f32_16x16x32_bf16 a[52:55], v[76:79], v[44:47], a[52:55]
v_mfma_f32_16x16x32_bf16 a[56:59], v[80:83], v[40:43], a[56:59]
s_add_u32 m0, s3, 0x1000
v_mfma_f32_16x16x32_bf16 a[56:59], v[84:87], v[44:47], a[56:59]
buffer_load_dwordx4 v8, s[20:23], s35 offen sc1 lds
s_add_u32 s35, s35, 0x10000
v_mfma_f32_16x16x32_bf16 a[60:63], v[88:91], v[40:43], a[60:63]
v_mfma_f32_16x16x32_bf16 a[60:63], v[92:95], v[44:47], a[60:63]
s_waitcnt lgkmcnt(2)
v_mfma_f32_16x16x32_bf16 a[64:67], v[64:67], v[48:51], a[64:67]
ds_read_b128 v[40:43], v2 offset:12288
v_mfma_f32_16x16x32_bf16 a[64:67], v[68:71], v[52:55], a[64:67]
ds_read_b128 v[44:47], v3 offset:12288
v_mfma_f32_16x16x32_bf16 a[68:71], v[72:75], v[48:51], a[68:71]
v_mfma_f32_16x16x32_bf16 a[68:71], v[76:79], v[52:55], a[68:71]
v_mfma_f32_16x16x32_bf16 a[72:75], v[80:83], v[48:51], a[72:75]
s_add_u32 m0, s3, 0x2000
v_mfma_f32_16x16x32_bf16 a[72:75], v[84:87], v[52:55], a[72:75]
buffer_load_dwordx4 v8, s[20:23], s35 offen sc1 lds
s_add_u32 s35, s35, 0x10000
v_mfma_f32_16x16x32_bf16 a[76:79], v[88:91], v[48:51], a[76:79]
v_mfma_f32_16x16x32_bf16 a[76:79], v[92:95], v[52:55], a[76:79]
s_waitcnt lgkmcnt(2)
v_mfma_f32_16x16x32_bf16 a[80:83], v[64:67], v[56:59], a[80:83]
ds_read_b128 v[48:51], v2 offset:14336
v_mfma_f32_16x16x32_bf16 a[80:83], v[68:71], v[60:63], a[80:83]
ds_read_b128 v[52:55], v3 offset:14336
v_mfma_f32_16x16x32_bf16 a[84:87], v[72:75], v[56:59], a[84:87]
v_mfma_f32_16x16x32_bf16 a[84:87], v[76:79], v[60:63], a[84:87]
v_mfma_f32_16x16x32_bf16 a[88:91], v[80:83], v[56:59], a[88:91]
v_mfma_f32_16x16x32_bf16 a[88:91], v[84:87], v[60:63], a[88:91]
v_mfma_f32_16x16x32_bf16 a[92:95], v[88:91], v[56:59], a[92:95]
v_mfma_f32_16x16x32_bf16 a[92:95], v[92:95], v[60:63], a[92:95]
s_waitcnt lgkmcnt(2)
v_mfma_f32_16x16x32_bf16 a[96:99], v[64:67], v[40:43], a[96:99]
ds_read_b128 v[56:59], v2 offset:16384
v_mfma_f32_16x16x32_bf16 a[96:99], v[68:71], v[44:47], a[96:99]
ds_read_b128 v[60:63], v3 offset:16384
v_mfma_f32_16x16x32_bf16 a[100:103], v[72:75], v[40:43], a[100:103]
v_mfma_f32_16x16x32_bf16 a[100:103], v[76:79], v[44:47], a[100:103]
v_mfma_f32_16x16x32_bf16 a[104:107], v[80:83], v[40:43], a[104:107]
v_mfma_f32_16x16x32_bf16 a[104:107], v[84:87], v[44:47], a[104:107]
v_mfma_f32_16x16x32_bf16 a[108:111], v[88:91], v[40:43], a[108:111]
v_mfma_f32_16x16x32_bf16 a[108:111], v[92:95], v[44:47], a[108:111]
s_waitcnt lgkmcnt(2)
v_mfma_f32_16x16x32_bf16 a[112:115], v[64:67], v[48:51], a[112:115]
ds_read_b128 v[40:43], v2 offset:18432
buffer_load_dwordx4 v[64:67], v1, s[12:15], s33 offen offset:0 sc1
v_mfma_f32_16x16x32_bf16 a[112:115], v[68:71], v[52:55], a[112:115]
ds_read_b128 v[44:47], v3 offset:18432
v_mfma_f32_16x16x32_bf16 a[116:119], v[72:75], v[48:51], a[116:119]
v_mfma_f32_16x16x32_bf16 a[116:119], v[76:79], v[52:55], a[116:119]
buffer_load_dwordx4 v[68:71], v1, s[12:15], s33 offen offset:1024 sc1
v_mfma_f32_16x16x32_bf16 a[120:123], v[80:83], v[48:51], a[120:123]
v_mfma_f32_16x16x32_bf16 a[120:123], v[84:87], v[52:55], a[120:123]
v_mfma_f32_16x16x32_bf16 a[124:127], v[88:91], v[48:51], a[124:127]
buffer_load_dwordx4 v[72:75], v1, s[12:15], s33 offen offset:2048 sc1
v_mfma_f32_16x16x32_bf16 a[124:127], v[92:95], v[52:55], a[124:127]
s_waitcnt vmcnt(14) lgkmcnt(2)
v_mfma_f32_16x16x32_bf16 a[0:3], v[96:99], v[56:59], a[0:3]
ds_read_b128 v[48:51], v2 offset:20480
v_mfma_f32_16x16x32_bf16 a[0:3], v[100:103], v[60:63], a[0:3]
ds_read_b128 v[52:55], v3 offset:20480
buffer_load_dwordx4 v[76:79], v1, s[12:15], s33 offen offset:3072 sc1
s_waitcnt vmcnt(13)
v_mfma_f32_16x16x32_bf16 a[4:7], v[104:107], v[56:59], a[4:7]
v_mfma_f32_16x16x32_bf16 a[4:7], v[108:111], v[60:63], a[4:7]
ds_read_b128 v[32:35], v6 offset:14336
v_xor_b32 v6, 0x10000, v6
s_waitcnt vmcnt(11)
v_mfma_f32_16x16x32_bf16 a[8:11], v[112:115], v[56:59], a[8:11]
buffer_load_dwordx4 v[80:83], v1, s[12:15], s34 offen offset:0 sc1
v_mfma_f32_16x16x32_bf16 a[8:11], v[116:119], v[60:63], a[8:11]
s_waitcnt vmcnt(10)
v_mfma_f32_16x16x32_bf16 a[12:15], v[120:123], v[56:59], a[12:15]
v_mfma_f32_16x16x32_bf16 a[12:15], v[124:127], v[60:63], a[12:15]
buffer_load_dwordx4 v[84:87], v1, s[12:15], s34 offen offset:1024 sc1
s_waitcnt lgkmcnt(3)
v_mfma_f32_16x16x32_bf16 a[16:19], v[96:99], v[40:43], a[16:19]
ds_read_b128 v[56:59], v2 offset:22528
v_mfma_f32_16x16x32_bf16 a[16:19], v[100:103], v[44:47], a[16:19]
ds_read_b128 v[60:63], v3 offset:22528
v_mfma_f32_16x16x32_bf16 a[20:23], v[104:107], v[40:43], a[20:23]
buffer_load_dwordx4 v[88:91], v1, s[12:15], s34 offen offset:2048 sc1
v_mfma_f32_16x16x32_bf16 a[20:23], v[108:111], v[44:47], a[20:23]
ds_read_b128 v[36:39], v7 offset:15360
v_xor_b32 v7, 0x10000, v7
v_mfma_f32_16x16x32_bf16 a[24:27], v[112:115], v[40:43], a[24:27]
v_mfma_f32_16x16x32_bf16 a[24:27], v[116:119], v[44:47], a[24:27]
buffer_load_dwordx4 v[92:95], v1, s[12:15], s34 offen offset:3072 sc1
s_add_u32 s33, s33, 0x8000
s_add_u32 s34, s34, 0x8000
v_mfma_f32_16x16x32_bf16 a[28:31], v[120:123], v[40:43], a[28:31]
s_add_u32 s6, s38, 0x2038000
s_waitcnt lgkmcnt(3)
buffer_store_dwordx4 v[32:35], v24, s[20:23], s6 offen sc1
v_mfma_f32_16x16x32_bf16 a[28:31], v[124:127], v[44:47], a[28:31]
v_mfma_f32_16x16x32_bf16 a[32:35], v[96:99], v[48:51], a[32:35]
ds_read_b128 v[40:43], v2 offset:24576
v_mfma_f32_16x16x32_bf16 a[32:35], v[100:103], v[52:55], a[32:35]
ds_read_b128 v[44:47], v3 offset:24576
v_mfma_f32_16x16x32_bf16 a[36:39], v[104:107], v[48:51], a[36:39]
v_mfma_f32_16x16x32_bf16 a[36:39], v[108:111], v[52:55], a[36:39]
v_mfma_f32_16x16x32_bf16 a[40:43], v[112:115], v[48:51], a[40:43]
s_add_u32 m0, s3, 0x3000
v_mfma_f32_16x16x32_bf16 a[40:43], v[116:119], v[52:55], a[40:43]
buffer_load_dwordx4 v8, s[20:23], s35 offen sc1 lds
s_sub_u32 s35, s35, 196480
v_mfma_f32_16x16x32_bf16 a[44:47], v[120:123], v[48:51], a[44:47]
s_add_u32 s6, s38, 0x203c000
s_waitcnt lgkmcnt(2)
buffer_store_dwordx4 v[36:39], v24, s[20:23], s6 offen sc1
v_xor_b32 v24, 0x200, v24
v_mfma_f32_16x16x32_bf16 a[44:47], v[124:127], v[52:55], a[44:47]
v_mfma_f32_16x16x32_bf16 a[48:51], v[96:99], v[56:59], a[48:51]
ds_read_b128 v[48:51], v2 offset:26624
v_mfma_f32_16x16x32_bf16 a[48:51], v[100:103], v[60:63], a[48:51]
ds_read_b128 v[52:55], v3 offset:26624
v_mfma_f32_16x16x32_bf16 a[52:55], v[104:107], v[56:59], a[52:55]
v_mfma_f32_16x16x32_bf16 a[52:55], v[108:111], v[60:63], a[52:55]
v_mfma_f32_16x16x32_bf16 a[56:59], v[112:115], v[56:59], a[56:59]
s_add_u32 m0, s3, 0x4000
v_mfma_f32_16x16x32_bf16 a[56:59], v[116:119], v[60:63], a[56:59]
buffer_load_dwordx4 v8, s[20:23], s35 offen sc1 lds
s_add_u32 s35, s35, 0x10000
v_mfma_f32_16x16x32_bf16 a[60:63], v[120:123], v[56:59], a[60:63]
v_mfma_f32_16x16x32_bf16 a[60:63], v[124:127], v[60:63], a[60:63]
s_waitcnt lgkmcnt(2)
v_mfma_f32_16x16x32_bf16 a[64:67], v[96:99], v[40:43], a[64:67]
ds_read_b128 v[56:59], v2 offset:28672
v_mfma_f32_16x16x32_bf16 a[64:67], v[100:103], v[44:47], a[64:67]
ds_read_b128 v[60:63], v3 offset:28672
v_mfma_f32_16x16x32_bf16 a[68:71], v[104:107], v[40:43], a[68:71]
v_mfma_f32_16x16x32_bf16 a[68:71], v[108:111], v[44:47], a[68:71]
v_mfma_f32_16x16x32_bf16 a[72:75], v[112:115], v[40:43], a[72:75]
s_add_u32 m0, s3, 0x5000
v_mfma_f32_16x16x32_bf16 a[72:75], v[116:119], v[44:47], a[72:75]
buffer_load_dwordx4 v8, s[20:23], s35 offen sc1 lds
s_add_u32 s35, s35, 0x10000
v_mfma_f32_16x16x32_bf16 a[76:79], v[120:123], v[40:43], a[76:79]
v_mfma_f32_16x16x32_bf16 a[76:79], v[124:127], v[44:47], a[76:79]
s_waitcnt lgkmcnt(2)
v_mfma_f32_16x16x32_bf16 a[80:83], v[96:99], v[48:51], a[80:83]
ds_read_b128 v[40:43], v2 offset:30720
v_mfma_f32_16x16x32_bf16 a[80:83], v[100:103], v[52:55], a[80:83]
ds_read_b128 v[44:47], v3 offset:30720
v_mfma_f32_16x16x32_bf16 a[84:87], v[104:107], v[48:51], a[84:87]
v_mfma_f32_16x16x32_bf16 a[84:87], v[108:111], v[52:55], a[84:87]
v_mfma_f32_16x16x32_bf16 a[88:91], v[112:115], v[48:51], a[88:91]
v_mfma_f32_16x16x32_bf16 a[88:91], v[116:119], v[52:55], a[88:91]
v_mfma_f32_16x16x32_bf16 a[92:95], v[120:123], v[48:51], a[92:95]
v_mfma_f32_16x16x32_bf16 a[92:95], v[124:127], v[52:55], a[92:95]
s_waitcnt lgkmcnt(2)
v_mfma_f32_16x16x32_bf16 a[96:99], v[96:99], v[56:59], a[96:99]
ds_read_b128 v[48:51], v2 offset:32768
v_mfma_f32_16x16x32_bf16 a[96:99], v[100:103], v[60:63], a[96:99]
ds_read_b128 v[52:55], v3 offset:32768
v_mfma_f32_16x16x32_bf16 a[100:103], v[104:107], v[56:59], a[100:103]
v_mfma_f32_16x16x32_bf16 a[100:103], v[108:111], v[60:63], a[100:103]
v_mfma_f32_16x16x32_bf16 a[104:107], v[112:115], v[56:59], a[104:107]
v_mfma_f32_16x16x32_bf16 a[104:107], v[116:119], v[60:63], a[104:107]
v_mfma_f32_16x16x32_bf16 a[108:111], v[120:123], v[56:59], a[108:111]
v_mfma_f32_16x16x32_bf16 a[108:111], v[124:127], v[60:63], a[108:111]
s_waitcnt lgkmcnt(2)
v_mfma_f32_16x16x32_bf16 a[112:115], v[96:99], v[40:43], a[112:115]
ds_read_b128 v[56:59], v2 offset:34816
buffer_load_dwordx4 v[96:99], v1, s[12:15], s33 offen offset:0 sc1
v_mfma_f32_16x16x32_bf16 a[112:115], v[100:103], v[44:47], a[112:115]
ds_read_b128 v[60:63], v3 offset:34816
v_mfma_f32_16x16x32_bf16 a[116:119], v[104:107], v[40:43], a[116:119]
v_mfma_f32_16x16x32_bf16 a[116:119], v[108:111], v[44:47], a[116:119]
buffer_load_dwordx4 v[100:103], v1, s[12:15], s33 offen offset:1024 sc1
v_mfma_f32_16x16x32_bf16 a[120:123], v[112:115], v[40:43], a[120:123]
v_mfma_f32_16x16x32_bf16 a[120:123], v[116:119], v[44:47], a[120:123]
v_mfma_f32_16x16x32_bf16 a[124:127], v[120:123], v[40:43], a[124:127]
buffer_load_dwordx4 v[104:107], v1, s[12:15], s33 offen offset:2048 sc1
v_mfma_f32_16x16x32_bf16 a[124:127], v[124:127], v[44:47], a[124:127]
s_waitcnt vmcnt(14) lgkmcnt(2)
v_mfma_f32_16x16x32_bf16 a[0:3], v[64:67], v[48:51], a[0:3]
ds_read_b128 v[40:43], v2 offset:36864
v_mfma_f32_16x16x32_bf16 a[0:3], v[68:71], v[52:55], a[0:3]
ds_read_b128 v[44:47], v3 offset:36864
buffer_load_dwordx4 v[108:111], v1, s[12:15], s33 offen offset:3072 sc1
s_waitcnt vmcnt(13)
v_mfma_f32_16x16x32_bf16 a[4:7], v[72:75], v[48:51], a[4:7]
v_mfma_f32_16x16x32_bf16 a[4:7], v[76:79], v[52:55], a[4:7]
s_waitcnt vmcnt(11)
v_mfma_f32_16x16x32_bf16 a[8:11], v[80:83], v[48:51], a[8:11]
buffer_load_dwordx4 v[112:115], v1, s[12:15], s34 offen offset:0 sc1
v_mfma_f32_16x16x32_bf16 a[8:11], v[84:87], v[52:55], a[8:11]
s_waitcnt vmcnt(10)
v_mfma_f32_16x16x32_bf16 a[12:15], v[88:91], v[48:51], a[12:15]
v_mfma_f32_16x16x32_bf16 a[12:15], v[92:95], v[52:55], a[12:15]
buffer_load_dwordx4 v[116:119], v1, s[12:15], s34 offen offset:1024 sc1
s_waitcnt lgkmcnt(2)
v_mfma_f32_16x16x32_bf16 a[16:19], v[64:67], v[56:59], a[16:19]
ds_read_b128 v[48:51], v2 offset:38912
v_mfma_f32_16x16x32_bf16 a[16:19], v[68:71], v[60:63], a[16:19]
ds_read_b128 v[52:55], v3 offset:38912
v_mfma_f32_16x16x32_bf16 a[20:23], v[72:75], v[56:59], a[20:23]
buffer_load_dwordx4 v[120:123], v1, s[12:15], s34 offen offset:2048 sc1
v_mfma_f32_16x16x32_bf16 a[20:23], v[76:79], v[60:63], a[20:23]
v_mfma_f32_16x16x32_bf16 a[24:27], v[80:83], v[56:59], a[24:27]
v_mfma_f32_16x16x32_bf16 a[24:27], v[84:87], v[60:63], a[24:27]
buffer_load_dwordx4 v[124:127], v1, s[12:15], s34 offen offset:3072 sc1
s_add_u32 s33, s33, 0x8000
s_add_u32 s34, s34, 0x8000
v_mfma_f32_16x16x32_bf16 a[28:31], v[88:91], v[56:59], a[28:31]
v_mfma_f32_16x16x32_bf16 a[28:31], v[92:95], v[60:63], a[28:31]
s_waitcnt lgkmcnt(2)
v_mfma_f32_16x16x32_bf16 a[32:35], v[64:67], v[40:43], a[32:35]
ds_read_b128 v[56:59], v2 offset:40960
v_mfma_f32_16x16x32_bf16 a[32:35], v[68:71], v[44:47], a[32:35]
ds_read_b128 v[60:63], v3 offset:40960
v_mfma_f32_16x16x32_bf16 a[36:39], v[72:75], v[40:43], a[36:39]
v_mfma_f32_16x16x32_bf16 a[36:39], v[76:79], v[44:47], a[36:39]
v_mfma_f32_16x16x32_bf16 a[40:43], v[80:83], v[40:43], a[40:43]
s_add_u32 m0, s3, 0x6000
v_mfma_f32_16x16x32_bf16 a[40:43], v[84:87], v[44:47], a[40:43]
buffer_load_dwordx4 v8, s[20:23], s35 offen sc1 lds
s_add_u32 s35, s35, 0x10000
v_mfma_f32_16x16x32_bf16 a[44:47], v[88:91], v[40:43], a[44:47]
v_mfma_f32_16x16x32_bf16 a[44:47], v[92:95], v[44:47], a[44:47]
s_waitcnt lgkmcnt(2)
v_mfma_f32_16x16x32_bf16 a[48:51], v[64:67], v[48:51], a[48:51]
ds_read_b128 v[40:43], v2 offset:43008
v_mfma_f32_16x16x32_bf16 a[48:51], v[68:71], v[52:55], a[48:51]
ds_read_b128 v[44:47], v3 offset:43008
v_mfma_f32_16x16x32_bf16 a[52:55], v[72:75], v[48:51], a[52:55]
v_mfma_f32_16x16x32_bf16 a[52:55], v[76:79], v[52:55], a[52:55]
v_mfma_f32_16x16x32_bf16 a[56:59], v[80:83], v[48:51], a[56:59]
s_add_u32 m0, s3, 0x7000
v_mfma_f32_16x16x32_bf16 a[56:59], v[84:87], v[52:55], a[56:59]
buffer_load_dwordx4 v8, s[20:23], s35 offen sc1 lds
s_sub_u32 s35, s35, 196480
v_mfma_f32_16x16x32_bf16 a[60:63], v[88:91], v[48:51], a[60:63]
v_mfma_f32_16x16x32_bf16 a[60:63], v[92:95], v[52:55], a[60:63]
s_waitcnt lgkmcnt(2)
v_mfma_f32_16x16x32_bf16 a[64:67], v[64:67], v[56:59], a[64:67]
ds_read_b128 v[48:51], v2 offset:45056
v_mfma_f32_16x16x32_bf16 a[64:67], v[68:71], v[60:63], a[64:67]
ds_read_b128 v[52:55], v3 offset:45056
v_mfma_f32_16x16x32_bf16 a[68:71], v[72:75], v[56:59], a[68:71]
v_mfma_f32_16x16x32_bf16 a[68:71], v[76:79], v[60:63], a[68:71]
v_mfma_f32_16x16x32_bf16 a[72:75], v[80:83], v[56:59], a[72:75]
s_add_u32 m0, s3, 0x8000
v_mfma_f32_16x16x32_bf16 a[72:75], v[84:87], v[60:63], a[72:75]
buffer_load_dwordx4 v8, s[20:23], s35 offen sc1 lds
s_add_u32 s35, s35, 0x10000
v_mfma_f32_16x16x32_bf16 a[76:79], v[88:91], v[56:59], a[76:79]
v_mfma_f32_16x16x32_bf16 a[76:79], v[92:95], v[60:63], a[76:79]
s_waitcnt lgkmcnt(2)
v_mfma_f32_16x16x32_bf16 a[80:83], v[64:67], v[40:43], a[80:83]
ds_read_b128 v[56:59], v2 offset:47104
v_mfma_f32_16x16x32_bf16 a[80:83], v[68:71], v[44:47], a[80:83]
ds_read_b128 v[60:63], v3 offset:47104
v_mfma_f32_16x16x32_bf16 a[84:87], v[72:75], v[40:43], a[84:87]
v_mfma_f32_16x16x32_bf16 a[84:87], v[76:79], v[44:47], a[84:87]
v_mfma_f32_16x16x32_bf16 a[88:91], v[80:83], v[40:43], a[88:91]
v_mfma_f32_16x16x32_bf16 a[88:91], v[84:87], v[44:47], a[88:91]
v_mfma_f32_16x16x32_bf16 a[92:95], v[88:91], v[40:43], a[92:95]
v_mfma_f32_16x16x32_bf16 a[92:95], v[92:95], v[44:47], a[92:95]
s_waitcnt lgkmcnt(2)
v_mfma_f32_16x16x32_bf16 a[96:99], v[64:67], v[48:51], a[96:99]
ds_read_b128 v[40:43], v2 offset:49152
v_mfma_f32_16x16x32_bf16 a[96:99], v[68:71], v[52:55], a[96:99]
ds_read_b128 v[44:47], v3 offset:49152
v_mfma_f32_16x16x32_bf16 a[100:103], v[72:75], v[48:51], a[100:103]
v_mfma_f32_16x16x32_bf16 a[100:103], v[76:79], v[52:55], a[100:103]
v_mfma_f32_16x16x32_bf16 a[104:107], v[80:83], v[48:51], a[104:107]
v_mfma_f32_16x16x32_bf16 a[104:107], v[84:87], v[52:55], a[104:107]
v_mfma_f32_16x16x32_bf16 a[108:111], v[88:91], v[48:51], a[108:111]
v_mfma_f32_16x16x32_bf16 a[108:111], v[92:95], v[52:55], a[108:111]
s_waitcnt lgkmcnt(2)
v_mfma_f32_16x16x32_bf16 a[112:115], v[64:67], v[56:59], a[112:115]
ds_read_b128 v[48:51], v2 offset:51200
buffer_load_dwordx4 v[64:67], v1, s[12:15], s33 offen offset:0 sc1
v_mfma_f32_16x16x32_bf16 a[112:115], v[68:71], v[60:63], a[112:115]
ds_read_b128 v[52:55], v3 offset:51200
v_mfma_f32_16x16x32_bf16 a[116:119], v[72:75], v[56:59], a[116:119]
v_mfma_f32_16x16x32_bf16 a[116:119], v[76:79], v[60:63], a[116:119]
buffer_load_dwordx4 v[68:71], v1, s[12:15], s33 offen offset:1024 sc1
v_mfma_f32_16x16x32_bf16 a[120:123], v[80:83], v[56:59], a[120:123]
v_mfma_f32_16x16x32_bf16 a[120:123], v[84:87], v[60:63], a[120:123]
v_mfma_f32_16x16x32_bf16 a[124:127], v[88:91], v[56:59], a[124:127]
buffer_load_dwordx4 v[72:75], v1, s[12:15], s33 offen offset:2048 sc1
v_mfma_f32_16x16x32_bf16 a[124:127], v[92:95], v[60:63], a[124:127]
s_waitcnt vmcnt(12) lgkmcnt(2)
v_mfma_f32_16x16x32_bf16 a[0:3], v[96:99], v[40:43], a[0:3]
ds_read_b128 v[56:59], v2 offset:53248
v_mfma_f32_16x16x32_bf16 a[0:3], v[100:103], v[44:47], a[0:3]
ds_read_b128 v[60:63], v3 offset:53248
buffer_load_dwordx4 v[76:79], v1, s[12:15], s33 offen offset:3072 sc1
s_waitcnt vmcnt(11)
v_mfma_f32_16x16x32_bf16 a[4:7], v[104:107], v[40:43], a[4:7]
v_mfma_f32_16x16x32_bf16 a[4:7], v[108:111], v[44:47], a[4:7]
s_waitcnt vmcnt(9)
v_mfma_f32_16x16x32_bf16 a[8:11], v[112:115], v[40:43], a[8:11]
buffer_load_dwordx4 v[80:83], v1, s[12:15], s34 offen offset:0 sc1
v_mfma_f32_16x16x32_bf16 a[8:11], v[116:119], v[44:47], a[8:11]
s_waitcnt vmcnt(8)
v_mfma_f32_16x16x32_bf16 a[12:15], v[120:123], v[40:43], a[12:15]
v_mfma_f32_16x16x32_bf16 a[12:15], v[124:127], v[44:47], a[12:15]
buffer_load_dwordx4 v[84:87], v1, s[12:15], s34 offen offset:1024 sc1
v_mov_b32 v0, 6
s_mov_b64 exec, 1
buffer_store_dword v0, off, s[24:27], s41 sc1
s_mov_b64 exec, -1
s_waitcnt lgkmcnt(2)
v_mfma_f32_16x16x32_bf16 a[16:19], v[96:99], v[48:51], a[16:19]
ds_read_b128 v[40:43], v2 offset:55296
v_mfma_f32_16x16x32_bf16 a[16:19], v[100:103], v[52:55], a[16:19]
ds_read_b128 v[44:47], v3 offset:55296
v_mfma_f32_16x16x32_bf16 a[20:23], v[104:107], v[48:51], a[20:23]
buffer_load_dwordx4 v[88:91], v1, s[12:15], s34 offen offset:2048 sc1
v_mfma_f32_16x16x32_bf16 a[20:23], v[108:111], v[52:55], a[20:23]
v_mfma_f32_16x16x32_bf16 a[24:27], v[112:115], v[48:51], a[24:27]
v_mfma_f32_16x16x32_bf16 a[24:27], v[116:119], v[52:55], a[24:27]
buffer_load_dwordx4 v[92:95], v1, s[12:15], s34 offen offset:3072 sc1
s_add_u32 s33, s33, 0x8000
s_add_u32 s34, s34, 0x8000
v_mfma_f32_16x16x32_bf16 a[28:31], v[120:123], v[48:51], a[28:31]
v_mfma_f32_16x16x32_bf16 a[28:31], v[124:127], v[52:55], a[28:31]
s_waitcnt lgkmcnt(2)
v_mfma_f32_16x16x32_bf16 a[32:35], v[96:99], v[56:59], a[32:35]
ds_read_b128 v[48:51], v2 offset:57344
v_mfma_f32_16x16x32_bf16 a[32:35], v[100:103], v[60:63], a[32:35]
ds_read_b128 v[52:55], v3 offset:57344
v_mfma_f32_16x16x32_bf16 a[36:39], v[104:107], v[56:59], a[36:39]
v_mfma_f32_16x16x32_bf16 a[36:39], v[108:111], v[60:63], a[36:39]
v_mfma_f32_16x16x32_bf16 a[40:43], v[112:115], v[56:59], a[40:43]
s_add_u32 m0, s3, 0x9000
v_mfma_f32_16x16x32_bf16 a[40:43], v[116:119], v[60:63], a[40:43]
buffer_load_dwordx4 v8, s[20:23], s35 offen sc1 lds
s_add_u32 s35, s35, 0x10000
v_mfma_f32_16x16x32_bf16 a[44:47], v[120:123], v[56:59], a[44:47]
v_mfma_f32_16x16x32_bf16 a[44:47], v[124:127], v[60:63], a[44:47]
s_waitcnt lgkmcnt(2)
v_mfma_f32_16x16x32_bf16 a[48:51], v[96:99], v[40:43], a[48:51]
ds_read_b128 v[56:59], v2 offset:59392
v_mfma_f32_16x16x32_bf16 a[48:51], v[100:103], v[44:47], a[48:51]
ds_read_b128 v[60:63], v3 offset:59392
v_mfma_f32_16x16x32_bf16 a[52:55], v[104:107], v[40:43], a[52:55]
v_mfma_f32_16x16x32_bf16 a[52:55], v[108:111], v[44:47], a[52:55]
v_mfma_f32_16x16x32_bf16 a[56:59], v[112:115], v[40:43], a[56:59]
s_add_u32 m0, s3, 0xa000
v_mfma_f32_16x16x32_bf16 a[56:59], v[116:119], v[44:47], a[56:59]
buffer_load_dwordx4 v8, s[20:23], s35 offen sc1 lds
s_add_u32 s35, s35, 0x10000
v_mfma_f32_16x16x32_bf16 a[60:63], v[120:123], v[40:43], a[60:63]
v_mfma_f32_16x16x32_bf16 a[60:63], v[124:127], v[44:47], a[60:63]
s_waitcnt lgkmcnt(2)
v_mfma_f32_16x16x32_bf16 a[64:67], v[96:99], v[48:51], a[64:67]
ds_read_b128 v[40:43], v2 offset:61440
v_mfma_f32_16x16x32_bf16 a[64:67], v[100:103], v[52:55], a[64:67]
ds_read_b128 v[44:47], v3 offset:61440
v_mfma_f32_16x16x32_bf16 a[68:71], v[104:107], v[48:51], a[68:71]
v_mfma_f32_16x16x32_bf16 a[68:71], v[108:111], v[52:55], a[68:71]
v_mfma_f32_16x16x32_bf16 a[72:75], v[112:115], v[48:51], a[72:75]
s_add_u32 m0, s3, 0xb000
v_mfma_f32_16x16x32_bf16 a[72:75], v[116:119], v[52:55], a[72:75]
buffer_load_dwordx4 v8, s[20:23], s35 offen sc1 lds
s_sub_u32 s35, s35, 196480
v_mfma_f32_16x16x32_bf16 a[76:79], v[120:123], v[48:51], a[76:79]
v_mfma_f32_16x16x32_bf16 a[76:79], v[124:127], v[52:55], a[76:79]
s_waitcnt lgkmcnt(2)
v_mfma_f32_16x16x32_bf16 a[80:83], v[96:99], v[56:59], a[80:83]
ds_read_b128 v[48:51], v2 offset:63488
v_mfma_f32_16x16x32_bf16 a[80:83], v[100:103], v[60:63], a[80:83]
ds_read_b128 v[52:55], v3 offset:63488
v_mfma_f32_16x16x32_bf16 a[84:87], v[104:107], v[56:59], a[84:87]
v_mfma_f32_16x16x32_bf16 a[84:87], v[108:111], v[60:63], a[84:87]
v_mfma_f32_16x16x32_bf16 a[88:91], v[112:115], v[56:59], a[88:91]
v_mfma_f32_16x16x32_bf16 a[88:91], v[116:119], v[60:63], a[88:91]
v_mfma_f32_16x16x32_bf16 a[92:95], v[120:123], v[56:59], a[92:95]
v_mfma_f32_16x16x32_bf16 a[92:95], v[124:127], v[60:63], a[92:95]
s_waitcnt lgkmcnt(2)
v_mfma_f32_16x16x32_bf16 a[96:99], v[96:99], v[40:43], a[96:99]
ds_read_b128 v[56:59], v2 offset:0
v_mfma_f32_16x16x32_bf16 a[96:99], v[100:103], v[44:47], a[96:99]
ds_read_b128 v[60:63], v3 offset:0
v_mfma_f32_16x16x32_bf16 a[100:103], v[104:107], v[40:43], a[100:103]
v_mfma_f32_16x16x32_bf16 a[100:103], v[108:111], v[44:47], a[100:103]
v_mfma_f32_16x16x32_bf16 a[104:107], v[112:115], v[40:43], a[104:107]
v_mfma_f32_16x16x32_bf16 a[104:107], v[116:119], v[44:47], a[104:107]
v_mfma_f32_16x16x32_bf16 a[108:111], v[120:123], v[40:43], a[108:111]
v_mfma_f32_16x16x32_bf16 a[108:111], v[124:127], v[44:47], a[108:111]
s_waitcnt lgkmcnt(2)
v_mfma_f32_16x16x32_bf16 a[112:115], v[96:99], v[48:51], a[112:115]
ds_read_b128 v[40:43], v2 offset:2048
buffer_load_dwordx4 v[96:99], v1, s[12:15], s33 offen offset:0 sc1
v_mfma_f32_16x16x32_bf16 a[112:115], v[100:103], v[52:55], a[112:115]
ds_read_b128 v[44:47], v3 offset:2048
v_mfma_f32_16x16x32_bf16 a[116:119], v[104:107], v[48:51], a[116:119]
v_mfma_f32_16x16x32_bf16 a[116:119], v[108:111], v[52:55], a[116:119]
buffer_load_dwordx4 v[100:103], v1, s[12:15], s33 offen offset:1024 sc1
v_mfma_f32_16x16x32_bf16 a[120:123], v[112:115], v[48:51], a[120:123]
v_mfma_f32_16x16x32_bf16 a[120:123], v[116:119], v[52:55], a[120:123]
v_mfma_f32_16x16x32_bf16 a[124:127], v[120:123], v[48:51], a[124:127]
buffer_load_dwordx4 v[104:107], v1, s[12:15], s33 offen offset:2048 sc1
v_mfma_f32_16x16x32_bf16 a[124:127], v[124:127], v[52:55], a[124:127]
s_waitcnt vmcnt(13) lgkmcnt(2)
v_mfma_f32_16x16x32_bf16 a[128:131], v[64:67], v[56:59], a[128:131]
ds_read_b128 v[48:51], v2 offset:4096
v_mfma_f32_16x16x32_bf16 a[128:131], v[68:71], v[60:63], a[128:131]
ds_read_b128 v[52:55], v3 offset:4096
buffer_load_dwordx4 v[108:111], v1, s[12:15], s33 offen offset:3072 sc1
s_waitcnt vmcnt(12)
v_mfma_f32_16x16x32_bf16 a[132:135], v[72:75], v[56:59], a[132:135]
v_mfma_f32_16x16x32_bf16 a[132:135], v[76:79], v[60:63], a[132:135]
s_waitcnt vmcnt(10)
v_mfma_f32_16x16x32_bf16 a[136:139], v[80:83], v[56:59], a[136:139]
buffer_load_dwordx4 v[112:115], v1, s[12:15], s34 offen offset:0 sc1
v_mfma_f32_16x16x32_bf16 a[136:139], v[84:87], v[60:63], a[136:139]
s_waitcnt vmcnt(8)
v_mfma_f32_16x16x32_bf16 a[140:143], v[88:91], v[56:59], a[140:143]
v_mfma_f32_16x16x32_bf16 a[140:143], v[92:95], v[60:63], a[140:143]
buffer_load_dwordx4 v[116:119], v1, s[12:15], s34 offen offset:1024 sc1
s_waitcnt lgkmcnt(2)
v_mfma_f32_16x16x32_bf16 a[144:147], v[64:67], v[40:43], a[144:147]
ds_read_b128 v[56:59], v2 offset:6144
v_mfma_f32_16x16x32_bf16 a[144:147], v[68:71], v[44:47], a[144:147]
ds_read_b128 v[60:63], v3 offset:6144
v_mfma_f32_16x16x32_bf16 a[148:151], v[72:75], v[40:43], a[148:151]
buffer_load_dwordx4 v[120:123], v1, s[12:15], s34 offen offset:2048 sc1
v_mfma_f32_16x16x32_bf16 a[148:151], v[76:79], v[44:47], a[148:151]
v_mfma_f32_16x16x32_bf16 a[152:155], v[80:83], v[40:43], a[152:155]
v_mfma_f32_16x16x32_bf16 a[152:155], v[84:87], v[44:47], a[152:155]
buffer_load_dwordx4 v[124:127], v1, s[12:15], s34 offen offset:3072 sc1
s_add_u32 s33, s33, 0x8000
s_add_u32 s34, s34, 0x8000
v_mfma_f32_16x16x32_bf16 a[156:159], v[88:91], v[40:43], a[156:159]
v_mfma_f32_16x16x32_bf16 a[156:159], v[92:95], v[44:47], a[156:159]
s_waitcnt lgkmcnt(2)
v_mfma_f32_16x16x32_bf16 a[160:163], v[64:67], v[48:51], a[160:163]
ds_read_b128 v[40:43], v2 offset:8192
v_mfma_f32_16x16x32_bf16 a[160:163], v[68:71], v[52:55], a[160:163]
ds_read_b128 v[44:47], v3 offset:8192
v_mfma_f32_16x16x32_bf16 a[164:167], v[72:75], v[48:51], a[164:167]
v_mfma_f32_16x16x32_bf16 a[164:167], v[76:79], v[52:55], a[164:167]
v_mfma_f32_16x16x32_bf16 a[168:171], v[80:83], v[48:51], a[168:171]
s_add_u32 m0, s3, 0xc000
v_mfma_f32_16x16x32_bf16 a[168:171], v[84:87], v[52:55], a[168:171]
buffer_load_dwordx4 v8, s[20:23], s35 offen sc1 lds
s_add_u32 s35, s35, 0x10000
v_mfma_f32_16x16x32_bf16 a[172:175], v[88:91], v[48:51], a[172:175]
v_mfma_f32_16x16x32_bf16 a[172:175], v[92:95], v[52:55], a[172:175]
s_waitcnt lgkmcnt(2)
v_mfma_f32_16x16x32_bf16 a[176:179], v[64:67], v[56:59], a[176:179]
ds_read_b128 v[48:51], v2 offset:10240
v_mfma_f32_16x16x32_bf16 a[176:179], v[68:71], v[60:63], a[176:179]
ds_read_b128 v[52:55], v3 offset:10240
v_mfma_f32_16x16x32_bf16 a[180:183], v[72:75], v[56:59], a[180:183]
v_mfma_f32_16x16x32_bf16 a[180:183], v[76:79], v[60:63], a[180:183]
v_mfma_f32_16x16x32_bf16 a[184:187], v[80:83], v[56:59], a[184:187]
s_add_u32 m0, s3, 0xd000
v_mfma_f32_16x16x32_bf16 a[184:187], v[84:87], v[60:63], a[184:187]
buffer_load_dwordx4 v8, s[20:23], s35 offen sc1 lds
s_add_u32 s35, s35, 0x10000
v_mfma_f32_16x16x32_bf16 a[188:191], v[88:91], v[56:59], a[188:191]
v_mfma_f32_16x16x32_bf16 a[188:191], v[92:95], v[60:63], a[188:191]
s_waitcnt lgkmcnt(2)
v_mfma_f32_16x16x32_bf16 a[192:195], v[64:67], v[40:43], a[192:195]
ds_read_b128 v[56:59], v2 offset:12288
v_mfma_f32_16x16x32_bf16 a[192:195], v[68:71], v[44:47], a[192:195]
ds_read_b128 v[60:63], v3 offset:12288
v_mfma_f32_16x16x32_bf16 a[196:199], v[72:75], v[40:43], a[196:199]
v_mfma_f32_16x16x32_bf16 a[196:199], v[76:79], v[44:47], a[196:199]
v_mfma_f32_16x16x32_bf16 a[200:203], v[80:83], v[40:43], a[200:203]
v_mfma_f32_16x16x32_bf16 a[200:203], v[84:87], v[44:47], a[200:203]
v_mfma_f32_16x16x32_bf16 a[204:207], v[88:91], v[40:43], a[204:207]
v_mfma_f32_16x16x32_bf16 a[204:207], v[92:95], v[44:47], a[204:207]
s_waitcnt lgkmcnt(2)
v_mfma_f32_16x16x32_bf16 a[208:211], v[64:67], v[48:51], a[208:211]
ds_read_b128 v[40:43], v2 offset:14336
v_mfma_f32_16x16x32_bf16 a[208:211], v[68:71], v[52:55], a[208:211]
ds_read_b128 v[44:47], v3 offset:14336
v_mfma_f32_16x16x32_bf16 a[212:215], v[72:75], v[48:51], a[212:215]
v_mfma_f32_16x16x32_bf16 a[212:215], v[76:79], v[52:55], a[212:215]
v_mfma_f32_16x16x32_bf16 a[216:219], v[80:83], v[48:51], a[216:219]
v_mfma_f32_16x16x32_bf16 a[216:219], v[84:87], v[52:55], a[216:219]
v_mfma_f32_16x16x32_bf16 a[220:223], v[88:91], v[48:51], a[220:223]
v_mfma_f32_16x16x32_bf16 a[220:223], v[92:95], v[52:55], a[220:223]
s_waitcnt lgkmcnt(2)
v_mfma_f32_16x16x32_bf16 a[224:227], v[64:67], v[56:59], a[224:227]
ds_read_b128 v[48:51], v2 offset:16384
v_mfma_f32_16x16x32_bf16 a[224:227], v[68:71], v[60:63], a[224:227]
ds_read_b128 v[52:55], v3 offset:16384
v_mfma_f32_16x16x32_bf16 a[228:231], v[72:75], v[56:59], a[228:231]
v_mfma_f32_16x16x32_bf16 a[228:231], v[76:79], v[60:63], a[228:231]
v_mfma_f32_16x16x32_bf16 a[232:235], v[80:83], v[56:59], a[232:235]
v_mfma_f32_16x16x32_bf16 a[232:235], v[84:87], v[60:63], a[232:235]
v_mfma_f32_16x16x32_bf16 a[236:239], v[88:91], v[56:59], a[236:239]
v_mfma_f32_16x16x32_bf16 a[236:239], v[92:95], v[60:63], a[236:239]
s_waitcnt lgkmcnt(2)
v_mfma_f32_16x16x32_bf16 a[240:243], v[64:67], v[40:43], a[240:243]
ds_read_b128 v[56:59], v2 offset:18432
buffer_load_dwordx4 v[64:67], v1, s[12:15], s33 offen offset:0 sc1
v_mfma_f32_16x16x32_bf16 a[240:243], v[68:71], v[44:47], a[240:243]
ds_read_b128 v[60:63], v3 offset:18432
v_mfma_f32_16x16x32_bf16 a[244:247], v[72:75], v[40:43], a[244:247]
v_mfma_f32_16x16x32_bf16 a[244:247], v[76:79], v[44:47], a[244:247]
buffer_load_dwordx4 v[68:71], v1, s[12:15], s33 offen offset:1024 sc1
v_mfma_f32_16x16x32_bf16 a[248:251], v[80:83], v[40:43], a[248:251]
v_mfma_f32_16x16x32_bf16 a[248:251], v[84:87], v[44:47], a[248:251]
v_mfma_f32_16x16x32_bf16 a[252:255], v[88:91], v[40:43], a[252:255]
buffer_load_dwordx4 v[72:75], v1, s[12:15], s33 offen offset:2048 sc1
v_mfma_f32_16x16x32_bf16 a[252:255], v[92:95], v[44:47], a[252:255]
s_waitcnt vmcnt(11) lgkmcnt(2)
v_mfma_f32_16x16x32_bf16 a[128:131], v[96:99], v[48:51], a[128:131]
ds_read_b128 v[40:43], v2 offset:20480
v_mfma_f32_16x16x32_bf16 a[128:131], v[100:103], v[52:55], a[128:131]
ds_read_b128 v[44:47], v3 offset:20480
buffer_load_dwordx4 v[76:79], v1, s[12:15], s33 offen offset:3072 sc1
s_waitcnt vmcnt(10)
v_mfma_f32_16x16x32_bf16 a[132:135], v[104:107], v[48:51], a[132:135]
v_mfma_f32_16x16x32_bf16 a[132:135], v[108:111], v[52:55], a[132:135]
s_waitcnt vmcnt(8)
v_mfma_f32_16x16x32_bf16 a[136:139], v[112:115], v[48:51], a[136:139]
buffer_load_dwordx4 v[80:83], v1, s[12:15], s34 offen offset:0 sc1
v_mfma_f32_16x16x32_bf16 a[136:139], v[116:119], v[52:55], a[136:139]
s_waitcnt vmcnt(7)
v_mfma_f32_16x16x32_bf16 a[140:143], v[120:123], v[48:51], a[140:143]
v_mfma_f32_16x16x32_bf16 a[140:143], v[124:127], v[52:55], a[140:143]
buffer_load_dwordx4 v[84:87], v1, s[12:15], s34 offen offset:1024 sc1
s_waitcnt lgkmcnt(2)
v_mfma_f32_16x16x32_bf16 a[144:147], v[96:99], v[56:59], a[144:147]
ds_read_b128 v[48:51], v2 offset:22528
v_mfma_f32_16x16x32_bf16 a[144:147], v[100:103], v[60:63], a[144:147]
ds_read_b128 v[52:55], v3 offset:22528
v_mfma_f32_16x16x32_bf16 a[148:151], v[104:107], v[56:59], a[148:151]
buffer_load_dwordx4 v[88:91], v1, s[12:15], s34 offen offset:2048 sc1
v_mfma_f32_16x16x32_bf16 a[148:151], v[108:111], v[60:63], a[148:151]
v_mfma_f32_16x16x32_bf16 a[152:155], v[112:115], v[56:59], a[152:155]
v_mfma_f32_16x16x32_bf16 a[152:155], v[116:119], v[60:63], a[152:155]
buffer_load_dwordx4 v[92:95], v1, s[12:15], s34 offen offset:3072 sc1
s_add_u32 s33, s33, 0x8000
s_add_u32 s34, s34, 0x8000
v_mfma_f32_16x16x32_bf16 a[156:159], v[120:123], v[56:59], a[156:159]
v_mfma_f32_16x16x32_bf16 a[156:159], v[124:127], v[60:63], a[156:159]
s_waitcnt lgkmcnt(2)
v_mfma_f32_16x16x32_bf16 a[160:163], v[96:99], v[40:43], a[160:163]
ds_read_b128 v[56:59], v2 offset:24576
v_mfma_f32_16x16x32_bf16 a[160:163], v[100:103], v[44:47], a[160:163]
ds_read_b128 v[60:63], v3 offset:24576
v_mfma_f32_16x16x32_bf16 a[164:167], v[104:107], v[40:43], a[164:167]
v_mfma_f32_16x16x32_bf16 a[164:167], v[108:111], v[44:47], a[164:167]
v_mfma_f32_16x16x32_bf16 a[168:171], v[112:115], v[40:43], a[168:171]
s_add_u32 m0, s3, 0xe000
v_mfma_f32_16x16x32_bf16 a[168:171], v[116:119], v[44:47], a[168:171]
buffer_load_dwordx4 v8, s[20:23], s35 offen sc1 lds
s_add_u32 s35, s35, 0x10000
v_mfma_f32_16x16x32_bf16 a[172:175], v[120:123], v[40:43], a[172:175]
v_mfma_f32_16x16x32_bf16 a[172:175], v[124:127], v[44:47], a[172:175]
s_waitcnt lgkmcnt(2)
v_mfma_f32_16x16x32_bf16 a[176:179], v[96:99], v[48:51], a[176:179]
ds_read_b128 v[40:43], v2 offset:26624
v_mfma_f32_16x16x32_bf16 a[176:179], v[100:103], v[52:55], a[176:179]
ds_read_b128 v[44:47], v3 offset:26624
v_mfma_f32_16x16x32_bf16 a[180:183], v[104:107], v[48:51], a[180:183]
v_mfma_f32_16x16x32_bf16 a[180:183], v[108:111], v[52:55], a[180:183]
v_mfma_f32_16x16x32_bf16 a[184:187], v[112:115], v[48:51], a[184:187]
s_add_u32 m0, s3, 0xf000
v_mfma_f32_16x16x32_bf16 a[184:187], v[116:119], v[52:55], a[184:187]
buffer_load_dwordx4 v8, s[20:23], s35 offen sc1 lds
v_xor_b32 v8, 0x200, v8
v_mfma_f32_16x16x32_bf16 a[188:191], v[120:123], v[48:51], a[188:191]
v_mfma_f32_16x16x32_bf16 a[188:191], v[124:127], v[52:55], a[188:191]
s_waitcnt lgkmcnt(2)
v_mfma_f32_16x16x32_bf16 a[192:195], v[96:99], v[56:59], a[192:195]
ds_read_b128 v[48:51], v2 offset:28672
v_mfma_f32_16x16x32_bf16 a[192:195], v[100:103], v[60:63], a[192:195]
ds_read_b128 v[52:55], v3 offset:28672
v_mfma_f32_16x16x32_bf16 a[196:199], v[104:107], v[56:59], a[196:199]
v_mfma_f32_16x16x32_bf16 a[196:199], v[108:111], v[60:63], a[196:199]
v_mfma_f32_16x16x32_bf16 a[200:203], v[112:115], v[56:59], a[200:203]
v_mfma_f32_16x16x32_bf16 a[200:203], v[116:119], v[60:63], a[200:203]
v_mfma_f32_16x16x32_bf16 a[204:207], v[120:123], v[56:59], a[204:207]
v_mfma_f32_16x16x32_bf16 a[204:207], v[124:127], v[60:63], a[204:207]
s_waitcnt lgkmcnt(2)
v_mfma_f32_16x16x32_bf16 a[208:211], v[96:99], v[40:43], a[208:211]
ds_read_b128 v[56:59], v2 offset:30720
v_mfma_f32_16x16x32_bf16 a[208:211], v[100:103], v[44:47], a[208:211]
ds_read_b128 v[60:63], v3 offset:30720
v_mfma_f32_16x16x32_bf16 a[212:215], v[104:107], v[40:43], a[212:215]
v_mfma_f32_16x16x32_bf16 a[212:215], v[108:111], v[44:47], a[212:215]
v_mfma_f32_16x16x32_bf16 a[216:219], v[112:115], v[40:43], a[216:219]
v_mfma_f32_16x16x32_bf16 a[216:219], v[116:119], v[44:47], a[216:219]
v_mfma_f32_16x16x32_bf16 a[220:223], v[120:123], v[40:43], a[220:223]
v_mfma_f32_16x16x32_bf16 a[220:223], v[124:127], v[44:47], a[220:223]
s_waitcnt lgkmcnt(2)
v_mfma_f32_16x16x32_bf16 a[224:227], v[96:99], v[48:51], a[224:227]
ds_read_b128 v[40:43], v2 offset:32768
v_mfma_f32_16x16x32_bf16 a[224:227], v[100:103], v[52:55], a[224:227]
ds_read_b128 v[44:47], v3 offset:32768
v_mfma_f32_16x16x32_bf16 a[228:231], v[104:107], v[48:51], a[228:231]
v_mfma_f32_16x16x32_bf16 a[228:231], v[108:111], v[52:55], a[228:231]
v_mfma_f32_16x16x32_bf16 a[232:235], v[112:115], v[48:51], a[232:235]
v_mfma_f32_16x16x32_bf16 a[232:235], v[116:119], v[52:55], a[232:235]
v_mfma_f32_16x16x32_bf16 a[236:239], v[120:123], v[48:51], a[236:239]
v_mfma_f32_16x16x32_bf16 a[236:239], v[124:127], v[52:55], a[236:239]
s_waitcnt lgkmcnt(2)
v_mfma_f32_16x16x32_bf16 a[240:243], v[96:99], v[56:59], a[240:243]
ds_read_b128 v[48:51], v2 offset:34816
buffer_load_dwordx4 v[96:99], v1, s[12:15], s33 offen offset:0 sc1
v_mfma_f32_16x16x32_bf16 a[240:243], v[100:103], v[60:63], a[240:243]
ds_read_b128 v[52:55], v3 offset:34816
v_mfma_f32_16x16x32_bf16 a[244:247], v[104:107], v[56:59], a[244:247]
v_mfma_f32_16x16x32_bf16 a[244:247], v[108:111], v[60:63], a[244:247]
buffer_load_dwordx4 v[100:103], v1, s[12:15], s33 offen offset:1024 sc1
v_mfma_f32_16x16x32_bf16 a[248:251], v[112:115], v[56:59], a[248:251]
v_mfma_f32_16x16x32_bf16 a[248:251], v[116:119], v[60:63], a[248:251]
v_mfma_f32_16x16x32_bf16 a[252:255], v[120:123], v[56:59], a[252:255]
buffer_load_dwordx4 v[104:107], v1, s[12:15], s33 offen offset:2048 sc1
v_mfma_f32_16x16x32_bf16 a[252:255], v[124:127], v[60:63], a[252:255]
s_waitcnt vmcnt(11) lgkmcnt(2)
v_mfma_f32_16x16x32_bf16 a[128:131], v[64:67], v[40:43], a[128:131]
ds_read_b128 v[56:59], v2 offset:36864
v_mfma_f32_16x16x32_bf16 a[128:131], v[68:71], v[44:47], a[128:131]
ds_read_b128 v[60:63], v3 offset:36864
buffer_load_dwordx4 v[108:111], v1, s[12:15], s33 offen offset:3072 sc1
buffer_load_dword v12, v11, s[24:27], s42 offen sc1
s_waitcnt vmcnt(11)
v_mfma_f32_16x16x32_bf16 a[132:135], v[72:75], v[40:43], a[132:135]
v_mfma_f32_16x16x32_bf16 a[132:135], v[76:79], v[44:47], a[132:135]
s_waitcnt vmcnt(9)
v_mfma_f32_16x16x32_bf16 a[136:139], v[80:83], v[40:43], a[136:139]
buffer_load_dwordx4 v[112:115], v1, s[12:15], s34 offen offset:0 sc1
v_mfma_f32_16x16x32_bf16 a[136:139], v[84:87], v[44:47], a[136:139]
s_waitcnt vmcnt(8)
v_mfma_f32_16x16x32_bf16 a[140:143], v[88:91], v[40:43], a[140:143]
v_mfma_f32_16x16x32_bf16 a[140:143], v[92:95], v[44:47], a[140:143]
buffer_load_dwordx4 v[116:119], v1, s[12:15], s34 offen offset:1024 sc1
s_waitcnt lgkmcnt(2)
v_mfma_f32_16x16x32_bf16 a[144:147], v[64:67], v[48:51], a[144:147]
ds_read_b128 v[40:43], v2 offset:38912
v_mfma_f32_16x16x32_bf16 a[144:147], v[68:71], v[52:55], a[144:147]
ds_read_b128 v[44:47], v3 offset:38912
v_mfma_f32_16x16x32_bf16 a[148:151], v[72:75], v[48:51], a[148:151]
buffer_load_dwordx4 v[120:123], v1, s[12:15], s34 offen offset:2048 sc1
v_mfma_f32_16x16x32_bf16 a[148:151], v[76:79], v[52:55], a[148:151]
v_lshlrev_b32 v20, 2, v1
s_add_u32 s5, s7, L_cs5-standalone__cross_network_dcn__recsys_kernel
buffer_load_dword v22, v20, s[28:31], s5 offen
v_mfma_f32_16x16x32_bf16 a[152:155], v[80:83], v[48:51], a[152:155]
v_mfma_f32_16x16x32_bf16 a[152:155], v[84:87], v[52:55], a[152:155]
buffer_load_dwordx4 v[124:127], v1, s[12:15], s34 offen offset:3072 sc1
s_add_u32 s33, s33, 0x8000
s_add_u32 s34, s34, 0x8000
v_mfma_f32_16x16x32_bf16 a[156:159], v[88:91], v[48:51], a[156:159]
v_mfma_f32_16x16x32_bf16 a[156:159], v[92:95], v[52:55], a[156:159]
s_waitcnt lgkmcnt(2)
v_mfma_f32_16x16x32_bf16 a[160:163], v[64:67], v[56:59], a[160:163]
ds_read_b128 v[48:51], v2 offset:40960
v_mfma_f32_16x16x32_bf16 a[160:163], v[68:71], v[60:63], a[160:163]
ds_read_b128 v[52:55], v3 offset:40960
v_mfma_f32_16x16x32_bf16 a[164:167], v[72:75], v[56:59], a[164:167]
v_mfma_f32_16x16x32_bf16 a[164:167], v[76:79], v[60:63], a[164:167]
v_mfma_f32_16x16x32_bf16 a[168:171], v[80:83], v[56:59], a[168:171]
v_mfma_f32_16x16x32_bf16 a[168:171], v[84:87], v[60:63], a[168:171]
v_mfma_f32_16x16x32_bf16 a[172:175], v[88:91], v[56:59], a[172:175]
v_mfma_f32_16x16x32_bf16 a[172:175], v[92:95], v[60:63], a[172:175]
s_waitcnt lgkmcnt(2)
v_mfma_f32_16x16x32_bf16 a[176:179], v[64:67], v[40:43], a[176:179]
ds_read_b128 v[56:59], v2 offset:43008
v_mfma_f32_16x16x32_bf16 a[176:179], v[68:71], v[44:47], a[176:179]
ds_read_b128 v[60:63], v3 offset:43008
v_mfma_f32_16x16x32_bf16 a[180:183], v[72:75], v[40:43], a[180:183]
v_mfma_f32_16x16x32_bf16 a[180:183], v[76:79], v[44:47], a[180:183]
v_mfma_f32_16x16x32_bf16 a[184:187], v[80:83], v[40:43], a[184:187]
v_mfma_f32_16x16x32_bf16 a[184:187], v[84:87], v[44:47], a[184:187]
v_mfma_f32_16x16x32_bf16 a[188:191], v[88:91], v[40:43], a[188:191]
v_mfma_f32_16x16x32_bf16 a[188:191], v[92:95], v[44:47], a[188:191]
s_waitcnt lgkmcnt(2)
v_mfma_f32_16x16x32_bf16 a[192:195], v[64:67], v[48:51], a[192:195]
ds_read_b128 v[40:43], v2 offset:45056
v_mfma_f32_16x16x32_bf16 a[192:195], v[68:71], v[52:55], a[192:195]
ds_read_b128 v[44:47], v3 offset:45056
v_mfma_f32_16x16x32_bf16 a[196:199], v[72:75], v[48:51], a[196:199]
v_mfma_f32_16x16x32_bf16 a[196:199], v[76:79], v[52:55], a[196:199]
v_mfma_f32_16x16x32_bf16 a[200:203], v[80:83], v[48:51], a[200:203]
v_mfma_f32_16x16x32_bf16 a[200:203], v[84:87], v[52:55], a[200:203]
v_mfma_f32_16x16x32_bf16 a[204:207], v[88:91], v[48:51], a[204:207]
v_mfma_f32_16x16x32_bf16 a[204:207], v[92:95], v[52:55], a[204:207]
s_waitcnt lgkmcnt(2)
v_mfma_f32_16x16x32_bf16 a[208:211], v[64:67], v[56:59], a[208:211]
ds_read_b128 v[48:51], v2 offset:47104
v_mfma_f32_16x16x32_bf16 a[208:211], v[68:71], v[60:63], a[208:211]
ds_read_b128 v[52:55], v3 offset:47104
v_mfma_f32_16x16x32_bf16 a[212:215], v[72:75], v[56:59], a[212:215]
v_mfma_f32_16x16x32_bf16 a[212:215], v[76:79], v[60:63], a[212:215]
v_mfma_f32_16x16x32_bf16 a[216:219], v[80:83], v[56:59], a[216:219]
v_mfma_f32_16x16x32_bf16 a[216:219], v[84:87], v[60:63], a[216:219]
v_mfma_f32_16x16x32_bf16 a[220:223], v[88:91], v[56:59], a[220:223]
v_mfma_f32_16x16x32_bf16 a[220:223], v[92:95], v[60:63], a[220:223]
s_waitcnt lgkmcnt(2)
v_mfma_f32_16x16x32_bf16 a[224:227], v[64:67], v[40:43], a[224:227]
ds_read_b128 v[56:59], v2 offset:49152
v_mfma_f32_16x16x32_bf16 a[224:227], v[68:71], v[44:47], a[224:227]
ds_read_b128 v[60:63], v3 offset:49152
v_mfma_f32_16x16x32_bf16 a[228:231], v[72:75], v[40:43], a[228:231]
v_mfma_f32_16x16x32_bf16 a[228:231], v[76:79], v[44:47], a[228:231]
v_mfma_f32_16x16x32_bf16 a[232:235], v[80:83], v[40:43], a[232:235]
v_mfma_f32_16x16x32_bf16 a[232:235], v[84:87], v[44:47], a[232:235]
v_mfma_f32_16x16x32_bf16 a[236:239], v[88:91], v[40:43], a[236:239]
v_mfma_f32_16x16x32_bf16 a[236:239], v[92:95], v[44:47], a[236:239]
s_waitcnt lgkmcnt(2)
v_mfma_f32_16x16x32_bf16 a[240:243], v[64:67], v[48:51], a[240:243]
ds_read_b128 v[40:43], v2 offset:51200
buffer_load_dwordx4 v[64:67], v1, s[12:15], s33 offen offset:0 sc1
v_mfma_f32_16x16x32_bf16 a[240:243], v[68:71], v[52:55], a[240:243]
ds_read_b128 v[44:47], v3 offset:51200
v_mfma_f32_16x16x32_bf16 a[244:247], v[72:75], v[48:51], a[244:247]
v_mfma_f32_16x16x32_bf16 a[244:247], v[76:79], v[52:55], a[244:247]
buffer_load_dwordx4 v[68:71], v1, s[12:15], s33 offen offset:1024 sc1
v_mfma_f32_16x16x32_bf16 a[248:251], v[80:83], v[48:51], a[248:251]
v_mfma_f32_16x16x32_bf16 a[248:251], v[84:87], v[52:55], a[248:251]
v_mfma_f32_16x16x32_bf16 a[252:255], v[88:91], v[48:51], a[252:255]
buffer_load_dwordx4 v[72:75], v1, s[12:15], s33 offen offset:2048 sc1
v_mfma_f32_16x16x32_bf16 a[252:255], v[92:95], v[52:55], a[252:255]
s_waitcnt vmcnt(11) lgkmcnt(2)
v_mfma_f32_16x16x32_bf16 a[128:131], v[96:99], v[56:59], a[128:131]
ds_read_b128 v[48:51], v2 offset:53248
v_mfma_f32_16x16x32_bf16 a[128:131], v[100:103], v[60:63], a[128:131]
ds_read_b128 v[52:55], v3 offset:53248
buffer_load_dwordx4 v[76:79], v1, s[12:15], s33 offen offset:3072 sc1
s_waitcnt vmcnt(10)
v_mfma_f32_16x16x32_bf16 a[132:135], v[104:107], v[56:59], a[132:135]
v_mfma_f32_16x16x32_bf16 a[132:135], v[108:111], v[60:63], a[132:135]
s_waitcnt vmcnt(7)
v_mfma_f32_16x16x32_bf16 a[136:139], v[112:115], v[56:59], a[136:139]
buffer_load_dwordx4 v[80:83], v1, s[12:15], s34 offen offset:0 sc1
v_mfma_f32_16x16x32_bf16 a[136:139], v[116:119], v[60:63], a[136:139]
s_waitcnt vmcnt(5)
v_mfma_f32_16x16x32_bf16 a[140:143], v[120:123], v[56:59], a[140:143]
v_mfma_f32_16x16x32_bf16 a[140:143], v[124:127], v[60:63], a[140:143]
buffer_load_dwordx4 v[84:87], v1, s[12:15], s34 offen offset:1024 sc1
s_waitcnt lgkmcnt(2)
v_mfma_f32_16x16x32_bf16 a[144:147], v[96:99], v[40:43], a[144:147]
ds_read_b128 v[56:59], v2 offset:55296
v_mfma_f32_16x16x32_bf16 a[144:147], v[100:103], v[44:47], a[144:147]
ds_read_b128 v[60:63], v3 offset:55296
v_mfma_f32_16x16x32_bf16 a[148:151], v[104:107], v[40:43], a[148:151]
buffer_load_dwordx4 v[88:91], v1, s[12:15], s34 offen offset:2048 sc1
v_mfma_f32_16x16x32_bf16 a[148:151], v[108:111], v[44:47], a[148:151]
v_mfma_f32_16x16x32_bf16 a[152:155], v[112:115], v[40:43], a[152:155]
v_mfma_f32_16x16x32_bf16 a[152:155], v[116:119], v[44:47], a[152:155]
buffer_load_dwordx4 v[92:95], v1, s[12:15], s34 offen offset:3072 sc1
s_add_u32 s33, s33, 0x8000
s_add_u32 s34, s34, 0x8000
v_mfma_f32_16x16x32_bf16 a[156:159], v[120:123], v[40:43], a[156:159]
v_mfma_f32_16x16x32_bf16 a[156:159], v[124:127], v[44:47], a[156:159]
s_waitcnt lgkmcnt(2)
v_mfma_f32_16x16x32_bf16 a[160:163], v[96:99], v[48:51], a[160:163]
ds_read_b128 v[40:43], v2 offset:57344
v_mfma_f32_16x16x32_bf16 a[160:163], v[100:103], v[52:55], a[160:163]
ds_read_b128 v[44:47], v3 offset:57344
v_mfma_f32_16x16x32_bf16 a[164:167], v[104:107], v[48:51], a[164:167]
v_mfma_f32_16x16x32_bf16 a[164:167], v[108:111], v[52:55], a[164:167]
v_mfma_f32_16x16x32_bf16 a[168:171], v[112:115], v[48:51], a[168:171]
v_mfma_f32_16x16x32_bf16 a[168:171], v[116:119], v[52:55], a[168:171]
v_mfma_f32_16x16x32_bf16 a[172:175], v[120:123], v[48:51], a[172:175]
v_mfma_f32_16x16x32_bf16 a[172:175], v[124:127], v[52:55], a[172:175]
s_waitcnt lgkmcnt(2)
v_mfma_f32_16x16x32_bf16 a[176:179], v[96:99], v[56:59], a[176:179]
ds_read_b128 v[48:51], v2 offset:59392
v_mfma_f32_16x16x32_bf16 a[176:179], v[100:103], v[60:63], a[176:179]
ds_read_b128 v[52:55], v3 offset:59392
v_mfma_f32_16x16x32_bf16 a[180:183], v[104:107], v[56:59], a[180:183]
v_mfma_f32_16x16x32_bf16 a[180:183], v[108:111], v[60:63], a[180:183]
v_mfma_f32_16x16x32_bf16 a[184:187], v[112:115], v[56:59], a[184:187]
v_mfma_f32_16x16x32_bf16 a[184:187], v[116:119], v[60:63], a[184:187]
v_mfma_f32_16x16x32_bf16 a[188:191], v[120:123], v[56:59], a[188:191]
v_mfma_f32_16x16x32_bf16 a[188:191], v[124:127], v[60:63], a[188:191]
s_waitcnt lgkmcnt(2)
v_mfma_f32_16x16x32_bf16 a[192:195], v[96:99], v[40:43], a[192:195]
ds_read_b128 v[56:59], v2 offset:61440
v_mfma_f32_16x16x32_bf16 a[192:195], v[100:103], v[44:47], a[192:195]
ds_read_b128 v[60:63], v3 offset:61440
v_mfma_f32_16x16x32_bf16 a[196:199], v[104:107], v[40:43], a[196:199]
v_mfma_f32_16x16x32_bf16 a[196:199], v[108:111], v[44:47], a[196:199]
v_mfma_f32_16x16x32_bf16 a[200:203], v[112:115], v[40:43], a[200:203]
v_mfma_f32_16x16x32_bf16 a[200:203], v[116:119], v[44:47], a[200:203]
v_mfma_f32_16x16x32_bf16 a[204:207], v[120:123], v[40:43], a[204:207]
v_mfma_f32_16x16x32_bf16 a[204:207], v[124:127], v[44:47], a[204:207]
s_waitcnt lgkmcnt(2)
v_mfma_f32_16x16x32_bf16 a[208:211], v[96:99], v[48:51], a[208:211]
ds_read_b128 v[40:43], v2 offset:63488
v_mfma_f32_16x16x32_bf16 a[208:211], v[100:103], v[52:55], a[208:211]
ds_read_b128 v[44:47], v3 offset:63488
v_mfma_f32_16x16x32_bf16 a[212:215], v[104:107], v[48:51], a[212:215]
v_mfma_f32_16x16x32_bf16 a[212:215], v[108:111], v[52:55], a[212:215]
v_mfma_f32_16x16x32_bf16 a[216:219], v[112:115], v[48:51], a[216:219]
v_mfma_f32_16x16x32_bf16 a[216:219], v[116:119], v[52:55], a[216:219]
v_mfma_f32_16x16x32_bf16 a[220:223], v[120:123], v[48:51], a[220:223]
v_mfma_f32_16x16x32_bf16 a[220:223], v[124:127], v[52:55], a[220:223]
s_waitcnt lgkmcnt(2)
v_mfma_f32_16x16x32_bf16 a[224:227], v[96:99], v[56:59], a[224:227]
v_mfma_f32_16x16x32_bf16 a[224:227], v[100:103], v[60:63], a[224:227]
v_mfma_f32_16x16x32_bf16 a[228:231], v[104:107], v[56:59], a[228:231]
v_mfma_f32_16x16x32_bf16 a[228:231], v[108:111], v[60:63], a[228:231]
v_mfma_f32_16x16x32_bf16 a[232:235], v[112:115], v[56:59], a[232:235]
v_mfma_f32_16x16x32_bf16 a[232:235], v[116:119], v[60:63], a[232:235]
v_mfma_f32_16x16x32_bf16 a[236:239], v[120:123], v[56:59], a[236:239]
v_mfma_f32_16x16x32_bf16 a[236:239], v[124:127], v[60:63], a[236:239]
s_waitcnt lgkmcnt(0)
s_barrier
v_xor_b32 v2, 0x10000, v2
v_xor_b32 v3, 0x10000, v3
v_mfma_f32_16x16x32_bf16 a[240:243], v[96:99], v[40:43], a[240:243]
ds_read_b128 v[48:51], v2 offset:0
buffer_load_dwordx4 v[96:99], v1, s[12:15], s33 offen offset:0 sc1
v_mfma_f32_16x16x32_bf16 a[240:243], v[100:103], v[44:47], a[240:243]
ds_read_b128 v[52:55], v3 offset:0
v_mfma_f32_16x16x32_bf16 a[244:247], v[104:107], v[40:43], a[244:247]
ds_read_b128 v[56:59], v2 offset:2048
v_mfma_f32_16x16x32_bf16 a[244:247], v[108:111], v[44:47], a[244:247]
ds_read_b128 v[60:63], v3 offset:2048
buffer_load_dwordx4 v[100:103], v1, s[12:15], s33 offen offset:1024 sc1
v_mfma_f32_16x16x32_bf16 a[248:251], v[112:115], v[40:43], a[248:251]
v_mfma_f32_16x16x32_bf16 a[248:251], v[116:119], v[44:47], a[248:251]
v_mfma_f32_16x16x32_bf16 a[252:255], v[120:123], v[40:43], a[252:255]
buffer_load_dwordx4 v[104:107], v1, s[12:15], s33 offen offset:2048 sc1
v_mfma_f32_16x16x32_bf16 a[252:255], v[124:127], v[44:47], a[252:255]
s_waitcnt vmcnt(9) lgkmcnt(2)
L_cs5:
v_mfma_f32_16x16x32_bf16 a[0:3], v[64:67], v[48:51], a[0:3]
ds_read_b128 v[40:43], v2 offset:4096
v_mfma_f32_16x16x32_bf16 a[0:3], v[68:71], v[52:55], a[0:3]
ds_read_b128 v[44:47], v3 offset:4096
buffer_load_dwordx4 v[108:111], v1, s[12:15], s33 offen offset:3072 sc1
s_waitcnt vmcnt(8)
v_mfma_f32_16x16x32_bf16 a[4:7], v[72:75], v[48:51], a[4:7]
v_cmp_gt_u32 vcc, 6, v12
s_cbranch_vccz L_pok5
s_mov_b32 s4, 0x40000
L_psp5:
s_sleep 2
buffer_load_dword v12, v11, s[24:27], s42 offen sc1
s_sub_u32 s4, s4, 1
s_cbranch_scc1 L_pok5
s_waitcnt vmcnt(0)
v_cmp_gt_u32 vcc, 6, v12
s_cbranch_vccnz L_psp5
L_pok5:
v_mfma_f32_16x16x32_bf16 a[4:7], v[76:79], v[52:55], a[4:7]
s_add_u32 s35, s38, 0x2000000
s_waitcnt vmcnt(6)
v_mfma_f32_16x16x32_bf16 a[8:11], v[80:83], v[48:51], a[8:11]
buffer_load_dwordx4 v[112:115], v1, s[12:15], s34 offen offset:0 sc1
v_mfma_f32_16x16x32_bf16 a[8:11], v[84:87], v[52:55], a[8:11]
s_waitcnt vmcnt(5)
v_mfma_f32_16x16x32_bf16 a[12:15], v[88:91], v[48:51], a[12:15]
v_mfma_f32_16x16x32_bf16 a[12:15], v[92:95], v[52:55], a[12:15]
buffer_load_dwordx4 v[116:119], v1, s[12:15], s34 offen offset:1024 sc1
s_waitcnt lgkmcnt(2)
v_mfma_f32_16x16x32_bf16 a[16:19], v[64:67], v[56:59], a[16:19]
ds_read_b128 v[48:51], v2 offset:6144
v_mfma_f32_16x16x32_bf16 a[16:19], v[68:71], v[60:63], a[16:19]
ds_read_b128 v[52:55], v3 offset:6144
v_mfma_f32_16x16x32_bf16 a[20:23], v[72:75], v[56:59], a[20:23]
buffer_load_dwordx4 v[120:123], v1, s[12:15], s34 offen offset:2048 sc1
v_mfma_f32_16x16x32_bf16 a[20:23], v[76:79], v[60:63], a[20:23]
v_mfma_f32_16x16x32_bf16 a[24:27], v[80:83], v[56:59], a[24:27]
v_mfma_f32_16x16x32_bf16 a[24:27], v[84:87], v[60:63], a[24:27]
buffer_load_dwordx4 v[124:127], v1, s[12:15], s34 offen offset:3072 sc1
s_add_u32 s33, s33, 0x8000
s_add_u32 s34, s34, 0x8000
v_mfma_f32_16x16x32_bf16 a[28:31], v[88:91], v[56:59], a[28:31]
s_add_u32 m0, s3, 0x10000
v_mfma_f32_16x16x32_bf16 a[28:31], v[92:95], v[60:63], a[28:31]
buffer_load_dwordx4 v8, s[20:23], s35 offen sc1 lds
s_add_u32 s35, s35, 0x10000
s_waitcnt lgkmcnt(2)
v_mfma_f32_16x16x32_bf16 a[32:35], v[64:67], v[40:43], a[32:35]
ds_read_b128 v[56:59], v2 offset:8192
v_mfma_f32_16x16x32_bf16 a[32:35], v[68:71], v[44:47], a[32:35]
ds_read_b128 v[60:63], v3 offset:8192
v_mfma_f32_16x16x32_bf16 a[36:39], v[72:75], v[40:43], a[36:39]
v_mfma_f32_16x16x32_bf16 a[36:39], v[76:79], v[44:47], a[36:39]
v_mfma_f32_16x16x32_bf16 a[40:43], v[80:83], v[40:43], a[40:43]
v_mfma_f32_16x16x32_bf16 a[40:43], v[84:87], v[44:47], a[40:43]
v_mfma_f32_16x16x32_bf16 a[44:47], v[88:91], v[40:43], a[44:47]
s_add_u32 m0, s3, 0x11000
v_mfma_f32_16x16x32_bf16 a[44:47], v[92:95], v[44:47], a[44:47]
buffer_load_dwordx4 v8, s[20:23], s35 offen sc1 lds
s_add_u32 s35, s35, 0x10000
s_waitcnt lgkmcnt(2)
v_mfma_f32_16x16x32_bf16 a[48:51], v[64:67], v[48:51], a[48:51]
ds_read_b128 v[40:43], v2 offset:10240
v_mfma_f32_16x16x32_bf16 a[48:51], v[68:71], v[52:55], a[48:51]
ds_read_b128 v[44:47], v3 offset:10240
v_mfma_f32_16x16x32_bf16 a[52:55], v[72:75], v[48:51], a[52:55]
v_mfma_f32_16x16x32_bf16 a[52:55], v[76:79], v[52:55], a[52:55]
v_mfma_f32_16x16x32_bf16 a[56:59], v[80:83], v[48:51], a[56:59]
v_mfma_f32_16x16x32_bf16 a[56:59], v[84:87], v[52:55], a[56:59]
v_mfma_f32_16x16x32_bf16 a[60:63], v[88:91], v[48:51], a[60:63]
s_add_u32 m0, s3, 0x12000
v_mfma_f32_16x16x32_bf16 a[60:63], v[92:95], v[52:55], a[60:63]
buffer_load_dwordx4 v8, s[20:23], s35 offen sc1 lds
s_add_u32 s35, s35, 0x10000
s_waitcnt lgkmcnt(2)
v_mfma_f32_16x16x32_bf16 a[64:67], v[64:67], v[56:59], a[64:67]
ds_read_b128 v[48:51], v2 offset:12288
v_mfma_f32_16x16x32_bf16 a[64:67], v[68:71], v[60:63], a[64:67]
ds_read_b128 v[52:55], v3 offset:12288
v_mfma_f32_16x16x32_bf16 a[68:71], v[72:75], v[56:59], a[68:71]
v_mfma_f32_16x16x32_bf16 a[68:71], v[76:79], v[60:63], a[68:71]
v_mfma_f32_16x16x32_bf16 a[72:75], v[80:83], v[56:59], a[72:75]
v_mfma_f32_16x16x32_bf16 a[72:75], v[84:87], v[60:63], a[72:75]
v_mfma_f32_16x16x32_bf16 a[76:79], v[88:91], v[56:59], a[76:79]
s_add_u32 m0, s3, 0x13000
v_mfma_f32_16x16x32_bf16 a[76:79], v[92:95], v[60:63], a[76:79]
buffer_load_dwordx4 v8, s[20:23], s35 offen sc1 lds
s_sub_u32 s35, s35, 196480
s_waitcnt lgkmcnt(2)
v_mfma_f32_16x16x32_bf16 a[80:83], v[64:67], v[40:43], a[80:83]
ds_read_b128 v[56:59], v2 offset:14336
v_mfma_f32_16x16x32_bf16 a[80:83], v[68:71], v[44:47], a[80:83]
ds_read_b128 v[60:63], v3 offset:14336
v_mfma_f32_16x16x32_bf16 a[84:87], v[72:75], v[40:43], a[84:87]
v_mfma_f32_16x16x32_bf16 a[84:87], v[76:79], v[44:47], a[84:87]
v_mfma_f32_16x16x32_bf16 a[88:91], v[80:83], v[40:43], a[88:91]
v_mfma_f32_16x16x32_bf16 a[88:91], v[84:87], v[44:47], a[88:91]
v_mfma_f32_16x16x32_bf16 a[92:95], v[88:91], v[40:43], a[92:95]
s_add_u32 m0, s3, 0x14000
v_mfma_f32_16x16x32_bf16 a[92:95], v[92:95], v[44:47], a[92:95]
buffer_load_dwordx4 v8, s[20:23], s35 offen sc1 lds
s_add_u32 s35, s35, 0x10000
s_waitcnt lgkmcnt(2)
v_mfma_f32_16x16x32_bf16 a[96:99], v[64:67], v[48:51], a[96:99]
ds_read_b128 v[40:43], v2 offset:16384
v_mfma_f32_16x16x32_bf16 a[96:99], v[68:71], v[52:55], a[96:99]
ds_read_b128 v[44:47], v3 offset:16384
v_mfma_f32_16x16x32_bf16 a[100:103], v[72:75], v[48:51], a[100:103]
v_mfma_f32_16x16x32_bf16 a[100:103], v[76:79], v[52:55], a[100:103]
v_mfma_f32_16x16x32_bf16 a[104:107], v[80:83], v[48:51], a[104:107]
v_mfma_f32_16x16x32_bf16 a[104:107], v[84:87], v[52:55], a[104:107]
v_mfma_f32_16x16x32_bf16 a[108:111], v[88:91], v[48:51], a[108:111]
s_add_u32 m0, s3, 0x15000
v_mfma_f32_16x16x32_bf16 a[108:111], v[92:95], v[52:55], a[108:111]
buffer_load_dwordx4 v8, s[20:23], s35 offen sc1 lds
s_add_u32 s35, s35, 0x10000
s_waitcnt lgkmcnt(2)
v_mfma_f32_16x16x32_bf16 a[112:115], v[64:67], v[56:59], a[112:115]
ds_read_b128 v[48:51], v2 offset:18432
buffer_load_dwordx4 v[64:67], v1, s[12:15], s33 offen offset:0 sc1
v_mfma_f32_16x16x32_bf16 a[112:115], v[68:71], v[60:63], a[112:115]
ds_read_b128 v[52:55], v3 offset:18432
v_mfma_f32_16x16x32_bf16 a[116:119], v[72:75], v[56:59], a[116:119]
v_mfma_f32_16x16x32_bf16 a[116:119], v[76:79], v[60:63], a[116:119]
buffer_load_dwordx4 v[68:71], v1, s[12:15], s33 offen offset:1024 sc1
v_mfma_f32_16x16x32_bf16 a[120:123], v[80:83], v[56:59], a[120:123]
v_mfma_f32_16x16x32_bf16 a[120:123], v[84:87], v[60:63], a[120:123]
v_mfma_f32_16x16x32_bf16 a[124:127], v[88:91], v[56:59], a[124:127]
buffer_load_dwordx4 v[72:75], v1, s[12:15], s33 offen offset:2048 sc1
v_mfma_f32_16x16x32_bf16 a[124:127], v[92:95], v[60:63], a[124:127]
s_waitcnt vmcnt(15) lgkmcnt(2)
v_mfma_f32_16x16x32_bf16 a[0:3], v[96:99], v[40:43], a[0:3]
ds_read_b128 v[56:59], v2 offset:20480
v_mfma_f32_16x16x32_bf16 a[0:3], v[100:103], v[44:47], a[0:3]
ds_read_b128 v[60:63], v3 offset:20480
buffer_load_dwordx4 v[76:79], v1, s[12:15], s33 offen offset:3072 sc1
s_waitcnt vmcnt(14)
v_mfma_f32_16x16x32_bf16 a[4:7], v[104:107], v[40:43], a[4:7]
v_mfma_f32_16x16x32_bf16 a[4:7], v[108:111], v[44:47], a[4:7]
s_waitcnt vmcnt(12)
v_mfma_f32_16x16x32_bf16 a[8:11], v[112:115], v[40:43], a[8:11]
buffer_load_dwordx4 v[80:83], v1, s[12:15], s34 offen offset:0 sc1
v_mfma_f32_16x16x32_bf16 a[8:11], v[116:119], v[44:47], a[8:11]
s_waitcnt vmcnt(11)
v_mfma_f32_16x16x32_bf16 a[12:15], v[120:123], v[40:43], a[12:15]
v_mfma_f32_16x16x32_bf16 a[12:15], v[124:127], v[44:47], a[12:15]
buffer_load_dwordx4 v[84:87], v1, s[12:15], s34 offen offset:1024 sc1
s_waitcnt lgkmcnt(2)
v_mfma_f32_16x16x32_bf16 a[16:19], v[96:99], v[48:51], a[16:19]
ds_read_b128 v[40:43], v2 offset:22528
v_mfma_f32_16x16x32_bf16 a[16:19], v[100:103], v[52:55], a[16:19]
ds_read_b128 v[44:47], v3 offset:22528
v_mfma_f32_16x16x32_bf16 a[20:23], v[104:107], v[48:51], a[20:23]
buffer_load_dwordx4 v[88:91], v1, s[12:15], s34 offen offset:2048 sc1
v_mfma_f32_16x16x32_bf16 a[20:23], v[108:111], v[52:55], a[20:23]
v_mfma_f32_16x16x32_bf16 a[24:27], v[112:115], v[48:51], a[24:27]
v_mfma_f32_16x16x32_bf16 a[24:27], v[116:119], v[52:55], a[24:27]
buffer_load_dwordx4 v[92:95], v1, s[12:15], s34 offen offset:3072 sc1
s_add_u32 s33, s33, 0x8000
s_add_u32 s34, s34, 0x8000
v_mfma_f32_16x16x32_bf16 a[28:31], v[120:123], v[48:51], a[28:31]
s_add_u32 m0, s3, 0x16000
v_mfma_f32_16x16x32_bf16 a[28:31], v[124:127], v[52:55], a[28:31]
buffer_load_dwordx4 v8, s[20:23], s35 offen sc1 lds
s_add_u32 s35, s35, 0x10000
s_waitcnt lgkmcnt(2)
v_mfma_f32_16x16x32_bf16 a[32:35], v[96:99], v[56:59], a[32:35]
ds_read_b128 v[48:51], v2 offset:24576
v_mfma_f32_16x16x32_bf16 a[32:35], v[100:103], v[60:63], a[32:35]
ds_read_b128 v[52:55], v3 offset:24576
v_mfma_f32_16x16x32_bf16 a[36:39], v[104:107], v[56:59], a[36:39]
v_mfma_f32_16x16x32_bf16 a[36:39], v[108:111], v[60:63], a[36:39]
v_mfma_f32_16x16x32_bf16 a[40:43], v[112:115], v[56:59], a[40:43]
v_mfma_f32_16x16x32_bf16 a[40:43], v[116:119], v[60:63], a[40:43]
v_mfma_f32_16x16x32_bf16 a[44:47], v[120:123], v[56:59], a[44:47]
s_add_u32 m0, s3, 0x17000
v_mfma_f32_16x16x32_bf16 a[44:47], v[124:127], v[60:63], a[44:47]
buffer_load_dwordx4 v8, s[20:23], s35 offen sc1 lds
s_sub_u32 s35, s35, 196480
s_waitcnt lgkmcnt(2)
v_mfma_f32_16x16x32_bf16 a[48:51], v[96:99], v[40:43], a[48:51]
ds_read_b128 v[56:59], v2 offset:26624
v_mfma_f32_16x16x32_bf16 a[48:51], v[100:103], v[44:47], a[48:51]
ds_read_b128 v[60:63], v3 offset:26624
v_mfma_f32_16x16x32_bf16 a[52:55], v[104:107], v[40:43], a[52:55]
v_mfma_f32_16x16x32_bf16 a[52:55], v[108:111], v[44:47], a[52:55]
v_mfma_f32_16x16x32_bf16 a[56:59], v[112:115], v[40:43], a[56:59]
v_mfma_f32_16x16x32_bf16 a[56:59], v[116:119], v[44:47], a[56:59]
v_mfma_f32_16x16x32_bf16 a[60:63], v[120:123], v[40:43], a[60:63]
s_add_u32 m0, s3, 0x18000
v_mfma_f32_16x16x32_bf16 a[60:63], v[124:127], v[44:47], a[60:63]
buffer_load_dwordx4 v8, s[20:23], s35 offen sc1 lds
s_add_u32 s35, s35, 0x10000
s_waitcnt lgkmcnt(2)
v_mfma_f32_16x16x32_bf16 a[64:67], v[96:99], v[48:51], a[64:67]
ds_read_b128 v[40:43], v2 offset:28672
v_mfma_f32_16x16x32_bf16 a[64:67], v[100:103], v[52:55], a[64:67]
ds_read_b128 v[44:47], v3 offset:28672
v_mfma_f32_16x16x32_bf16 a[68:71], v[104:107], v[48:51], a[68:71]
v_mfma_f32_16x16x32_bf16 a[68:71], v[108:111], v[52:55], a[68:71]
v_mfma_f32_16x16x32_bf16 a[72:75], v[112:115], v[48:51], a[72:75]
v_mfma_f32_16x16x32_bf16 a[72:75], v[116:119], v[52:55], a[72:75]
v_mfma_f32_16x16x32_bf16 a[76:79], v[120:123], v[48:51], a[76:79]
s_add_u32 m0, s3, 0x19000
v_mfma_f32_16x16x32_bf16 a[76:79], v[124:127], v[52:55], a[76:79]
buffer_load_dwordx4 v8, s[20:23], s35 offen sc1 lds
s_add_u32 s35, s35, 0x10000
s_waitcnt lgkmcnt(2)
v_mfma_f32_16x16x32_bf16 a[80:83], v[96:99], v[56:59], a[80:83]
ds_read_b128 v[48:51], v2 offset:30720
v_mfma_f32_16x16x32_bf16 a[80:83], v[100:103], v[60:63], a[80:83]
ds_read_b128 v[52:55], v3 offset:30720
v_mfma_f32_16x16x32_bf16 a[84:87], v[104:107], v[56:59], a[84:87]
v_mfma_f32_16x16x32_bf16 a[84:87], v[108:111], v[60:63], a[84:87]
v_mfma_f32_16x16x32_bf16 a[88:91], v[112:115], v[56:59], a[88:91]
v_mfma_f32_16x16x32_bf16 a[88:91], v[116:119], v[60:63], a[88:91]
v_mfma_f32_16x16x32_bf16 a[92:95], v[120:123], v[56:59], a[92:95]
s_add_u32 m0, s3, 0x1a000
v_mfma_f32_16x16x32_bf16 a[92:95], v[124:127], v[60:63], a[92:95]
buffer_load_dwordx4 v8, s[20:23], s35 offen sc1 lds
s_add_u32 s35, s35, 0x10000
s_waitcnt lgkmcnt(2)
v_mfma_f32_16x16x32_bf16 a[96:99], v[96:99], v[40:43], a[96:99]
ds_read_b128 v[56:59], v2 offset:32768
v_mfma_f32_16x16x32_bf16 a[96:99], v[100:103], v[44:47], a[96:99]
ds_read_b128 v[60:63], v3 offset:32768
v_mfma_f32_16x16x32_bf16 a[100:103], v[104:107], v[40:43], a[100:103]
v_mfma_f32_16x16x32_bf16 a[100:103], v[108:111], v[44:47], a[100:103]
v_mfma_f32_16x16x32_bf16 a[104:107], v[112:115], v[40:43], a[104:107]
v_mfma_f32_16x16x32_bf16 a[104:107], v[116:119], v[44:47], a[104:107]
v_mfma_f32_16x16x32_bf16 a[108:111], v[120:123], v[40:43], a[108:111]
s_add_u32 m0, s3, 0x1b000
v_mfma_f32_16x16x32_bf16 a[108:111], v[124:127], v[44:47], a[108:111]
buffer_load_dwordx4 v8, s[20:23], s35 offen sc1 lds
s_sub_u32 s35, s35, 196480
s_waitcnt lgkmcnt(2)
v_mfma_f32_16x16x32_bf16 a[112:115], v[96:99], v[48:51], a[112:115]
ds_read_b128 v[40:43], v2 offset:34816
buffer_load_dwordx4 v[96:99], v1, s[12:15], s33 offen offset:0 sc1
v_mfma_f32_16x16x32_bf16 a[112:115], v[100:103], v[52:55], a[112:115]
ds_read_b128 v[44:47], v3 offset:34816
v_mfma_f32_16x16x32_bf16 a[116:119], v[104:107], v[48:51], a[116:119]
v_mfma_f32_16x16x32_bf16 a[116:119], v[108:111], v[52:55], a[116:119]
buffer_load_dwordx4 v[100:103], v1, s[12:15], s33 offen offset:1024 sc1
v_mfma_f32_16x16x32_bf16 a[120:123], v[112:115], v[48:51], a[120:123]
v_mfma_f32_16x16x32_bf16 a[120:123], v[116:119], v[52:55], a[120:123]
v_mfma_f32_16x16x32_bf16 a[124:127], v[120:123], v[48:51], a[124:127]
buffer_load_dwordx4 v[104:107], v1, s[12:15], s33 offen offset:2048 sc1
v_mfma_f32_16x16x32_bf16 a[124:127], v[124:127], v[52:55], a[124:127]
s_waitcnt vmcnt(15) lgkmcnt(2)
v_mfma_f32_16x16x32_bf16 a[0:3], v[64:67], v[56:59], a[0:3]
ds_read_b128 v[48:51], v2 offset:36864
v_mfma_f32_16x16x32_bf16 a[0:3], v[68:71], v[60:63], a[0:3]
ds_read_b128 v[52:55], v3 offset:36864
buffer_load_dwordx4 v[108:111], v1, s[12:15], s33 offen offset:3072 sc1
s_waitcnt vmcnt(14)
v_mfma_f32_16x16x32_bf16 a[4:7], v[72:75], v[56:59], a[4:7]
v_mfma_f32_16x16x32_bf16 a[4:7], v[76:79], v[60:63], a[4:7]
s_waitcnt vmcnt(12)
v_mfma_f32_16x16x32_bf16 a[8:11], v[80:83], v[56:59], a[8:11]
buffer_load_dwordx4 v[112:115], v1, s[12:15], s34 offen offset:0 sc1
v_mfma_f32_16x16x32_bf16 a[8:11], v[84:87], v[60:63], a[8:11]
s_waitcnt vmcnt(11)
v_mfma_f32_16x16x32_bf16 a[12:15], v[88:91], v[56:59], a[12:15]
v_mfma_f32_16x16x32_bf16 a[12:15], v[92:95], v[60:63], a[12:15]
buffer_load_dwordx4 v[116:119], v1, s[12:15], s34 offen offset:1024 sc1
s_waitcnt lgkmcnt(2)
v_mfma_f32_16x16x32_bf16 a[16:19], v[64:67], v[40:43], a[16:19]
ds_read_b128 v[56:59], v2 offset:38912
v_mfma_f32_16x16x32_bf16 a[16:19], v[68:71], v[44:47], a[16:19]
ds_read_b128 v[60:63], v3 offset:38912
v_mfma_f32_16x16x32_bf16 a[20:23], v[72:75], v[40:43], a[20:23]
buffer_load_dwordx4 v[120:123], v1, s[12:15], s34 offen offset:2048 sc1
v_mfma_f32_16x16x32_bf16 a[20:23], v[76:79], v[44:47], a[20:23]
v_mfma_f32_16x16x32_bf16 a[24:27], v[80:83], v[40:43], a[24:27]
v_mfma_f32_16x16x32_bf16 a[24:27], v[84:87], v[44:47], a[24:27]
buffer_load_dwordx4 v[124:127], v1, s[12:15], s34 offen offset:3072 sc1
s_add_u32 s33, s33, 0x28000
s_add_u32 s34, s34, 0x28000
v_mfma_f32_16x16x32_bf16 a[28:31], v[88:91], v[40:43], a[28:31]
s_add_u32 m0, s3, 0x1c000
v_mfma_f32_16x16x32_bf16 a[28:31], v[92:95], v[44:47], a[28:31]
buffer_load_dwordx4 v8, s[20:23], s35 offen sc1 lds
s_add_u32 s35, s35, 0x10000
s_waitcnt lgkmcnt(2)
v_mfma_f32_16x16x32_bf16 a[32:35], v[64:67], v[48:51], a[32:35]
ds_read_b128 v[40:43], v2 offset:40960
v_mfma_f32_16x16x32_bf16 a[32:35], v[68:71], v[52:55], a[32:35]
ds_read_b128 v[44:47], v3 offset:40960
v_mfma_f32_16x16x32_bf16 a[36:39], v[72:75], v[48:51], a[36:39]
v_mfma_f32_16x16x32_bf16 a[36:39], v[76:79], v[52:55], a[36:39]
v_mfma_f32_16x16x32_bf16 a[40:43], v[80:83], v[48:51], a[40:43]
v_mfma_f32_16x16x32_bf16 a[40:43], v[84:87], v[52:55], a[40:43]
v_mfma_f32_16x16x32_bf16 a[44:47], v[88:91], v[48:51], a[44:47]
s_add_u32 m0, s3, 0x1d000
v_mfma_f32_16x16x32_bf16 a[44:47], v[92:95], v[52:55], a[44:47]
buffer_load_dwordx4 v8, s[20:23], s35 offen sc1 lds
s_add_u32 s35, s35, 0x10000
s_waitcnt lgkmcnt(2)
v_mfma_f32_16x16x32_bf16 a[48:51], v[64:67], v[56:59], a[48:51]
ds_read_b128 v[48:51], v2 offset:43008
v_mfma_f32_16x16x32_bf16 a[48:51], v[68:71], v[60:63], a[48:51]
ds_read_b128 v[52:55], v3 offset:43008
v_mfma_f32_16x16x32_bf16 a[52:55], v[72:75], v[56:59], a[52:55]
v_mfma_f32_16x16x32_bf16 a[52:55], v[76:79], v[60:63], a[52:55]
v_mfma_f32_16x16x32_bf16 a[56:59], v[80:83], v[56:59], a[56:59]
v_mfma_f32_16x16x32_bf16 a[56:59], v[84:87], v[60:63], a[56:59]
v_mfma_f32_16x16x32_bf16 a[60:63], v[88:91], v[56:59], a[60:63]
s_add_u32 m0, s3, 0x1e000
v_mfma_f32_16x16x32_bf16 a[60:63], v[92:95], v[60:63], a[60:63]
buffer_load_dwordx4 v8, s[20:23], s35 offen sc1 lds
s_add_u32 s35, s35, 0x10000
s_waitcnt lgkmcnt(2)
v_mfma_f32_16x16x32_bf16 a[64:67], v[64:67], v[40:43], a[64:67]
ds_read_b128 v[56:59], v2 offset:45056
v_mfma_f32_16x16x32_bf16 a[64:67], v[68:71], v[44:47], a[64:67]
ds_read_b128 v[60:63], v3 offset:45056
v_mfma_f32_16x16x32_bf16 a[68:71], v[72:75], v[40:43], a[68:71]
v_mfma_f32_16x16x32_bf16 a[68:71], v[76:79], v[44:47], a[68:71]
v_mfma_f32_16x16x32_bf16 a[72:75], v[80:83], v[40:43], a[72:75]
v_mfma_f32_16x16x32_bf16 a[72:75], v[84:87], v[44:47], a[72:75]
v_mfma_f32_16x16x32_bf16 a[76:79], v[88:91], v[40:43], a[76:79]
s_add_u32 m0, s3, 0x1f000
v_mfma_f32_16x16x32_bf16 a[76:79], v[92:95], v[44:47], a[76:79]
buffer_load_dwordx4 v8, s[20:23], s35 offen sc1 lds
v_xor_b32 v8, 0x200, v8
s_waitcnt lgkmcnt(2)
v_mfma_f32_16x16x32_bf16 a[80:83], v[64:67], v[48:51], a[80:83]
ds_read_b128 v[40:43], v2 offset:47104
v_mfma_f32_16x16x32_bf16 a[80:83], v[68:71], v[52:55], a[80:83]
ds_read_b128 v[44:47], v3 offset:47104
v_mfma_f32_16x16x32_bf16 a[84:87], v[72:75], v[48:51], a[84:87]
v_mfma_f32_16x16x32_bf16 a[84:87], v[76:79], v[52:55], a[84:87]
v_mfma_f32_16x16x32_bf16 a[88:91], v[80:83], v[48:51], a[88:91]
v_mfma_f32_16x16x32_bf16 a[88:91], v[84:87], v[52:55], a[88:91]
v_mfma_f32_16x16x32_bf16 a[92:95], v[88:91], v[48:51], a[92:95]
v_mfma_f32_16x16x32_bf16 a[92:95], v[92:95], v[52:55], a[92:95]
s_waitcnt lgkmcnt(2)
v_mfma_f32_16x16x32_bf16 a[96:99], v[64:67], v[56:59], a[96:99]
ds_read_b128 v[48:51], v2 offset:49152
v_mfma_f32_16x16x32_bf16 a[96:99], v[68:71], v[60:63], a[96:99]
ds_read_b128 v[52:55], v3 offset:49152
v_mfma_f32_16x16x32_bf16 a[100:103], v[72:75], v[56:59], a[100:103]
v_mfma_f32_16x16x32_bf16 a[100:103], v[76:79], v[60:63], a[100:103]
v_mfma_f32_16x16x32_bf16 a[104:107], v[80:83], v[56:59], a[104:107]
v_mfma_f32_16x16x32_bf16 a[104:107], v[84:87], v[60:63], a[104:107]
v_mfma_f32_16x16x32_bf16 a[108:111], v[88:91], v[56:59], a[108:111]
v_mfma_f32_16x16x32_bf16 a[108:111], v[92:95], v[60:63], a[108:111]
s_waitcnt lgkmcnt(2)
v_mfma_f32_16x16x32_bf16 a[112:115], v[64:67], v[40:43], a[112:115]
ds_read_b128 v[56:59], v2 offset:51200
buffer_load_dwordx4 v[64:67], v1, s[12:15], s33 offen offset:0 sc1
v_mfma_f32_16x16x32_bf16 a[112:115], v[68:71], v[44:47], a[112:115]
ds_read_b128 v[60:63], v3 offset:51200
v_mfma_f32_16x16x32_bf16 a[116:119], v[72:75], v[40:43], a[116:119]
v_mfma_f32_16x16x32_bf16 a[116:119], v[76:79], v[44:47], a[116:119]
buffer_load_dwordx4 v[68:71], v1, s[12:15], s33 offen offset:1024 sc1
v_mfma_f32_16x16x32_bf16 a[120:123], v[80:83], v[40:43], a[120:123]
v_mfma_f32_16x16x32_bf16 a[120:123], v[84:87], v[44:47], a[120:123]
v_mfma_f32_16x16x32_bf16 a[124:127], v[88:91], v[40:43], a[124:127]
buffer_load_dwordx4 v[72:75], v1, s[12:15], s33 offen offset:2048 sc1
v_mfma_f32_16x16x32_bf16 a[124:127], v[92:95], v[44:47], a[124:127]
s_waitcnt vmcnt(13) lgkmcnt(2)
v_mfma_f32_16x16x32_bf16 a[0:3], v[96:99], v[48:51], a[0:3]
ds_read_b128 v[40:43], v2 offset:53248
v_mfma_f32_16x16x32_bf16 a[0:3], v[100:103], v[52:55], a[0:3]
ds_read_b128 v[44:47], v3 offset:53248
buffer_load_dwordx4 v[76:79], v1, s[12:15], s33 offen offset:3072 sc1
s_waitcnt vmcnt(12)
v_mfma_f32_16x16x32_bf16 a[4:7], v[104:107], v[48:51], a[4:7]
v_mfma_f32_16x16x32_bf16 a[4:7], v[108:111], v[52:55], a[4:7]
s_waitcnt vmcnt(10)
v_mfma_f32_16x16x32_bf16 a[8:11], v[112:115], v[48:51], a[8:11]
buffer_load_dwordx4 v[80:83], v1, s[12:15], s34 offen offset:0 sc1
v_mfma_f32_16x16x32_bf16 a[8:11], v[116:119], v[52:55], a[8:11]
s_waitcnt vmcnt(9)
v_mfma_f32_16x16x32_bf16 a[12:15], v[120:123], v[48:51], a[12:15]
v_mfma_f32_16x16x32_bf16 a[12:15], v[124:127], v[52:55], a[12:15]
buffer_load_dwordx4 v[84:87], v1, s[12:15], s34 offen offset:1024 sc1
s_waitcnt lgkmcnt(2)
v_mfma_f32_16x16x32_bf16 a[16:19], v[96:99], v[56:59], a[16:19]
ds_read_b128 v[48:51], v2 offset:55296
v_mfma_f32_16x16x32_bf16 a[16:19], v[100:103], v[60:63], a[16:19]
ds_read_b128 v[52:55], v3 offset:55296
v_mfma_f32_16x16x32_bf16 a[20:23], v[104:107], v[56:59], a[20:23]
buffer_load_dwordx4 v[88:91], v1, s[12:15], s34 offen offset:2048 sc1
v_mfma_f32_16x16x32_bf16 a[20:23], v[108:111], v[60:63], a[20:23]
v_mfma_f32_16x16x32_bf16 a[24:27], v[112:115], v[56:59], a[24:27]
v_mfma_f32_16x16x32_bf16 a[24:27], v[116:119], v[60:63], a[24:27]
buffer_load_dwordx4 v[92:95], v1, s[12:15], s34 offen offset:3072 sc1
s_add_u32 s33, s33, 0x8000
s_add_u32 s34, s34, 0x8000
v_mfma_f32_16x16x32_bf16 a[28:31], v[120:123], v[56:59], a[28:31]
v_mfma_f32_16x16x32_bf16 a[28:31], v[124:127], v[60:63], a[28:31]
s_waitcnt lgkmcnt(2)
v_mfma_f32_16x16x32_bf16 a[32:35], v[96:99], v[40:43], a[32:35]
ds_read_b128 v[56:59], v2 offset:57344
v_mfma_f32_16x16x32_bf16 a[32:35], v[100:103], v[44:47], a[32:35]
ds_read_b128 v[60:63], v3 offset:57344
v_mfma_f32_16x16x32_bf16 a[36:39], v[104:107], v[40:43], a[36:39]
v_mfma_f32_16x16x32_bf16 a[36:39], v[108:111], v[44:47], a[36:39]
v_mfma_f32_16x16x32_bf16 a[40:43], v[112:115], v[40:43], a[40:43]
v_mfma_f32_16x16x32_bf16 a[40:43], v[116:119], v[44:47], a[40:43]
v_mfma_f32_16x16x32_bf16 a[44:47], v[120:123], v[40:43], a[44:47]
v_mfma_f32_16x16x32_bf16 a[44:47], v[124:127], v[44:47], a[44:47]
s_waitcnt lgkmcnt(2)
v_mfma_f32_16x16x32_bf16 a[48:51], v[96:99], v[48:51], a[48:51]
ds_read_b128 v[40:43], v2 offset:59392
v_mfma_f32_16x16x32_bf16 a[48:51], v[100:103], v[52:55], a[48:51]
ds_read_b128 v[44:47], v3 offset:59392
v_mfma_f32_16x16x32_bf16 a[52:55], v[104:107], v[48:51], a[52:55]
v_mfma_f32_16x16x32_bf16 a[52:55], v[108:111], v[52:55], a[52:55]
v_mfma_f32_16x16x32_bf16 a[56:59], v[112:115], v[48:51], a[56:59]
v_mfma_f32_16x16x32_bf16 a[56:59], v[116:119], v[52:55], a[56:59]
v_mfma_f32_16x16x32_bf16 a[60:63], v[120:123], v[48:51], a[60:63]
v_mfma_f32_16x16x32_bf16 a[60:63], v[124:127], v[52:55], a[60:63]
s_waitcnt lgkmcnt(2)
v_mfma_f32_16x16x32_bf16 a[64:67], v[96:99], v[56:59], a[64:67]
ds_read_b128 v[48:51], v2 offset:61440
v_mfma_f32_16x16x32_bf16 a[64:67], v[100:103], v[60:63], a[64:67]
ds_read_b128 v[52:55], v3 offset:61440
v_mfma_f32_16x16x32_bf16 a[68:71], v[104:107], v[56:59], a[68:71]
v_mfma_f32_16x16x32_bf16 a[68:71], v[108:111], v[60:63], a[68:71]
v_mfma_f32_16x16x32_bf16 a[72:75], v[112:115], v[56:59], a[72:75]
v_mfma_f32_16x16x32_bf16 a[72:75], v[116:119], v[60:63], a[72:75]
v_mfma_f32_16x16x32_bf16 a[76:79], v[120:123], v[56:59], a[76:79]
v_mfma_f32_16x16x32_bf16 a[76:79], v[124:127], v[60:63], a[76:79]
s_waitcnt lgkmcnt(2)
v_mfma_f32_16x16x32_bf16 a[80:83], v[96:99], v[40:43], a[80:83]
ds_read_b128 v[56:59], v2 offset:63488
v_mfma_f32_16x16x32_bf16 a[80:83], v[100:103], v[44:47], a[80:83]
ds_read_b128 v[60:63], v3 offset:63488
v_mfma_f32_16x16x32_bf16 a[84:87], v[104:107], v[40:43], a[84:87]
v_mfma_f32_16x16x32_bf16 a[84:87], v[108:111], v[44:47], a[84:87]
v_mfma_f32_16x16x32_bf16 a[88:91], v[112:115], v[40:43], a[88:91]
v_mfma_f32_16x16x32_bf16 a[88:91], v[116:119], v[44:47], a[88:91]
v_mfma_f32_16x16x32_bf16 a[92:95], v[120:123], v[40:43], a[92:95]
v_mfma_f32_16x16x32_bf16 a[92:95], v[124:127], v[44:47], a[92:95]
s_waitcnt lgkmcnt(2)
v_mfma_f32_16x16x32_bf16 a[96:99], v[96:99], v[48:51], a[96:99]
v_mfma_f32_16x16x32_bf16 a[96:99], v[100:103], v[52:55], a[96:99]
v_mfma_f32_16x16x32_bf16 a[100:103], v[104:107], v[48:51], a[100:103]
v_mfma_f32_16x16x32_bf16 a[100:103], v[108:111], v[52:55], a[100:103]
v_mfma_f32_16x16x32_bf16 a[104:107], v[112:115], v[48:51], a[104:107]
v_mfma_f32_16x16x32_bf16 a[104:107], v[116:119], v[52:55], a[104:107]
v_mfma_f32_16x16x32_bf16 a[108:111], v[120:123], v[48:51], a[108:111]
v_mfma_f32_16x16x32_bf16 a[108:111], v[124:127], v[52:55], a[108:111]
s_waitcnt lgkmcnt(0)
s_waitcnt vmcnt(8)
s_barrier
v_xor_b32 v2, 0x10000, v2
v_xor_b32 v3, 0x10000, v3
v_mfma_f32_16x16x32_bf16 a[112:115], v[96:99], v[56:59], a[112:115]
ds_read_b128 v[40:43], v2 offset:0
buffer_load_dwordx4 v[96:99], v1, s[12:15], s33 offen offset:0 sc1
v_mfma_f32_16x16x32_bf16 a[112:115], v[100:103], v[60:63], a[112:115]
ds_read_b128 v[44:47], v3 offset:0
v_mfma_f32_16x16x32_bf16 a[116:119], v[104:107], v[56:59], a[116:119]
ds_read_b128 v[48:51], v2 offset:2048
v_mfma_f32_16x16x32_bf16 a[116:119], v[108:111], v[60:63], a[116:119]
ds_read_b128 v[52:55], v3 offset:2048
buffer_load_dwordx4 v[100:103], v1, s[12:15], s33 offen offset:1024 sc1
v_mfma_f32_16x16x32_bf16 a[120:123], v[112:115], v[56:59], a[120:123]
v_mfma_f32_16x16x32_bf16 a[120:123], v[116:119], v[60:63], a[120:123]
v_mfma_f32_16x16x32_bf16 a[124:127], v[120:123], v[56:59], a[124:127]
buffer_load_dwordx4 v[104:107], v1, s[12:15], s33 offen offset:2048 sc1
v_mfma_f32_16x16x32_bf16 a[124:127], v[124:127], v[60:63], a[124:127]
s_waitcnt vmcnt(9) lgkmcnt(2)
v_mfma_f32_16x16x32_bf16 a[0:3], v[64:67], v[40:43], a[0:3]
ds_read_b128 v[56:59], v2 offset:4096
v_mfma_f32_16x16x32_bf16 a[0:3], v[68:71], v[44:47], a[0:3]
ds_read_b128 v[60:63], v3 offset:4096
buffer_load_dwordx4 v[108:111], v1, s[12:15], s33 offen offset:3072 sc1
s_waitcnt vmcnt(8)
v_mfma_f32_16x16x32_bf16 a[4:7], v[72:75], v[40:43], a[4:7]
v_mfma_f32_16x16x32_bf16 a[4:7], v[76:79], v[44:47], a[4:7]
s_waitcnt vmcnt(6)
v_mfma_f32_16x16x32_bf16 a[8:11], v[80:83], v[40:43], a[8:11]
buffer_load_dwordx4 v[112:115], v1, s[12:15], s34 offen offset:0 sc1
v_mfma_f32_16x16x32_bf16 a[8:11], v[84:87], v[44:47], a[8:11]
s_waitcnt vmcnt(5)
v_mfma_f32_16x16x32_bf16 a[12:15], v[88:91], v[40:43], a[12:15]
v_mfma_f32_16x16x32_bf16 a[12:15], v[92:95], v[44:47], a[12:15]
buffer_load_dwordx4 v[116:119], v1, s[12:15], s34 offen offset:1024 sc1
s_waitcnt lgkmcnt(2)
v_mfma_f32_16x16x32_bf16 a[16:19], v[64:67], v[48:51], a[16:19]
ds_read_b128 v[40:43], v2 offset:6144
v_mfma_f32_16x16x32_bf16 a[16:19], v[68:71], v[52:55], a[16:19]
ds_read_b128 v[44:47], v3 offset:6144
v_mfma_f32_16x16x32_bf16 a[20:23], v[72:75], v[48:51], a[20:23]
buffer_load_dwordx4 v[120:123], v1, s[12:15], s34 offen offset:2048 sc1
v_mfma_f32_16x16x32_bf16 a[20:23], v[76:79], v[52:55], a[20:23]
v_mfma_f32_16x16x32_bf16 a[24:27], v[80:83], v[48:51], a[24:27]
v_mfma_f32_16x16x32_bf16 a[24:27], v[84:87], v[52:55], a[24:27]
buffer_load_dwordx4 v[124:127], v1, s[12:15], s34 offen offset:3072 sc1
s_add_u32 s33, s33, 0x8000
s_add_u32 s34, s34, 0x8000
v_mfma_f32_16x16x32_bf16 a[28:31], v[88:91], v[48:51], a[28:31]
v_mfma_f32_16x16x32_bf16 a[28:31], v[92:95], v[52:55], a[28:31]
s_waitcnt lgkmcnt(2)
v_mfma_f32_16x16x32_bf16 a[32:35], v[64:67], v[56:59], a[32:35]
ds_read_b128 v[48:51], v2 offset:8192
v_mfma_f32_16x16x32_bf16 a[32:35], v[68:71], v[60:63], a[32:35]
ds_read_b128 v[52:55], v3 offset:8192
v_mfma_f32_16x16x32_bf16 a[36:39], v[72:75], v[56:59], a[36:39]
v_mfma_f32_16x16x32_bf16 a[36:39], v[76:79], v[60:63], a[36:39]
v_mfma_f32_16x16x32_bf16 a[40:43], v[80:83], v[56:59], a[40:43]
v_mfma_f32_16x16x32_bf16 a[40:43], v[84:87], v[60:63], a[40:43]
v_mfma_f32_16x16x32_bf16 a[44:47], v[88:91], v[56:59], a[44:47]
v_mfma_f32_16x16x32_bf16 a[44:47], v[92:95], v[60:63], a[44:47]
s_waitcnt lgkmcnt(2)
v_mfma_f32_16x16x32_bf16 a[48:51], v[64:67], v[40:43], a[48:51]
ds_read_b128 v[56:59], v2 offset:10240
v_mfma_f32_16x16x32_bf16 a[48:51], v[68:71], v[44:47], a[48:51]
ds_read_b128 v[60:63], v3 offset:10240
v_mfma_f32_16x16x32_bf16 a[52:55], v[72:75], v[40:43], a[52:55]
v_mfma_f32_16x16x32_bf16 a[52:55], v[76:79], v[44:47], a[52:55]
v_mfma_f32_16x16x32_bf16 a[56:59], v[80:83], v[40:43], a[56:59]
v_mfma_f32_16x16x32_bf16 a[56:59], v[84:87], v[44:47], a[56:59]
v_mfma_f32_16x16x32_bf16 a[60:63], v[88:91], v[40:43], a[60:63]
v_mfma_f32_16x16x32_bf16 a[60:63], v[92:95], v[44:47], a[60:63]
s_waitcnt lgkmcnt(2)
v_mfma_f32_16x16x32_bf16 a[64:67], v[64:67], v[48:51], a[64:67]
ds_read_b128 v[40:43], v2 offset:12288
v_mfma_f32_16x16x32_bf16 a[64:67], v[68:71], v[52:55], a[64:67]
ds_read_b128 v[44:47], v3 offset:12288
v_mfma_f32_16x16x32_bf16 a[68:71], v[72:75], v[48:51], a[68:71]
v_mfma_f32_16x16x32_bf16 a[68:71], v[76:79], v[52:55], a[68:71]
v_mfma_f32_16x16x32_bf16 a[72:75], v[80:83], v[48:51], a[72:75]
v_mfma_f32_16x16x32_bf16 a[72:75], v[84:87], v[52:55], a[72:75]
v_mfma_f32_16x16x32_bf16 a[76:79], v[88:91], v[48:51], a[76:79]
v_mfma_f32_16x16x32_bf16 a[76:79], v[92:95], v[52:55], a[76:79]
s_waitcnt lgkmcnt(2)
v_mfma_f32_16x16x32_bf16 a[80:83], v[64:67], v[56:59], a[80:83]
ds_read_b128 v[48:51], v2 offset:14336
v_mfma_f32_16x16x32_bf16 a[80:83], v[68:71], v[60:63], a[80:83]
ds_read_b128 v[52:55], v3 offset:14336
v_mfma_f32_16x16x32_bf16 a[84:87], v[72:75], v[56:59], a[84:87]
v_mfma_f32_16x16x32_bf16 a[84:87], v[76:79], v[60:63], a[84:87]
v_mfma_f32_16x16x32_bf16 a[88:91], v[80:83], v[56:59], a[88:91]
v_mfma_f32_16x16x32_bf16 a[88:91], v[84:87], v[60:63], a[88:91]
v_mfma_f32_16x16x32_bf16 a[92:95], v[88:91], v[56:59], a[92:95]
v_mfma_f32_16x16x32_bf16 a[92:95], v[92:95], v[60:63], a[92:95]
s_waitcnt lgkmcnt(2)
v_mfma_f32_16x16x32_bf16 a[96:99], v[64:67], v[40:43], a[96:99]
ds_read_b128 v[56:59], v2 offset:16384
v_mfma_f32_16x16x32_bf16 a[96:99], v[68:71], v[44:47], a[96:99]
ds_read_b128 v[60:63], v3 offset:16384
v_mfma_f32_16x16x32_bf16 a[100:103], v[72:75], v[40:43], a[100:103]
v_mfma_f32_16x16x32_bf16 a[100:103], v[76:79], v[44:47], a[100:103]
v_mfma_f32_16x16x32_bf16 a[104:107], v[80:83], v[40:43], a[104:107]
v_mfma_f32_16x16x32_bf16 a[104:107], v[84:87], v[44:47], a[104:107]
v_mfma_f32_16x16x32_bf16 a[108:111], v[88:91], v[40:43], a[108:111]
v_mfma_f32_16x16x32_bf16 a[108:111], v[92:95], v[44:47], a[108:111]
s_waitcnt lgkmcnt(2)
v_mfma_f32_16x16x32_bf16 a[112:115], v[64:67], v[48:51], a[112:115]
ds_read_b128 v[40:43], v2 offset:18432
buffer_load_dwordx4 v[64:67], v1, s[12:15], s33 offen offset:0 sc1
v_mfma_f32_16x16x32_bf16 a[112:115], v[68:71], v[52:55], a[112:115]
ds_read_b128 v[44:47], v3 offset:18432
v_mfma_f32_16x16x32_bf16 a[116:119], v[72:75], v[48:51], a[116:119]
v_mfma_f32_16x16x32_bf16 a[116:119], v[76:79], v[52:55], a[116:119]
buffer_load_dwordx4 v[68:71], v1, s[12:15], s33 offen offset:1024 sc1
v_mfma_f32_16x16x32_bf16 a[120:123], v[80:83], v[48:51], a[120:123]
v_mfma_f32_16x16x32_bf16 a[120:123], v[84:87], v[52:55], a[120:123]
v_mfma_f32_16x16x32_bf16 a[124:127], v[88:91], v[48:51], a[124:127]
buffer_load_dwordx4 v[72:75], v1, s[12:15], s33 offen offset:2048 sc1
v_mfma_f32_16x16x32_bf16 a[124:127], v[92:95], v[52:55], a[124:127]
s_waitcnt vmcnt(9) lgkmcnt(2)
v_mfma_f32_16x16x32_bf16 a[0:3], v[96:99], v[56:59], a[0:3]
ds_read_b128 v[48:51], v2 offset:20480
v_mfma_f32_16x16x32_bf16 a[0:3], v[100:103], v[60:63], a[0:3]
ds_read_b128 v[52:55], v3 offset:20480
buffer_load_dwordx4 v[76:79], v1, s[12:15], s33 offen offset:3072 sc1
s_waitcnt vmcnt(8)
v_mfma_f32_16x16x32_bf16 a[4:7], v[104:107], v[56:59], a[4:7]
v_mfma_f32_16x16x32_bf16 a[4:7], v[108:111], v[60:63], a[4:7]
s_waitcnt vmcnt(6)
v_mfma_f32_16x16x32_bf16 a[8:11], v[112:115], v[56:59], a[8:11]
buffer_load_dwordx4 v[80:83], v1, s[12:15], s34 offen offset:0 sc1
v_mfma_f32_16x16x32_bf16 a[8:11], v[116:119], v[60:63], a[8:11]
s_waitcnt vmcnt(5)
v_mfma_f32_16x16x32_bf16 a[12:15], v[120:123], v[56:59], a[12:15]
v_mfma_f32_16x16x32_bf16 a[12:15], v[124:127], v[60:63], a[12:15]
buffer_load_dwordx4 v[84:87], v1, s[12:15], s34 offen offset:1024 sc1
s_waitcnt lgkmcnt(2)
v_mfma_f32_16x16x32_bf16 a[16:19], v[96:99], v[40:43], a[16:19]
ds_read_b128 v[56:59], v2 offset:22528
v_mfma_f32_16x16x32_bf16 a[16:19], v[100:103], v[44:47], a[16:19]
ds_read_b128 v[60:63], v3 offset:22528
v_mfma_f32_16x16x32_bf16 a[20:23], v[104:107], v[40:43], a[20:23]
buffer_load_dwordx4 v[88:91], v1, s[12:15], s34 offen offset:2048 sc1
v_mfma_f32_16x16x32_bf16 a[20:23], v[108:111], v[44:47], a[20:23]
v_mfma_f32_16x16x32_bf16 a[24:27], v[112:115], v[40:43], a[24:27]
v_mfma_f32_16x16x32_bf16 a[24:27], v[116:119], v[44:47], a[24:27]
buffer_load_dwordx4 v[92:95], v1, s[12:15], s34 offen offset:3072 sc1
s_add_u32 s33, s33, 0x8000
s_add_u32 s34, s34, 0x8000
v_mfma_f32_16x16x32_bf16 a[28:31], v[120:123], v[40:43], a[28:31]
v_mfma_f32_16x16x32_bf16 a[28:31], v[124:127], v[44:47], a[28:31]
s_waitcnt lgkmcnt(2)
v_mfma_f32_16x16x32_bf16 a[32:35], v[96:99], v[48:51], a[32:35]
ds_read_b128 v[40:43], v2 offset:24576
v_mfma_f32_16x16x32_bf16 a[32:35], v[100:103], v[52:55], a[32:35]
ds_read_b128 v[44:47], v3 offset:24576
v_mfma_f32_16x16x32_bf16 a[36:39], v[104:107], v[48:51], a[36:39]
v_mfma_f32_16x16x32_bf16 a[36:39], v[108:111], v[52:55], a[36:39]
v_mfma_f32_16x16x32_bf16 a[40:43], v[112:115], v[48:51], a[40:43]
v_mfma_f32_16x16x32_bf16 a[40:43], v[116:119], v[52:55], a[40:43]
v_mfma_f32_16x16x32_bf16 a[44:47], v[120:123], v[48:51], a[44:47]
v_mfma_f32_16x16x32_bf16 a[44:47], v[124:127], v[52:55], a[44:47]
s_waitcnt lgkmcnt(2)
v_mfma_f32_16x16x32_bf16 a[48:51], v[96:99], v[56:59], a[48:51]
ds_read_b128 v[48:51], v2 offset:26624
v_mfma_f32_16x16x32_bf16 a[48:51], v[100:103], v[60:63], a[48:51]
ds_read_b128 v[52:55], v3 offset:26624
v_mfma_f32_16x16x32_bf16 a[52:55], v[104:107], v[56:59], a[52:55]
v_mfma_f32_16x16x32_bf16 a[52:55], v[108:111], v[60:63], a[52:55]
v_mfma_f32_16x16x32_bf16 a[56:59], v[112:115], v[56:59], a[56:59]
v_mfma_f32_16x16x32_bf16 a[56:59], v[116:119], v[60:63], a[56:59]
v_mfma_f32_16x16x32_bf16 a[60:63], v[120:123], v[56:59], a[60:63]
v_mfma_f32_16x16x32_bf16 a[60:63], v[124:127], v[60:63], a[60:63]
s_waitcnt lgkmcnt(2)
v_mfma_f32_16x16x32_bf16 a[64:67], v[96:99], v[40:43], a[64:67]
ds_read_b128 v[56:59], v2 offset:28672
v_mfma_f32_16x16x32_bf16 a[64:67], v[100:103], v[44:47], a[64:67]
ds_read_b128 v[60:63], v3 offset:28672
v_mfma_f32_16x16x32_bf16 a[68:71], v[104:107], v[40:43], a[68:71]
v_mfma_f32_16x16x32_bf16 a[68:71], v[108:111], v[44:47], a[68:71]
v_mfma_f32_16x16x32_bf16 a[72:75], v[112:115], v[40:43], a[72:75]
v_mfma_f32_16x16x32_bf16 a[72:75], v[116:119], v[44:47], a[72:75]
v_mfma_f32_16x16x32_bf16 a[76:79], v[120:123], v[40:43], a[76:79]
v_mfma_f32_16x16x32_bf16 a[76:79], v[124:127], v[44:47], a[76:79]
s_waitcnt lgkmcnt(2)
v_mfma_f32_16x16x32_bf16 a[80:83], v[96:99], v[48:51], a[80:83]
ds_read_b128 v[40:43], v2 offset:30720
v_mfma_f32_16x16x32_bf16 a[80:83], v[100:103], v[52:55], a[80:83]
ds_read_b128 v[44:47], v3 offset:30720
v_mfma_f32_16x16x32_bf16 a[84:87], v[104:107], v[48:51], a[84:87]
v_mfma_f32_16x16x32_bf16 a[84:87], v[108:111], v[52:55], a[84:87]
v_mfma_f32_16x16x32_bf16 a[88:91], v[112:115], v[48:51], a[88:91]
v_mfma_f32_16x16x32_bf16 a[88:91], v[116:119], v[52:55], a[88:91]
v_mfma_f32_16x16x32_bf16 a[92:95], v[120:123], v[48:51], a[92:95]
v_mfma_f32_16x16x32_bf16 a[92:95], v[124:127], v[52:55], a[92:95]
s_waitcnt lgkmcnt(2)
v_mfma_f32_16x16x32_bf16 a[96:99], v[96:99], v[56:59], a[96:99]
ds_read_b128 v[48:51], v2 offset:32768
v_mfma_f32_16x16x32_bf16 a[96:99], v[100:103], v[60:63], a[96:99]
ds_read_b128 v[52:55], v3 offset:32768
v_mfma_f32_16x16x32_bf16 a[100:103], v[104:107], v[56:59], a[100:103]
v_mfma_f32_16x16x32_bf16 a[100:103], v[108:111], v[60:63], a[100:103]
v_mfma_f32_16x16x32_bf16 a[104:107], v[112:115], v[56:59], a[104:107]
v_mfma_f32_16x16x32_bf16 a[104:107], v[116:119], v[60:63], a[104:107]
v_mfma_f32_16x16x32_bf16 a[108:111], v[120:123], v[56:59], a[108:111]
v_mfma_f32_16x16x32_bf16 a[108:111], v[124:127], v[60:63], a[108:111]
s_waitcnt lgkmcnt(2)
v_mfma_f32_16x16x32_bf16 a[112:115], v[96:99], v[40:43], a[112:115]
ds_read_b128 v[56:59], v2 offset:34816
buffer_load_dwordx4 v[96:99], v1, s[12:15], s33 offen offset:0 sc1
v_mfma_f32_16x16x32_bf16 a[112:115], v[100:103], v[44:47], a[112:115]
ds_read_b128 v[60:63], v3 offset:34816
v_mfma_f32_16x16x32_bf16 a[116:119], v[104:107], v[40:43], a[116:119]
v_mfma_f32_16x16x32_bf16 a[116:119], v[108:111], v[44:47], a[116:119]
buffer_load_dwordx4 v[100:103], v1, s[12:15], s33 offen offset:1024 sc1
v_mfma_f32_16x16x32_bf16 a[120:123], v[112:115], v[40:43], a[120:123]
v_mfma_f32_16x16x32_bf16 a[120:123], v[116:119], v[44:47], a[120:123]
v_mfma_f32_16x16x32_bf16 a[124:127], v[120:123], v[40:43], a[124:127]
buffer_load_dwordx4 v[104:107], v1, s[12:15], s33 offen offset:2048 sc1
v_mfma_f32_16x16x32_bf16 a[124:127], v[124:127], v[44:47], a[124:127]
s_waitcnt vmcnt(9) lgkmcnt(2)
v_mfma_f32_16x16x32_bf16 a[0:3], v[64:67], v[48:51], a[0:3]
ds_read_b128 v[40:43], v2 offset:36864
v_mfma_f32_16x16x32_bf16 a[0:3], v[68:71], v[52:55], a[0:3]
ds_read_b128 v[44:47], v3 offset:36864
buffer_load_dwordx4 v[108:111], v1, s[12:15], s33 offen offset:3072 sc1
s_waitcnt vmcnt(8)
v_mfma_f32_16x16x32_bf16 a[4:7], v[72:75], v[48:51], a[4:7]
v_mfma_f32_16x16x32_bf16 a[4:7], v[76:79], v[52:55], a[4:7]
s_waitcnt vmcnt(6)
v_mfma_f32_16x16x32_bf16 a[8:11], v[80:83], v[48:51], a[8:11]
buffer_load_dwordx4 v[112:115], v1, s[12:15], s34 offen offset:0 sc1
v_mfma_f32_16x16x32_bf16 a[8:11], v[84:87], v[52:55], a[8:11]
s_waitcnt vmcnt(5)
v_mfma_f32_16x16x32_bf16 a[12:15], v[88:91], v[48:51], a[12:15]
v_mfma_f32_16x16x32_bf16 a[12:15], v[92:95], v[52:55], a[12:15]
buffer_load_dwordx4 v[116:119], v1, s[12:15], s34 offen offset:1024 sc1
s_waitcnt lgkmcnt(2)
v_mfma_f32_16x16x32_bf16 a[16:19], v[64:67], v[56:59], a[16:19]
ds_read_b128 v[48:51], v2 offset:38912
v_mfma_f32_16x16x32_bf16 a[16:19], v[68:71], v[60:63], a[16:19]
ds_read_b128 v[52:55], v3 offset:38912
v_mfma_f32_16x16x32_bf16 a[20:23], v[72:75], v[56:59], a[20:23]
buffer_load_dwordx4 v[120:123], v1, s[12:15], s34 offen offset:2048 sc1
v_mfma_f32_16x16x32_bf16 a[20:23], v[76:79], v[60:63], a[20:23]
v_mfma_f32_16x16x32_bf16 a[24:27], v[80:83], v[56:59], a[24:27]
v_mfma_f32_16x16x32_bf16 a[24:27], v[84:87], v[60:63], a[24:27]
buffer_load_dwordx4 v[124:127], v1, s[12:15], s34 offen offset:3072 sc1
s_add_u32 s33, s33, 0xfffc8000
s_add_u32 s34, s34, 0xfffc8000
v_mfma_f32_16x16x32_bf16 a[28:31], v[88:91], v[56:59], a[28:31]
v_mfma_f32_16x16x32_bf16 a[28:31], v[92:95], v[60:63], a[28:31]
s_waitcnt lgkmcnt(2)
v_mfma_f32_16x16x32_bf16 a[32:35], v[64:67], v[40:43], a[32:35]
ds_read_b128 v[56:59], v2 offset:40960
v_mfma_f32_16x16x32_bf16 a[32:35], v[68:71], v[44:47], a[32:35]
ds_read_b128 v[60:63], v3 offset:40960
v_mfma_f32_16x16x32_bf16 a[36:39], v[72:75], v[40:43], a[36:39]
v_mfma_f32_16x16x32_bf16 a[36:39], v[76:79], v[44:47], a[36:39]
v_mfma_f32_16x16x32_bf16 a[40:43], v[80:83], v[40:43], a[40:43]
v_mfma_f32_16x16x32_bf16 a[40:43], v[84:87], v[44:47], a[40:43]
v_mfma_f32_16x16x32_bf16 a[44:47], v[88:91], v[40:43], a[44:47]
v_mfma_f32_16x16x32_bf16 a[44:47], v[92:95], v[44:47], a[44:47]
s_waitcnt lgkmcnt(2)
v_mfma_f32_16x16x32_bf16 a[48:51], v[64:67], v[48:51], a[48:51]
ds_read_b128 v[40:43], v2 offset:43008
v_mfma_f32_16x16x32_bf16 a[48:51], v[68:71], v[52:55], a[48:51]
ds_read_b128 v[44:47], v3 offset:43008
v_mfma_f32_16x16x32_bf16 a[52:55], v[72:75], v[48:51], a[52:55]
v_mfma_f32_16x16x32_bf16 a[52:55], v[76:79], v[52:55], a[52:55]
v_mfma_f32_16x16x32_bf16 a[56:59], v[80:83], v[48:51], a[56:59]
v_mfma_f32_16x16x32_bf16 a[56:59], v[84:87], v[52:55], a[56:59]
v_mfma_f32_16x16x32_bf16 a[60:63], v[88:91], v[48:51], a[60:63]
v_mfma_f32_16x16x32_bf16 a[60:63], v[92:95], v[52:55], a[60:63]
s_waitcnt lgkmcnt(2)
v_mfma_f32_16x16x32_bf16 a[64:67], v[64:67], v[56:59], a[64:67]
ds_read_b128 v[48:51], v2 offset:45056
v_mfma_f32_16x16x32_bf16 a[64:67], v[68:71], v[60:63], a[64:67]
ds_read_b128 v[52:55], v3 offset:45056
v_mfma_f32_16x16x32_bf16 a[68:71], v[72:75], v[56:59], a[68:71]
v_mfma_f32_16x16x32_bf16 a[68:71], v[76:79], v[60:63], a[68:71]
v_mfma_f32_16x16x32_bf16 a[72:75], v[80:83], v[56:59], a[72:75]
v_mfma_f32_16x16x32_bf16 a[72:75], v[84:87], v[60:63], a[72:75]
v_mfma_f32_16x16x32_bf16 a[76:79], v[88:91], v[56:59], a[76:79]
v_mfma_f32_16x16x32_bf16 a[76:79], v[92:95], v[60:63], a[76:79]
s_waitcnt lgkmcnt(2)
v_mfma_f32_16x16x32_bf16 a[80:83], v[64:67], v[40:43], a[80:83]
ds_read_b128 v[56:59], v2 offset:47104
v_mfma_f32_16x16x32_bf16 a[80:83], v[68:71], v[44:47], a[80:83]
ds_read_b128 v[60:63], v3 offset:47104
v_mfma_f32_16x16x32_bf16 a[84:87], v[72:75], v[40:43], a[84:87]
v_mfma_f32_16x16x32_bf16 a[84:87], v[76:79], v[44:47], a[84:87]
v_mfma_f32_16x16x32_bf16 a[88:91], v[80:83], v[40:43], a[88:91]
v_mfma_f32_16x16x32_bf16 a[88:91], v[84:87], v[44:47], a[88:91]
v_mfma_f32_16x16x32_bf16 a[92:95], v[88:91], v[40:43], a[92:95]
v_mfma_f32_16x16x32_bf16 a[92:95], v[92:95], v[44:47], a[92:95]
s_waitcnt lgkmcnt(2)
v_mfma_f32_16x16x32_bf16 a[96:99], v[64:67], v[48:51], a[96:99]
ds_read_b128 v[40:43], v2 offset:49152
v_mfma_f32_16x16x32_bf16 a[96:99], v[68:71], v[52:55], a[96:99]
ds_read_b128 v[44:47], v3 offset:49152
v_mfma_f32_16x16x32_bf16 a[100:103], v[72:75], v[48:51], a[100:103]
v_mfma_f32_16x16x32_bf16 a[100:103], v[76:79], v[52:55], a[100:103]
v_mfma_f32_16x16x32_bf16 a[104:107], v[80:83], v[48:51], a[104:107]
v_mfma_f32_16x16x32_bf16 a[104:107], v[84:87], v[52:55], a[104:107]
v_mfma_f32_16x16x32_bf16 a[108:111], v[88:91], v[48:51], a[108:111]
v_mfma_f32_16x16x32_bf16 a[108:111], v[92:95], v[52:55], a[108:111]
s_waitcnt lgkmcnt(2)
v_mfma_f32_16x16x32_bf16 a[112:115], v[64:67], v[56:59], a[112:115]
ds_read_b128 v[48:51], v2 offset:51200
buffer_load_dwordx4 v[64:67], v1, s[12:15], s33 offen offset:0 sc1
v_mfma_f32_16x16x32_bf16 a[112:115], v[68:71], v[60:63], a[112:115]
ds_read_b128 v[52:55], v3 offset:51200
v_mfma_f32_16x16x32_bf16 a[116:119], v[72:75], v[56:59], a[116:119]
v_mfma_f32_16x16x32_bf16 a[116:119], v[76:79], v[60:63], a[116:119]
buffer_load_dwordx4 v[68:71], v1, s[12:15], s33 offen offset:1024 sc1
v_mfma_f32_16x16x32_bf16 a[120:123], v[80:83], v[56:59], a[120:123]
v_mfma_f32_16x16x32_bf16 a[120:123], v[84:87], v[60:63], a[120:123]
v_mfma_f32_16x16x32_bf16 a[124:127], v[88:91], v[56:59], a[124:127]
buffer_load_dwordx4 v[72:75], v1, s[12:15], s33 offen offset:2048 sc1
v_mfma_f32_16x16x32_bf16 a[124:127], v[92:95], v[60:63], a[124:127]
s_waitcnt vmcnt(9) lgkmcnt(2)
v_mfma_f32_16x16x32_bf16 a[0:3], v[96:99], v[40:43], a[0:3]
ds_read_b128 v[56:59], v2 offset:53248
v_mfma_f32_16x16x32_bf16 a[0:3], v[100:103], v[44:47], a[0:3]
ds_read_b128 v[60:63], v3 offset:53248
buffer_load_dwordx4 v[76:79], v1, s[12:15], s33 offen offset:3072 sc1
s_waitcnt vmcnt(8)
v_mfma_f32_16x16x32_bf16 a[4:7], v[104:107], v[40:43], a[4:7]
v_mfma_f32_16x16x32_bf16 a[4:7], v[108:111], v[44:47], a[4:7]
s_waitcnt vmcnt(6)
v_mfma_f32_16x16x32_bf16 a[8:11], v[112:115], v[40:43], a[8:11]
buffer_load_dwordx4 v[80:83], v1, s[12:15], s34 offen offset:0 sc1
v_mfma_f32_16x16x32_bf16 a[8:11], v[116:119], v[44:47], a[8:11]
s_waitcnt vmcnt(5)
v_mfma_f32_16x16x32_bf16 a[12:15], v[120:123], v[40:43], a[12:15]
v_mfma_f32_16x16x32_bf16 a[12:15], v[124:127], v[44:47], a[12:15]
buffer_load_dwordx4 v[84:87], v1, s[12:15], s34 offen offset:1024 sc1
s_waitcnt lgkmcnt(2)
v_mfma_f32_16x16x32_bf16 a[16:19], v[96:99], v[48:51], a[16:19]
ds_read_b128 v[40:43], v2 offset:55296
v_mfma_f32_16x16x32_bf16 a[16:19], v[100:103], v[52:55], a[16:19]
ds_read_b128 v[44:47], v3 offset:55296
v_mfma_f32_16x16x32_bf16 a[20:23], v[104:107], v[48:51], a[20:23]
buffer_load_dwordx4 v[88:91], v1, s[12:15], s34 offen offset:2048 sc1
v_mfma_f32_16x16x32_bf16 a[20:23], v[108:111], v[52:55], a[20:23]
s_lshl_b32 s5, s3, 2
v_mfma_f32_16x16x32_bf16 a[24:27], v[112:115], v[48:51], a[24:27]
s_add_u32 s5, s5, 0x21800
v_and_b32 v4, 0x7ff, v4
v_mfma_f32_16x16x32_bf16 a[24:27], v[116:119], v[52:55], a[24:27]
buffer_load_dwordx4 v[92:95], v1, s[12:15], s34 offen offset:3072 sc1
s_add_u32 s33, s33, 0x8000
s_add_u32 s34, s34, 0x8000
v_mfma_f32_16x16x32_bf16 a[28:31], v[120:123], v[48:51], a[28:31]
v_mfma_f32_16x16x32_bf16 a[28:31], v[124:127], v[52:55], a[28:31]
v_add_u32 v4, s5, v4
s_waitcnt lgkmcnt(2)
v_mfma_f32_16x16x32_bf16 a[32:35], v[96:99], v[56:59], a[32:35]
ds_read_b128 v[48:51], v2 offset:57344
v_mfma_f32_16x16x32_bf16 a[32:35], v[100:103], v[60:63], a[32:35]
ds_read_b128 v[52:55], v3 offset:57344
v_mfma_f32_16x16x32_bf16 a[36:39], v[104:107], v[56:59], a[36:39]
v_and_b32 v5, 0x7ff, v5
v_mfma_f32_16x16x32_bf16 a[36:39], v[108:111], v[60:63], a[36:39]
v_add_u32 v5, s5, v5
v_and_b32 v6, 0x7ff, v6
v_mfma_f32_16x16x32_bf16 a[40:43], v[112:115], v[56:59], a[40:43]
v_add_u32 v6, s5, v6
v_mfma_f32_16x16x32_bf16 a[40:43], v[116:119], v[60:63], a[40:43]
v_and_b32 v7, 0x7ff, v7
v_add_u32 v7, s5, v7
v_mfma_f32_16x16x32_bf16 a[44:47], v[120:123], v[56:59], a[44:47]
s_add_u32 s36, s37, 0
v_mfma_f32_16x16x32_bf16 a[44:47], v[124:127], v[60:63], a[44:47]
v_accvgpr_read_b32 v12, a0
s_waitcnt lgkmcnt(2)
v_mfma_f32_16x16x32_bf16 a[48:51], v[96:99], v[40:43], a[48:51]
ds_read_b128 v[56:59], v2 offset:59392
v_mfma_f32_16x16x32_bf16 a[48:51], v[100:103], v[44:47], a[48:51]
ds_read_b128 v[60:63], v3 offset:59392
v_mfma_f32_16x16x32_bf16 a[52:55], v[104:107], v[40:43], a[52:55]
v_accvgpr_read_b32 v13, a4
v_lshlrev_b32 v16, 16, v128
v_mfma_f32_16x16x32_bf16 a[52:55], v[108:111], v[44:47], a[52:55]
v_and_b32 v17, 0xffff0000, v128
v_mfma_f32_16x16x32_bf16 a[56:59], v[112:115], v[40:43], a[56:59]
v_mul_f32 v12, v12, v16
v_mul_f32 v13, v13, v17
v_mfma_f32_16x16x32_bf16 a[56:59], v[116:119], v[44:47], a[56:59]
v_cvt_pk_bf16_f32 v20, v12, v13
v_mfma_f32_16x16x32_bf16 a[60:63], v[120:123], v[40:43], a[60:63]
v_accvgpr_read_b32 v14, a8
v_mfma_f32_16x16x32_bf16 a[60:63], v[124:127], v[44:47], a[60:63]
v_accvgpr_read_b32 v15, a12
v_lshlrev_b32 v18, 16, v129
s_waitcnt lgkmcnt(2)
v_mfma_f32_16x16x32_bf16 a[64:67], v[96:99], v[48:51], a[64:67]
ds_read_b128 v[40:43], v2 offset:61440
v_mfma_f32_16x16x32_bf16 a[64:67], v[100:103], v[52:55], a[64:67]
ds_read_b128 v[44:47], v3 offset:61440
v_mfma_f32_16x16x32_bf16 a[68:71], v[104:107], v[48:51], a[68:71]
v_and_b32 v19, 0xffff0000, v129
v_mfma_f32_16x16x32_bf16 a[68:71], v[108:111], v[52:55], a[68:71]
v_mul_f32 v14, v14, v18
v_mul_f32 v15, v15, v19
v_mfma_f32_16x16x32_bf16 a[72:75], v[112:115], v[48:51], a[72:75]
v_cvt_pk_bf16_f32 v21, v14, v15
v_mfma_f32_16x16x32_bf16 a[72:75], v[116:119], v[52:55], a[72:75]
v_accvgpr_read_b32 v12, a1
v_mfma_f32_16x16x32_bf16 a[76:79], v[120:123], v[48:51], a[76:79]
v_accvgpr_read_b32 v13, a5
v_lshlrev_b32 v16, 16, v130
v_mfma_f32_16x16x32_bf16 a[76:79], v[124:127], v[52:55], a[76:79]
v_and_b32 v17, 0xffff0000, v130
s_waitcnt lgkmcnt(2)
v_mfma_f32_16x16x32_bf16 a[80:83], v[96:99], v[56:59], a[80:83]
ds_read_b128 v[48:51], v2 offset:63488
v_mfma_f32_16x16x32_bf16 a[80:83], v[100:103], v[60:63], a[80:83]
ds_read_b128 v[52:55], v3 offset:63488
v_mfma_f32_16x16x32_bf16 a[84:87], v[104:107], v[56:59], a[84:87]
v_mul_f32 v12, v12, v16
v_mul_f32 v13, v13, v17
v_mfma_f32_16x16x32_bf16 a[84:87], v[108:111], v[60:63], a[84:87]
v_cvt_pk_bf16_f32 v22, v12, v13
v_mfma_f32_16x16x32_bf16 a[88:91], v[112:115], v[56:59], a[88:91]
v_accvgpr_read_b32 v14, a9
v_mfma_f32_16x16x32_bf16 a[88:91], v[116:119], v[60:63], a[88:91]
v_accvgpr_read_b32 v15, a13
v_lshlrev_b32 v18, 16, v131
v_mfma_f32_16x16x32_bf16 a[92:95], v[120:123], v[56:59], a[92:95]
v_and_b32 v19, 0xffff0000, v131
v_mfma_f32_16x16x32_bf16 a[92:95], v[124:127], v[60:63], a[92:95]
v_mul_f32 v14, v14, v18
v_mul_f32 v15, v15, v19
s_waitcnt lgkmcnt(2)
v_mfma_f32_16x16x32_bf16 a[96:99], v[96:99], v[40:43], a[96:99]
v_mfma_f32_16x16x32_bf16 a[96:99], v[100:103], v[44:47], a[96:99]
v_cvt_pk_bf16_f32 v23, v14, v15
ds_write_b128 v4, v[20:23] offset:0
v_mfma_f32_16x16x32_bf16 a[100:103], v[104:107], v[40:43], a[100:103]
v_accvgpr_read_b32 v12, a2
v_mfma_f32_16x16x32_bf16 a[100:103], v[108:111], v[44:47], a[100:103]
v_accvgpr_read_b32 v13, a6
v_mfma_f32_16x16x32_bf16 a[104:107], v[112:115], v[40:43], a[104:107]
v_lshlrev_b32 v16, 16, v132
v_and_b32 v17, 0xffff0000, v132
v_mfma_f32_16x16x32_bf16 a[104:107], v[116:119], v[44:47], a[104:107]
v_mul_f32 v12, v12, v16
v_mfma_f32_16x16x32_bf16 a[108:111], v[120:123], v[40:43], a[108:111]
v_mul_f32 v13, v13, v17
v_cvt_pk_bf16_f32 v24, v12, v13
v_mfma_f32_16x16x32_bf16 a[108:111], v[124:127], v[44:47], a[108:111]
v_accvgpr_read_b32 v14, a10
s_waitcnt lgkmcnt(1)
v_xor_b32 v2, 0x10000, v2
v_xor_b32 v3, 0x10000, v3
v_mfma_f32_16x16x32_bf16 a[112:115], v[96:99], v[48:51], a[112:115]
ds_read_b128 v[56:59], v2 offset:0
buffer_load_dwordx4 v[96:99], v1, s[12:15], s33 offen offset:0 sc1
v_mfma_f32_16x16x32_bf16 a[112:115], v[100:103], v[52:55], a[112:115]
ds_read_b128 v[60:63], v3 offset:0
v_mfma_f32_16x16x32_bf16 a[116:119], v[104:107], v[48:51], a[116:119]
ds_read_b128 v[40:43], v2 offset:2048
v_mfma_f32_16x16x32_bf16 a[116:119], v[108:111], v[52:55], a[116:119]
ds_read_b128 v[44:47], v3 offset:2048
buffer_load_dwordx4 v[100:103], v1, s[12:15], s33 offen offset:1024 sc1
v_mfma_f32_16x16x32_bf16 a[120:123], v[112:115], v[48:51], a[120:123]
v_mfma_f32_16x16x32_bf16 a[120:123], v[116:119], v[52:55], a[120:123]
v_accvgpr_read_b32 v15, a14
v_mfma_f32_16x16x32_bf16 a[124:127], v[120:123], v[48:51], a[124:127]
buffer_load_dwordx4 v[104:107], v1, s[12:15], s33 offen offset:2048 sc1
v_mfma_f32_16x16x32_bf16 a[124:127], v[124:127], v[52:55], a[124:127]
v_lshlrev_b32 v18, 16, v133
s_waitcnt vmcnt(9) lgkmcnt(2)
v_mfma_f32_16x16x32_bf16 a[128:131], v[64:67], v[56:59], a[128:131]
ds_read_b128 v[48:51], v2 offset:4096
v_mfma_f32_16x16x32_bf16 a[128:131], v[68:71], v[60:63], a[128:131]
ds_read_b128 v[52:55], v3 offset:4096
buffer_load_dwordx4 v[108:111], v1, s[12:15], s33 offen offset:3072 sc1
s_waitcnt vmcnt(8)
v_mfma_f32_16x16x32_bf16 a[132:135], v[72:75], v[56:59], a[132:135]
v_mfma_f32_16x16x32_bf16 a[132:135], v[76:79], v[60:63], a[132:135]
v_and_b32 v19, 0xffff0000, v133
s_waitcnt vmcnt(6)
v_mfma_f32_16x16x32_bf16 a[136:139], v[80:83], v[56:59], a[136:139]
buffer_load_dwordx4 v[112:115], v1, s[12:15], s34 offen offset:0 sc1
v_mfma_f32_16x16x32_bf16 a[136:139], v[84:87], v[60:63], a[136:139]
v_mul_f32 v14, v14, v18
s_waitcnt vmcnt(5)
v_mfma_f32_16x16x32_bf16 a[140:143], v[88:91], v[56:59], a[140:143]
v_mfma_f32_16x16x32_bf16 a[140:143], v[92:95], v[60:63], a[140:143]
buffer_load_dwordx4 v[116:119], v1, s[12:15], s34 offen offset:1024 sc1
v_mul_f32 v15, v15, v19
s_waitcnt lgkmcnt(2)
v_mfma_f32_16x16x32_bf16 a[144:147], v[64:67], v[40:43], a[144:147]
ds_read_b128 v[56:59], v2 offset:6144
v_mfma_f32_16x16x32_bf16 a[144:147], v[68:71], v[44:47], a[144:147]
ds_read_b128 v[60:63], v3 offset:6144
v_mfma_f32_16x16x32_bf16 a[148:151], v[72:75], v[40:43], a[148:151]
buffer_load_dwordx4 v[120:123], v1, s[12:15], s34 offen offset:2048 sc1
v_mfma_f32_16x16x32_bf16 a[148:151], v[76:79], v[44:47], a[148:151]
v_cvt_pk_bf16_f32 v25, v14, v15
v_accvgpr_read_b32 v12, a3
v_mfma_f32_16x16x32_bf16 a[152:155], v[80:83], v[40:43], a[152:155]
v_accvgpr_read_b32 v13, a7
v_mfma_f32_16x16x32_bf16 a[152:155], v[84:87], v[44:47], a[152:155]
buffer_load_dwordx4 v[124:127], v1, s[12:15], s34 offen offset:3072 sc1
s_add_u32 s33, s33, 0x8000
s_add_u32 s34, s34, 0x8000
v_mfma_f32_16x16x32_bf16 a[156:159], v[88:91], v[40:43], a[156:159]
v_mfma_f32_16x16x32_bf16 a[156:159], v[92:95], v[44:47], a[156:159]
v_lshlrev_b32 v16, 16, v134
s_waitcnt lgkmcnt(2)
v_mfma_f32_16x16x32_bf16 a[160:163], v[64:67], v[48:51], a[160:163]
ds_read_b128 v[40:43], v2 offset:8192
v_mfma_f32_16x16x32_bf16 a[160:163], v[68:71], v[52:55], a[160:163]
ds_read_b128 v[44:47], v3 offset:8192
v_mfma_f32_16x16x32_bf16 a[164:167], v[72:75], v[48:51], a[164:167]
v_and_b32 v17, 0xffff0000, v134
v_mul_f32 v12, v12, v16
v_mfma_f32_16x16x32_bf16 a[164:167], v[76:79], v[52:55], a[164:167]
v_mul_f32 v13, v13, v17
v_mfma_f32_16x16x32_bf16 a[168:171], v[80:83], v[48:51], a[168:171]
v_cvt_pk_bf16_f32 v26, v12, v13
v_mfma_f32_16x16x32_bf16 a[168:171], v[84:87], v[52:55], a[168:171]
v_accvgpr_read_b32 v14, a11
v_accvgpr_read_b32 v15, a15
v_mfma_f32_16x16x32_bf16 a[172:175], v[88:91], v[48:51], a[172:175]
v_lshlrev_b32 v18, 16, v135
v_mfma_f32_16x16x32_bf16 a[172:175], v[92:95], v[52:55], a[172:175]
v_and_b32 v19, 0xffff0000, v135
v_mul_f32 v14, v14, v18
s_waitcnt lgkmcnt(2)
v_mfma_f32_16x16x32_bf16 a[176:179], v[64:67], v[56:59], a[176:179]
ds_read_b128 v[48:51], v2 offset:10240
v_mfma_f32_16x16x32_bf16 a[176:179], v[68:71], v[60:63], a[176:179]
ds_read_b128 v[52:55], v3 offset:10240
v_mfma_f32_16x16x32_bf16 a[180:183], v[72:75], v[56:59], a[180:183]
v_mul_f32 v15, v15, v19
v_mfma_f32_16x16x32_bf16 a[180:183], v[76:79], v[60:63], a[180:183]
v_cvt_pk_bf16_f32 v27, v14, v15
v_mfma_f32_16x16x32_bf16 a[184:187], v[80:83], v[56:59], a[184:187]
ds_write_b128 v5, v[24:27] offset:0
ds_read_b128 v[32:35], v6 offset:0
v_mfma_f32_16x16x32_bf16 a[184:187], v[84:87], v[60:63], a[184:187]
ds_read_b128 v[36:39], v7 offset:1024
v_mfma_f32_16x16x32_bf16 a[188:191], v[88:91], v[56:59], a[188:191]
v_accvgpr_read_b32 v12, a16
v_accvgpr_read_b32 v13, a20
v_mfma_f32_16x16x32_bf16 a[188:191], v[92:95], v[60:63], a[188:191]
v_lshlrev_b32 v16, 16, v136
s_waitcnt lgkmcnt(5)
v_mfma_f32_16x16x32_bf16 a[192:195], v[64:67], v[40:43], a[192:195]
ds_read_b128 v[56:59], v2 offset:12288
v_mfma_f32_16x16x32_bf16 a[192:195], v[68:71], v[44:47], a[192:195]
ds_read_b128 v[60:63], v3 offset:12288
v_mfma_f32_16x16x32_bf16 a[196:199], v[72:75], v[40:43], a[196:199]
v_and_b32 v17, 0xffff0000, v136
v_mfma_f32_16x16x32_bf16 a[196:199], v[76:79], v[44:47], a[196:199]
v_mul_f32 v12, v12, v16
v_mul_f32 v13, v13, v17
v_mfma_f32_16x16x32_bf16 a[200:203], v[80:83], v[40:43], a[200:203]
v_cvt_pk_bf16_f32 v20, v12, v13
v_mfma_f32_16x16x32_bf16 a[200:203], v[84:87], v[44:47], a[200:203]
v_accvgpr_read_b32 v14, a24
v_accvgpr_read_b32 v15, a28
v_mfma_f32_16x16x32_bf16 a[204:207], v[88:91], v[40:43], a[204:207]
v_lshlrev_b32 v18, 16, v137
v_mfma_f32_16x16x32_bf16 a[204:207], v[92:95], v[44:47], a[204:207]
v_and_b32 v19, 0xffff0000, v137
v_mul_f32 v14, v14, v18
s_waitcnt lgkmcnt(5)
v_mfma_f32_16x16x32_bf16 a[208:211], v[64:67], v[48:51], a[208:211]
ds_read_b128 v[40:43], v2 offset:14336
v_mfma_f32_16x16x32_bf16 a[208:211], v[68:71], v[52:55], a[208:211]
ds_read_b128 v[44:47], v3 offset:14336
v_mfma_f32_16x16x32_bf16 a[212:215], v[72:75], v[48:51], a[212:215]
v_mul_f32 v15, v15, v19
v_mfma_f32_16x16x32_bf16 a[212:215], v[76:79], v[52:55], a[212:215]
v_cvt_pk_bf16_f32 v21, v14, v15
v_mfma_f32_16x16x32_bf16 a[216:219], v[80:83], v[48:51], a[216:219]
v_accvgpr_read_b32 v12, a17
v_accvgpr_read_b32 v13, a21
v_mfma_f32_16x16x32_bf16 a[216:219], v[84:87], v[52:55], a[216:219]
v_lshlrev_b32 v16, 16, v138
v_mfma_f32_16x16x32_bf16 a[220:223], v[88:91], v[48:51], a[220:223]
v_and_b32 v17, 0xffff0000, v138
v_mul_f32 v12, v12, v16
v_mfma_f32_16x16x32_bf16 a[220:223], v[92:95], v[52:55], a[220:223]
v_mul_f32 v13, v13, v17
s_waitcnt lgkmcnt(2)
v_mfma_f32_16x16x32_bf16 a[224:227], v[64:67], v[56:59], a[224:227]
ds_read_b128 v[48:51], v2 offset:16384
v_mfma_f32_16x16x32_bf16 a[224:227], v[68:71], v[60:63], a[224:227]
ds_read_b128 v[52:55], v3 offset:16384
v_mfma_f32_16x16x32_bf16 a[228:231], v[72:75], v[56:59], a[228:231]
v_cvt_pk_bf16_f32 v22, v12, v13
v_mfma_f32_16x16x32_bf16 a[228:231], v[76:79], v[60:63], a[228:231]
v_accvgpr_read_b32 v14, a25
v_accvgpr_read_b32 v15, a29
v_mfma_f32_16x16x32_bf16 a[232:235], v[80:83], v[56:59], a[232:235]
v_lshlrev_b32 v18, 16, v139
v_mfma_f32_16x16x32_bf16 a[232:235], v[84:87], v[60:63], a[232:235]
v_and_b32 v19, 0xffff0000, v139
v_mul_f32 v14, v14, v18
v_mfma_f32_16x16x32_bf16 a[236:239], v[88:91], v[56:59], a[236:239]
v_mul_f32 v15, v15, v19
v_mfma_f32_16x16x32_bf16 a[236:239], v[92:95], v[60:63], a[236:239]
v_cvt_pk_bf16_f32 v23, v14, v15
s_waitcnt lgkmcnt(2)
v_mfma_f32_16x16x32_bf16 a[240:243], v[64:67], v[40:43], a[240:243]
ds_read_b128 v[56:59], v2 offset:18432
buffer_load_dwordx4 v[64:67], v1, s[12:15], s33 offen offset:0 sc1
v_mfma_f32_16x16x32_bf16 a[240:243], v[68:71], v[44:47], a[240:243]
ds_read_b128 v[60:63], v3 offset:18432
v_mfma_f32_16x16x32_bf16 a[244:247], v[72:75], v[40:43], a[244:247]
ds_write_b128 v4, v[20:23] offset:2048
v_mfma_f32_16x16x32_bf16 a[244:247], v[76:79], v[44:47], a[244:247]
buffer_load_dwordx4 v[68:71], v1, s[12:15], s33 offen offset:1024 sc1
v_mfma_f32_16x16x32_bf16 a[248:251], v[80:83], v[40:43], a[248:251]
buffer_store_dwordx4 v[32:35], v9, s[16:19], s36 offen sc1
s_add_u32 s36, s36, 0x4000
v_mfma_f32_16x16x32_bf16 a[248:251], v[84:87], v[44:47], a[248:251]
buffer_store_dwordx4 v[36:39], v9, s[16:19], s36 offen sc1
v_mfma_f32_16x16x32_bf16 a[252:255], v[88:91], v[40:43], a[252:255]
buffer_load_dwordx4 v[72:75], v1, s[12:15], s33 offen offset:2048 sc1
v_mfma_f32_16x16x32_bf16 a[252:255], v[92:95], v[44:47], a[252:255]
s_add_u32 s36, s36, 0x4000
v_accvgpr_read_b32 v12, a18
s_waitcnt vmcnt(11) lgkmcnt(3)
v_mfma_f32_16x16x32_bf16 a[128:131], v[96:99], v[48:51], a[128:131]
ds_read_b128 v[40:43], v2 offset:20480
v_mfma_f32_16x16x32_bf16 a[128:131], v[100:103], v[52:55], a[128:131]
ds_read_b128 v[44:47], v3 offset:20480
buffer_load_dwordx4 v[76:79], v1, s[12:15], s33 offen offset:3072 sc1
s_waitcnt vmcnt(10)
v_mfma_f32_16x16x32_bf16 a[132:135], v[104:107], v[48:51], a[132:135]
v_mfma_f32_16x16x32_bf16 a[132:135], v[108:111], v[52:55], a[132:135]
v_accvgpr_read_b32 v13, a22
s_waitcnt vmcnt(8)
v_mfma_f32_16x16x32_bf16 a[136:139], v[112:115], v[48:51], a[136:139]
buffer_load_dwordx4 v[80:83], v1, s[12:15], s34 offen offset:0 sc1
v_mfma_f32_16x16x32_bf16 a[136:139], v[116:119], v[52:55], a[136:139]
s_waitcnt vmcnt(7)
v_mfma_f32_16x16x32_bf16 a[140:143], v[120:123], v[48:51], a[140:143]
v_lshlrev_b32 v16, 16, v140
v_mfma_f32_16x16x32_bf16 a[140:143], v[124:127], v[52:55], a[140:143]
buffer_load_dwordx4 v[84:87], v1, s[12:15], s34 offen offset:1024 sc1
s_waitcnt lgkmcnt(3)
v_mfma_f32_16x16x32_bf16 a[144:147], v[96:99], v[56:59], a[144:147]
ds_read_b128 v[48:51], v2 offset:22528
v_mfma_f32_16x16x32_bf16 a[144:147], v[100:103], v[60:63], a[144:147]
ds_read_b128 v[52:55], v3 offset:22528
v_mfma_f32_16x16x32_bf16 a[148:151], v[104:107], v[56:59], a[148:151]
buffer_load_dwordx4 v[88:91], v1, s[12:15], s34 offen offset:2048 sc1
v_and_b32 v17, 0xffff0000, v140
v_mfma_f32_16x16x32_bf16 a[148:151], v[108:111], v[60:63], a[148:151]
v_mul_f32 v12, v12, v16
v_mfma_f32_16x16x32_bf16 a[152:155], v[112:115], v[56:59], a[152:155]
v_mul_f32 v13, v13, v17
v_mfma_f32_16x16x32_bf16 a[152:155], v[116:119], v[60:63], a[152:155]
buffer_load_dwordx4 v[92:95], v1, s[12:15], s34 offen offset:3072 sc1
s_add_u32 s33, s33, 0x8000
s_add_u32 s34, s34, 0x8000
v_mfma_f32_16x16x32_bf16 a[156:159], v[120:123], v[56:59], a[156:159]
v_mfma_f32_16x16x32_bf16 a[156:159], v[124:127], v[60:63], a[156:159]
v_cvt_pk_bf16_f32 v24, v12, v13
v_accvgpr_read_b32 v14, a26
s_waitcnt lgkmcnt(2)
v_mfma_f32_16x16x32_bf16 a[160:163], v[96:99], v[40:43], a[160:163]
ds_read_b128 v[56:59], v2 offset:24576
v_mfma_f32_16x16x32_bf16 a[160:163], v[100:103], v[44:47], a[160:163]
ds_read_b128 v[60:63], v3 offset:24576
v_mfma_f32_16x16x32_bf16 a[164:167], v[104:107], v[40:43], a[164:167]
v_accvgpr_read_b32 v15, a30
v_mfma_f32_16x16x32_bf16 a[164:167], v[108:111], v[44:47], a[164:167]
v_lshlrev_b32 v18, 16, v141
v_mfma_f32_16x16x32_bf16 a[168:171], v[112:115], v[40:43], a[168:171]
v_and_b32 v19, 0xffff0000, v141
v_mul_f32 v14, v14, v18
v_mfma_f32_16x16x32_bf16 a[168:171], v[116:119], v[44:47], a[168:171]
v_mul_f32 v15, v15, v19
v_mfma_f32_16x16x32_bf16 a[172:175], v[120:123], v[40:43], a[172:175]
v_cvt_pk_bf16_f32 v25, v14, v15
v_accvgpr_read_b32 v12, a19
v_mfma_f32_16x16x32_bf16 a[172:175], v[124:127], v[44:47], a[172:175]
v_accvgpr_read_b32 v13, a23
s_waitcnt lgkmcnt(2)
v_mfma_f32_16x16x32_bf16 a[176:179], v[96:99], v[48:51], a[176:179]
ds_read_b128 v[40:43], v2 offset:26624
v_mfma_f32_16x16x32_bf16 a[176:179], v[100:103], v[52:55], a[176:179]
ds_read_b128 v[44:47], v3 offset:26624
v_mfma_f32_16x16x32_bf16 a[180:183], v[104:107], v[48:51], a[180:183]
v_lshlrev_b32 v16, 16, v142
v_mfma_f32_16x16x32_bf16 a[180:183], v[108:111], v[52:55], a[180:183]
v_and_b32 v17, 0xffff0000, v142
v_mul_f32 v12, v12, v16
v_mfma_f32_16x16x32_bf16 a[184:187], v[112:115], v[48:51], a[184:187]
v_mul_f32 v13, v13, v17
v_mfma_f32_16x16x32_bf16 a[184:187], v[116:119], v[52:55], a[184:187]
v_cvt_pk_bf16_f32 v26, v12, v13
v_accvgpr_read_b32 v14, a27
v_mfma_f32_16x16x32_bf16 a[188:191], v[120:123], v[48:51], a[188:191]
v_accvgpr_read_b32 v15, a31
v_mfma_f32_16x16x32_bf16 a[188:191], v[124:127], v[52:55], a[188:191]
v_lshlrev_b32 v18, 16, v143
v_and_b32 v19, 0xffff0000, v143
s_waitcnt lgkmcnt(2)
v_mfma_f32_16x16x32_bf16 a[192:195], v[96:99], v[56:59], a[192:195]
ds_read_b128 v[48:51], v2 offset:28672
v_mfma_f32_16x16x32_bf16 a[192:195], v[100:103], v[60:63], a[192:195]
ds_read_b128 v[52:55], v3 offset:28672
v_mfma_f32_16x16x32_bf16 a[196:199], v[104:107], v[56:59], a[196:199]
v_mul_f32 v14, v14, v18
v_mfma_f32_16x16x32_bf16 a[196:199], v[108:111], v[60:63], a[196:199]
v_mul_f32 v15, v15, v19
v_mfma_f32_16x16x32_bf16 a[200:203], v[112:115], v[56:59], a[200:203]
v_cvt_pk_bf16_f32 v27, v14, v15
ds_write_b128 v5, v[24:27] offset:2048
v_mfma_f32_16x16x32_bf16 a[200:203], v[116:119], v[60:63], a[200:203]
ds_read_b128 v[32:35], v6 offset:2048
v_mfma_f32_16x16x32_bf16 a[204:207], v[120:123], v[56:59], a[204:207]
ds_read_b128 v[36:39], v7 offset:3072
v_accvgpr_read_b32 v12, a32
v_mfma_f32_16x16x32_bf16 a[204:207], v[124:127], v[60:63], a[204:207]
v_accvgpr_read_b32 v13, a36
s_waitcnt lgkmcnt(5)
v_mfma_f32_16x16x32_bf16 a[208:211], v[96:99], v[40:43], a[208:211]
ds_read_b128 v[56:59], v2 offset:30720
v_mfma_f32_16x16x32_bf16 a[208:211], v[100:103], v[44:47], a[208:211]
ds_read_b128 v[60:63], v3 offset:30720
v_mfma_f32_16x16x32_bf16 a[212:215], v[104:107], v[40:43], a[212:215]
v_lshlrev_b32 v16, 16, v144
v_mfma_f32_16x16x32_bf16 a[212:215], v[108:111], v[44:47], a[212:215]
v_and_b32 v17, 0xffff0000, v144
v_mul_f32 v12, v12, v16
v_mfma_f32_16x16x32_bf16 a[216:219], v[112:115], v[40:43], a[216:219]
v_mul_f32 v13, v13, v17
v_mfma_f32_16x16x32_bf16 a[216:219], v[116:119], v[44:47], a[216:219]
v_cvt_pk_bf16_f32 v20, v12, v13
v_accvgpr_read_b32 v14, a40
v_mfma_f32_16x16x32_bf16 a[220:223], v[120:123], v[40:43], a[220:223]
v_accvgpr_read_b32 v15, a44
v_mfma_f32_16x16x32_bf16 a[220:223], v[124:127], v[44:47], a[220:223]
v_lshlrev_b32 v18, 16, v145
v_and_b32 v19, 0xffff0000, v145
s_waitcnt lgkmcnt(5)
v_mfma_f32_16x16x32_bf16 a[224:227], v[96:99], v[48:51], a[224:227]
ds_read_b128 v[40:43], v2 offset:32768
v_mfma_f32_16x16x32_bf16 a[224:227], v[100:103], v[52:55], a[224:227]
ds_read_b128 v[44:47], v3 offset:32768
v_mfma_f32_16x16x32_bf16 a[228:231], v[104:107], v[48:51], a[228:231]
v_mul_f32 v14, v14, v18
v_mfma_f32_16x16x32_bf16 a[228:231], v[108:111], v[52:55], a[228:231]
v_mul_f32 v15, v15, v19
v_mfma_f32_16x16x32_bf16 a[232:235], v[112:115], v[48:51], a[232:235]
v_cvt_pk_bf16_f32 v21, v14, v15
v_accvgpr_read_b32 v12, a33
v_mfma_f32_16x16x32_bf16 a[232:235], v[116:119], v[52:55], a[232:235]
v_accvgpr_read_b32 v13, a37
v_mfma_f32_16x16x32_bf16 a[236:239], v[120:123], v[48:51], a[236:239]
v_lshlrev_b32 v16, 16, v146
v_and_b32 v17, 0xffff0000, v146
v_mfma_f32_16x16x32_bf16 a[236:239], v[124:127], v[52:55], a[236:239]
v_mul_f32 v12, v12, v16
s_waitcnt lgkmcnt(2)
v_mfma_f32_16x16x32_bf16 a[240:243], v[96:99], v[56:59], a[240:243]
ds_read_b128 v[48:51], v2 offset:34816
buffer_load_dwordx4 v[96:99], v1, s[12:15], s33 offen offset:0 sc1
v_mfma_f32_16x16x32_bf16 a[240:243], v[100:103], v[60:63], a[240:243]
ds_read_b128 v[52:55], v3 offset:34816
v_mfma_f32_16x16x32_bf16 a[244:247], v[104:107], v[56:59], a[244:247]
v_mfma_f32_16x16x32_bf16 a[244:247], v[108:111], v[60:63], a[244:247]
buffer_load_dwordx4 v[100:103], v1, s[12:15], s33 offen offset:1024 sc1
v_mul_f32 v13, v13, v17
v_mfma_f32_16x16x32_bf16 a[248:251], v[112:115], v[56:59], a[248:251]
v_cvt_pk_bf16_f32 v22, v12, v13
v_mfma_f32_16x16x32_bf16 a[248:251], v[116:119], v[60:63], a[248:251]
v_accvgpr_read_b32 v14, a41
v_accvgpr_read_b32 v15, a45
v_mfma_f32_16x16x32_bf16 a[252:255], v[120:123], v[56:59], a[252:255]
buffer_load_dwordx4 v[104:107], v1, s[12:15], s33 offen offset:2048 sc1
v_mfma_f32_16x16x32_bf16 a[252:255], v[124:127], v[60:63], a[252:255]
v_lshlrev_b32 v18, 16, v147
s_waitcnt vmcnt(11) lgkmcnt(2)
v_mfma_f32_16x16x32_bf16 a[128:131], v[64:67], v[40:43], a[128:131]
ds_read_b128 v[56:59], v2 offset:36864
v_mfma_f32_16x16x32_bf16 a[128:131], v[68:71], v[44:47], a[128:131]
ds_read_b128 v[60:63], v3 offset:36864
buffer_load_dwordx4 v[108:111], v1, s[12:15], s33 offen offset:3072 sc1
s_waitcnt vmcnt(8)
v_mfma_f32_16x16x32_bf16 a[132:135], v[72:75], v[40:43], a[132:135]
v_mfma_f32_16x16x32_bf16 a[132:135], v[76:79], v[44:47], a[132:135]
v_and_b32 v19, 0xffff0000, v147
s_waitcnt vmcnt(6)
v_mfma_f32_16x16x32_bf16 a[136:139], v[80:83], v[40:43], a[136:139]
buffer_load_dwordx4 v[112:115], v1, s[12:15], s34 offen offset:0 sc1
v_mfma_f32_16x16x32_bf16 a[136:139], v[84:87], v[44:47], a[136:139]
v_mul_f32 v14, v14, v18
s_waitcnt vmcnt(5)
v_mfma_f32_16x16x32_bf16 a[140:143], v[88:91], v[40:43], a[140:143]
v_mfma_f32_16x16x32_bf16 a[140:143], v[92:95], v[44:47], a[140:143]
buffer_load_dwordx4 v[116:119], v1, s[12:15], s34 offen offset:1024 sc1
v_mul_f32 v15, v15, v19
s_waitcnt lgkmcnt(2)
v_mfma_f32_16x16x32_bf16 a[144:147], v[64:67], v[48:51], a[144:147]
ds_read_b128 v[40:43], v2 offset:38912
v_mfma_f32_16x16x32_bf16 a[144:147], v[68:71], v[52:55], a[144:147]
ds_read_b128 v[44:47], v3 offset:38912
v_mfma_f32_16x16x32_bf16 a[148:151], v[72:75], v[48:51], a[148:151]
buffer_load_dwordx4 v[120:123], v1, s[12:15], s34 offen offset:2048 sc1
v_mfma_f32_16x16x32_bf16 a[148:151], v[76:79], v[52:55], a[148:151]
v_cvt_pk_bf16_f32 v23, v14, v15
ds_write_b128 v4, v[20:23] offset:0
v_mfma_f32_16x16x32_bf16 a[152:155], v[80:83], v[48:51], a[152:155]
buffer_store_dwordx4 v[32:35], v9, s[16:19], s36 offen sc1
v_mfma_f32_16x16x32_bf16 a[152:155], v[84:87], v[52:55], a[152:155]
buffer_load_dwordx4 v[124:127], v1, s[12:15], s34 offen offset:3072 sc1
s_add_u32 s33, s33, 0x28000
s_add_u32 s34, s34, 0x28000
v_mfma_f32_16x16x32_bf16 a[156:159], v[88:91], v[48:51], a[156:159]
v_mfma_f32_16x16x32_bf16 a[156:159], v[92:95], v[52:55], a[156:159]
s_add_u32 s36, s36, 0x4000
s_waitcnt lgkmcnt(3)
v_mfma_f32_16x16x32_bf16 a[160:163], v[64:67], v[56:59], a[160:163]
ds_read_b128 v[48:51], v2 offset:40960
v_mfma_f32_16x16x32_bf16 a[160:163], v[68:71], v[60:63], a[160:163]
ds_read_b128 v[52:55], v3 offset:40960
v_mfma_f32_16x16x32_bf16 a[164:167], v[72:75], v[56:59], a[164:167]
buffer_store_dwordx4 v[36:39], v9, s[16:19], s36 offen sc1
s_add_u32 s36, s36, 0x4000
v_mfma_f32_16x16x32_bf16 a[164:167], v[76:79], v[60:63], a[164:167]
v_accvgpr_read_b32 v12, a34
v_mfma_f32_16x16x32_bf16 a[168:171], v[80:83], v[56:59], a[168:171]
v_accvgpr_read_b32 v13, a38
v_lshlrev_b32 v16, 16, v148
v_mfma_f32_16x16x32_bf16 a[168:171], v[84:87], v[60:63], a[168:171]
v_and_b32 v17, 0xffff0000, v148
v_mfma_f32_16x16x32_bf16 a[172:175], v[88:91], v[56:59], a[172:175]
v_mul_f32 v12, v12, v16
v_mfma_f32_16x16x32_bf16 a[172:175], v[92:95], v[60:63], a[172:175]
v_mul_f32 v13, v13, v17
v_cvt_pk_bf16_f32 v24, v12, v13
s_waitcnt lgkmcnt(3)
v_mfma_f32_16x16x32_bf16 a[176:179], v[64:67], v[40:43], a[176:179]
ds_read_b128 v[56:59], v2 offset:43008
v_mfma_f32_16x16x32_bf16 a[176:179], v[68:71], v[44:47], a[176:179]
ds_read_b128 v[60:63], v3 offset:43008
v_mfma_f32_16x16x32_bf16 a[180:183], v[72:75], v[40:43], a[180:183]
v_accvgpr_read_b32 v14, a42
v_mfma_f32_16x16x32_bf16 a[180:183], v[76:79], v[44:47], a[180:183]
v_accvgpr_read_b32 v15, a46
v_lshlrev_b32 v18, 16, v149
v_mfma_f32_16x16x32_bf16 a[184:187], v[80:83], v[40:43], a[184:187]
v_and_b32 v19, 0xffff0000, v149
v_mfma_f32_16x16x32_bf16 a[184:187], v[84:87], v[44:47], a[184:187]
v_mul_f32 v14, v14, v18
v_mfma_f32_16x16x32_bf16 a[188:191], v[88:91], v[40:43], a[188:191]
v_mul_f32 v15, v15, v19
v_cvt_pk_bf16_f32 v25, v14, v15
v_mfma_f32_16x16x32_bf16 a[188:191], v[92:95], v[44:47], a[188:191]
v_accvgpr_read_b32 v12, a35
s_waitcnt lgkmcnt(2)
v_mfma_f32_16x16x32_bf16 a[192:195], v[64:67], v[48:51], a[192:195]
ds_read_b128 v[40:43], v2 offset:45056
v_mfma_f32_16x16x32_bf16 a[192:195], v[68:71], v[52:55], a[192:195]
ds_read_b128 v[44:47], v3 offset:45056
v_mfma_f32_16x16x32_bf16 a[196:199], v[72:75], v[48:51], a[196:199]
v_accvgpr_read_b32 v13, a39
v_lshlrev_b32 v16, 16, v150
v_mfma_f32_16x16x32_bf16 a[196:199], v[76:79], v[52:55], a[196:199]
v_and_b32 v17, 0xffff0000, v150
v_mfma_f32_16x16x32_bf16 a[200:203], v[80:83], v[48:51], a[200:203]
v_mul_f32 v12, v12, v16
v_mfma_f32_16x16x32_bf16 a[200:203], v[84:87], v[52:55], a[200:203]
v_mul_f32 v13, v13, v17
v_cvt_pk_bf16_f32 v26, v12, v13
v_mfma_f32_16x16x32_bf16 a[204:207], v[88:91], v[48:51], a[204:207]
v_accvgpr_read_b32 v14, a43
v_mfma_f32_16x16x32_bf16 a[204:207], v[92:95], v[52:55], a[204:207]
v_accvgpr_read_b32 v15, a47
v_lshlrev_b32 v18, 16, v151
s_waitcnt lgkmcnt(2)
v_mfma_f32_16x16x32_bf16 a[208:211], v[64:67], v[56:59], a[208:211]
ds_read_b128 v[48:51], v2 offset:47104
v_mfma_f32_16x16x32_bf16 a[208:211], v[68:71], v[60:63], a[208:211]
ds_read_b128 v[52:55], v3 offset:47104
v_mfma_f32_16x16x32_bf16 a[212:215], v[72:75], v[56:59], a[212:215]
v_and_b32 v19, 0xffff0000, v151
v_mfma_f32_16x16x32_bf16 a[212:215], v[76:79], v[60:63], a[212:215]
v_mul_f32 v14, v14, v18
v_mfma_f32_16x16x32_bf16 a[216:219], v[80:83], v[56:59], a[216:219]
v_mul_f32 v15, v15, v19
v_cvt_pk_bf16_f32 v27, v14, v15
v_mfma_f32_16x16x32_bf16 a[216:219], v[84:87], v[60:63], a[216:219]
ds_write_b128 v5, v[24:27] offset:0
v_mfma_f32_16x16x32_bf16 a[220:223], v[88:91], v[56:59], a[220:223]
ds_read_b128 v[32:35], v6 offset:0
ds_read_b128 v[36:39], v7 offset:1024
v_mfma_f32_16x16x32_bf16 a[220:223], v[92:95], v[60:63], a[220:223]
v_accvgpr_read_b32 v12, a48
s_waitcnt lgkmcnt(5)
v_mfma_f32_16x16x32_bf16 a[224:227], v[64:67], v[40:43], a[224:227]
ds_read_b128 v[56:59], v2 offset:49152
v_mfma_f32_16x16x32_bf16 a[224:227], v[68:71], v[44:47], a[224:227]
ds_read_b128 v[60:63], v3 offset:49152
v_mfma_f32_16x16x32_bf16 a[228:231], v[72:75], v[40:43], a[228:231]
v_accvgpr_read_b32 v13, a52
v_lshlrev_b32 v16, 16, v152
v_mfma_f32_16x16x32_bf16 a[228:231], v[76:79], v[44:47], a[228:231]
v_and_b32 v17, 0xffff0000, v152
v_mfma_f32_16x16x32_bf16 a[232:235], v[80:83], v[40:43], a[232:235]
v_mul_f32 v12, v12, v16
v_mfma_f32_16x16x32_bf16 a[232:235], v[84:87], v[44:47], a[232:235]
v_mul_f32 v13, v13, v17
v_cvt_pk_bf16_f32 v20, v12, v13
v_mfma_f32_16x16x32_bf16 a[236:239], v[88:91], v[40:43], a[236:239]
v_accvgpr_read_b32 v14, a56
v_mfma_f32_16x16x32_bf16 a[236:239], v[92:95], v[44:47], a[236:239]
v_accvgpr_read_b32 v15, a60
v_lshlrev_b32 v18, 16, v153
s_waitcnt lgkmcnt(5)
v_mfma_f32_16x16x32_bf16 a[240:243], v[64:67], v[48:51], a[240:243]
ds_read_b128 v[40:43], v2 offset:51200
buffer_load_dwordx4 v[64:67], v1, s[12:15], s33 offen offset:0 sc1
v_mfma_f32_16x16x32_bf16 a[240:243], v[68:71], v[52:55], a[240:243]
ds_read_b128 v[44:47], v3 offset:51200
v_mfma_f32_16x16x32_bf16 a[244:247], v[72:75], v[48:51], a[244:247]
v_mfma_f32_16x16x32_bf16 a[244:247], v[76:79], v[52:55], a[244:247]
buffer_load_dwordx4 v[68:71], v1, s[12:15], s33 offen offset:1024 sc1
v_mfma_f32_16x16x32_bf16 a[248:251], v[80:83], v[48:51], a[248:251]
v_and_b32 v19, 0xffff0000, v153
v_mul_f32 v14, v14, v18
v_mfma_f32_16x16x32_bf16 a[248:251], v[84:87], v[52:55], a[248:251]
v_mul_f32 v15, v15, v19
v_mfma_f32_16x16x32_bf16 a[252:255], v[88:91], v[48:51], a[252:255]
buffer_load_dwordx4 v[72:75], v1, s[12:15], s33 offen offset:2048 sc1
v_cvt_pk_bf16_f32 v21, v14, v15
v_mfma_f32_16x16x32_bf16 a[252:255], v[92:95], v[52:55], a[252:255]
v_accvgpr_read_b32 v12, a49
s_waitcnt vmcnt(11) lgkmcnt(2)
v_mfma_f32_16x16x32_bf16 a[128:131], v[96:99], v[56:59], a[128:131]
ds_read_b128 v[48:51], v2 offset:53248
v_mfma_f32_16x16x32_bf16 a[128:131], v[100:103], v[60:63], a[128:131]
ds_read_b128 v[52:55], v3 offset:53248
buffer_load_dwordx4 v[76:79], v1, s[12:15], s33 offen offset:3072 sc1
s_waitcnt vmcnt(10)
v_mfma_f32_16x16x32_bf16 a[132:135], v[104:107], v[56:59], a[132:135]
v_mfma_f32_16x16x32_bf16 a[132:135], v[108:111], v[60:63], a[132:135]
v_accvgpr_read_b32 v13, a53
s_waitcnt vmcnt(8)
v_mfma_f32_16x16x32_bf16 a[136:139], v[112:115], v[56:59], a[136:139]
buffer_load_dwordx4 v[80:83], v1, s[12:15], s34 offen offset:0 sc1
v_mfma_f32_16x16x32_bf16 a[136:139], v[116:119], v[60:63], a[136:139]
v_lshlrev_b32 v16, 16, v154
s_waitcnt vmcnt(6)
v_mfma_f32_16x16x32_bf16 a[140:143], v[120:123], v[56:59], a[140:143]
v_mfma_f32_16x16x32_bf16 a[140:143], v[124:127], v[60:63], a[140:143]
buffer_load_dwordx4 v[84:87], v1, s[12:15], s34 offen offset:1024 sc1
v_and_b32 v17, 0xffff0000, v154
s_waitcnt lgkmcnt(2)
v_mfma_f32_16x16x32_bf16 a[144:147], v[96:99], v[40:43], a[144:147]
ds_read_b128 v[56:59], v2 offset:55296
v_mfma_f32_16x16x32_bf16 a[144:147], v[100:103], v[44:47], a[144:147]
ds_read_b128 v[60:63], v3 offset:55296
v_mfma_f32_16x16x32_bf16 a[148:151], v[104:107], v[40:43], a[148:151]
buffer_load_dwordx4 v[88:91], v1, s[12:15], s34 offen offset:2048 sc1
v_mfma_f32_16x16x32_bf16 a[148:151], v[108:111], v[44:47], a[148:151]
v_mul_f32 v12, v12, v16
v_mfma_f32_16x16x32_bf16 a[152:155], v[112:115], v[40:43], a[152:155]
v_mul_f32 v13, v13, v17
v_cvt_pk_bf16_f32 v22, v12, v13
v_mfma_f32_16x16x32_bf16 a[152:155], v[116:119], v[44:47], a[152:155]
buffer_load_dwordx4 v[92:95], v1, s[12:15], s34 offen offset:3072 sc1
s_add_u32 s33, s33, 0x8000
s_add_u32 s34, s34, 0x8000
v_mfma_f32_16x16x32_bf16 a[156:159], v[120:123], v[40:43], a[156:159]
v_mfma_f32_16x16x32_bf16 a[156:159], v[124:127], v[44:47], a[156:159]
v_accvgpr_read_b32 v14, a57
s_waitcnt lgkmcnt(2)
v_mfma_f32_16x16x32_bf16 a[160:163], v[96:99], v[48:51], a[160:163]
ds_read_b128 v[40:43], v2 offset:57344
v_mfma_f32_16x16x32_bf16 a[160:163], v[100:103], v[52:55], a[160:163]
ds_read_b128 v[44:47], v3 offset:57344
v_mfma_f32_16x16x32_bf16 a[164:167], v[104:107], v[48:51], a[164:167]
v_accvgpr_read_b32 v15, a61
v_mfma_f32_16x16x32_bf16 a[164:167], v[108:111], v[52:55], a[164:167]
v_lshlrev_b32 v18, 16, v155
v_and_b32 v19, 0xffff0000, v155
v_mfma_f32_16x16x32_bf16 a[168:171], v[112:115], v[48:51], a[168:171]
v_mul_f32 v14, v14, v18
v_mfma_f32_16x16x32_bf16 a[168:171], v[116:119], v[52:55], a[168:171]
v_mul_f32 v15, v15, v19
v_cvt_pk_bf16_f32 v23, v14, v15
v_mfma_f32_16x16x32_bf16 a[172:175], v[120:123], v[48:51], a[172:175]
ds_write_b128 v4, v[20:23] offset:2048
v_mfma_f32_16x16x32_bf16 a[172:175], v[124:127], v[52:55], a[172:175]
buffer_store_dwordx4 v[32:35], v9, s[16:19], s36 offen sc1
s_add_u32 s36, s36, 0x4000
s_waitcnt lgkmcnt(3)
v_mfma_f32_16x16x32_bf16 a[176:179], v[96:99], v[56:59], a[176:179]
ds_read_b128 v[48:51], v2 offset:59392
v_mfma_f32_16x16x32_bf16 a[176:179], v[100:103], v[60:63], a[176:179]
ds_read_b128 v[52:55], v3 offset:59392
v_mfma_f32_16x16x32_bf16 a[180:183], v[104:107], v[56:59], a[180:183]
buffer_store_dwordx4 v[36:39], v9, s[16:19], s36 offen sc1
v_mfma_f32_16x16x32_bf16 a[180:183], v[108:111], v[60:63], a[180:183]
s_add_u32 s36, s36, 0x4000
v_mfma_f32_16x16x32_bf16 a[184:187], v[112:115], v[56:59], a[184:187]
v_accvgpr_read_b32 v12, a50
v_accvgpr_read_b32 v13, a54
v_mfma_f32_16x16x32_bf16 a[184:187], v[116:119], v[60:63], a[184:187]
v_lshlrev_b32 v16, 16, v156
v_mfma_f32_16x16x32_bf16 a[188:191], v[120:123], v[56:59], a[188:191]
v_and_b32 v17, 0xffff0000, v156
v_mul_f32 v12, v12, v16
v_mfma_f32_16x16x32_bf16 a[188:191], v[124:127], v[60:63], a[188:191]
v_mul_f32 v13, v13, v17
s_waitcnt lgkmcnt(3)
v_mfma_f32_16x16x32_bf16 a[192:195], v[96:99], v[40:43], a[192:195]
ds_read_b128 v[56:59], v2 offset:61440
v_mfma_f32_16x16x32_bf16 a[192:195], v[100:103], v[44:47], a[192:195]
ds_read_b128 v[60:63], v3 offset:61440
v_mfma_f32_16x16x32_bf16 a[196:199], v[104:107], v[40:43], a[196:199]
v_cvt_pk_bf16_f32 v24, v12, v13
v_mfma_f32_16x16x32_bf16 a[196:199], v[108:111], v[44:47], a[196:199]
v_accvgpr_read_b32 v14, a58
v_accvgpr_read_b32 v15, a62
v_mfma_f32_16x16x32_bf16 a[200:203], v[112:115], v[40:43], a[200:203]
v_lshlrev_b32 v18, 16, v157
v_mfma_f32_16x16x32_bf16 a[200:203], v[116:119], v[44:47], a[200:203]
ds_read_b32 v28, v10 offset:5120
v_and_b32 v19, 0xffff0000, v157
v_mfma_f32_16x16x32_bf16 a[204:207], v[120:123], v[40:43], a[204:207]
v_mul_f32 v14, v14, v18
v_mfma_f32_16x16x32_bf16 a[204:207], v[124:127], v[44:47], a[204:207]
v_mul_f32 v15, v15, v19
v_cvt_pk_bf16_f32 v25, v14, v15
s_waitcnt lgkmcnt(3)
v_mfma_f32_16x16x32_bf16 a[208:211], v[96:99], v[48:51], a[208:211]
ds_read_b128 v[40:43], v2 offset:63488
v_mfma_f32_16x16x32_bf16 a[208:211], v[100:103], v[52:55], a[208:211]
ds_read_b128 v[44:47], v3 offset:63488
v_mfma_f32_16x16x32_bf16 a[212:215], v[104:107], v[48:51], a[212:215]
v_accvgpr_read_b32 v12, a51
v_mfma_f32_16x16x32_bf16 a[212:215], v[108:111], v[52:55], a[212:215]
v_accvgpr_read_b32 v13, a55
v_mfma_f32_16x16x32_bf16 a[216:219], v[112:115], v[48:51], a[216:219]
v_lshlrev_b32 v16, 16, v158
v_and_b32 v17, 0xffff0000, v158
v_mfma_f32_16x16x32_bf16 a[216:219], v[116:119], v[52:55], a[216:219]
v_mul_f32 v12, v12, v16
v_mfma_f32_16x16x32_bf16 a[220:223], v[120:123], v[48:51], a[220:223]
v_mul_f32 v13, v13, v17
v_cvt_pk_bf16_f32 v26, v12, v13
v_mfma_f32_16x16x32_bf16 a[220:223], v[124:127], v[52:55], a[220:223]
v_accvgpr_read_b32 v14, a59
s_waitcnt lgkmcnt(3)
v_mfma_f32_16x16x32_bf16 a[224:227], v[96:99], v[56:59], a[224:227]
v_accvgpr_read_b32 v15, a63
v_mfma_f32_16x16x32_bf16 a[224:227], v[100:103], v[60:63], a[224:227]
v_lshlrev_b32 v18, 16, v159
v_mfma_f32_16x16x32_bf16 a[228:231], v[104:107], v[56:59], a[228:231]
v_and_b32 v19, 0xffff0000, v159
v_mfma_f32_16x16x32_bf16 a[228:231], v[108:111], v[60:63], a[228:231]
v_mul_f32 v14, v14, v18
v_mul_f32 v15, v15, v19
v_mfma_f32_16x16x32_bf16 a[232:235], v[112:115], v[56:59], a[232:235]
v_cvt_pk_bf16_f32 v27, v14, v15
v_mfma_f32_16x16x32_bf16 a[232:235], v[116:119], v[60:63], a[232:235]
ds_write_b128 v5, v[24:27] offset:2048
ds_read_b128 v[32:35], v6 offset:2048
v_mfma_f32_16x16x32_bf16 a[236:239], v[120:123], v[56:59], a[236:239]
ds_read_b128 v[36:39], v7 offset:3072
v_mfma_f32_16x16x32_bf16 a[236:239], v[124:127], v[60:63], a[236:239]
v_accvgpr_read_b32 v12, a64
v_accvgpr_read_b32 v13, a68
s_waitcnt lgkmcnt(3)
v_xor_b32 v2, 0x10000, v2
v_xor_b32 v3, 0x10000, v3
v_mfma_f32_16x16x32_bf16 a[240:243], v[96:99], v[40:43], a[240:243]
ds_read_b128 v[48:51], v2 offset:0
buffer_load_dwordx4 v[96:99], v1, s[12:15], s33 offen offset:0 sc1
v_mfma_f32_16x16x32_bf16 a[240:243], v[100:103], v[44:47], a[240:243]
ds_read_b128 v[52:55], v3 offset:0
v_mfma_f32_16x16x32_bf16 a[244:247], v[104:107], v[40:43], a[244:247]
ds_read_b128 v[56:59], v2 offset:2048
v_mfma_f32_16x16x32_bf16 a[244:247], v[108:111], v[44:47], a[244:247]
ds_read_b128 v[60:63], v3 offset:2048
buffer_load_dwordx4 v[100:103], v1, s[12:15], s33 offen offset:1024 sc1
v_mfma_f32_16x16x32_bf16 a[248:251], v[112:115], v[40:43], a[248:251]
v_mfma_f32_16x16x32_bf16 a[248:251], v[116:119], v[44:47], a[248:251]
v_lshlrev_b32 v16, 16, v160
v_mfma_f32_16x16x32_bf16 a[252:255], v[120:123], v[40:43], a[252:255]
buffer_load_dwordx4 v[104:107], v1, s[12:15], s33 offen offset:2048 sc1
v_mfma_f32_16x16x32_bf16 a[252:255], v[124:127], v[44:47], a[252:255]
v_and_b32 v17, 0xffff0000, v160
v_mul_f32 v12, v12, v16
s_waitcnt vmcnt(11) lgkmcnt(2)
v_mfma_f32_16x16x32_bf16 a[128:131], v[64:67], v[48:51], a[128:131]
ds_read_b128 v[40:43], v2 offset:4096
v_mfma_f32_16x16x32_bf16 a[128:131], v[68:71], v[52:55], a[128:131]
ds_read_b128 v[44:47], v3 offset:4096
buffer_load_dwordx4 v[108:111], v1, s[12:15], s33 offen offset:3072 sc1
s_waitcnt vmcnt(10)
v_mfma_f32_16x16x32_bf16 a[132:135], v[72:75], v[48:51], a[132:135]
v_mfma_f32_16x16x32_bf16 a[132:135], v[76:79], v[52:55], a[132:135]
s_waitcnt vmcnt(8)
v_mfma_f32_16x16x32_bf16 a[136:139], v[80:83], v[48:51], a[136:139]
buffer_load_dwordx4 v[112:115], v1, s[12:15], s34 offen offset:0 sc1
v_mfma_f32_16x16x32_bf16 a[136:139], v[84:87], v[52:55], a[136:139]
v_mul_f32 v13, v13, v17
v_mfma_f32_16x16x4_4b_bf16 a[192:207], v[28:29], v[30:31], a[192:207]
v_cvt_pk_bf16_f32 v20, v12, v13
v_accvgpr_read_b32 v14, a72
v_accvgpr_read_b32 v15, a76
v_lshlrev_b32 v18, 16, v161
v_and_b32 v19, 0xffff0000, v161
v_mul_f32 v14, v14, v18
v_mul_f32 v15, v15, v19
v_cvt_pk_bf16_f32 v21, v14, v15
v_accvgpr_read_b32 v12, a65
v_accvgpr_read_b32 v13, a69
s_waitcnt vmcnt(7)
v_mfma_f32_16x16x32_bf16 a[140:143], v[88:91], v[48:51], a[140:143]
v_lshlrev_b32 v16, 16, v162
v_mfma_f32_16x16x32_bf16 a[140:143], v[92:95], v[52:55], a[140:143]
buffer_load_dwordx4 v[116:119], v1, s[12:15], s34 offen offset:1024 sc1
s_waitcnt lgkmcnt(2)
v_mfma_f32_16x16x32_bf16 a[144:147], v[64:67], v[56:59], a[144:147]
ds_read_b128 v[48:51], v2 offset:6144
v_mfma_f32_16x16x32_bf16 a[144:147], v[68:71], v[60:63], a[144:147]
ds_read_b128 v[52:55], v3 offset:6144
v_mfma_f32_16x16x32_bf16 a[148:151], v[72:75], v[56:59], a[148:151]
buffer_load_dwordx4 v[120:123], v1, s[12:15], s34 offen offset:2048 sc1
v_mfma_f32_16x16x32_bf16 a[148:151], v[76:79], v[60:63], a[148:151]
v_and_b32 v17, 0xffff0000, v162
v_mul_f32 v12, v12, v16
v_mfma_f32_16x16x32_bf16 a[152:155], v[80:83], v[56:59], a[152:155]
v_mul_f32 v13, v13, v17
v_mfma_f32_16x16x32_bf16 a[152:155], v[84:87], v[60:63], a[152:155]
buffer_load_dwordx4 v[124:127], v1, s[12:15], s34 offen offset:3072 sc1
s_add_u32 s33, s33, 0x8000
s_add_u32 s34, s34, 0x8000
v_mfma_f32_16x16x4_4b_bf16 a[208:223], v[28:29], v[30:31], a[208:223]
v_cvt_pk_bf16_f32 v22, v12, v13
v_accvgpr_read_b32 v14, a73
v_accvgpr_read_b32 v15, a77
v_lshlrev_b32 v18, 16, v163
v_and_b32 v19, 0xffff0000, v163
v_mul_f32 v14, v14, v18
v_mul_f32 v15, v15, v19
v_cvt_pk_bf16_f32 v23, v14, v15
ds_write_b128 v4, v[20:23] offset:0
v_mfma_f32_16x16x32_bf16 a[156:159], v[88:91], v[56:59], a[156:159]
buffer_store_dwordx4 v[32:35], v9, s[16:19], s36 offen sc1
v_mfma_f32_16x16x32_bf16 a[156:159], v[92:95], v[60:63], a[156:159]
s_add_u32 s36, s36, 0x4000
s_waitcnt lgkmcnt(3)
v_mfma_f32_16x16x32_bf16 a[160:163], v[64:67], v[40:43], a[160:163]
ds_read_b128 v[56:59], v2 offset:8192
v_mfma_f32_16x16x32_bf16 a[160:163], v[68:71], v[44:47], a[160:163]
ds_read_b128 v[60:63], v3 offset:8192
v_mfma_f32_16x16x32_bf16 a[164:167], v[72:75], v[40:43], a[164:167]
buffer_store_dwordx4 v[36:39], v9, s[16:19], s36 offen sc1
s_add_u32 s36, s36, 0x4000
v_mfma_f32_16x16x32_bf16 a[164:167], v[76:79], v[44:47], a[164:167]
v_accvgpr_read_b32 v12, a66
v_mfma_f32_16x16x32_bf16 a[168:171], v[80:83], v[40:43], a[168:171]
v_accvgpr_read_b32 v13, a70
v_lshlrev_b32 v16, 16, v164
v_mfma_f32_16x16x32_bf16 a[168:171], v[84:87], v[44:47], a[168:171]
v_and_b32 v17, 0xffff0000, v164
v_mfma_f32_16x16x4_4b_bf16 a[224:239], v[28:29], v[30:31], a[224:239]
v_mul_f32 v12, v12, v16
v_mul_f32 v13, v13, v17
v_cvt_pk_bf16_f32 v24, v12, v13
v_accvgpr_read_b32 v14, a74
v_accvgpr_read_b32 v15, a78
v_lshlrev_b32 v18, 16, v165
v_and_b32 v19, 0xffff0000, v165
v_mul_f32 v14, v14, v18
v_mul_f32 v15, v15, v19
v_cvt_pk_bf16_f32 v25, v14, v15
v_mfma_f32_16x16x32_bf16 a[172:175], v[88:91], v[40:43], a[172:175]
v_accvgpr_read_b32 v12, a67
v_mfma_f32_16x16x32_bf16 a[172:175], v[92:95], v[44:47], a[172:175]
v_accvgpr_read_b32 v13, a71
v_lshlrev_b32 v16, 16, v166
s_waitcnt lgkmcnt(3)
v_mfma_f32_16x16x32_bf16 a[176:179], v[64:67], v[48:51], a[176:179]
ds_read_b128 v[40:43], v2 offset:10240
v_mfma_f32_16x16x32_bf16 a[176:179], v[68:71], v[52:55], a[176:179]
ds_read_b128 v[44:47], v3 offset:10240
v_mfma_f32_16x16x32_bf16 a[180:183], v[72:75], v[48:51], a[180:183]
v_and_b32 v17, 0xffff0000, v166
v_mfma_f32_16x16x32_bf16 a[180:183], v[76:79], v[52:55], a[180:183]
v_mul_f32 v12, v12, v16
v_mul_f32 v13, v13, v17
v_mfma_f32_16x16x32_bf16 a[184:187], v[80:83], v[48:51], a[184:187]
v_cvt_pk_bf16_f32 v26, v12, v13
v_mfma_f32_16x16x32_bf16 a[184:187], v[84:87], v[52:55], a[184:187]
v_accvgpr_read_b32 v14, a75
v_accvgpr_read_b32 v15, a79
v_mfma_f32_16x16x4_4b_bf16 a[240:255], v[28:29], v[30:31], a[240:255]
v_lshlrev_b32 v18, 16, v167
v_and_b32 v19, 0xffff0000, v167
v_mul_f32 v14, v14, v18
v_mul_f32 v15, v15, v19
v_cvt_pk_bf16_f32 v27, v14, v15
ds_write_b128 v5, v[24:27] offset:0
ds_read_b128 v[32:35], v6 offset:0
ds_read_b128 v[36:39], v7 offset:1024
v_accvgpr_read_b32 v12, a80
v_accvgpr_read_b32 v13, a84
v_mfma_f32_16x16x32_bf16 a[188:191], v[88:91], v[48:51], a[188:191]
v_lshlrev_b32 v16, 16, v168
v_mfma_f32_16x16x32_bf16 a[188:191], v[92:95], v[52:55], a[188:191]
v_and_b32 v17, 0xffff0000, v168
s_waitcnt lgkmcnt(5)
v_mfma_f32_16x16x32_bf16 a[192:195], v[64:67], v[56:59], a[192:195]
ds_read_b128 v[48:51], v2 offset:12288
v_mfma_f32_16x16x32_bf16 a[192:195], v[68:71], v[60:63], a[192:195]
ds_read_b128 v[52:55], v3 offset:12288
v_mfma_f32_16x16x32_bf16 a[196:199], v[72:75], v[56:59], a[196:199]
v_mul_f32 v12, v12, v16
v_mul_f32 v13, v13, v17
v_mfma_f32_16x16x32_bf16 a[196:199], v[76:79], v[60:63], a[196:199]
v_cvt_pk_bf16_f32 v20, v12, v13
v_mfma_f32_16x16x32_bf16 a[200:203], v[80:83], v[56:59], a[200:203]
v_accvgpr_read_b32 v14, a88
v_accvgpr_read_b32 v15, a92
v_mfma_f32_16x16x32_bf16 a[200:203], v[84:87], v[60:63], a[200:203]
v_lshlrev_b32 v18, 16, v169
v_mfma_f32_16x16x4_4b_bf16 a[128:143], v[28:29], v[30:31], a[128:143]
v_and_b32 v19, 0xffff0000, v169
v_mul_f32 v14, v14, v18
v_mul_f32 v15, v15, v19
v_cvt_pk_bf16_f32 v21, v14, v15
v_accvgpr_read_b32 v12, a81
v_accvgpr_read_b32 v13, a85
v_lshlrev_b32 v16, 16, v170
v_and_b32 v17, 0xffff0000, v170
v_mul_f32 v12, v12, v16
v_mul_f32 v13, v13, v17
v_mfma_f32_16x16x32_bf16 a[204:207], v[88:91], v[56:59], a[204:207]
v_cvt_pk_bf16_f32 v22, v12, v13
v_mfma_f32_16x16x32_bf16 a[204:207], v[92:95], v[60:63], a[204:207]
v_accvgpr_read_b32 v14, a89
v_accvgpr_read_b32 v15, a93
s_waitcnt lgkmcnt(5)
v_mfma_f32_16x16x32_bf16 a[208:211], v[64:67], v[40:43], a[208:211]
ds_read_b128 v[56:59], v2 offset:14336
v_mfma_f32_16x16x32_bf16 a[208:211], v[68:71], v[44:47], a[208:211]
ds_read_b128 v[60:63], v3 offset:14336
v_mfma_f32_16x16x32_bf16 a[212:215], v[72:75], v[40:43], a[212:215]
v_lshlrev_b32 v18, 16, v171
v_mfma_f32_16x16x32_bf16 a[212:215], v[76:79], v[44:47], a[212:215]
v_and_b32 v19, 0xffff0000, v171
v_mul_f32 v14, v14, v18
v_mfma_f32_16x16x32_bf16 a[216:219], v[80:83], v[40:43], a[216:219]
v_mul_f32 v15, v15, v19
v_mfma_f32_16x16x32_bf16 a[216:219], v[84:87], v[44:47], a[216:219]
v_cvt_pk_bf16_f32 v23, v14, v15
ds_write_b128 v4, v[20:23] offset:2048
v_mfma_f32_16x16x4_4b_bf16 a[144:159], v[28:29], v[30:31], a[144:159]
s_waitcnt lgkmcnt(5)
buffer_store_dwordx4 v[32:35], v9, s[16:19], s36 offen sc1
s_add_u32 s36, s36, 0x4000
buffer_store_dwordx4 v[36:39], v9, s[16:19], s36 offen sc1
s_add_u32 s36, s36, 0x4000
v_accvgpr_read_b32 v12, a82
v_accvgpr_read_b32 v13, a86
v_lshlrev_b32 v16, 16, v172
v_and_b32 v17, 0xffff0000, v172
v_mul_f32 v12, v12, v16
v_mul_f32 v13, v13, v17
v_mfma_f32_16x16x32_bf16 a[220:223], v[88:91], v[40:43], a[220:223]
v_cvt_pk_bf16_f32 v24, v12, v13
v_mfma_f32_16x16x32_bf16 a[220:223], v[92:95], v[44:47], a[220:223]
v_accvgpr_read_b32 v14, a90
s_waitcnt lgkmcnt(3)
v_mfma_f32_16x16x32_bf16 a[224:227], v[64:67], v[48:51], a[224:227]
ds_read_b128 v[40:43], v2 offset:16384
v_mfma_f32_16x16x32_bf16 a[224:227], v[68:71], v[52:55], a[224:227]
ds_read_b128 v[44:47], v3 offset:16384
v_mfma_f32_16x16x32_bf16 a[228:231], v[72:75], v[48:51], a[228:231]
v_accvgpr_read_b32 v15, a94
v_lshlrev_b32 v18, 16, v173
v_mfma_f32_16x16x32_bf16 a[228:231], v[76:79], v[52:55], a[228:231]
v_and_b32 v19, 0xffff0000, v173
v_mfma_f32_16x16x32_bf16 a[232:235], v[80:83], v[48:51], a[232:235]
v_mul_f32 v14, v14, v18
v_mul_f32 v15, v15, v19
v_mfma_f32_16x16x32_bf16 a[232:235], v[84:87], v[52:55], a[232:235]
v_cvt_pk_bf16_f32 v25, v14, v15
v_mfma_f32_16x16x4_4b_bf16 a[160:175], v[28:29], v[30:31], a[160:175]
v_accvgpr_read_b32 v12, a83
v_accvgpr_read_b32 v13, a87
v_lshlrev_b32 v16, 16, v174
v_and_b32 v17, 0xffff0000, v174
v_mul_f32 v12, v12, v16
v_mul_f32 v13, v13, v17
v_cvt_pk_bf16_f32 v26, v12, v13
v_accvgpr_read_b32 v14, a91
v_accvgpr_read_b32 v15, a95
v_lshlrev_b32 v18, 16, v175
v_mfma_f32_16x16x32_bf16 a[236:239], v[88:91], v[48:51], a[236:239]
v_and_b32 v19, 0xffff0000, v175
v_mfma_f32_16x16x32_bf16 a[236:239], v[92:95], v[52:55], a[236:239]
v_mul_f32 v14, v14, v18
v_mul_f32 v15, v15, v19
s_waitcnt lgkmcnt(3)
v_mfma_f32_16x16x32_bf16 a[240:243], v[64:67], v[56:59], a[240:243]
ds_read_b128 v[48:51], v2 offset:18432
buffer_load_dwordx4 v[64:67], v1, s[12:15], s33 offen offset:0 sc1
v_mfma_f32_16x16x32_bf16 a[240:243], v[68:71], v[60:63], a[240:243]
ds_read_b128 v[52:55], v3 offset:18432
v_mfma_f32_16x16x32_bf16 a[244:247], v[72:75], v[56:59], a[244:247]
v_mfma_f32_16x16x32_bf16 a[244:247], v[76:79], v[60:63], a[244:247]
buffer_load_dwordx4 v[68:71], v1, s[12:15], s33 offen offset:1024 sc1
v_cvt_pk_bf16_f32 v27, v14, v15
v_mfma_f32_16x16x32_bf16 a[248:251], v[80:83], v[56:59], a[248:251]
ds_write_b128 v5, v[24:27] offset:2048
v_mfma_f32_16x16x32_bf16 a[248:251], v[84:87], v[60:63], a[248:251]
ds_read_b128 v[32:35], v6 offset:2048
ds_read_b128 v[36:39], v7 offset:3072
v_mfma_f32_16x16x4_4b_bf16 a[176:191], v[28:29], v[30:31], a[176:191]
v_accvgpr_read_b32 v12, a96
v_accvgpr_read_b32 v13, a100
v_lshlrev_b32 v16, 16, v176
v_and_b32 v17, 0xffff0000, v176
v_mul_f32 v12, v12, v16
v_mul_f32 v13, v13, v17
v_cvt_pk_bf16_f32 v20, v12, v13
v_accvgpr_read_b32 v14, a104
v_accvgpr_read_b32 v15, a108
v_lshlrev_b32 v18, 16, v177
v_mfma_f32_16x16x32_bf16 a[252:255], v[88:91], v[56:59], a[252:255]
buffer_load_dwordx4 v[72:75], v1, s[12:15], s33 offen offset:2048 sc1
v_mfma_f32_16x16x32_bf16 a[252:255], v[92:95], v[60:63], a[252:255]
v_and_b32 v19, 0xffff0000, v177
s_waitcnt vmcnt(13) lgkmcnt(5)
v_mfma_f32_16x16x32_bf16 a[128:131], v[96:99], v[40:43], a[128:131]
ds_read_b128 v[56:59], v2 offset:20480
v_mfma_f32_16x16x32_bf16 a[128:131], v[100:103], v[44:47], a[128:131]
ds_read_b128 v[60:63], v3 offset:20480
buffer_load_dwordx4 v[76:79], v1, s[12:15], s33 offen offset:3072 sc1
s_waitcnt vmcnt(12)
v_mfma_f32_16x16x32_bf16 a[132:135], v[104:107], v[40:43], a[132:135]
v_mfma_f32_16x16x32_bf16 a[132:135], v[108:111], v[44:47], a[132:135]
v_mul_f32 v14, v14, v18
s_waitcnt vmcnt(10)
v_mfma_f32_16x16x32_bf16 a[136:139], v[112:115], v[40:43], a[136:139]
buffer_load_dwordx4 v[80:83], v1, s[12:15], s34 offen offset:0 sc1
v_mfma_f32_16x16x32_bf16 a[136:139], v[116:119], v[44:47], a[136:139]
v_mul_f32 v15, v15, v19
s_waitcnt vmcnt(9)
v_mfma_f32_16x16x32_bf16 a[140:143], v[120:123], v[40:43], a[140:143]
v_mfma_f32_16x16x32_bf16 a[140:143], v[124:127], v[44:47], a[140:143]
buffer_load_dwordx4 v[84:87], v1, s[12:15], s34 offen offset:1024 sc1
v_cvt_pk_bf16_f32 v21, v14, v15
s_waitcnt lgkmcnt(5)
v_mfma_f32_16x16x32_bf16 a[144:147], v[96:99], v[48:51], a[144:147]
ds_read_b128 v[40:43], v2 offset:22528
v_mfma_f32_16x16x32_bf16 a[144:147], v[100:103], v[52:55], a[144:147]
ds_read_b128 v[44:47], v3 offset:22528
v_mfma_f32_16x16x32_bf16 a[148:151], v[104:107], v[48:51], a[148:151]
buffer_load_dwordx4 v[88:91], v1, s[12:15], s34 offen offset:2048 sc1
v_mfma_f32_16x16x32_bf16 a[148:151], v[108:111], v[52:55], a[148:151]
v_accvgpr_read_b32 v12, a97
v_accvgpr_read_b32 v13, a101
v_mfma_f32_16x16x32_bf16 a[152:155], v[112:115], v[48:51], a[152:155]
v_lshlrev_b32 v16, 16, v178
v_mfma_f32_16x16x32_bf16 a[152:155], v[116:119], v[52:55], a[152:155]
buffer_load_dwordx4 v[92:95], v1, s[12:15], s34 offen offset:3072 sc1
s_add_u32 s33, s33, 0x8000
s_add_u32 s34, s34, 0x8000
v_mfma_f32_16x16x32_bf16 a[156:159], v[120:123], v[48:51], a[156:159]
v_mfma_f32_16x16x32_bf16 a[156:159], v[124:127], v[52:55], a[156:159]
v_and_b32 v17, 0xffff0000, v178
s_waitcnt lgkmcnt(2)
v_mfma_f32_16x16x32_bf16 a[160:163], v[96:99], v[56:59], a[160:163]
ds_read_b128 v[48:51], v2 offset:24576
v_mfma_f32_16x16x32_bf16 a[160:163], v[100:103], v[60:63], a[160:163]
ds_read_b128 v[52:55], v3 offset:24576
v_mfma_f32_16x16x32_bf16 a[164:167], v[104:107], v[56:59], a[164:167]
v_mul_f32 v12, v12, v16
v_mul_f32 v13, v13, v17
v_mfma_f32_16x16x32_bf16 a[164:167], v[108:111], v[60:63], a[164:167]
v_cvt_pk_bf16_f32 v22, v12, v13
v_mfma_f32_16x16x32_bf16 a[168:171], v[112:115], v[56:59], a[168:171]
v_accvgpr_read_b32 v14, a105
v_accvgpr_read_b32 v15, a109
v_mfma_f32_16x16x32_bf16 a[168:171], v[116:119], v[60:63], a[168:171]
v_lshlrev_b32 v18, 16, v179
v_mfma_f32_16x16x32_bf16 a[172:175], v[120:123], v[56:59], a[172:175]
v_and_b32 v19, 0xffff0000, v179
v_mul_f32 v14, v14, v18
v_mfma_f32_16x16x32_bf16 a[172:175], v[124:127], v[60:63], a[172:175]
v_mul_f32 v15, v15, v19
s_waitcnt lgkmcnt(2)
v_mfma_f32_16x16x32_bf16 a[176:179], v[96:99], v[40:43], a[176:179]
ds_read_b128 v[56:59], v2 offset:26624
v_mfma_f32_16x16x32_bf16 a[176:179], v[100:103], v[44:47], a[176:179]
ds_read_b128 v[60:63], v3 offset:26624
v_mfma_f32_16x16x32_bf16 a[180:183], v[104:107], v[40:43], a[180:183]
v_cvt_pk_bf16_f32 v23, v14, v15
v_mfma_f32_16x16x32_bf16 a[180:183], v[108:111], v[44:47], a[180:183]
ds_write_b128 v4, v[20:23] offset:0
buffer_store_dwordx4 v[32:35], v9, s[16:19], s36 offen sc1
v_mfma_f32_16x16x32_bf16 a[184:187], v[112:115], v[40:43], a[184:187]
s_add_u32 s36, s36, 0x4000
v_mfma_f32_16x16x32_bf16 a[184:187], v[116:119], v[44:47], a[184:187]
buffer_store_dwordx4 v[36:39], v9, s[16:19], s36 offen sc1
s_add_u32 s36, s36, 0x4000
v_mfma_f32_16x16x32_bf16 a[188:191], v[120:123], v[40:43], a[188:191]
v_accvgpr_read_b32 v12, a98
v_mfma_f32_16x16x32_bf16 a[188:191], v[124:127], v[44:47], a[188:191]
v_accvgpr_read_b32 v13, a102
v_lshlrev_b32 v16, 16, v180
s_waitcnt lgkmcnt(3)
v_mfma_f32_16x16x32_bf16 a[192:195], v[96:99], v[48:51], a[192:195]
ds_read_b128 v[40:43], v2 offset:28672
v_mfma_f32_16x16x32_bf16 a[192:195], v[100:103], v[52:55], a[192:195]
ds_read_b128 v[44:47], v3 offset:28672
v_mfma_f32_16x16x32_bf16 a[196:199], v[104:107], v[48:51], a[196:199]
v_and_b32 v17, 0xffff0000, v180
v_mfma_f32_16x16x32_bf16 a[196:199], v[108:111], v[52:55], a[196:199]
v_mul_f32 v12, v12, v16
v_mfma_f32_16x16x32_bf16 a[200:203], v[112:115], v[48:51], a[200:203]
v_mul_f32 v13, v13, v17
v_cvt_pk_bf16_f32 v24, v12, v13
v_mfma_f32_16x16x32_bf16 a[200:203], v[116:119], v[52:55], a[200:203]
v_accvgpr_read_b32 v14, a106
v_mfma_f32_16x16x32_bf16 a[204:207], v[120:123], v[48:51], a[204:207]
v_accvgpr_read_b32 v15, a110
v_lshlrev_b32 v18, 16, v181
v_mfma_f32_16x16x32_bf16 a[204:207], v[124:127], v[52:55], a[204:207]
v_and_b32 v19, 0xffff0000, v181
s_waitcnt lgkmcnt(3)
v_mfma_f32_16x16x32_bf16 a[208:211], v[96:99], v[56:59], a[208:211]
ds_read_b128 v[48:51], v2 offset:30720
v_mfma_f32_16x16x32_bf16 a[208:211], v[100:103], v[60:63], a[208:211]
ds_read_b128 v[52:55], v3 offset:30720
v_mfma_f32_16x16x32_bf16 a[212:215], v[104:107], v[56:59], a[212:215]
v_mul_f32 v14, v14, v18
v_mfma_f32_16x16x32_bf16 a[212:215], v[108:111], v[60:63], a[212:215]
v_mul_f32 v15, v15, v19
v_cvt_pk_bf16_f32 v25, v14, v15
v_mfma_f32_16x16x32_bf16 a[216:219], v[112:115], v[56:59], a[216:219]
v_accvgpr_read_b32 v12, a99
v_mfma_f32_16x16x32_bf16 a[216:219], v[116:119], v[60:63], a[216:219]
v_accvgpr_read_b32 v13, a103
v_lshlrev_b32 v16, 16, v182
v_mfma_f32_16x16x32_bf16 a[220:223], v[120:123], v[56:59], a[220:223]
v_and_b32 v17, 0xffff0000, v182
v_mfma_f32_16x16x32_bf16 a[220:223], v[124:127], v[60:63], a[220:223]
v_mul_f32 v12, v12, v16
v_mul_f32 v13, v13, v17
s_waitcnt lgkmcnt(2)
v_mfma_f32_16x16x32_bf16 a[224:227], v[96:99], v[40:43], a[224:227]
ds_read_b128 v[56:59], v2 offset:32768
v_mfma_f32_16x16x32_bf16 a[224:227], v[100:103], v[44:47], a[224:227]
ds_read_b128 v[60:63], v3 offset:32768
v_mfma_f32_16x16x32_bf16 a[228:231], v[104:107], v[40:43], a[228:231]
v_cvt_pk_bf16_f32 v26, v12, v13
v_mfma_f32_16x16x32_bf16 a[228:231], v[108:111], v[44:47], a[228:231]
v_accvgpr_read_b32 v14, a107
v_mfma_f32_16x16x32_bf16 a[232:235], v[112:115], v[40:43], a[232:235]
v_accvgpr_read_b32 v15, a111
v_lshlrev_b32 v18, 16, v183
v_mfma_f32_16x16x32_bf16 a[232:235], v[116:119], v[44:47], a[232:235]
v_and_b32 v19, 0xffff0000, v183
v_mfma_f32_16x16x32_bf16 a[236:239], v[120:123], v[40:43], a[236:239]
v_mul_f32 v14, v14, v18
v_mul_f32 v15, v15, v19
v_mfma_f32_16x16x32_bf16 a[236:239], v[124:127], v[44:47], a[236:239]
v_cvt_pk_bf16_f32 v27, v14, v15
s_waitcnt lgkmcnt(2)
v_mfma_f32_16x16x32_bf16 a[240:243], v[96:99], v[48:51], a[240:243]
ds_read_b128 v[40:43], v2 offset:34816
buffer_load_dwordx4 v[96:99], v1, s[12:15], s33 offen offset:0 sc1
v_mfma_f32_16x16x32_bf16 a[240:243], v[100:103], v[52:55], a[240:243]
ds_read_b128 v[44:47], v3 offset:34816
v_mfma_f32_16x16x32_bf16 a[244:247], v[104:107], v[48:51], a[244:247]
ds_write_b128 v5, v[24:27] offset:0
v_mfma_f32_16x16x32_bf16 a[244:247], v[108:111], v[52:55], a[244:247]
buffer_load_dwordx4 v[100:103], v1, s[12:15], s33 offen offset:1024 sc1
v_mfma_f32_16x16x32_bf16 a[248:251], v[112:115], v[48:51], a[248:251]
ds_read_b128 v[32:35], v6 offset:0
v_mfma_f32_16x16x32_bf16 a[248:251], v[116:119], v[52:55], a[248:251]
ds_read_b128 v[36:39], v7 offset:1024
v_accvgpr_read_b32 v12, a112
v_mfma_f32_16x16x32_bf16 a[252:255], v[120:123], v[48:51], a[252:255]
buffer_load_dwordx4 v[104:107], v1, s[12:15], s33 offen offset:2048 sc1
v_mfma_f32_16x16x32_bf16 a[252:255], v[124:127], v[52:55], a[252:255]
v_accvgpr_read_b32 v13, a116
v_lshlrev_b32 v16, 16, v184
s_waitcnt vmcnt(11) lgkmcnt(5)
v_mfma_f32_16x16x32_bf16 a[128:131], v[64:67], v[56:59], a[128:131]
ds_read_b128 v[48:51], v2 offset:36864
v_mfma_f32_16x16x32_bf16 a[128:131], v[68:71], v[60:63], a[128:131]
ds_read_b128 v[52:55], v3 offset:36864
buffer_load_dwordx4 v[108:111], v1, s[12:15], s33 offen offset:3072 sc1
s_waitcnt vmcnt(10)
v_mfma_f32_16x16x32_bf16 a[132:135], v[72:75], v[56:59], a[132:135]
v_mfma_f32_16x16x32_bf16 a[132:135], v[76:79], v[60:63], a[132:135]
v_and_b32 v17, 0xffff0000, v184
s_waitcnt vmcnt(8)
v_mfma_f32_16x16x32_bf16 a[136:139], v[80:83], v[56:59], a[136:139]
buffer_load_dwordx4 v[112:115], v1, s[12:15], s34 offen offset:0 sc1
v_mfma_f32_16x16x32_bf16 a[136:139], v[84:87], v[60:63], a[136:139]
s_waitcnt vmcnt(7)
v_mfma_f32_16x16x32_bf16 a[140:143], v[88:91], v[56:59], a[140:143]
v_mul_f32 v12, v12, v16
v_mfma_f32_16x16x32_bf16 a[140:143], v[92:95], v[60:63], a[140:143]
buffer_load_dwordx4 v[116:119], v1, s[12:15], s34 offen offset:1024 sc1
s_waitcnt lgkmcnt(5)
v_mfma_f32_16x16x32_bf16 a[144:147], v[64:67], v[40:43], a[144:147]
ds_read_b128 v[56:59], v2 offset:38912
v_mfma_f32_16x16x32_bf16 a[144:147], v[68:71], v[44:47], a[144:147]
ds_read_b128 v[60:63], v3 offset:38912
v_mfma_f32_16x16x32_bf16 a[148:151], v[72:75], v[40:43], a[148:151]
buffer_load_dwordx4 v[120:123], v1, s[12:15], s34 offen offset:2048 sc1
v_mul_f32 v13, v13, v17
v_mfma_f32_16x16x32_bf16 a[148:151], v[76:79], v[44:47], a[148:151]
v_cvt_pk_bf16_f32 v20, v12, v13
v_mfma_f32_16x16x32_bf16 a[152:155], v[80:83], v[40:43], a[152:155]
v_accvgpr_read_b32 v14, a120
v_accvgpr_read_b32 v15, a124
v_mfma_f32_16x16x32_bf16 a[152:155], v[84:87], v[44:47], a[152:155]
buffer_load_dwordx4 v[124:127], v1, s[12:15], s34 offen offset:3072 sc1
s_add_u32 s33, s33, 0x88000
s_add_u32 s34, s34, 0x88000
v_mfma_f32_16x16x32_bf16 a[156:159], v[88:91], v[40:43], a[156:159]
v_mfma_f32_16x16x32_bf16 a[156:159], v[92:95], v[44:47], a[156:159]
v_lshlrev_b32 v18, 16, v185
s_waitcnt lgkmcnt(2)
v_mfma_f32_16x16x32_bf16 a[160:163], v[64:67], v[48:51], a[160:163]
ds_read_b128 v[40:43], v2 offset:40960
v_mfma_f32_16x16x32_bf16 a[160:163], v[68:71], v[52:55], a[160:163]
ds_read_b128 v[44:47], v3 offset:40960
v_mfma_f32_16x16x32_bf16 a[164:167], v[72:75], v[48:51], a[164:167]
v_and_b32 v19, 0xffff0000, v185
v_mfma_f32_16x16x32_bf16 a[164:167], v[76:79], v[52:55], a[164:167]
v_mul_f32 v14, v14, v18
v_mul_f32 v15, v15, v19
v_mfma_f32_16x16x32_bf16 a[168:171], v[80:83], v[48:51], a[168:171]
v_cvt_pk_bf16_f32 v21, v14, v15
v_mfma_f32_16x16x32_bf16 a[168:171], v[84:87], v[52:55], a[168:171]
v_accvgpr_read_b32 v12, a113
v_accvgpr_read_b32 v13, a117
v_mfma_f32_16x16x32_bf16 a[172:175], v[88:91], v[48:51], a[172:175]
v_lshlrev_b32 v16, 16, v186
v_mfma_f32_16x16x32_bf16 a[172:175], v[92:95], v[52:55], a[172:175]
v_and_b32 v17, 0xffff0000, v186
v_mul_f32 v12, v12, v16
s_waitcnt lgkmcnt(2)
v_mfma_f32_16x16x32_bf16 a[176:179], v[64:67], v[56:59], a[176:179]
ds_read_b128 v[48:51], v2 offset:43008
v_mfma_f32_16x16x32_bf16 a[176:179], v[68:71], v[60:63], a[176:179]
ds_read_b128 v[52:55], v3 offset:43008
v_mfma_f32_16x16x32_bf16 a[180:183], v[72:75], v[56:59], a[180:183]
v_mul_f32 v13, v13, v17
v_mfma_f32_16x16x32_bf16 a[180:183], v[76:79], v[60:63], a[180:183]
v_cvt_pk_bf16_f32 v22, v12, v13
v_mfma_f32_16x16x32_bf16 a[184:187], v[80:83], v[56:59], a[184:187]
v_accvgpr_read_b32 v14, a121
v_accvgpr_read_b32 v15, a125
v_mfma_f32_16x16x32_bf16 a[184:187], v[84:87], v[60:63], a[184:187]
v_lshlrev_b32 v18, 16, v187
v_mfma_f32_16x16x32_bf16 a[188:191], v[88:91], v[56:59], a[188:191]
v_and_b32 v19, 0xffff0000, v187
v_mul_f32 v14, v14, v18
v_mfma_f32_16x16x32_bf16 a[188:191], v[92:95], v[60:63], a[188:191]
v_mul_f32 v15, v15, v19
s_waitcnt lgkmcnt(2)
v_mfma_f32_16x16x32_bf16 a[192:195], v[64:67], v[40:43], a[192:195]
ds_read_b128 v[56:59], v2 offset:45056
v_mfma_f32_16x16x32_bf16 a[192:195], v[68:71], v[44:47], a[192:195]
ds_read_b128 v[60:63], v3 offset:45056
v_mfma_f32_16x16x32_bf16 a[196:199], v[72:75], v[40:43], a[196:199]
v_cvt_pk_bf16_f32 v23, v14, v15
ds_write_b128 v4, v[20:23] offset:2048
v_mfma_f32_16x16x32_bf16 a[196:199], v[76:79], v[44:47], a[196:199]
buffer_store_dwordx4 v[32:35], v9, s[16:19], s36 offen sc1
v_mfma_f32_16x16x32_bf16 a[200:203], v[80:83], v[40:43], a[200:203]
s_add_u32 s36, s36, 0x4000
buffer_store_dwordx4 v[36:39], v9, s[16:19], s36 offen sc1
v_mfma_f32_16x16x32_bf16 a[200:203], v[84:87], v[44:47], a[200:203]
s_add_u32 s36, s36, 0x4000
v_mfma_f32_16x16x32_bf16 a[204:207], v[88:91], v[40:43], a[204:207]
v_accvgpr_read_b32 v12, a114
v_accvgpr_read_b32 v13, a118
v_mfma_f32_16x16x32_bf16 a[204:207], v[92:95], v[44:47], a[204:207]
v_lshlrev_b32 v16, 16, v188
s_waitcnt lgkmcnt(3)
v_mfma_f32_16x16x32_bf16 a[208:211], v[64:67], v[48:51], a[208:211]
ds_read_b128 v[40:43], v2 offset:47104
v_mfma_f32_16x16x32_bf16 a[208:211], v[68:71], v[52:55], a[208:211]
ds_read_b128 v[44:47], v3 offset:47104
v_mfma_f32_16x16x32_bf16 a[212:215], v[72:75], v[48:51], a[212:215]
v_and_b32 v17, 0xffff0000, v188
v_mfma_f32_16x16x32_bf16 a[212:215], v[76:79], v[52:55], a[212:215]
v_mul_f32 v12, v12, v16
v_mul_f32 v13, v13, v17
v_mfma_f32_16x16x32_bf16 a[216:219], v[80:83], v[48:51], a[216:219]
v_cvt_pk_bf16_f32 v24, v12, v13
v_mfma_f32_16x16x32_bf16 a[216:219], v[84:87], v[52:55], a[216:219]
v_accvgpr_read_b32 v14, a122
v_accvgpr_read_b32 v15, a126
v_mfma_f32_16x16x32_bf16 a[220:223], v[88:91], v[48:51], a[220:223]
v_lshlrev_b32 v18, 16, v189
v_mfma_f32_16x16x32_bf16 a[220:223], v[92:95], v[52:55], a[220:223]
v_and_b32 v19, 0xffff0000, v189
v_mul_f32 v14, v14, v18
s_waitcnt lgkmcnt(3)
v_mfma_f32_16x16x32_bf16 a[224:227], v[64:67], v[56:59], a[224:227]
ds_read_b128 v[48:51], v2 offset:49152
v_mfma_f32_16x16x32_bf16 a[224:227], v[68:71], v[60:63], a[224:227]
ds_read_b128 v[52:55], v3 offset:49152
v_mfma_f32_16x16x32_bf16 a[228:231], v[72:75], v[56:59], a[228:231]
v_mul_f32 v15, v15, v19
v_mfma_f32_16x16x32_bf16 a[228:231], v[76:79], v[60:63], a[228:231]
v_cvt_pk_bf16_f32 v25, v14, v15
v_accvgpr_read_b32 v12, a115
v_mfma_f32_16x16x32_bf16 a[232:235], v[80:83], v[56:59], a[232:235]
v_accvgpr_read_b32 v13, a119
v_mfma_f32_16x16x32_bf16 a[232:235], v[84:87], v[60:63], a[232:235]
v_lshlrev_b32 v16, 16, v190
v_and_b32 v17, 0xffff0000, v190
v_mfma_f32_16x16x32_bf16 a[236:239], v[88:91], v[56:59], a[236:239]
v_mul_f32 v12, v12, v16
v_mfma_f32_16x16x32_bf16 a[236:239], v[92:95], v[60:63], a[236:239]
v_mul_f32 v13, v13, v17
s_waitcnt lgkmcnt(2)
v_mfma_f32_16x16x32_bf16 a[240:243], v[64:67], v[40:43], a[240:243]
ds_read_b128 v[56:59], v2 offset:51200
v_mfma_f32_16x16x32_bf16 a[240:243], v[68:71], v[44:47], a[240:243]
ds_read_b128 v[60:63], v3 offset:51200
v_mfma_f32_16x16x32_bf16 a[244:247], v[72:75], v[40:43], a[244:247]
v_cvt_pk_bf16_f32 v26, v12, v13
v_accvgpr_read_b32 v14, a123
v_mfma_f32_16x16x32_bf16 a[244:247], v[76:79], v[44:47], a[244:247]
v_accvgpr_read_b32 v15, a127
v_mfma_f32_16x16x32_bf16 a[248:251], v[80:83], v[40:43], a[248:251]
v_lshlrev_b32 v18, 16, v191
v_and_b32 v19, 0xffff0000, v191
v_mfma_f32_16x16x32_bf16 a[248:251], v[84:87], v[44:47], a[248:251]
v_mul_f32 v14, v14, v18
v_mfma_f32_16x16x32_bf16 a[252:255], v[88:91], v[40:43], a[252:255]
v_mul_f32 v15, v15, v19
v_cvt_pk_bf16_f32 v27, v14, v15
v_mfma_f32_16x16x32_bf16 a[252:255], v[92:95], v[44:47], a[252:255]
ds_write_b128 v5, v[24:27] offset:2048
s_waitcnt vmcnt(8) lgkmcnt(3)
v_mfma_f32_16x16x32_bf16 a[128:131], v[96:99], v[48:51], a[128:131]
ds_read_b128 v[40:43], v2 offset:53248
v_mfma_f32_16x16x32_bf16 a[128:131], v[100:103], v[52:55], a[128:131]
ds_read_b128 v[44:47], v3 offset:53248
s_waitcnt vmcnt(6)
v_mfma_f32_16x16x32_bf16 a[132:135], v[104:107], v[48:51], a[132:135]
ds_read_b128 v[32:35], v6 offset:2048
v_mfma_f32_16x16x32_bf16 a[132:135], v[108:111], v[52:55], a[132:135]
ds_read_b128 v[36:39], v7 offset:3072
s_waitcnt vmcnt(4)
v_mfma_f32_16x16x32_bf16 a[136:139], v[112:115], v[48:51], a[136:139]
s_waitcnt lgkmcnt(0)
buffer_store_dwordx4 v[32:35], v9, s[16:19], s36 offen sc1
v_mfma_f32_16x16x32_bf16 a[136:139], v[116:119], v[52:55], a[136:139]
s_add_u32 s36, s36, 0x4000
s_waitcnt vmcnt(3)
v_mfma_f32_16x16x32_bf16 a[140:143], v[120:123], v[48:51], a[140:143]
v_mfma_f32_16x16x32_bf16 a[140:143], v[124:127], v[52:55], a[140:143]
buffer_store_dwordx4 v[36:39], v9, s[16:19], s36 offen sc1
s_add_u32 s36, s36, 0x4000
v_mfma_f32_16x16x32_bf16 a[144:147], v[96:99], v[56:59], a[144:147]
ds_read_b128 v[48:51], v2 offset:55296
v_mfma_f32_16x16x32_bf16 a[144:147], v[100:103], v[60:63], a[144:147]
ds_read_b128 v[52:55], v3 offset:55296
v_mfma_f32_16x16x32_bf16 a[148:151], v[104:107], v[56:59], a[148:151]
s_add_u32 s36, s37, 512
v_accvgpr_read_b32 v12, a128
v_accvgpr_read_b32 v13, a132
v_lshlrev_b32 v16, 16, v192
v_mfma_f32_16x16x32_bf16 a[148:151], v[108:111], v[60:63], a[148:151]
v_and_b32 v17, 0xffff0000, v192
v_mul_f32 v12, v12, v16
v_mul_f32 v13, v13, v17
v_cvt_pk_bf16_f32 v20, v12, v13
v_accvgpr_read_b32 v14, a136
v_mfma_f32_16x16x32_bf16 a[152:155], v[112:115], v[56:59], a[152:155]
v_accvgpr_read_b32 v15, a140
v_lshlrev_b32 v18, 16, v193
v_and_b32 v19, 0xffff0000, v193
v_mul_f32 v14, v14, v18
v_mfma_f32_16x16x32_bf16 a[152:155], v[116:119], v[60:63], a[152:155]
v_mul_f32 v15, v15, v19
v_cvt_pk_bf16_f32 v21, v14, v15
v_accvgpr_read_b32 v12, a129
v_accvgpr_read_b32 v13, a133
v_lshlrev_b32 v16, 16, v194
v_mfma_f32_16x16x32_bf16 a[156:159], v[120:123], v[56:59], a[156:159]
v_and_b32 v17, 0xffff0000, v194
v_mul_f32 v12, v12, v16
v_mul_f32 v13, v13, v17
v_cvt_pk_bf16_f32 v22, v12, v13
v_mfma_f32_16x16x32_bf16 a[156:159], v[124:127], v[60:63], a[156:159]
v_accvgpr_read_b32 v14, a137
v_accvgpr_read_b32 v15, a141
v_lshlrev_b32 v18, 16, v195
v_and_b32 v19, 0xffff0000, v195
v_mul_f32 v14, v14, v18
v_mfma_f32_16x16x32_bf16 a[160:163], v[96:99], v[40:43], a[160:163]
ds_read_b128 v[56:59], v2 offset:57344
v_mul_f32 v15, v15, v19
v_cvt_pk_bf16_f32 v23, v14, v15
ds_write_b128 v4, v[20:23] offset:0
v_mfma_f32_16x16x32_bf16 a[160:163], v[100:103], v[44:47], a[160:163]
ds_read_b128 v[60:63], v3 offset:57344
v_accvgpr_read_b32 v12, a130
v_accvgpr_read_b32 v13, a134
v_lshlrev_b32 v16, 16, v196
v_and_b32 v17, 0xffff0000, v196
v_mfma_f32_16x16x32_bf16 a[164:167], v[104:107], v[40:43], a[164:167]
v_mul_f32 v12, v12, v16
v_mul_f32 v13, v13, v17
v_cvt_pk_bf16_f32 v24, v12, v13
v_accvgpr_read_b32 v14, a138
v_mfma_f32_16x16x32_bf16 a[164:167], v[108:111], v[44:47], a[164:167]
v_accvgpr_read_b32 v15, a142
v_lshlrev_b32 v18, 16, v197
v_and_b32 v19, 0xffff0000, v197
v_mul_f32 v14, v14, v18
v_mul_f32 v15, v15, v19
v_mfma_f32_16x16x32_bf16 a[168:171], v[112:115], v[40:43], a[168:171]
v_cvt_pk_bf16_f32 v25, v14, v15
v_accvgpr_read_b32 v12, a131
v_accvgpr_read_b32 v13, a135
v_lshlrev_b32 v16, 16, v198
v_mfma_f32_16x16x32_bf16 a[168:171], v[116:119], v[44:47], a[168:171]
v_and_b32 v17, 0xffff0000, v198
v_mul_f32 v12, v12, v16
v_mul_f32 v13, v13, v17
v_cvt_pk_bf16_f32 v26, v12, v13
v_accvgpr_read_b32 v14, a139
v_mfma_f32_16x16x32_bf16 a[172:175], v[120:123], v[40:43], a[172:175]
v_accvgpr_read_b32 v15, a143
v_lshlrev_b32 v18, 16, v199
v_and_b32 v19, 0xffff0000, v199
v_mul_f32 v14, v14, v18
v_mfma_f32_16x16x32_bf16 a[172:175], v[124:127], v[44:47], a[172:175]
v_mul_f32 v15, v15, v19
v_cvt_pk_bf16_f32 v27, v14, v15
ds_write_b128 v5, v[24:27] offset:0
ds_read_b128 v[32:35], v6 offset:0
ds_read_b128 v[36:39], v7 offset:1024
s_waitcnt lgkmcnt(6)
v_mfma_f32_16x16x32_bf16 a[176:179], v[96:99], v[48:51], a[176:179]
ds_read_b128 v[40:43], v2 offset:59392
v_accvgpr_read_b32 v12, a144
v_accvgpr_read_b32 v13, a148
v_mfma_f32_16x16x32_bf16 a[176:179], v[100:103], v[52:55], a[176:179]
ds_read_b128 v[44:47], v3 offset:59392
v_lshlrev_b32 v16, 16, v200
v_and_b32 v17, 0xffff0000, v200
v_mul_f32 v12, v12, v16
v_mul_f32 v13, v13, v17
v_mfma_f32_16x16x32_bf16 a[180:183], v[104:107], v[48:51], a[180:183]
v_cvt_pk_bf16_f32 v20, v12, v13
v_accvgpr_read_b32 v14, a152
v_accvgpr_read_b32 v15, a156
v_lshlrev_b32 v18, 16, v201
v_mfma_f32_16x16x32_bf16 a[180:183], v[108:111], v[52:55], a[180:183]
v_and_b32 v19, 0xffff0000, v201
v_mul_f32 v14, v14, v18
v_mul_f32 v15, v15, v19
v_cvt_pk_bf16_f32 v21, v14, v15
v_accvgpr_read_b32 v12, a145
v_mfma_f32_16x16x32_bf16 a[184:187], v[112:115], v[48:51], a[184:187]
v_accvgpr_read_b32 v13, a149
v_lshlrev_b32 v16, 16, v202
v_and_b32 v17, 0xffff0000, v202
v_mul_f32 v12, v12, v16
v_mfma_f32_16x16x32_bf16 a[184:187], v[116:119], v[52:55], a[184:187]
v_mul_f32 v13, v13, v17
v_cvt_pk_bf16_f32 v22, v12, v13
v_accvgpr_read_b32 v14, a153
v_accvgpr_read_b32 v15, a157
v_lshlrev_b32 v18, 16, v203
v_mfma_f32_16x16x32_bf16 a[188:191], v[120:123], v[48:51], a[188:191]
v_and_b32 v19, 0xffff0000, v203
v_mul_f32 v14, v14, v18
v_mul_f32 v15, v15, v19
v_cvt_pk_bf16_f32 v23, v14, v15
v_mfma_f32_16x16x32_bf16 a[188:191], v[124:127], v[52:55], a[188:191]
ds_write_b128 v4, v[20:23] offset:2048
s_waitcnt lgkmcnt(3)
buffer_store_dwordx4 v[32:35], v9, s[16:19], s36 offen sc1
s_add_u32 s36, s36, 0x4000
buffer_store_dwordx4 v[36:39], v9, s[16:19], s36 offen sc1
s_add_u32 s36, s36, 0x4000
v_mfma_f32_16x16x32_bf16 a[192:195], v[96:99], v[56:59], a[192:195]
ds_read_b128 v[48:51], v2 offset:61440
v_accvgpr_read_b32 v12, a146
v_accvgpr_read_b32 v13, a150
v_lshlrev_b32 v16, 16, v204
v_mfma_f32_16x16x32_bf16 a[192:195], v[100:103], v[60:63], a[192:195]
ds_read_b128 v[52:55], v3 offset:61440
v_and_b32 v17, 0xffff0000, v204
v_mul_f32 v12, v12, v16
v_mul_f32 v13, v13, v17
v_cvt_pk_bf16_f32 v24, v12, v13
v_mfma_f32_16x16x32_bf16 a[196:199], v[104:107], v[56:59], a[196:199]
v_accvgpr_read_b32 v14, a154
v_accvgpr_read_b32 v15, a158
v_lshlrev_b32 v18, 16, v205
v_and_b32 v19, 0xffff0000, v205
v_mfma_f32_16x16x32_bf16 a[196:199], v[108:111], v[60:63], a[196:199]
v_mul_f32 v14, v14, v18
v_mul_f32 v15, v15, v19
v_cvt_pk_bf16_f32 v25, v14, v15
v_accvgpr_read_b32 v12, a147
v_accvgpr_read_b32 v13, a151
v_mfma_f32_16x16x32_bf16 a[200:203], v[112:115], v[56:59], a[200:203]
v_lshlrev_b32 v16, 16, v206
v_and_b32 v17, 0xffff0000, v206
v_mul_f32 v12, v12, v16
v_mul_f32 v13, v13, v17
v_mfma_f32_16x16x32_bf16 a[200:203], v[116:119], v[60:63], a[200:203]
v_cvt_pk_bf16_f32 v26, v12, v13
v_accvgpr_read_b32 v14, a155
v_accvgpr_read_b32 v15, a159
v_lshlrev_b32 v18, 16, v207
v_and_b32 v19, 0xffff0000, v207
v_mfma_f32_16x16x32_bf16 a[204:207], v[120:123], v[56:59], a[204:207]
v_mul_f32 v14, v14, v18
v_mul_f32 v15, v15, v19
v_cvt_pk_bf16_f32 v27, v14, v15
ds_write_b128 v5, v[24:27] offset:2048
v_mfma_f32_16x16x32_bf16 a[204:207], v[124:127], v[60:63], a[204:207]
ds_read_b128 v[32:35], v6 offset:2048
ds_read_b128 v[36:39], v7 offset:3072
v_accvgpr_read_b32 v12, a160
v_accvgpr_read_b32 v13, a164
v_lshlrev_b32 v16, 16, v208
s_waitcnt lgkmcnt(6)
v_mfma_f32_16x16x32_bf16 a[208:211], v[96:99], v[40:43], a[208:211]
ds_read_b128 v[56:59], v2 offset:63488
v_and_b32 v17, 0xffff0000, v208
v_mul_f32 v12, v12, v16
v_mfma_f32_16x16x32_bf16 a[208:211], v[100:103], v[44:47], a[208:211]
ds_read_b128 v[60:63], v3 offset:63488
v_mul_f32 v13, v13, v17
v_cvt_pk_bf16_f32 v20, v12, v13
v_accvgpr_read_b32 v14, a168
v_accvgpr_read_b32 v15, a172
v_mfma_f32_16x16x32_bf16 a[212:215], v[104:107], v[40:43], a[212:215]
v_lshlrev_b32 v18, 16, v209
v_and_b32 v19, 0xffff0000, v209
v_mul_f32 v14, v14, v18
v_mul_f32 v15, v15, v19
v_mfma_f32_16x16x32_bf16 a[212:215], v[108:111], v[44:47], a[212:215]
v_cvt_pk_bf16_f32 v21, v14, v15
v_accvgpr_read_b32 v12, a161
v_accvgpr_read_b32 v13, a165
v_lshlrev_b32 v16, 16, v210
v_and_b32 v17, 0xffff0000, v210
v_mfma_f32_16x16x32_bf16 a[216:219], v[112:115], v[40:43], a[216:219]
v_mul_f32 v12, v12, v16
v_mul_f32 v13, v13, v17
v_cvt_pk_bf16_f32 v22, v12, v13
v_accvgpr_read_b32 v14, a169
v_mfma_f32_16x16x32_bf16 a[216:219], v[116:119], v[44:47], a[216:219]
v_accvgpr_read_b32 v15, a173
v_lshlrev_b32 v18, 16, v211
v_and_b32 v19, 0xffff0000, v211
v_mul_f32 v14, v14, v18
v_mul_f32 v15, v15, v19
v_mfma_f32_16x16x32_bf16 a[220:223], v[120:123], v[40:43], a[220:223]
v_cvt_pk_bf16_f32 v23, v14, v15
ds_write_b128 v4, v[20:23] offset:0
s_waitcnt lgkmcnt(3)
buffer_store_dwordx4 v[32:35], v9, s[16:19], s36 offen sc1
s_add_u32 s36, s36, 0x4000
v_mfma_f32_16x16x32_bf16 a[220:223], v[124:127], v[44:47], a[220:223]
buffer_store_dwordx4 v[36:39], v9, s[16:19], s36 offen sc1
s_add_u32 s36, s36, 0x4000
v_accvgpr_read_b32 v12, a162
v_accvgpr_read_b32 v13, a166
v_lshlrev_b32 v16, 16, v212
v_mfma_f32_16x16x32_bf16 a[224:227], v[96:99], v[48:51], a[224:227]
v_and_b32 v17, 0xffff0000, v212
v_mul_f32 v12, v12, v16
v_mul_f32 v13, v13, v17
v_cvt_pk_bf16_f32 v24, v12, v13
v_mfma_f32_16x16x32_bf16 a[224:227], v[100:103], v[52:55], a[224:227]
v_accvgpr_read_b32 v14, a170
v_accvgpr_read_b32 v15, a174
v_lshlrev_b32 v18, 16, v213
v_and_b32 v19, 0xffff0000, v213
v_mul_f32 v14, v14, v18
v_mfma_f32_16x16x32_bf16 a[228:231], v[104:107], v[48:51], a[228:231]
v_mul_f32 v15, v15, v19
v_cvt_pk_bf16_f32 v25, v14, v15
v_accvgpr_read_b32 v12, a163
v_accvgpr_read_b32 v13, a167
v_mfma_f32_16x16x32_bf16 a[228:231], v[108:111], v[52:55], a[228:231]
v_lshlrev_b32 v16, 16, v214
v_and_b32 v17, 0xffff0000, v214
v_mul_f32 v12, v12, v16
v_mul_f32 v13, v13, v17
v_cvt_pk_bf16_f32 v26, v12, v13
v_mfma_f32_16x16x32_bf16 a[232:235], v[112:115], v[48:51], a[232:235]
v_accvgpr_read_b32 v14, a171
v_accvgpr_read_b32 v15, a175
v_lshlrev_b32 v18, 16, v215
v_and_b32 v19, 0xffff0000, v215
v_mfma_f32_16x16x32_bf16 a[232:235], v[116:119], v[52:55], a[232:235]
v_mul_f32 v14, v14, v18
v_mul_f32 v15, v15, v19
v_cvt_pk_bf16_f32 v27, v14, v15
ds_write_b128 v5, v[24:27] offset:0
ds_read_b128 v[32:35], v6 offset:0
v_mfma_f32_16x16x32_bf16 a[236:239], v[120:123], v[48:51], a[236:239]
ds_read_b128 v[36:39], v7 offset:1024
v_accvgpr_read_b32 v12, a176
v_accvgpr_read_b32 v13, a180
v_lshlrev_b32 v16, 16, v216
v_mfma_f32_16x16x32_bf16 a[236:239], v[124:127], v[52:55], a[236:239]
v_and_b32 v17, 0xffff0000, v216
v_mul_f32 v12, v12, v16
v_mul_f32 v13, v13, v17
v_cvt_pk_bf16_f32 v20, v12, v13
v_accvgpr_read_b32 v14, a184
s_waitcnt lgkmcnt(4)
v_mfma_f32_16x16x32_bf16 a[240:243], v[96:99], v[56:59], a[240:243]
v_accvgpr_read_b32 v15, a188
v_lshlrev_b32 v18, 16, v217
v_and_b32 v19, 0xffff0000, v217
v_mfma_f32_16x16x32_bf16 a[240:243], v[100:103], v[60:63], a[240:243]
v_mul_f32 v14, v14, v18
v_mul_f32 v15, v15, v19
v_cvt_pk_bf16_f32 v21, v14, v15
v_accvgpr_read_b32 v12, a177
v_accvgpr_read_b32 v13, a181
v_mfma_f32_16x16x32_bf16 a[244:247], v[104:107], v[56:59], a[244:247]
v_lshlrev_b32 v16, 16, v218
v_and_b32 v17, 0xffff0000, v218
v_mul_f32 v12, v12, v16
v_mul_f32 v13, v13, v17
v_mfma_f32_16x16x32_bf16 a[244:247], v[108:111], v[60:63], a[244:247]
v_cvt_pk_bf16_f32 v22, v12, v13
v_accvgpr_read_b32 v14, a185
v_accvgpr_read_b32 v15, a189
v_lshlrev_b32 v18, 16, v219
v_and_b32 v19, 0xffff0000, v219
v_mfma_f32_16x16x32_bf16 a[248:251], v[112:115], v[56:59], a[248:251]
v_mul_f32 v14, v14, v18
v_mul_f32 v15, v15, v19
v_cvt_pk_bf16_f32 v23, v14, v15
ds_write_b128 v4, v[20:23] offset:2048
v_mfma_f32_16x16x32_bf16 a[248:251], v[116:119], v[60:63], a[248:251]
s_waitcnt lgkmcnt(1)
buffer_store_dwordx4 v[32:35], v9, s[16:19], s36 offen sc1
s_add_u32 s36, s36, 0x4000
buffer_store_dwordx4 v[36:39], v9, s[16:19], s36 offen sc1
s_add_u32 s36, s36, 0x4000
v_accvgpr_read_b32 v12, a178
v_mfma_f32_16x16x32_bf16 a[252:255], v[120:123], v[56:59], a[252:255]
v_accvgpr_read_b32 v13, a182
v_lshlrev_b32 v16, 16, v220
v_and_b32 v17, 0xffff0000, v220
v_mul_f32 v12, v12, v16
v_mfma_f32_16x16x32_bf16 a[252:255], v[124:127], v[60:63], a[252:255]
v_mul_f32 v13, v13, v17
v_cvt_pk_bf16_f32 v24, v12, v13
v_accvgpr_read_b32 v14, a186
v_accvgpr_read_b32 v15, a190
v_lshlrev_b32 v18, 16, v221
s_nop 7
v_and_b32 v19, 0xffff0000, v221
v_mul_f32 v14, v14, v18
v_mul_f32 v15, v15, v19
v_cvt_pk_bf16_f32 v25, v14, v15
v_accvgpr_read_b32 v12, a179
v_accvgpr_read_b32 v13, a183
v_lshlrev_b32 v16, 16, v222
v_and_b32 v17, 0xffff0000, v222
v_mul_f32 v12, v12, v16
v_mul_f32 v13, v13, v17
v_cvt_pk_bf16_f32 v26, v12, v13
v_accvgpr_read_b32 v14, a187
v_accvgpr_read_b32 v15, a191
v_lshlrev_b32 v18, 16, v223
v_and_b32 v19, 0xffff0000, v223
v_mul_f32 v14, v14, v18
v_mul_f32 v15, v15, v19
v_cvt_pk_bf16_f32 v27, v14, v15
ds_write_b128 v5, v[24:27] offset:2048
ds_read_b128 v[32:35], v6 offset:2048
ds_read_b128 v[36:39], v7 offset:3072
v_accvgpr_read_b32 v12, a192
v_accvgpr_read_b32 v13, a196
v_lshlrev_b32 v16, 16, v224
v_and_b32 v17, 0xffff0000, v224
v_mul_f32 v12, v12, v16
v_mul_f32 v13, v13, v17
v_cvt_pk_bf16_f32 v20, v12, v13
v_accvgpr_read_b32 v14, a200
v_accvgpr_read_b32 v15, a204
v_lshlrev_b32 v18, 16, v225
v_and_b32 v19, 0xffff0000, v225
v_mul_f32 v14, v14, v18
v_mul_f32 v15, v15, v19
v_cvt_pk_bf16_f32 v21, v14, v15
v_accvgpr_read_b32 v12, a193
v_accvgpr_read_b32 v13, a197
v_lshlrev_b32 v16, 16, v226
v_and_b32 v17, 0xffff0000, v226
v_mul_f32 v12, v12, v16
v_mul_f32 v13, v13, v17
v_cvt_pk_bf16_f32 v22, v12, v13
v_accvgpr_read_b32 v14, a201
v_accvgpr_read_b32 v15, a205
v_lshlrev_b32 v18, 16, v227
v_and_b32 v19, 0xffff0000, v227
v_mul_f32 v14, v14, v18
v_mul_f32 v15, v15, v19
v_cvt_pk_bf16_f32 v23, v14, v15
ds_write_b128 v4, v[20:23] offset:0
s_waitcnt lgkmcnt(1)
buffer_store_dwordx4 v[32:35], v9, s[16:19], s36 offen sc1
s_add_u32 s36, s36, 0x4000
buffer_store_dwordx4 v[36:39], v9, s[16:19], s36 offen sc1
s_add_u32 s36, s36, 0x4000
v_accvgpr_read_b32 v12, a194
v_accvgpr_read_b32 v13, a198
v_lshlrev_b32 v16, 16, v228
v_and_b32 v17, 0xffff0000, v228
v_mul_f32 v12, v12, v16
v_mul_f32 v13, v13, v17
v_cvt_pk_bf16_f32 v24, v12, v13
v_accvgpr_read_b32 v14, a202
v_accvgpr_read_b32 v15, a206
v_lshlrev_b32 v18, 16, v229
v_and_b32 v19, 0xffff0000, v229
v_mul_f32 v14, v14, v18
v_mul_f32 v15, v15, v19
v_cvt_pk_bf16_f32 v25, v14, v15
v_accvgpr_read_b32 v12, a195
v_accvgpr_read_b32 v13, a199
v_lshlrev_b32 v16, 16, v230
v_and_b32 v17, 0xffff0000, v230
v_mul_f32 v12, v12, v16
v_mul_f32 v13, v13, v17
v_cvt_pk_bf16_f32 v26, v12, v13
v_accvgpr_read_b32 v14, a203
v_accvgpr_read_b32 v15, a207
v_lshlrev_b32 v18, 16, v231
v_and_b32 v19, 0xffff0000, v231
v_mul_f32 v14, v14, v18
v_mul_f32 v15, v15, v19
v_cvt_pk_bf16_f32 v27, v14, v15
ds_write_b128 v5, v[24:27] offset:0
ds_read_b128 v[32:35], v6 offset:0
ds_read_b128 v[36:39], v7 offset:1024
v_accvgpr_read_b32 v12, a208
v_accvgpr_read_b32 v13, a212
v_lshlrev_b32 v16, 16, v232
v_and_b32 v17, 0xffff0000, v232
v_mul_f32 v12, v12, v16
v_mul_f32 v13, v13, v17
v_cvt_pk_bf16_f32 v20, v12, v13
v_accvgpr_read_b32 v14, a216
v_accvgpr_read_b32 v15, a220
v_lshlrev_b32 v18, 16, v233
v_and_b32 v19, 0xffff0000, v233
v_mul_f32 v14, v14, v18
v_mul_f32 v15, v15, v19
v_cvt_pk_bf16_f32 v21, v14, v15
v_accvgpr_read_b32 v12, a209
v_accvgpr_read_b32 v13, a213
v_lshlrev_b32 v16, 16, v234
v_and_b32 v17, 0xffff0000, v234
v_mul_f32 v12, v12, v16
v_mul_f32 v13, v13, v17
v_cvt_pk_bf16_f32 v22, v12, v13
v_accvgpr_read_b32 v14, a217
v_accvgpr_read_b32 v15, a221
v_lshlrev_b32 v18, 16, v235
v_and_b32 v19, 0xffff0000, v235
v_mul_f32 v14, v14, v18
v_mul_f32 v15, v15, v19
v_cvt_pk_bf16_f32 v23, v14, v15
ds_write_b128 v4, v[20:23] offset:2048
s_waitcnt lgkmcnt(1)
buffer_store_dwordx4 v[32:35], v9, s[16:19], s36 offen sc1
s_add_u32 s36, s36, 0x4000
buffer_store_dwordx4 v[36:39], v9, s[16:19], s36 offen sc1
s_add_u32 s36, s36, 0x4000
v_accvgpr_read_b32 v12, a210
v_accvgpr_read_b32 v13, a214
v_lshlrev_b32 v16, 16, v236
v_and_b32 v17, 0xffff0000, v236
v_mul_f32 v12, v12, v16
v_mul_f32 v13, v13, v17
v_cvt_pk_bf16_f32 v24, v12, v13
v_accvgpr_read_b32 v14, a218
v_accvgpr_read_b32 v15, a222
v_lshlrev_b32 v18, 16, v237
v_and_b32 v19, 0xffff0000, v237
v_mul_f32 v14, v14, v18
v_mul_f32 v15, v15, v19
v_cvt_pk_bf16_f32 v25, v14, v15
v_accvgpr_read_b32 v12, a211
v_accvgpr_read_b32 v13, a215
v_lshlrev_b32 v16, 16, v238
v_and_b32 v17, 0xffff0000, v238
v_mul_f32 v12, v12, v16
v_mul_f32 v13, v13, v17
v_cvt_pk_bf16_f32 v26, v12, v13
v_accvgpr_read_b32 v14, a219
v_accvgpr_read_b32 v15, a223
v_lshlrev_b32 v18, 16, v239
v_and_b32 v19, 0xffff0000, v239
v_mul_f32 v14, v14, v18
v_mul_f32 v15, v15, v19
v_cvt_pk_bf16_f32 v27, v14, v15
ds_write_b128 v5, v[24:27] offset:2048
ds_read_b128 v[32:35], v6 offset:2048
ds_read_b128 v[36:39], v7 offset:3072
v_accvgpr_read_b32 v12, a224
v_accvgpr_read_b32 v13, a228
v_lshlrev_b32 v16, 16, v240
v_and_b32 v17, 0xffff0000, v240
v_mul_f32 v12, v12, v16
v_mul_f32 v13, v13, v17
v_cvt_pk_bf16_f32 v20, v12, v13
v_accvgpr_read_b32 v14, a232
v_accvgpr_read_b32 v15, a236
v_lshlrev_b32 v18, 16, v241
v_and_b32 v19, 0xffff0000, v241
v_mul_f32 v14, v14, v18
v_mul_f32 v15, v15, v19
v_cvt_pk_bf16_f32 v21, v14, v15
v_accvgpr_read_b32 v12, a225
v_accvgpr_read_b32 v13, a229
v_lshlrev_b32 v16, 16, v242
v_and_b32 v17, 0xffff0000, v242
v_mul_f32 v12, v12, v16
v_mul_f32 v13, v13, v17
v_cvt_pk_bf16_f32 v22, v12, v13
v_accvgpr_read_b32 v14, a233
v_accvgpr_read_b32 v15, a237
v_lshlrev_b32 v18, 16, v243
v_and_b32 v19, 0xffff0000, v243
v_mul_f32 v14, v14, v18
v_mul_f32 v15, v15, v19
v_cvt_pk_bf16_f32 v23, v14, v15
ds_write_b128 v4, v[20:23] offset:0
s_waitcnt lgkmcnt(1)
buffer_store_dwordx4 v[32:35], v9, s[16:19], s36 offen sc1
s_add_u32 s36, s36, 0x4000
buffer_store_dwordx4 v[36:39], v9, s[16:19], s36 offen sc1
s_add_u32 s36, s36, 0x4000
v_accvgpr_read_b32 v12, a226
v_accvgpr_read_b32 v13, a230
v_lshlrev_b32 v16, 16, v244
v_and_b32 v17, 0xffff0000, v244
v_mul_f32 v12, v12, v16
v_mul_f32 v13, v13, v17
v_cvt_pk_bf16_f32 v24, v12, v13
v_accvgpr_read_b32 v14, a234
v_accvgpr_read_b32 v15, a238
v_lshlrev_b32 v18, 16, v245
v_and_b32 v19, 0xffff0000, v245
v_mul_f32 v14, v14, v18
v_mul_f32 v15, v15, v19
v_cvt_pk_bf16_f32 v25, v14, v15
v_accvgpr_read_b32 v12, a227
v_accvgpr_read_b32 v13, a231
v_lshlrev_b32 v16, 16, v246
v_and_b32 v17, 0xffff0000, v246
v_mul_f32 v12, v12, v16
v_mul_f32 v13, v13, v17
v_cvt_pk_bf16_f32 v26, v12, v13
v_accvgpr_read_b32 v14, a235
v_accvgpr_read_b32 v15, a239
v_lshlrev_b32 v18, 16, v247
v_and_b32 v19, 0xffff0000, v247
v_mul_f32 v14, v14, v18
v_mul_f32 v15, v15, v19
v_cvt_pk_bf16_f32 v27, v14, v15
ds_write_b128 v5, v[24:27] offset:0
ds_read_b128 v[32:35], v6 offset:0
ds_read_b128 v[36:39], v7 offset:1024
v_accvgpr_read_b32 v12, a240
v_accvgpr_read_b32 v13, a244
v_lshlrev_b32 v16, 16, v248
v_and_b32 v17, 0xffff0000, v248
v_mul_f32 v12, v12, v16
v_mul_f32 v13, v13, v17
v_cvt_pk_bf16_f32 v20, v12, v13
v_accvgpr_read_b32 v14, a248
v_accvgpr_read_b32 v15, a252
v_lshlrev_b32 v18, 16, v249
v_and_b32 v19, 0xffff0000, v249
v_mul_f32 v14, v14, v18
v_mul_f32 v15, v15, v19
v_cvt_pk_bf16_f32 v21, v14, v15
v_accvgpr_read_b32 v12, a241
v_accvgpr_read_b32 v13, a245
v_lshlrev_b32 v16, 16, v250
v_and_b32 v17, 0xffff0000, v250
v_mul_f32 v12, v12, v16
v_mul_f32 v13, v13, v17
v_cvt_pk_bf16_f32 v22, v12, v13
v_accvgpr_read_b32 v14, a249
v_accvgpr_read_b32 v15, a253
v_lshlrev_b32 v18, 16, v251
v_and_b32 v19, 0xffff0000, v251
v_mul_f32 v14, v14, v18
v_mul_f32 v15, v15, v19
v_cvt_pk_bf16_f32 v23, v14, v15
ds_write_b128 v4, v[20:23] offset:2048
s_waitcnt lgkmcnt(1)
buffer_store_dwordx4 v[32:35], v9, s[16:19], s36 offen sc1
s_add_u32 s36, s36, 0x4000
buffer_store_dwordx4 v[36:39], v9, s[16:19], s36 offen sc1
s_add_u32 s36, s36, 0x4000
v_accvgpr_read_b32 v12, a242
v_accvgpr_read_b32 v13, a246
v_lshlrev_b32 v16, 16, v252
v_and_b32 v17, 0xffff0000, v252
v_mul_f32 v12, v12, v16
v_mul_f32 v13, v13, v17
v_cvt_pk_bf16_f32 v24, v12, v13
v_accvgpr_read_b32 v14, a250
v_accvgpr_read_b32 v15, a254
v_lshlrev_b32 v18, 16, v253
v_and_b32 v19, 0xffff0000, v253
v_mul_f32 v14, v14, v18
v_mul_f32 v15, v15, v19
v_cvt_pk_bf16_f32 v25, v14, v15
v_accvgpr_read_b32 v12, a243
v_accvgpr_read_b32 v13, a247
v_lshlrev_b32 v16, 16, v254
v_and_b32 v17, 0xffff0000, v254
v_mul_f32 v12, v12, v16
v_mul_f32 v13, v13, v17
v_cvt_pk_bf16_f32 v26, v12, v13
v_accvgpr_read_b32 v14, a251
v_accvgpr_read_b32 v15, a255
v_lshlrev_b32 v18, 16, v255
v_and_b32 v19, 0xffff0000, v255
v_mul_f32 v14, v14, v18
v_mul_f32 v15, v15, v19
v_cvt_pk_bf16_f32 v27, v14, v15
ds_write_b128 v5, v[24:27] offset:2048
ds_read_b128 v[32:35], v6 offset:2048
ds_read_b128 v[36:39], v7 offset:3072
s_waitcnt lgkmcnt(0)
buffer_store_dwordx4 v[32:35], v9, s[16:19], s36 offen sc1
s_add_u32 s36, s36, 0x4000
buffer_store_dwordx4 v[36:39], v9, s[16:19], s36 offen sc1
s_add_u32 s36, s36, 0x4000
L_done:
s_endpgm
L_end:
.section .rodata,"a"
.p2align 6
.amdhsa_kernel standalone__cross_network_dcn__recsys_kernel
  .amdhsa_next_free_vgpr 512
  .amdhsa_next_free_sgpr 102
  .amdhsa_accum_offset 256
  .amdhsa_group_segment_fixed_size 0
  .amdhsa_kernarg_size 48
  .amdhsa_user_sgpr_count 2
  .amdhsa_user_sgpr_kernarg_segment_ptr 1
  .amdhsa_system_sgpr_workgroup_id_x 1
  .amdhsa_float_denorm_mode_32 3
.end_amdhsa_kernel
```
